```python
import torch

def _softmax(x, axis=-1):
    return torch.softmax(x, dim=axis)
def _gelu(x):
    return torch.nn.functional.gelu(x, approximate="tanh")
def _silu(x):
    return torch.nn.functional.silu(x)
def _sigmoid(x):
    return torch.sigmoid(x)
def _layernorm(x, axis=-1, eps=1e-5):
    m = x.mean(dim=axis, keepdim=True)
    v = x.var(dim=axis, keepdim=True, unbiased=False)
    return (x - m) / torch.sqrt(v + eps)
def _scatter_add(tgt, idx, src, axis=0):
    return tgt.clone().index_add_(axis, idx, src)
def _segment_sum(src, seg, n):
    out = torch.zeros((n,) + src.shape[1:], dtype=src.dtype)
    return out.index_add_(0, seg, src)
def _pad(x, pw):
    flat = tuple(v for pair in reversed(pw) for v in pair)
    return torch.nn.functional.pad(x, flat)

kernel_name = 'sequential_preLN__compressed_kv_cla__dense_activation_relu__prompt'

def setup_inputs():

    _w = (lambda a: (lambda t: t.to(torch.bfloat16) if t.is_floating_point() else t)(torch.as_tensor(a)))
    def _A_setup():
        B, H, Sq, Sk, D, M = 1, 32, 2048, 2048, 128, 576
        Dc = 4 * D
        return {
            "x": _w((lambda *s: torch.randn(*s, dtype=torch.bfloat16) * 0.05)(B, Sq, M)),
            "c_kv": _w((lambda *s: torch.randn(*s, dtype=torch.bfloat16) * 0.4)(B, Sk, Dc)),
            "w_q": _w((lambda *s: torch.randn(*s, dtype=torch.bfloat16) * 3.2)(M, H, D) * (M ** -0.5)),
            "w_uk": _w((lambda *s: torch.randn(*s, dtype=torch.bfloat16) * 3.2)(Dc, H, D) * (Dc ** -0.5)),
            "w_uv": _w((lambda *s: torch.randn(*s, dtype=torch.bfloat16) * 0.4)(Dc, H, D) * (Dc ** -0.5)),
            "w_o": _w((lambda *s: torch.randn(*s, dtype=torch.bfloat16) * 0.4)(H, D, M) * ((H * D) ** -0.5)),
        }
    _A_in = _A_setup()

    def _B_setup():
        B, S, D, Dff = 1, 2048, 576, 4608
        return {
            "x": _w((lambda *s: torch.randn(*s, dtype=torch.bfloat16) * 0.05)(B, S, D)),
            "w1": _w((lambda *s: torch.randn(*s, dtype=torch.bfloat16) * 0.05)(D, Dff)),
            "w2": _w((lambda *s: torch.randn(*s, dtype=torch.bfloat16) * 0.05)(Dff, D)),
        }
    _B_in = _B_setup()

    return {
        "A_x": _A_in["x"],
        "A_c_kv": _A_in["c_kv"],
        "A_w_q": _A_in["w_q"],
        "A_w_uk": _A_in["w_uk"],
        "A_w_uv": _A_in["w_uv"],
        "A_w_o": _A_in["w_o"],
        "B_x": _B_in["x"],
        "B_w1": _B_in["w1"],
        "B_w2": _B_in["w2"],
    }

def reference(A_x, A_c_kv, A_w_q, A_w_uk, A_w_uv, A_w_o, B_x, B_w1, B_w2):
    def _A_ref(x, c_kv, w_q, w_uk, w_uv, w_o):
        B, Sq, M = x.shape[0], x.shape[1], x.shape[2]
        Sk = c_kv.shape[1]
        H, D = w_q.shape[1], w_q.shape[2]
        q = torch.einsum("bqm,mhd->bhqd", x, w_q)
        k = torch.einsum("bkc,chd->bhkd", c_kv, w_uk)
        v = torch.einsum("bkc,chd->bhkd", c_kv, w_uv)
        scores = torch.einsum("bhqd,bhkd->bhqk", q, k) * (D ** -0.5)
        off = Sk - Sq
        qi = torch.arange(Sq)[:, None]
        kj = torch.arange(Sk)[None, :]
        cmask = kj <= (qi + off)
        scores = torch.where(cmask[None, None], scores, -1e9)
        p = _softmax(scores, axis=-1)
        ctx = torch.einsum("bhqk,bhkd->bhqd", p, v)
        return torch.einsum("bhqd,hdm->bqm", ctx, w_o)

    def _B_ref(x, w1, w2):
        h = torch.einsum("bsd,df->bsf", x, w1)
        zero = torch.zeros_like(h)
        h = torch.maximum(h, zero)
        return torch.einsum("bsf,fd->bsd", h, w2)

    x = A_x
    h = x + _A_ref(_layernorm(x, axis=-1), A_c_kv, A_w_q, A_w_uk, A_w_uv, A_w_o)
    h2 = h + _B_ref(_layernorm(h, axis=-1), B_w1, B_w2)
    return h2
```

```asm
; @launch grid=(256,1,1) block=(256,1,1) lds=163840
.amdgcn_target "amdgcn-amd-amdhsa--gfx950"
.text
.globl sequential_preLN__compressed_kv_cla__dense_activation_relu__prompt_kernel
.p2align 8
.type sequential_preLN__compressed_kv_cla__dense_activation_relu__prompt_kernel,@function
L_end:
s_endpgm
L_xsp0:
buffer_load_dword v7, v6, s[12:15], s7 offen sc1
s_waitcnt vmcnt(0)
v_cmp_ne_u32 vcc, s82, v7
s_sub_u32 s83, s83, 1
s_cselect_b32 s83, 0, s83
s_cselect_b64 vcc, 0, vcc
s_nop 1
s_cbranch_vccnz L_xsp0
s_branch L_xsr0
L_xsp1:
buffer_load_dword v7, v6, s[12:15], s7 offen sc1
s_waitcnt vmcnt(0)
v_cmp_ne_u32 vcc, s82, v7
s_sub_u32 s83, s83, 1
s_cselect_b32 s83, 0, s83
s_cselect_b64 vcc, 0, vcc
s_nop 1
s_cbranch_vccnz L_xsp1
s_branch L_xsr1
L_ksp:
buffer_load_dword v7, v9, s[12:15], s7 offen sc1
s_waitcnt vmcnt(0)
v_cmp_ne_u32 vcc, s82, v7
s_sub_u32 s83, s83, 1
s_cselect_b32 s83, 0, s83
s_cselect_b64 vcc, 0, vcc
s_nop 1
s_cbranch_vccnz L_ksp
s_branch L_ksr
L_k2_redo:
s_mov_b64 exec, -1
s_mov_b32 s82, s60
s_mov_b32 s83, s58
s_load_dwordx16 s[16:31], s[0:1], 0
s_load_dwordx2 s[6:7], s[0:1], 64
s_waitcnt lgkmcnt(0)
s_mov_b32 s50, s20
s_mov_b32 s51, s21
s_cmp_eq_u32 s3, 0
s_cselect_b32 s48, s30, s6
s_cselect_b32 s49, s31, s7
s_mov_b32 s43, 5308416
s_cmp_eq_u32 s3, 3
s_cselect_b32 s48, s26, s48
s_cselect_b32 s49, s27, s49
s_cselect_b32 s43, 4718592, s43
s_cmp_eq_u32 s3, 2
s_cselect_b32 s43, 0, s43
s_and_b32 s60, s2, 7
s_lshr_b32 s61, s2, 3
s_and_b32 s62, s61, 3
s_lshr_b32 s25, s61, 2
s_lshl_b32 s24, s60, 2
s_add_u32 s24, s24, s62
s_mov_b32 s29, 0
s_sub_u32 s60, 15, s25
s_lshl_b32 s60, s60, 1
s_and_b32 s61, s3, 1
s_add_u32 s60, s60, s61
s_lshl_b32 s62, s25, 1
s_add_u32 s62, s62, 3
s_sub_u32 s62, s62, s3
s_cmp_lt_u32 s3, 2
s_cselect_b32 s63, s60, s62
s_cselect_b64 s[52:53], -1, 0
s_lshl_b32 s58, s63, 6
s_lshl_b32 s59, s63, 1
s_add_u32 s59, s59, 2
s_mul_i32 s30, s63, 73728
s_and_b32 s61, s2, 7
s_mul_i32 s61, s61, 2342912
s_lshl_b32 s31, s24, 12
s_add_u32 s61, s61, s31
s_add_u32 s61, s61, 167772160
s_mul_i32 s31, s62, 73728
s_add_u32 s31, s31, s61
s_mul_i32 s32, s60, 73728
s_add_u32 s32, s32, s61
s_and_b32 s60, s3, 1
s_lshr_b32 s61, s3, 1
s_lshl_b32 s56, s61, 18
s_lshl_b32 s62, s60, 7
s_add_u32 s56, s56, s62
s_lshl_b32 s57, s60, 13
s_lshl_b32 s62, s61, 12
s_add_u32 s57, s57, s62
s_lshl_b32 s22, s61, 16
s_lshl_b32 s62, s60, 13
s_add_u32 s22, s22, s62
s_cmp_lt_u32 s3, 2
s_cselect_b32 s21, 1, -1
s_lshl_b32 s21, s21, 13
s_mul_i32 s46, s60, 33554432
s_mul_i32 s63, s24, 524800
s_add_u32 s46, s46, s63
s_mul_i32 s63, s61, 270336
s_add_u32 s46, s46, s63
s_add_u32 s46, s46, 33554432
s_lshl_b32 s62, s25, 15
s_sub_u32 s62, 253952, s62
s_cmp_lt_u32 s3, 2
s_cselect_b32 s18, 270336, s62
s_mov_b32 s19, 0x20000
s_add_u32 s16, s12, s46
s_addc_u32 s17, s13, 0
s_lshl_b32 s62, s24, 8
s_sub_u32 s10, 4718592, s62
s_mov_b32 s11, 0x20000
s_add_u32 s8, s50, s62
s_addc_u32 s9, s51, 0
s_lshl_b32 s6, s2, 7
s_lshl_b32 s60, s3, 2
s_add_u32 s6, s6, s60
s_add_u32 s6, s6, 123731968
s_sub_u32 s60, 3, s3
s_add_u32 s61, s3, 2
s_cmp_lt_u32 s3, 2
s_cselect_b32 s60, s61, s60
s_lshl_b32 s60, s60, 10
s_lshl_b32 s7, s25, 12
s_add_u32 s7, s7, s60
s_add_u32 s7, s7, 123731968
s_mov_b32 s29, 1
v_mov_b32 v48, 0
v_mov_b32 v49, 0
v_mov_b32 v50, 0
v_mov_b32 v51, 0
v_mov_b32 v52, 0
v_mov_b32 v53, 0
v_mov_b32 v54, 0
v_mov_b32 v55, 0
v_mov_b32 v56, 0
v_mov_b32 v57, 0
v_mov_b32 v58, 0
v_mov_b32 v59, 0
v_mov_b32 v60, 0
v_mov_b32 v61, 0
v_mov_b32 v62, 0
v_mov_b32 v63, 0
s_waitcnt vmcnt(0)
s_barrier
L_k2_re:
v_lshrrev_b32 v20, 3, v0
v_bfe_u32 v22, v0, 1, 2
v_and_b32 v23, 1, v0
v_bfe_u32 v21, v0, 4, 1
v_xor_b32 v21, v21, v22
v_lshlrev_b32 v20, 13, v20
v_lshl_add_u32 v20, v23, 4, v20
v_xor_b32 v24, 0, v21
v_lshl_add_u32 v10, v24, 5, v20
v_xor_b32 v24, 2, v21
v_lshl_add_u32 v11, v24, 5, v20
v_add_u32 v11, 64512, v11
v_xor_b32 v24, 0, v21
v_lshl_add_u32 v12, v24, 5, v20
v_add_u32 v12, 129024, v12
v_xor_b32 v24, 2, v21
v_lshl_add_u32 v13, v24, 5, v20
v_add_u32 v13, 193536, v13
v_lshrrev_b32 v20, 4, v0
v_bfe_u32 v21, v0, 2, 2
v_and_b32 v22, 3, v0
v_lshl_add_u32 v23, v20, 3, v21
v_lshlrev_b32 v23, 7, v23
v_lshl_add_u32 v23, v22, 3, v23
v_and_b32 v24, 1, v20
v_lshrrev_b32 v21, 1, v21
v_lshl_or_b32 v24, v24, 1, v21
v_xor_b32 v21, 0, v24
v_lshl_add_u32 v36, v21, 5, v23
v_add_u32 v40, 0x10000, v36
v_add_u32 v44, 0x20000, v36
v_xor_b32 v21, 1, v24
v_lshl_add_u32 v37, v21, 5, v23
v_add_u32 v41, 0x10000, v37
v_add_u32 v45, 0x20000, v37
v_xor_b32 v21, 2, v24
v_lshl_add_u32 v38, v21, 5, v23
v_add_u32 v42, 0x10000, v38
v_add_u32 v46, 0x20000, v38
v_xor_b32 v21, 3, v24
v_lshl_add_u32 v39, v21, 5, v23
v_add_u32 v43, 0x10000, v39
v_add_u32 v47, 0x20000, v39
v_mov_b32 v8, s82
v_and_b32 v20, 3, v0
v_lshlrev_b32 v20, 2, v20
v_lshrrev_b32 v21, 2, v0
v_lshl_add_u32 v9, v21, 11, v20
s_add_u32 s60, s56, 0
s_add_u32 m0, s57, 65536
s_nop 0
buffer_load_dwordx4 v10, s[8:11], s60 offen offset:0 lds
buffer_load_dwordx4 v11, s[8:11], s60 offen offset:1024 lds
buffer_load_dwordx4 v12, s[8:11], s60 offen offset:2048 lds
buffer_load_dwordx4 v13, s[8:11], s60 offen offset:3072 lds
s_add_u32 s60, s56, 524288
s_add_u32 m0, s57, 81920
s_nop 0
buffer_load_dwordx4 v10, s[8:11], s60 offen offset:0 lds
buffer_load_dwordx4 v11, s[8:11], s60 offen offset:1024 lds
buffer_load_dwordx4 v12, s[8:11], s60 offen offset:2048 lds
buffer_load_dwordx4 v13, s[8:11], s60 offen offset:3072 lds
s_add_u32 s60, s56, 1048576
s_add_u32 m0, s57, 98304
s_nop 0
buffer_load_dwordx4 v10, s[8:11], s60 offen offset:0 lds
buffer_load_dwordx4 v11, s[8:11], s60 offen offset:1024 lds
buffer_load_dwordx4 v12, s[8:11], s60 offen offset:2048 lds
buffer_load_dwordx4 v13, s[8:11], s60 offen offset:3072 lds
s_add_u32 s60, s56, 1572864
s_add_u32 m0, s57, 114688
s_nop 0
buffer_load_dwordx4 v10, s[8:11], s60 offen offset:0 lds
buffer_load_dwordx4 v11, s[8:11], s60 offen offset:1024 lds
buffer_load_dwordx4 v12, s[8:11], s60 offen offset:2048 lds
buffer_load_dwordx4 v13, s[8:11], s60 offen offset:3072 lds
s_add_u32 s44, s30, 0
s_add_u32 s45, s30, 18432
s_add_u32 s46, s30, 36864
s_add_u32 s47, s30, 55296
buffer_load_dwordx4 a[0:3], v1, s[12:15], s44 offen offset:0 sc1
buffer_load_dwordx4 a[4:7], v1, s[12:15], s45 offen offset:0 sc1
buffer_load_dwordx4 a[8:11], v1, s[12:15], s46 offen offset:0 sc1
buffer_load_dwordx4 a[12:15], v1, s[12:15], s47 offen offset:0 sc1
buffer_load_dwordx4 a[16:19], v1, s[12:15], s44 offen offset:1024 sc1
buffer_load_dwordx4 a[20:23], v1, s[12:15], s45 offen offset:1024 sc1
buffer_load_dwordx4 a[24:27], v1, s[12:15], s46 offen offset:1024 sc1
buffer_load_dwordx4 a[28:31], v1, s[12:15], s47 offen offset:1024 sc1
buffer_load_dwordx4 a[32:35], v1, s[12:15], s44 offen offset:2048 sc1
buffer_load_dwordx4 a[36:39], v1, s[12:15], s45 offen offset:2048 sc1
buffer_load_dwordx4 a[40:43], v1, s[12:15], s46 offen offset:2048 sc1
buffer_load_dwordx4 a[44:47], v1, s[12:15], s47 offen offset:2048 sc1
buffer_load_dwordx4 a[48:51], v1, s[12:15], s44 offen offset:3072 sc1
buffer_load_dwordx4 a[52:55], v1, s[12:15], s45 offen offset:3072 sc1
buffer_load_dwordx4 a[56:59], v1, s[12:15], s46 offen offset:3072 sc1
buffer_load_dwordx4 a[60:63], v1, s[12:15], s47 offen offset:3072 sc1
s_add_u32 s44, s30, 4096
s_add_u32 s45, s30, 22528
s_add_u32 s46, s30, 40960
s_add_u32 s47, s30, 59392
buffer_load_dwordx4 a[64:67], v1, s[12:15], s44 offen offset:0 sc1
buffer_load_dwordx4 a[68:71], v1, s[12:15], s45 offen offset:0 sc1
buffer_load_dwordx4 a[72:75], v1, s[12:15], s46 offen offset:0 sc1
buffer_load_dwordx4 a[76:79], v1, s[12:15], s47 offen offset:0 sc1
s_waitcnt vmcnt(0)
s_barrier
ds_read_b64_tr_b16 v[64:65], v40 offset:0
ds_read_b64_tr_b16 v[66:67], v40 offset:512
ds_read_b64_tr_b16 v[68:69], v40 offset:4096
ds_read_b64_tr_b16 v[70:71], v40 offset:4608
ds_read_b64_tr_b16 v[72:73], v41 offset:0
ds_read_b64_tr_b16 v[74:75], v41 offset:512
ds_read_b64_tr_b16 v[76:77], v41 offset:4096
ds_read_b64_tr_b16 v[78:79], v41 offset:4608
s_waitcnt lgkmcnt(4)
v_mfma_f32_16x16x32_bf16 v[128:131], v[64:67], a[0:3], 0
ds_read_b64_tr_b16 v[80:81], v42 offset:0
v_mfma_f32_16x16x32_bf16 v[128:131], v[68:71], a[16:19], v[128:131]
ds_read_b64_tr_b16 v[82:83], v42 offset:512
v_mfma_f32_16x16x32_bf16 v[160:163], v[68:71], a[20:23], 0
ds_read_b64_tr_b16 v[84:85], v42 offset:4096
v_mfma_f32_16x16x32_bf16 v[160:163], v[64:67], a[4:7], v[160:163]
v_mfma_f32_16x16x32_bf16 v[192:195], v[64:67], a[8:11], 0
ds_read_b64_tr_b16 v[86:87], v42 offset:4608
v_mfma_f32_16x16x32_bf16 v[192:195], v[68:71], a[24:27], v[192:195]
v_mfma_f32_16x16x32_bf16 v[224:227], v[68:71], a[28:31], 0
v_mfma_f32_16x16x32_bf16 v[224:227], v[64:67], a[12:15], v[224:227]
s_waitcnt lgkmcnt(4)
v_mfma_f32_16x16x32_bf16 v[132:135], v[72:75], a[0:3], 0
ds_read_b64_tr_b16 v[64:65], v43 offset:0
v_mfma_f32_16x16x32_bf16 v[132:135], v[76:79], a[16:19], v[132:135]
ds_read_b64_tr_b16 v[66:67], v43 offset:512
v_mfma_f32_16x16x32_bf16 v[164:167], v[76:79], a[20:23], 0
ds_read_b64_tr_b16 v[68:69], v43 offset:4096
v_mfma_f32_16x16x32_bf16 v[164:167], v[72:75], a[4:7], v[164:167]
v_mfma_f32_16x16x32_bf16 v[196:199], v[72:75], a[8:11], 0
ds_read_b64_tr_b16 v[70:71], v43 offset:4608
v_mfma_f32_16x16x32_bf16 v[196:199], v[76:79], a[24:27], v[196:199]
v_mfma_f32_16x16x32_bf16 v[228:231], v[76:79], a[28:31], 0
v_mfma_f32_16x16x32_bf16 v[228:231], v[72:75], a[12:15], v[228:231]
s_waitcnt lgkmcnt(4)
s_branch L_qj
L_k2_maxp:
s_waitcnt vmcnt(0) lgkmcnt(0)
s_barrier
v_lshrrev_b32 v16, 4, v0
v_lshlrev_b32 v16, 2, v16
v_and_b32 v17, 15, v0
v_sub_u32 v16, v17, v16
v_add_u32 v32, s58, v16
v_add_u32 v33, 16, v32
v_add_u32 v34, 32, v32
v_add_u32 v35, 48, v32
v_mov_b32 v28, v5
v_mov_b32 v29, v5
v_mov_b32 v30, v5
v_mov_b32 v31, v5
s_mul_i32 s60, s24, 524800
s_add_u32 s60, s60, 33554432
s_mov_b32 s61, s59
L_k2_maxl:
s_add_u32 s62, s60, 4096
buffer_load_dwordx4 a[64:67], v1, s[12:15], s60 offen offset:0 sc1
buffer_load_dwordx4 a[68:71], v1, s[12:15], s60 offen offset:1024 sc1
buffer_load_dwordx4 a[72:75], v1, s[12:15], s60 offen offset:2048 sc1
buffer_load_dwordx4 a[76:79], v1, s[12:15], s60 offen offset:3072 sc1
buffer_load_dwordx4 a[80:83], v1, s[12:15], s62 offen offset:0 sc1
buffer_load_dwordx4 a[84:87], v1, s[12:15], s62 offen offset:1024 sc1
buffer_load_dwordx4 a[88:91], v1, s[12:15], s62 offen offset:2048 sc1
buffer_load_dwordx4 a[92:95], v1, s[12:15], s62 offen offset:3072 sc1
s_waitcnt vmcnt(0)
v_mfma_f32_16x16x32_bf16 v[96:99], a[64:67], a[192:195], 0
v_mfma_f32_16x16x32_bf16 v[100:103], a[80:83], a[192:195], 0
v_mfma_f32_16x16x32_bf16 v[96:99], a[68:71], a[196:199], v[96:99]
v_mfma_f32_16x16x32_bf16 v[100:103], a[84:87], a[196:199], v[100:103]
v_mfma_f32_16x16x32_bf16 v[96:99], a[72:75], a[200:203], v[96:99]
v_mfma_f32_16x16x32_bf16 v[100:103], a[88:91], a[200:203], v[100:103]
v_mfma_f32_16x16x32_bf16 v[96:99], a[76:79], a[204:207], v[96:99]
v_mfma_f32_16x16x32_bf16 v[100:103], a[92:95], a[204:207], v[100:103]
v_mfma_f32_16x16x32_bf16 v[104:107], a[64:67], a[208:211], 0
v_mfma_f32_16x16x32_bf16 v[108:111], a[80:83], a[208:211], 0
v_mfma_f32_16x16x32_bf16 v[104:107], a[68:71], a[212:215], v[104:107]
v_mfma_f32_16x16x32_bf16 v[108:111], a[84:87], a[212:215], v[108:111]
v_mfma_f32_16x16x32_bf16 v[104:107], a[72:75], a[216:219], v[104:107]
v_mfma_f32_16x16x32_bf16 v[108:111], a[88:91], a[216:219], v[108:111]
v_mfma_f32_16x16x32_bf16 v[104:107], a[76:79], a[220:223], v[104:107]
v_mfma_f32_16x16x32_bf16 v[108:111], a[92:95], a[220:223], v[108:111]
v_mfma_f32_16x16x32_bf16 v[112:115], a[64:67], a[224:227], 0
v_mfma_f32_16x16x32_bf16 v[116:119], a[80:83], a[224:227], 0
v_mfma_f32_16x16x32_bf16 v[112:115], a[68:71], a[228:231], v[112:115]
v_mfma_f32_16x16x32_bf16 v[116:119], a[84:87], a[228:231], v[116:119]
v_mfma_f32_16x16x32_bf16 v[112:115], a[72:75], a[232:235], v[112:115]
v_mfma_f32_16x16x32_bf16 v[116:119], a[88:91], a[232:235], v[116:119]
v_mfma_f32_16x16x32_bf16 v[112:115], a[76:79], a[236:239], v[112:115]
v_mfma_f32_16x16x32_bf16 v[116:119], a[92:95], a[236:239], v[116:119]
v_mfma_f32_16x16x32_bf16 v[120:123], a[64:67], a[240:243], 0
v_mfma_f32_16x16x32_bf16 v[124:127], a[80:83], a[240:243], 0
v_mfma_f32_16x16x32_bf16 v[120:123], a[68:71], a[244:247], v[120:123]
v_mfma_f32_16x16x32_bf16 v[124:127], a[84:87], a[244:247], v[124:127]
v_mfma_f32_16x16x32_bf16 v[120:123], a[72:75], a[248:251], v[120:123]
v_mfma_f32_16x16x32_bf16 v[124:127], a[88:91], a[248:251], v[124:127]
v_mfma_f32_16x16x32_bf16 v[120:123], a[76:79], a[252:255], v[120:123]
v_mfma_f32_16x16x32_bf16 v[124:127], a[92:95], a[252:255], v[124:127]
v_cmp_gt_i32 vcc, 0, v32
s_nop 1
v_cndmask_b32 v96, v96, v5, vcc
v_max_f32 v28, v28, v96
v_cmp_gt_i32 vcc, 1, v32
s_nop 1
v_cndmask_b32 v97, v97, v5, vcc
v_max_f32 v28, v28, v97
v_cmp_gt_i32 vcc, 2, v32
s_nop 1
v_cndmask_b32 v98, v98, v5, vcc
v_max_f32 v28, v28, v98
v_cmp_gt_i32 vcc, 3, v32
s_nop 1
v_cndmask_b32 v99, v99, v5, vcc
v_max_f32 v28, v28, v99
v_cmp_gt_i32 vcc, 16, v32
s_nop 1
v_cndmask_b32 v100, v100, v5, vcc
v_max_f32 v28, v28, v100
v_cmp_gt_i32 vcc, 17, v32
s_nop 1
v_cndmask_b32 v101, v101, v5, vcc
v_max_f32 v28, v28, v101
v_cmp_gt_i32 vcc, 18, v32
s_nop 1
v_cndmask_b32 v102, v102, v5, vcc
v_max_f32 v28, v28, v102
v_cmp_gt_i32 vcc, 19, v32
s_nop 1
v_cndmask_b32 v103, v103, v5, vcc
v_max_f32 v28, v28, v103
v_subrev_u32 v32, 32, v32
v_cmp_gt_i32 vcc, 0, v33
s_nop 1
v_cndmask_b32 v104, v104, v5, vcc
v_max_f32 v29, v29, v104
v_cmp_gt_i32 vcc, 1, v33
s_nop 1
v_cndmask_b32 v105, v105, v5, vcc
v_max_f32 v29, v29, v105
v_cmp_gt_i32 vcc, 2, v33
s_nop 1
v_cndmask_b32 v106, v106, v5, vcc
v_max_f32 v29, v29, v106
v_cmp_gt_i32 vcc, 3, v33
s_nop 1
v_cndmask_b32 v107, v107, v5, vcc
v_max_f32 v29, v29, v107
v_cmp_gt_i32 vcc, 16, v33
s_nop 1
v_cndmask_b32 v108, v108, v5, vcc
v_max_f32 v29, v29, v108
v_cmp_gt_i32 vcc, 17, v33
s_nop 1
v_cndmask_b32 v109, v109, v5, vcc
v_max_f32 v29, v29, v109
v_cmp_gt_i32 vcc, 18, v33
s_nop 1
v_cndmask_b32 v110, v110, v5, vcc
v_max_f32 v29, v29, v110
v_cmp_gt_i32 vcc, 19, v33
s_nop 1
v_cndmask_b32 v111, v111, v5, vcc
v_max_f32 v29, v29, v111
v_subrev_u32 v33, 32, v33
v_cmp_gt_i32 vcc, 0, v34
s_nop 1
v_cndmask_b32 v112, v112, v5, vcc
v_max_f32 v30, v30, v112
v_cmp_gt_i32 vcc, 1, v34
s_nop 1
v_cndmask_b32 v113, v113, v5, vcc
v_max_f32 v30, v30, v113
v_cmp_gt_i32 vcc, 2, v34
s_nop 1
v_cndmask_b32 v114, v114, v5, vcc
v_max_f32 v30, v30, v114
v_cmp_gt_i32 vcc, 3, v34
s_nop 1
v_cndmask_b32 v115, v115, v5, vcc
v_max_f32 v30, v30, v115
v_cmp_gt_i32 vcc, 16, v34
s_nop 1
v_cndmask_b32 v116, v116, v5, vcc
v_max_f32 v30, v30, v116
v_cmp_gt_i32 vcc, 17, v34
s_nop 1
v_cndmask_b32 v117, v117, v5, vcc
v_max_f32 v30, v30, v117
v_cmp_gt_i32 vcc, 18, v34
s_nop 1
v_cndmask_b32 v118, v118, v5, vcc
v_max_f32 v30, v30, v118
v_cmp_gt_i32 vcc, 19, v34
s_nop 1
v_cndmask_b32 v119, v119, v5, vcc
v_max_f32 v30, v30, v119
v_subrev_u32 v34, 32, v34
v_cmp_gt_i32 vcc, 0, v35
s_nop 1
v_cndmask_b32 v120, v120, v5, vcc
v_max_f32 v31, v31, v120
v_cmp_gt_i32 vcc, 1, v35
s_nop 1
v_cndmask_b32 v121, v121, v5, vcc
v_max_f32 v31, v31, v121
v_cmp_gt_i32 vcc, 2, v35
s_nop 1
v_cndmask_b32 v122, v122, v5, vcc
v_max_f32 v31, v31, v122
v_cmp_gt_i32 vcc, 3, v35
s_nop 1
v_cndmask_b32 v123, v123, v5, vcc
v_max_f32 v31, v31, v123
v_cmp_gt_i32 vcc, 16, v35
s_nop 1
v_cndmask_b32 v124, v124, v5, vcc
v_max_f32 v31, v31, v124
v_cmp_gt_i32 vcc, 17, v35
s_nop 1
v_cndmask_b32 v125, v125, v5, vcc
v_max_f32 v31, v31, v125
v_cmp_gt_i32 vcc, 18, v35
s_nop 1
v_cndmask_b32 v126, v126, v5, vcc
v_max_f32 v31, v31, v126
v_cmp_gt_i32 vcc, 19, v35
s_nop 1
v_cndmask_b32 v127, v127, v5, vcc
v_max_f32 v31, v31, v127
v_subrev_u32 v35, 32, v35
s_add_u32 s60, s60, 8192
s_sub_u32 s61, s61, 1
s_cmp_lg_u32 s61, 0
s_cbranch_scc1 L_k2_maxl
v_mov_b32 v16, v28
s_nop 1
v_permlane16_swap_b32 v28, v16
v_max_f32 v28, v28, v16
v_mov_b32 v16, v28
s_nop 1
v_permlane32_swap_b32 v28, v16
v_max_f32 v28, v28, v16
v_sub_f32 v28, 0, v28
v_mov_b32 v48, v28
v_mov_b32 v49, v28
v_mov_b32 v50, v28
v_mov_b32 v51, v28
v_mov_b32 v16, v29
s_nop 1
v_permlane16_swap_b32 v29, v16
v_max_f32 v29, v29, v16
v_mov_b32 v16, v29
s_nop 1
v_permlane32_swap_b32 v29, v16
v_max_f32 v29, v29, v16
v_sub_f32 v29, 0, v29
v_mov_b32 v52, v29
v_mov_b32 v53, v29
v_mov_b32 v54, v29
v_mov_b32 v55, v29
v_mov_b32 v16, v30
s_nop 1
v_permlane16_swap_b32 v30, v16
v_max_f32 v30, v30, v16
v_mov_b32 v16, v30
s_nop 1
v_permlane32_swap_b32 v30, v16
v_max_f32 v30, v30, v16
v_sub_f32 v30, 0, v30
v_mov_b32 v56, v30
v_mov_b32 v57, v30
v_mov_b32 v58, v30
v_mov_b32 v59, v30
v_mov_b32 v16, v31
s_nop 1
v_permlane16_swap_b32 v31, v16
v_max_f32 v31, v31, v16
v_mov_b32 v16, v31
s_nop 1
v_permlane32_swap_b32 v31, v16
v_max_f32 v31, v31, v16
v_sub_f32 v31, 0, v31
v_mov_b32 v60, v31
v_mov_b32 v61, v31
v_mov_b32 v62, v31
v_mov_b32 v63, v31
s_lshl_b32 s60, s3, 10
v_add_u32 v18, s60, v1
v_and_b32 v19, 0x7ff, v18
ds_write_b128 v18, v[28:31]
s_waitcnt lgkmcnt(0)
s_barrier
ds_read_b128 v[14:17], v19
s_waitcnt lgkmcnt(0)
s_barrier
s_mov_b32 s29, 2
s_branch L_k2_re
L_text0:
L_k1_v:
ds_read_b64_tr_b16 v[20:21], v36 offset:0
ds_read_b64_tr_b16 v[22:23], v36 offset:512
ds_read_b64_tr_b16 v[24:25], v36 offset:4096
ds_read_b64_tr_b16 v[26:27], v36 offset:4608
ds_read_b64_tr_b16 v[28:29], v37 offset:0
ds_read_b64_tr_b16 v[30:31], v37 offset:512
ds_read_b64_tr_b16 v[32:33], v37 offset:4096
ds_read_b64_tr_b16 v[34:35], v37 offset:4608
s_waitcnt lgkmcnt(4)
v_mfma_f32_16x16x32_bf16 v[64:67], a[0:3], v[20:23], 0
ds_read_b64_tr_b16 v[240:241], v38 offset:0
v_mfma_f32_16x16x32_bf16 v[64:67], a[16:19], v[24:27], v[64:67]
ds_read_b64_tr_b16 v[242:243], v38 offset:512
v_mfma_f32_16x16x32_bf16 v[68:71], a[20:23], v[24:27], 0
ds_read_b64_tr_b16 v[244:245], v38 offset:4096
s_add_u32 s63, s99, 384
s_bitset0_b32 s63, 10
s_add_u32 m0, s100, 0
v_mfma_f32_16x16x32_bf16 v[68:71], a[4:7], v[20:23], v[68:71]
buffer_load_dwordx4 v48, s[88:91], s63 offen lds
v_mfma_f32_16x16x32_bf16 v[72:75], a[8:11], v[20:23], 0
ds_read_b64_tr_b16 v[246:247], v38 offset:4608
v_mfma_f32_16x16x32_bf16 v[72:75], a[24:27], v[24:27], v[72:75]
v_mfma_f32_16x16x32_bf16 v[76:79], a[28:31], v[24:27], 0
s_add_u32 m0, s100, 1024
v_mfma_f32_16x16x32_bf16 v[76:79], a[12:15], v[20:23], v[76:79]
buffer_load_dwordx4 v49, s[88:91], s63 offen lds
s_waitcnt lgkmcnt(4)
v_mfma_f32_16x16x32_bf16 v[80:83], a[0:3], v[28:31], 0
ds_read_b64_tr_b16 v[24:25], v39 offset:0
v_mfma_f32_16x16x32_bf16 v[80:83], a[16:19], v[32:35], v[80:83]
ds_read_b64_tr_b16 v[26:27], v39 offset:512
v_mfma_f32_16x16x32_bf16 v[84:87], a[20:23], v[32:35], 0
ds_read_b64_tr_b16 v[20:21], v39 offset:4096
s_add_u32 s62, s96, 1572864
s_bitset0_b32 s62, 22
s_add_u32 m0, s98, 49152
v_mfma_f32_16x16x32_bf16 v[84:87], a[4:7], v[28:31], v[84:87]
buffer_load_dwordx4 v10, s[84:87], s62 offen offset:0 lds
v_mfma_f32_16x16x32_bf16 v[88:91], a[8:11], v[28:31], 0
ds_read_b64_tr_b16 v[22:23], v39 offset:4608
v_mfma_f32_16x16x32_bf16 v[88:91], a[24:27], v[32:35], v[88:91]
v_mfma_f32_16x16x32_bf16 v[92:95], a[28:31], v[32:35], 0
s_waitcnt vmcnt(22)
ds_read_b128 a[32:35], v2 offset:8192
v_mfma_f32_16x16x32_bf16 v[92:95], a[12:15], v[28:31], v[92:95]
ds_read_b128 a[36:39], v2 offset:10240
s_waitcnt lgkmcnt(6)
v_mfma_f32_16x16x32_bf16 v[96:99], a[0:3], v[240:243], 0
ds_read_b64_tr_b16 v[32:33], v36 offset:8192
v_mfma_f32_16x16x32_bf16 v[96:99], a[16:19], v[244:247], v[96:99]
ds_read_b64_tr_b16 v[34:35], v36 offset:8704
v_mfma_f32_16x16x32_bf16 v[100:103], a[20:23], v[244:247], 0
ds_read_b64_tr_b16 v[28:29], v36 offset:12288
s_add_u32 m0, s100, 2048
v_mfma_f32_16x16x32_bf16 v[100:103], a[4:7], v[240:243], v[100:103]
buffer_load_dwordx4 v50, s[88:91], s63 offen lds
v_mfma_f32_16x16x32_bf16 v[104:107], a[8:11], v[240:243], 0
ds_read_b64_tr_b16 v[30:31], v36 offset:12800
v_mfma_f32_16x16x32_bf16 v[104:107], a[24:27], v[244:247], v[104:107]
v_mfma_f32_16x16x32_bf16 v[108:111], a[28:31], v[244:247], 0
s_add_u32 m0, s100, 3072
ds_read_b128 a[40:43], v2 offset:12288
v_mfma_f32_16x16x32_bf16 v[108:111], a[12:15], v[240:243], v[108:111]
buffer_load_dwordx4 v51, s[88:91], s63 offen lds
s_waitcnt lgkmcnt(7)
v_mfma_f32_16x16x32_bf16 v[112:115], a[0:3], v[24:27], 0
ds_read_b64_tr_b16 v[244:245], v37 offset:8192
v_mfma_f32_16x16x32_bf16 v[112:115], a[16:19], v[20:23], v[112:115]
ds_read_b64_tr_b16 v[246:247], v37 offset:8704
v_mfma_f32_16x16x32_bf16 v[116:119], a[20:23], v[20:23], 0
ds_read_b64_tr_b16 v[240:241], v37 offset:12288
s_add_u32 m0, s98, 49152
v_mfma_f32_16x16x32_bf16 v[116:119], a[4:7], v[24:27], v[116:119]
buffer_load_dwordx4 v11, s[84:87], s62 offen offset:1024 lds
v_mfma_f32_16x16x32_bf16 v[120:123], a[8:11], v[24:27], 0
ds_read_b64_tr_b16 v[242:243], v37 offset:12800
v_mfma_f32_16x16x32_bf16 v[120:123], a[24:27], v[20:23], v[120:123]
v_mfma_f32_16x16x32_bf16 v[124:127], a[28:31], v[20:23], 0
ds_read_b128 a[44:47], v2 offset:14336
v_mfma_f32_16x16x32_bf16 v[124:127], a[12:15], v[24:27], v[124:127]
ds_read_b128 a[48:51], v3 offset:8192
s_waitcnt lgkmcnt(7)
v_mfma_f32_16x16x32_bf16 v[128:131], a[0:3], v[32:35], 0
ds_read_b64_tr_b16 v[20:21], v38 offset:8192
v_mfma_f32_16x16x32_bf16 v[128:131], a[16:19], v[28:31], v[128:131]
ds_read_b64_tr_b16 v[22:23], v38 offset:8704
v_mfma_f32_16x16x32_bf16 v[132:135], a[20:23], v[28:31], 0
ds_read_b64_tr_b16 v[24:25], v38 offset:12288
s_add_u32 m0, s100, 4096
v_mfma_f32_16x16x32_bf16 v[132:135], a[4:7], v[32:35], v[132:135]
buffer_load_dwordx4 v52, s[88:91], s63 offen lds
v_mfma_f32_16x16x32_bf16 v[136:139], a[8:11], v[32:35], 0
ds_read_b64_tr_b16 v[26:27], v38 offset:12800
v_mfma_f32_16x16x32_bf16 v[136:139], a[24:27], v[28:31], v[136:139]
v_mfma_f32_16x16x32_bf16 v[140:143], a[28:31], v[28:31], 0
s_add_u32 m0, s100, 5120
ds_read_b128 a[52:55], v3 offset:10240
v_mfma_f32_16x16x32_bf16 v[140:143], a[12:15], v[32:35], v[140:143]
buffer_load_dwordx4 v53, s[88:91], s63 offen lds
s_waitcnt lgkmcnt(7)
v_mfma_f32_16x16x32_bf16 v[144:147], a[0:3], v[244:247], 0
ds_read_b64_tr_b16 v[28:29], v39 offset:8192
v_mfma_f32_16x16x32_bf16 v[144:147], a[16:19], v[240:243], v[144:147]
ds_read_b64_tr_b16 v[30:31], v39 offset:8704
v_mfma_f32_16x16x32_bf16 v[148:151], a[20:23], v[240:243], 0
ds_read_b64_tr_b16 v[32:33], v39 offset:12288
s_add_u32 m0, s98, 49152
v_mfma_f32_16x16x32_bf16 v[148:151], a[4:7], v[244:247], v[148:151]
buffer_load_dwordx4 v12, s[84:87], s62 offen offset:2048 lds
v_mfma_f32_16x16x32_bf16 v[152:155], a[8:11], v[244:247], 0
ds_read_b64_tr_b16 v[34:35], v39 offset:12800
v_mfma_f32_16x16x32_bf16 v[152:155], a[24:27], v[240:243], v[152:155]
v_mfma_f32_16x16x32_bf16 v[156:159], a[28:31], v[240:243], 0
ds_read_b128 a[56:59], v3 offset:12288
v_mfma_f32_16x16x32_bf16 v[156:159], a[12:15], v[244:247], v[156:159]
ds_read_b128 a[60:63], v3 offset:14336
s_waitcnt vmcnt(24) lgkmcnt(7)
s_barrier
v_mfma_f32_16x16x32_bf16 v[160:163], a[0:3], v[20:23], 0
ds_read_b64_tr_b16 v[240:241], v36 offset:16384
v_mfma_f32_16x16x32_bf16 v[160:163], a[16:19], v[24:27], v[160:163]
ds_read_b64_tr_b16 v[242:243], v36 offset:16896
v_mfma_f32_16x16x32_bf16 v[164:167], a[20:23], v[24:27], 0
ds_read_b64_tr_b16 v[244:245], v36 offset:20480
s_add_u32 m0, s100, 6144
v_mfma_f32_16x16x32_bf16 v[164:167], a[4:7], v[20:23], v[164:167]
buffer_load_dwordx4 v54, s[88:91], s63 offen lds
v_mfma_f32_16x16x32_bf16 v[168:171], a[8:11], v[20:23], 0
ds_read_b64_tr_b16 v[246:247], v36 offset:20992
v_mfma_f32_16x16x32_bf16 v[168:171], a[24:27], v[24:27], v[168:171]
v_mfma_f32_16x16x32_bf16 v[172:175], a[28:31], v[24:27], 0
s_add_u32 m0, s100, 7168
v_mfma_f32_16x16x32_bf16 v[172:175], a[12:15], v[20:23], v[172:175]
buffer_load_dwordx4 v55, s[88:91], s63 offen lds
s_waitcnt lgkmcnt(6)
v_mfma_f32_16x16x32_bf16 v[176:179], a[0:3], v[28:31], 0
ds_read_b64_tr_b16 v[24:25], v37 offset:16384
v_mfma_f32_16x16x32_bf16 v[176:179], a[16:19], v[32:35], v[176:179]
ds_read_b64_tr_b16 v[26:27], v37 offset:16896
v_mfma_f32_16x16x32_bf16 v[180:183], a[20:23], v[32:35], 0
ds_read_b64_tr_b16 v[20:21], v37 offset:20480
s_add_u32 m0, s98, 49152
v_mfma_f32_16x16x32_bf16 v[180:183], a[4:7], v[28:31], v[180:183]
buffer_load_dwordx4 v13, s[84:87], s62 offen offset:3072 lds
v_mfma_f32_16x16x32_bf16 v[184:187], a[8:11], v[28:31], 0
ds_read_b64_tr_b16 v[22:23], v37 offset:20992
v_mfma_f32_16x16x32_bf16 v[184:187], a[24:27], v[32:35], v[184:187]
v_mfma_f32_16x16x32_bf16 v[188:191], a[28:31], v[32:35], 0
v_mfma_f32_16x16x32_bf16 v[188:191], a[12:15], v[28:31], v[188:191]
s_waitcnt lgkmcnt(4)
v_mfma_f32_16x16x32_bf16 v[64:67], a[32:35], v[240:243], v[64:67]
ds_read_b64_tr_b16 v[32:33], v38 offset:16384
v_mfma_f32_16x16x32_bf16 v[64:67], a[48:51], v[244:247], v[64:67]
ds_read_b64_tr_b16 v[34:35], v38 offset:16896
v_mfma_f32_16x16x32_bf16 v[68:71], a[52:55], v[244:247], v[68:71]
ds_read_b64_tr_b16 v[28:29], v38 offset:20480
s_add_u32 s63, s99, 512
s_bitset0_b32 s63, 10
s_add_u32 m0, s100, 8192
v_mfma_f32_16x16x32_bf16 v[68:71], a[36:39], v[240:243], v[68:71]
buffer_load_dwordx4 v48, s[88:91], s63 offen lds
v_mfma_f32_16x16x32_bf16 v[72:75], a[40:43], v[240:243], v[72:75]
ds_read_b64_tr_b16 v[30:31], v38 offset:20992
v_mfma_f32_16x16x32_bf16 v[72:75], a[56:59], v[244:247], v[72:75]
v_mfma_f32_16x16x32_bf16 v[76:79], a[60:63], v[244:247], v[76:79]
s_add_u32 m0, s100, 9216
v_mfma_f32_16x16x32_bf16 v[76:79], a[44:47], v[240:243], v[76:79]
buffer_load_dwordx4 v49, s[88:91], s63 offen lds
s_waitcnt lgkmcnt(4)
v_mfma_f32_16x16x32_bf16 v[80:83], a[32:35], v[24:27], v[80:83]
ds_read_b64_tr_b16 v[244:245], v39 offset:16384
v_mfma_f32_16x16x32_bf16 v[80:83], a[48:51], v[20:23], v[80:83]
ds_read_b64_tr_b16 v[246:247], v39 offset:16896
v_mfma_f32_16x16x32_bf16 v[84:87], a[52:55], v[20:23], v[84:87]
ds_read_b64_tr_b16 v[240:241], v39 offset:20480
s_add_u32 s62, s96, 2097152
s_bitset0_b32 s62, 22
s_add_u32 m0, s98, 0
v_mfma_f32_16x16x32_bf16 v[84:87], a[36:39], v[24:27], v[84:87]
buffer_load_dwordx4 v10, s[84:87], s62 offen offset:0 lds
v_mfma_f32_16x16x32_bf16 v[88:91], a[40:43], v[24:27], v[88:91]
ds_read_b64_tr_b16 v[242:243], v39 offset:20992
v_mfma_f32_16x16x32_bf16 v[88:91], a[56:59], v[20:23], v[88:91]
v_mfma_f32_16x16x32_bf16 v[92:95], a[60:63], v[20:23], v[92:95]
s_waitcnt vmcnt(22)
ds_read_b128 a[64:67], v2 offset:16384
v_mfma_f32_16x16x32_bf16 v[92:95], a[44:47], v[24:27], v[92:95]
ds_read_b128 a[68:71], v2 offset:18432
s_waitcnt lgkmcnt(6)
v_mfma_f32_16x16x32_bf16 v[96:99], a[32:35], v[32:35], v[96:99]
ds_read_b64_tr_b16 v[20:21], v36 offset:24576
v_mfma_f32_16x16x32_bf16 v[96:99], a[48:51], v[28:31], v[96:99]
ds_read_b64_tr_b16 v[22:23], v36 offset:25088
v_mfma_f32_16x16x32_bf16 v[100:103], a[52:55], v[28:31], v[100:103]
ds_read_b64_tr_b16 v[24:25], v36 offset:28672
s_add_u32 m0, s100, 10240
v_mfma_f32_16x16x32_bf16 v[100:103], a[36:39], v[32:35], v[100:103]
buffer_load_dwordx4 v50, s[88:91], s63 offen lds
v_mfma_f32_16x16x32_bf16 v[104:107], a[40:43], v[32:35], v[104:107]
ds_read_b64_tr_b16 v[26:27], v36 offset:29184
v_mfma_f32_16x16x32_bf16 v[104:107], a[56:59], v[28:31], v[104:107]
v_mfma_f32_16x16x32_bf16 v[108:111], a[60:63], v[28:31], v[108:111]
s_add_u32 m0, s100, 11264
ds_read_b128 a[72:75], v2 offset:20480
v_mfma_f32_16x16x32_bf16 v[108:111], a[44:47], v[32:35], v[108:111]
buffer_load_dwordx4 v51, s[88:91], s63 offen lds
s_waitcnt lgkmcnt(7)
v_mfma_f32_16x16x32_bf16 v[112:115], a[32:35], v[244:247], v[112:115]
ds_read_b64_tr_b16 v[28:29], v37 offset:24576
v_mfma_f32_16x16x32_bf16 v[112:115], a[48:51], v[240:243], v[112:115]
ds_read_b64_tr_b16 v[30:31], v37 offset:25088
v_mfma_f32_16x16x32_bf16 v[116:119], a[52:55], v[240:243], v[116:119]
ds_read_b64_tr_b16 v[32:33], v37 offset:28672
s_add_u32 m0, s98, 0
v_mfma_f32_16x16x32_bf16 v[116:119], a[36:39], v[244:247], v[116:119]
buffer_load_dwordx4 v11, s[84:87], s62 offen offset:1024 lds
v_mfma_f32_16x16x32_bf16 v[120:123], a[40:43], v[244:247], v[120:123]
ds_read_b64_tr_b16 v[34:35], v37 offset:29184
v_mfma_f32_16x16x32_bf16 v[120:123], a[56:59], v[240:243], v[120:123]
v_mfma_f32_16x16x32_bf16 v[124:127], a[60:63], v[240:243], v[124:127]
ds_read_b128 a[76:79], v2 offset:22528
v_mfma_f32_16x16x32_bf16 v[124:127], a[44:47], v[244:247], v[124:127]
ds_read_b128 a[80:83], v3 offset:16384
s_waitcnt lgkmcnt(7)
v_mfma_f32_16x16x32_bf16 v[128:131], a[32:35], v[20:23], v[128:131]
ds_read_b64_tr_b16 v[240:241], v38 offset:24576
v_mfma_f32_16x16x32_bf16 v[128:131], a[48:51], v[24:27], v[128:131]
ds_read_b64_tr_b16 v[242:243], v38 offset:25088
v_mfma_f32_16x16x32_bf16 v[132:135], a[52:55], v[24:27], v[132:135]
ds_read_b64_tr_b16 v[244:245], v38 offset:28672
s_add_u32 m0, s100, 12288
v_mfma_f32_16x16x32_bf16 v[132:135], a[36:39], v[20:23], v[132:135]
buffer_load_dwordx4 v52, s[88:91], s63 offen lds
v_mfma_f32_16x16x32_bf16 v[136:139], a[40:43], v[20:23], v[136:139]
ds_read_b64_tr_b16 v[246:247], v38 offset:29184
v_mfma_f32_16x16x32_bf16 v[136:139], a[56:59], v[24:27], v[136:139]
v_mfma_f32_16x16x32_bf16 v[140:143], a[60:63], v[24:27], v[140:143]
s_add_u32 m0, s100, 13312
ds_read_b128 a[84:87], v3 offset:18432
v_mfma_f32_16x16x32_bf16 v[140:143], a[44:47], v[20:23], v[140:143]
buffer_load_dwordx4 v53, s[88:91], s63 offen lds
s_waitcnt lgkmcnt(7)
v_mfma_f32_16x16x32_bf16 v[144:147], a[32:35], v[28:31], v[144:147]
ds_read_b64_tr_b16 v[24:25], v39 offset:24576
v_mfma_f32_16x16x32_bf16 v[144:147], a[48:51], v[32:35], v[144:147]
ds_read_b64_tr_b16 v[26:27], v39 offset:25088
v_mfma_f32_16x16x32_bf16 v[148:151], a[52:55], v[32:35], v[148:151]
ds_read_b64_tr_b16 v[20:21], v39 offset:28672
s_add_u32 m0, s98, 0
v_mfma_f32_16x16x32_bf16 v[148:151], a[36:39], v[28:31], v[148:151]
buffer_load_dwordx4 v12, s[84:87], s62 offen offset:2048 lds
v_mfma_f32_16x16x32_bf16 v[152:155], a[40:43], v[28:31], v[152:155]
ds_read_b64_tr_b16 v[22:23], v39 offset:29184
v_mfma_f32_16x16x32_bf16 v[152:155], a[56:59], v[32:35], v[152:155]
v_mfma_f32_16x16x32_bf16 v[156:159], a[60:63], v[32:35], v[156:159]
ds_read_b128 a[88:91], v3 offset:20480
v_mfma_f32_16x16x32_bf16 v[156:159], a[44:47], v[28:31], v[156:159]
ds_read_b128 a[92:95], v3 offset:22528
s_waitcnt vmcnt(24) lgkmcnt(7)
s_barrier
v_mfma_f32_16x16x32_bf16 v[160:163], a[32:35], v[240:243], v[160:163]
ds_read_b64_tr_b16 v[32:33], v36 offset:32768
v_mfma_f32_16x16x32_bf16 v[160:163], a[48:51], v[244:247], v[160:163]
ds_read_b64_tr_b16 v[34:35], v36 offset:33280
v_mfma_f32_16x16x32_bf16 v[164:167], a[52:55], v[244:247], v[164:167]
ds_read_b64_tr_b16 v[28:29], v36 offset:36864
s_add_u32 m0, s100, 14336
v_mfma_f32_16x16x32_bf16 v[164:167], a[36:39], v[240:243], v[164:167]
buffer_load_dwordx4 v54, s[88:91], s63 offen lds
v_mfma_f32_16x16x32_bf16 v[168:171], a[40:43], v[240:243], v[168:171]
ds_read_b64_tr_b16 v[30:31], v36 offset:37376
v_mfma_f32_16x16x32_bf16 v[168:171], a[56:59], v[244:247], v[168:171]
v_mfma_f32_16x16x32_bf16 v[172:175], a[60:63], v[244:247], v[172:175]
s_add_u32 m0, s100, 15360
v_mfma_f32_16x16x32_bf16 v[172:175], a[44:47], v[240:243], v[172:175]
buffer_load_dwordx4 v55, s[88:91], s63 offen lds
s_waitcnt lgkmcnt(6)
v_mfma_f32_16x16x32_bf16 v[176:179], a[32:35], v[24:27], v[176:179]
ds_read_b64_tr_b16 v[244:245], v37 offset:32768
v_mfma_f32_16x16x32_bf16 v[176:179], a[48:51], v[20:23], v[176:179]
ds_read_b64_tr_b16 v[246:247], v37 offset:33280
v_mfma_f32_16x16x32_bf16 v[180:183], a[52:55], v[20:23], v[180:183]
ds_read_b64_tr_b16 v[240:241], v37 offset:36864
s_add_u32 m0, s98, 0
v_mfma_f32_16x16x32_bf16 v[180:183], a[36:39], v[24:27], v[180:183]
buffer_load_dwordx4 v13, s[84:87], s62 offen offset:3072 lds
v_mfma_f32_16x16x32_bf16 v[184:187], a[40:43], v[24:27], v[184:187]
ds_read_b64_tr_b16 v[242:243], v37 offset:37376
v_mfma_f32_16x16x32_bf16 v[184:187], a[56:59], v[20:23], v[184:187]
v_mfma_f32_16x16x32_bf16 v[188:191], a[60:63], v[20:23], v[188:191]
v_mfma_f32_16x16x32_bf16 v[188:191], a[44:47], v[24:27], v[188:191]
s_waitcnt lgkmcnt(4)
v_mfma_f32_16x16x32_bf16 v[64:67], a[64:67], v[32:35], v[64:67]
ds_read_b64_tr_b16 v[20:21], v38 offset:32768
s_waitcnt vmcnt(24)
v_mfma_f32_16x16x32_bf16 v[64:67], a[80:83], v[28:31], v[64:67]
ds_read_b64_tr_b16 v[22:23], v38 offset:33280
v_lshlrev_b32 v208, 16, v192
v_mfma_f32_16x16x32_bf16 v[68:71], a[84:87], v[28:31], v[68:71]
ds_read_b64_tr_b16 v[24:25], v38 offset:36864
s_add_u32 s63, s99, 640
s_bitset0_b32 s63, 10
s_add_u32 m0, s100, 16384
v_mfma_f32_16x16x32_bf16 v[68:71], a[68:71], v[32:35], v[68:71]
buffer_load_dwordx4 v48, s[88:91], s63 offen lds
v_and_b32 v209, 0xffff0000, v192
v_mfma_f32_16x16x32_bf16 v[72:75], a[72:75], v[32:35], v[72:75]
ds_read_b64_tr_b16 v[26:27], v38 offset:37376
v_lshlrev_b32 v210, 16, v193
v_mfma_f32_16x16x32_bf16 v[72:75], a[88:91], v[28:31], v[72:75]
v_and_b32 v211, 0xffff0000, v193
v_mfma_f32_16x16x32_bf16 v[76:79], a[92:95], v[28:31], v[76:79]
s_add_u32 m0, s100, 17408
v_lshlrev_b32 v212, 16, v194
v_mfma_f32_16x16x32_bf16 v[76:79], a[76:79], v[32:35], v[76:79]
buffer_load_dwordx4 v49, s[88:91], s63 offen lds
v_and_b32 v213, 0xffff0000, v194
s_waitcnt lgkmcnt(4)
v_mfma_f32_16x16x32_bf16 v[80:83], a[64:67], v[244:247], v[80:83]
ds_read_b64_tr_b16 v[28:29], v39 offset:32768
v_lshlrev_b32 v214, 16, v195
v_mfma_f32_16x16x32_bf16 v[80:83], a[80:83], v[240:243], v[80:83]
ds_read_b64_tr_b16 v[30:31], v39 offset:33280
v_and_b32 v215, 0xffff0000, v195
v_mfma_f32_16x16x32_bf16 v[84:87], a[84:87], v[240:243], v[84:87]
ds_read_b64_tr_b16 v[32:33], v39 offset:36864
s_add_u32 s62, s96, 2621440
s_bitset0_b32 s62, 22
s_add_u32 m0, s98, 16384
v_mfma_f32_16x16x32_bf16 v[84:87], a[68:71], v[244:247], v[84:87]
buffer_load_dwordx4 v10, s[84:87], s62 offen offset:0 lds
v_lshlrev_b32 v216, 16, v196
v_mfma_f32_16x16x32_bf16 v[88:91], a[72:75], v[244:247], v[88:91]
ds_read_b64_tr_b16 v[34:35], v39 offset:37376
v_and_b32 v217, 0xffff0000, v196
v_mfma_f32_16x16x32_bf16 v[88:91], a[88:91], v[240:243], v[88:91]
v_lshlrev_b32 v218, 16, v197
v_mfma_f32_16x16x32_bf16 v[92:95], a[92:95], v[240:243], v[92:95]
s_waitcnt vmcnt(16)
ds_read_b128 a[96:99], v2 offset:0
v_mfma_f32_16x16x32_bf16 v[92:95], a[76:79], v[244:247], v[92:95]
ds_read_b128 a[100:103], v2 offset:2048
v_and_b32 v219, 0xffff0000, v197
s_waitcnt lgkmcnt(6)
v_mfma_f32_16x16x32_bf16 v[96:99], a[64:67], v[20:23], v[96:99]
ds_read_b64_tr_b16 v[240:241], v36 offset:40960
v_lshlrev_b32 v220, 16, v198
v_mfma_f32_16x16x32_bf16 v[96:99], a[80:83], v[24:27], v[96:99]
ds_read_b64_tr_b16 v[242:243], v36 offset:41472
v_and_b32 v221, 0xffff0000, v198
v_mfma_f32_16x16x32_bf16 v[100:103], a[84:87], v[24:27], v[100:103]
ds_read_b64_tr_b16 v[244:245], v36 offset:45056
s_add_u32 m0, s100, 18432
v_mfma_f32_16x16x32_bf16 v[100:103], a[68:71], v[20:23], v[100:103]
buffer_load_dwordx4 v50, s[88:91], s63 offen lds
v_lshlrev_b32 v222, 16, v199
v_mfma_f32_16x16x32_bf16 v[104:107], a[72:75], v[20:23], v[104:107]
ds_read_b64_tr_b16 v[246:247], v36 offset:45568
v_and_b32 v223, 0xffff0000, v199
v_mfma_f32_16x16x32_bf16 v[104:107], a[88:91], v[24:27], v[104:107]
v_lshlrev_b32 v224, 16, v200
v_mfma_f32_16x16x32_bf16 v[108:111], a[92:95], v[24:27], v[108:111]
s_add_u32 m0, s100, 19456
ds_read_b128 a[104:107], v2 offset:4096
v_mfma_f32_16x16x32_bf16 v[108:111], a[76:79], v[20:23], v[108:111]
buffer_load_dwordx4 v51, s[88:91], s63 offen lds
v_and_b32 v225, 0xffff0000, v200
s_waitcnt lgkmcnt(7)
v_mfma_f32_16x16x32_bf16 v[112:115], a[64:67], v[28:31], v[112:115]
ds_read_b64_tr_b16 v[24:25], v37 offset:40960
v_lshlrev_b32 v226, 16, v201
v_mfma_f32_16x16x32_bf16 v[112:115], a[80:83], v[32:35], v[112:115]
ds_read_b64_tr_b16 v[26:27], v37 offset:41472
v_and_b32 v227, 0xffff0000, v201
v_mfma_f32_16x16x32_bf16 v[116:119], a[84:87], v[32:35], v[116:119]
ds_read_b64_tr_b16 v[20:21], v37 offset:45056
s_add_u32 m0, s98, 16384
v_mfma_f32_16x16x32_bf16 v[116:119], a[68:71], v[28:31], v[116:119]
buffer_load_dwordx4 v11, s[84:87], s62 offen offset:1024 lds
v_lshlrev_b32 v228, 16, v202
v_mfma_f32_16x16x32_bf16 v[120:123], a[72:75], v[28:31], v[120:123]
ds_read_b64_tr_b16 v[22:23], v37 offset:45568
v_and_b32 v229, 0xffff0000, v202
v_mfma_f32_16x16x32_bf16 v[120:123], a[88:91], v[32:35], v[120:123]
v_lshlrev_b32 v230, 16, v203
v_mfma_f32_16x16x32_bf16 v[124:127], a[92:95], v[32:35], v[124:127]
ds_read_b128 a[108:111], v2 offset:6144
v_and_b32 v231, 0xffff0000, v203
v_mfma_f32_16x16x32_bf16 v[124:127], a[76:79], v[28:31], v[124:127]
ds_read_b128 a[112:115], v3 offset:0
v_add_f32 v232, v208, v209
s_waitcnt lgkmcnt(7)
v_mfma_f32_16x16x32_bf16 v[128:131], a[64:67], v[240:243], v[128:131]
ds_read_b64_tr_b16 v[32:33], v38 offset:40960
v_add_f32 v234, v210, v211
v_mfma_f32_16x16x32_bf16 v[128:131], a[80:83], v[244:247], v[128:131]
ds_read_b64_tr_b16 v[34:35], v38 offset:41472
v_add_f32 v232, v232, v212
v_mfma_f32_16x16x32_bf16 v[132:135], a[84:87], v[244:247], v[132:135]
ds_read_b64_tr_b16 v[28:29], v38 offset:45056
s_add_u32 m0, s100, 20480
v_mfma_f32_16x16x32_bf16 v[132:135], a[68:71], v[240:243], v[132:135]
buffer_load_dwordx4 v52, s[88:91], s63 offen lds
v_add_f32 v234, v234, v213
v_mfma_f32_16x16x32_bf16 v[136:139], a[72:75], v[240:243], v[136:139]
ds_read_b64_tr_b16 v[30:31], v38 offset:45568
v_add_f32 v232, v232, v214
v_mfma_f32_16x16x32_bf16 v[136:139], a[88:91], v[244:247], v[136:139]
v_add_f32 v234, v234, v215
v_mfma_f32_16x16x32_bf16 v[140:143], a[92:95], v[244:247], v[140:143]
s_add_u32 m0, s100, 21504
ds_read_b128 a[116:119], v3 offset:2048
v_mfma_f32_16x16x32_bf16 v[140:143], a[76:79], v[240:243], v[140:143]
buffer_load_dwordx4 v53, s[88:91], s63 offen lds
v_add_f32 v232, v232, v216
s_waitcnt lgkmcnt(7)
v_mfma_f32_16x16x32_bf16 v[144:147], a[64:67], v[24:27], v[144:147]
ds_read_b64_tr_b16 v[244:245], v39 offset:40960
v_add_f32 v234, v234, v217
v_mfma_f32_16x16x32_bf16 v[144:147], a[80:83], v[20:23], v[144:147]
ds_read_b64_tr_b16 v[246:247], v39 offset:41472
v_add_f32 v232, v232, v218
v_mfma_f32_16x16x32_bf16 v[148:151], a[84:87], v[20:23], v[148:151]
ds_read_b64_tr_b16 v[240:241], v39 offset:45056
s_add_u32 m0, s98, 16384
v_mfma_f32_16x16x32_bf16 v[148:151], a[68:71], v[24:27], v[148:151]
buffer_load_dwordx4 v12, s[84:87], s62 offen offset:2048 lds
v_add_f32 v234, v234, v219
v_mfma_f32_16x16x32_bf16 v[152:155], a[72:75], v[24:27], v[152:155]
ds_read_b64_tr_b16 v[242:243], v39 offset:45568
v_add_f32 v232, v232, v220
v_mfma_f32_16x16x32_bf16 v[152:155], a[88:91], v[20:23], v[152:155]
v_add_f32 v234, v234, v221
v_mfma_f32_16x16x32_bf16 v[156:159], a[92:95], v[20:23], v[156:159]
ds_read_b128 a[120:123], v3 offset:4096
v_add_f32 v232, v232, v222
v_mfma_f32_16x16x32_bf16 v[156:159], a[76:79], v[24:27], v[156:159]
ds_read_b128 a[124:127], v3 offset:6144
v_add_f32 v234, v234, v223
s_waitcnt vmcnt(21) lgkmcnt(7)
s_barrier
v_mfma_f32_16x16x32_bf16 v[160:163], a[64:67], v[32:35], v[160:163]
ds_read_b64_tr_b16 v[20:21], v36 offset:49152
v_add_f32 v232, v232, v224
v_mfma_f32_16x16x32_bf16 v[160:163], a[80:83], v[28:31], v[160:163]
ds_read_b64_tr_b16 v[22:23], v36 offset:49664
v_add_f32 v234, v234, v225
v_mfma_f32_16x16x32_bf16 v[164:167], a[84:87], v[28:31], v[164:167]
ds_read_b64_tr_b16 v[24:25], v36 offset:53248
s_add_u32 m0, s100, 22528
v_mfma_f32_16x16x32_bf16 v[164:167], a[68:71], v[32:35], v[164:167]
buffer_load_dwordx4 v54, s[88:91], s63 offen lds
v_add_f32 v232, v232, v226
v_mfma_f32_16x16x32_bf16 v[168:171], a[72:75], v[32:35], v[168:171]
ds_read_b64_tr_b16 v[26:27], v36 offset:53760
v_add_f32 v234, v234, v227
v_mfma_f32_16x16x32_bf16 v[168:171], a[88:91], v[28:31], v[168:171]
v_add_f32 v232, v232, v228
v_mfma_f32_16x16x32_bf16 v[172:175], a[92:95], v[28:31], v[172:175]
s_add_u32 m0, s100, 23552
v_add_f32 v234, v234, v229
v_mfma_f32_16x16x32_bf16 v[172:175], a[76:79], v[32:35], v[172:175]
buffer_load_dwordx4 v55, s[88:91], s63 offen lds
v_add_f32 v232, v232, v230
s_waitcnt lgkmcnt(6)
v_mfma_f32_16x16x32_bf16 v[176:179], a[64:67], v[244:247], v[176:179]
ds_read_b64_tr_b16 v[28:29], v37 offset:49152
v_add_f32 v234, v234, v231
v_mfma_f32_16x16x32_bf16 v[176:179], a[80:83], v[240:243], v[176:179]
ds_read_b64_tr_b16 v[30:31], v37 offset:49664
v_add_f32 v232, v232, v234
v_mfma_f32_16x16x32_bf16 v[180:183], a[84:87], v[240:243], v[180:183]
ds_read_b64_tr_b16 v[32:33], v37 offset:53248
s_add_u32 m0, s98, 16384
v_mfma_f32_16x16x32_bf16 v[180:183], a[68:71], v[244:247], v[180:183]
buffer_load_dwordx4 v13, s[84:87], s62 offen offset:3072 lds
v_add_f32_dpp v232, v232, v232 row_ror:8 row_mask:0xf bank_mask:0xf
v_mfma_f32_16x16x32_bf16 v[184:187], a[72:75], v[244:247], v[184:187]
ds_read_b64_tr_b16 v[34:35], v37 offset:53760
v_add_f32_dpp v232, v232, v232 row_ror:4 row_mask:0xf bank_mask:0xf
v_mfma_f32_16x16x32_bf16 v[184:187], a[88:91], v[240:243], v[184:187]
s_nop 0
v_add_f32_dpp v232, v232, v232 row_ror:2 row_mask:0xf bank_mask:0xf
s_bfm_b64 exec, 12, 0
buffer_load_dword v57, v19, s[8:11], s55 offen
s_mov_b64 exec, -1
v_mfma_f32_16x16x32_bf16 v[188:191], a[92:95], v[240:243], v[188:191]
v_add_f32_dpp v232, v232, v232 row_ror:1 row_mask:0xf bank_mask:0xf
v_mfma_f32_16x16x32_bf16 v[188:191], a[76:79], v[244:247], v[188:191]
v_mov_b32 v235, v232
s_waitcnt lgkmcnt(4)
v_mfma_f32_16x16x32_bf16 v[64:67], a[96:99], v[20:23], v[64:67]
ds_read_b64_tr_b16 v[240:241], v38 offset:49152
v_permlane16_swap_b32 v232, v235
v_mfma_f32_16x16x32_bf16 v[64:67], a[112:115], v[24:27], v[64:67]
ds_read_b64_tr_b16 v[242:243], v38 offset:49664
v_add_f32 v232, v232, v235
v_mfma_f32_16x16x32_bf16 v[68:71], a[116:119], v[24:27], v[68:71]
ds_read_b64_tr_b16 v[244:245], v38 offset:53248
s_add_u32 s63, s99, 768
s_bitset0_b32 s63, 10
s_add_u32 m0, s100, 0
v_mfma_f32_16x16x32_bf16 v[68:71], a[100:103], v[20:23], v[68:71]
buffer_load_dwordx4 v48, s[88:91], s63 offen lds
v_mul_f32 v232, 0.001736111111111111, v232
v_mfma_f32_16x16x32_bf16 v[72:75], a[104:107], v[20:23], v[72:75]
ds_read_b64_tr_b16 v[246:247], v38 offset:53760
v_cvt_pk_bf16_f32 v233, v232, v232
v_mfma_f32_16x16x32_bf16 v[72:75], a[120:123], v[24:27], v[72:75]
v_lshlrev_b32 v233, 16, v233
v_mfma_f32_16x16x32_bf16 v[76:79], a[124:127], v[24:27], v[76:79]
s_add_u32 m0, s100, 1024
v_sub_f32 v232, v232, v233
v_mfma_f32_16x16x32_bf16 v[76:79], a[108:111], v[20:23], v[76:79]
buffer_load_dwordx4 v49, s[88:91], s63 offen lds
v_cndmask_b32 v233, 0, v233, s[36:37]
s_waitcnt lgkmcnt(4)
v_mfma_f32_16x16x32_bf16 v[80:83], a[96:99], v[28:31], v[80:83]
ds_read_b64_tr_b16 v[24:25], v39 offset:49152
v_sub_f32 v208, v208, v233
v_mfma_f32_16x16x32_bf16 v[80:83], a[112:115], v[32:35], v[80:83]
ds_read_b64_tr_b16 v[26:27], v39 offset:49664
v_sub_f32 v209, v209, v233
v_mfma_f32_16x16x32_bf16 v[84:87], a[116:119], v[32:35], v[84:87]
ds_read_b64_tr_b16 v[20:21], v39 offset:53248
s_add_u32 s62, s96, 3145728
s_bitset0_b32 s62, 22
s_add_u32 m0, s98, 32768
v_mfma_f32_16x16x32_bf16 v[84:87], a[100:103], v[28:31], v[84:87]
buffer_load_dwordx4 v10, s[84:87], s62 offen offset:0 lds
v_sub_f32 v210, v210, v233
v_mfma_f32_16x16x32_bf16 v[88:91], a[104:107], v[28:31], v[88:91]
ds_read_b64_tr_b16 v[22:23], v39 offset:53760
v_sub_f32 v211, v211, v233
v_mfma_f32_16x16x32_bf16 v[88:91], a[120:123], v[32:35], v[88:91]
v_sub_f32 v212, v212, v233
v_mfma_f32_16x16x32_bf16 v[92:95], a[124:127], v[32:35], v[92:95]
s_waitcnt vmcnt(17)
ds_read_b128 a[128:131], v2 offset:8192
v_mfma_f32_16x16x32_bf16 v[92:95], a[108:111], v[28:31], v[92:95]
ds_read_b128 a[132:135], v2 offset:10240
v_sub_f32 v213, v213, v233
s_waitcnt lgkmcnt(6)
v_mfma_f32_16x16x32_bf16 v[96:99], a[96:99], v[240:243], v[96:99]
ds_read_b64_tr_b16 v[32:33], v36 offset:57344
v_sub_f32 v214, v214, v233
v_mfma_f32_16x16x32_bf16 v[96:99], a[112:115], v[244:247], v[96:99]
ds_read_b64_tr_b16 v[34:35], v36 offset:57856
v_sub_f32 v215, v215, v233
v_mfma_f32_16x16x32_bf16 v[100:103], a[116:119], v[244:247], v[100:103]
ds_read_b64_tr_b16 v[28:29], v36 offset:61440
s_add_u32 m0, s100, 2048
v_mfma_f32_16x16x32_bf16 v[100:103], a[100:103], v[240:243], v[100:103]
buffer_load_dwordx4 v50, s[88:91], s63 offen lds
v_sub_f32 v216, v216, v233
v_mfma_f32_16x16x32_bf16 v[104:107], a[104:107], v[240:243], v[104:107]
ds_read_b64_tr_b16 v[30:31], v36 offset:61952
v_sub_f32 v217, v217, v233
v_mfma_f32_16x16x32_bf16 v[104:107], a[120:123], v[244:247], v[104:107]
v_sub_f32 v218, v218, v233
v_mfma_f32_16x16x32_bf16 v[108:111], a[124:127], v[244:247], v[108:111]
s_add_u32 m0, s100, 3072
ds_read_b128 a[136:139], v2 offset:12288
v_mfma_f32_16x16x32_bf16 v[108:111], a[108:111], v[240:243], v[108:111]
buffer_load_dwordx4 v51, s[88:91], s63 offen lds
v_sub_f32 v219, v219, v233
s_waitcnt lgkmcnt(7)
v_mfma_f32_16x16x32_bf16 v[112:115], a[96:99], v[24:27], v[112:115]
ds_read_b64_tr_b16 v[244:245], v37 offset:57344
v_sub_f32 v220, v220, v233
v_mfma_f32_16x16x32_bf16 v[112:115], a[112:115], v[20:23], v[112:115]
ds_read_b64_tr_b16 v[246:247], v37 offset:57856
v_sub_f32 v221, v221, v233
v_mfma_f32_16x16x32_bf16 v[116:119], a[116:119], v[20:23], v[116:119]
ds_read_b64_tr_b16 v[240:241], v37 offset:61440
s_add_u32 m0, s98, 32768
v_mfma_f32_16x16x32_bf16 v[116:119], a[100:103], v[24:27], v[116:119]
buffer_load_dwordx4 v11, s[84:87], s62 offen offset:1024 lds
v_sub_f32 v222, v222, v233
v_mfma_f32_16x16x32_bf16 v[120:123], a[104:107], v[24:27], v[120:123]
ds_read_b64_tr_b16 v[242:243], v37 offset:61952
v_sub_f32 v223, v223, v233
v_mfma_f32_16x16x32_bf16 v[120:123], a[120:123], v[20:23], v[120:123]
v_sub_f32 v224, v224, v233
v_mfma_f32_16x16x32_bf16 v[124:127], a[124:127], v[20:23], v[124:127]
ds_read_b128 a[140:143], v2 offset:14336
v_sub_f32 v225, v225, v233
v_mfma_f32_16x16x32_bf16 v[124:127], a[108:111], v[24:27], v[124:127]
ds_read_b128 a[144:147], v3 offset:8192
v_sub_f32 v226, v226, v233
s_waitcnt lgkmcnt(7)
v_mfma_f32_16x16x32_bf16 v[128:131], a[96:99], v[32:35], v[128:131]
ds_read_b64_tr_b16 v[20:21], v38 offset:57344
v_sub_f32 v227, v227, v233
v_mfma_f32_16x16x32_bf16 v[128:131], a[112:115], v[28:31], v[128:131]
ds_read_b64_tr_b16 v[22:23], v38 offset:57856
v_sub_f32 v228, v228, v233
v_mfma_f32_16x16x32_bf16 v[132:135], a[116:119], v[28:31], v[132:135]
ds_read_b64_tr_b16 v[24:25], v38 offset:61440
s_add_u32 m0, s100, 4096
v_mfma_f32_16x16x32_bf16 v[132:135], a[100:103], v[32:35], v[132:135]
buffer_load_dwordx4 v52, s[88:91], s63 offen lds
v_sub_f32 v229, v229, v233
v_mfma_f32_16x16x32_bf16 v[136:139], a[104:107], v[32:35], v[136:139]
ds_read_b64_tr_b16 v[26:27], v38 offset:61952
v_sub_f32 v230, v230, v233
v_mfma_f32_16x16x32_bf16 v[136:139], a[120:123], v[28:31], v[136:139]
v_sub_f32 v231, v231, v233
v_mfma_f32_16x16x32_bf16 v[140:143], a[124:127], v[28:31], v[140:143]
s_add_u32 m0, s100, 5120
ds_read_b128 a[148:151], v3 offset:10240
v_mfma_f32_16x16x32_bf16 v[140:143], a[108:111], v[32:35], v[140:143]
buffer_load_dwordx4 v53, s[88:91], s63 offen lds
v_mul_f32 v234, v208, v208
s_waitcnt lgkmcnt(7)
v_mfma_f32_16x16x32_bf16 v[144:147], a[96:99], v[244:247], v[144:147]
ds_read_b64_tr_b16 v[28:29], v39 offset:57344
v_mul_f32 v236, v209, v209
v_mfma_f32_16x16x32_bf16 v[144:147], a[112:115], v[240:243], v[144:147]
ds_read_b64_tr_b16 v[30:31], v39 offset:57856
v_fmac_f32 v234, v210, v210
v_mfma_f32_16x16x32_bf16 v[148:151], a[116:119], v[240:243], v[148:151]
ds_read_b64_tr_b16 v[32:33], v39 offset:61440
s_add_u32 m0, s98, 32768
v_mfma_f32_16x16x32_bf16 v[148:151], a[100:103], v[244:247], v[148:151]
buffer_load_dwordx4 v12, s[84:87], s62 offen offset:2048 lds
v_fmac_f32 v236, v211, v211
v_mfma_f32_16x16x32_bf16 v[152:155], a[104:107], v[244:247], v[152:155]
ds_read_b64_tr_b16 v[34:35], v39 offset:61952
v_fmac_f32 v234, v212, v212
v_mfma_f32_16x16x32_bf16 v[152:155], a[120:123], v[240:243], v[152:155]
v_fmac_f32 v236, v213, v213
v_mfma_f32_16x16x32_bf16 v[156:159], a[124:127], v[240:243], v[156:159]
ds_read_b128 a[152:155], v3 offset:12288
v_fmac_f32 v234, v214, v214
v_mfma_f32_16x16x32_bf16 v[156:159], a[108:111], v[244:247], v[156:159]
ds_read_b128 a[156:159], v3 offset:14336
v_fmac_f32 v236, v215, v215
s_waitcnt vmcnt(22) lgkmcnt(7)
s_barrier
v_mfma_f32_16x16x32_bf16 v[160:163], a[96:99], v[20:23], v[160:163]
ds_read_b64_tr_b16 v[240:241], v36 offset:0
v_fmac_f32 v234, v216, v216
v_mfma_f32_16x16x32_bf16 v[160:163], a[112:115], v[24:27], v[160:163]
ds_read_b64_tr_b16 v[242:243], v36 offset:512
v_fmac_f32 v236, v217, v217
v_mfma_f32_16x16x32_bf16 v[164:167], a[116:119], v[24:27], v[164:167]
ds_read_b64_tr_b16 v[244:245], v36 offset:4096
s_add_u32 m0, s100, 6144
v_mfma_f32_16x16x32_bf16 v[164:167], a[100:103], v[20:23], v[164:167]
buffer_load_dwordx4 v54, s[88:91], s63 offen lds
v_fmac_f32 v234, v218, v218
v_mfma_f32_16x16x32_bf16 v[168:171], a[104:107], v[20:23], v[168:171]
ds_read_b64_tr_b16 v[246:247], v36 offset:4608
v_fmac_f32 v236, v219, v219
v_mfma_f32_16x16x32_bf16 v[168:171], a[120:123], v[24:27], v[168:171]
v_fmac_f32 v234, v220, v220
v_mfma_f32_16x16x32_bf16 v[172:175], a[124:127], v[24:27], v[172:175]
s_add_u32 m0, s100, 7168
v_fmac_f32 v236, v221, v221
v_mfma_f32_16x16x32_bf16 v[172:175], a[108:111], v[20:23], v[172:175]
buffer_load_dwordx4 v55, s[88:91], s63 offen lds
v_fmac_f32 v234, v222, v222
s_waitcnt lgkmcnt(6)
v_mfma_f32_16x16x32_bf16 v[176:179], a[96:99], v[28:31], v[176:179]
ds_read_b64_tr_b16 v[24:25], v37 offset:0
v_fmac_f32 v236, v223, v223
v_mfma_f32_16x16x32_bf16 v[176:179], a[112:115], v[32:35], v[176:179]
ds_read_b64_tr_b16 v[26:27], v37 offset:512
v_fmac_f32 v234, v224, v224
v_mfma_f32_16x16x32_bf16 v[180:183], a[116:119], v[32:35], v[180:183]
ds_read_b64_tr_b16 v[20:21], v37 offset:4096
s_add_u32 m0, s98, 32768
v_mfma_f32_16x16x32_bf16 v[180:183], a[100:103], v[28:31], v[180:183]
buffer_load_dwordx4 v13, s[84:87], s62 offen offset:3072 lds
v_fmac_f32 v236, v225, v225
v_mfma_f32_16x16x32_bf16 v[184:187], a[104:107], v[28:31], v[184:187]
ds_read_b64_tr_b16 v[22:23], v37 offset:4608
v_fmac_f32 v234, v226, v226
v_mfma_f32_16x16x32_bf16 v[184:187], a[120:123], v[32:35], v[184:187]
v_fmac_f32 v236, v227, v227
s_bfm_b64 exec, 12, 12
buffer_load_dword v58, v19, s[8:11], s55 offen
s_mov_b64 exec, -1
v_mfma_f32_16x16x32_bf16 v[188:191], a[124:127], v[32:35], v[188:191]
v_fmac_f32 v234, v228, v228
v_mfma_f32_16x16x32_bf16 v[188:191], a[108:111], v[28:31], v[188:191]
v_fmac_f32 v236, v229, v229
s_waitcnt lgkmcnt(4)
v_mfma_f32_16x16x32_bf16 v[64:67], a[128:131], v[240:243], v[64:67]
ds_read_b64_tr_b16 v[32:33], v38 offset:0
v_fmac_f32 v234, v230, v230
v_mfma_f32_16x16x32_bf16 v[64:67], a[144:147], v[244:247], v[64:67]
ds_read_b64_tr_b16 v[34:35], v38 offset:512
v_fmac_f32 v236, v231, v231
v_mfma_f32_16x16x32_bf16 v[68:71], a[148:151], v[244:247], v[68:71]
ds_read_b64_tr_b16 v[28:29], v38 offset:4096
s_add_u32 s63, s99, 896
s_bitset0_b32 s63, 10
s_add_u32 m0, s100, 8192
v_mfma_f32_16x16x32_bf16 v[68:71], a[132:135], v[240:243], v[68:71]
buffer_load_dwordx4 v48, s[88:91], s63 offen lds
v_add_f32 v234, v234, v236
v_mfma_f32_16x16x32_bf16 v[72:75], a[136:139], v[240:243], v[72:75]
ds_read_b64_tr_b16 v[30:31], v38 offset:4608
v_add_f32_dpp v234, v234, v234 row_ror:8 row_mask:0xf bank_mask:0xf
v_mfma_f32_16x16x32_bf16 v[72:75], a[152:155], v[244:247], v[72:75]
s_nop 0
v_add_f32_dpp v234, v234, v234 row_ror:4 row_mask:0xf bank_mask:0xf
v_mfma_f32_16x16x32_bf16 v[76:79], a[156:159], v[244:247], v[76:79]
s_add_u32 m0, s100, 9216
v_add_f32_dpp v234, v234, v234 row_ror:2 row_mask:0xf bank_mask:0xf
v_mfma_f32_16x16x32_bf16 v[76:79], a[140:143], v[240:243], v[76:79]
buffer_load_dwordx4 v49, s[88:91], s63 offen lds
v_add_f32_dpp v234, v234, v234 row_ror:1 row_mask:0xf bank_mask:0xf
s_waitcnt lgkmcnt(4)
v_mfma_f32_16x16x32_bf16 v[80:83], a[128:131], v[24:27], v[80:83]
ds_read_b64_tr_b16 v[244:245], v39 offset:0
v_mov_b32 v235, v234
v_mfma_f32_16x16x32_bf16 v[80:83], a[144:147], v[20:23], v[80:83]
ds_read_b64_tr_b16 v[246:247], v39 offset:512
v_permlane16_swap_b32 v234, v235
v_mfma_f32_16x16x32_bf16 v[84:87], a[148:151], v[20:23], v[84:87]
ds_read_b64_tr_b16 v[240:241], v39 offset:4096
s_add_u32 s62, s96, 3670016
s_bitset0_b32 s62, 22
s_add_u32 m0, s98, 49152
v_mfma_f32_16x16x32_bf16 v[84:87], a[132:135], v[24:27], v[84:87]
buffer_load_dwordx4 v10, s[84:87], s62 offen offset:0 lds
v_add_f32 v234, v234, v235
v_mfma_f32_16x16x32_bf16 v[88:91], a[136:139], v[24:27], v[88:91]
ds_read_b64_tr_b16 v[242:243], v39 offset:4608
v_mul_f32 v232, v232, v232
v_mfma_f32_16x16x32_bf16 v[88:91], a[152:155], v[20:23], v[88:91]
v_mov_b32 v236, 0.001736111111111111
v_mfma_f32_16x16x32_bf16 v[92:95], a[156:159], v[20:23], v[92:95]
s_waitcnt vmcnt(18)
ds_read_b128 a[160:163], v2 offset:16384
v_mfma_f32_16x16x32_bf16 v[92:95], a[140:143], v[24:27], v[92:95]
ds_read_b128 a[164:167], v2 offset:18432
v_fma_f32 v234, v234, v236, -v232
s_waitcnt lgkmcnt(6)
v_mfma_f32_16x16x32_bf16 v[96:99], a[128:131], v[32:35], v[96:99]
ds_read_b64_tr_b16 v[20:21], v36 offset:8192
v_max_f32 v234, 0, v234
v_mfma_f32_16x16x32_bf16 v[96:99], a[144:147], v[28:31], v[96:99]
ds_read_b64_tr_b16 v[22:23], v36 offset:8704
v_cvt_pk_bf16_f32 v234, v234, v234
v_mfma_f32_16x16x32_bf16 v[100:103], a[148:151], v[28:31], v[100:103]
ds_read_b64_tr_b16 v[24:25], v36 offset:12288
s_add_u32 m0, s100, 10240
v_mfma_f32_16x16x32_bf16 v[100:103], a[132:135], v[32:35], v[100:103]
buffer_load_dwordx4 v50, s[88:91], s63 offen lds
v_lshlrev_b32 v234, 16, v234
v_mfma_f32_16x16x32_bf16 v[104:107], a[136:139], v[32:35], v[104:107]
ds_read_b64_tr_b16 v[26:27], v36 offset:12800
v_add_f32 v234, 0x3727c5ac, v234
v_mfma_f32_16x16x32_bf16 v[104:107], a[152:155], v[28:31], v[104:107]
v_cvt_pk_bf16_f32 v234, v234, v234
v_mfma_f32_16x16x32_bf16 v[108:111], a[156:159], v[28:31], v[108:111]
s_add_u32 m0, s100, 11264
ds_read_b128 a[168:171], v2 offset:20480
v_mfma_f32_16x16x32_bf16 v[108:111], a[140:143], v[32:35], v[108:111]
buffer_load_dwordx4 v51, s[88:91], s63 offen lds
v_lshlrev_b32 v234, 16, v234
s_waitcnt lgkmcnt(7)
v_mfma_f32_16x16x32_bf16 v[112:115], a[128:131], v[244:247], v[112:115]
ds_read_b64_tr_b16 v[28:29], v37 offset:8192
v_sqrt_f32 v234, v234
v_mfma_f32_16x16x32_bf16 v[112:115], a[144:147], v[240:243], v[112:115]
ds_read_b64_tr_b16 v[30:31], v37 offset:8704
v_cvt_pk_bf16_f32 v234, v234, v234
v_mfma_f32_16x16x32_bf16 v[116:119], a[148:151], v[240:243], v[116:119]
ds_read_b64_tr_b16 v[32:33], v37 offset:12288
s_add_u32 m0, s98, 49152
v_mfma_f32_16x16x32_bf16 v[116:119], a[132:135], v[244:247], v[116:119]
buffer_load_dwordx4 v11, s[84:87], s62 offen offset:1024 lds
v_lshlrev_b32 v234, 16, v234
v_mfma_f32_16x16x32_bf16 v[120:123], a[136:139], v[244:247], v[120:123]
ds_read_b64_tr_b16 v[34:35], v37 offset:12800
v_rcp_f32 v234, v234
v_mfma_f32_16x16x32_bf16 v[120:123], a[152:155], v[240:243], v[120:123]
v_cvt_pk_bf16_f32 v209, v208, v209
v_mfma_f32_16x16x32_bf16 v[124:127], a[156:159], v[240:243], v[124:127]
ds_read_b128 a[172:175], v2 offset:22528
v_cvt_pk_bf16_f32 v211, v210, v211
v_mfma_f32_16x16x32_bf16 v[124:127], a[140:143], v[244:247], v[124:127]
ds_read_b128 a[176:179], v3 offset:16384
v_cvt_pk_bf16_f32 v213, v212, v213
s_waitcnt lgkmcnt(7)
v_mfma_f32_16x16x32_bf16 v[128:131], a[128:131], v[20:23], v[128:131]
ds_read_b64_tr_b16 v[240:241], v38 offset:8192
v_cvt_pk_bf16_f32 v215, v214, v215
v_mfma_f32_16x16x32_bf16 v[128:131], a[144:147], v[24:27], v[128:131]
ds_read_b64_tr_b16 v[242:243], v38 offset:8704
v_cvt_pk_bf16_f32 v217, v216, v217
v_mfma_f32_16x16x32_bf16 v[132:135], a[148:151], v[24:27], v[132:135]
ds_read_b64_tr_b16 v[244:245], v38 offset:12288
s_add_u32 m0, s100, 12288
v_mfma_f32_16x16x32_bf16 v[132:135], a[132:135], v[20:23], v[132:135]
buffer_load_dwordx4 v52, s[88:91], s63 offen lds
v_cvt_pk_bf16_f32 v219, v218, v219
v_mfma_f32_16x16x32_bf16 v[136:139], a[136:139], v[20:23], v[136:139]
ds_read_b64_tr_b16 v[246:247], v38 offset:12800
v_cvt_pk_bf16_f32 v221, v220, v221
v_mfma_f32_16x16x32_bf16 v[136:139], a[152:155], v[24:27], v[136:139]
v_cvt_pk_bf16_f32 v223, v222, v223
v_mfma_f32_16x16x32_bf16 v[140:143], a[156:159], v[24:27], v[140:143]
s_add_u32 m0, s100, 13312
ds_read_b128 a[180:183], v3 offset:18432
v_mfma_f32_16x16x32_bf16 v[140:143], a[140:143], v[20:23], v[140:143]
buffer_load_dwordx4 v53, s[88:91], s63 offen lds
v_cvt_pk_bf16_f32 v225, v224, v225
s_waitcnt lgkmcnt(7)
v_mfma_f32_16x16x32_bf16 v[144:147], a[128:131], v[28:31], v[144:147]
ds_read_b64_tr_b16 v[24:25], v39 offset:8192
v_cvt_pk_bf16_f32 v227, v226, v227
v_mfma_f32_16x16x32_bf16 v[144:147], a[144:147], v[32:35], v[144:147]
ds_read_b64_tr_b16 v[26:27], v39 offset:8704
v_cvt_pk_bf16_f32 v229, v228, v229
v_mfma_f32_16x16x32_bf16 v[148:151], a[148:151], v[32:35], v[148:151]
ds_read_b64_tr_b16 v[20:21], v39 offset:12288
s_add_u32 m0, s98, 49152
v_mfma_f32_16x16x32_bf16 v[148:151], a[132:135], v[28:31], v[148:151]
buffer_load_dwordx4 v12, s[84:87], s62 offen offset:2048 lds
v_cvt_pk_bf16_f32 v231, v230, v231
v_mfma_f32_16x16x32_bf16 v[152:155], a[136:139], v[28:31], v[152:155]
ds_read_b64_tr_b16 v[22:23], v39 offset:12800
v_lshlrev_b32 v208, 16, v209
v_mfma_f32_16x16x32_bf16 v[152:155], a[152:155], v[32:35], v[152:155]
v_and_b32 v209, 0xffff0000, v209
v_mfma_f32_16x16x32_bf16 v[156:159], a[156:159], v[32:35], v[156:159]
ds_read_b128 a[184:187], v3 offset:20480
v_lshlrev_b32 v210, 16, v211
v_mfma_f32_16x16x32_bf16 v[156:159], a[140:143], v[28:31], v[156:159]
ds_read_b128 a[188:191], v3 offset:22528
v_and_b32 v211, 0xffff0000, v211
s_waitcnt vmcnt(23) lgkmcnt(7)
s_barrier
v_mfma_f32_16x16x32_bf16 v[160:163], a[128:131], v[240:243], v[160:163]
ds_read_b64_tr_b16 v[32:33], v36 offset:16384
v_lshlrev_b32 v212, 16, v213
v_mfma_f32_16x16x32_bf16 v[160:163], a[144:147], v[244:247], v[160:163]
ds_read_b64_tr_b16 v[34:35], v36 offset:16896
v_and_b32 v213, 0xffff0000, v213
v_mfma_f32_16x16x32_bf16 v[164:167], a[148:151], v[244:247], v[164:167]
ds_read_b64_tr_b16 v[28:29], v36 offset:20480
s_add_u32 m0, s100, 14336
v_mfma_f32_16x16x32_bf16 v[164:167], a[132:135], v[240:243], v[164:167]
buffer_load_dwordx4 v54, s[88:91], s63 offen lds
v_lshlrev_b32 v214, 16, v215
v_mfma_f32_16x16x32_bf16 v[168:171], a[136:139], v[240:243], v[168:171]
ds_read_b64_tr_b16 v[30:31], v36 offset:20992
v_and_b32 v215, 0xffff0000, v215
v_mfma_f32_16x16x32_bf16 v[168:171], a[152:155], v[244:247], v[168:171]
v_lshlrev_b32 v216, 16, v217
v_mfma_f32_16x16x32_bf16 v[172:175], a[156:159], v[244:247], v[172:175]
s_add_u32 m0, s100, 15360
v_and_b32 v217, 0xffff0000, v217
v_mfma_f32_16x16x32_bf16 v[172:175], a[140:143], v[240:243], v[172:175]
buffer_load_dwordx4 v55, s[88:91], s63 offen lds
v_lshlrev_b32 v218, 16, v219
s_waitcnt lgkmcnt(6)
v_mfma_f32_16x16x32_bf16 v[176:179], a[128:131], v[24:27], v[176:179]
ds_read_b64_tr_b16 v[244:245], v37 offset:16384
v_and_b32 v219, 0xffff0000, v219
v_mfma_f32_16x16x32_bf16 v[176:179], a[144:147], v[20:23], v[176:179]
ds_read_b64_tr_b16 v[246:247], v37 offset:16896
v_lshlrev_b32 v220, 16, v221
v_mfma_f32_16x16x32_bf16 v[180:183], a[148:151], v[20:23], v[180:183]
ds_read_b64_tr_b16 v[240:241], v37 offset:20480
s_add_u32 m0, s98, 49152
v_mfma_f32_16x16x32_bf16 v[180:183], a[132:135], v[24:27], v[180:183]
buffer_load_dwordx4 v13, s[84:87], s62 offen offset:3072 lds
v_and_b32 v221, 0xffff0000, v221
v_mfma_f32_16x16x32_bf16 v[184:187], a[136:139], v[24:27], v[184:187]
ds_read_b64_tr_b16 v[242:243], v37 offset:20992
v_lshlrev_b32 v222, 16, v223
v_mfma_f32_16x16x32_bf16 v[184:187], a[152:155], v[20:23], v[184:187]
v_and_b32 v223, 0xffff0000, v223
s_bfm_b64 exec, 12, 24
buffer_load_dword v59, v19, s[8:11], s55 offen
s_mov_b64 exec, -1
v_mfma_f32_16x16x32_bf16 v[188:191], a[156:159], v[20:23], v[188:191]
v_lshlrev_b32 v224, 16, v225
v_mfma_f32_16x16x32_bf16 v[188:191], a[140:143], v[24:27], v[188:191]
v_and_b32 v225, 0xffff0000, v225
s_waitcnt lgkmcnt(4)
v_mfma_f32_16x16x32_bf16 v[64:67], a[160:163], v[32:35], v[64:67]
ds_read_b64_tr_b16 v[20:21], v38 offset:16384
v_lshlrev_b32 v226, 16, v227
v_mfma_f32_16x16x32_bf16 v[64:67], a[176:179], v[28:31], v[64:67]
ds_read_b64_tr_b16 v[22:23], v38 offset:16896
v_and_b32 v227, 0xffff0000, v227
v_mfma_f32_16x16x32_bf16 v[68:71], a[180:183], v[28:31], v[68:71]
ds_read_b64_tr_b16 v[24:25], v38 offset:20480
s_add_u32 s62, s97, 256
s_bitset0_b32 s62, 22
s_add_u32 m0, s98, 0
v_mfma_f32_16x16x32_bf16 v[68:71], a[164:167], v[32:35], v[68:71]
buffer_load_dwordx4 v10, s[84:87], s62 offen offset:0 lds
v_lshlrev_b32 v228, 16, v229
v_mfma_f32_16x16x32_bf16 v[72:75], a[168:171], v[32:35], v[72:75]
ds_read_b64_tr_b16 v[26:27], v38 offset:20992
v_and_b32 v229, 0xffff0000, v229
v_mfma_f32_16x16x32_bf16 v[72:75], a[184:187], v[28:31], v[72:75]
v_lshlrev_b32 v230, 16, v231
v_mfma_f32_16x16x32_bf16 v[76:79], a[188:191], v[28:31], v[76:79]
v_and_b32 v231, 0xffff0000, v231
v_mfma_f32_16x16x32_bf16 v[76:79], a[172:175], v[32:35], v[76:79]
v_mul_f32 v208, v208, v234
s_waitcnt lgkmcnt(4)
v_mfma_f32_16x16x32_bf16 v[80:83], a[160:163], v[244:247], v[80:83]
ds_read_b64_tr_b16 v[48:49], v39 offset:16384
v_mul_f32 v209, v209, v234
v_mfma_f32_16x16x32_bf16 v[80:83], a[176:179], v[240:243], v[80:83]
ds_read_b64_tr_b16 v[50:51], v39 offset:16896
v_mul_f32 v210, v210, v234
v_mfma_f32_16x16x32_bf16 v[84:87], a[180:183], v[240:243], v[84:87]
ds_read_b64_tr_b16 v[52:53], v39 offset:20480
v_mul_f32 v211, v211, v234
v_mfma_f32_16x16x32_bf16 v[84:87], a[164:167], v[244:247], v[84:87]
v_mul_f32 v212, v212, v234
v_mfma_f32_16x16x32_bf16 v[88:91], a[168:171], v[244:247], v[88:91]
ds_read_b64_tr_b16 v[54:55], v39 offset:20992
v_mul_f32 v213, v213, v234
v_mfma_f32_16x16x32_bf16 v[88:91], a[184:187], v[240:243], v[88:91]
v_mul_f32 v214, v214, v234
v_mfma_f32_16x16x32_bf16 v[92:95], a[188:191], v[240:243], v[92:95]
s_waitcnt vmcnt(16)
ds_read_b128 a[192:195], v2 offset:0
v_mfma_f32_16x16x32_bf16 v[92:95], a[172:175], v[244:247], v[92:95]
ds_read_b128 a[196:199], v2 offset:2048
v_mul_f32 v215, v215, v234
s_waitcnt lgkmcnt(6)
v_mfma_f32_16x16x32_bf16 v[96:99], a[160:163], v[20:23], v[96:99]
ds_read_b64_tr_b16 v[28:29], v36 offset:24576
v_mul_f32 v216, v216, v234
v_mfma_f32_16x16x32_bf16 v[96:99], a[176:179], v[24:27], v[96:99]
ds_read_b64_tr_b16 v[30:31], v36 offset:25088
v_mul_f32 v217, v217, v234
v_mfma_f32_16x16x32_bf16 v[100:103], a[180:183], v[24:27], v[100:103]
ds_read_b64_tr_b16 v[32:33], v36 offset:28672
v_mul_f32 v218, v218, v234
v_mfma_f32_16x16x32_bf16 v[100:103], a[164:167], v[20:23], v[100:103]
buffer_load_dwordx4 v11, s[84:87], s62 offen offset:1024 lds
v_mul_f32 v219, v219, v234
v_mfma_f32_16x16x32_bf16 v[104:107], a[168:171], v[20:23], v[104:107]
ds_read_b64_tr_b16 v[34:35], v36 offset:29184
v_mul_f32 v220, v220, v234
v_mfma_f32_16x16x32_bf16 v[104:107], a[184:187], v[24:27], v[104:107]
v_mul_f32 v221, v221, v234
v_mfma_f32_16x16x32_bf16 v[108:111], a[188:191], v[24:27], v[108:111]
ds_read_b128 a[200:203], v2 offset:4096
v_mul_f32 v222, v222, v234
v_mfma_f32_16x16x32_bf16 v[108:111], a[172:175], v[20:23], v[108:111]
v_mul_f32 v223, v223, v234
s_waitcnt lgkmcnt(7)
v_mfma_f32_16x16x32_bf16 v[112:115], a[160:163], v[48:51], v[112:115]
ds_read_b64_tr_b16 v[240:241], v37 offset:24576
v_mul_f32 v224, v224, v234
v_mfma_f32_16x16x32_bf16 v[112:115], a[176:179], v[52:55], v[112:115]
ds_read_b64_tr_b16 v[242:243], v37 offset:25088
v_mul_f32 v225, v225, v234
v_mfma_f32_16x16x32_bf16 v[116:119], a[180:183], v[52:55], v[116:119]
ds_read_b64_tr_b16 v[244:245], v37 offset:28672
v_mul_f32 v226, v226, v234
v_mfma_f32_16x16x32_bf16 v[116:119], a[164:167], v[48:51], v[116:119]
v_mul_f32 v227, v227, v234
v_mfma_f32_16x16x32_bf16 v[120:123], a[168:171], v[48:51], v[120:123]
ds_read_b64_tr_b16 v[246:247], v37 offset:29184
v_mul_f32 v228, v228, v234
v_mfma_f32_16x16x32_bf16 v[120:123], a[184:187], v[52:55], v[120:123]
v_mul_f32 v229, v229, v234
v_mfma_f32_16x16x32_bf16 v[124:127], a[188:191], v[52:55], v[124:127]
ds_read_b128 a[204:207], v2 offset:6144
v_mul_f32 v230, v230, v234
v_mfma_f32_16x16x32_bf16 v[124:127], a[172:175], v[48:51], v[124:127]
ds_read_b128 a[208:211], v3 offset:0
v_mul_f32 v231, v231, v234
s_waitcnt lgkmcnt(7)
v_mfma_f32_16x16x32_bf16 v[128:131], a[160:163], v[28:31], v[128:131]
ds_read_b64_tr_b16 v[24:25], v38 offset:24576
v_cvt_pk_bf16_f32 v208, v208, v209
v_mfma_f32_16x16x32_bf16 v[128:131], a[176:179], v[32:35], v[128:131]
ds_read_b64_tr_b16 v[26:27], v38 offset:25088
v_cvt_pk_bf16_f32 v209, v210, v211
v_mfma_f32_16x16x32_bf16 v[132:135], a[180:183], v[32:35], v[132:135]
ds_read_b64_tr_b16 v[20:21], v38 offset:28672
v_cvt_pk_bf16_f32 v210, v212, v213
v_mfma_f32_16x16x32_bf16 v[132:135], a[164:167], v[28:31], v[132:135]
buffer_load_dwordx4 v12, s[84:87], s62 offen offset:2048 lds
v_cvt_pk_bf16_f32 v211, v214, v215
v_mfma_f32_16x16x32_bf16 v[136:139], a[168:171], v[28:31], v[136:139]
ds_read_b64_tr_b16 v[22:23], v38 offset:29184
v_cvt_pk_bf16_f32 v212, v216, v217
v_mfma_f32_16x16x32_bf16 v[136:139], a[184:187], v[32:35], v[136:139]
v_cvt_pk_bf16_f32 v213, v218, v219
v_mfma_f32_16x16x32_bf16 v[140:143], a[188:191], v[32:35], v[140:143]
ds_read_b128 a[212:215], v3 offset:2048
v_cvt_pk_bf16_f32 v214, v220, v221
v_mfma_f32_16x16x32_bf16 v[140:143], a[172:175], v[28:31], v[140:143]
v_cvt_pk_bf16_f32 v215, v222, v223
s_waitcnt lgkmcnt(7)
v_mfma_f32_16x16x32_bf16 v[144:147], a[160:163], v[240:243], v[144:147]
ds_read_b64_tr_b16 v[52:53], v39 offset:24576
v_cvt_pk_bf16_f32 v216, v224, v225
v_mfma_f32_16x16x32_bf16 v[144:147], a[176:179], v[244:247], v[144:147]
ds_read_b64_tr_b16 v[54:55], v39 offset:25088
v_cvt_pk_bf16_f32 v217, v226, v227
v_mfma_f32_16x16x32_bf16 v[148:151], a[180:183], v[244:247], v[148:151]
ds_read_b64_tr_b16 v[48:49], v39 offset:28672
v_cvt_pk_bf16_f32 v218, v228, v229
v_mfma_f32_16x16x32_bf16 v[148:151], a[164:167], v[240:243], v[148:151]
v_cvt_pk_bf16_f32 v219, v230, v231
v_mfma_f32_16x16x32_bf16 v[152:155], a[168:171], v[240:243], v[152:155]
ds_read_b64_tr_b16 v[50:51], v39 offset:29184
buffer_store_dwordx4 v[208:211], v4, s[12:15], s38 offen sc1
v_mfma_f32_16x16x32_bf16 v[152:155], a[184:187], v[244:247], v[152:155]
buffer_store_dwordx4 v[212:215], v4, s[12:15], s39 offen sc1
v_mfma_f32_16x16x32_bf16 v[156:159], a[188:191], v[244:247], v[156:159]
ds_read_b128 a[216:219], v3 offset:4096
buffer_store_dwordx4 v[216:219], v4, s[12:15], s40 offen sc1
v_mfma_f32_16x16x32_bf16 v[156:159], a[172:175], v[240:243], v[156:159]
ds_read_b128 a[220:223], v3 offset:6144
s_waitcnt vmcnt(20) lgkmcnt(7)
s_barrier
v_mfma_f32_16x16x32_bf16 v[160:163], a[160:163], v[24:27], v[160:163]
ds_read_b64_tr_b16 v[32:33], v36 offset:32768
v_mfma_f32_16x16x32_bf16 v[160:163], a[176:179], v[20:23], v[160:163]
ds_read_b64_tr_b16 v[34:35], v36 offset:33280
v_mfma_f32_16x16x32_bf16 v[164:167], a[180:183], v[20:23], v[164:167]
ds_read_b64_tr_b16 v[28:29], v36 offset:36864
v_mfma_f32_16x16x32_bf16 v[164:167], a[164:167], v[24:27], v[164:167]
buffer_load_dwordx4 v13, s[84:87], s62 offen offset:3072 lds
v_mfma_f32_16x16x32_bf16 v[168:171], a[168:171], v[24:27], v[168:171]
ds_read_b64_tr_b16 v[30:31], v36 offset:37376
v_mfma_f32_16x16x32_bf16 v[168:171], a[184:187], v[20:23], v[168:171]
v_mfma_f32_16x16x32_bf16 v[172:175], a[188:191], v[20:23], v[172:175]
v_mfma_f32_16x16x32_bf16 v[172:175], a[172:175], v[24:27], v[172:175]
s_waitcnt lgkmcnt(6)
v_mfma_f32_16x16x32_bf16 v[176:179], a[160:163], v[52:55], v[176:179]
ds_read_b64_tr_b16 v[244:245], v37 offset:32768
v_mfma_f32_16x16x32_bf16 v[176:179], a[176:179], v[48:51], v[176:179]
ds_read_b64_tr_b16 v[246:247], v37 offset:33280
v_mfma_f32_16x16x32_bf16 v[180:183], a[180:183], v[48:51], v[180:183]
ds_read_b64_tr_b16 v[240:241], v37 offset:36864
v_mfma_f32_16x16x32_bf16 v[180:183], a[164:167], v[52:55], v[180:183]
v_mfma_f32_16x16x32_bf16 v[184:187], a[168:171], v[52:55], v[184:187]
ds_read_b64_tr_b16 v[242:243], v37 offset:37376
v_mfma_f32_16x16x32_bf16 v[184:187], a[184:187], v[48:51], v[184:187]
v_mfma_f32_16x16x32_bf16 v[188:191], a[188:191], v[48:51], v[188:191]
v_mfma_f32_16x16x32_bf16 v[188:191], a[172:175], v[52:55], v[188:191]
s_waitcnt lgkmcnt(4)
v_mfma_f32_16x16x32_bf16 v[64:67], a[192:195], v[32:35], v[64:67]
ds_read_b64_tr_b16 v[20:21], v38 offset:32768
v_mfma_f32_16x16x32_bf16 v[64:67], a[208:211], v[28:31], v[64:67]
ds_read_b64_tr_b16 v[22:23], v38 offset:33280
v_mfma_f32_16x16x32_bf16 v[68:71], a[212:215], v[28:31], v[68:71]
ds_read_b64_tr_b16 v[24:25], v38 offset:36864
s_add_u32 s62, s97, 1048832
s_bitset0_b32 s62, 22
s_add_u32 m0, s98, 16384
v_mfma_f32_16x16x32_bf16 v[68:71], a[196:199], v[32:35], v[68:71]
buffer_load_dwordx4 v10, s[84:87], s62 offen offset:0 lds
v_mfma_f32_16x16x32_bf16 v[72:75], a[200:203], v[32:35], v[72:75]
ds_read_b64_tr_b16 v[26:27], v38 offset:37376
v_mfma_f32_16x16x32_bf16 v[72:75], a[216:219], v[28:31], v[72:75]
v_mfma_f32_16x16x32_bf16 v[76:79], a[220:223], v[28:31], v[76:79]
v_mfma_f32_16x16x32_bf16 v[76:79], a[204:207], v[32:35], v[76:79]
s_waitcnt lgkmcnt(4)
v_mfma_f32_16x16x32_bf16 v[80:83], a[192:195], v[244:247], v[80:83]
ds_read_b64_tr_b16 v[48:49], v39 offset:32768
v_mfma_f32_16x16x32_bf16 v[80:83], a[208:211], v[240:243], v[80:83]
ds_read_b64_tr_b16 v[50:51], v39 offset:33280
v_mfma_f32_16x16x32_bf16 v[84:87], a[212:215], v[240:243], v[84:87]
ds_read_b64_tr_b16 v[52:53], v39 offset:36864
v_mfma_f32_16x16x32_bf16 v[84:87], a[196:199], v[244:247], v[84:87]
v_mfma_f32_16x16x32_bf16 v[88:91], a[200:203], v[244:247], v[88:91]
ds_read_b64_tr_b16 v[54:55], v39 offset:37376
v_mfma_f32_16x16x32_bf16 v[88:91], a[216:219], v[240:243], v[88:91]
v_mfma_f32_16x16x32_bf16 v[92:95], a[220:223], v[240:243], v[92:95]
s_waitcnt vmcnt(10)
ds_read_b128 a[224:227], v2 offset:8192
v_mfma_f32_16x16x32_bf16 v[92:95], a[204:207], v[244:247], v[92:95]
ds_read_b128 a[228:231], v2 offset:10240
s_waitcnt lgkmcnt(6)
v_mfma_f32_16x16x32_bf16 v[96:99], a[192:195], v[20:23], v[96:99]
ds_read_b64_tr_b16 v[28:29], v36 offset:40960
v_mfma_f32_16x16x32_bf16 v[96:99], a[208:211], v[24:27], v[96:99]
ds_read_b64_tr_b16 v[30:31], v36 offset:41472
v_mfma_f32_16x16x32_bf16 v[100:103], a[212:215], v[24:27], v[100:103]
ds_read_b64_tr_b16 v[32:33], v36 offset:45056
v_mfma_f32_16x16x32_bf16 v[100:103], a[196:199], v[20:23], v[100:103]
buffer_load_dwordx4 v11, s[84:87], s62 offen offset:1024 lds
v_mfma_f32_16x16x32_bf16 v[104:107], a[200:203], v[20:23], v[104:107]
ds_read_b64_tr_b16 v[34:35], v36 offset:45568
v_mfma_f32_16x16x32_bf16 v[104:107], a[216:219], v[24:27], v[104:107]
v_mfma_f32_16x16x32_bf16 v[108:111], a[220:223], v[24:27], v[108:111]
ds_read_b128 a[232:235], v2 offset:12288
v_mfma_f32_16x16x32_bf16 v[108:111], a[204:207], v[20:23], v[108:111]
s_waitcnt lgkmcnt(7)
v_mfma_f32_16x16x32_bf16 v[112:115], a[192:195], v[48:51], v[112:115]
ds_read_b64_tr_b16 v[240:241], v37 offset:40960
v_mfma_f32_16x16x32_bf16 v[112:115], a[208:211], v[52:55], v[112:115]
ds_read_b64_tr_b16 v[242:243], v37 offset:41472
v_mfma_f32_16x16x32_bf16 v[116:119], a[212:215], v[52:55], v[116:119]
ds_read_b64_tr_b16 v[244:245], v37 offset:45056
v_mfma_f32_16x16x32_bf16 v[116:119], a[196:199], v[48:51], v[116:119]
v_mfma_f32_16x16x32_bf16 v[120:123], a[200:203], v[48:51], v[120:123]
ds_read_b64_tr_b16 v[246:247], v37 offset:45568
v_mfma_f32_16x16x32_bf16 v[120:123], a[216:219], v[52:55], v[120:123]
v_mfma_f32_16x16x32_bf16 v[124:127], a[220:223], v[52:55], v[124:127]
ds_read_b128 a[236:239], v2 offset:14336
v_mfma_f32_16x16x32_bf16 v[124:127], a[204:207], v[48:51], v[124:127]
ds_read_b128 a[240:243], v3 offset:8192
s_waitcnt lgkmcnt(7)
v_mfma_f32_16x16x32_bf16 v[128:131], a[192:195], v[28:31], v[128:131]
ds_read_b64_tr_b16 v[24:25], v38 offset:40960
v_mfma_f32_16x16x32_bf16 v[128:131], a[208:211], v[32:35], v[128:131]
ds_read_b64_tr_b16 v[26:27], v38 offset:41472
v_mfma_f32_16x16x32_bf16 v[132:135], a[212:215], v[32:35], v[132:135]
ds_read_b64_tr_b16 v[20:21], v38 offset:45056
v_mfma_f32_16x16x32_bf16 v[132:135], a[196:199], v[28:31], v[132:135]
buffer_load_dwordx4 v12, s[84:87], s62 offen offset:2048 lds
v_mfma_f32_16x16x32_bf16 v[136:139], a[200:203], v[28:31], v[136:139]
ds_read_b64_tr_b16 v[22:23], v38 offset:45568
v_mfma_f32_16x16x32_bf16 v[136:139], a[216:219], v[32:35], v[136:139]
v_mfma_f32_16x16x32_bf16 v[140:143], a[220:223], v[32:35], v[140:143]
ds_read_b128 a[244:247], v3 offset:10240
v_mfma_f32_16x16x32_bf16 v[140:143], a[204:207], v[28:31], v[140:143]
s_waitcnt lgkmcnt(7)
v_mfma_f32_16x16x32_bf16 v[144:147], a[192:195], v[240:243], v[144:147]
ds_read_b64_tr_b16 v[52:53], v39 offset:40960
v_mfma_f32_16x16x32_bf16 v[144:147], a[208:211], v[244:247], v[144:147]
ds_read_b64_tr_b16 v[54:55], v39 offset:41472
v_mfma_f32_16x16x32_bf16 v[148:151], a[212:215], v[244:247], v[148:151]
ds_read_b64_tr_b16 v[48:49], v39 offset:45056
v_mfma_f32_16x16x32_bf16 v[148:151], a[196:199], v[240:243], v[148:151]
v_mfma_f32_16x16x32_bf16 v[152:155], a[200:203], v[240:243], v[152:155]
ds_read_b64_tr_b16 v[50:51], v39 offset:45568
v_mfma_f32_16x16x32_bf16 v[152:155], a[216:219], v[244:247], v[152:155]
v_mfma_f32_16x16x32_bf16 v[156:159], a[220:223], v[244:247], v[156:159]
ds_read_b128 a[248:251], v3 offset:12288
v_mfma_f32_16x16x32_bf16 v[156:159], a[204:207], v[240:243], v[156:159]
ds_read_b128 a[252:255], v3 offset:14336
s_waitcnt vmcnt(11) lgkmcnt(7)
s_barrier
v_mfma_f32_16x16x32_bf16 v[160:163], a[192:195], v[24:27], v[160:163]
ds_read_b64_tr_b16 v[32:33], v36 offset:49152
v_mfma_f32_16x16x32_bf16 v[160:163], a[208:211], v[20:23], v[160:163]
ds_read_b64_tr_b16 v[34:35], v36 offset:49664
v_mfma_f32_16x16x32_bf16 v[164:167], a[212:215], v[20:23], v[164:167]
ds_read_b64_tr_b16 v[28:29], v36 offset:53248
v_mfma_f32_16x16x32_bf16 v[164:167], a[196:199], v[24:27], v[164:167]
buffer_load_dwordx4 v13, s[84:87], s62 offen offset:3072 lds
v_mfma_f32_16x16x32_bf16 v[168:171], a[200:203], v[24:27], v[168:171]
ds_read_b64_tr_b16 v[30:31], v36 offset:53760
v_mfma_f32_16x16x32_bf16 v[168:171], a[216:219], v[20:23], v[168:171]
v_mfma_f32_16x16x32_bf16 v[172:175], a[220:223], v[20:23], v[172:175]
v_mfma_f32_16x16x32_bf16 v[172:175], a[204:207], v[24:27], v[172:175]
s_waitcnt lgkmcnt(6)
v_mfma_f32_16x16x32_bf16 v[176:179], a[192:195], v[52:55], v[176:179]
ds_read_b64_tr_b16 v[244:245], v37 offset:49152
v_mfma_f32_16x16x32_bf16 v[176:179], a[208:211], v[48:51], v[176:179]
ds_read_b64_tr_b16 v[246:247], v37 offset:49664
v_mfma_f32_16x16x32_bf16 v[180:183], a[212:215], v[48:51], v[180:183]
ds_read_b64_tr_b16 v[240:241], v37 offset:53248
v_mfma_f32_16x16x32_bf16 v[180:183], a[196:199], v[52:55], v[180:183]
v_mfma_f32_16x16x32_bf16 v[184:187], a[200:203], v[52:55], v[184:187]
ds_read_b64_tr_b16 v[242:243], v37 offset:53760
v_mfma_f32_16x16x32_bf16 v[184:187], a[216:219], v[48:51], v[184:187]
v_mfma_f32_16x16x32_bf16 v[188:191], a[220:223], v[48:51], v[188:191]
v_mfma_f32_16x16x32_bf16 v[188:191], a[204:207], v[52:55], v[188:191]
s_waitcnt lgkmcnt(4)
v_mfma_f32_16x16x32_bf16 v[64:67], a[224:227], v[32:35], v[64:67]
ds_read_b64_tr_b16 v[20:21], v38 offset:49152
v_mfma_f32_16x16x32_bf16 v[64:67], a[240:243], v[28:31], v[64:67]
ds_read_b64_tr_b16 v[22:23], v38 offset:49664
v_mfma_f32_16x16x32_bf16 v[68:71], a[244:247], v[28:31], v[68:71]
ds_read_b64_tr_b16 v[24:25], v38 offset:53248
s_add_u32 s62, s97, 2097408
s_bitset0_b32 s62, 22
s_add_u32 m0, s98, 32768
v_mfma_f32_16x16x32_bf16 v[68:71], a[228:231], v[32:35], v[68:71]
buffer_load_dwordx4 v10, s[84:87], s62 offen offset:0 lds
v_mfma_f32_16x16x32_bf16 v[72:75], a[232:235], v[32:35], v[72:75]
ds_read_b64_tr_b16 v[26:27], v38 offset:53760
v_mfma_f32_16x16x32_bf16 v[72:75], a[248:251], v[28:31], v[72:75]
v_mfma_f32_16x16x32_bf16 v[76:79], a[252:255], v[28:31], v[76:79]
v_mfma_f32_16x16x32_bf16 v[76:79], a[236:239], v[32:35], v[76:79]
s_waitcnt lgkmcnt(4)
v_mfma_f32_16x16x32_bf16 v[80:83], a[224:227], v[244:247], v[80:83]
ds_read_b64_tr_b16 v[48:49], v39 offset:49152
v_mfma_f32_16x16x32_bf16 v[80:83], a[240:243], v[240:243], v[80:83]
ds_read_b64_tr_b16 v[50:51], v39 offset:49664
v_mfma_f32_16x16x32_bf16 v[84:87], a[244:247], v[240:243], v[84:87]
ds_read_b64_tr_b16 v[52:53], v39 offset:53248
v_mfma_f32_16x16x32_bf16 v[84:87], a[228:231], v[244:247], v[84:87]
v_mfma_f32_16x16x32_bf16 v[88:91], a[232:235], v[244:247], v[88:91]
ds_read_b64_tr_b16 v[54:55], v39 offset:53760
v_mfma_f32_16x16x32_bf16 v[88:91], a[248:251], v[240:243], v[88:91]
v_mfma_f32_16x16x32_bf16 v[92:95], a[252:255], v[240:243], v[92:95]
v_mfma_f32_16x16x32_bf16 v[92:95], a[236:239], v[244:247], v[92:95]
s_waitcnt lgkmcnt(4)
v_mfma_f32_16x16x32_bf16 v[96:99], a[224:227], v[20:23], v[96:99]
ds_read_b64_tr_b16 v[28:29], v36 offset:57344
v_mfma_f32_16x16x32_bf16 v[96:99], a[240:243], v[24:27], v[96:99]
ds_read_b64_tr_b16 v[30:31], v36 offset:57856
v_mfma_f32_16x16x32_bf16 v[100:103], a[244:247], v[24:27], v[100:103]
ds_read_b64_tr_b16 v[32:33], v36 offset:61440
v_mfma_f32_16x16x32_bf16 v[100:103], a[228:231], v[20:23], v[100:103]
buffer_load_dwordx4 v11, s[84:87], s62 offen offset:1024 lds
v_mfma_f32_16x16x32_bf16 v[104:107], a[232:235], v[20:23], v[104:107]
ds_read_b64_tr_b16 v[34:35], v36 offset:61952
v_mfma_f32_16x16x32_bf16 v[104:107], a[248:251], v[24:27], v[104:107]
v_mfma_f32_16x16x32_bf16 v[108:111], a[252:255], v[24:27], v[108:111]
v_mfma_f32_16x16x32_bf16 v[108:111], a[236:239], v[20:23], v[108:111]
s_waitcnt lgkmcnt(4)
v_mfma_f32_16x16x32_bf16 v[112:115], a[224:227], v[48:51], v[112:115]
ds_read_b64_tr_b16 v[240:241], v37 offset:57344
v_mfma_f32_16x16x32_bf16 v[112:115], a[240:243], v[52:55], v[112:115]
ds_read_b64_tr_b16 v[242:243], v37 offset:57856
v_mfma_f32_16x16x32_bf16 v[116:119], a[244:247], v[52:55], v[116:119]
ds_read_b64_tr_b16 v[244:245], v37 offset:61440
v_mfma_f32_16x16x32_bf16 v[116:119], a[228:231], v[48:51], v[116:119]
v_mfma_f32_16x16x32_bf16 v[120:123], a[232:235], v[48:51], v[120:123]
ds_read_b64_tr_b16 v[246:247], v37 offset:61952
v_mfma_f32_16x16x32_bf16 v[120:123], a[248:251], v[52:55], v[120:123]
v_mfma_f32_16x16x32_bf16 v[124:127], a[252:255], v[52:55], v[124:127]
v_mfma_f32_16x16x32_bf16 v[124:127], a[236:239], v[48:51], v[124:127]
s_waitcnt lgkmcnt(4)
v_mfma_f32_16x16x32_bf16 v[128:131], a[224:227], v[28:31], v[128:131]
ds_read_b64_tr_b16 v[24:25], v38 offset:57344
v_mfma_f32_16x16x32_bf16 v[128:131], a[240:243], v[32:35], v[128:131]
ds_read_b64_tr_b16 v[26:27], v38 offset:57856
v_mfma_f32_16x16x32_bf16 v[132:135], a[244:247], v[32:35], v[132:135]
ds_read_b64_tr_b16 v[20:21], v38 offset:61440
v_mfma_f32_16x16x32_bf16 v[132:135], a[228:231], v[28:31], v[132:135]
buffer_load_dwordx4 v12, s[84:87], s62 offen offset:2048 lds
v_mfma_f32_16x16x32_bf16 v[136:139], a[232:235], v[28:31], v[136:139]
ds_read_b64_tr_b16 v[22:23], v38 offset:61952
v_cvt_pk_bf16_f32 v64, v64, v65
v_mfma_f32_16x16x32_bf16 v[136:139], a[248:251], v[32:35], v[136:139]
v_cvt_pk_bf16_f32 v65, v66, v67
v_cvt_pk_bf16_f32 v66, v68, v69
v_mfma_f32_16x16x32_bf16 v[140:143], a[252:255], v[32:35], v[140:143]
v_cvt_pk_bf16_f32 v67, v70, v71
s_add_u32 s61, s101, 0
v_mfma_f32_16x16x32_bf16 v[140:143], a[236:239], v[28:31], v[140:143]
buffer_store_dwordx4 v[64:67], v1, s[12:15], s61 offen offset:0 sc1
s_waitcnt lgkmcnt(4)
v_mfma_f32_16x16x32_bf16 v[144:147], a[224:227], v[240:243], v[144:147]
ds_read_b64_tr_b16 v[52:53], v39 offset:57344
v_mfma_f32_16x16x32_bf16 v[144:147], a[240:243], v[244:247], v[144:147]
ds_read_b64_tr_b16 v[54:55], v39 offset:57856
v_mfma_f32_16x16x32_bf16 v[148:151], a[244:247], v[244:247], v[148:151]
ds_read_b64_tr_b16 v[48:49], v39 offset:61440
v_mfma_f32_16x16x32_bf16 v[148:151], a[228:231], v[240:243], v[148:151]
v_mfma_f32_16x16x32_bf16 v[152:155], a[232:235], v[240:243], v[152:155]
ds_read_b64_tr_b16 v[50:51], v39 offset:61952
v_mfma_f32_16x16x32_bf16 v[152:155], a[248:251], v[244:247], v[152:155]
v_mfma_f32_16x16x32_bf16 v[156:159], a[252:255], v[244:247], v[156:159]
v_mfma_f32_16x16x32_bf16 v[156:159], a[236:239], v[240:243], v[156:159]
s_waitcnt vmcnt(8) lgkmcnt(4)
s_barrier
v_mfma_f32_16x16x32_bf16 v[160:163], a[224:227], v[24:27], v[160:163]
ds_read_b64_tr_b16 v[32:33], v36 offset:0
v_mfma_f32_16x16x32_bf16 v[160:163], a[240:243], v[20:23], v[160:163]
ds_read_b64_tr_b16 v[34:35], v36 offset:512
v_mfma_f32_16x16x32_bf16 v[164:167], a[244:247], v[20:23], v[164:167]
ds_read_b64_tr_b16 v[28:29], v36 offset:4096
v_mfma_f32_16x16x32_bf16 v[164:167], a[228:231], v[24:27], v[164:167]
buffer_load_dwordx4 v13, s[84:87], s62 offen offset:3072 lds
v_mfma_f32_16x16x32_bf16 v[168:171], a[232:235], v[24:27], v[168:171]
ds_read_b64_tr_b16 v[30:31], v36 offset:4608
v_cvt_pk_bf16_f32 v72, v72, v73
v_mfma_f32_16x16x32_bf16 v[168:171], a[248:251], v[20:23], v[168:171]
v_cvt_pk_bf16_f32 v73, v74, v75
v_cvt_pk_bf16_f32 v74, v76, v77
v_mfma_f32_16x16x32_bf16 v[172:175], a[252:255], v[20:23], v[172:175]
v_cvt_pk_bf16_f32 v75, v78, v79
s_add_u32 s61, s101, 8192
v_mfma_f32_16x16x32_bf16 v[172:175], a[236:239], v[24:27], v[172:175]
buffer_store_dwordx4 v[72:75], v1, s[12:15], s61 offen offset:0 sc1
s_waitcnt lgkmcnt(4)
v_mfma_f32_16x16x32_bf16 v[176:179], a[224:227], v[52:55], v[176:179]
ds_read_b64_tr_b16 v[20:21], v37 offset:0
v_mfma_f32_16x16x32_bf16 v[176:179], a[240:243], v[48:51], v[176:179]
ds_read_b64_tr_b16 v[22:23], v37 offset:512
v_mfma_f32_16x16x32_bf16 v[180:183], a[244:247], v[48:51], v[180:183]
ds_read_b64_tr_b16 v[24:25], v37 offset:4096
v_mfma_f32_16x16x32_bf16 v[180:183], a[228:231], v[52:55], v[180:183]
v_mfma_f32_16x16x32_bf16 v[184:187], a[232:235], v[52:55], v[184:187]
ds_read_b64_tr_b16 v[26:27], v37 offset:4608
v_mfma_f32_16x16x32_bf16 v[184:187], a[248:251], v[48:51], v[184:187]
v_mfma_f32_16x16x32_bf16 v[188:191], a[252:255], v[48:51], v[188:191]
v_mfma_f32_16x16x32_bf16 v[188:191], a[236:239], v[52:55], v[188:191]
s_waitcnt lgkmcnt(4)
v_mfma_f32_16x16x32_bf16 v[192:195], a[0:3], v[32:35], 0
ds_read_b64_tr_b16 v[48:49], v38 offset:0
v_mfma_f32_16x16x32_bf16 v[192:195], a[16:19], v[28:31], v[192:195]
ds_read_b64_tr_b16 v[50:51], v38 offset:512
v_mfma_f32_16x16x32_bf16 v[196:199], a[20:23], v[28:31], 0
ds_read_b64_tr_b16 v[52:53], v38 offset:4096
s_add_u32 s62, s97, 3145984
s_bitset0_b32 s62, 22
s_add_u32 m0, s98, 49152
v_mfma_f32_16x16x32_bf16 v[196:199], a[4:7], v[32:35], v[196:199]
buffer_load_dwordx4 v10, s[84:87], s62 offen offset:0 lds
v_mfma_f32_16x16x32_bf16 v[200:203], a[8:11], v[32:35], 0
ds_read_b64_tr_b16 v[54:55], v38 offset:4608
v_cvt_pk_bf16_f32 v80, v80, v81
v_mfma_f32_16x16x32_bf16 v[200:203], a[24:27], v[28:31], v[200:203]
v_cvt_pk_bf16_f32 v81, v82, v83
v_cvt_pk_bf16_f32 v82, v84, v85
v_mfma_f32_16x16x32_bf16 v[204:207], a[28:31], v[28:31], 0
v_cvt_pk_bf16_f32 v83, v86, v87
s_add_u32 s61, s101, 0
v_mfma_f32_16x16x32_bf16 v[204:207], a[12:15], v[32:35], v[204:207]
buffer_store_dwordx4 v[80:83], v1, s[12:15], s61 offen offset:1024 sc1
s_waitcnt lgkmcnt(4)
v_mfma_f32_16x16x32_bf16 v[208:211], a[0:3], v[20:23], 0
ds_read_b64_tr_b16 v[28:29], v39 offset:0
v_mfma_f32_16x16x32_bf16 v[208:211], a[16:19], v[24:27], v[208:211]
ds_read_b64_tr_b16 v[30:31], v39 offset:512
v_mfma_f32_16x16x32_bf16 v[212:215], a[20:23], v[24:27], 0
ds_read_b64_tr_b16 v[32:33], v39 offset:4096
v_mfma_f32_16x16x32_bf16 v[212:215], a[4:7], v[20:23], v[212:215]
v_mfma_f32_16x16x32_bf16 v[216:219], a[8:11], v[20:23], 0
ds_read_b64_tr_b16 v[34:35], v39 offset:4608
v_mfma_f32_16x16x32_bf16 v[216:219], a[24:27], v[24:27], v[216:219]
v_mfma_f32_16x16x32_bf16 v[220:223], a[28:31], v[24:27], 0
v_mfma_f32_16x16x32_bf16 v[220:223], a[12:15], v[20:23], v[220:223]
s_waitcnt lgkmcnt(4)
v_mfma_f32_16x16x32_bf16 v[224:227], a[0:3], v[48:51], 0
ds_read_b64_tr_b16 v[24:25], v36 offset:8192
v_mfma_f32_16x16x32_bf16 v[224:227], a[16:19], v[52:55], v[224:227]
ds_read_b64_tr_b16 v[26:27], v36 offset:8704
v_mfma_f32_16x16x32_bf16 v[228:231], a[20:23], v[52:55], 0
ds_read_b64_tr_b16 v[20:21], v36 offset:12288
v_mfma_f32_16x16x32_bf16 v[228:231], a[4:7], v[48:51], v[228:231]
buffer_load_dwordx4 v11, s[84:87], s62 offen offset:1024 lds
v_mfma_f32_16x16x32_bf16 v[232:235], a[8:11], v[48:51], 0
ds_read_b64_tr_b16 v[22:23], v36 offset:12800
v_cvt_pk_bf16_f32 v88, v88, v89
v_mfma_f32_16x16x32_bf16 v[232:235], a[24:27], v[52:55], v[232:235]
v_cvt_pk_bf16_f32 v89, v90, v91
v_cvt_pk_bf16_f32 v90, v92, v93
v_mfma_f32_16x16x32_bf16 v[236:239], a[28:31], v[52:55], 0
v_cvt_pk_bf16_f32 v91, v94, v95
s_add_u32 s61, s101, 8192
v_mfma_f32_16x16x32_bf16 v[236:239], a[12:15], v[48:51], v[236:239]
buffer_store_dwordx4 v[88:91], v1, s[12:15], s61 offen offset:1024 sc1
s_waitcnt lgkmcnt(4)
v_mfma_f32_16x16x32_bf16 v[240:243], a[0:3], v[28:31], 0
ds_read_b64_tr_b16 v[52:53], v37 offset:8192
v_mfma_f32_16x16x32_bf16 v[240:243], a[16:19], v[32:35], v[240:243]
ds_read_b64_tr_b16 v[54:55], v37 offset:8704
v_mfma_f32_16x16x32_bf16 v[244:247], a[20:23], v[32:35], 0
ds_read_b64_tr_b16 v[48:49], v37 offset:12288
v_mfma_f32_16x16x32_bf16 v[244:247], a[4:7], v[28:31], v[244:247]
v_mfma_f32_16x16x32_bf16 v[248:251], a[8:11], v[28:31], 0
ds_read_b64_tr_b16 v[50:51], v37 offset:12800
v_mfma_f32_16x16x32_bf16 v[248:251], a[24:27], v[32:35], v[248:251]
v_mfma_f32_16x16x32_bf16 v[252:255], a[28:31], v[32:35], 0
v_mfma_f32_16x16x32_bf16 v[252:255], a[12:15], v[28:31], v[252:255]
s_waitcnt lgkmcnt(4)
v_mfma_f32_16x16x32_bf16 v[192:195], a[32:35], v[24:27], v[192:195]
ds_read_b64_tr_b16 v[32:33], v38 offset:8192
v_mfma_f32_16x16x32_bf16 v[192:195], a[48:51], v[20:23], v[192:195]
ds_read_b64_tr_b16 v[34:35], v38 offset:8704
v_mfma_f32_16x16x32_bf16 v[196:199], a[52:55], v[20:23], v[196:199]
ds_read_b64_tr_b16 v[28:29], v38 offset:12288
v_mfma_f32_16x16x32_bf16 v[196:199], a[36:39], v[24:27], v[196:199]
buffer_load_dwordx4 v12, s[84:87], s62 offen offset:2048 lds
v_mfma_f32_16x16x32_bf16 v[200:203], a[40:43], v[24:27], v[200:203]
ds_read_b64_tr_b16 v[30:31], v38 offset:12800
v_cvt_pk_bf16_f32 v96, v96, v97
v_mfma_f32_16x16x32_bf16 v[200:203], a[56:59], v[20:23], v[200:203]
v_cvt_pk_bf16_f32 v97, v98, v99
v_cvt_pk_bf16_f32 v98, v100, v101
v_mfma_f32_16x16x32_bf16 v[204:207], a[60:63], v[20:23], v[204:207]
v_cvt_pk_bf16_f32 v99, v102, v103
s_add_u32 s61, s101, 0
v_mfma_f32_16x16x32_bf16 v[204:207], a[44:47], v[24:27], v[204:207]
buffer_store_dwordx4 v[96:99], v1, s[12:15], s61 offen offset:2048 sc1
s_waitcnt lgkmcnt(4)
v_mfma_f32_16x16x32_bf16 v[208:211], a[32:35], v[52:55], v[208:211]
ds_read_b64_tr_b16 v[20:21], v39 offset:8192
v_mfma_f32_16x16x32_bf16 v[208:211], a[48:51], v[48:51], v[208:211]
ds_read_b64_tr_b16 v[22:23], v39 offset:8704
v_mfma_f32_16x16x32_bf16 v[212:215], a[52:55], v[48:51], v[212:215]
ds_read_b64_tr_b16 v[24:25], v39 offset:12288
v_mfma_f32_16x16x32_bf16 v[212:215], a[36:39], v[52:55], v[212:215]
v_mfma_f32_16x16x32_bf16 v[216:219], a[40:43], v[52:55], v[216:219]
ds_read_b64_tr_b16 v[26:27], v39 offset:12800
v_mfma_f32_16x16x32_bf16 v[216:219], a[56:59], v[48:51], v[216:219]
v_mfma_f32_16x16x32_bf16 v[220:223], a[60:63], v[48:51], v[220:223]
v_mfma_f32_16x16x32_bf16 v[220:223], a[44:47], v[52:55], v[220:223]
s_waitcnt vmcnt(12) lgkmcnt(4)
s_barrier
v_mfma_f32_16x16x32_bf16 v[224:227], a[32:35], v[32:35], v[224:227]
ds_read_b64_tr_b16 v[48:49], v36 offset:16384
v_mfma_f32_16x16x32_bf16 v[224:227], a[48:51], v[28:31], v[224:227]
ds_read_b64_tr_b16 v[50:51], v36 offset:16896
v_mfma_f32_16x16x32_bf16 v[228:231], a[52:55], v[28:31], v[228:231]
ds_read_b64_tr_b16 v[52:53], v36 offset:20480
v_mfma_f32_16x16x32_bf16 v[228:231], a[36:39], v[32:35], v[228:231]
buffer_load_dwordx4 v13, s[84:87], s62 offen offset:3072 lds
v_mfma_f32_16x16x32_bf16 v[232:235], a[40:43], v[32:35], v[232:235]
ds_read_b64_tr_b16 v[54:55], v36 offset:20992
v_cvt_pk_bf16_f32 v104, v104, v105
v_mfma_f32_16x16x32_bf16 v[232:235], a[56:59], v[28:31], v[232:235]
v_cvt_pk_bf16_f32 v105, v106, v107
v_cvt_pk_bf16_f32 v106, v108, v109
v_mfma_f32_16x16x32_bf16 v[236:239], a[60:63], v[28:31], v[236:239]
v_cvt_pk_bf16_f32 v107, v110, v111
s_add_u32 s61, s101, 8192
v_mfma_f32_16x16x32_bf16 v[236:239], a[44:47], v[32:35], v[236:239]
buffer_store_dwordx4 v[104:107], v1, s[12:15], s61 offen offset:2048 sc1
s_waitcnt lgkmcnt(4)
v_mfma_f32_16x16x32_bf16 v[240:243], a[32:35], v[20:23], v[240:243]
s_mov_b64 exec, 1
buffer_store_dword v8, off, s[12:15], s6 offset:0 sc1
s_mov_b64 exec, -1
ds_read_b64_tr_b16 v[28:29], v37 offset:16384
v_mfma_f32_16x16x32_bf16 v[240:243], a[48:51], v[24:27], v[240:243]
ds_read_b64_tr_b16 v[30:31], v37 offset:16896
v_mfma_f32_16x16x32_bf16 v[244:247], a[52:55], v[24:27], v[244:247]
ds_read_b64_tr_b16 v[32:33], v37 offset:20480
v_mfma_f32_16x16x32_bf16 v[244:247], a[36:39], v[20:23], v[244:247]
v_mfma_f32_16x16x32_bf16 v[248:251], a[40:43], v[20:23], v[248:251]
ds_read_b64_tr_b16 v[34:35], v37 offset:20992
v_mfma_f32_16x16x32_bf16 v[248:251], a[56:59], v[24:27], v[248:251]
v_mfma_f32_16x16x32_bf16 v[252:255], a[60:63], v[24:27], v[252:255]
v_mfma_f32_16x16x32_bf16 v[252:255], a[44:47], v[20:23], v[252:255]
s_waitcnt lgkmcnt(4)
v_mfma_f32_16x16x32_bf16 v[192:195], a[64:67], v[48:51], v[192:195]
ds_read_b64_tr_b16 v[24:25], v38 offset:16384
v_mfma_f32_16x16x32_bf16 v[192:195], a[80:83], v[52:55], v[192:195]
ds_read_b64_tr_b16 v[26:27], v38 offset:16896
v_mfma_f32_16x16x32_bf16 v[196:199], a[84:87], v[52:55], v[196:199]
ds_read_b64_tr_b16 v[20:21], v38 offset:20480
s_add_u32 s62, s97, 384
s_bitset0_b32 s62, 22
s_add_u32 m0, s98, 0
v_mfma_f32_16x16x32_bf16 v[196:199], a[68:71], v[48:51], v[196:199]
buffer_load_dwordx4 v10, s[84:87], s62 offen offset:0 lds
v_mfma_f32_16x16x32_bf16 v[200:203], a[72:75], v[48:51], v[200:203]
ds_read_b64_tr_b16 v[22:23], v38 offset:20992
v_cvt_pk_bf16_f32 v112, v112, v113
v_mfma_f32_16x16x32_bf16 v[200:203], a[88:91], v[52:55], v[200:203]
v_cvt_pk_bf16_f32 v113, v114, v115
v_cvt_pk_bf16_f32 v114, v116, v117
v_mfma_f32_16x16x32_bf16 v[204:207], a[92:95], v[52:55], v[204:207]
v_cvt_pk_bf16_f32 v115, v118, v119
s_add_u32 s61, s101, 0
v_mfma_f32_16x16x32_bf16 v[204:207], a[76:79], v[48:51], v[204:207]
buffer_store_dwordx4 v[112:115], v1, s[12:15], s61 offen offset:3072 sc1
s_waitcnt lgkmcnt(4)
v_mfma_f32_16x16x32_bf16 v[208:211], a[64:67], v[28:31], v[208:211]
ds_read_b64_tr_b16 v[52:53], v39 offset:16384
v_mfma_f32_16x16x32_bf16 v[208:211], a[80:83], v[32:35], v[208:211]
ds_read_b64_tr_b16 v[54:55], v39 offset:16896
v_mfma_f32_16x16x32_bf16 v[212:215], a[84:87], v[32:35], v[212:215]
ds_read_b64_tr_b16 v[48:49], v39 offset:20480
v_mfma_f32_16x16x32_bf16 v[212:215], a[68:71], v[28:31], v[212:215]
v_mfma_f32_16x16x32_bf16 v[216:219], a[72:75], v[28:31], v[216:219]
ds_read_b64_tr_b16 v[50:51], v39 offset:20992
v_mfma_f32_16x16x32_bf16 v[216:219], a[88:91], v[32:35], v[216:219]
v_mfma_f32_16x16x32_bf16 v[220:223], a[92:95], v[32:35], v[220:223]
v_mfma_f32_16x16x32_bf16 v[220:223], a[76:79], v[28:31], v[220:223]
s_waitcnt lgkmcnt(4)
v_mfma_f32_16x16x32_bf16 v[224:227], a[64:67], v[24:27], v[224:227]
ds_read_b64_tr_b16 v[32:33], v36 offset:24576
v_mfma_f32_16x16x32_bf16 v[224:227], a[80:83], v[20:23], v[224:227]
ds_read_b64_tr_b16 v[34:35], v36 offset:25088
v_mfma_f32_16x16x32_bf16 v[228:231], a[84:87], v[20:23], v[228:231]
ds_read_b64_tr_b16 v[28:29], v36 offset:28672
v_mfma_f32_16x16x32_bf16 v[228:231], a[68:71], v[24:27], v[228:231]
buffer_load_dwordx4 v11, s[84:87], s62 offen offset:1024 lds
v_mfma_f32_16x16x32_bf16 v[232:235], a[72:75], v[24:27], v[232:235]
ds_read_b64_tr_b16 v[30:31], v36 offset:29184
v_cvt_pk_bf16_f32 v120, v120, v121
v_mfma_f32_16x16x32_bf16 v[232:235], a[88:91], v[20:23], v[232:235]
v_cvt_pk_bf16_f32 v121, v122, v123
v_cvt_pk_bf16_f32 v122, v124, v125
v_mfma_f32_16x16x32_bf16 v[236:239], a[92:95], v[20:23], v[236:239]
v_cvt_pk_bf16_f32 v123, v126, v127
s_add_u32 s61, s101, 8192
v_mfma_f32_16x16x32_bf16 v[236:239], a[76:79], v[24:27], v[236:239]
buffer_store_dwordx4 v[120:123], v1, s[12:15], s61 offen offset:3072 sc1
s_waitcnt lgkmcnt(4)
v_mfma_f32_16x16x32_bf16 v[240:243], a[64:67], v[52:55], v[240:243]
ds_read_b64_tr_b16 v[20:21], v37 offset:24576
v_mfma_f32_16x16x32_bf16 v[240:243], a[80:83], v[48:51], v[240:243]
ds_read_b64_tr_b16 v[22:23], v37 offset:25088
v_mfma_f32_16x16x32_bf16 v[244:247], a[84:87], v[48:51], v[244:247]
ds_read_b64_tr_b16 v[24:25], v37 offset:28672
v_mfma_f32_16x16x32_bf16 v[244:247], a[68:71], v[52:55], v[244:247]
v_mfma_f32_16x16x32_bf16 v[248:251], a[72:75], v[52:55], v[248:251]
ds_read_b64_tr_b16 v[26:27], v37 offset:29184
v_mfma_f32_16x16x32_bf16 v[248:251], a[88:91], v[48:51], v[248:251]
v_mfma_f32_16x16x32_bf16 v[252:255], a[92:95], v[48:51], v[252:255]
v_mfma_f32_16x16x32_bf16 v[252:255], a[76:79], v[52:55], v[252:255]
s_waitcnt lgkmcnt(4)
v_mfma_f32_16x16x32_bf16 v[192:195], a[96:99], v[32:35], v[192:195]
ds_read_b64_tr_b16 v[48:49], v38 offset:24576
v_mfma_f32_16x16x32_bf16 v[192:195], a[112:115], v[28:31], v[192:195]
ds_read_b64_tr_b16 v[50:51], v38 offset:25088
v_mfma_f32_16x16x32_bf16 v[196:199], a[116:119], v[28:31], v[196:199]
ds_read_b64_tr_b16 v[52:53], v38 offset:28672
v_mfma_f32_16x16x32_bf16 v[196:199], a[100:103], v[32:35], v[196:199]
buffer_load_dwordx4 v12, s[84:87], s62 offen offset:2048 lds
v_mfma_f32_16x16x32_bf16 v[200:203], a[104:107], v[32:35], v[200:203]
ds_read_b64_tr_b16 v[54:55], v38 offset:29184
v_cvt_pk_bf16_f32 v128, v128, v129
v_mfma_f32_16x16x32_bf16 v[200:203], a[120:123], v[28:31], v[200:203]
v_cvt_pk_bf16_f32 v129, v130, v131
v_cvt_pk_bf16_f32 v130, v132, v133
v_mfma_f32_16x16x32_bf16 v[204:207], a[124:127], v[28:31], v[204:207]
v_cvt_pk_bf16_f32 v131, v134, v135
s_add_u32 s61, s101, 4096
v_mfma_f32_16x16x32_bf16 v[204:207], a[108:111], v[32:35], v[204:207]
buffer_store_dwordx4 v[128:131], v1, s[12:15], s61 offen offset:0 sc1
s_waitcnt lgkmcnt(4)
v_mfma_f32_16x16x32_bf16 v[208:211], a[96:99], v[20:23], v[208:211]
ds_read_b64_tr_b16 v[28:29], v39 offset:24576
v_mfma_f32_16x16x32_bf16 v[208:211], a[112:115], v[24:27], v[208:211]
ds_read_b64_tr_b16 v[30:31], v39 offset:25088
v_mfma_f32_16x16x32_bf16 v[212:215], a[116:119], v[24:27], v[212:215]
ds_read_b64_tr_b16 v[32:33], v39 offset:28672
v_mfma_f32_16x16x32_bf16 v[212:215], a[100:103], v[20:23], v[212:215]
v_mfma_f32_16x16x32_bf16 v[216:219], a[104:107], v[20:23], v[216:219]
ds_read_b64_tr_b16 v[34:35], v39 offset:29184
v_mfma_f32_16x16x32_bf16 v[216:219], a[120:123], v[24:27], v[216:219]
v_mfma_f32_16x16x32_bf16 v[220:223], a[124:127], v[24:27], v[220:223]
v_mfma_f32_16x16x32_bf16 v[220:223], a[108:111], v[20:23], v[220:223]
s_waitcnt vmcnt(16) lgkmcnt(4)
s_barrier
v_mfma_f32_16x16x32_bf16 v[224:227], a[96:99], v[48:51], v[224:227]
ds_read_b64_tr_b16 v[24:25], v36 offset:32768
v_mfma_f32_16x16x32_bf16 v[224:227], a[112:115], v[52:55], v[224:227]
ds_read_b64_tr_b16 v[26:27], v36 offset:33280
v_mfma_f32_16x16x32_bf16 v[228:231], a[116:119], v[52:55], v[228:231]
ds_read_b64_tr_b16 v[20:21], v36 offset:36864
v_mfma_f32_16x16x32_bf16 v[228:231], a[100:103], v[48:51], v[228:231]
buffer_load_dwordx4 v13, s[84:87], s62 offen offset:3072 lds
v_mfma_f32_16x16x32_bf16 v[232:235], a[104:107], v[48:51], v[232:235]
ds_read_b64_tr_b16 v[22:23], v36 offset:37376
v_mfma_f32_16x16x32_bf16 v[232:235], a[120:123], v[52:55], v[232:235]
v_mfma_f32_16x16x32_bf16 v[236:239], a[124:127], v[52:55], v[236:239]
v_cvt_pk_bf16_f32 v136, v136, v137
v_cvt_pk_bf16_f32 v137, v138, v139
v_mfma_f32_16x16x32_bf16 v[236:239], a[108:111], v[48:51], v[236:239]
v_cvt_pk_bf16_f32 v138, v140, v141
v_cvt_pk_bf16_f32 v139, v142, v143
s_waitcnt lgkmcnt(4)
v_mfma_f32_16x16x32_bf16 v[240:243], a[96:99], v[28:31], v[240:243]
ds_read_b64_tr_b16 v[52:53], v37 offset:32768
s_add_u32 s61, s101, 12288
v_mfma_f32_16x16x32_bf16 v[240:243], a[112:115], v[32:35], v[240:243]
ds_read_b64_tr_b16 v[54:55], v37 offset:33280
buffer_store_dwordx4 v[136:139], v1, s[12:15], s61 offen offset:0 sc1
v_mfma_f32_16x16x32_bf16 v[244:247], a[116:119], v[32:35], v[244:247]
ds_read_b64_tr_b16 v[48:49], v37 offset:36864
v_mfma_f32_16x16x32_bf16 v[244:247], a[100:103], v[28:31], v[244:247]
v_mfma_f32_16x16x32_bf16 v[248:251], a[104:107], v[28:31], v[248:251]
ds_read_b64_tr_b16 v[50:51], v37 offset:37376
v_mfma_f32_16x16x32_bf16 v[248:251], a[120:123], v[32:35], v[248:251]
v_mfma_f32_16x16x32_bf16 v[252:255], a[124:127], v[32:35], v[252:255]
v_mfma_f32_16x16x32_bf16 v[252:255], a[108:111], v[28:31], v[252:255]
s_waitcnt lgkmcnt(4)
v_mfma_f32_16x16x32_bf16 v[192:195], a[128:131], v[24:27], v[192:195]
ds_read_b64_tr_b16 v[32:33], v38 offset:32768
v_mfma_f32_16x16x32_bf16 v[192:195], a[144:147], v[20:23], v[192:195]
ds_read_b64_tr_b16 v[34:35], v38 offset:33280
v_mfma_f32_16x16x32_bf16 v[196:199], a[148:151], v[20:23], v[196:199]
ds_read_b64_tr_b16 v[28:29], v38 offset:36864
s_add_u32 s62, s97, 1048960
s_bitset0_b32 s62, 22
s_add_u32 m0, s98, 16384
v_mfma_f32_16x16x32_bf16 v[196:199], a[132:135], v[24:27], v[196:199]
buffer_load_dwordx4 v10, s[84:87], s62 offen offset:0 lds
v_mfma_f32_16x16x32_bf16 v[200:203], a[136:139], v[24:27], v[200:203]
ds_read_b64_tr_b16 v[30:31], v38 offset:37376
v_mfma_f32_16x16x32_bf16 v[200:203], a[152:155], v[20:23], v[200:203]
v_mfma_f32_16x16x32_bf16 v[204:207], a[156:159], v[20:23], v[204:207]
v_mfma_f32_16x16x32_bf16 v[204:207], a[140:143], v[24:27], v[204:207]
s_waitcnt lgkmcnt(4)
v_mfma_f32_16x16x32_bf16 v[208:211], a[128:131], v[52:55], v[208:211]
ds_read_b64_tr_b16 v[20:21], v39 offset:32768
v_cvt_pk_bf16_f32 v144, v144, v145
v_mfma_f32_16x16x32_bf16 v[208:211], a[144:147], v[48:51], v[208:211]
ds_read_b64_tr_b16 v[22:23], v39 offset:33280
v_cvt_pk_bf16_f32 v145, v146, v147
v_mfma_f32_16x16x32_bf16 v[212:215], a[148:151], v[48:51], v[212:215]
ds_read_b64_tr_b16 v[24:25], v39 offset:36864
v_cvt_pk_bf16_f32 v146, v148, v149
v_mfma_f32_16x16x32_bf16 v[212:215], a[132:135], v[52:55], v[212:215]
v_cvt_pk_bf16_f32 v147, v150, v151
s_add_u32 s61, s101, 4096
v_mfma_f32_16x16x32_bf16 v[216:219], a[136:139], v[52:55], v[216:219]
ds_read_b64_tr_b16 v[26:27], v39 offset:37376
buffer_store_dwordx4 v[144:147], v1, s[12:15], s61 offen offset:1024 sc1
v_mfma_f32_16x16x32_bf16 v[216:219], a[152:155], v[48:51], v[216:219]
v_mfma_f32_16x16x32_bf16 v[220:223], a[156:159], v[48:51], v[220:223]
v_mfma_f32_16x16x32_bf16 v[220:223], a[140:143], v[52:55], v[220:223]
s_waitcnt lgkmcnt(4)
v_mfma_f32_16x16x32_bf16 v[224:227], a[128:131], v[32:35], v[224:227]
ds_read_b64_tr_b16 v[48:49], v36 offset:40960
v_mfma_f32_16x16x32_bf16 v[224:227], a[144:147], v[28:31], v[224:227]
ds_read_b64_tr_b16 v[50:51], v36 offset:41472
v_mfma_f32_16x16x32_bf16 v[228:231], a[148:151], v[28:31], v[228:231]
ds_read_b64_tr_b16 v[52:53], v36 offset:45056
v_mfma_f32_16x16x32_bf16 v[228:231], a[132:135], v[32:35], v[228:231]
buffer_load_dwordx4 v11, s[84:87], s62 offen offset:1024 lds
v_mfma_f32_16x16x32_bf16 v[232:235], a[136:139], v[32:35], v[232:235]
ds_read_b64_tr_b16 v[54:55], v36 offset:45568
v_mfma_f32_16x16x32_bf16 v[232:235], a[152:155], v[28:31], v[232:235]
v_mfma_f32_16x16x32_bf16 v[236:239], a[156:159], v[28:31], v[236:239]
v_mfma_f32_16x16x32_bf16 v[236:239], a[140:143], v[32:35], v[236:239]
s_waitcnt lgkmcnt(4)
v_mfma_f32_16x16x32_bf16 v[240:243], a[128:131], v[20:23], v[240:243]
ds_read_b64_tr_b16 v[28:29], v37 offset:40960
v_mfma_f32_16x16x32_bf16 v[240:243], a[144:147], v[24:27], v[240:243]
ds_read_b64_tr_b16 v[30:31], v37 offset:41472
v_mfma_f32_16x16x32_bf16 v[244:247], a[148:151], v[24:27], v[244:247]
ds_read_b64_tr_b16 v[32:33], v37 offset:45056
v_cvt_pk_bf16_f32 v152, v152, v153
v_mfma_f32_16x16x32_bf16 v[244:247], a[132:135], v[20:23], v[244:247]
v_cvt_pk_bf16_f32 v153, v154, v155
v_cvt_pk_bf16_f32 v154, v156, v157
v_mfma_f32_16x16x32_bf16 v[248:251], a[136:139], v[20:23], v[248:251]
ds_read_b64_tr_b16 v[34:35], v37 offset:45568
v_cvt_pk_bf16_f32 v155, v158, v159
v_mfma_f32_16x16x32_bf16 v[248:251], a[152:155], v[24:27], v[248:251]
s_add_u32 s61, s101, 12288
buffer_store_dwordx4 v[152:155], v1, s[12:15], s61 offen offset:1024 sc1
v_mfma_f32_16x16x32_bf16 v[252:255], a[156:159], v[24:27], v[252:255]
v_mfma_f32_16x16x32_bf16 v[252:255], a[140:143], v[20:23], v[252:255]
s_waitcnt lgkmcnt(4)
v_mfma_f32_16x16x32_bf16 v[192:195], a[160:163], v[48:51], v[192:195]
ds_read_b64_tr_b16 v[24:25], v38 offset:40960
v_mfma_f32_16x16x32_bf16 v[192:195], a[176:179], v[52:55], v[192:195]
ds_read_b64_tr_b16 v[26:27], v38 offset:41472
v_mfma_f32_16x16x32_bf16 v[196:199], a[180:183], v[52:55], v[196:199]
ds_read_b64_tr_b16 v[20:21], v38 offset:45056
v_mfma_f32_16x16x32_bf16 v[196:199], a[164:167], v[48:51], v[196:199]
buffer_load_dwordx4 v12, s[84:87], s62 offen offset:2048 lds
v_mfma_f32_16x16x32_bf16 v[200:203], a[168:171], v[48:51], v[200:203]
ds_read_b64_tr_b16 v[22:23], v38 offset:45568
v_mfma_f32_16x16x32_bf16 v[200:203], a[184:187], v[52:55], v[200:203]
v_mfma_f32_16x16x32_bf16 v[204:207], a[188:191], v[52:55], v[204:207]
v_mfma_f32_16x16x32_bf16 v[204:207], a[172:175], v[48:51], v[204:207]
s_waitcnt lgkmcnt(4)
v_mfma_f32_16x16x32_bf16 v[208:211], a[160:163], v[28:31], v[208:211]
ds_read_b64_tr_b16 v[52:53], v39 offset:40960
v_mfma_f32_16x16x32_bf16 v[208:211], a[176:179], v[32:35], v[208:211]
ds_read_b64_tr_b16 v[54:55], v39 offset:41472
v_mfma_f32_16x16x32_bf16 v[212:215], a[180:183], v[32:35], v[212:215]
ds_read_b64_tr_b16 v[48:49], v39 offset:45056
v_mfma_f32_16x16x32_bf16 v[212:215], a[164:167], v[28:31], v[212:215]
v_mfma_f32_16x16x32_bf16 v[216:219], a[168:171], v[28:31], v[216:219]
ds_read_b64_tr_b16 v[50:51], v39 offset:45568
v_cvt_pk_bf16_f32 v160, v160, v161
v_mfma_f32_16x16x32_bf16 v[216:219], a[184:187], v[32:35], v[216:219]
v_cvt_pk_bf16_f32 v161, v162, v163
v_cvt_pk_bf16_f32 v162, v164, v165
v_mfma_f32_16x16x32_bf16 v[220:223], a[188:191], v[32:35], v[220:223]
v_cvt_pk_bf16_f32 v163, v166, v167
s_add_u32 s61, s101, 4096
v_mfma_f32_16x16x32_bf16 v[220:223], a[172:175], v[28:31], v[220:223]
buffer_store_dwordx4 v[160:163], v1, s[12:15], s61 offen offset:2048 sc1
s_waitcnt vmcnt(16) lgkmcnt(4)
s_barrier
v_mfma_f32_16x16x32_bf16 v[224:227], a[160:163], v[24:27], v[224:227]
ds_read_b64_tr_b16 v[32:33], v36 offset:49152
v_mfma_f32_16x16x32_bf16 v[224:227], a[176:179], v[20:23], v[224:227]
ds_read_b64_tr_b16 v[34:35], v36 offset:49664
v_mfma_f32_16x16x32_bf16 v[228:231], a[180:183], v[20:23], v[228:231]
ds_read_b64_tr_b16 v[28:29], v36 offset:53248
v_mfma_f32_16x16x32_bf16 v[228:231], a[164:167], v[24:27], v[228:231]
buffer_load_dwordx4 v13, s[84:87], s62 offen offset:3072 lds
v_mfma_f32_16x16x32_bf16 v[232:235], a[168:171], v[24:27], v[232:235]
ds_read_b64_tr_b16 v[30:31], v36 offset:53760
v_mfma_f32_16x16x32_bf16 v[232:235], a[184:187], v[20:23], v[232:235]
v_mfma_f32_16x16x32_bf16 v[236:239], a[188:191], v[20:23], v[236:239]
v_mfma_f32_16x16x32_bf16 v[236:239], a[172:175], v[24:27], v[236:239]
s_waitcnt lgkmcnt(4)
v_mfma_f32_16x16x32_bf16 v[240:243], a[160:163], v[52:55], v[240:243]
ds_read_b64_tr_b16 v[20:21], v37 offset:49152
v_mfma_f32_16x16x32_bf16 v[240:243], a[176:179], v[48:51], v[240:243]
ds_read_b64_tr_b16 v[22:23], v37 offset:49664
v_mfma_f32_16x16x32_bf16 v[244:247], a[180:183], v[48:51], v[244:247]
ds_read_b64_tr_b16 v[24:25], v37 offset:53248
v_mfma_f32_16x16x32_bf16 v[244:247], a[164:167], v[52:55], v[244:247]
v_mfma_f32_16x16x32_bf16 v[248:251], a[168:171], v[52:55], v[248:251]
ds_read_b64_tr_b16 v[26:27], v37 offset:53760
v_mfma_f32_16x16x32_bf16 v[248:251], a[184:187], v[48:51], v[248:251]
v_mfma_f32_16x16x32_bf16 v[252:255], a[188:191], v[48:51], v[252:255]
v_cvt_pk_bf16_f32 v168, v168, v169
v_cvt_pk_bf16_f32 v169, v170, v171
v_mfma_f32_16x16x32_bf16 v[252:255], a[172:175], v[52:55], v[252:255]
v_cvt_pk_bf16_f32 v170, v172, v173
v_cvt_pk_bf16_f32 v171, v174, v175
s_waitcnt lgkmcnt(4)
v_mfma_f32_16x16x32_bf16 v[192:195], a[192:195], v[32:35], v[192:195]
ds_read_b64_tr_b16 v[48:49], v38 offset:49152
s_add_u32 s61, s101, 12288
v_mfma_f32_16x16x32_bf16 v[192:195], a[208:211], v[28:31], v[192:195]
ds_read_b64_tr_b16 v[50:51], v38 offset:49664
buffer_store_dwordx4 v[168:171], v1, s[12:15], s61 offen offset:2048 sc1
v_mfma_f32_16x16x32_bf16 v[196:199], a[212:215], v[28:31], v[196:199]
ds_read_b64_tr_b16 v[52:53], v38 offset:53248
s_add_u32 s62, s97, 2097536
s_bitset0_b32 s62, 22
s_add_u32 m0, s98, 32768
v_mfma_f32_16x16x32_bf16 v[196:199], a[196:199], v[32:35], v[196:199]
buffer_load_dwordx4 v10, s[84:87], s62 offen offset:0 lds
v_mfma_f32_16x16x32_bf16 v[200:203], a[200:203], v[32:35], v[200:203]
ds_read_b64_tr_b16 v[54:55], v38 offset:53760
v_mfma_f32_16x16x32_bf16 v[200:203], a[216:219], v[28:31], v[200:203]
v_mfma_f32_16x16x32_bf16 v[204:207], a[220:223], v[28:31], v[204:207]
v_mfma_f32_16x16x32_bf16 v[204:207], a[204:207], v[32:35], v[204:207]
s_waitcnt lgkmcnt(4)
v_mfma_f32_16x16x32_bf16 v[208:211], a[192:195], v[20:23], v[208:211]
ds_read_b64_tr_b16 v[28:29], v39 offset:49152
v_mfma_f32_16x16x32_bf16 v[208:211], a[208:211], v[24:27], v[208:211]
ds_read_b64_tr_b16 v[30:31], v39 offset:49664
v_mfma_f32_16x16x32_bf16 v[212:215], a[212:215], v[24:27], v[212:215]
ds_read_b64_tr_b16 v[32:33], v39 offset:53248
v_mfma_f32_16x16x32_bf16 v[212:215], a[196:199], v[20:23], v[212:215]
v_mfma_f32_16x16x32_bf16 v[216:219], a[200:203], v[20:23], v[216:219]
ds_read_b64_tr_b16 v[34:35], v39 offset:53760
v_mfma_f32_16x16x32_bf16 v[216:219], a[216:219], v[24:27], v[216:219]
v_mfma_f32_16x16x32_bf16 v[220:223], a[220:223], v[24:27], v[220:223]
v_mfma_f32_16x16x32_bf16 v[220:223], a[204:207], v[20:23], v[220:223]
s_waitcnt lgkmcnt(4)
v_mfma_f32_16x16x32_bf16 v[224:227], a[192:195], v[48:51], v[224:227]
ds_read_b64_tr_b16 v[24:25], v36 offset:57344
v_cvt_pk_bf16_f32 v176, v176, v177
v_mfma_f32_16x16x32_bf16 v[224:227], a[208:211], v[52:55], v[224:227]
ds_read_b64_tr_b16 v[26:27], v36 offset:57856
v_cvt_pk_bf16_f32 v177, v178, v179
v_mfma_f32_16x16x32_bf16 v[228:231], a[212:215], v[52:55], v[228:231]
ds_read_b64_tr_b16 v[20:21], v36 offset:61440
v_cvt_pk_bf16_f32 v178, v180, v181
v_mfma_f32_16x16x32_bf16 v[228:231], a[196:199], v[48:51], v[228:231]
buffer_load_dwordx4 v11, s[84:87], s62 offen offset:1024 lds
v_cvt_pk_bf16_f32 v179, v182, v183
v_mfma_f32_16x16x32_bf16 v[232:235], a[200:203], v[48:51], v[232:235]
ds_read_b64_tr_b16 v[22:23], v36 offset:61952
s_add_u32 s61, s101, 4096
v_mfma_f32_16x16x32_bf16 v[232:235], a[216:219], v[52:55], v[232:235]
buffer_store_dwordx4 v[176:179], v1, s[12:15], s61 offen offset:3072 sc1
v_mfma_f32_16x16x32_bf16 v[236:239], a[220:223], v[52:55], v[236:239]
v_mfma_f32_16x16x32_bf16 v[236:239], a[204:207], v[48:51], v[236:239]
s_waitcnt lgkmcnt(4)
v_mfma_f32_16x16x32_bf16 v[240:243], a[192:195], v[28:31], v[240:243]
ds_read_b64_tr_b16 v[52:53], v37 offset:57344
v_mfma_f32_16x16x32_bf16 v[240:243], a[208:211], v[32:35], v[240:243]
ds_read_b64_tr_b16 v[54:55], v37 offset:57856
v_mfma_f32_16x16x32_bf16 v[244:247], a[212:215], v[32:35], v[244:247]
ds_read_b64_tr_b16 v[48:49], v37 offset:61440
v_mfma_f32_16x16x32_bf16 v[244:247], a[196:199], v[28:31], v[244:247]
v_mfma_f32_16x16x32_bf16 v[248:251], a[200:203], v[28:31], v[248:251]
ds_read_b64_tr_b16 v[50:51], v37 offset:61952
v_mfma_f32_16x16x32_bf16 v[248:251], a[216:219], v[32:35], v[248:251]
v_mfma_f32_16x16x32_bf16 v[252:255], a[220:223], v[32:35], v[252:255]
v_mfma_f32_16x16x32_bf16 v[252:255], a[204:207], v[28:31], v[252:255]
s_waitcnt lgkmcnt(4)
v_mfma_f32_16x16x32_bf16 v[192:195], a[224:227], v[24:27], v[192:195]
ds_read_b64_tr_b16 v[32:33], v38 offset:57344
v_mfma_f32_16x16x32_bf16 v[192:195], a[240:243], v[20:23], v[192:195]
ds_read_b64_tr_b16 v[34:35], v38 offset:57856
v_mfma_f32_16x16x32_bf16 v[196:199], a[244:247], v[20:23], v[196:199]
ds_read_b64_tr_b16 v[28:29], v38 offset:61440
v_cvt_pk_bf16_f32 v184, v184, v185
v_mfma_f32_16x16x32_bf16 v[196:199], a[228:231], v[24:27], v[196:199]
buffer_load_dwordx4 v12, s[84:87], s62 offen offset:2048 lds
v_cvt_pk_bf16_f32 v185, v186, v187
v_mfma_f32_16x16x32_bf16 v[200:203], a[232:235], v[24:27], v[200:203]
ds_read_b64_tr_b16 v[30:31], v38 offset:61952
v_cvt_pk_bf16_f32 v186, v188, v189
v_mfma_f32_16x16x32_bf16 v[200:203], a[248:251], v[20:23], v[200:203]
v_cvt_pk_bf16_f32 v187, v190, v191
s_add_u32 s61, s101, 12288
v_mfma_f32_16x16x32_bf16 v[204:207], a[252:255], v[20:23], v[204:207]
buffer_store_dwordx4 v[184:187], v1, s[12:15], s61 offen offset:3072 sc1
v_mfma_f32_16x16x32_bf16 v[204:207], a[236:239], v[24:27], v[204:207]
s_waitcnt lgkmcnt(4)
v_mfma_f32_16x16x32_bf16 v[208:211], a[224:227], v[52:55], v[208:211]
ds_read_b64_tr_b16 v[20:21], v39 offset:57344
v_mfma_f32_16x16x32_bf16 v[208:211], a[240:243], v[48:51], v[208:211]
ds_read_b64_tr_b16 v[22:23], v39 offset:57856
v_mfma_f32_16x16x32_bf16 v[212:215], a[244:247], v[48:51], v[212:215]
ds_read_b64_tr_b16 v[24:25], v39 offset:61440
v_mfma_f32_16x16x32_bf16 v[212:215], a[228:231], v[52:55], v[212:215]
v_mfma_f32_16x16x32_bf16 v[216:219], a[232:235], v[52:55], v[216:219]
ds_read_b64_tr_b16 v[26:27], v39 offset:61952
v_mfma_f32_16x16x32_bf16 v[216:219], a[248:251], v[48:51], v[216:219]
v_mfma_f32_16x16x32_bf16 v[220:223], a[252:255], v[48:51], v[220:223]
v_mfma_f32_16x16x32_bf16 v[220:223], a[236:239], v[52:55], v[220:223]
s_waitcnt vmcnt(14) lgkmcnt(4)
s_barrier
v_mfma_f32_16x16x32_bf16 v[224:227], a[224:227], v[32:35], v[224:227]
ds_read_b64_tr_b16 v[48:49], v36 offset:0
v_mfma_f32_16x16x32_bf16 v[224:227], a[240:243], v[28:31], v[224:227]
ds_read_b64_tr_b16 v[50:51], v36 offset:512
v_mfma_f32_16x16x32_bf16 v[228:231], a[244:247], v[28:31], v[228:231]
ds_read_b64_tr_b16 v[52:53], v36 offset:4096
v_mfma_f32_16x16x32_bf16 v[228:231], a[228:231], v[32:35], v[228:231]
buffer_load_dwordx4 v13, s[84:87], s62 offen offset:3072 lds
v_mfma_f32_16x16x32_bf16 v[232:235], a[232:235], v[32:35], v[232:235]
ds_read_b64_tr_b16 v[54:55], v36 offset:4608
v_mfma_f32_16x16x32_bf16 v[232:235], a[248:251], v[28:31], v[232:235]
v_mfma_f32_16x16x32_bf16 v[236:239], a[252:255], v[28:31], v[236:239]
v_mfma_f32_16x16x32_bf16 v[236:239], a[236:239], v[32:35], v[236:239]
s_waitcnt lgkmcnt(4)
v_mfma_f32_16x16x32_bf16 v[240:243], a[224:227], v[20:23], v[240:243]
ds_read_b64_tr_b16 v[28:29], v37 offset:0
v_mfma_f32_16x16x32_bf16 v[240:243], a[240:243], v[24:27], v[240:243]
ds_read_b64_tr_b16 v[30:31], v37 offset:512
v_mfma_f32_16x16x32_bf16 v[244:247], a[244:247], v[24:27], v[244:247]
ds_read_b64_tr_b16 v[32:33], v37 offset:4096
v_mfma_f32_16x16x32_bf16 v[244:247], a[228:231], v[20:23], v[244:247]
v_mfma_f32_16x16x32_bf16 v[248:251], a[232:235], v[20:23], v[248:251]
ds_read_b64_tr_b16 v[34:35], v37 offset:4608
v_mfma_f32_16x16x32_bf16 v[248:251], a[248:251], v[24:27], v[248:251]
v_mfma_f32_16x16x32_bf16 v[252:255], a[252:255], v[24:27], v[252:255]
v_mfma_f32_16x16x32_bf16 v[252:255], a[236:239], v[20:23], v[252:255]
s_waitcnt lgkmcnt(4)
v_mfma_f32_16x16x32_bf16 v[64:67], a[0:3], v[48:51], 0
ds_read_b64_tr_b16 v[24:25], v36 offset:8192
v_mfma_f32_16x16x32_bf16 v[64:67], a[16:19], v[52:55], v[64:67]
ds_read_b64_tr_b16 v[26:27], v36 offset:8704
v_mfma_f32_16x16x32_bf16 v[68:71], a[20:23], v[52:55], 0
ds_read_b64_tr_b16 v[20:21], v36 offset:12288
s_add_u32 s62, s97, 3146112
s_bitset0_b32 s62, 22
s_add_u32 m0, s98, 49152
v_mfma_f32_16x16x32_bf16 v[68:71], a[4:7], v[48:51], v[68:71]
buffer_load_dwordx4 v10, s[84:87], s62 offen offset:0 lds
v_mfma_f32_16x16x32_bf16 v[72:75], a[8:11], v[48:51], 0
ds_read_b64_tr_b16 v[22:23], v36 offset:12800
v_mfma_f32_16x16x32_bf16 v[72:75], a[24:27], v[52:55], v[72:75]
v_mfma_f32_16x16x32_bf16 v[76:79], a[28:31], v[52:55], 0
v_cvt_pk_bf16_f32 v192, v192, v193
v_cvt_pk_bf16_f32 v193, v194, v195
v_mfma_f32_16x16x32_bf16 v[76:79], a[12:15], v[48:51], v[76:79]
v_cvt_pk_bf16_f32 v194, v196, v197
v_cvt_pk_bf16_f32 v195, v198, v199
s_waitcnt lgkmcnt(4)
v_mfma_f32_16x16x32_bf16 v[80:83], a[0:3], v[28:31], 0
ds_read_b64_tr_b16 v[52:53], v37 offset:8192
s_add_u32 s61, s33, 0
v_mfma_f32_16x16x32_bf16 v[80:83], a[16:19], v[32:35], v[80:83]
ds_read_b64_tr_b16 v[54:55], v37 offset:8704
buffer_store_dwordx4 v[192:195], v1, s[12:15], s61 offen offset:0 sc1
v_mfma_f32_16x16x32_bf16 v[84:87], a[20:23], v[32:35], 0
ds_read_b64_tr_b16 v[48:49], v37 offset:12288
v_mfma_f32_16x16x32_bf16 v[84:87], a[4:7], v[28:31], v[84:87]
buffer_load_dwordx4 v11, s[84:87], s62 offen offset:1024 lds
v_mfma_f32_16x16x32_bf16 v[88:91], a[8:11], v[28:31], 0
ds_read_b64_tr_b16 v[50:51], v37 offset:12800
v_mfma_f32_16x16x32_bf16 v[88:91], a[24:27], v[32:35], v[88:91]
v_mfma_f32_16x16x32_bf16 v[92:95], a[28:31], v[32:35], 0
v_mfma_f32_16x16x32_bf16 v[92:95], a[12:15], v[28:31], v[92:95]
s_waitcnt vmcnt(10) lgkmcnt(4)
s_barrier
v_mfma_f32_16x16x32_bf16 v[64:67], a[32:35], v[24:27], v[64:67]
ds_read_b64_tr_b16 v[32:33], v36 offset:16384
v_mfma_f32_16x16x32_bf16 v[64:67], a[48:51], v[20:23], v[64:67]
ds_read_b64_tr_b16 v[34:35], v36 offset:16896
v_mfma_f32_16x16x32_bf16 v[68:71], a[52:55], v[20:23], v[68:71]
ds_read_b64_tr_b16 v[28:29], v36 offset:20480
v_mfma_f32_16x16x32_bf16 v[68:71], a[36:39], v[24:27], v[68:71]
buffer_load_dwordx4 v12, s[84:87], s62 offen offset:2048 lds
v_mfma_f32_16x16x32_bf16 v[72:75], a[40:43], v[24:27], v[72:75]
ds_read_b64_tr_b16 v[30:31], v36 offset:20992
v_mfma_f32_16x16x32_bf16 v[72:75], a[56:59], v[20:23], v[72:75]
v_mfma_f32_16x16x32_bf16 v[76:79], a[60:63], v[20:23], v[76:79]
v_cvt_pk_bf16_f32 v200, v200, v201
v_cvt_pk_bf16_f32 v201, v202, v203
v_mfma_f32_16x16x32_bf16 v[76:79], a[44:47], v[24:27], v[76:79]
v_cvt_pk_bf16_f32 v202, v204, v205
v_cvt_pk_bf16_f32 v203, v206, v207
s_waitcnt lgkmcnt(4)
v_mfma_f32_16x16x32_bf16 v[80:83], a[32:35], v[52:55], v[80:83]
ds_read_b64_tr_b16 v[20:21], v37 offset:16384
s_add_u32 s61, s33, 8192
v_mfma_f32_16x16x32_bf16 v[80:83], a[48:51], v[48:51], v[80:83]
ds_read_b64_tr_b16 v[22:23], v37 offset:16896
buffer_store_dwordx4 v[200:203], v1, s[12:15], s61 offen offset:0 sc1
v_mfma_f32_16x16x32_bf16 v[84:87], a[52:55], v[48:51], v[84:87]
ds_read_b64_tr_b16 v[24:25], v37 offset:20480
v_mfma_f32_16x16x32_bf16 v[84:87], a[36:39], v[52:55], v[84:87]
buffer_load_dwordx4 v13, s[84:87], s62 offen offset:3072 lds
v_mfma_f32_16x16x32_bf16 v[88:91], a[40:43], v[52:55], v[88:91]
ds_read_b64_tr_b16 v[26:27], v37 offset:20992
v_mfma_f32_16x16x32_bf16 v[88:91], a[56:59], v[48:51], v[88:91]
v_mfma_f32_16x16x32_bf16 v[92:95], a[60:63], v[48:51], v[92:95]
v_mfma_f32_16x16x32_bf16 v[92:95], a[44:47], v[52:55], v[92:95]
s_waitcnt lgkmcnt(4)
v_mfma_f32_16x16x32_bf16 v[64:67], a[64:67], v[32:35], v[64:67]
ds_read_b64_tr_b16 v[48:49], v36 offset:24576
v_mfma_f32_16x16x32_bf16 v[64:67], a[80:83], v[28:31], v[64:67]
ds_read_b64_tr_b16 v[50:51], v36 offset:25088
v_mfma_f32_16x16x32_bf16 v[68:71], a[84:87], v[28:31], v[68:71]
ds_read_b64_tr_b16 v[52:53], v36 offset:28672
v_mfma_f32_16x16x32_bf16 v[68:71], a[68:71], v[32:35], v[68:71]
global_load_dword v63, v[60:61], off
v_mfma_f32_16x16x32_bf16 v[72:75], a[72:75], v[32:35], v[72:75]
ds_read_b64_tr_b16 v[54:55], v36 offset:29184
buffer_load_dword v7, v6, s[12:15], s7 offen sc1
v_mfma_f32_16x16x32_bf16 v[72:75], a[88:91], v[28:31], v[72:75]
v_mfma_f32_16x16x32_bf16 v[76:79], a[92:95], v[28:31], v[76:79]
v_cvt_pk_bf16_f32 v208, v208, v209
v_cvt_pk_bf16_f32 v209, v210, v211
v_mfma_f32_16x16x32_bf16 v[76:79], a[76:79], v[32:35], v[76:79]
v_cvt_pk_bf16_f32 v210, v212, v213
v_cvt_pk_bf16_f32 v211, v214, v215
s_waitcnt lgkmcnt(4)
v_mfma_f32_16x16x32_bf16 v[80:83], a[64:67], v[20:23], v[80:83]
ds_read_b64_tr_b16 v[28:29], v37 offset:24576
s_add_u32 s61, s33, 0
v_mfma_f32_16x16x32_bf16 v[80:83], a[80:83], v[24:27], v[80:83]
ds_read_b64_tr_b16 v[30:31], v37 offset:25088
buffer_store_dwordx4 v[208:211], v1, s[12:15], s61 offen offset:1024 sc1
v_mfma_f32_16x16x32_bf16 v[84:87], a[84:87], v[24:27], v[84:87]
ds_read_b64_tr_b16 v[32:33], v37 offset:28672
s_add_u32 s60, s56, 0
v_mfma_f32_16x16x32_bf16 v[84:87], a[68:71], v[20:23], v[84:87]
s_add_u32 m0, s57, 65536
v_mfma_f32_16x16x32_bf16 v[88:91], a[72:75], v[20:23], v[88:91]
ds_read_b64_tr_b16 v[34:35], v37 offset:29184
v_mfma_f32_16x16x32_bf16 v[88:91], a[88:91], v[24:27], v[88:91]
buffer_load_dwordx4 v10, s[8:11], s60 offen offset:0 lds
v_mfma_f32_16x16x32_bf16 v[92:95], a[92:95], v[24:27], v[92:95]
v_mfma_f32_16x16x32_bf16 v[92:95], a[76:79], v[20:23], v[92:95]
s_waitcnt vmcnt(10) lgkmcnt(4)
s_barrier
v_mfma_f32_16x16x32_bf16 v[64:67], a[96:99], v[48:51], v[64:67]
ds_read_b64_tr_b16 v[24:25], v36 offset:32768
v_mfma_f32_16x16x32_bf16 v[64:67], a[112:115], v[52:55], v[64:67]
ds_read_b64_tr_b16 v[26:27], v36 offset:33280
v_mfma_f32_16x16x32_bf16 v[68:71], a[116:119], v[52:55], v[68:71]
ds_read_b64_tr_b16 v[20:21], v36 offset:36864
v_mfma_f32_16x16x32_bf16 v[68:71], a[100:103], v[48:51], v[68:71]
buffer_load_dwordx4 v11, s[8:11], s60 offen offset:1024 lds
v_mfma_f32_16x16x32_bf16 v[72:75], a[104:107], v[48:51], v[72:75]
ds_read_b64_tr_b16 v[22:23], v36 offset:37376
v_mfma_f32_16x16x32_bf16 v[72:75], a[120:123], v[52:55], v[72:75]
buffer_load_dwordx4 v12, s[8:11], s60 offen offset:2048 lds
v_mfma_f32_16x16x32_bf16 v[76:79], a[124:127], v[52:55], v[76:79]
v_cvt_pk_bf16_f32 v216, v216, v217
v_cvt_pk_bf16_f32 v217, v218, v219
v_mfma_f32_16x16x32_bf16 v[76:79], a[108:111], v[48:51], v[76:79]
v_cvt_pk_bf16_f32 v218, v220, v221
v_cvt_pk_bf16_f32 v219, v222, v223
s_waitcnt lgkmcnt(4)
v_mfma_f32_16x16x32_bf16 v[80:83], a[96:99], v[28:31], v[80:83]
ds_read_b64_tr_b16 v[52:53], v37 offset:32768
s_add_u32 s61, s33, 8192
v_mfma_f32_16x16x32_bf16 v[80:83], a[112:115], v[32:35], v[80:83]
ds_read_b64_tr_b16 v[54:55], v37 offset:33280
buffer_store_dwordx4 v[216:219], v1, s[12:15], s61 offen offset:1024 sc1
v_mfma_f32_16x16x32_bf16 v[84:87], a[116:119], v[32:35], v[84:87]
ds_read_b64_tr_b16 v[48:49], v37 offset:36864
v_mfma_f32_16x16x32_bf16 v[84:87], a[100:103], v[28:31], v[84:87]
buffer_load_dwordx4 v13, s[8:11], s60 offen offset:3072 lds
v_mfma_f32_16x16x32_bf16 v[88:91], a[104:107], v[28:31], v[88:91]
ds_read_b64_tr_b16 v[50:51], v37 offset:37376
v_mfma_f32_16x16x32_bf16 v[88:91], a[120:123], v[32:35], v[88:91]
v_mfma_f32_16x16x32_bf16 v[92:95], a[124:127], v[32:35], v[92:95]
s_add_u32 s60, s56, 524288
s_add_u32 m0, s57, 81920
v_mfma_f32_16x16x32_bf16 v[92:95], a[108:111], v[28:31], v[92:95]
s_waitcnt lgkmcnt(4)
v_mfma_f32_16x16x32_bf16 v[64:67], a[128:131], v[24:27], v[64:67]
ds_read_b64_tr_b16 v[32:33], v36 offset:40960
v_mfma_f32_16x16x32_bf16 v[64:67], a[144:147], v[20:23], v[64:67]
ds_read_b64_tr_b16 v[34:35], v36 offset:41472
v_mfma_f32_16x16x32_bf16 v[68:71], a[148:151], v[20:23], v[68:71]
ds_read_b64_tr_b16 v[28:29], v36 offset:45056
v_mfma_f32_16x16x32_bf16 v[68:71], a[132:135], v[24:27], v[68:71]
buffer_load_dwordx4 v10, s[8:11], s60 offen offset:0 lds
v_mfma_f32_16x16x32_bf16 v[72:75], a[136:139], v[24:27], v[72:75]
ds_read_b64_tr_b16 v[30:31], v36 offset:45568
v_mfma_f32_16x16x32_bf16 v[72:75], a[152:155], v[20:23], v[72:75]
buffer_load_dwordx4 v11, s[8:11], s60 offen offset:1024 lds
v_mfma_f32_16x16x32_bf16 v[76:79], a[156:159], v[20:23], v[76:79]
v_cvt_pk_bf16_f32 v224, v224, v225
v_cvt_pk_bf16_f32 v225, v226, v227
v_mfma_f32_16x16x32_bf16 v[76:79], a[140:143], v[24:27], v[76:79]
v_cvt_pk_bf16_f32 v226, v228, v229
v_cvt_pk_bf16_f32 v227, v230, v231
s_waitcnt lgkmcnt(4)
v_mfma_f32_16x16x32_bf16 v[80:83], a[128:131], v[52:55], v[80:83]
ds_read_b64_tr_b16 v[20:21], v37 offset:40960
s_add_u32 s61, s33, 0
v_mfma_f32_16x16x32_bf16 v[80:83], a[144:147], v[48:51], v[80:83]
ds_read_b64_tr_b16 v[22:23], v37 offset:41472
buffer_store_dwordx4 v[224:227], v1, s[12:15], s61 offen offset:2048 sc1
v_mfma_f32_16x16x32_bf16 v[84:87], a[148:151], v[48:51], v[84:87]
ds_read_b64_tr_b16 v[24:25], v37 offset:45056
v_mfma_f32_16x16x32_bf16 v[84:87], a[132:135], v[52:55], v[84:87]
buffer_load_dwordx4 v12, s[8:11], s60 offen offset:2048 lds
v_mfma_f32_16x16x32_bf16 v[88:91], a[136:139], v[52:55], v[88:91]
ds_read_b64_tr_b16 v[26:27], v37 offset:45568
v_mfma_f32_16x16x32_bf16 v[88:91], a[152:155], v[48:51], v[88:91]
buffer_load_dwordx4 v13, s[8:11], s60 offen offset:3072 lds
v_mfma_f32_16x16x32_bf16 v[92:95], a[156:159], v[48:51], v[92:95]
v_mfma_f32_16x16x32_bf16 v[92:95], a[140:143], v[52:55], v[92:95]
s_waitcnt vmcnt(13) lgkmcnt(4)
s_barrier
v_mfma_f32_16x16x32_bf16 v[64:67], a[160:163], v[32:35], v[64:67]
ds_read_b64_tr_b16 v[48:49], v36 offset:49152
v_mfma_f32_16x16x32_bf16 v[64:67], a[176:179], v[28:31], v[64:67]
ds_read_b64_tr_b16 v[50:51], v36 offset:49664
v_mfma_f32_16x16x32_bf16 v[68:71], a[180:183], v[28:31], v[68:71]
ds_read_b64_tr_b16 v[52:53], v36 offset:53248
s_add_u32 s60, s56, 1048576
v_mfma_f32_16x16x32_bf16 v[68:71], a[164:167], v[32:35], v[68:71]
s_add_u32 m0, s57, 98304
v_mfma_f32_16x16x32_bf16 v[72:75], a[168:171], v[32:35], v[72:75]
ds_read_b64_tr_b16 v[54:55], v36 offset:53760
v_mfma_f32_16x16x32_bf16 v[72:75], a[184:187], v[28:31], v[72:75]
buffer_load_dwordx4 v10, s[8:11], s60 offen offset:0 lds
v_mfma_f32_16x16x32_bf16 v[76:79], a[188:191], v[28:31], v[76:79]
v_cvt_pk_bf16_f32 v232, v232, v233
v_cvt_pk_bf16_f32 v233, v234, v235
v_mfma_f32_16x16x32_bf16 v[76:79], a[172:175], v[32:35], v[76:79]
v_cvt_pk_bf16_f32 v234, v236, v237
v_cvt_pk_bf16_f32 v235, v238, v239
s_waitcnt lgkmcnt(4)
v_mfma_f32_16x16x32_bf16 v[80:83], a[160:163], v[20:23], v[80:83]
ds_read_b64_tr_b16 v[28:29], v37 offset:49152
s_add_u32 s61, s33, 8192
v_mfma_f32_16x16x32_bf16 v[80:83], a[176:179], v[24:27], v[80:83]
ds_read_b64_tr_b16 v[30:31], v37 offset:49664
buffer_store_dwordx4 v[232:235], v1, s[12:15], s61 offen offset:2048 sc1
v_mfma_f32_16x16x32_bf16 v[84:87], a[180:183], v[24:27], v[84:87]
ds_read_b64_tr_b16 v[32:33], v37 offset:53248
v_mfma_f32_16x16x32_bf16 v[84:87], a[164:167], v[20:23], v[84:87]
buffer_load_dwordx4 v11, s[8:11], s60 offen offset:1024 lds
v_mfma_f32_16x16x32_bf16 v[88:91], a[168:171], v[20:23], v[88:91]
ds_read_b64_tr_b16 v[34:35], v37 offset:53760
v_mov_b32 v56, 0
v_mfma_f32_16x16x32_bf16 v[88:91], a[184:187], v[24:27], v[88:91]
buffer_load_dwordx4 v12, s[8:11], s60 offen offset:2048 lds
v_mfma_f32_16x16x32_bf16 v[92:95], a[188:191], v[24:27], v[92:95]
v_mov_b32 v57, 0
v_mov_b32 v58, 0
v_mfma_f32_16x16x32_bf16 v[92:95], a[172:175], v[20:23], v[92:95]
v_mov_b32 v59, 0
s_waitcnt lgkmcnt(4)
v_mfma_f32_16x16x32_bf16 v[64:67], a[192:195], v[48:51], v[64:67]
ds_read_b64_tr_b16 v[24:25], v36 offset:57344
v_mov_b32 v62, 0
v_mfma_f32_16x16x32_bf16 v[64:67], a[208:211], v[52:55], v[64:67]
ds_read_b64_tr_b16 v[26:27], v36 offset:57856
v_mfma_f32_16x16x32_bf16 v[68:71], a[212:215], v[52:55], v[68:71]
ds_read_b64_tr_b16 v[20:21], v36 offset:61440
v_mfma_f32_16x16x32_bf16 v[68:71], a[196:199], v[48:51], v[68:71]
buffer_load_dwordx4 v13, s[8:11], s60 offen offset:3072 lds
v_mfma_f32_16x16x32_bf16 v[72:75], a[200:203], v[48:51], v[72:75]
ds_read_b64_tr_b16 v[22:23], v36 offset:61952
v_mfma_f32_16x16x32_bf16 v[72:75], a[216:219], v[52:55], v[72:75]
v_mfma_f32_16x16x32_bf16 v[76:79], a[220:223], v[52:55], v[76:79]
s_add_u32 s60, s56, 1572864
v_cvt_pk_bf16_f32 v240, v240, v241
v_cvt_pk_bf16_f32 v241, v242, v243
v_mfma_f32_16x16x32_bf16 v[76:79], a[204:207], v[48:51], v[76:79]
s_add_u32 m0, s57, 114688
v_cvt_pk_bf16_f32 v242, v244, v245
v_cvt_pk_bf16_f32 v243, v246, v247
s_waitcnt lgkmcnt(4)
v_mfma_f32_16x16x32_bf16 v[80:83], a[192:195], v[28:31], v[80:83]
ds_read_b64_tr_b16 v[52:53], v37 offset:57344
s_add_u32 s61, s33, 0
v_mfma_f32_16x16x32_bf16 v[80:83], a[208:211], v[32:35], v[80:83]
ds_read_b64_tr_b16 v[54:55], v37 offset:57856
buffer_store_dwordx4 v[240:243], v1, s[12:15], s61 offen offset:3072 sc1
v_mfma_f32_16x16x32_bf16 v[84:87], a[212:215], v[32:35], v[84:87]
ds_read_b64_tr_b16 v[48:49], v37 offset:61440
v_mfma_f32_16x16x32_bf16 v[84:87], a[196:199], v[28:31], v[84:87]
buffer_load_dwordx4 v10, s[8:11], s60 offen offset:0 lds
v_mfma_f32_16x16x32_bf16 v[88:91], a[200:203], v[28:31], v[88:91]
ds_read_b64_tr_b16 v[50:51], v37 offset:61952
v_mfma_f32_16x16x32_bf16 v[88:91], a[216:219], v[32:35], v[88:91]
buffer_load_dwordx4 v11, s[8:11], s60 offen offset:1024 lds
v_mfma_f32_16x16x32_bf16 v[92:95], a[220:223], v[32:35], v[92:95]
v_mfma_f32_16x16x32_bf16 v[92:95], a[204:207], v[28:31], v[92:95]
s_waitcnt lgkmcnt(4)
v_mfma_f32_16x16x32_bf16 v[64:67], a[224:227], v[24:27], v[64:67]
ds_read_b64_tr_b16 v[32:33], v38 offset:0
s_waitcnt vmcnt(19)
v_mfma_f32_16x16x32_bf16 v[64:67], a[240:243], v[20:23], v[64:67]
ds_read_b64_tr_b16 v[34:35], v38 offset:512
v_cmp_ne_u32 vcc, s82, v7
v_mfma_f32_16x16x32_bf16 v[68:71], a[244:247], v[20:23], v[68:71]
ds_read_b64_tr_b16 v[28:29], v38 offset:4096
v_mfma_f32_16x16x32_bf16 v[68:71], a[228:231], v[24:27], v[68:71]
s_nop 1
s_cbranch_vccnz L_xsp1
L_xsr1:
v_mfma_f32_16x16x32_bf16 v[72:75], a[232:235], v[24:27], v[72:75]
ds_read_b64_tr_b16 v[30:31], v38 offset:4608
v_mfma_f32_16x16x32_bf16 v[72:75], a[248:251], v[20:23], v[72:75]
buffer_load_dwordx4 v12, s[8:11], s60 offen offset:2048 lds
v_mfma_f32_16x16x32_bf16 v[76:79], a[252:255], v[20:23], v[76:79]
v_cvt_pk_bf16_f32 v248, v248, v249
v_cvt_pk_bf16_f32 v249, v250, v251
v_mfma_f32_16x16x32_bf16 v[76:79], a[236:239], v[24:27], v[76:79]
v_cvt_pk_bf16_f32 v250, v252, v253
v_cvt_pk_bf16_f32 v251, v254, v255
s_waitcnt lgkmcnt(4)
v_mfma_f32_16x16x32_bf16 v[80:83], a[224:227], v[52:55], v[80:83]
ds_read_b64_tr_b16 v[20:21], v39 offset:0
s_add_u32 s61, s33, 8192
v_mfma_f32_16x16x32_bf16 v[80:83], a[240:243], v[48:51], v[80:83]
ds_read_b64_tr_b16 v[22:23], v39 offset:512
buffer_store_dwordx4 v[248:251], v1, s[12:15], s61 offen offset:3072 sc1
v_mfma_f32_16x16x32_bf16 v[84:87], a[244:247], v[48:51], v[84:87]
ds_read_b64_tr_b16 v[24:25], v39 offset:4096
v_mfma_f32_16x16x32_bf16 v[84:87], a[228:231], v[52:55], v[84:87]
buffer_load_dwordx4 v13, s[8:11], s60 offen offset:3072 lds
v_mfma_f32_16x16x32_bf16 v[88:91], a[232:235], v[52:55], v[88:91]
ds_read_b64_tr_b16 v[26:27], v39 offset:4608
s_add_u32 s44, s30, 0
v_mfma_f32_16x16x32_bf16 v[88:91], a[248:251], v[48:51], v[88:91]
s_add_u32 s45, s30, 18432
s_add_u32 s46, s30, 36864
s_add_u32 s47, s30, 55296
v_mfma_f32_16x16x32_bf16 v[92:95], a[252:255], v[48:51], v[92:95]
v_mfma_f32_16x16x32_bf16 v[92:95], a[236:239], v[52:55], v[92:95]
s_waitcnt lgkmcnt(4)
v_mfma_f32_16x16x32_bf16 v[96:99], a[0:3], v[32:35], 0
ds_read_b64_tr_b16 v[48:49], v38 offset:8192
v_mfma_f32_16x16x32_bf16 v[96:99], a[16:19], v[28:31], v[96:99]
ds_read_b64_tr_b16 v[50:51], v38 offset:8704
v_mfma_f32_16x16x32_bf16 v[100:103], a[20:23], v[28:31], 0
ds_read_b64_tr_b16 v[52:53], v38 offset:12288
v_mfma_f32_16x16x32_bf16 v[100:103], a[4:7], v[32:35], v[100:103]
v_mfma_f32_16x16x32_bf16 v[104:107], a[8:11], v[32:35], 0
ds_read_b64_tr_b16 v[54:55], v38 offset:12800
v_mfma_f32_16x16x32_bf16 v[104:107], a[24:27], v[28:31], v[104:107]
v_mfma_f32_16x16x32_bf16 v[108:111], a[28:31], v[28:31], 0
v_cvt_pk_bf16_f32 v64, v64, v65
v_cvt_pk_bf16_f32 v65, v66, v67
v_mfma_f32_16x16x32_bf16 v[108:111], a[12:15], v[32:35], v[108:111]
v_cvt_pk_bf16_f32 v66, v68, v69
v_cvt_pk_bf16_f32 v67, v70, v71
s_waitcnt lgkmcnt(4)
v_mfma_f32_16x16x32_bf16 v[112:115], a[0:3], v[20:23], 0
ds_read_b64_tr_b16 v[28:29], v39 offset:8192
s_add_u32 s61, s33, 4096
v_mfma_f32_16x16x32_bf16 v[112:115], a[16:19], v[24:27], v[112:115]
ds_read_b64_tr_b16 v[30:31], v39 offset:8704
buffer_store_dwordx4 v[64:67], v1, s[12:15], s61 offen offset:0 sc1
v_mfma_f32_16x16x32_bf16 v[116:119], a[20:23], v[24:27], 0
ds_read_b64_tr_b16 v[32:33], v39 offset:12288
v_mfma_f32_16x16x32_bf16 v[116:119], a[4:7], v[20:23], v[116:119]
v_mfma_f32_16x16x32_bf16 v[120:123], a[8:11], v[20:23], 0
ds_read_b64_tr_b16 v[34:35], v39 offset:12800
v_mfma_f32_16x16x32_bf16 v[120:123], a[24:27], v[24:27], v[120:123]
v_mfma_f32_16x16x32_bf16 v[124:127], a[28:31], v[24:27], 0
v_mfma_f32_16x16x32_bf16 v[124:127], a[12:15], v[20:23], v[124:127]
s_waitcnt lgkmcnt(4)
v_mfma_f32_16x16x32_bf16 v[96:99], a[32:35], v[48:51], v[96:99]
ds_read_b64_tr_b16 v[24:25], v38 offset:16384
v_mfma_f32_16x16x32_bf16 v[96:99], a[48:51], v[52:55], v[96:99]
ds_read_b64_tr_b16 v[26:27], v38 offset:16896
v_mfma_f32_16x16x32_bf16 v[100:103], a[52:55], v[52:55], v[100:103]
ds_read_b64_tr_b16 v[20:21], v38 offset:20480
v_mfma_f32_16x16x32_bf16 v[100:103], a[36:39], v[48:51], v[100:103]
buffer_load_dwordx4 a[0:3], v1, s[12:15], s44 offen offset:0 sc1
v_mfma_f32_16x16x32_bf16 v[104:107], a[40:43], v[48:51], v[104:107]
ds_read_b64_tr_b16 v[22:23], v38 offset:20992
v_mfma_f32_16x16x32_bf16 v[104:107], a[56:59], v[52:55], v[104:107]
v_mfma_f32_16x16x32_bf16 v[108:111], a[60:63], v[52:55], v[108:111]
buffer_load_dwordx4 a[4:7], v1, s[12:15], s45 offen offset:0 sc1
v_mfma_f32_16x16x32_bf16 v[108:111], a[44:47], v[48:51], v[108:111]
s_waitcnt lgkmcnt(4)
v_mfma_f32_16x16x32_bf16 v[112:115], a[32:35], v[28:31], v[112:115]
ds_read_b64_tr_b16 v[52:53], v39 offset:16384
v_mfma_f32_16x16x32_bf16 v[112:115], a[48:51], v[32:35], v[112:115]
ds_read_b64_tr_b16 v[54:55], v39 offset:16896
v_mfma_f32_16x16x32_bf16 v[116:119], a[52:55], v[32:35], v[116:119]
ds_read_b64_tr_b16 v[48:49], v39 offset:20480
v_cvt_pk_bf16_f32 v72, v72, v73
v_mfma_f32_16x16x32_bf16 v[116:119], a[36:39], v[28:31], v[116:119]
v_cvt_pk_bf16_f32 v73, v74, v75
v_cvt_pk_bf16_f32 v74, v76, v77
v_mfma_f32_16x16x32_bf16 v[120:123], a[40:43], v[28:31], v[120:123]
ds_read_b64_tr_b16 v[50:51], v39 offset:20992
v_cvt_pk_bf16_f32 v75, v78, v79
v_mfma_f32_16x16x32_bf16 v[120:123], a[56:59], v[32:35], v[120:123]
s_add_u32 s61, s33, 12288
buffer_store_dwordx4 v[72:75], v1, s[12:15], s61 offen offset:0 sc1
v_mfma_f32_16x16x32_bf16 v[124:127], a[60:63], v[32:35], v[124:127]
buffer_load_dwordx4 a[8:11], v1, s[12:15], s46 offen offset:0 sc1
v_mfma_f32_16x16x32_bf16 v[124:127], a[44:47], v[28:31], v[124:127]
s_waitcnt lgkmcnt(4)
v_mfma_f32_16x16x32_bf16 v[96:99], a[64:67], v[24:27], v[96:99]
ds_read_b64_tr_b16 v[32:33], v38 offset:24576
v_mfma_f32_16x16x32_bf16 v[96:99], a[80:83], v[20:23], v[96:99]
ds_read_b64_tr_b16 v[34:35], v38 offset:25088
v_mfma_f32_16x16x32_bf16 v[100:103], a[84:87], v[20:23], v[100:103]
ds_read_b64_tr_b16 v[28:29], v38 offset:28672
v_mfma_f32_16x16x32_bf16 v[100:103], a[68:71], v[24:27], v[100:103]
buffer_load_dwordx4 a[12:15], v1, s[12:15], s47 offen offset:0 sc1
v_mfma_f32_16x16x32_bf16 v[104:107], a[72:75], v[24:27], v[104:107]
ds_read_b64_tr_b16 v[30:31], v38 offset:29184
v_mfma_f32_16x16x32_bf16 v[104:107], a[88:91], v[20:23], v[104:107]
buffer_load_dwordx4 a[16:19], v1, s[12:15], s44 offen offset:1024 sc1
v_mfma_f32_16x16x32_bf16 v[108:111], a[92:95], v[20:23], v[108:111]
v_mfma_f32_16x16x32_bf16 v[108:111], a[76:79], v[24:27], v[108:111]
s_waitcnt lgkmcnt(4)
v_mfma_f32_16x16x32_bf16 v[112:115], a[64:67], v[52:55], v[112:115]
ds_read_b64_tr_b16 v[20:21], v39 offset:24576
v_mfma_f32_16x16x32_bf16 v[112:115], a[80:83], v[48:51], v[112:115]
ds_read_b64_tr_b16 v[22:23], v39 offset:25088
v_mfma_f32_16x16x32_bf16 v[116:119], a[84:87], v[48:51], v[116:119]
ds_read_b64_tr_b16 v[24:25], v39 offset:28672
v_mfma_f32_16x16x32_bf16 v[116:119], a[68:71], v[52:55], v[116:119]
buffer_load_dwordx4 a[20:23], v1, s[12:15], s45 offen offset:1024 sc1
v_mfma_f32_16x16x32_bf16 v[120:123], a[72:75], v[52:55], v[120:123]
ds_read_b64_tr_b16 v[26:27], v39 offset:29184
v_mfma_f32_16x16x32_bf16 v[120:123], a[88:91], v[48:51], v[120:123]
v_mfma_f32_16x16x32_bf16 v[124:127], a[92:95], v[48:51], v[124:127]
v_cvt_pk_bf16_f32 v80, v80, v81
v_cvt_pk_bf16_f32 v81, v82, v83
v_mfma_f32_16x16x32_bf16 v[124:127], a[76:79], v[52:55], v[124:127]
v_cvt_pk_bf16_f32 v82, v84, v85
v_cvt_pk_bf16_f32 v83, v86, v87
s_waitcnt lgkmcnt(4)
v_mfma_f32_16x16x32_bf16 v[96:99], a[96:99], v[32:35], v[96:99]
ds_read_b64_tr_b16 v[48:49], v38 offset:32768
s_add_u32 s61, s33, 4096
v_mfma_f32_16x16x32_bf16 v[96:99], a[112:115], v[28:31], v[96:99]
ds_read_b64_tr_b16 v[50:51], v38 offset:33280
buffer_store_dwordx4 v[80:83], v1, s[12:15], s61 offen offset:1024 sc1
v_mfma_f32_16x16x32_bf16 v[100:103], a[116:119], v[28:31], v[100:103]
ds_read_b64_tr_b16 v[52:53], v38 offset:36864
buffer_load_dwordx4 a[24:27], v1, s[12:15], s46 offen offset:1024 sc1
v_mfma_f32_16x16x32_bf16 v[100:103], a[100:103], v[32:35], v[100:103]
v_mfma_f32_16x16x32_bf16 v[104:107], a[104:107], v[32:35], v[104:107]
ds_read_b64_tr_b16 v[54:55], v38 offset:37376
v_mfma_f32_16x16x32_bf16 v[104:107], a[120:123], v[28:31], v[104:107]
buffer_load_dwordx4 a[28:31], v1, s[12:15], s47 offen offset:1024 sc1
v_mfma_f32_16x16x32_bf16 v[108:111], a[124:127], v[28:31], v[108:111]
v_mfma_f32_16x16x32_bf16 v[108:111], a[108:111], v[32:35], v[108:111]
s_waitcnt lgkmcnt(4)
v_mfma_f32_16x16x32_bf16 v[112:115], a[96:99], v[20:23], v[112:115]
ds_read_b64_tr_b16 v[28:29], v39 offset:32768
v_mfma_f32_16x16x32_bf16 v[112:115], a[112:115], v[24:27], v[112:115]
ds_read_b64_tr_b16 v[30:31], v39 offset:33280
v_mfma_f32_16x16x32_bf16 v[116:119], a[116:119], v[24:27], v[116:119]
ds_read_b64_tr_b16 v[32:33], v39 offset:36864
v_mfma_f32_16x16x32_bf16 v[116:119], a[100:103], v[20:23], v[116:119]
buffer_load_dwordx4 a[32:35], v1, s[12:15], s44 offen offset:2048 sc1
v_mfma_f32_16x16x32_bf16 v[120:123], a[104:107], v[20:23], v[120:123]
ds_read_b64_tr_b16 v[34:35], v39 offset:37376
v_mfma_f32_16x16x32_bf16 v[120:123], a[120:123], v[24:27], v[120:123]
v_mfma_f32_16x16x32_bf16 v[124:127], a[124:127], v[24:27], v[124:127]
buffer_load_dwordx4 a[36:39], v1, s[12:15], s45 offen offset:2048 sc1
v_mfma_f32_16x16x32_bf16 v[124:127], a[108:111], v[20:23], v[124:127]
s_waitcnt lgkmcnt(4)
v_mfma_f32_16x16x32_bf16 v[96:99], a[128:131], v[48:51], v[96:99]
ds_read_b64_tr_b16 v[24:25], v38 offset:40960
v_mfma_f32_16x16x32_bf16 v[96:99], a[144:147], v[52:55], v[96:99]
ds_read_b64_tr_b16 v[26:27], v38 offset:41472
v_mfma_f32_16x16x32_bf16 v[100:103], a[148:151], v[52:55], v[100:103]
ds_read_b64_tr_b16 v[20:21], v38 offset:45056
v_cvt_pk_bf16_f32 v88, v88, v89
v_mfma_f32_16x16x32_bf16 v[100:103], a[132:135], v[48:51], v[100:103]
v_cvt_pk_bf16_f32 v89, v90, v91
v_cvt_pk_bf16_f32 v90, v92, v93
v_mfma_f32_16x16x32_bf16 v[104:107], a[136:139], v[48:51], v[104:107]
ds_read_b64_tr_b16 v[22:23], v38 offset:45568
v_cvt_pk_bf16_f32 v91, v94, v95
v_mfma_f32_16x16x32_bf16 v[104:107], a[152:155], v[52:55], v[104:107]
s_add_u32 s61, s33, 12288
buffer_store_dwordx4 v[88:91], v1, s[12:15], s61 offen offset:1024 sc1
v_mfma_f32_16x16x32_bf16 v[108:111], a[156:159], v[52:55], v[108:111]
buffer_load_dwordx4 a[40:43], v1, s[12:15], s46 offen offset:2048 sc1
v_mfma_f32_16x16x32_bf16 v[108:111], a[140:143], v[48:51], v[108:111]
s_waitcnt lgkmcnt(4)
v_mfma_f32_16x16x32_bf16 v[112:115], a[128:131], v[28:31], v[112:115]
ds_read_b64_tr_b16 v[52:53], v39 offset:40960
v_mfma_f32_16x16x32_bf16 v[112:115], a[144:147], v[32:35], v[112:115]
ds_read_b64_tr_b16 v[54:55], v39 offset:41472
v_mfma_f32_16x16x32_bf16 v[116:119], a[148:151], v[32:35], v[116:119]
ds_read_b64_tr_b16 v[48:49], v39 offset:45056
v_mfma_f32_16x16x32_bf16 v[116:119], a[132:135], v[28:31], v[116:119]
buffer_load_dwordx4 a[44:47], v1, s[12:15], s47 offen offset:2048 sc1
v_mfma_f32_16x16x32_bf16 v[120:123], a[136:139], v[28:31], v[120:123]
ds_read_b64_tr_b16 v[50:51], v39 offset:45568
v_mfma_f32_16x16x32_bf16 v[120:123], a[152:155], v[32:35], v[120:123]
buffer_load_dwordx4 a[48:51], v1, s[12:15], s44 offen offset:3072 sc1
v_mfma_f32_16x16x32_bf16 v[124:127], a[156:159], v[32:35], v[124:127]
v_mfma_f32_16x16x32_bf16 v[124:127], a[140:143], v[28:31], v[124:127]
s_waitcnt lgkmcnt(4)
v_mfma_f32_16x16x32_bf16 v[96:99], a[160:163], v[24:27], v[96:99]
ds_read_b64_tr_b16 v[32:33], v38 offset:49152
v_mfma_f32_16x16x32_bf16 v[96:99], a[176:179], v[20:23], v[96:99]
ds_read_b64_tr_b16 v[34:35], v38 offset:49664
v_mfma_f32_16x16x32_bf16 v[100:103], a[180:183], v[20:23], v[100:103]
ds_read_b64_tr_b16 v[28:29], v38 offset:53248
v_mfma_f32_16x16x32_bf16 v[100:103], a[164:167], v[24:27], v[100:103]
buffer_load_dwordx4 a[52:55], v1, s[12:15], s45 offen offset:3072 sc1
v_mfma_f32_16x16x32_bf16 v[104:107], a[168:171], v[24:27], v[104:107]
ds_read_b64_tr_b16 v[30:31], v38 offset:53760
v_mfma_f32_16x16x32_bf16 v[104:107], a[184:187], v[20:23], v[104:107]
v_mfma_f32_16x16x32_bf16 v[108:111], a[188:191], v[20:23], v[108:111]
v_mfma_f32_16x16x32_bf16 v[108:111], a[172:175], v[24:27], v[108:111]
s_waitcnt lgkmcnt(4)
v_mfma_f32_16x16x32_bf16 v[112:115], a[160:163], v[52:55], v[112:115]
ds_read_b64_tr_b16 v[20:21], v39 offset:49152
v_mfma_f32_16x16x32_bf16 v[112:115], a[176:179], v[48:51], v[112:115]
ds_read_b64_tr_b16 v[22:23], v39 offset:49664
v_mfma_f32_16x16x32_bf16 v[116:119], a[180:183], v[48:51], v[116:119]
ds_read_b64_tr_b16 v[24:25], v39 offset:53248
buffer_load_dwordx4 a[56:59], v1, s[12:15], s46 offen offset:3072 sc1
v_mfma_f32_16x16x32_bf16 v[116:119], a[164:167], v[52:55], v[116:119]
v_mfma_f32_16x16x32_bf16 v[120:123], a[168:171], v[52:55], v[120:123]
ds_read_b64_tr_b16 v[26:27], v39 offset:53760
v_mfma_f32_16x16x32_bf16 v[120:123], a[184:187], v[48:51], v[120:123]
buffer_load_dwordx4 a[60:63], v1, s[12:15], s47 offen offset:3072 sc1
v_mfma_f32_16x16x32_bf16 v[124:127], a[188:191], v[48:51], v[124:127]
s_add_u32 s44, s30, 4096
s_add_u32 s45, s30, 22528
s_add_u32 s46, s30, 40960
v_mfma_f32_16x16x32_bf16 v[124:127], a[172:175], v[52:55], v[124:127]
s_add_u32 s47, s30, 59392
s_waitcnt lgkmcnt(4)
v_mfma_f32_16x16x32_bf16 v[96:99], a[192:195], v[32:35], v[96:99]
ds_read_b64_tr_b16 v[48:49], v38 offset:57344
v_mfma_f32_16x16x32_bf16 v[96:99], a[208:211], v[28:31], v[96:99]
ds_read_b64_tr_b16 v[50:51], v38 offset:57856
v_mfma_f32_16x16x32_bf16 v[100:103], a[212:215], v[28:31], v[100:103]
ds_read_b64_tr_b16 v[52:53], v38 offset:61440
v_mfma_f32_16x16x32_bf16 v[100:103], a[196:199], v[32:35], v[100:103]
buffer_load_dwordx4 a[64:67], v1, s[12:15], s44 offen offset:0 sc1
v_mfma_f32_16x16x32_bf16 v[104:107], a[200:203], v[32:35], v[104:107]
ds_read_b64_tr_b16 v[54:55], v38 offset:61952
v_mfma_f32_16x16x32_bf16 v[104:107], a[216:219], v[28:31], v[104:107]
v_mfma_f32_16x16x32_bf16 v[108:111], a[220:223], v[28:31], v[108:111]
ds_read_b64_tr_b16 v[28:29], v39 offset:57344
v_mfma_f32_16x16x32_bf16 v[108:111], a[204:207], v[32:35], v[108:111]
s_waitcnt lgkmcnt(5)
v_mfma_f32_16x16x32_bf16 v[112:115], a[192:195], v[20:23], v[112:115]
ds_read_b64_tr_b16 v[30:31], v39 offset:57856
v_mfma_f32_16x16x32_bf16 v[112:115], a[208:211], v[24:27], v[112:115]
ds_read_b64_tr_b16 v[32:33], v39 offset:61440
buffer_load_dwordx4 a[68:71], v1, s[12:15], s45 offen offset:0 sc1
v_mfma_f32_16x16x32_bf16 v[116:119], a[212:215], v[24:27], v[116:119]
ds_read_b64_tr_b16 v[34:35], v39 offset:61952
v_mfma_f32_16x16x32_bf16 v[116:119], a[196:199], v[20:23], v[116:119]
s_waitcnt vmcnt(38)
s_barrier
v_mfma_f32_16x16x32_bf16 v[120:123], a[200:203], v[20:23], v[120:123]
buffer_load_dwordx4 a[72:75], v1, s[12:15], s46 offen offset:0 sc1
v_mfma_f32_16x16x32_bf16 v[120:123], a[216:219], v[24:27], v[120:123]
v_mfma_f32_16x16x32_bf16 v[124:127], a[220:223], v[24:27], v[124:127]
ds_read_b64_tr_b16 v[64:65], v40 offset:0
ds_read_b64_tr_b16 v[66:67], v40 offset:512
v_mfma_f32_16x16x32_bf16 v[124:127], a[204:207], v[20:23], v[124:127]
ds_read_b64_tr_b16 v[68:69], v40 offset:4096
s_waitcnt lgkmcnt(7)
v_mfma_f32_16x16x32_bf16 v[96:99], a[224:227], v[48:51], v[96:99]
buffer_load_dwordx4 a[76:79], v1, s[12:15], s47 offen offset:0 sc1
v_mfma_f32_16x16x32_bf16 v[96:99], a[240:243], v[52:55], v[96:99]
ds_read_b64_tr_b16 v[70:71], v40 offset:4608
s_waitcnt lgkmcnt(4)
v_mfma_f32_16x16x32_bf16 v[112:115], a[224:227], v[28:31], v[112:115]
ds_read_b64_tr_b16 v[72:73], v41 offset:0
ds_read_b64_tr_b16 v[74:75], v41 offset:512
v_mfma_f32_16x16x32_bf16 v[112:115], a[240:243], v[32:35], v[112:115]
ds_read_b64_tr_b16 v[76:77], v41 offset:4096
ds_read_b64_tr_b16 v[78:79], v41 offset:4608
v_mfma_f32_16x16x32_bf16 v[100:103], a[244:247], v[52:55], v[100:103]
v_mfma_f32_16x16x32_bf16 v[100:103], a[228:231], v[48:51], v[100:103]
v_mfma_f32_16x16x32_bf16 v[116:119], a[244:247], v[32:35], v[116:119]
v_mfma_f32_16x16x32_bf16 v[116:119], a[228:231], v[28:31], v[116:119]
v_mfma_f32_16x16x32_bf16 v[104:107], a[232:235], v[48:51], v[104:107]
v_cvt_pk_bf16_f32 v96, v96, v97
v_cvt_pk_bf16_f32 v97, v98, v99
v_mfma_f32_16x16x32_bf16 v[104:107], a[248:251], v[52:55], v[104:107]
s_nop 1
v_cvt_pk_bf16_f32 v98, v100, v101
v_cvt_pk_bf16_f32 v99, v102, v103
v_mfma_f32_16x16x32_bf16 v[120:123], a[232:235], v[28:31], v[120:123]
s_add_u32 s61, s33, 4096
v_mfma_f32_16x16x32_bf16 v[120:123], a[248:251], v[32:35], v[120:123]
v_mfma_f32_16x16x32_bf16 v[108:111], a[252:255], v[52:55], v[108:111]
v_mfma_f32_16x16x32_bf16 v[108:111], a[236:239], v[48:51], v[108:111]
v_mfma_f32_16x16x32_bf16 v[124:127], a[252:255], v[32:35], v[124:127]
v_mfma_f32_16x16x32_bf16 v[124:127], a[236:239], v[28:31], v[124:127]
s_waitcnt vmcnt(13) lgkmcnt(4)
v_mfma_f32_16x16x32_bf16 v[128:131], v[64:67], a[0:3], 0
ds_read_b64_tr_b16 v[80:81], v42 offset:0
v_mfma_f32_16x16x32_bf16 v[128:131], v[68:71], a[16:19], v[128:131]
ds_read_b64_tr_b16 v[82:83], v42 offset:512
v_mfma_f32_16x16x32_bf16 v[160:163], v[68:71], a[20:23], 0
ds_read_b64_tr_b16 v[84:85], v42 offset:4096
v_mfma_f32_16x16x32_bf16 v[160:163], v[64:67], a[4:7], v[160:163]
buffer_store_dwordx4 v[96:99], v1, s[12:15], s61 offen offset:2048 sc1
v_mfma_f32_16x16x32_bf16 v[192:195], v[64:67], a[8:11], 0
ds_read_b64_tr_b16 v[86:87], v42 offset:4608
v_cvt_pk_bf16_f32 v112, v112, v113
v_mfma_f32_16x16x32_bf16 v[192:195], v[68:71], a[24:27], v[192:195]
v_cvt_pk_bf16_f32 v113, v114, v115
v_cvt_pk_bf16_f32 v114, v116, v117
v_mfma_f32_16x16x32_bf16 v[224:227], v[68:71], a[28:31], 0
v_cvt_pk_bf16_f32 v115, v118, v119
s_add_u32 s61, s33, 4096
v_mfma_f32_16x16x32_bf16 v[224:227], v[64:67], a[12:15], v[224:227]
s_waitcnt lgkmcnt(4)
v_mfma_f32_16x16x32_bf16 v[132:135], v[72:75], a[0:3], 0
ds_read_b64_tr_b16 v[64:65], v43 offset:0
buffer_store_dwordx4 v[112:115], v1, s[12:15], s61 offen offset:3072 sc1
v_mfma_f32_16x16x32_bf16 v[132:135], v[76:79], a[16:19], v[132:135]
ds_read_b64_tr_b16 v[66:67], v43 offset:512
v_cvt_pk_bf16_f32 v104, v104, v105
v_cvt_pk_bf16_f32 v105, v106, v107
v_cvt_pk_bf16_f32 v106, v108, v109
v_mfma_f32_16x16x32_bf16 v[164:167], v[76:79], a[20:23], 0
ds_read_b64_tr_b16 v[68:69], v43 offset:4096
v_cvt_pk_bf16_f32 v107, v110, v111
s_add_u32 s61, s33, 12288
buffer_store_dwordx4 v[104:107], v1, s[12:15], s61 offen offset:2048 sc1
v_mfma_f32_16x16x32_bf16 v[164:167], v[72:75], a[4:7], v[164:167]
v_cvt_pk_bf16_f32 v120, v120, v121
v_cvt_pk_bf16_f32 v121, v122, v123
v_cvt_pk_bf16_f32 v122, v124, v125
v_cvt_pk_bf16_f32 v123, v126, v127
v_mfma_f32_16x16x32_bf16 v[196:199], v[72:75], a[8:11], 0
ds_read_b64_tr_b16 v[70:71], v43 offset:4608
s_add_u32 s61, s33, 12288
buffer_store_dwordx4 v[120:123], v1, s[12:15], s61 offen offset:3072 sc1
v_mfma_f32_16x16x32_bf16 v[196:199], v[76:79], a[24:27], v[196:199]
v_mov_b32 v48, 0
v_mov_b32 v49, 0
v_mov_b32 v50, 0
v_mov_b32 v51, 0
v_mfma_f32_16x16x32_bf16 v[228:231], v[76:79], a[28:31], 0
v_mov_b32 v52, 0
v_mov_b32 v53, 0
v_mov_b32 v54, 0
v_mfma_f32_16x16x32_bf16 v[228:231], v[72:75], a[12:15], v[228:231]
s_waitcnt lgkmcnt(4)
v_mov_b32 v55, 0
v_mov_b32 v60, 0
v_mov_b32 v61, 0
v_mov_b32 v63, 0
s_branch L_qj
.p2align 8
sequential_preLN__compressed_kv_cla__dense_activation_relu__prompt_kernel:
s_cmp_ge_u32 s2, 256
s_cbranch_scc1 L_end
s_load_dwordx16 s[16:31], s[0:1], 0
s_load_dwordx2 s[12:13], s[0:1], 88
s_load_dwordx2 s[6:7], s[0:1], 64
s_getpc_b64 s[4:5]
L_pc0:
s_sub_u32 s4, s4, L_pc0-L_text0
s_subb_u32 s5, s5, 0
s_lshl_b32 s60, s2, 11
s_and_b32 s60, s60, 0xc000
v_lshlrev_b32 v56, 6, v0
v_add_u32 v56, s60, v56
v_min_u32 v58, L_qj-L_text0, v56
v_mov_b32 v59, 0
v_lshl_add_u64 v[58:59], v[58:59], 0, s[4:5]
global_load_dword v57, v[58:59], off
v_lshrrev_b32 v15, 6, v0
v_and_b32 v0, 63, v0
v_readfirstlane_b32 s3, v15
s_and_b32 s40, s2, 7
s_lshr_b32 s41, s2, 3
s_and_b32 s42, s41, 3
s_lshr_b32 s43, s41, 2
s_and_b32 s44, s42, 1
s_lshl_b32 s45, s40, 1
s_add_u32 s44, s44, s45
s_lshr_b32 s45, s42, 1
s_lshl_b32 s47, s44, 9
s_lshl_b32 s97, s3, 18
s_add_u32 s97, s97, s47
s_and_b32 s48, s3, 1
s_lshl_b32 s48, s48, 18
s_add_u32 s96, s47, s48
s_lshr_b32 s48, s3, 1
s_lshl_b32 s48, s48, 7
s_add_u32 s96, s96, s48
s_bfe_u32 s49, s2, 65541
s_lshl_b32 s48, s49, 8
s_add_u32 s96, s96, s48
s_sub_u32 s97, s97, s48
s_lshl_b32 s98, s3, 12
s_mul_i32 s100, s3, 24576
s_add_u32 s100, s100, 65536
s_lshl_b32 s46, s43, 2
s_add_u32 s46, s46, s3
s_lshl_b32 s99, s46, 16
s_lshr_b32 s48, s43, 1
s_add_u32 s48, s48, s42
s_and_b32 s48, s48, 2
s_lshl_b32 s60, s48, 8
s_add_u32 s99, s99, s60
s_lshl_b32 s48, s48, 20
s_add_u32 s96, s96, s48
s_add_u32 s97, s97, s48
v_lshrrev_b32 v16, 3, v0
v_and_b32 v17, 7, v0
v_lshrrev_b32 v18, 4, v0
v_xor_b32 v17, v17, v18
v_lshlrev_b32 v19, 10, v16
v_lshl_add_u32 v48, v17, 4, v19
v_xor_b32 v49, 64, v48
v_add_u32 v49, 8192, v49
v_add_u32 v50, 16384, v48
v_add_u32 v51, 16384, v49
v_add_u32 v52, 32768, v48
v_add_u32 v53, 32768, v49
v_add_u32 v54, 49152, v48
v_add_u32 v55, 49152, v49
v_lshrrev_b32 v20, 3, v0
v_bfe_u32 v22, v0, 1, 2
v_and_b32 v23, 1, v0
v_bfe_u32 v21, v0, 4, 1
v_xor_b32 v21, v21, v22
v_lshlrev_b32 v20, 13, v20
v_lshl_add_u32 v20, v23, 4, v20
v_xor_b32 v24, 0, v21
v_lshl_add_u32 v10, v24, 5, v20
v_xor_b32 v24, 2, v21
v_lshl_add_u32 v11, v24, 5, v20
v_add_u32 v11, 64512, v11
v_xor_b32 v24, 0, v21
v_lshl_add_u32 v12, v24, 5, v20
v_add_u32 v12, 129024, v12
v_xor_b32 v24, 2, v21
v_lshl_add_u32 v13, v24, 5, v20
v_add_u32 v13, 193536, v13
s_mov_b32 s86, 4194304
s_mov_b32 s87, 0x20000
s_mov_b32 s90, 2097152
s_mov_b32 s91, 0x20000
s_mov_b32 s60, 123994112
s_waitcnt lgkmcnt(0)
s_mov_b32 s88, s18
s_mov_b32 s89, s19
s_cmp_eq_u32 s45, 0
s_cselect_b32 s84, s22, s24
s_cselect_b32 s85, s23, s25
s_add_u32 s63, s99, 0
s_add_u32 m0, s100, 0
s_nop 0
buffer_load_dwordx4 v48, s[88:91], s63 offen lds
s_add_u32 m0, s100, 1024
s_nop 0
buffer_load_dwordx4 v49, s[88:91], s63 offen lds
s_add_u32 m0, s100, 2048
s_nop 0
buffer_load_dwordx4 v50, s[88:91], s63 offen lds
s_add_u32 m0, s100, 3072
s_nop 0
buffer_load_dwordx4 v51, s[88:91], s63 offen lds
s_add_u32 m0, s100, 4096
s_nop 0
buffer_load_dwordx4 v52, s[88:91], s63 offen lds
s_add_u32 m0, s100, 5120
s_nop 0
buffer_load_dwordx4 v53, s[88:91], s63 offen lds
s_add_u32 m0, s100, 6144
s_nop 0
buffer_load_dwordx4 v54, s[88:91], s63 offen lds
s_add_u32 m0, s100, 7168
s_nop 0
buffer_load_dwordx4 v55, s[88:91], s63 offen lds
s_add_u32 s62, s96, 0
s_add_u32 m0, s98, 0
s_nop 0
buffer_load_dwordx4 v10, s[84:87], s62 offen offset:0 lds
buffer_load_dwordx4 v11, s[84:87], s62 offen offset:1024 lds
buffer_load_dwordx4 v12, s[84:87], s62 offen offset:2048 lds
buffer_load_dwordx4 v13, s[84:87], s62 offen offset:3072 lds
s_load_dword s82, s[12:13], s60
v_and_b32 v24, 31, v0
v_lshrrev_b32 v25, 5, v0
s_lshr_b32 s60, s2, 5
s_lshl_b32 s60, s60, 7
s_sub_u32 s61, 1792, s60
s_bitcmp1_b32 s2, 4
s_cselect_b32 s60, s61, s60
s_and_b32 s61, s2, 31
s_lshl_b32 s61, s61, 3
s_add_u32 s60, s60, s61
s_lshl_b32 s61, s3, 1
s_add_u32 s60, s60, s61
v_add_u32 v25, s60, v25
v_cmp_gt_u32 s[36:37], 24, v24
v_mul_u32_u24 v26, 1152, v25
v_lshl_add_u32 v26, v24, 4, v26
v_mov_b32 v27, 0x7fffffff
v_cndmask_b32 v26, v27, v26, s[36:37]
s_mov_b32 s92, s16
s_mov_b32 s93, s17
s_mov_b32 s94, 2359296
s_mov_b32 s95, 0x20000
s_mov_b32 s14, 268435456
s_mov_b32 s15, 0x20000
v_lshrrev_b32 v16, 4, v25
v_mul_u32_u24 v16, 18432, v16
v_lshrrev_b32 v17, 2, v24
v_lshl_add_u32 v16, v17, 10, v16
v_and_b32 v17, 3, v24
v_lshl_add_u32 v16, v17, 8, v16
v_and_b32 v17, 15, v25
v_lshl_add_u32 v16, v17, 4, v16
v_cndmask_b32 v4, v27, v16, s[36:37]
v_lshrrev_b32 v20, 4, v0
v_bfe_u32 v21, v0, 2, 2
v_and_b32 v22, 3, v0
v_lshl_add_u32 v23, v20, 3, v21
v_lshlrev_b32 v23, 7, v23
v_lshl_add_u32 v23, v22, 3, v23
v_and_b32 v24, 1, v20
v_lshrrev_b32 v21, 1, v21
v_lshl_or_b32 v24, v24, 1, v21
v_xor_b32 v21, 0, v24
v_lshl_add_u32 v36, v21, 5, v23
v_add_u32 v40, 0x10000, v36
v_add_u32 v44, 0x20000, v36
v_xor_b32 v21, 1, v24
v_lshl_add_u32 v37, v21, 5, v23
v_add_u32 v41, 0x10000, v37
v_add_u32 v45, 0x20000, v37
v_xor_b32 v21, 2, v24
v_lshl_add_u32 v38, v21, 5, v23
v_add_u32 v42, 0x10000, v38
v_add_u32 v46, 0x20000, v38
v_xor_b32 v21, 3, v24
v_lshl_add_u32 v39, v21, 5, v23
v_add_u32 v43, 0x10000, v39
v_add_u32 v47, 0x20000, v39
v_and_b32 v17, 15, v0
v_lshrrev_b32 v18, 1, v17
v_xor_b32 v18, v18, v20
v_lshlrev_b32 v17, 7, v17
v_lshl_add_u32 v17, v18, 4, v17
v_xor_b32 v18, 64, v17
v_add_u32 v2, s100, v17
v_add_u32 v3, s100, v18
v_lshlrev_b32 v1, 4, v0
s_mul_i32 s101, s44, 1049600
s_lshl_b32 s60, s46, 14
s_add_u32 s101, s101, s60
s_mul_i32 s60, s45, 33554432
s_add_u32 s101, s101, s60
s_add_u32 s101, s101, 33554432
s_mul_i32 s60, s49, 524800
s_add_u32 s33, s101, 524800
s_sub_u32 s33, s33, s60
s_add_u32 s101, s101, s60
s_lshl_b32 s49, s49, 8
s_mov_b32 s39, 6144
s_mov_b32 s40, 12288
s_mov_b32 s38, 0
s_lshl_b32 s41, s2, 2
s_add_u32 s41, s41, s3
s_mul_i32 s41, s41, 8192
v_mul_u32_u24 v5, 128, v0
v_lshrrev_b32 v16, 1, v0
v_and_b32 v17, 1, v0
v_lshlrev_b32 v17, 7, v17
v_lshl_add_u32 v19, v16, 13, v17
s_lshl_b32 s54, s46, 17
s_add_u32 s54, s54, s47
s_add_u32 s54, s54, 256
s_mul_i32 s55, s46, 147456
s_sub_u32 s54, s54, s49
s_mov_b32 s34, 0x3e0293ee
s_mov_b32 s35, 0x3e0293ee
s_mov_b32 s83, 4096
s_add_u32 s4, s4, L_qj-L_text0
s_addc_u32 s5, s5, 0
v_min_u32 v60, L_k2_last-L_qj, v56
v_mov_b32 v61, 0
v_lshl_add_u64 v[60:61], v[60:61], 0, s[4:5]
s_mov_b32 s47, s45
s_mov_b32 s50, s20
s_mov_b32 s51, s21
s_cmp_eq_u32 s3, 0
s_cselect_b32 s48, s30, s6
s_cselect_b32 s49, s31, s7
s_mov_b32 s43, 5308416
s_cmp_eq_u32 s3, 3
s_cselect_b32 s48, s26, s48
s_cselect_b32 s49, s27, s49
s_cselect_b32 s43, 4718592, s43
s_cmp_eq_u32 s3, 2
s_cselect_b32 s43, 0, s43
s_and_b32 s60, s2, 7
s_lshr_b32 s61, s2, 3
s_and_b32 s62, s61, 3
s_lshr_b32 s25, s61, 2
s_lshl_b32 s24, s60, 2
s_add_u32 s24, s24, s62
s_mov_b32 s29, 0
s_sub_u32 s60, 15, s25
s_lshl_b32 s60, s60, 1
s_and_b32 s61, s3, 1
s_add_u32 s60, s60, s61
s_lshl_b32 s62, s25, 1
s_add_u32 s62, s62, 3
s_sub_u32 s62, s62, s3
s_cmp_lt_u32 s3, 2
s_cselect_b32 s63, s60, s62
s_cselect_b64 s[52:53], -1, 0
s_lshl_b32 s58, s63, 6
s_lshl_b32 s59, s63, 1
s_add_u32 s59, s59, 2
s_mul_i32 s30, s63, 73728
s_and_b32 s61, s2, 7
s_mul_i32 s61, s61, 2342912
s_lshl_b32 s31, s24, 12
s_add_u32 s61, s61, s31
s_add_u32 s61, s61, 167772160
s_mul_i32 s31, s62, 73728
s_add_u32 s31, s31, s61
s_mul_i32 s32, s60, 73728
s_add_u32 s32, s32, s61
s_and_b32 s60, s3, 1
s_lshr_b32 s61, s3, 1
s_lshl_b32 s56, s61, 18
s_lshl_b32 s62, s60, 7
s_add_u32 s56, s56, s62
s_lshl_b32 s57, s60, 13
s_lshl_b32 s62, s61, 12
s_add_u32 s57, s57, s62
s_lshl_b32 s22, s61, 16
s_lshl_b32 s62, s60, 13
s_add_u32 s22, s22, s62
s_cmp_lt_u32 s3, 2
s_cselect_b32 s21, 1, -1
s_lshl_b32 s21, s21, 13
s_mul_i32 s46, s60, 33554432
s_mul_i32 s63, s24, 524800
s_add_u32 s46, s46, s63
s_mul_i32 s63, s61, 270336
s_add_u32 s46, s46, s63
s_add_u32 s46, s46, 33554432
s_lshl_b32 s62, s25, 15
s_sub_u32 s62, 253952, s62
s_cmp_lt_u32 s3, 2
s_cselect_b32 s18, 270336, s62
s_mov_b32 s19, 0x20000
s_add_u32 s16, s12, s46
s_addc_u32 s17, s13, 0
s_lshl_b32 s62, s24, 8
s_sub_u32 s10, 4718592, s62
s_mov_b32 s11, 0x20000
s_add_u32 s8, s50, s62
s_addc_u32 s9, s51, 0
s_lshl_b32 s6, s2, 7
s_lshl_b32 s60, s3, 2
s_add_u32 s6, s6, s60
s_add_u32 s6, s6, 123731968
s_sub_u32 s60, 3, s3
s_add_u32 s61, s3, 2
s_cmp_lt_u32 s3, 2
s_cselect_b32 s60, s61, s60
s_lshl_b32 s60, s60, 10
s_lshl_b32 s7, s25, 12
s_add_u32 s7, s7, s60
s_add_u32 s7, s7, 123731968
v_bfe_u32 v16, v0, 2, 3
v_and_b32 v17, 3, v0
v_lshlrev_b32 v17, 2, v17
v_lshl_add_u32 v6, v16, 7, v17
v_lshrrev_b32 v16, 2, v0
v_lshl_add_u32 v9, v16, 11, v17
v_mov_b32 v14, 0
v_mov_b32 v15, 0
v_mov_b32 v16, 0
v_mov_b32 v17, 0
s_add_u32 s63, s99, 128
s_add_u32 m0, s100, 8192
s_nop 0
buffer_load_dwordx4 v48, s[88:91], s63 offen lds
s_add_u32 m0, s100, 9216
s_nop 0
buffer_load_dwordx4 v49, s[88:91], s63 offen lds
s_add_u32 m0, s100, 10240
s_nop 0
buffer_load_dwordx4 v50, s[88:91], s63 offen lds
s_add_u32 m0, s100, 11264
s_nop 0
buffer_load_dwordx4 v51, s[88:91], s63 offen lds
s_add_u32 m0, s100, 12288
s_nop 0
buffer_load_dwordx4 v52, s[88:91], s63 offen lds
s_add_u32 m0, s100, 13312
s_nop 0
buffer_load_dwordx4 v53, s[88:91], s63 offen lds
s_add_u32 m0, s100, 14336
s_nop 0
buffer_load_dwordx4 v54, s[88:91], s63 offen lds
s_add_u32 m0, s100, 15360
s_nop 0
buffer_load_dwordx4 v55, s[88:91], s63 offen lds
s_add_u32 s62, s96, 524288
s_add_u32 m0, s98, 16384
s_nop 0
buffer_load_dwordx4 v10, s[84:87], s62 offen offset:0 lds
buffer_load_dwordx4 v11, s[84:87], s62 offen offset:1024 lds
buffer_load_dwordx4 v12, s[84:87], s62 offen offset:2048 lds
buffer_load_dwordx4 v13, s[84:87], s62 offen offset:3072 lds
s_add_u32 s63, s99, 256
s_bitset0_b32 s63, 10
s_add_u32 m0, s100, 16384
s_nop 0
buffer_load_dwordx4 v48, s[88:91], s63 offen lds
s_add_u32 m0, s100, 17408
s_nop 0
buffer_load_dwordx4 v49, s[88:91], s63 offen lds
s_add_u32 m0, s100, 18432
s_nop 0
buffer_load_dwordx4 v50, s[88:91], s63 offen lds
s_add_u32 m0, s100, 19456
s_nop 0
buffer_load_dwordx4 v51, s[88:91], s63 offen lds
s_add_u32 m0, s100, 20480
s_nop 0
buffer_load_dwordx4 v52, s[88:91], s63 offen lds
s_add_u32 m0, s100, 21504
s_nop 0
buffer_load_dwordx4 v53, s[88:91], s63 offen lds
s_add_u32 m0, s100, 22528
s_nop 0
buffer_load_dwordx4 v54, s[88:91], s63 offen lds
s_add_u32 m0, s100, 23552
s_nop 0
buffer_load_dwordx4 v55, s[88:91], s63 offen lds
s_add_u32 s62, s96, 1048576
s_bitset0_b32 s62, 22
s_add_u32 m0, s98, 32768
s_nop 0
buffer_load_dwordx4 v10, s[84:87], s62 offen offset:0 lds
buffer_load_dwordx4 v11, s[84:87], s62 offen offset:1024 lds
buffer_load_dwordx4 v12, s[84:87], s62 offen offset:2048 lds
buffer_load_dwordx4 v13, s[84:87], s62 offen offset:3072 lds
buffer_load_dwordx4 v[192:195], v26, s[92:95], 0 offen offset:0
buffer_load_dwordx4 v[196:199], v26, s[92:95], 0 offen offset:384
buffer_load_dwordx4 v[200:203], v26, s[92:95], 0 offen offset:768
s_waitcnt vmcnt(31)
s_waitcnt lgkmcnt(0)
ds_read_b128 a[0:3], v2 offset:0
ds_read_b128 a[4:7], v2 offset:2048
ds_read_b128 a[8:11], v2 offset:4096
ds_read_b128 a[12:15], v2 offset:6144
ds_read_b128 a[16:19], v3 offset:0
ds_read_b128 a[20:23], v3 offset:2048
ds_read_b128 a[24:27], v3 offset:4096
ds_read_b128 a[28:31], v3 offset:6144
s_add_u32 s82, s82, 1
s_addc_u32 s82, s82, 0
v_mov_b32 v8, s82
s_waitcnt vmcnt(27)
s_barrier
s_cmp_eq_u32 s47, 0
s_cbranch_scc0 L_k1_v
ds_read_b64_tr_b16 v[20:21], v36 offset:0
ds_read_b64_tr_b16 v[22:23], v36 offset:512
ds_read_b64_tr_b16 v[24:25], v36 offset:4096
ds_read_b64_tr_b16 v[26:27], v36 offset:4608
ds_read_b64_tr_b16 v[28:29], v37 offset:0
ds_read_b64_tr_b16 v[30:31], v37 offset:512
ds_read_b64_tr_b16 v[32:33], v37 offset:4096
ds_read_b64_tr_b16 v[34:35], v37 offset:4608
s_waitcnt lgkmcnt(4)
v_mfma_f32_16x16x32_bf16 v[64:67], v[20:23], a[0:3], 0
ds_read_b64_tr_b16 v[240:241], v38 offset:0
v_mfma_f32_16x16x32_bf16 v[64:67], v[24:27], a[16:19], v[64:67]
ds_read_b64_tr_b16 v[242:243], v38 offset:512
v_mfma_f32_16x16x32_bf16 v[68:71], v[24:27], a[20:23], 0
ds_read_b64_tr_b16 v[244:245], v38 offset:4096
s_add_u32 s63, s99, 384
s_bitset0_b32 s63, 10
s_add_u32 m0, s100, 0
v_mfma_f32_16x16x32_bf16 v[68:71], v[20:23], a[4:7], v[68:71]
buffer_load_dwordx4 v48, s[88:91], s63 offen lds
v_mfma_f32_16x16x32_bf16 v[72:75], v[20:23], a[8:11], 0
ds_read_b64_tr_b16 v[246:247], v38 offset:4608
v_mfma_f32_16x16x32_bf16 v[72:75], v[24:27], a[24:27], v[72:75]
v_mfma_f32_16x16x32_bf16 v[76:79], v[24:27], a[28:31], 0
s_add_u32 m0, s100, 1024
v_mfma_f32_16x16x32_bf16 v[76:79], v[20:23], a[12:15], v[76:79]
buffer_load_dwordx4 v49, s[88:91], s63 offen lds
s_waitcnt lgkmcnt(4)
v_mfma_f32_16x16x32_bf16 v[80:83], v[28:31], a[0:3], 0
ds_read_b64_tr_b16 v[24:25], v39 offset:0
v_mfma_f32_16x16x32_bf16 v[80:83], v[32:35], a[16:19], v[80:83]
ds_read_b64_tr_b16 v[26:27], v39 offset:512
v_mfma_f32_16x16x32_bf16 v[84:87], v[32:35], a[20:23], 0
ds_read_b64_tr_b16 v[20:21], v39 offset:4096
s_add_u32 s62, s96, 1572864
s_bitset0_b32 s62, 22
s_add_u32 m0, s98, 49152
v_mfma_f32_16x16x32_bf16 v[84:87], v[28:31], a[4:7], v[84:87]
buffer_load_dwordx4 v10, s[84:87], s62 offen offset:0 lds
v_mfma_f32_16x16x32_bf16 v[88:91], v[28:31], a[8:11], 0
ds_read_b64_tr_b16 v[22:23], v39 offset:4608
v_mfma_f32_16x16x32_bf16 v[88:91], v[32:35], a[24:27], v[88:91]
v_mfma_f32_16x16x32_bf16 v[92:95], v[32:35], a[28:31], 0
s_waitcnt vmcnt(22)
ds_read_b128 a[32:35], v2 offset:8192
v_mfma_f32_16x16x32_bf16 v[92:95], v[28:31], a[12:15], v[92:95]
ds_read_b128 a[36:39], v2 offset:10240
s_waitcnt lgkmcnt(6)
v_mfma_f32_16x16x32_bf16 v[96:99], v[240:243], a[0:3], 0
ds_read_b64_tr_b16 v[32:33], v36 offset:8192
v_mfma_f32_16x16x32_bf16 v[96:99], v[244:247], a[16:19], v[96:99]
ds_read_b64_tr_b16 v[34:35], v36 offset:8704
v_mfma_f32_16x16x32_bf16 v[100:103], v[244:247], a[20:23], 0
ds_read_b64_tr_b16 v[28:29], v36 offset:12288
s_add_u32 m0, s100, 2048
v_mfma_f32_16x16x32_bf16 v[100:103], v[240:243], a[4:7], v[100:103]
buffer_load_dwordx4 v50, s[88:91], s63 offen lds
v_mfma_f32_16x16x32_bf16 v[104:107], v[240:243], a[8:11], 0
ds_read_b64_tr_b16 v[30:31], v36 offset:12800
v_mfma_f32_16x16x32_bf16 v[104:107], v[244:247], a[24:27], v[104:107]
v_mfma_f32_16x16x32_bf16 v[108:111], v[244:247], a[28:31], 0
s_add_u32 m0, s100, 3072
ds_read_b128 a[40:43], v2 offset:12288
v_mfma_f32_16x16x32_bf16 v[108:111], v[240:243], a[12:15], v[108:111]
buffer_load_dwordx4 v51, s[88:91], s63 offen lds
s_waitcnt lgkmcnt(7)
v_mfma_f32_16x16x32_bf16 v[112:115], v[24:27], a[0:3], 0
ds_read_b64_tr_b16 v[244:245], v37 offset:8192
v_mfma_f32_16x16x32_bf16 v[112:115], v[20:23], a[16:19], v[112:115]
ds_read_b64_tr_b16 v[246:247], v37 offset:8704
v_mfma_f32_16x16x32_bf16 v[116:119], v[20:23], a[20:23], 0
ds_read_b64_tr_b16 v[240:241], v37 offset:12288
s_add_u32 m0, s98, 49152
v_mfma_f32_16x16x32_bf16 v[116:119], v[24:27], a[4:7], v[116:119]
buffer_load_dwordx4 v11, s[84:87], s62 offen offset:1024 lds
v_mfma_f32_16x16x32_bf16 v[120:123], v[24:27], a[8:11], 0
ds_read_b64_tr_b16 v[242:243], v37 offset:12800
v_mfma_f32_16x16x32_bf16 v[120:123], v[20:23], a[24:27], v[120:123]
v_mfma_f32_16x16x32_bf16 v[124:127], v[20:23], a[28:31], 0
ds_read_b128 a[44:47], v2 offset:14336
v_mfma_f32_16x16x32_bf16 v[124:127], v[24:27], a[12:15], v[124:127]
ds_read_b128 a[48:51], v3 offset:8192
s_waitcnt lgkmcnt(7)
v_mfma_f32_16x16x32_bf16 v[128:131], v[32:35], a[0:3], 0
ds_read_b64_tr_b16 v[20:21], v38 offset:8192
v_mfma_f32_16x16x32_bf16 v[128:131], v[28:31], a[16:19], v[128:131]
ds_read_b64_tr_b16 v[22:23], v38 offset:8704
v_mfma_f32_16x16x32_bf16 v[132:135], v[28:31], a[20:23], 0
ds_read_b64_tr_b16 v[24:25], v38 offset:12288
s_add_u32 m0, s100, 4096
v_mfma_f32_16x16x32_bf16 v[132:135], v[32:35], a[4:7], v[132:135]
buffer_load_dwordx4 v52, s[88:91], s63 offen lds
v_mfma_f32_16x16x32_bf16 v[136:139], v[32:35], a[8:11], 0
ds_read_b64_tr_b16 v[26:27], v38 offset:12800
v_mfma_f32_16x16x32_bf16 v[136:139], v[28:31], a[24:27], v[136:139]
v_mfma_f32_16x16x32_bf16 v[140:143], v[28:31], a[28:31], 0
s_add_u32 m0, s100, 5120
ds_read_b128 a[52:55], v3 offset:10240
v_mfma_f32_16x16x32_bf16 v[140:143], v[32:35], a[12:15], v[140:143]
buffer_load_dwordx4 v53, s[88:91], s63 offen lds
s_waitcnt lgkmcnt(7)
v_mfma_f32_16x16x32_bf16 v[144:147], v[244:247], a[0:3], 0
ds_read_b64_tr_b16 v[28:29], v39 offset:8192
v_mfma_f32_16x16x32_bf16 v[144:147], v[240:243], a[16:19], v[144:147]
ds_read_b64_tr_b16 v[30:31], v39 offset:8704
v_mfma_f32_16x16x32_bf16 v[148:151], v[240:243], a[20:23], 0
ds_read_b64_tr_b16 v[32:33], v39 offset:12288
s_add_u32 m0, s98, 49152
v_mfma_f32_16x16x32_bf16 v[148:151], v[244:247], a[4:7], v[148:151]
buffer_load_dwordx4 v12, s[84:87], s62 offen offset:2048 lds
v_mfma_f32_16x16x32_bf16 v[152:155], v[244:247], a[8:11], 0
ds_read_b64_tr_b16 v[34:35], v39 offset:12800
v_mfma_f32_16x16x32_bf16 v[152:155], v[240:243], a[24:27], v[152:155]
v_mfma_f32_16x16x32_bf16 v[156:159], v[240:243], a[28:31], 0
ds_read_b128 a[56:59], v3 offset:12288
v_mfma_f32_16x16x32_bf16 v[156:159], v[244:247], a[12:15], v[156:159]
ds_read_b128 a[60:63], v3 offset:14336
s_waitcnt vmcnt(24) lgkmcnt(7)
s_barrier
v_mfma_f32_16x16x32_bf16 v[160:163], v[20:23], a[0:3], 0
ds_read_b64_tr_b16 v[240:241], v36 offset:16384
v_mfma_f32_16x16x32_bf16 v[160:163], v[24:27], a[16:19], v[160:163]
ds_read_b64_tr_b16 v[242:243], v36 offset:16896
v_mfma_f32_16x16x32_bf16 v[164:167], v[24:27], a[20:23], 0
ds_read_b64_tr_b16 v[244:245], v36 offset:20480
s_add_u32 m0, s100, 6144
v_mfma_f32_16x16x32_bf16 v[164:167], v[20:23], a[4:7], v[164:167]
buffer_load_dwordx4 v54, s[88:91], s63 offen lds
v_mfma_f32_16x16x32_bf16 v[168:171], v[20:23], a[8:11], 0
ds_read_b64_tr_b16 v[246:247], v36 offset:20992
v_mfma_f32_16x16x32_bf16 v[168:171], v[24:27], a[24:27], v[168:171]
v_mfma_f32_16x16x32_bf16 v[172:175], v[24:27], a[28:31], 0
s_add_u32 m0, s100, 7168
v_mfma_f32_16x16x32_bf16 v[172:175], v[20:23], a[12:15], v[172:175]
buffer_load_dwordx4 v55, s[88:91], s63 offen lds
s_waitcnt lgkmcnt(6)
v_mfma_f32_16x16x32_bf16 v[176:179], v[28:31], a[0:3], 0
ds_read_b64_tr_b16 v[24:25], v37 offset:16384
v_mfma_f32_16x16x32_bf16 v[176:179], v[32:35], a[16:19], v[176:179]
ds_read_b64_tr_b16 v[26:27], v37 offset:16896
v_mfma_f32_16x16x32_bf16 v[180:183], v[32:35], a[20:23], 0
ds_read_b64_tr_b16 v[20:21], v37 offset:20480
s_add_u32 m0, s98, 49152
v_mfma_f32_16x16x32_bf16 v[180:183], v[28:31], a[4:7], v[180:183]
buffer_load_dwordx4 v13, s[84:87], s62 offen offset:3072 lds
v_mfma_f32_16x16x32_bf16 v[184:187], v[28:31], a[8:11], 0
ds_read_b64_tr_b16 v[22:23], v37 offset:20992
v_mfma_f32_16x16x32_bf16 v[184:187], v[32:35], a[24:27], v[184:187]
v_mfma_f32_16x16x32_bf16 v[188:191], v[32:35], a[28:31], 0
v_mfma_f32_16x16x32_bf16 v[188:191], v[28:31], a[12:15], v[188:191]
s_waitcnt lgkmcnt(4)
v_mfma_f32_16x16x32_bf16 v[64:67], v[240:243], a[32:35], v[64:67]
ds_read_b64_tr_b16 v[32:33], v38 offset:16384
v_mfma_f32_16x16x32_bf16 v[64:67], v[244:247], a[48:51], v[64:67]
ds_read_b64_tr_b16 v[34:35], v38 offset:16896
v_mfma_f32_16x16x32_bf16 v[68:71], v[244:247], a[52:55], v[68:71]
ds_read_b64_tr_b16 v[28:29], v38 offset:20480
s_add_u32 s63, s99, 512
s_bitset0_b32 s63, 10
s_add_u32 m0, s100, 8192
v_mfma_f32_16x16x32_bf16 v[68:71], v[240:243], a[36:39], v[68:71]
buffer_load_dwordx4 v48, s[88:91], s63 offen lds
v_mfma_f32_16x16x32_bf16 v[72:75], v[240:243], a[40:43], v[72:75]
ds_read_b64_tr_b16 v[30:31], v38 offset:20992
v_mfma_f32_16x16x32_bf16 v[72:75], v[244:247], a[56:59], v[72:75]
v_mfma_f32_16x16x32_bf16 v[76:79], v[244:247], a[60:63], v[76:79]
s_add_u32 m0, s100, 9216
v_mfma_f32_16x16x32_bf16 v[76:79], v[240:243], a[44:47], v[76:79]
buffer_load_dwordx4 v49, s[88:91], s63 offen lds
s_waitcnt lgkmcnt(4)
v_mfma_f32_16x16x32_bf16 v[80:83], v[24:27], a[32:35], v[80:83]
ds_read_b64_tr_b16 v[244:245], v39 offset:16384
v_mfma_f32_16x16x32_bf16 v[80:83], v[20:23], a[48:51], v[80:83]
ds_read_b64_tr_b16 v[246:247], v39 offset:16896
v_mfma_f32_16x16x32_bf16 v[84:87], v[20:23], a[52:55], v[84:87]
ds_read_b64_tr_b16 v[240:241], v39 offset:20480
s_add_u32 s62, s96, 2097152
s_bitset0_b32 s62, 22
s_add_u32 m0, s98, 0
v_mfma_f32_16x16x32_bf16 v[84:87], v[24:27], a[36:39], v[84:87]
buffer_load_dwordx4 v10, s[84:87], s62 offen offset:0 lds
v_mfma_f32_16x16x32_bf16 v[88:91], v[24:27], a[40:43], v[88:91]
ds_read_b64_tr_b16 v[242:243], v39 offset:20992
v_mfma_f32_16x16x32_bf16 v[88:91], v[20:23], a[56:59], v[88:91]
v_mfma_f32_16x16x32_bf16 v[92:95], v[20:23], a[60:63], v[92:95]
s_waitcnt vmcnt(22)
ds_read_b128 a[64:67], v2 offset:16384
v_mfma_f32_16x16x32_bf16 v[92:95], v[24:27], a[44:47], v[92:95]
ds_read_b128 a[68:71], v2 offset:18432
s_waitcnt lgkmcnt(6)
v_mfma_f32_16x16x32_bf16 v[96:99], v[32:35], a[32:35], v[96:99]
ds_read_b64_tr_b16 v[20:21], v36 offset:24576
v_mfma_f32_16x16x32_bf16 v[96:99], v[28:31], a[48:51], v[96:99]
ds_read_b64_tr_b16 v[22:23], v36 offset:25088
v_mfma_f32_16x16x32_bf16 v[100:103], v[28:31], a[52:55], v[100:103]
ds_read_b64_tr_b16 v[24:25], v36 offset:28672
s_add_u32 m0, s100, 10240
v_mfma_f32_16x16x32_bf16 v[100:103], v[32:35], a[36:39], v[100:103]
buffer_load_dwordx4 v50, s[88:91], s63 offen lds
v_mfma_f32_16x16x32_bf16 v[104:107], v[32:35], a[40:43], v[104:107]
ds_read_b64_tr_b16 v[26:27], v36 offset:29184
v_mfma_f32_16x16x32_bf16 v[104:107], v[28:31], a[56:59], v[104:107]
v_mfma_f32_16x16x32_bf16 v[108:111], v[28:31], a[60:63], v[108:111]
s_add_u32 m0, s100, 11264
ds_read_b128 a[72:75], v2 offset:20480
v_mfma_f32_16x16x32_bf16 v[108:111], v[32:35], a[44:47], v[108:111]
buffer_load_dwordx4 v51, s[88:91], s63 offen lds
s_waitcnt lgkmcnt(7)
v_mfma_f32_16x16x32_bf16 v[112:115], v[244:247], a[32:35], v[112:115]
ds_read_b64_tr_b16 v[28:29], v37 offset:24576
v_mfma_f32_16x16x32_bf16 v[112:115], v[240:243], a[48:51], v[112:115]
ds_read_b64_tr_b16 v[30:31], v37 offset:25088
v_mfma_f32_16x16x32_bf16 v[116:119], v[240:243], a[52:55], v[116:119]
ds_read_b64_tr_b16 v[32:33], v37 offset:28672
s_add_u32 m0, s98, 0
v_mfma_f32_16x16x32_bf16 v[116:119], v[244:247], a[36:39], v[116:119]
buffer_load_dwordx4 v11, s[84:87], s62 offen offset:1024 lds
v_mfma_f32_16x16x32_bf16 v[120:123], v[244:247], a[40:43], v[120:123]
ds_read_b64_tr_b16 v[34:35], v37 offset:29184
v_mfma_f32_16x16x32_bf16 v[120:123], v[240:243], a[56:59], v[120:123]
v_mfma_f32_16x16x32_bf16 v[124:127], v[240:243], a[60:63], v[124:127]
ds_read_b128 a[76:79], v2 offset:22528
v_mfma_f32_16x16x32_bf16 v[124:127], v[244:247], a[44:47], v[124:127]
ds_read_b128 a[80:83], v3 offset:16384
s_waitcnt lgkmcnt(7)
v_mfma_f32_16x16x32_bf16 v[128:131], v[20:23], a[32:35], v[128:131]
ds_read_b64_tr_b16 v[240:241], v38 offset:24576
v_mfma_f32_16x16x32_bf16 v[128:131], v[24:27], a[48:51], v[128:131]
ds_read_b64_tr_b16 v[242:243], v38 offset:25088
v_mfma_f32_16x16x32_bf16 v[132:135], v[24:27], a[52:55], v[132:135]
ds_read_b64_tr_b16 v[244:245], v38 offset:28672
s_add_u32 m0, s100, 12288
v_mfma_f32_16x16x32_bf16 v[132:135], v[20:23], a[36:39], v[132:135]
buffer_load_dwordx4 v52, s[88:91], s63 offen lds
v_mfma_f32_16x16x32_bf16 v[136:139], v[20:23], a[40:43], v[136:139]
ds_read_b64_tr_b16 v[246:247], v38 offset:29184
v_mfma_f32_16x16x32_bf16 v[136:139], v[24:27], a[56:59], v[136:139]
v_mfma_f32_16x16x32_bf16 v[140:143], v[24:27], a[60:63], v[140:143]
s_add_u32 m0, s100, 13312
ds_read_b128 a[84:87], v3 offset:18432
v_mfma_f32_16x16x32_bf16 v[140:143], v[20:23], a[44:47], v[140:143]
buffer_load_dwordx4 v53, s[88:91], s63 offen lds
s_waitcnt lgkmcnt(7)
v_mfma_f32_16x16x32_bf16 v[144:147], v[28:31], a[32:35], v[144:147]
ds_read_b64_tr_b16 v[24:25], v39 offset:24576
v_mfma_f32_16x16x32_bf16 v[144:147], v[32:35], a[48:51], v[144:147]
ds_read_b64_tr_b16 v[26:27], v39 offset:25088
v_mfma_f32_16x16x32_bf16 v[148:151], v[32:35], a[52:55], v[148:151]
ds_read_b64_tr_b16 v[20:21], v39 offset:28672
s_add_u32 m0, s98, 0
v_mfma_f32_16x16x32_bf16 v[148:151], v[28:31], a[36:39], v[148:151]
buffer_load_dwordx4 v12, s[84:87], s62 offen offset:2048 lds
v_mfma_f32_16x16x32_bf16 v[152:155], v[28:31], a[40:43], v[152:155]
ds_read_b64_tr_b16 v[22:23], v39 offset:29184
v_mfma_f32_16x16x32_bf16 v[152:155], v[32:35], a[56:59], v[152:155]
v_mfma_f32_16x16x32_bf16 v[156:159], v[32:35], a[60:63], v[156:159]
ds_read_b128 a[88:91], v3 offset:20480
v_mfma_f32_16x16x32_bf16 v[156:159], v[28:31], a[44:47], v[156:159]
ds_read_b128 a[92:95], v3 offset:22528
s_waitcnt vmcnt(24) lgkmcnt(7)
s_barrier
v_mfma_f32_16x16x32_bf16 v[160:163], v[240:243], a[32:35], v[160:163]
ds_read_b64_tr_b16 v[32:33], v36 offset:32768
v_mfma_f32_16x16x32_bf16 v[160:163], v[244:247], a[48:51], v[160:163]
ds_read_b64_tr_b16 v[34:35], v36 offset:33280
v_mfma_f32_16x16x32_bf16 v[164:167], v[244:247], a[52:55], v[164:167]
ds_read_b64_tr_b16 v[28:29], v36 offset:36864
s_add_u32 m0, s100, 14336
v_mfma_f32_16x16x32_bf16 v[164:167], v[240:243], a[36:39], v[164:167]
buffer_load_dwordx4 v54, s[88:91], s63 offen lds
v_mfma_f32_16x16x32_bf16 v[168:171], v[240:243], a[40:43], v[168:171]
ds_read_b64_tr_b16 v[30:31], v36 offset:37376
v_mfma_f32_16x16x32_bf16 v[168:171], v[244:247], a[56:59], v[168:171]
v_mfma_f32_16x16x32_bf16 v[172:175], v[244:247], a[60:63], v[172:175]
s_add_u32 m0, s100, 15360
v_mfma_f32_16x16x32_bf16 v[172:175], v[240:243], a[44:47], v[172:175]
buffer_load_dwordx4 v55, s[88:91], s63 offen lds
s_waitcnt lgkmcnt(6)
v_mfma_f32_16x16x32_bf16 v[176:179], v[24:27], a[32:35], v[176:179]
ds_read_b64_tr_b16 v[244:245], v37 offset:32768
v_mfma_f32_16x16x32_bf16 v[176:179], v[20:23], a[48:51], v[176:179]
ds_read_b64_tr_b16 v[246:247], v37 offset:33280
v_mfma_f32_16x16x32_bf16 v[180:183], v[20:23], a[52:55], v[180:183]
ds_read_b64_tr_b16 v[240:241], v37 offset:36864
s_add_u32 m0, s98, 0
v_mfma_f32_16x16x32_bf16 v[180:183], v[24:27], a[36:39], v[180:183]
buffer_load_dwordx4 v13, s[84:87], s62 offen offset:3072 lds
v_mfma_f32_16x16x32_bf16 v[184:187], v[24:27], a[40:43], v[184:187]
ds_read_b64_tr_b16 v[242:243], v37 offset:37376
v_mfma_f32_16x16x32_bf16 v[184:187], v[20:23], a[56:59], v[184:187]
v_mfma_f32_16x16x32_bf16 v[188:191], v[20:23], a[60:63], v[188:191]
v_mfma_f32_16x16x32_bf16 v[188:191], v[24:27], a[44:47], v[188:191]
s_waitcnt lgkmcnt(4)
v_mfma_f32_16x16x32_bf16 v[64:67], v[32:35], a[64:67], v[64:67]
ds_read_b64_tr_b16 v[20:21], v38 offset:32768
s_waitcnt vmcnt(24)
v_mfma_f32_16x16x32_bf16 v[64:67], v[28:31], a[80:83], v[64:67]
ds_read_b64_tr_b16 v[22:23], v38 offset:33280
v_lshlrev_b32 v208, 16, v192
v_mfma_f32_16x16x32_bf16 v[68:71], v[28:31], a[84:87], v[68:71]
ds_read_b64_tr_b16 v[24:25], v38 offset:36864
s_add_u32 s63, s99, 640
s_bitset0_b32 s63, 10
s_add_u32 m0, s100, 16384
v_mfma_f32_16x16x32_bf16 v[68:71], v[32:35], a[68:71], v[68:71]
buffer_load_dwordx4 v48, s[88:91], s63 offen lds
v_and_b32 v209, 0xffff0000, v192
v_mfma_f32_16x16x32_bf16 v[72:75], v[32:35], a[72:75], v[72:75]
ds_read_b64_tr_b16 v[26:27], v38 offset:37376
v_lshlrev_b32 v210, 16, v193
v_mfma_f32_16x16x32_bf16 v[72:75], v[28:31], a[88:91], v[72:75]
v_and_b32 v211, 0xffff0000, v193
v_mfma_f32_16x16x32_bf16 v[76:79], v[28:31], a[92:95], v[76:79]
s_add_u32 m0, s100, 17408
v_lshlrev_b32 v212, 16, v194
v_mfma_f32_16x16x32_bf16 v[76:79], v[32:35], a[76:79], v[76:79]
buffer_load_dwordx4 v49, s[88:91], s63 offen lds
v_and_b32 v213, 0xffff0000, v194
s_waitcnt lgkmcnt(4)
v_mfma_f32_16x16x32_bf16 v[80:83], v[244:247], a[64:67], v[80:83]
ds_read_b64_tr_b16 v[28:29], v39 offset:32768
v_lshlrev_b32 v214, 16, v195
v_mfma_f32_16x16x32_bf16 v[80:83], v[240:243], a[80:83], v[80:83]
ds_read_b64_tr_b16 v[30:31], v39 offset:33280
v_and_b32 v215, 0xffff0000, v195
v_mfma_f32_16x16x32_bf16 v[84:87], v[240:243], a[84:87], v[84:87]
ds_read_b64_tr_b16 v[32:33], v39 offset:36864
s_add_u32 s62, s96, 2621440
s_bitset0_b32 s62, 22
s_add_u32 m0, s98, 16384
v_mfma_f32_16x16x32_bf16 v[84:87], v[244:247], a[68:71], v[84:87]
buffer_load_dwordx4 v10, s[84:87], s62 offen offset:0 lds
v_lshlrev_b32 v216, 16, v196
v_mfma_f32_16x16x32_bf16 v[88:91], v[244:247], a[72:75], v[88:91]
ds_read_b64_tr_b16 v[34:35], v39 offset:37376
v_and_b32 v217, 0xffff0000, v196
v_mfma_f32_16x16x32_bf16 v[88:91], v[240:243], a[88:91], v[88:91]
v_lshlrev_b32 v218, 16, v197
v_mfma_f32_16x16x32_bf16 v[92:95], v[240:243], a[92:95], v[92:95]
s_waitcnt vmcnt(16)
ds_read_b128 a[96:99], v2 offset:0
v_mfma_f32_16x16x32_bf16 v[92:95], v[244:247], a[76:79], v[92:95]
ds_read_b128 a[100:103], v2 offset:2048
v_and_b32 v219, 0xffff0000, v197
s_waitcnt lgkmcnt(6)
v_mfma_f32_16x16x32_bf16 v[96:99], v[20:23], a[64:67], v[96:99]
ds_read_b64_tr_b16 v[240:241], v36 offset:40960
v_lshlrev_b32 v220, 16, v198
v_mfma_f32_16x16x32_bf16 v[96:99], v[24:27], a[80:83], v[96:99]
ds_read_b64_tr_b16 v[242:243], v36 offset:41472
v_and_b32 v221, 0xffff0000, v198
v_mfma_f32_16x16x32_bf16 v[100:103], v[24:27], a[84:87], v[100:103]
ds_read_b64_tr_b16 v[244:245], v36 offset:45056
s_add_u32 m0, s100, 18432
v_mfma_f32_16x16x32_bf16 v[100:103], v[20:23], a[68:71], v[100:103]
buffer_load_dwordx4 v50, s[88:91], s63 offen lds
v_lshlrev_b32 v222, 16, v199
v_mfma_f32_16x16x32_bf16 v[104:107], v[20:23], a[72:75], v[104:107]
ds_read_b64_tr_b16 v[246:247], v36 offset:45568
v_and_b32 v223, 0xffff0000, v199
v_mfma_f32_16x16x32_bf16 v[104:107], v[24:27], a[88:91], v[104:107]
v_lshlrev_b32 v224, 16, v200
v_mfma_f32_16x16x32_bf16 v[108:111], v[24:27], a[92:95], v[108:111]
s_add_u32 m0, s100, 19456
ds_read_b128 a[104:107], v2 offset:4096
v_mfma_f32_16x16x32_bf16 v[108:111], v[20:23], a[76:79], v[108:111]
buffer_load_dwordx4 v51, s[88:91], s63 offen lds
v_and_b32 v225, 0xffff0000, v200
s_waitcnt lgkmcnt(7)
v_mfma_f32_16x16x32_bf16 v[112:115], v[28:31], a[64:67], v[112:115]
ds_read_b64_tr_b16 v[24:25], v37 offset:40960
v_lshlrev_b32 v226, 16, v201
v_mfma_f32_16x16x32_bf16 v[112:115], v[32:35], a[80:83], v[112:115]
ds_read_b64_tr_b16 v[26:27], v37 offset:41472
v_and_b32 v227, 0xffff0000, v201
v_mfma_f32_16x16x32_bf16 v[116:119], v[32:35], a[84:87], v[116:119]
ds_read_b64_tr_b16 v[20:21], v37 offset:45056
s_add_u32 m0, s98, 16384
v_mfma_f32_16x16x32_bf16 v[116:119], v[28:31], a[68:71], v[116:119]
buffer_load_dwordx4 v11, s[84:87], s62 offen offset:1024 lds
v_lshlrev_b32 v228, 16, v202
v_mfma_f32_16x16x32_bf16 v[120:123], v[28:31], a[72:75], v[120:123]
ds_read_b64_tr_b16 v[22:23], v37 offset:45568
v_and_b32 v229, 0xffff0000, v202
v_mfma_f32_16x16x32_bf16 v[120:123], v[32:35], a[88:91], v[120:123]
v_lshlrev_b32 v230, 16, v203
v_mfma_f32_16x16x32_bf16 v[124:127], v[32:35], a[92:95], v[124:127]
ds_read_b128 a[108:111], v2 offset:6144
v_and_b32 v231, 0xffff0000, v203
v_mfma_f32_16x16x32_bf16 v[124:127], v[28:31], a[76:79], v[124:127]
ds_read_b128 a[112:115], v3 offset:0
v_add_f32 v232, v208, v209
s_waitcnt lgkmcnt(7)
v_mfma_f32_16x16x32_bf16 v[128:131], v[240:243], a[64:67], v[128:131]
ds_read_b64_tr_b16 v[32:33], v38 offset:40960
v_add_f32 v234, v210, v211
v_mfma_f32_16x16x32_bf16 v[128:131], v[244:247], a[80:83], v[128:131]
ds_read_b64_tr_b16 v[34:35], v38 offset:41472
v_add_f32 v232, v232, v212
v_mfma_f32_16x16x32_bf16 v[132:135], v[244:247], a[84:87], v[132:135]
ds_read_b64_tr_b16 v[28:29], v38 offset:45056
s_add_u32 m0, s100, 20480
v_mfma_f32_16x16x32_bf16 v[132:135], v[240:243], a[68:71], v[132:135]
buffer_load_dwordx4 v52, s[88:91], s63 offen lds
v_add_f32 v234, v234, v213
v_mfma_f32_16x16x32_bf16 v[136:139], v[240:243], a[72:75], v[136:139]
ds_read_b64_tr_b16 v[30:31], v38 offset:45568
v_add_f32 v232, v232, v214
v_mfma_f32_16x16x32_bf16 v[136:139], v[244:247], a[88:91], v[136:139]
v_add_f32 v234, v234, v215
v_mfma_f32_16x16x32_bf16 v[140:143], v[244:247], a[92:95], v[140:143]
s_add_u32 m0, s100, 21504
ds_read_b128 a[116:119], v3 offset:2048
v_mfma_f32_16x16x32_bf16 v[140:143], v[240:243], a[76:79], v[140:143]
buffer_load_dwordx4 v53, s[88:91], s63 offen lds
v_add_f32 v232, v232, v216
s_waitcnt lgkmcnt(7)
v_mfma_f32_16x16x32_bf16 v[144:147], v[24:27], a[64:67], v[144:147]
ds_read_b64_tr_b16 v[244:245], v39 offset:40960
v_add_f32 v234, v234, v217
v_mfma_f32_16x16x32_bf16 v[144:147], v[20:23], a[80:83], v[144:147]
ds_read_b64_tr_b16 v[246:247], v39 offset:41472
v_add_f32 v232, v232, v218
v_mfma_f32_16x16x32_bf16 v[148:151], v[20:23], a[84:87], v[148:151]
ds_read_b64_tr_b16 v[240:241], v39 offset:45056
s_add_u32 m0, s98, 16384
v_mfma_f32_16x16x32_bf16 v[148:151], v[24:27], a[68:71], v[148:151]
buffer_load_dwordx4 v12, s[84:87], s62 offen offset:2048 lds
v_add_f32 v234, v234, v219
v_mfma_f32_16x16x32_bf16 v[152:155], v[24:27], a[72:75], v[152:155]
ds_read_b64_tr_b16 v[242:243], v39 offset:45568
v_add_f32 v232, v232, v220
v_mfma_f32_16x16x32_bf16 v[152:155], v[20:23], a[88:91], v[152:155]
v_add_f32 v234, v234, v221
v_mfma_f32_16x16x32_bf16 v[156:159], v[20:23], a[92:95], v[156:159]
ds_read_b128 a[120:123], v3 offset:4096
v_add_f32 v232, v232, v222
v_mfma_f32_16x16x32_bf16 v[156:159], v[24:27], a[76:79], v[156:159]
ds_read_b128 a[124:127], v3 offset:6144
v_add_f32 v234, v234, v223
s_waitcnt vmcnt(21) lgkmcnt(7)
s_barrier
v_mfma_f32_16x16x32_bf16 v[160:163], v[32:35], a[64:67], v[160:163]
ds_read_b64_tr_b16 v[20:21], v36 offset:49152
v_add_f32 v232, v232, v224
v_mfma_f32_16x16x32_bf16 v[160:163], v[28:31], a[80:83], v[160:163]
ds_read_b64_tr_b16 v[22:23], v36 offset:49664
v_add_f32 v234, v234, v225
v_mfma_f32_16x16x32_bf16 v[164:167], v[28:31], a[84:87], v[164:167]
ds_read_b64_tr_b16 v[24:25], v36 offset:53248
s_add_u32 m0, s100, 22528
v_mfma_f32_16x16x32_bf16 v[164:167], v[32:35], a[68:71], v[164:167]
buffer_load_dwordx4 v54, s[88:91], s63 offen lds
v_add_f32 v232, v232, v226
v_mfma_f32_16x16x32_bf16 v[168:171], v[32:35], a[72:75], v[168:171]
ds_read_b64_tr_b16 v[26:27], v36 offset:53760
v_add_f32 v234, v234, v227
v_mfma_f32_16x16x32_bf16 v[168:171], v[28:31], a[88:91], v[168:171]
v_add_f32 v232, v232, v228
v_mfma_f32_16x16x32_bf16 v[172:175], v[28:31], a[92:95], v[172:175]
s_add_u32 m0, s100, 23552
v_add_f32 v234, v234, v229
v_mfma_f32_16x16x32_bf16 v[172:175], v[32:35], a[76:79], v[172:175]
buffer_load_dwordx4 v55, s[88:91], s63 offen lds
v_add_f32 v232, v232, v230
s_waitcnt lgkmcnt(6)
v_mfma_f32_16x16x32_bf16 v[176:179], v[244:247], a[64:67], v[176:179]
ds_read_b64_tr_b16 v[28:29], v37 offset:49152
v_add_f32 v234, v234, v231
v_mfma_f32_16x16x32_bf16 v[176:179], v[240:243], a[80:83], v[176:179]
ds_read_b64_tr_b16 v[30:31], v37 offset:49664
v_add_f32 v232, v232, v234
v_mfma_f32_16x16x32_bf16 v[180:183], v[240:243], a[84:87], v[180:183]
ds_read_b64_tr_b16 v[32:33], v37 offset:53248
s_add_u32 m0, s98, 16384
v_mfma_f32_16x16x32_bf16 v[180:183], v[244:247], a[68:71], v[180:183]
buffer_load_dwordx4 v13, s[84:87], s62 offen offset:3072 lds
v_add_f32_dpp v232, v232, v232 row_ror:8 row_mask:0xf bank_mask:0xf
v_mfma_f32_16x16x32_bf16 v[184:187], v[244:247], a[72:75], v[184:187]
ds_read_b64_tr_b16 v[34:35], v37 offset:53760
v_add_f32_dpp v232, v232, v232 row_ror:4 row_mask:0xf bank_mask:0xf
v_mfma_f32_16x16x32_bf16 v[184:187], v[240:243], a[88:91], v[184:187]
s_nop 0
v_add_f32_dpp v232, v232, v232 row_ror:2 row_mask:0xf bank_mask:0xf
s_bfm_b64 exec, 12, 0
buffer_load_dword v57, v19, s[8:11], s55 offen
s_mov_b64 exec, -1
v_mfma_f32_16x16x32_bf16 v[188:191], v[240:243], a[92:95], v[188:191]
v_add_f32_dpp v232, v232, v232 row_ror:1 row_mask:0xf bank_mask:0xf
v_mfma_f32_16x16x32_bf16 v[188:191], v[244:247], a[76:79], v[188:191]
v_mov_b32 v235, v232
s_waitcnt lgkmcnt(4)
v_mfma_f32_16x16x32_bf16 v[64:67], v[20:23], a[96:99], v[64:67]
ds_read_b64_tr_b16 v[240:241], v38 offset:49152
v_permlane16_swap_b32 v232, v235
v_mfma_f32_16x16x32_bf16 v[64:67], v[24:27], a[112:115], v[64:67]
ds_read_b64_tr_b16 v[242:243], v38 offset:49664
v_add_f32 v232, v232, v235
v_mfma_f32_16x16x32_bf16 v[68:71], v[24:27], a[116:119], v[68:71]
ds_read_b64_tr_b16 v[244:245], v38 offset:53248
s_add_u32 s63, s99, 768
s_bitset0_b32 s63, 10
s_add_u32 m0, s100, 0
v_mfma_f32_16x16x32_bf16 v[68:71], v[20:23], a[100:103], v[68:71]
buffer_load_dwordx4 v48, s[88:91], s63 offen lds
v_mul_f32 v232, 0.001736111111111111, v232
v_mfma_f32_16x16x32_bf16 v[72:75], v[20:23], a[104:107], v[72:75]
ds_read_b64_tr_b16 v[246:247], v38 offset:53760
v_cvt_pk_bf16_f32 v233, v232, v232
v_mfma_f32_16x16x32_bf16 v[72:75], v[24:27], a[120:123], v[72:75]
v_lshlrev_b32 v233, 16, v233
v_mfma_f32_16x16x32_bf16 v[76:79], v[24:27], a[124:127], v[76:79]
s_add_u32 m0, s100, 1024
v_sub_f32 v232, v232, v233
v_mfma_f32_16x16x32_bf16 v[76:79], v[20:23], a[108:111], v[76:79]
buffer_load_dwordx4 v49, s[88:91], s63 offen lds
v_cndmask_b32 v233, 0, v233, s[36:37]
s_waitcnt lgkmcnt(4)
v_mfma_f32_16x16x32_bf16 v[80:83], v[28:31], a[96:99], v[80:83]
ds_read_b64_tr_b16 v[24:25], v39 offset:49152
v_sub_f32 v208, v208, v233
v_mfma_f32_16x16x32_bf16 v[80:83], v[32:35], a[112:115], v[80:83]
ds_read_b64_tr_b16 v[26:27], v39 offset:49664
v_sub_f32 v209, v209, v233
v_mfma_f32_16x16x32_bf16 v[84:87], v[32:35], a[116:119], v[84:87]
ds_read_b64_tr_b16 v[20:21], v39 offset:53248
s_add_u32 s62, s96, 3145728
s_bitset0_b32 s62, 22
s_add_u32 m0, s98, 32768
v_mfma_f32_16x16x32_bf16 v[84:87], v[28:31], a[100:103], v[84:87]
buffer_load_dwordx4 v10, s[84:87], s62 offen offset:0 lds
v_sub_f32 v210, v210, v233
v_mfma_f32_16x16x32_bf16 v[88:91], v[28:31], a[104:107], v[88:91]
ds_read_b64_tr_b16 v[22:23], v39 offset:53760
v_sub_f32 v211, v211, v233
v_mfma_f32_16x16x32_bf16 v[88:91], v[32:35], a[120:123], v[88:91]
v_sub_f32 v212, v212, v233
v_mfma_f32_16x16x32_bf16 v[92:95], v[32:35], a[124:127], v[92:95]
s_waitcnt vmcnt(17)
ds_read_b128 a[128:131], v2 offset:8192
v_mfma_f32_16x16x32_bf16 v[92:95], v[28:31], a[108:111], v[92:95]
ds_read_b128 a[132:135], v2 offset:10240
v_sub_f32 v213, v213, v233
s_waitcnt lgkmcnt(6)
v_mfma_f32_16x16x32_bf16 v[96:99], v[240:243], a[96:99], v[96:99]
ds_read_b64_tr_b16 v[32:33], v36 offset:57344
v_sub_f32 v214, v214, v233
v_mfma_f32_16x16x32_bf16 v[96:99], v[244:247], a[112:115], v[96:99]
ds_read_b64_tr_b16 v[34:35], v36 offset:57856
v_sub_f32 v215, v215, v233
v_mfma_f32_16x16x32_bf16 v[100:103], v[244:247], a[116:119], v[100:103]
ds_read_b64_tr_b16 v[28:29], v36 offset:61440
s_add_u32 m0, s100, 2048
v_mfma_f32_16x16x32_bf16 v[100:103], v[240:243], a[100:103], v[100:103]
buffer_load_dwordx4 v50, s[88:91], s63 offen lds
v_sub_f32 v216, v216, v233
v_mfma_f32_16x16x32_bf16 v[104:107], v[240:243], a[104:107], v[104:107]
ds_read_b64_tr_b16 v[30:31], v36 offset:61952
v_sub_f32 v217, v217, v233
v_mfma_f32_16x16x32_bf16 v[104:107], v[244:247], a[120:123], v[104:107]
v_sub_f32 v218, v218, v233
v_mfma_f32_16x16x32_bf16 v[108:111], v[244:247], a[124:127], v[108:111]
s_add_u32 m0, s100, 3072
ds_read_b128 a[136:139], v2 offset:12288
v_mfma_f32_16x16x32_bf16 v[108:111], v[240:243], a[108:111], v[108:111]
buffer_load_dwordx4 v51, s[88:91], s63 offen lds
v_sub_f32 v219, v219, v233
s_waitcnt lgkmcnt(7)
v_mfma_f32_16x16x32_bf16 v[112:115], v[24:27], a[96:99], v[112:115]
ds_read_b64_tr_b16 v[244:245], v37 offset:57344
v_sub_f32 v220, v220, v233
v_mfma_f32_16x16x32_bf16 v[112:115], v[20:23], a[112:115], v[112:115]
ds_read_b64_tr_b16 v[246:247], v37 offset:57856
v_sub_f32 v221, v221, v233
v_mfma_f32_16x16x32_bf16 v[116:119], v[20:23], a[116:119], v[116:119]
ds_read_b64_tr_b16 v[240:241], v37 offset:61440
s_add_u32 m0, s98, 32768
v_mfma_f32_16x16x32_bf16 v[116:119], v[24:27], a[100:103], v[116:119]
buffer_load_dwordx4 v11, s[84:87], s62 offen offset:1024 lds
v_sub_f32 v222, v222, v233
v_mfma_f32_16x16x32_bf16 v[120:123], v[24:27], a[104:107], v[120:123]
ds_read_b64_tr_b16 v[242:243], v37 offset:61952
v_sub_f32 v223, v223, v233
v_mfma_f32_16x16x32_bf16 v[120:123], v[20:23], a[120:123], v[120:123]
v_sub_f32 v224, v224, v233
v_mfma_f32_16x16x32_bf16 v[124:127], v[20:23], a[124:127], v[124:127]
ds_read_b128 a[140:143], v2 offset:14336
v_sub_f32 v225, v225, v233
v_mfma_f32_16x16x32_bf16 v[124:127], v[24:27], a[108:111], v[124:127]
ds_read_b128 a[144:147], v3 offset:8192
v_sub_f32 v226, v226, v233
s_waitcnt lgkmcnt(7)
v_mfma_f32_16x16x32_bf16 v[128:131], v[32:35], a[96:99], v[128:131]
ds_read_b64_tr_b16 v[20:21], v38 offset:57344
v_sub_f32 v227, v227, v233
v_mfma_f32_16x16x32_bf16 v[128:131], v[28:31], a[112:115], v[128:131]
ds_read_b64_tr_b16 v[22:23], v38 offset:57856
v_sub_f32 v228, v228, v233
v_mfma_f32_16x16x32_bf16 v[132:135], v[28:31], a[116:119], v[132:135]
ds_read_b64_tr_b16 v[24:25], v38 offset:61440
s_add_u32 m0, s100, 4096
v_mfma_f32_16x16x32_bf16 v[132:135], v[32:35], a[100:103], v[132:135]
buffer_load_dwordx4 v52, s[88:91], s63 offen lds
v_sub_f32 v229, v229, v233
v_mfma_f32_16x16x32_bf16 v[136:139], v[32:35], a[104:107], v[136:139]
ds_read_b64_tr_b16 v[26:27], v38 offset:61952
v_sub_f32 v230, v230, v233
v_mfma_f32_16x16x32_bf16 v[136:139], v[28:31], a[120:123], v[136:139]
v_sub_f32 v231, v231, v233
v_mfma_f32_16x16x32_bf16 v[140:143], v[28:31], a[124:127], v[140:143]
s_add_u32 m0, s100, 5120
ds_read_b128 a[148:151], v3 offset:10240
v_mfma_f32_16x16x32_bf16 v[140:143], v[32:35], a[108:111], v[140:143]
buffer_load_dwordx4 v53, s[88:91], s63 offen lds
v_mul_f32 v234, v208, v208
s_waitcnt lgkmcnt(7)
v_mfma_f32_16x16x32_bf16 v[144:147], v[244:247], a[96:99], v[144:147]
ds_read_b64_tr_b16 v[28:29], v39 offset:57344
v_mul_f32 v236, v209, v209
v_mfma_f32_16x16x32_bf16 v[144:147], v[240:243], a[112:115], v[144:147]
ds_read_b64_tr_b16 v[30:31], v39 offset:57856
v_fmac_f32 v234, v210, v210
v_mfma_f32_16x16x32_bf16 v[148:151], v[240:243], a[116:119], v[148:151]
ds_read_b64_tr_b16 v[32:33], v39 offset:61440
s_add_u32 m0, s98, 32768
v_mfma_f32_16x16x32_bf16 v[148:151], v[244:247], a[100:103], v[148:151]
buffer_load_dwordx4 v12, s[84:87], s62 offen offset:2048 lds
v_fmac_f32 v236, v211, v211
v_mfma_f32_16x16x32_bf16 v[152:155], v[244:247], a[104:107], v[152:155]
ds_read_b64_tr_b16 v[34:35], v39 offset:61952
v_fmac_f32 v234, v212, v212
v_mfma_f32_16x16x32_bf16 v[152:155], v[240:243], a[120:123], v[152:155]
v_fmac_f32 v236, v213, v213
v_mfma_f32_16x16x32_bf16 v[156:159], v[240:243], a[124:127], v[156:159]
ds_read_b128 a[152:155], v3 offset:12288
v_fmac_f32 v234, v214, v214
v_mfma_f32_16x16x32_bf16 v[156:159], v[244:247], a[108:111], v[156:159]
ds_read_b128 a[156:159], v3 offset:14336
v_fmac_f32 v236, v215, v215
s_waitcnt vmcnt(22) lgkmcnt(7)
s_barrier
v_mfma_f32_16x16x32_bf16 v[160:163], v[20:23], a[96:99], v[160:163]
ds_read_b64_tr_b16 v[240:241], v36 offset:0
v_fmac_f32 v234, v216, v216
v_mfma_f32_16x16x32_bf16 v[160:163], v[24:27], a[112:115], v[160:163]
ds_read_b64_tr_b16 v[242:243], v36 offset:512
v_fmac_f32 v236, v217, v217
v_mfma_f32_16x16x32_bf16 v[164:167], v[24:27], a[116:119], v[164:167]
ds_read_b64_tr_b16 v[244:245], v36 offset:4096
s_add_u32 m0, s100, 6144
v_mfma_f32_16x16x32_bf16 v[164:167], v[20:23], a[100:103], v[164:167]
buffer_load_dwordx4 v54, s[88:91], s63 offen lds
v_fmac_f32 v234, v218, v218
v_mfma_f32_16x16x32_bf16 v[168:171], v[20:23], a[104:107], v[168:171]
ds_read_b64_tr_b16 v[246:247], v36 offset:4608
v_fmac_f32 v236, v219, v219
v_mfma_f32_16x16x32_bf16 v[168:171], v[24:27], a[120:123], v[168:171]
v_fmac_f32 v234, v220, v220
v_mfma_f32_16x16x32_bf16 v[172:175], v[24:27], a[124:127], v[172:175]
s_add_u32 m0, s100, 7168
v_fmac_f32 v236, v221, v221
v_mfma_f32_16x16x32_bf16 v[172:175], v[20:23], a[108:111], v[172:175]
buffer_load_dwordx4 v55, s[88:91], s63 offen lds
v_fmac_f32 v234, v222, v222
s_waitcnt lgkmcnt(6)
v_mfma_f32_16x16x32_bf16 v[176:179], v[28:31], a[96:99], v[176:179]
ds_read_b64_tr_b16 v[24:25], v37 offset:0
v_fmac_f32 v236, v223, v223
v_mfma_f32_16x16x32_bf16 v[176:179], v[32:35], a[112:115], v[176:179]
ds_read_b64_tr_b16 v[26:27], v37 offset:512
v_fmac_f32 v234, v224, v224
v_mfma_f32_16x16x32_bf16 v[180:183], v[32:35], a[116:119], v[180:183]
ds_read_b64_tr_b16 v[20:21], v37 offset:4096
s_add_u32 m0, s98, 32768
v_mfma_f32_16x16x32_bf16 v[180:183], v[28:31], a[100:103], v[180:183]
buffer_load_dwordx4 v13, s[84:87], s62 offen offset:3072 lds
v_fmac_f32 v236, v225, v225
v_mfma_f32_16x16x32_bf16 v[184:187], v[28:31], a[104:107], v[184:187]
ds_read_b64_tr_b16 v[22:23], v37 offset:4608
v_fmac_f32 v234, v226, v226
v_mfma_f32_16x16x32_bf16 v[184:187], v[32:35], a[120:123], v[184:187]
v_fmac_f32 v236, v227, v227
s_bfm_b64 exec, 12, 12
buffer_load_dword v58, v19, s[8:11], s55 offen
s_mov_b64 exec, -1
v_mfma_f32_16x16x32_bf16 v[188:191], v[32:35], a[124:127], v[188:191]
v_fmac_f32 v234, v228, v228
v_mfma_f32_16x16x32_bf16 v[188:191], v[28:31], a[108:111], v[188:191]
v_fmac_f32 v236, v229, v229
s_waitcnt lgkmcnt(4)
v_mfma_f32_16x16x32_bf16 v[64:67], v[240:243], a[128:131], v[64:67]
ds_read_b64_tr_b16 v[32:33], v38 offset:0
v_fmac_f32 v234, v230, v230
v_mfma_f32_16x16x32_bf16 v[64:67], v[244:247], a[144:147], v[64:67]
ds_read_b64_tr_b16 v[34:35], v38 offset:512
v_fmac_f32 v236, v231, v231
v_mfma_f32_16x16x32_bf16 v[68:71], v[244:247], a[148:151], v[68:71]
ds_read_b64_tr_b16 v[28:29], v38 offset:4096
s_add_u32 s63, s99, 896
s_bitset0_b32 s63, 10
s_add_u32 m0, s100, 8192
v_mfma_f32_16x16x32_bf16 v[68:71], v[240:243], a[132:135], v[68:71]
buffer_load_dwordx4 v48, s[88:91], s63 offen lds
v_add_f32 v234, v234, v236
v_mfma_f32_16x16x32_bf16 v[72:75], v[240:243], a[136:139], v[72:75]
ds_read_b64_tr_b16 v[30:31], v38 offset:4608
v_add_f32_dpp v234, v234, v234 row_ror:8 row_mask:0xf bank_mask:0xf
v_mfma_f32_16x16x32_bf16 v[72:75], v[244:247], a[152:155], v[72:75]
s_nop 0
v_add_f32_dpp v234, v234, v234 row_ror:4 row_mask:0xf bank_mask:0xf
v_mfma_f32_16x16x32_bf16 v[76:79], v[244:247], a[156:159], v[76:79]
s_add_u32 m0, s100, 9216
v_add_f32_dpp v234, v234, v234 row_ror:2 row_mask:0xf bank_mask:0xf
v_mfma_f32_16x16x32_bf16 v[76:79], v[240:243], a[140:143], v[76:79]
buffer_load_dwordx4 v49, s[88:91], s63 offen lds
v_add_f32_dpp v234, v234, v234 row_ror:1 row_mask:0xf bank_mask:0xf
s_waitcnt lgkmcnt(4)
v_mfma_f32_16x16x32_bf16 v[80:83], v[24:27], a[128:131], v[80:83]
ds_read_b64_tr_b16 v[244:245], v39 offset:0
v_mov_b32 v235, v234
v_mfma_f32_16x16x32_bf16 v[80:83], v[20:23], a[144:147], v[80:83]
ds_read_b64_tr_b16 v[246:247], v39 offset:512
v_permlane16_swap_b32 v234, v235
v_mfma_f32_16x16x32_bf16 v[84:87], v[20:23], a[148:151], v[84:87]
ds_read_b64_tr_b16 v[240:241], v39 offset:4096
s_add_u32 s62, s96, 3670016
s_bitset0_b32 s62, 22
s_add_u32 m0, s98, 49152
v_mfma_f32_16x16x32_bf16 v[84:87], v[24:27], a[132:135], v[84:87]
buffer_load_dwordx4 v10, s[84:87], s62 offen offset:0 lds
v_add_f32 v234, v234, v235
v_mfma_f32_16x16x32_bf16 v[88:91], v[24:27], a[136:139], v[88:91]
ds_read_b64_tr_b16 v[242:243], v39 offset:4608
v_mul_f32 v232, v232, v232
v_mfma_f32_16x16x32_bf16 v[88:91], v[20:23], a[152:155], v[88:91]
v_mov_b32 v236, 0.001736111111111111
v_mfma_f32_16x16x32_bf16 v[92:95], v[20:23], a[156:159], v[92:95]
s_waitcnt vmcnt(18)
ds_read_b128 a[160:163], v2 offset:16384
v_mfma_f32_16x16x32_bf16 v[92:95], v[24:27], a[140:143], v[92:95]
ds_read_b128 a[164:167], v2 offset:18432
v_fma_f32 v234, v234, v236, -v232
s_waitcnt lgkmcnt(6)
v_mfma_f32_16x16x32_bf16 v[96:99], v[32:35], a[128:131], v[96:99]
ds_read_b64_tr_b16 v[20:21], v36 offset:8192
v_max_f32 v234, 0, v234
v_mfma_f32_16x16x32_bf16 v[96:99], v[28:31], a[144:147], v[96:99]
ds_read_b64_tr_b16 v[22:23], v36 offset:8704
v_cvt_pk_bf16_f32 v234, v234, v234
v_mfma_f32_16x16x32_bf16 v[100:103], v[28:31], a[148:151], v[100:103]
ds_read_b64_tr_b16 v[24:25], v36 offset:12288
s_add_u32 m0, s100, 10240
v_mfma_f32_16x16x32_bf16 v[100:103], v[32:35], a[132:135], v[100:103]
buffer_load_dwordx4 v50, s[88:91], s63 offen lds
v_lshlrev_b32 v234, 16, v234
v_mfma_f32_16x16x32_bf16 v[104:107], v[32:35], a[136:139], v[104:107]
ds_read_b64_tr_b16 v[26:27], v36 offset:12800
v_add_f32 v234, 0x3727c5ac, v234
v_mfma_f32_16x16x32_bf16 v[104:107], v[28:31], a[152:155], v[104:107]
v_cvt_pk_bf16_f32 v234, v234, v234
v_mfma_f32_16x16x32_bf16 v[108:111], v[28:31], a[156:159], v[108:111]
s_add_u32 m0, s100, 11264
ds_read_b128 a[168:171], v2 offset:20480
v_mfma_f32_16x16x32_bf16 v[108:111], v[32:35], a[140:143], v[108:111]
buffer_load_dwordx4 v51, s[88:91], s63 offen lds
v_lshlrev_b32 v234, 16, v234
s_waitcnt lgkmcnt(7)
v_mfma_f32_16x16x32_bf16 v[112:115], v[244:247], a[128:131], v[112:115]
ds_read_b64_tr_b16 v[28:29], v37 offset:8192
v_sqrt_f32 v234, v234
v_mfma_f32_16x16x32_bf16 v[112:115], v[240:243], a[144:147], v[112:115]
ds_read_b64_tr_b16 v[30:31], v37 offset:8704
v_cvt_pk_bf16_f32 v234, v234, v234
v_mfma_f32_16x16x32_bf16 v[116:119], v[240:243], a[148:151], v[116:119]
ds_read_b64_tr_b16 v[32:33], v37 offset:12288
s_add_u32 m0, s98, 49152
v_mfma_f32_16x16x32_bf16 v[116:119], v[244:247], a[132:135], v[116:119]
buffer_load_dwordx4 v11, s[84:87], s62 offen offset:1024 lds
v_lshlrev_b32 v234, 16, v234
v_mfma_f32_16x16x32_bf16 v[120:123], v[244:247], a[136:139], v[120:123]
ds_read_b64_tr_b16 v[34:35], v37 offset:12800
v_rcp_f32 v234, v234
v_mfma_f32_16x16x32_bf16 v[120:123], v[240:243], a[152:155], v[120:123]
v_cvt_pk_bf16_f32 v209, v208, v209
v_mfma_f32_16x16x32_bf16 v[124:127], v[240:243], a[156:159], v[124:127]
ds_read_b128 a[172:175], v2 offset:22528
v_cvt_pk_bf16_f32 v211, v210, v211
v_mfma_f32_16x16x32_bf16 v[124:127], v[244:247], a[140:143], v[124:127]
ds_read_b128 a[176:179], v3 offset:16384
v_cvt_pk_bf16_f32 v213, v212, v213
s_waitcnt lgkmcnt(7)
v_mfma_f32_16x16x32_bf16 v[128:131], v[20:23], a[128:131], v[128:131]
ds_read_b64_tr_b16 v[240:241], v38 offset:8192
v_cvt_pk_bf16_f32 v215, v214, v215
v_mfma_f32_16x16x32_bf16 v[128:131], v[24:27], a[144:147], v[128:131]
ds_read_b64_tr_b16 v[242:243], v38 offset:8704
v_cvt_pk_bf16_f32 v217, v216, v217
v_mfma_f32_16x16x32_bf16 v[132:135], v[24:27], a[148:151], v[132:135]
ds_read_b64_tr_b16 v[244:245], v38 offset:12288
s_add_u32 m0, s100, 12288
v_mfma_f32_16x16x32_bf16 v[132:135], v[20:23], a[132:135], v[132:135]
buffer_load_dwordx4 v52, s[88:91], s63 offen lds
v_cvt_pk_bf16_f32 v219, v218, v219
v_mfma_f32_16x16x32_bf16 v[136:139], v[20:23], a[136:139], v[136:139]
ds_read_b64_tr_b16 v[246:247], v38 offset:12800
v_cvt_pk_bf16_f32 v221, v220, v221
v_mfma_f32_16x16x32_bf16 v[136:139], v[24:27], a[152:155], v[136:139]
v_cvt_pk_bf16_f32 v223, v222, v223
v_mfma_f32_16x16x32_bf16 v[140:143], v[24:27], a[156:159], v[140:143]
s_add_u32 m0, s100, 13312
ds_read_b128 a[180:183], v3 offset:18432
v_mfma_f32_16x16x32_bf16 v[140:143], v[20:23], a[140:143], v[140:143]
buffer_load_dwordx4 v53, s[88:91], s63 offen lds
v_cvt_pk_bf16_f32 v225, v224, v225
s_waitcnt lgkmcnt(7)
v_mfma_f32_16x16x32_bf16 v[144:147], v[28:31], a[128:131], v[144:147]
ds_read_b64_tr_b16 v[24:25], v39 offset:8192
v_cvt_pk_bf16_f32 v227, v226, v227
v_mfma_f32_16x16x32_bf16 v[144:147], v[32:35], a[144:147], v[144:147]
ds_read_b64_tr_b16 v[26:27], v39 offset:8704
v_cvt_pk_bf16_f32 v229, v228, v229
v_mfma_f32_16x16x32_bf16 v[148:151], v[32:35], a[148:151], v[148:151]
ds_read_b64_tr_b16 v[20:21], v39 offset:12288
s_add_u32 m0, s98, 49152
v_mfma_f32_16x16x32_bf16 v[148:151], v[28:31], a[132:135], v[148:151]
buffer_load_dwordx4 v12, s[84:87], s62 offen offset:2048 lds
v_cvt_pk_bf16_f32 v231, v230, v231
v_mfma_f32_16x16x32_bf16 v[152:155], v[28:31], a[136:139], v[152:155]
ds_read_b64_tr_b16 v[22:23], v39 offset:12800
v_lshlrev_b32 v208, 16, v209
v_mfma_f32_16x16x32_bf16 v[152:155], v[32:35], a[152:155], v[152:155]
v_and_b32 v209, 0xffff0000, v209
v_mfma_f32_16x16x32_bf16 v[156:159], v[32:35], a[156:159], v[156:159]
ds_read_b128 a[184:187], v3 offset:20480
v_lshlrev_b32 v210, 16, v211
v_mfma_f32_16x16x32_bf16 v[156:159], v[28:31], a[140:143], v[156:159]
ds_read_b128 a[188:191], v3 offset:22528
v_and_b32 v211, 0xffff0000, v211
s_waitcnt vmcnt(23) lgkmcnt(7)
s_barrier
v_mfma_f32_16x16x32_bf16 v[160:163], v[240:243], a[128:131], v[160:163]
ds_read_b64_tr_b16 v[32:33], v36 offset:16384
v_lshlrev_b32 v212, 16, v213
v_mfma_f32_16x16x32_bf16 v[160:163], v[244:247], a[144:147], v[160:163]
ds_read_b64_tr_b16 v[34:35], v36 offset:16896
v_and_b32 v213, 0xffff0000, v213
v_mfma_f32_16x16x32_bf16 v[164:167], v[244:247], a[148:151], v[164:167]
ds_read_b64_tr_b16 v[28:29], v36 offset:20480
s_add_u32 m0, s100, 14336
v_mfma_f32_16x16x32_bf16 v[164:167], v[240:243], a[132:135], v[164:167]
buffer_load_dwordx4 v54, s[88:91], s63 offen lds
v_lshlrev_b32 v214, 16, v215
v_mfma_f32_16x16x32_bf16 v[168:171], v[240:243], a[136:139], v[168:171]
ds_read_b64_tr_b16 v[30:31], v36 offset:20992
v_and_b32 v215, 0xffff0000, v215
v_mfma_f32_16x16x32_bf16 v[168:171], v[244:247], a[152:155], v[168:171]
v_lshlrev_b32 v216, 16, v217
v_mfma_f32_16x16x32_bf16 v[172:175], v[244:247], a[156:159], v[172:175]
s_add_u32 m0, s100, 15360
v_and_b32 v217, 0xffff0000, v217
v_mfma_f32_16x16x32_bf16 v[172:175], v[240:243], a[140:143], v[172:175]
buffer_load_dwordx4 v55, s[88:91], s63 offen lds
v_lshlrev_b32 v218, 16, v219
s_waitcnt lgkmcnt(6)
v_mfma_f32_16x16x32_bf16 v[176:179], v[24:27], a[128:131], v[176:179]
ds_read_b64_tr_b16 v[244:245], v37 offset:16384
v_and_b32 v219, 0xffff0000, v219
v_mfma_f32_16x16x32_bf16 v[176:179], v[20:23], a[144:147], v[176:179]
ds_read_b64_tr_b16 v[246:247], v37 offset:16896
v_lshlrev_b32 v220, 16, v221
v_mfma_f32_16x16x32_bf16 v[180:183], v[20:23], a[148:151], v[180:183]
ds_read_b64_tr_b16 v[240:241], v37 offset:20480
s_add_u32 m0, s98, 49152
v_mfma_f32_16x16x32_bf16 v[180:183], v[24:27], a[132:135], v[180:183]
buffer_load_dwordx4 v13, s[84:87], s62 offen offset:3072 lds
v_and_b32 v221, 0xffff0000, v221
v_mfma_f32_16x16x32_bf16 v[184:187], v[24:27], a[136:139], v[184:187]
ds_read_b64_tr_b16 v[242:243], v37 offset:20992
v_lshlrev_b32 v222, 16, v223
v_mfma_f32_16x16x32_bf16 v[184:187], v[20:23], a[152:155], v[184:187]
v_and_b32 v223, 0xffff0000, v223
s_bfm_b64 exec, 12, 24
buffer_load_dword v59, v19, s[8:11], s55 offen
s_mov_b64 exec, -1
v_mfma_f32_16x16x32_bf16 v[188:191], v[20:23], a[156:159], v[188:191]
v_lshlrev_b32 v224, 16, v225
v_mfma_f32_16x16x32_bf16 v[188:191], v[24:27], a[140:143], v[188:191]
v_and_b32 v225, 0xffff0000, v225
s_waitcnt lgkmcnt(4)
v_mfma_f32_16x16x32_bf16 v[64:67], v[32:35], a[160:163], v[64:67]
ds_read_b64_tr_b16 v[20:21], v38 offset:16384
v_lshlrev_b32 v226, 16, v227
v_mfma_f32_16x16x32_bf16 v[64:67], v[28:31], a[176:179], v[64:67]
ds_read_b64_tr_b16 v[22:23], v38 offset:16896
v_and_b32 v227, 0xffff0000, v227
v_mfma_f32_16x16x32_bf16 v[68:71], v[28:31], a[180:183], v[68:71]
ds_read_b64_tr_b16 v[24:25], v38 offset:20480
s_add_u32 s62, s97, 256
s_bitset0_b32 s62, 22
s_add_u32 m0, s98, 0
v_mfma_f32_16x16x32_bf16 v[68:71], v[32:35], a[164:167], v[68:71]
buffer_load_dwordx4 v10, s[84:87], s62 offen offset:0 lds
v_lshlrev_b32 v228, 16, v229
v_mfma_f32_16x16x32_bf16 v[72:75], v[32:35], a[168:171], v[72:75]
ds_read_b64_tr_b16 v[26:27], v38 offset:20992
v_and_b32 v229, 0xffff0000, v229
v_mfma_f32_16x16x32_bf16 v[72:75], v[28:31], a[184:187], v[72:75]
v_lshlrev_b32 v230, 16, v231
v_mfma_f32_16x16x32_bf16 v[76:79], v[28:31], a[188:191], v[76:79]
v_and_b32 v231, 0xffff0000, v231
v_mfma_f32_16x16x32_bf16 v[76:79], v[32:35], a[172:175], v[76:79]
v_mul_f32 v208, v208, v234
s_waitcnt lgkmcnt(4)
v_mfma_f32_16x16x32_bf16 v[80:83], v[244:247], a[160:163], v[80:83]
ds_read_b64_tr_b16 v[48:49], v39 offset:16384
v_mul_f32 v209, v209, v234
v_mfma_f32_16x16x32_bf16 v[80:83], v[240:243], a[176:179], v[80:83]
ds_read_b64_tr_b16 v[50:51], v39 offset:16896
v_mul_f32 v210, v210, v234
v_mfma_f32_16x16x32_bf16 v[84:87], v[240:243], a[180:183], v[84:87]
ds_read_b64_tr_b16 v[52:53], v39 offset:20480
v_mul_f32 v211, v211, v234
v_mfma_f32_16x16x32_bf16 v[84:87], v[244:247], a[164:167], v[84:87]
v_mul_f32 v212, v212, v234
v_mfma_f32_16x16x32_bf16 v[88:91], v[244:247], a[168:171], v[88:91]
ds_read_b64_tr_b16 v[54:55], v39 offset:20992
v_mul_f32 v213, v213, v234
v_mfma_f32_16x16x32_bf16 v[88:91], v[240:243], a[184:187], v[88:91]
v_mul_f32 v214, v214, v234
v_mfma_f32_16x16x32_bf16 v[92:95], v[240:243], a[188:191], v[92:95]
s_waitcnt vmcnt(16)
ds_read_b128 a[192:195], v2 offset:0
v_mfma_f32_16x16x32_bf16 v[92:95], v[244:247], a[172:175], v[92:95]
ds_read_b128 a[196:199], v2 offset:2048
v_mul_f32 v215, v215, v234
s_waitcnt lgkmcnt(6)
v_mfma_f32_16x16x32_bf16 v[96:99], v[20:23], a[160:163], v[96:99]
ds_read_b64_tr_b16 v[28:29], v36 offset:24576
v_mul_f32 v216, v216, v234
v_mfma_f32_16x16x32_bf16 v[96:99], v[24:27], a[176:179], v[96:99]
ds_read_b64_tr_b16 v[30:31], v36 offset:25088
v_mul_f32 v217, v217, v234
v_mfma_f32_16x16x32_bf16 v[100:103], v[24:27], a[180:183], v[100:103]
ds_read_b64_tr_b16 v[32:33], v36 offset:28672
v_mul_f32 v218, v218, v234
v_mfma_f32_16x16x32_bf16 v[100:103], v[20:23], a[164:167], v[100:103]
buffer_load_dwordx4 v11, s[84:87], s62 offen offset:1024 lds
v_mul_f32 v219, v219, v234
v_mfma_f32_16x16x32_bf16 v[104:107], v[20:23], a[168:171], v[104:107]
ds_read_b64_tr_b16 v[34:35], v36 offset:29184
v_mul_f32 v220, v220, v234
v_mfma_f32_16x16x32_bf16 v[104:107], v[24:27], a[184:187], v[104:107]
v_mul_f32 v221, v221, v234
v_mfma_f32_16x16x32_bf16 v[108:111], v[24:27], a[188:191], v[108:111]
ds_read_b128 a[200:203], v2 offset:4096
v_mul_f32 v222, v222, v234
v_mfma_f32_16x16x32_bf16 v[108:111], v[20:23], a[172:175], v[108:111]
v_mul_f32 v223, v223, v234
s_waitcnt lgkmcnt(7)
v_mfma_f32_16x16x32_bf16 v[112:115], v[48:51], a[160:163], v[112:115]
ds_read_b64_tr_b16 v[240:241], v37 offset:24576
v_mul_f32 v224, v224, v234
v_mfma_f32_16x16x32_bf16 v[112:115], v[52:55], a[176:179], v[112:115]
ds_read_b64_tr_b16 v[242:243], v37 offset:25088
v_mul_f32 v225, v225, v234
v_mfma_f32_16x16x32_bf16 v[116:119], v[52:55], a[180:183], v[116:119]
ds_read_b64_tr_b16 v[244:245], v37 offset:28672
v_mul_f32 v226, v226, v234
v_mfma_f32_16x16x32_bf16 v[116:119], v[48:51], a[164:167], v[116:119]
v_mul_f32 v227, v227, v234
v_mfma_f32_16x16x32_bf16 v[120:123], v[48:51], a[168:171], v[120:123]
ds_read_b64_tr_b16 v[246:247], v37 offset:29184
v_mul_f32 v228, v228, v234
v_mfma_f32_16x16x32_bf16 v[120:123], v[52:55], a[184:187], v[120:123]
v_mul_f32 v229, v229, v234
v_mfma_f32_16x16x32_bf16 v[124:127], v[52:55], a[188:191], v[124:127]
ds_read_b128 a[204:207], v2 offset:6144
v_mul_f32 v230, v230, v234
v_mfma_f32_16x16x32_bf16 v[124:127], v[48:51], a[172:175], v[124:127]
ds_read_b128 a[208:211], v3 offset:0
v_mul_f32 v231, v231, v234
s_waitcnt lgkmcnt(7)
v_mfma_f32_16x16x32_bf16 v[128:131], v[28:31], a[160:163], v[128:131]
ds_read_b64_tr_b16 v[24:25], v38 offset:24576
v_cvt_pk_bf16_f32 v208, v208, v209
v_mfma_f32_16x16x32_bf16 v[128:131], v[32:35], a[176:179], v[128:131]
ds_read_b64_tr_b16 v[26:27], v38 offset:25088
v_cvt_pk_bf16_f32 v209, v210, v211
v_mfma_f32_16x16x32_bf16 v[132:135], v[32:35], a[180:183], v[132:135]
ds_read_b64_tr_b16 v[20:21], v38 offset:28672
v_cvt_pk_bf16_f32 v210, v212, v213
v_mfma_f32_16x16x32_bf16 v[132:135], v[28:31], a[164:167], v[132:135]
buffer_load_dwordx4 v12, s[84:87], s62 offen offset:2048 lds
v_cvt_pk_bf16_f32 v211, v214, v215
v_mfma_f32_16x16x32_bf16 v[136:139], v[28:31], a[168:171], v[136:139]
ds_read_b64_tr_b16 v[22:23], v38 offset:29184
v_cvt_pk_bf16_f32 v212, v216, v217
v_mfma_f32_16x16x32_bf16 v[136:139], v[32:35], a[184:187], v[136:139]
v_cvt_pk_bf16_f32 v213, v218, v219
v_mfma_f32_16x16x32_bf16 v[140:143], v[32:35], a[188:191], v[140:143]
ds_read_b128 a[212:215], v3 offset:2048
v_cvt_pk_bf16_f32 v214, v220, v221
v_mfma_f32_16x16x32_bf16 v[140:143], v[28:31], a[172:175], v[140:143]
v_cvt_pk_bf16_f32 v215, v222, v223
s_waitcnt lgkmcnt(7)
v_mfma_f32_16x16x32_bf16 v[144:147], v[240:243], a[160:163], v[144:147]
ds_read_b64_tr_b16 v[52:53], v39 offset:24576
v_cvt_pk_bf16_f32 v216, v224, v225
v_mfma_f32_16x16x32_bf16 v[144:147], v[244:247], a[176:179], v[144:147]
ds_read_b64_tr_b16 v[54:55], v39 offset:25088
v_cvt_pk_bf16_f32 v217, v226, v227
v_mfma_f32_16x16x32_bf16 v[148:151], v[244:247], a[180:183], v[148:151]
ds_read_b64_tr_b16 v[48:49], v39 offset:28672
v_cvt_pk_bf16_f32 v218, v228, v229
v_mfma_f32_16x16x32_bf16 v[148:151], v[240:243], a[164:167], v[148:151]
v_cvt_pk_bf16_f32 v219, v230, v231
v_mfma_f32_16x16x32_bf16 v[152:155], v[240:243], a[168:171], v[152:155]
ds_read_b64_tr_b16 v[50:51], v39 offset:29184
buffer_store_dwordx4 v[208:211], v4, s[12:15], s38 offen sc1
v_mfma_f32_16x16x32_bf16 v[152:155], v[244:247], a[184:187], v[152:155]
buffer_store_dwordx4 v[212:215], v4, s[12:15], s39 offen sc1
v_mfma_f32_16x16x32_bf16 v[156:159], v[244:247], a[188:191], v[156:159]
ds_read_b128 a[216:219], v3 offset:4096
buffer_store_dwordx4 v[216:219], v4, s[12:15], s40 offen sc1
v_mfma_f32_16x16x32_bf16 v[156:159], v[240:243], a[172:175], v[156:159]
ds_read_b128 a[220:223], v3 offset:6144
s_waitcnt vmcnt(20) lgkmcnt(7)
s_barrier
v_mfma_f32_16x16x32_bf16 v[160:163], v[24:27], a[160:163], v[160:163]
ds_read_b64_tr_b16 v[32:33], v36 offset:32768
v_mfma_f32_16x16x32_bf16 v[160:163], v[20:23], a[176:179], v[160:163]
ds_read_b64_tr_b16 v[34:35], v36 offset:33280
v_mfma_f32_16x16x32_bf16 v[164:167], v[20:23], a[180:183], v[164:167]
ds_read_b64_tr_b16 v[28:29], v36 offset:36864
v_mfma_f32_16x16x32_bf16 v[164:167], v[24:27], a[164:167], v[164:167]
buffer_load_dwordx4 v13, s[84:87], s62 offen offset:3072 lds
v_mfma_f32_16x16x32_bf16 v[168:171], v[24:27], a[168:171], v[168:171]
ds_read_b64_tr_b16 v[30:31], v36 offset:37376
v_mfma_f32_16x16x32_bf16 v[168:171], v[20:23], a[184:187], v[168:171]
v_mfma_f32_16x16x32_bf16 v[172:175], v[20:23], a[188:191], v[172:175]
v_mfma_f32_16x16x32_bf16 v[172:175], v[24:27], a[172:175], v[172:175]
s_waitcnt lgkmcnt(6)
v_mfma_f32_16x16x32_bf16 v[176:179], v[52:55], a[160:163], v[176:179]
ds_read_b64_tr_b16 v[244:245], v37 offset:32768
v_mfma_f32_16x16x32_bf16 v[176:179], v[48:51], a[176:179], v[176:179]
ds_read_b64_tr_b16 v[246:247], v37 offset:33280
v_mfma_f32_16x16x32_bf16 v[180:183], v[48:51], a[180:183], v[180:183]
ds_read_b64_tr_b16 v[240:241], v37 offset:36864
v_mfma_f32_16x16x32_bf16 v[180:183], v[52:55], a[164:167], v[180:183]
v_mfma_f32_16x16x32_bf16 v[184:187], v[52:55], a[168:171], v[184:187]
ds_read_b64_tr_b16 v[242:243], v37 offset:37376
v_mfma_f32_16x16x32_bf16 v[184:187], v[48:51], a[184:187], v[184:187]
v_mfma_f32_16x16x32_bf16 v[188:191], v[48:51], a[188:191], v[188:191]
v_mfma_f32_16x16x32_bf16 v[188:191], v[52:55], a[172:175], v[188:191]
s_waitcnt lgkmcnt(4)
v_mfma_f32_16x16x32_bf16 v[64:67], v[32:35], a[192:195], v[64:67]
ds_read_b64_tr_b16 v[20:21], v38 offset:32768
v_mfma_f32_16x16x32_bf16 v[64:67], v[28:31], a[208:211], v[64:67]
ds_read_b64_tr_b16 v[22:23], v38 offset:33280
v_mfma_f32_16x16x32_bf16 v[68:71], v[28:31], a[212:215], v[68:71]
ds_read_b64_tr_b16 v[24:25], v38 offset:36864
s_add_u32 s62, s97, 1048832
s_bitset0_b32 s62, 22
s_add_u32 m0, s98, 16384
v_mfma_f32_16x16x32_bf16 v[68:71], v[32:35], a[196:199], v[68:71]
buffer_load_dwordx4 v10, s[84:87], s62 offen offset:0 lds
v_mfma_f32_16x16x32_bf16 v[72:75], v[32:35], a[200:203], v[72:75]
ds_read_b64_tr_b16 v[26:27], v38 offset:37376
v_mfma_f32_16x16x32_bf16 v[72:75], v[28:31], a[216:219], v[72:75]
v_mfma_f32_16x16x32_bf16 v[76:79], v[28:31], a[220:223], v[76:79]
v_mfma_f32_16x16x32_bf16 v[76:79], v[32:35], a[204:207], v[76:79]
s_waitcnt lgkmcnt(4)
v_mfma_f32_16x16x32_bf16 v[80:83], v[244:247], a[192:195], v[80:83]
ds_read_b64_tr_b16 v[48:49], v39 offset:32768
v_mfma_f32_16x16x32_bf16 v[80:83], v[240:243], a[208:211], v[80:83]
ds_read_b64_tr_b16 v[50:51], v39 offset:33280
v_mfma_f32_16x16x32_bf16 v[84:87], v[240:243], a[212:215], v[84:87]
ds_read_b64_tr_b16 v[52:53], v39 offset:36864
v_mfma_f32_16x16x32_bf16 v[84:87], v[244:247], a[196:199], v[84:87]
v_mfma_f32_16x16x32_bf16 v[88:91], v[244:247], a[200:203], v[88:91]
ds_read_b64_tr_b16 v[54:55], v39 offset:37376
v_mfma_f32_16x16x32_bf16 v[88:91], v[240:243], a[216:219], v[88:91]
v_mfma_f32_16x16x32_bf16 v[92:95], v[240:243], a[220:223], v[92:95]
s_waitcnt vmcnt(10)
ds_read_b128 a[224:227], v2 offset:8192
v_mfma_f32_16x16x32_bf16 v[92:95], v[244:247], a[204:207], v[92:95]
ds_read_b128 a[228:231], v2 offset:10240
s_waitcnt lgkmcnt(6)
v_mfma_f32_16x16x32_bf16 v[96:99], v[20:23], a[192:195], v[96:99]
ds_read_b64_tr_b16 v[28:29], v36 offset:40960
v_mfma_f32_16x16x32_bf16 v[96:99], v[24:27], a[208:211], v[96:99]
ds_read_b64_tr_b16 v[30:31], v36 offset:41472
v_mfma_f32_16x16x32_bf16 v[100:103], v[24:27], a[212:215], v[100:103]
ds_read_b64_tr_b16 v[32:33], v36 offset:45056
v_mfma_f32_16x16x32_bf16 v[100:103], v[20:23], a[196:199], v[100:103]
buffer_load_dwordx4 v11, s[84:87], s62 offen offset:1024 lds
v_mfma_f32_16x16x32_bf16 v[104:107], v[20:23], a[200:203], v[104:107]
ds_read_b64_tr_b16 v[34:35], v36 offset:45568
v_mfma_f32_16x16x32_bf16 v[104:107], v[24:27], a[216:219], v[104:107]
v_mfma_f32_16x16x32_bf16 v[108:111], v[24:27], a[220:223], v[108:111]
ds_read_b128 a[232:235], v2 offset:12288
v_mfma_f32_16x16x32_bf16 v[108:111], v[20:23], a[204:207], v[108:111]
s_waitcnt lgkmcnt(7)
v_mfma_f32_16x16x32_bf16 v[112:115], v[48:51], a[192:195], v[112:115]
ds_read_b64_tr_b16 v[240:241], v37 offset:40960
v_mfma_f32_16x16x32_bf16 v[112:115], v[52:55], a[208:211], v[112:115]
ds_read_b64_tr_b16 v[242:243], v37 offset:41472
v_mfma_f32_16x16x32_bf16 v[116:119], v[52:55], a[212:215], v[116:119]
ds_read_b64_tr_b16 v[244:245], v37 offset:45056
v_mfma_f32_16x16x32_bf16 v[116:119], v[48:51], a[196:199], v[116:119]
v_mfma_f32_16x16x32_bf16 v[120:123], v[48:51], a[200:203], v[120:123]
ds_read_b64_tr_b16 v[246:247], v37 offset:45568
v_mfma_f32_16x16x32_bf16 v[120:123], v[52:55], a[216:219], v[120:123]
v_mfma_f32_16x16x32_bf16 v[124:127], v[52:55], a[220:223], v[124:127]
ds_read_b128 a[236:239], v2 offset:14336
v_mfma_f32_16x16x32_bf16 v[124:127], v[48:51], a[204:207], v[124:127]
ds_read_b128 a[240:243], v3 offset:8192
s_waitcnt lgkmcnt(7)
v_mfma_f32_16x16x32_bf16 v[128:131], v[28:31], a[192:195], v[128:131]
ds_read_b64_tr_b16 v[24:25], v38 offset:40960
v_mfma_f32_16x16x32_bf16 v[128:131], v[32:35], a[208:211], v[128:131]
ds_read_b64_tr_b16 v[26:27], v38 offset:41472
v_mfma_f32_16x16x32_bf16 v[132:135], v[32:35], a[212:215], v[132:135]
ds_read_b64_tr_b16 v[20:21], v38 offset:45056
v_mfma_f32_16x16x32_bf16 v[132:135], v[28:31], a[196:199], v[132:135]
buffer_load_dwordx4 v12, s[84:87], s62 offen offset:2048 lds
v_mfma_f32_16x16x32_bf16 v[136:139], v[28:31], a[200:203], v[136:139]
ds_read_b64_tr_b16 v[22:23], v38 offset:45568
v_mfma_f32_16x16x32_bf16 v[136:139], v[32:35], a[216:219], v[136:139]
v_mfma_f32_16x16x32_bf16 v[140:143], v[32:35], a[220:223], v[140:143]
ds_read_b128 a[244:247], v3 offset:10240
v_mfma_f32_16x16x32_bf16 v[140:143], v[28:31], a[204:207], v[140:143]
s_waitcnt lgkmcnt(7)
v_mfma_f32_16x16x32_bf16 v[144:147], v[240:243], a[192:195], v[144:147]
ds_read_b64_tr_b16 v[52:53], v39 offset:40960
v_mfma_f32_16x16x32_bf16 v[144:147], v[244:247], a[208:211], v[144:147]
ds_read_b64_tr_b16 v[54:55], v39 offset:41472
v_mfma_f32_16x16x32_bf16 v[148:151], v[244:247], a[212:215], v[148:151]
ds_read_b64_tr_b16 v[48:49], v39 offset:45056
v_mfma_f32_16x16x32_bf16 v[148:151], v[240:243], a[196:199], v[148:151]
v_mfma_f32_16x16x32_bf16 v[152:155], v[240:243], a[200:203], v[152:155]
ds_read_b64_tr_b16 v[50:51], v39 offset:45568
v_mfma_f32_16x16x32_bf16 v[152:155], v[244:247], a[216:219], v[152:155]
v_mfma_f32_16x16x32_bf16 v[156:159], v[244:247], a[220:223], v[156:159]
ds_read_b128 a[248:251], v3 offset:12288
v_mfma_f32_16x16x32_bf16 v[156:159], v[240:243], a[204:207], v[156:159]
ds_read_b128 a[252:255], v3 offset:14336
s_waitcnt vmcnt(11) lgkmcnt(7)
s_barrier
v_mfma_f32_16x16x32_bf16 v[160:163], v[24:27], a[192:195], v[160:163]
ds_read_b64_tr_b16 v[32:33], v36 offset:49152
v_mfma_f32_16x16x32_bf16 v[160:163], v[20:23], a[208:211], v[160:163]
ds_read_b64_tr_b16 v[34:35], v36 offset:49664
v_mfma_f32_16x16x32_bf16 v[164:167], v[20:23], a[212:215], v[164:167]
ds_read_b64_tr_b16 v[28:29], v36 offset:53248
v_mfma_f32_16x16x32_bf16 v[164:167], v[24:27], a[196:199], v[164:167]
buffer_load_dwordx4 v13, s[84:87], s62 offen offset:3072 lds
v_mfma_f32_16x16x32_bf16 v[168:171], v[24:27], a[200:203], v[168:171]
ds_read_b64_tr_b16 v[30:31], v36 offset:53760
v_mfma_f32_16x16x32_bf16 v[168:171], v[20:23], a[216:219], v[168:171]
v_mfma_f32_16x16x32_bf16 v[172:175], v[20:23], a[220:223], v[172:175]
v_mfma_f32_16x16x32_bf16 v[172:175], v[24:27], a[204:207], v[172:175]
s_waitcnt lgkmcnt(6)
v_mfma_f32_16x16x32_bf16 v[176:179], v[52:55], a[192:195], v[176:179]
ds_read_b64_tr_b16 v[244:245], v37 offset:49152
v_mfma_f32_16x16x32_bf16 v[176:179], v[48:51], a[208:211], v[176:179]
ds_read_b64_tr_b16 v[246:247], v37 offset:49664
v_mfma_f32_16x16x32_bf16 v[180:183], v[48:51], a[212:215], v[180:183]
ds_read_b64_tr_b16 v[240:241], v37 offset:53248
v_mfma_f32_16x16x32_bf16 v[180:183], v[52:55], a[196:199], v[180:183]
v_mfma_f32_16x16x32_bf16 v[184:187], v[52:55], a[200:203], v[184:187]
ds_read_b64_tr_b16 v[242:243], v37 offset:53760
v_mfma_f32_16x16x32_bf16 v[184:187], v[48:51], a[216:219], v[184:187]
v_mfma_f32_16x16x32_bf16 v[188:191], v[48:51], a[220:223], v[188:191]
v_mfma_f32_16x16x32_bf16 v[188:191], v[52:55], a[204:207], v[188:191]
s_waitcnt lgkmcnt(4)
v_mfma_f32_16x16x32_bf16 v[64:67], v[32:35], a[224:227], v[64:67]
ds_read_b64_tr_b16 v[20:21], v38 offset:49152
v_mfma_f32_16x16x32_bf16 v[64:67], v[28:31], a[240:243], v[64:67]
ds_read_b64_tr_b16 v[22:23], v38 offset:49664
v_mfma_f32_16x16x32_bf16 v[68:71], v[28:31], a[244:247], v[68:71]
ds_read_b64_tr_b16 v[24:25], v38 offset:53248
s_add_u32 s62, s97, 2097408
s_bitset0_b32 s62, 22
s_add_u32 m0, s98, 32768
v_mfma_f32_16x16x32_bf16 v[68:71], v[32:35], a[228:231], v[68:71]
buffer_load_dwordx4 v10, s[84:87], s62 offen offset:0 lds
v_mfma_f32_16x16x32_bf16 v[72:75], v[32:35], a[232:235], v[72:75]
ds_read_b64_tr_b16 v[26:27], v38 offset:53760
v_mfma_f32_16x16x32_bf16 v[72:75], v[28:31], a[248:251], v[72:75]
v_mfma_f32_16x16x32_bf16 v[76:79], v[28:31], a[252:255], v[76:79]
v_mfma_f32_16x16x32_bf16 v[76:79], v[32:35], a[236:239], v[76:79]
s_waitcnt lgkmcnt(4)
v_mfma_f32_16x16x32_bf16 v[80:83], v[244:247], a[224:227], v[80:83]
ds_read_b64_tr_b16 v[48:49], v39 offset:49152
v_mfma_f32_16x16x32_bf16 v[80:83], v[240:243], a[240:243], v[80:83]
ds_read_b64_tr_b16 v[50:51], v39 offset:49664
v_mfma_f32_16x16x32_bf16 v[84:87], v[240:243], a[244:247], v[84:87]
ds_read_b64_tr_b16 v[52:53], v39 offset:53248
v_mfma_f32_16x16x32_bf16 v[84:87], v[244:247], a[228:231], v[84:87]
v_mfma_f32_16x16x32_bf16 v[88:91], v[244:247], a[232:235], v[88:91]
ds_read_b64_tr_b16 v[54:55], v39 offset:53760
v_mfma_f32_16x16x32_bf16 v[88:91], v[240:243], a[248:251], v[88:91]
v_mfma_f32_16x16x32_bf16 v[92:95], v[240:243], a[252:255], v[92:95]
v_mfma_f32_16x16x32_bf16 v[92:95], v[244:247], a[236:239], v[92:95]
s_waitcnt lgkmcnt(4)
v_mfma_f32_16x16x32_bf16 v[96:99], v[20:23], a[224:227], v[96:99]
ds_read_b64_tr_b16 v[28:29], v36 offset:57344
v_mfma_f32_16x16x32_bf16 v[96:99], v[24:27], a[240:243], v[96:99]
ds_read_b64_tr_b16 v[30:31], v36 offset:57856
v_mfma_f32_16x16x32_bf16 v[100:103], v[24:27], a[244:247], v[100:103]
ds_read_b64_tr_b16 v[32:33], v36 offset:61440
v_mfma_f32_16x16x32_bf16 v[100:103], v[20:23], a[228:231], v[100:103]
buffer_load_dwordx4 v11, s[84:87], s62 offen offset:1024 lds
v_mfma_f32_16x16x32_bf16 v[104:107], v[20:23], a[232:235], v[104:107]
ds_read_b64_tr_b16 v[34:35], v36 offset:61952
v_mfma_f32_16x16x32_bf16 v[104:107], v[24:27], a[248:251], v[104:107]
v_mfma_f32_16x16x32_bf16 v[108:111], v[24:27], a[252:255], v[108:111]
v_mfma_f32_16x16x32_bf16 v[108:111], v[20:23], a[236:239], v[108:111]
s_waitcnt lgkmcnt(4)
v_mfma_f32_16x16x32_bf16 v[112:115], v[48:51], a[224:227], v[112:115]
ds_read_b64_tr_b16 v[240:241], v37 offset:57344
v_mfma_f32_16x16x32_bf16 v[112:115], v[52:55], a[240:243], v[112:115]
ds_read_b64_tr_b16 v[242:243], v37 offset:57856
v_mfma_f32_16x16x32_bf16 v[116:119], v[52:55], a[244:247], v[116:119]
ds_read_b64_tr_b16 v[244:245], v37 offset:61440
v_mfma_f32_16x16x32_bf16 v[116:119], v[48:51], a[228:231], v[116:119]
v_mfma_f32_16x16x32_bf16 v[120:123], v[48:51], a[232:235], v[120:123]
ds_read_b64_tr_b16 v[246:247], v37 offset:61952
v_mfma_f32_16x16x32_bf16 v[120:123], v[52:55], a[248:251], v[120:123]
v_mfma_f32_16x16x32_bf16 v[124:127], v[52:55], a[252:255], v[124:127]
v_mfma_f32_16x16x32_bf16 v[124:127], v[48:51], a[236:239], v[124:127]
s_waitcnt lgkmcnt(4)
v_mfma_f32_16x16x32_bf16 v[128:131], v[28:31], a[224:227], v[128:131]
ds_read_b64_tr_b16 v[24:25], v38 offset:57344
v_mfma_f32_16x16x32_bf16 v[128:131], v[32:35], a[240:243], v[128:131]
ds_read_b64_tr_b16 v[26:27], v38 offset:57856
v_mfma_f32_16x16x32_bf16 v[132:135], v[32:35], a[244:247], v[132:135]
ds_read_b64_tr_b16 v[20:21], v38 offset:61440
v_mfma_f32_16x16x32_bf16 v[132:135], v[28:31], a[228:231], v[132:135]
buffer_load_dwordx4 v12, s[84:87], s62 offen offset:2048 lds
v_mfma_f32_16x16x32_bf16 v[136:139], v[28:31], a[232:235], v[136:139]
ds_read_b64_tr_b16 v[22:23], v38 offset:61952
v_pk_mul_f32 v[64:65], v[64:65], s[34:35]
v_mfma_f32_16x16x32_bf16 v[136:139], v[32:35], a[248:251], v[136:139]
v_pk_mul_f32 v[66:67], v[66:67], s[34:35]
v_pk_mul_f32 v[80:81], v[80:81], s[34:35]
v_mfma_f32_16x16x32_bf16 v[140:143], v[32:35], a[252:255], v[140:143]
v_pk_mul_f32 v[82:83], v[82:83], s[34:35]
v_cvt_pk_bf16_f32 v64, v64, v65
v_mfma_f32_16x16x32_bf16 v[140:143], v[28:31], a[236:239], v[140:143]
v_cvt_pk_bf16_f32 v65, v66, v67
v_cvt_pk_bf16_f32 v66, v80, v81
s_waitcnt lgkmcnt(4)
v_mfma_f32_16x16x32_bf16 v[144:147], v[240:243], a[224:227], v[144:147]
ds_read_b64_tr_b16 v[52:53], v39 offset:57344
v_cvt_pk_bf16_f32 v67, v82, v83
v_mfma_f32_16x16x32_bf16 v[144:147], v[244:247], a[240:243], v[144:147]
ds_read_b64_tr_b16 v[54:55], v39 offset:57856
s_add_u32 s61, s101, 0
v_mfma_f32_16x16x32_bf16 v[148:151], v[244:247], a[244:247], v[148:151]
ds_read_b64_tr_b16 v[48:49], v39 offset:61440
buffer_store_dwordx4 v[64:67], v1, s[12:15], s61 offen offset:0 sc1
v_mfma_f32_16x16x32_bf16 v[148:151], v[240:243], a[228:231], v[148:151]
v_mfma_f32_16x16x32_bf16 v[152:155], v[240:243], a[232:235], v[152:155]
ds_read_b64_tr_b16 v[50:51], v39 offset:61952
v_mfma_f32_16x16x32_bf16 v[152:155], v[244:247], a[248:251], v[152:155]
v_mfma_f32_16x16x32_bf16 v[156:159], v[244:247], a[252:255], v[156:159]
v_mfma_f32_16x16x32_bf16 v[156:159], v[240:243], a[236:239], v[156:159]
s_waitcnt vmcnt(8) lgkmcnt(4)
s_barrier
v_mfma_f32_16x16x32_bf16 v[160:163], v[24:27], a[224:227], v[160:163]
ds_read_b64_tr_b16 v[32:33], v36 offset:0
v_mfma_f32_16x16x32_bf16 v[160:163], v[20:23], a[240:243], v[160:163]
ds_read_b64_tr_b16 v[34:35], v36 offset:512
v_mfma_f32_16x16x32_bf16 v[164:167], v[20:23], a[244:247], v[164:167]
ds_read_b64_tr_b16 v[28:29], v36 offset:4096
v_mfma_f32_16x16x32_bf16 v[164:167], v[24:27], a[228:231], v[164:167]
buffer_load_dwordx4 v13, s[84:87], s62 offen offset:3072 lds
v_mfma_f32_16x16x32_bf16 v[168:171], v[24:27], a[232:235], v[168:171]
ds_read_b64_tr_b16 v[30:31], v36 offset:4608
v_pk_mul_f32 v[68:69], v[68:69], s[34:35]
v_mfma_f32_16x16x32_bf16 v[168:171], v[20:23], a[248:251], v[168:171]
v_pk_mul_f32 v[70:71], v[70:71], s[34:35]
v_pk_mul_f32 v[84:85], v[84:85], s[34:35]
v_mfma_f32_16x16x32_bf16 v[172:175], v[20:23], a[252:255], v[172:175]
v_pk_mul_f32 v[86:87], v[86:87], s[34:35]
v_cvt_pk_bf16_f32 v68, v68, v69
v_mfma_f32_16x16x32_bf16 v[172:175], v[24:27], a[236:239], v[172:175]
v_cvt_pk_bf16_f32 v69, v70, v71
v_cvt_pk_bf16_f32 v70, v84, v85
s_waitcnt lgkmcnt(4)
v_mfma_f32_16x16x32_bf16 v[176:179], v[52:55], a[224:227], v[176:179]
ds_read_b64_tr_b16 v[20:21], v37 offset:0
v_cvt_pk_bf16_f32 v71, v86, v87
v_mfma_f32_16x16x32_bf16 v[176:179], v[48:51], a[240:243], v[176:179]
ds_read_b64_tr_b16 v[22:23], v37 offset:512
s_add_u32 s61, s101, 4096
v_mfma_f32_16x16x32_bf16 v[180:183], v[48:51], a[244:247], v[180:183]
ds_read_b64_tr_b16 v[24:25], v37 offset:4096
buffer_store_dwordx4 v[68:71], v1, s[12:15], s61 offen offset:0 sc1
v_mfma_f32_16x16x32_bf16 v[180:183], v[52:55], a[228:231], v[180:183]
v_mfma_f32_16x16x32_bf16 v[184:187], v[52:55], a[232:235], v[184:187]
ds_read_b64_tr_b16 v[26:27], v37 offset:4608
v_mfma_f32_16x16x32_bf16 v[184:187], v[48:51], a[248:251], v[184:187]
v_mfma_f32_16x16x32_bf16 v[188:191], v[48:51], a[252:255], v[188:191]
v_mfma_f32_16x16x32_bf16 v[188:191], v[52:55], a[236:239], v[188:191]
s_waitcnt lgkmcnt(4)
v_mfma_f32_16x16x32_bf16 v[192:195], v[32:35], a[0:3], 0
ds_read_b64_tr_b16 v[48:49], v38 offset:0
v_mfma_f32_16x16x32_bf16 v[192:195], v[28:31], a[16:19], v[192:195]
ds_read_b64_tr_b16 v[50:51], v38 offset:512
v_mfma_f32_16x16x32_bf16 v[196:199], v[28:31], a[20:23], 0
ds_read_b64_tr_b16 v[52:53], v38 offset:4096
s_add_u32 s62, s97, 3145984
s_bitset0_b32 s62, 22
s_add_u32 m0, s98, 49152
v_mfma_f32_16x16x32_bf16 v[196:199], v[32:35], a[4:7], v[196:199]
buffer_load_dwordx4 v10, s[84:87], s62 offen offset:0 lds
v_mfma_f32_16x16x32_bf16 v[200:203], v[32:35], a[8:11], 0
ds_read_b64_tr_b16 v[54:55], v38 offset:4608
v_pk_mul_f32 v[72:73], v[72:73], s[34:35]
v_mfma_f32_16x16x32_bf16 v[200:203], v[28:31], a[24:27], v[200:203]
v_pk_mul_f32 v[74:75], v[74:75], s[34:35]
v_pk_mul_f32 v[88:89], v[88:89], s[34:35]
v_mfma_f32_16x16x32_bf16 v[204:207], v[28:31], a[28:31], 0
v_pk_mul_f32 v[90:91], v[90:91], s[34:35]
v_cvt_pk_bf16_f32 v72, v72, v73
v_mfma_f32_16x16x32_bf16 v[204:207], v[32:35], a[12:15], v[204:207]
v_cvt_pk_bf16_f32 v73, v74, v75
v_cvt_pk_bf16_f32 v74, v88, v89
s_waitcnt lgkmcnt(4)
v_mfma_f32_16x16x32_bf16 v[208:211], v[20:23], a[0:3], 0
ds_read_b64_tr_b16 v[28:29], v39 offset:0
v_cvt_pk_bf16_f32 v75, v90, v91
v_mfma_f32_16x16x32_bf16 v[208:211], v[24:27], a[16:19], v[208:211]
ds_read_b64_tr_b16 v[30:31], v39 offset:512
s_add_u32 s61, s101, 8192
v_mfma_f32_16x16x32_bf16 v[212:215], v[24:27], a[20:23], 0
ds_read_b64_tr_b16 v[32:33], v39 offset:4096
buffer_store_dwordx4 v[72:75], v1, s[12:15], s61 offen offset:0 sc1
v_mfma_f32_16x16x32_bf16 v[212:215], v[20:23], a[4:7], v[212:215]
v_mfma_f32_16x16x32_bf16 v[216:219], v[20:23], a[8:11], 0
ds_read_b64_tr_b16 v[34:35], v39 offset:4608
v_mfma_f32_16x16x32_bf16 v[216:219], v[24:27], a[24:27], v[216:219]
v_mfma_f32_16x16x32_bf16 v[220:223], v[24:27], a[28:31], 0
v_mfma_f32_16x16x32_bf16 v[220:223], v[20:23], a[12:15], v[220:223]
s_waitcnt lgkmcnt(4)
v_mfma_f32_16x16x32_bf16 v[224:227], v[48:51], a[0:3], 0
ds_read_b64_tr_b16 v[24:25], v36 offset:8192
v_mfma_f32_16x16x32_bf16 v[224:227], v[52:55], a[16:19], v[224:227]
ds_read_b64_tr_b16 v[26:27], v36 offset:8704
v_mfma_f32_16x16x32_bf16 v[228:231], v[52:55], a[20:23], 0
ds_read_b64_tr_b16 v[20:21], v36 offset:12288
v_mfma_f32_16x16x32_bf16 v[228:231], v[48:51], a[4:7], v[228:231]
buffer_load_dwordx4 v11, s[84:87], s62 offen offset:1024 lds
v_mfma_f32_16x16x32_bf16 v[232:235], v[48:51], a[8:11], 0
ds_read_b64_tr_b16 v[22:23], v36 offset:12800
v_pk_mul_f32 v[76:77], v[76:77], s[34:35]
v_mfma_f32_16x16x32_bf16 v[232:235], v[52:55], a[24:27], v[232:235]
v_pk_mul_f32 v[78:79], v[78:79], s[34:35]
v_pk_mul_f32 v[92:93], v[92:93], s[34:35]
v_mfma_f32_16x16x32_bf16 v[236:239], v[52:55], a[28:31], 0
v_pk_mul_f32 v[94:95], v[94:95], s[34:35]
v_cvt_pk_bf16_f32 v76, v76, v77
v_mfma_f32_16x16x32_bf16 v[236:239], v[48:51], a[12:15], v[236:239]
v_cvt_pk_bf16_f32 v77, v78, v79
v_cvt_pk_bf16_f32 v78, v92, v93
s_waitcnt lgkmcnt(4)
v_mfma_f32_16x16x32_bf16 v[240:243], v[28:31], a[0:3], 0
ds_read_b64_tr_b16 v[52:53], v37 offset:8192
v_cvt_pk_bf16_f32 v79, v94, v95
v_mfma_f32_16x16x32_bf16 v[240:243], v[32:35], a[16:19], v[240:243]
ds_read_b64_tr_b16 v[54:55], v37 offset:8704
s_add_u32 s61, s101, 12288
v_mfma_f32_16x16x32_bf16 v[244:247], v[32:35], a[20:23], 0
ds_read_b64_tr_b16 v[48:49], v37 offset:12288
buffer_store_dwordx4 v[76:79], v1, s[12:15], s61 offen offset:0 sc1
v_mfma_f32_16x16x32_bf16 v[244:247], v[28:31], a[4:7], v[244:247]
v_mfma_f32_16x16x32_bf16 v[248:251], v[28:31], a[8:11], 0
ds_read_b64_tr_b16 v[50:51], v37 offset:12800
v_mfma_f32_16x16x32_bf16 v[248:251], v[32:35], a[24:27], v[248:251]
v_mfma_f32_16x16x32_bf16 v[252:255], v[32:35], a[28:31], 0
v_mfma_f32_16x16x32_bf16 v[252:255], v[28:31], a[12:15], v[252:255]
s_waitcnt lgkmcnt(4)
v_mfma_f32_16x16x32_bf16 v[192:195], v[24:27], a[32:35], v[192:195]
ds_read_b64_tr_b16 v[32:33], v38 offset:8192
v_mfma_f32_16x16x32_bf16 v[192:195], v[20:23], a[48:51], v[192:195]
ds_read_b64_tr_b16 v[34:35], v38 offset:8704
v_mfma_f32_16x16x32_bf16 v[196:199], v[20:23], a[52:55], v[196:199]
ds_read_b64_tr_b16 v[28:29], v38 offset:12288
v_mfma_f32_16x16x32_bf16 v[196:199], v[24:27], a[36:39], v[196:199]
buffer_load_dwordx4 v12, s[84:87], s62 offen offset:2048 lds
v_mfma_f32_16x16x32_bf16 v[200:203], v[24:27], a[40:43], v[200:203]
ds_read_b64_tr_b16 v[30:31], v38 offset:12800
v_pk_mul_f32 v[96:97], v[96:97], s[34:35]
v_mfma_f32_16x16x32_bf16 v[200:203], v[20:23], a[56:59], v[200:203]
v_pk_mul_f32 v[98:99], v[98:99], s[34:35]
v_pk_mul_f32 v[112:113], v[112:113], s[34:35]
v_mfma_f32_16x16x32_bf16 v[204:207], v[20:23], a[60:63], v[204:207]
v_pk_mul_f32 v[114:115], v[114:115], s[34:35]
v_cvt_pk_bf16_f32 v96, v96, v97
v_mfma_f32_16x16x32_bf16 v[204:207], v[24:27], a[44:47], v[204:207]
v_cvt_pk_bf16_f32 v97, v98, v99
v_cvt_pk_bf16_f32 v98, v112, v113
s_waitcnt lgkmcnt(4)
v_mfma_f32_16x16x32_bf16 v[208:211], v[52:55], a[32:35], v[208:211]
ds_read_b64_tr_b16 v[20:21], v39 offset:8192
v_cvt_pk_bf16_f32 v99, v114, v115
v_mfma_f32_16x16x32_bf16 v[208:211], v[48:51], a[48:51], v[208:211]
ds_read_b64_tr_b16 v[22:23], v39 offset:8704
s_add_u32 s61, s101, 0
v_mfma_f32_16x16x32_bf16 v[212:215], v[48:51], a[52:55], v[212:215]
ds_read_b64_tr_b16 v[24:25], v39 offset:12288
buffer_store_dwordx4 v[96:99], v1, s[12:15], s61 offen offset:1024 sc1
v_mfma_f32_16x16x32_bf16 v[212:215], v[52:55], a[36:39], v[212:215]
v_mfma_f32_16x16x32_bf16 v[216:219], v[52:55], a[40:43], v[216:219]
ds_read_b64_tr_b16 v[26:27], v39 offset:12800
v_mfma_f32_16x16x32_bf16 v[216:219], v[48:51], a[56:59], v[216:219]
v_mfma_f32_16x16x32_bf16 v[220:223], v[48:51], a[60:63], v[220:223]
v_mfma_f32_16x16x32_bf16 v[220:223], v[52:55], a[44:47], v[220:223]
s_waitcnt vmcnt(12) lgkmcnt(4)
s_barrier
v_mfma_f32_16x16x32_bf16 v[224:227], v[32:35], a[32:35], v[224:227]
ds_read_b64_tr_b16 v[48:49], v36 offset:16384
v_mfma_f32_16x16x32_bf16 v[224:227], v[28:31], a[48:51], v[224:227]
ds_read_b64_tr_b16 v[50:51], v36 offset:16896
v_mfma_f32_16x16x32_bf16 v[228:231], v[28:31], a[52:55], v[228:231]
ds_read_b64_tr_b16 v[52:53], v36 offset:20480
v_mfma_f32_16x16x32_bf16 v[228:231], v[32:35], a[36:39], v[228:231]
buffer_load_dwordx4 v13, s[84:87], s62 offen offset:3072 lds
v_mfma_f32_16x16x32_bf16 v[232:235], v[32:35], a[40:43], v[232:235]
ds_read_b64_tr_b16 v[54:55], v36 offset:20992
v_pk_mul_f32 v[100:101], v[100:101], s[34:35]
v_mfma_f32_16x16x32_bf16 v[232:235], v[28:31], a[56:59], v[232:235]
v_pk_mul_f32 v[102:103], v[102:103], s[34:35]
v_pk_mul_f32 v[116:117], v[116:117], s[34:35]
v_mfma_f32_16x16x32_bf16 v[236:239], v[28:31], a[60:63], v[236:239]
v_pk_mul_f32 v[118:119], v[118:119], s[34:35]
v_cvt_pk_bf16_f32 v100, v100, v101
v_mfma_f32_16x16x32_bf16 v[236:239], v[32:35], a[44:47], v[236:239]
v_cvt_pk_bf16_f32 v101, v102, v103
v_cvt_pk_bf16_f32 v102, v116, v117
s_waitcnt lgkmcnt(4)
v_mfma_f32_16x16x32_bf16 v[240:243], v[20:23], a[32:35], v[240:243]
s_mov_b64 exec, 1
buffer_store_dword v8, off, s[12:15], s6 offset:0 sc1
s_mov_b64 exec, -1
ds_read_b64_tr_b16 v[28:29], v37 offset:16384
v_cvt_pk_bf16_f32 v103, v118, v119
v_mfma_f32_16x16x32_bf16 v[240:243], v[24:27], a[48:51], v[240:243]
ds_read_b64_tr_b16 v[30:31], v37 offset:16896
s_add_u32 s61, s101, 4096
v_mfma_f32_16x16x32_bf16 v[244:247], v[24:27], a[52:55], v[244:247]
ds_read_b64_tr_b16 v[32:33], v37 offset:20480
buffer_store_dwordx4 v[100:103], v1, s[12:15], s61 offen offset:1024 sc1
v_mfma_f32_16x16x32_bf16 v[244:247], v[20:23], a[36:39], v[244:247]
v_mfma_f32_16x16x32_bf16 v[248:251], v[20:23], a[40:43], v[248:251]
ds_read_b64_tr_b16 v[34:35], v37 offset:20992
v_mfma_f32_16x16x32_bf16 v[248:251], v[24:27], a[56:59], v[248:251]
v_mfma_f32_16x16x32_bf16 v[252:255], v[24:27], a[60:63], v[252:255]
v_mfma_f32_16x16x32_bf16 v[252:255], v[20:23], a[44:47], v[252:255]
s_waitcnt lgkmcnt(4)
v_mfma_f32_16x16x32_bf16 v[192:195], v[48:51], a[64:67], v[192:195]
ds_read_b64_tr_b16 v[24:25], v38 offset:16384
v_mfma_f32_16x16x32_bf16 v[192:195], v[52:55], a[80:83], v[192:195]
ds_read_b64_tr_b16 v[26:27], v38 offset:16896
v_mfma_f32_16x16x32_bf16 v[196:199], v[52:55], a[84:87], v[196:199]
ds_read_b64_tr_b16 v[20:21], v38 offset:20480
s_add_u32 s62, s97, 384
s_bitset0_b32 s62, 22
s_add_u32 m0, s98, 0
v_mfma_f32_16x16x32_bf16 v[196:199], v[48:51], a[68:71], v[196:199]
buffer_load_dwordx4 v10, s[84:87], s62 offen offset:0 lds
v_mfma_f32_16x16x32_bf16 v[200:203], v[48:51], a[72:75], v[200:203]
ds_read_b64_tr_b16 v[22:23], v38 offset:20992
v_pk_mul_f32 v[104:105], v[104:105], s[34:35]
v_mfma_f32_16x16x32_bf16 v[200:203], v[52:55], a[88:91], v[200:203]
v_pk_mul_f32 v[106:107], v[106:107], s[34:35]
v_pk_mul_f32 v[120:121], v[120:121], s[34:35]
v_mfma_f32_16x16x32_bf16 v[204:207], v[52:55], a[92:95], v[204:207]
v_pk_mul_f32 v[122:123], v[122:123], s[34:35]
v_cvt_pk_bf16_f32 v104, v104, v105
v_mfma_f32_16x16x32_bf16 v[204:207], v[48:51], a[76:79], v[204:207]
v_cvt_pk_bf16_f32 v105, v106, v107
v_cvt_pk_bf16_f32 v106, v120, v121
s_waitcnt lgkmcnt(4)
v_mfma_f32_16x16x32_bf16 v[208:211], v[28:31], a[64:67], v[208:211]
ds_read_b64_tr_b16 v[52:53], v39 offset:16384
v_cvt_pk_bf16_f32 v107, v122, v123
v_mfma_f32_16x16x32_bf16 v[208:211], v[32:35], a[80:83], v[208:211]
ds_read_b64_tr_b16 v[54:55], v39 offset:16896
s_add_u32 s61, s101, 8192
v_mfma_f32_16x16x32_bf16 v[212:215], v[32:35], a[84:87], v[212:215]
ds_read_b64_tr_b16 v[48:49], v39 offset:20480
buffer_store_dwordx4 v[104:107], v1, s[12:15], s61 offen offset:1024 sc1
v_mfma_f32_16x16x32_bf16 v[212:215], v[28:31], a[68:71], v[212:215]
v_mfma_f32_16x16x32_bf16 v[216:219], v[28:31], a[72:75], v[216:219]
ds_read_b64_tr_b16 v[50:51], v39 offset:20992
v_mfma_f32_16x16x32_bf16 v[216:219], v[32:35], a[88:91], v[216:219]
v_mfma_f32_16x16x32_bf16 v[220:223], v[32:35], a[92:95], v[220:223]
v_mfma_f32_16x16x32_bf16 v[220:223], v[28:31], a[76:79], v[220:223]
s_waitcnt lgkmcnt(4)
v_mfma_f32_16x16x32_bf16 v[224:227], v[24:27], a[64:67], v[224:227]
ds_read_b64_tr_b16 v[32:33], v36 offset:24576
v_mfma_f32_16x16x32_bf16 v[224:227], v[20:23], a[80:83], v[224:227]
ds_read_b64_tr_b16 v[34:35], v36 offset:25088
v_mfma_f32_16x16x32_bf16 v[228:231], v[20:23], a[84:87], v[228:231]
ds_read_b64_tr_b16 v[28:29], v36 offset:28672
v_mfma_f32_16x16x32_bf16 v[228:231], v[24:27], a[68:71], v[228:231]
buffer_load_dwordx4 v11, s[84:87], s62 offen offset:1024 lds
v_mfma_f32_16x16x32_bf16 v[232:235], v[24:27], a[72:75], v[232:235]
ds_read_b64_tr_b16 v[30:31], v36 offset:29184
v_pk_mul_f32 v[108:109], v[108:109], s[34:35]
v_mfma_f32_16x16x32_bf16 v[232:235], v[20:23], a[88:91], v[232:235]
v_pk_mul_f32 v[110:111], v[110:111], s[34:35]
v_pk_mul_f32 v[124:125], v[124:125], s[34:35]
v_mfma_f32_16x16x32_bf16 v[236:239], v[20:23], a[92:95], v[236:239]
v_pk_mul_f32 v[126:127], v[126:127], s[34:35]
v_cvt_pk_bf16_f32 v108, v108, v109
v_mfma_f32_16x16x32_bf16 v[236:239], v[24:27], a[76:79], v[236:239]
v_cvt_pk_bf16_f32 v109, v110, v111
v_cvt_pk_bf16_f32 v110, v124, v125
s_waitcnt lgkmcnt(4)
v_mfma_f32_16x16x32_bf16 v[240:243], v[52:55], a[64:67], v[240:243]
ds_read_b64_tr_b16 v[20:21], v37 offset:24576
v_cvt_pk_bf16_f32 v111, v126, v127
v_mfma_f32_16x16x32_bf16 v[240:243], v[48:51], a[80:83], v[240:243]
ds_read_b64_tr_b16 v[22:23], v37 offset:25088
s_add_u32 s61, s101, 12288
v_mfma_f32_16x16x32_bf16 v[244:247], v[48:51], a[84:87], v[244:247]
ds_read_b64_tr_b16 v[24:25], v37 offset:28672
buffer_store_dwordx4 v[108:111], v1, s[12:15], s61 offen offset:1024 sc1
v_mfma_f32_16x16x32_bf16 v[244:247], v[52:55], a[68:71], v[244:247]
v_mfma_f32_16x16x32_bf16 v[248:251], v[52:55], a[72:75], v[248:251]
ds_read_b64_tr_b16 v[26:27], v37 offset:29184
v_mfma_f32_16x16x32_bf16 v[248:251], v[48:51], a[88:91], v[248:251]
v_mfma_f32_16x16x32_bf16 v[252:255], v[48:51], a[92:95], v[252:255]
v_mfma_f32_16x16x32_bf16 v[252:255], v[52:55], a[76:79], v[252:255]
s_waitcnt lgkmcnt(4)
v_mfma_f32_16x16x32_bf16 v[192:195], v[32:35], a[96:99], v[192:195]
ds_read_b64_tr_b16 v[48:49], v38 offset:24576
v_mfma_f32_16x16x32_bf16 v[192:195], v[28:31], a[112:115], v[192:195]
ds_read_b64_tr_b16 v[50:51], v38 offset:25088
v_mfma_f32_16x16x32_bf16 v[196:199], v[28:31], a[116:119], v[196:199]
ds_read_b64_tr_b16 v[52:53], v38 offset:28672
v_mfma_f32_16x16x32_bf16 v[196:199], v[32:35], a[100:103], v[196:199]
buffer_load_dwordx4 v12, s[84:87], s62 offen offset:2048 lds
v_mfma_f32_16x16x32_bf16 v[200:203], v[32:35], a[104:107], v[200:203]
ds_read_b64_tr_b16 v[54:55], v38 offset:29184
v_pk_mul_f32 v[128:129], v[128:129], s[34:35]
v_mfma_f32_16x16x32_bf16 v[200:203], v[28:31], a[120:123], v[200:203]
v_pk_mul_f32 v[130:131], v[130:131], s[34:35]
v_pk_mul_f32 v[144:145], v[144:145], s[34:35]
v_mfma_f32_16x16x32_bf16 v[204:207], v[28:31], a[124:127], v[204:207]
v_pk_mul_f32 v[146:147], v[146:147], s[34:35]
v_cvt_pk_bf16_f32 v128, v128, v129
v_mfma_f32_16x16x32_bf16 v[204:207], v[32:35], a[108:111], v[204:207]
v_cvt_pk_bf16_f32 v129, v130, v131
v_cvt_pk_bf16_f32 v130, v144, v145
s_waitcnt lgkmcnt(4)
v_mfma_f32_16x16x32_bf16 v[208:211], v[20:23], a[96:99], v[208:211]
ds_read_b64_tr_b16 v[28:29], v39 offset:24576
v_cvt_pk_bf16_f32 v131, v146, v147
v_mfma_f32_16x16x32_bf16 v[208:211], v[24:27], a[112:115], v[208:211]
ds_read_b64_tr_b16 v[30:31], v39 offset:25088
s_add_u32 s61, s101, 0
v_mfma_f32_16x16x32_bf16 v[212:215], v[24:27], a[116:119], v[212:215]
ds_read_b64_tr_b16 v[32:33], v39 offset:28672
buffer_store_dwordx4 v[128:131], v1, s[12:15], s61 offen offset:2048 sc1
v_mfma_f32_16x16x32_bf16 v[212:215], v[20:23], a[100:103], v[212:215]
v_mfma_f32_16x16x32_bf16 v[216:219], v[20:23], a[104:107], v[216:219]
ds_read_b64_tr_b16 v[34:35], v39 offset:29184
v_mfma_f32_16x16x32_bf16 v[216:219], v[24:27], a[120:123], v[216:219]
v_mfma_f32_16x16x32_bf16 v[220:223], v[24:27], a[124:127], v[220:223]
v_mfma_f32_16x16x32_bf16 v[220:223], v[20:23], a[108:111], v[220:223]
s_waitcnt vmcnt(16) lgkmcnt(4)
s_barrier
v_mfma_f32_16x16x32_bf16 v[224:227], v[48:51], a[96:99], v[224:227]
ds_read_b64_tr_b16 v[24:25], v36 offset:32768
v_mfma_f32_16x16x32_bf16 v[224:227], v[52:55], a[112:115], v[224:227]
ds_read_b64_tr_b16 v[26:27], v36 offset:33280
v_mfma_f32_16x16x32_bf16 v[228:231], v[52:55], a[116:119], v[228:231]
ds_read_b64_tr_b16 v[20:21], v36 offset:36864
v_mfma_f32_16x16x32_bf16 v[228:231], v[48:51], a[100:103], v[228:231]
buffer_load_dwordx4 v13, s[84:87], s62 offen offset:3072 lds
v_mfma_f32_16x16x32_bf16 v[232:235], v[48:51], a[104:107], v[232:235]
ds_read_b64_tr_b16 v[22:23], v36 offset:37376
v_mfma_f32_16x16x32_bf16 v[232:235], v[52:55], a[120:123], v[232:235]
v_mfma_f32_16x16x32_bf16 v[236:239], v[52:55], a[124:127], v[236:239]
v_pk_mul_f32 v[132:133], v[132:133], s[34:35]
v_pk_mul_f32 v[134:135], v[134:135], s[34:35]
v_mfma_f32_16x16x32_bf16 v[236:239], v[48:51], a[108:111], v[236:239]
v_pk_mul_f32 v[148:149], v[148:149], s[34:35]
v_pk_mul_f32 v[150:151], v[150:151], s[34:35]
s_waitcnt lgkmcnt(4)
v_mfma_f32_16x16x32_bf16 v[240:243], v[28:31], a[96:99], v[240:243]
ds_read_b64_tr_b16 v[52:53], v37 offset:32768
v_cvt_pk_bf16_f32 v132, v132, v133
v_mfma_f32_16x16x32_bf16 v[240:243], v[32:35], a[112:115], v[240:243]
ds_read_b64_tr_b16 v[54:55], v37 offset:33280
v_cvt_pk_bf16_f32 v133, v134, v135
v_mfma_f32_16x16x32_bf16 v[244:247], v[32:35], a[116:119], v[244:247]
ds_read_b64_tr_b16 v[48:49], v37 offset:36864
v_cvt_pk_bf16_f32 v134, v148, v149
v_mfma_f32_16x16x32_bf16 v[244:247], v[28:31], a[100:103], v[244:247]
v_cvt_pk_bf16_f32 v135, v150, v151
s_add_u32 s61, s101, 4096
v_mfma_f32_16x16x32_bf16 v[248:251], v[28:31], a[104:107], v[248:251]
ds_read_b64_tr_b16 v[50:51], v37 offset:37376
buffer_store_dwordx4 v[132:135], v1, s[12:15], s61 offen offset:2048 sc1
v_mfma_f32_16x16x32_bf16 v[248:251], v[32:35], a[120:123], v[248:251]
v_mfma_f32_16x16x32_bf16 v[252:255], v[32:35], a[124:127], v[252:255]
v_mfma_f32_16x16x32_bf16 v[252:255], v[28:31], a[108:111], v[252:255]
s_waitcnt lgkmcnt(4)
v_mfma_f32_16x16x32_bf16 v[192:195], v[24:27], a[128:131], v[192:195]
ds_read_b64_tr_b16 v[32:33], v38 offset:32768
v_mfma_f32_16x16x32_bf16 v[192:195], v[20:23], a[144:147], v[192:195]
ds_read_b64_tr_b16 v[34:35], v38 offset:33280
v_mfma_f32_16x16x32_bf16 v[196:199], v[20:23], a[148:151], v[196:199]
ds_read_b64_tr_b16 v[28:29], v38 offset:36864
s_add_u32 s62, s97, 1048960
s_bitset0_b32 s62, 22
s_add_u32 m0, s98, 16384
v_mfma_f32_16x16x32_bf16 v[196:199], v[24:27], a[132:135], v[196:199]
buffer_load_dwordx4 v10, s[84:87], s62 offen offset:0 lds
v_mfma_f32_16x16x32_bf16 v[200:203], v[24:27], a[136:139], v[200:203]
ds_read_b64_tr_b16 v[30:31], v38 offset:37376
v_mfma_f32_16x16x32_bf16 v[200:203], v[20:23], a[152:155], v[200:203]
v_mfma_f32_16x16x32_bf16 v[204:207], v[20:23], a[156:159], v[204:207]
v_mfma_f32_16x16x32_bf16 v[204:207], v[24:27], a[140:143], v[204:207]
s_waitcnt lgkmcnt(4)
v_mfma_f32_16x16x32_bf16 v[208:211], v[52:55], a[128:131], v[208:211]
ds_read_b64_tr_b16 v[20:21], v39 offset:32768
v_pk_mul_f32 v[136:137], v[136:137], s[34:35]
v_mfma_f32_16x16x32_bf16 v[208:211], v[48:51], a[144:147], v[208:211]
ds_read_b64_tr_b16 v[22:23], v39 offset:33280
v_pk_mul_f32 v[138:139], v[138:139], s[34:35]
v_mfma_f32_16x16x32_bf16 v[212:215], v[48:51], a[148:151], v[212:215]
ds_read_b64_tr_b16 v[24:25], v39 offset:36864
v_pk_mul_f32 v[152:153], v[152:153], s[34:35]
v_mfma_f32_16x16x32_bf16 v[212:215], v[52:55], a[132:135], v[212:215]
v_pk_mul_f32 v[154:155], v[154:155], s[34:35]
v_cvt_pk_bf16_f32 v136, v136, v137
v_mfma_f32_16x16x32_bf16 v[216:219], v[52:55], a[136:139], v[216:219]
ds_read_b64_tr_b16 v[26:27], v39 offset:37376
v_cvt_pk_bf16_f32 v137, v138, v139
v_mfma_f32_16x16x32_bf16 v[216:219], v[48:51], a[152:155], v[216:219]
v_cvt_pk_bf16_f32 v138, v152, v153
v_cvt_pk_bf16_f32 v139, v154, v155
v_mfma_f32_16x16x32_bf16 v[220:223], v[48:51], a[156:159], v[220:223]
s_add_u32 s61, s101, 8192
buffer_store_dwordx4 v[136:139], v1, s[12:15], s61 offen offset:2048 sc1
v_mfma_f32_16x16x32_bf16 v[220:223], v[52:55], a[140:143], v[220:223]
s_waitcnt lgkmcnt(4)
v_mfma_f32_16x16x32_bf16 v[224:227], v[32:35], a[128:131], v[224:227]
ds_read_b64_tr_b16 v[48:49], v36 offset:40960
v_mfma_f32_16x16x32_bf16 v[224:227], v[28:31], a[144:147], v[224:227]
ds_read_b64_tr_b16 v[50:51], v36 offset:41472
v_mfma_f32_16x16x32_bf16 v[228:231], v[28:31], a[148:151], v[228:231]
ds_read_b64_tr_b16 v[52:53], v36 offset:45056
v_mfma_f32_16x16x32_bf16 v[228:231], v[32:35], a[132:135], v[228:231]
buffer_load_dwordx4 v11, s[84:87], s62 offen offset:1024 lds
v_mfma_f32_16x16x32_bf16 v[232:235], v[32:35], a[136:139], v[232:235]
ds_read_b64_tr_b16 v[54:55], v36 offset:45568
v_mfma_f32_16x16x32_bf16 v[232:235], v[28:31], a[152:155], v[232:235]
v_mfma_f32_16x16x32_bf16 v[236:239], v[28:31], a[156:159], v[236:239]
v_mfma_f32_16x16x32_bf16 v[236:239], v[32:35], a[140:143], v[236:239]
s_waitcnt lgkmcnt(4)
v_mfma_f32_16x16x32_bf16 v[240:243], v[20:23], a[128:131], v[240:243]
ds_read_b64_tr_b16 v[28:29], v37 offset:40960
v_mfma_f32_16x16x32_bf16 v[240:243], v[24:27], a[144:147], v[240:243]
ds_read_b64_tr_b16 v[30:31], v37 offset:41472
v_mfma_f32_16x16x32_bf16 v[244:247], v[24:27], a[148:151], v[244:247]
ds_read_b64_tr_b16 v[32:33], v37 offset:45056
v_pk_mul_f32 v[140:141], v[140:141], s[34:35]
v_mfma_f32_16x16x32_bf16 v[244:247], v[20:23], a[132:135], v[244:247]
v_pk_mul_f32 v[142:143], v[142:143], s[34:35]
v_pk_mul_f32 v[156:157], v[156:157], s[34:35]
v_mfma_f32_16x16x32_bf16 v[248:251], v[20:23], a[136:139], v[248:251]
ds_read_b64_tr_b16 v[34:35], v37 offset:45568
v_pk_mul_f32 v[158:159], v[158:159], s[34:35]
v_mfma_f32_16x16x32_bf16 v[248:251], v[24:27], a[152:155], v[248:251]
v_cvt_pk_bf16_f32 v140, v140, v141
v_cvt_pk_bf16_f32 v141, v142, v143
v_mfma_f32_16x16x32_bf16 v[252:255], v[24:27], a[156:159], v[252:255]
v_cvt_pk_bf16_f32 v142, v156, v157
v_cvt_pk_bf16_f32 v143, v158, v159
v_mfma_f32_16x16x32_bf16 v[252:255], v[20:23], a[140:143], v[252:255]
s_add_u32 s61, s101, 12288
buffer_store_dwordx4 v[140:143], v1, s[12:15], s61 offen offset:2048 sc1
s_waitcnt lgkmcnt(4)
v_mfma_f32_16x16x32_bf16 v[192:195], v[48:51], a[160:163], v[192:195]
ds_read_b64_tr_b16 v[24:25], v38 offset:40960
v_mfma_f32_16x16x32_bf16 v[192:195], v[52:55], a[176:179], v[192:195]
ds_read_b64_tr_b16 v[26:27], v38 offset:41472
v_mfma_f32_16x16x32_bf16 v[196:199], v[52:55], a[180:183], v[196:199]
ds_read_b64_tr_b16 v[20:21], v38 offset:45056
v_mfma_f32_16x16x32_bf16 v[196:199], v[48:51], a[164:167], v[196:199]
buffer_load_dwordx4 v12, s[84:87], s62 offen offset:2048 lds
v_mfma_f32_16x16x32_bf16 v[200:203], v[48:51], a[168:171], v[200:203]
ds_read_b64_tr_b16 v[22:23], v38 offset:45568
v_mfma_f32_16x16x32_bf16 v[200:203], v[52:55], a[184:187], v[200:203]
v_mfma_f32_16x16x32_bf16 v[204:207], v[52:55], a[188:191], v[204:207]
v_mfma_f32_16x16x32_bf16 v[204:207], v[48:51], a[172:175], v[204:207]
s_waitcnt lgkmcnt(4)
v_mfma_f32_16x16x32_bf16 v[208:211], v[28:31], a[160:163], v[208:211]
ds_read_b64_tr_b16 v[52:53], v39 offset:40960
v_mfma_f32_16x16x32_bf16 v[208:211], v[32:35], a[176:179], v[208:211]
ds_read_b64_tr_b16 v[54:55], v39 offset:41472
v_mfma_f32_16x16x32_bf16 v[212:215], v[32:35], a[180:183], v[212:215]
ds_read_b64_tr_b16 v[48:49], v39 offset:45056
v_mfma_f32_16x16x32_bf16 v[212:215], v[28:31], a[164:167], v[212:215]
v_mfma_f32_16x16x32_bf16 v[216:219], v[28:31], a[168:171], v[216:219]
ds_read_b64_tr_b16 v[50:51], v39 offset:45568
v_pk_mul_f32 v[160:161], v[160:161], s[34:35]
v_mfma_f32_16x16x32_bf16 v[216:219], v[32:35], a[184:187], v[216:219]
v_pk_mul_f32 v[162:163], v[162:163], s[34:35]
v_pk_mul_f32 v[176:177], v[176:177], s[34:35]
v_mfma_f32_16x16x32_bf16 v[220:223], v[32:35], a[188:191], v[220:223]
v_pk_mul_f32 v[178:179], v[178:179], s[34:35]
v_cvt_pk_bf16_f32 v160, v160, v161
v_mfma_f32_16x16x32_bf16 v[220:223], v[28:31], a[172:175], v[220:223]
v_cvt_pk_bf16_f32 v161, v162, v163
v_cvt_pk_bf16_f32 v162, v176, v177
s_waitcnt vmcnt(15) lgkmcnt(4)
s_barrier
v_mfma_f32_16x16x32_bf16 v[224:227], v[24:27], a[160:163], v[224:227]
ds_read_b64_tr_b16 v[32:33], v36 offset:49152
v_cvt_pk_bf16_f32 v163, v178, v179
v_mfma_f32_16x16x32_bf16 v[224:227], v[20:23], a[176:179], v[224:227]
ds_read_b64_tr_b16 v[34:35], v36 offset:49664
s_add_u32 s61, s101, 0
v_mfma_f32_16x16x32_bf16 v[228:231], v[20:23], a[180:183], v[228:231]
ds_read_b64_tr_b16 v[28:29], v36 offset:53248
buffer_store_dwordx4 v[160:163], v1, s[12:15], s61 offen offset:3072 sc1
v_mfma_f32_16x16x32_bf16 v[228:231], v[24:27], a[164:167], v[228:231]
buffer_load_dwordx4 v13, s[84:87], s62 offen offset:3072 lds
v_mfma_f32_16x16x32_bf16 v[232:235], v[24:27], a[168:171], v[232:235]
ds_read_b64_tr_b16 v[30:31], v36 offset:53760
v_mfma_f32_16x16x32_bf16 v[232:235], v[20:23], a[184:187], v[232:235]
v_mfma_f32_16x16x32_bf16 v[236:239], v[20:23], a[188:191], v[236:239]
v_mfma_f32_16x16x32_bf16 v[236:239], v[24:27], a[172:175], v[236:239]
s_waitcnt lgkmcnt(4)
v_mfma_f32_16x16x32_bf16 v[240:243], v[52:55], a[160:163], v[240:243]
ds_read_b64_tr_b16 v[20:21], v37 offset:49152
v_mfma_f32_16x16x32_bf16 v[240:243], v[48:51], a[176:179], v[240:243]
ds_read_b64_tr_b16 v[22:23], v37 offset:49664
v_mfma_f32_16x16x32_bf16 v[244:247], v[48:51], a[180:183], v[244:247]
ds_read_b64_tr_b16 v[24:25], v37 offset:53248
v_mfma_f32_16x16x32_bf16 v[244:247], v[52:55], a[164:167], v[244:247]
v_mfma_f32_16x16x32_bf16 v[248:251], v[52:55], a[168:171], v[248:251]
ds_read_b64_tr_b16 v[26:27], v37 offset:53760
v_mfma_f32_16x16x32_bf16 v[248:251], v[48:51], a[184:187], v[248:251]
v_mfma_f32_16x16x32_bf16 v[252:255], v[48:51], a[188:191], v[252:255]
v_pk_mul_f32 v[164:165], v[164:165], s[34:35]
v_pk_mul_f32 v[166:167], v[166:167], s[34:35]
v_mfma_f32_16x16x32_bf16 v[252:255], v[52:55], a[172:175], v[252:255]
v_pk_mul_f32 v[180:181], v[180:181], s[34:35]
v_pk_mul_f32 v[182:183], v[182:183], s[34:35]
s_waitcnt lgkmcnt(4)
v_mfma_f32_16x16x32_bf16 v[192:195], v[32:35], a[192:195], v[192:195]
ds_read_b64_tr_b16 v[48:49], v38 offset:49152
v_cvt_pk_bf16_f32 v164, v164, v165
v_mfma_f32_16x16x32_bf16 v[192:195], v[28:31], a[208:211], v[192:195]
ds_read_b64_tr_b16 v[50:51], v38 offset:49664
v_cvt_pk_bf16_f32 v165, v166, v167
v_mfma_f32_16x16x32_bf16 v[196:199], v[28:31], a[212:215], v[196:199]
ds_read_b64_tr_b16 v[52:53], v38 offset:53248
s_add_u32 s62, s97, 2097536
s_bitset0_b32 s62, 22
s_add_u32 m0, s98, 32768
v_mfma_f32_16x16x32_bf16 v[196:199], v[32:35], a[196:199], v[196:199]
buffer_load_dwordx4 v10, s[84:87], s62 offen offset:0 lds
v_cvt_pk_bf16_f32 v166, v180, v181
v_mfma_f32_16x16x32_bf16 v[200:203], v[32:35], a[200:203], v[200:203]
ds_read_b64_tr_b16 v[54:55], v38 offset:53760
v_cvt_pk_bf16_f32 v167, v182, v183
v_mfma_f32_16x16x32_bf16 v[200:203], v[28:31], a[216:219], v[200:203]
s_add_u32 s61, s101, 4096
buffer_store_dwordx4 v[164:167], v1, s[12:15], s61 offen offset:3072 sc1
v_mfma_f32_16x16x32_bf16 v[204:207], v[28:31], a[220:223], v[204:207]
v_mfma_f32_16x16x32_bf16 v[204:207], v[32:35], a[204:207], v[204:207]
s_waitcnt lgkmcnt(4)
v_mfma_f32_16x16x32_bf16 v[208:211], v[20:23], a[192:195], v[208:211]
ds_read_b64_tr_b16 v[28:29], v39 offset:49152
v_mfma_f32_16x16x32_bf16 v[208:211], v[24:27], a[208:211], v[208:211]
ds_read_b64_tr_b16 v[30:31], v39 offset:49664
v_mfma_f32_16x16x32_bf16 v[212:215], v[24:27], a[212:215], v[212:215]
ds_read_b64_tr_b16 v[32:33], v39 offset:53248
v_mfma_f32_16x16x32_bf16 v[212:215], v[20:23], a[196:199], v[212:215]
v_mfma_f32_16x16x32_bf16 v[216:219], v[20:23], a[200:203], v[216:219]
ds_read_b64_tr_b16 v[34:35], v39 offset:53760
v_mfma_f32_16x16x32_bf16 v[216:219], v[24:27], a[216:219], v[216:219]
v_mfma_f32_16x16x32_bf16 v[220:223], v[24:27], a[220:223], v[220:223]
v_mfma_f32_16x16x32_bf16 v[220:223], v[20:23], a[204:207], v[220:223]
s_waitcnt lgkmcnt(4)
v_mfma_f32_16x16x32_bf16 v[224:227], v[48:51], a[192:195], v[224:227]
ds_read_b64_tr_b16 v[24:25], v36 offset:57344
v_pk_mul_f32 v[168:169], v[168:169], s[34:35]
v_mfma_f32_16x16x32_bf16 v[224:227], v[52:55], a[208:211], v[224:227]
ds_read_b64_tr_b16 v[26:27], v36 offset:57856
v_pk_mul_f32 v[170:171], v[170:171], s[34:35]
v_mfma_f32_16x16x32_bf16 v[228:231], v[52:55], a[212:215], v[228:231]
ds_read_b64_tr_b16 v[20:21], v36 offset:61440
v_pk_mul_f32 v[184:185], v[184:185], s[34:35]
v_mfma_f32_16x16x32_bf16 v[228:231], v[48:51], a[196:199], v[228:231]
buffer_load_dwordx4 v11, s[84:87], s62 offen offset:1024 lds
v_pk_mul_f32 v[186:187], v[186:187], s[34:35]
v_mfma_f32_16x16x32_bf16 v[232:235], v[48:51], a[200:203], v[232:235]
ds_read_b64_tr_b16 v[22:23], v36 offset:61952
v_cvt_pk_bf16_f32 v168, v168, v169
v_mfma_f32_16x16x32_bf16 v[232:235], v[52:55], a[216:219], v[232:235]
v_cvt_pk_bf16_f32 v169, v170, v171
v_cvt_pk_bf16_f32 v170, v184, v185
v_mfma_f32_16x16x32_bf16 v[236:239], v[52:55], a[220:223], v[236:239]
v_cvt_pk_bf16_f32 v171, v186, v187
s_add_u32 s61, s101, 8192
v_mfma_f32_16x16x32_bf16 v[236:239], v[48:51], a[204:207], v[236:239]
buffer_store_dwordx4 v[168:171], v1, s[12:15], s61 offen offset:3072 sc1
s_waitcnt lgkmcnt(4)
v_mfma_f32_16x16x32_bf16 v[240:243], v[28:31], a[192:195], v[240:243]
ds_read_b64_tr_b16 v[52:53], v37 offset:57344
v_mfma_f32_16x16x32_bf16 v[240:243], v[32:35], a[208:211], v[240:243]
ds_read_b64_tr_b16 v[54:55], v37 offset:57856
v_mfma_f32_16x16x32_bf16 v[244:247], v[32:35], a[212:215], v[244:247]
ds_read_b64_tr_b16 v[48:49], v37 offset:61440
v_mfma_f32_16x16x32_bf16 v[244:247], v[28:31], a[196:199], v[244:247]
v_mfma_f32_16x16x32_bf16 v[248:251], v[28:31], a[200:203], v[248:251]
ds_read_b64_tr_b16 v[50:51], v37 offset:61952
v_mfma_f32_16x16x32_bf16 v[248:251], v[32:35], a[216:219], v[248:251]
v_mfma_f32_16x16x32_bf16 v[252:255], v[32:35], a[220:223], v[252:255]
v_mfma_f32_16x16x32_bf16 v[252:255], v[28:31], a[204:207], v[252:255]
s_waitcnt lgkmcnt(4)
v_mfma_f32_16x16x32_bf16 v[192:195], v[24:27], a[224:227], v[192:195]
ds_read_b64_tr_b16 v[32:33], v38 offset:57344
v_mfma_f32_16x16x32_bf16 v[192:195], v[20:23], a[240:243], v[192:195]
ds_read_b64_tr_b16 v[34:35], v38 offset:57856
v_mfma_f32_16x16x32_bf16 v[196:199], v[20:23], a[244:247], v[196:199]
ds_read_b64_tr_b16 v[28:29], v38 offset:61440
v_pk_mul_f32 v[172:173], v[172:173], s[34:35]
v_mfma_f32_16x16x32_bf16 v[196:199], v[24:27], a[228:231], v[196:199]
buffer_load_dwordx4 v12, s[84:87], s62 offen offset:2048 lds
v_pk_mul_f32 v[174:175], v[174:175], s[34:35]
v_mfma_f32_16x16x32_bf16 v[200:203], v[24:27], a[232:235], v[200:203]
ds_read_b64_tr_b16 v[30:31], v38 offset:61952
v_pk_mul_f32 v[188:189], v[188:189], s[34:35]
v_mfma_f32_16x16x32_bf16 v[200:203], v[20:23], a[248:251], v[200:203]
v_pk_mul_f32 v[190:191], v[190:191], s[34:35]
v_cvt_pk_bf16_f32 v172, v172, v173
v_mfma_f32_16x16x32_bf16 v[204:207], v[20:23], a[252:255], v[204:207]
v_cvt_pk_bf16_f32 v173, v174, v175
v_cvt_pk_bf16_f32 v174, v188, v189
v_mfma_f32_16x16x32_bf16 v[204:207], v[24:27], a[236:239], v[204:207]
v_cvt_pk_bf16_f32 v175, v190, v191
s_add_u32 s61, s101, 12288
s_waitcnt lgkmcnt(4)
v_mfma_f32_16x16x32_bf16 v[208:211], v[52:55], a[224:227], v[208:211]
ds_read_b64_tr_b16 v[20:21], v39 offset:57344
buffer_store_dwordx4 v[172:175], v1, s[12:15], s61 offen offset:3072 sc1
v_mfma_f32_16x16x32_bf16 v[208:211], v[48:51], a[240:243], v[208:211]
ds_read_b64_tr_b16 v[22:23], v39 offset:57856
v_mfma_f32_16x16x32_bf16 v[212:215], v[48:51], a[244:247], v[212:215]
ds_read_b64_tr_b16 v[24:25], v39 offset:61440
v_mfma_f32_16x16x32_bf16 v[212:215], v[52:55], a[228:231], v[212:215]
v_mfma_f32_16x16x32_bf16 v[216:219], v[52:55], a[232:235], v[216:219]
ds_read_b64_tr_b16 v[26:27], v39 offset:61952
v_mfma_f32_16x16x32_bf16 v[216:219], v[48:51], a[248:251], v[216:219]
v_mfma_f32_16x16x32_bf16 v[220:223], v[48:51], a[252:255], v[220:223]
v_mfma_f32_16x16x32_bf16 v[220:223], v[52:55], a[236:239], v[220:223]
s_waitcnt vmcnt(14) lgkmcnt(4)
s_barrier
v_mfma_f32_16x16x32_bf16 v[224:227], v[32:35], a[224:227], v[224:227]
ds_read_b64_tr_b16 v[48:49], v36 offset:0
v_mfma_f32_16x16x32_bf16 v[224:227], v[28:31], a[240:243], v[224:227]
ds_read_b64_tr_b16 v[50:51], v36 offset:512
v_mfma_f32_16x16x32_bf16 v[228:231], v[28:31], a[244:247], v[228:231]
ds_read_b64_tr_b16 v[52:53], v36 offset:4096
v_mfma_f32_16x16x32_bf16 v[228:231], v[32:35], a[228:231], v[228:231]
buffer_load_dwordx4 v13, s[84:87], s62 offen offset:3072 lds
v_mfma_f32_16x16x32_bf16 v[232:235], v[32:35], a[232:235], v[232:235]
ds_read_b64_tr_b16 v[54:55], v36 offset:4608
v_mfma_f32_16x16x32_bf16 v[232:235], v[28:31], a[248:251], v[232:235]
v_mfma_f32_16x16x32_bf16 v[236:239], v[28:31], a[252:255], v[236:239]
v_mfma_f32_16x16x32_bf16 v[236:239], v[32:35], a[236:239], v[236:239]
s_waitcnt lgkmcnt(4)
v_mfma_f32_16x16x32_bf16 v[240:243], v[20:23], a[224:227], v[240:243]
ds_read_b64_tr_b16 v[28:29], v37 offset:0
v_mfma_f32_16x16x32_bf16 v[240:243], v[24:27], a[240:243], v[240:243]
ds_read_b64_tr_b16 v[30:31], v37 offset:512
v_mfma_f32_16x16x32_bf16 v[244:247], v[24:27], a[244:247], v[244:247]
ds_read_b64_tr_b16 v[32:33], v37 offset:4096
v_mfma_f32_16x16x32_bf16 v[244:247], v[20:23], a[228:231], v[244:247]
v_mfma_f32_16x16x32_bf16 v[248:251], v[20:23], a[232:235], v[248:251]
ds_read_b64_tr_b16 v[34:35], v37 offset:4608
v_mfma_f32_16x16x32_bf16 v[248:251], v[24:27], a[248:251], v[248:251]
v_mfma_f32_16x16x32_bf16 v[252:255], v[24:27], a[252:255], v[252:255]
v_mfma_f32_16x16x32_bf16 v[252:255], v[20:23], a[236:239], v[252:255]
s_waitcnt lgkmcnt(4)
v_mfma_f32_16x16x32_bf16 v[64:67], v[48:51], a[0:3], 0
ds_read_b64_tr_b16 v[24:25], v36 offset:8192
v_mfma_f32_16x16x32_bf16 v[64:67], v[52:55], a[16:19], v[64:67]
ds_read_b64_tr_b16 v[26:27], v36 offset:8704
v_mfma_f32_16x16x32_bf16 v[68:71], v[52:55], a[20:23], 0
ds_read_b64_tr_b16 v[20:21], v36 offset:12288
s_add_u32 s62, s97, 3146112
s_bitset0_b32 s62, 22
s_add_u32 m0, s98, 49152
v_mfma_f32_16x16x32_bf16 v[68:71], v[48:51], a[4:7], v[68:71]
buffer_load_dwordx4 v10, s[84:87], s62 offen offset:0 lds
v_mfma_f32_16x16x32_bf16 v[72:75], v[48:51], a[8:11], 0
ds_read_b64_tr_b16 v[22:23], v36 offset:12800
v_mfma_f32_16x16x32_bf16 v[72:75], v[52:55], a[24:27], v[72:75]
v_mfma_f32_16x16x32_bf16 v[76:79], v[52:55], a[28:31], 0
v_pk_mul_f32 v[192:193], v[192:193], s[34:35]
v_pk_mul_f32 v[194:195], v[194:195], s[34:35]
v_mfma_f32_16x16x32_bf16 v[76:79], v[48:51], a[12:15], v[76:79]
v_pk_mul_f32 v[208:209], v[208:209], s[34:35]
v_pk_mul_f32 v[210:211], v[210:211], s[34:35]
s_waitcnt lgkmcnt(4)
v_mfma_f32_16x16x32_bf16 v[80:83], v[28:31], a[0:3], 0
ds_read_b64_tr_b16 v[52:53], v37 offset:8192
v_cvt_pk_bf16_f32 v192, v192, v193
v_mfma_f32_16x16x32_bf16 v[80:83], v[32:35], a[16:19], v[80:83]
ds_read_b64_tr_b16 v[54:55], v37 offset:8704
v_cvt_pk_bf16_f32 v193, v194, v195
v_mfma_f32_16x16x32_bf16 v[84:87], v[32:35], a[20:23], 0
ds_read_b64_tr_b16 v[48:49], v37 offset:12288
v_cvt_pk_bf16_f32 v194, v208, v209
v_mfma_f32_16x16x32_bf16 v[84:87], v[28:31], a[4:7], v[84:87]
buffer_load_dwordx4 v11, s[84:87], s62 offen offset:1024 lds
v_cvt_pk_bf16_f32 v195, v210, v211
v_mfma_f32_16x16x32_bf16 v[88:91], v[28:31], a[8:11], 0
ds_read_b64_tr_b16 v[50:51], v37 offset:12800
s_add_u32 s61, s33, 0
v_mfma_f32_16x16x32_bf16 v[88:91], v[32:35], a[24:27], v[88:91]
buffer_store_dwordx4 v[192:195], v1, s[12:15], s61 offen offset:0 sc1
v_mfma_f32_16x16x32_bf16 v[92:95], v[32:35], a[28:31], 0
v_mfma_f32_16x16x32_bf16 v[92:95], v[28:31], a[12:15], v[92:95]
s_waitcnt vmcnt(10) lgkmcnt(4)
s_barrier
v_mfma_f32_16x16x32_bf16 v[64:67], v[24:27], a[32:35], v[64:67]
ds_read_b64_tr_b16 v[32:33], v36 offset:16384
v_mfma_f32_16x16x32_bf16 v[64:67], v[20:23], a[48:51], v[64:67]
ds_read_b64_tr_b16 v[34:35], v36 offset:16896
v_mfma_f32_16x16x32_bf16 v[68:71], v[20:23], a[52:55], v[68:71]
ds_read_b64_tr_b16 v[28:29], v36 offset:20480
v_mfma_f32_16x16x32_bf16 v[68:71], v[24:27], a[36:39], v[68:71]
buffer_load_dwordx4 v12, s[84:87], s62 offen offset:2048 lds
v_mfma_f32_16x16x32_bf16 v[72:75], v[24:27], a[40:43], v[72:75]
ds_read_b64_tr_b16 v[30:31], v36 offset:20992
v_mfma_f32_16x16x32_bf16 v[72:75], v[20:23], a[56:59], v[72:75]
v_mfma_f32_16x16x32_bf16 v[76:79], v[20:23], a[60:63], v[76:79]
v_pk_mul_f32 v[196:197], v[196:197], s[34:35]
v_pk_mul_f32 v[198:199], v[198:199], s[34:35]
v_mfma_f32_16x16x32_bf16 v[76:79], v[24:27], a[44:47], v[76:79]
v_pk_mul_f32 v[212:213], v[212:213], s[34:35]
v_pk_mul_f32 v[214:215], v[214:215], s[34:35]
s_waitcnt lgkmcnt(4)
v_mfma_f32_16x16x32_bf16 v[80:83], v[52:55], a[32:35], v[80:83]
ds_read_b64_tr_b16 v[20:21], v37 offset:16384
v_cvt_pk_bf16_f32 v196, v196, v197
v_mfma_f32_16x16x32_bf16 v[80:83], v[48:51], a[48:51], v[80:83]
ds_read_b64_tr_b16 v[22:23], v37 offset:16896
v_cvt_pk_bf16_f32 v197, v198, v199
v_mfma_f32_16x16x32_bf16 v[84:87], v[48:51], a[52:55], v[84:87]
ds_read_b64_tr_b16 v[24:25], v37 offset:20480
v_cvt_pk_bf16_f32 v198, v212, v213
v_mfma_f32_16x16x32_bf16 v[84:87], v[52:55], a[36:39], v[84:87]
buffer_load_dwordx4 v13, s[84:87], s62 offen offset:3072 lds
v_cvt_pk_bf16_f32 v199, v214, v215
v_mfma_f32_16x16x32_bf16 v[88:91], v[52:55], a[40:43], v[88:91]
ds_read_b64_tr_b16 v[26:27], v37 offset:20992
s_add_u32 s61, s33, 4096
v_mfma_f32_16x16x32_bf16 v[88:91], v[48:51], a[56:59], v[88:91]
buffer_store_dwordx4 v[196:199], v1, s[12:15], s61 offen offset:0 sc1
v_mfma_f32_16x16x32_bf16 v[92:95], v[48:51], a[60:63], v[92:95]
v_mfma_f32_16x16x32_bf16 v[92:95], v[52:55], a[44:47], v[92:95]
s_waitcnt lgkmcnt(4)
v_mfma_f32_16x16x32_bf16 v[64:67], v[32:35], a[64:67], v[64:67]
ds_read_b64_tr_b16 v[48:49], v36 offset:24576
v_mfma_f32_16x16x32_bf16 v[64:67], v[28:31], a[80:83], v[64:67]
ds_read_b64_tr_b16 v[50:51], v36 offset:25088
v_mfma_f32_16x16x32_bf16 v[68:71], v[28:31], a[84:87], v[68:71]
ds_read_b64_tr_b16 v[52:53], v36 offset:28672
v_mfma_f32_16x16x32_bf16 v[68:71], v[32:35], a[68:71], v[68:71]
global_load_dword v63, v[60:61], off
v_mfma_f32_16x16x32_bf16 v[72:75], v[32:35], a[72:75], v[72:75]
ds_read_b64_tr_b16 v[54:55], v36 offset:29184
buffer_load_dword v7, v6, s[12:15], s7 offen sc1
v_mfma_f32_16x16x32_bf16 v[72:75], v[28:31], a[88:91], v[72:75]
v_mfma_f32_16x16x32_bf16 v[76:79], v[28:31], a[92:95], v[76:79]
v_pk_mul_f32 v[200:201], v[200:201], s[34:35]
v_pk_mul_f32 v[202:203], v[202:203], s[34:35]
v_mfma_f32_16x16x32_bf16 v[76:79], v[32:35], a[76:79], v[76:79]
v_pk_mul_f32 v[216:217], v[216:217], s[34:35]
v_pk_mul_f32 v[218:219], v[218:219], s[34:35]
s_waitcnt lgkmcnt(4)
v_mfma_f32_16x16x32_bf16 v[80:83], v[20:23], a[64:67], v[80:83]
ds_read_b64_tr_b16 v[28:29], v37 offset:24576
v_cvt_pk_bf16_f32 v200, v200, v201
v_mfma_f32_16x16x32_bf16 v[80:83], v[24:27], a[80:83], v[80:83]
ds_read_b64_tr_b16 v[30:31], v37 offset:25088
v_cvt_pk_bf16_f32 v201, v202, v203
v_mfma_f32_16x16x32_bf16 v[84:87], v[24:27], a[84:87], v[84:87]
s_add_u32 s60, s56, 0
ds_read_b64_tr_b16 v[32:33], v37 offset:28672
v_cvt_pk_bf16_f32 v202, v216, v217
v_mfma_f32_16x16x32_bf16 v[84:87], v[20:23], a[68:71], v[84:87]
s_add_u32 m0, s57, 65536
v_cvt_pk_bf16_f32 v203, v218, v219
s_add_u32 s61, s33, 8192
v_mfma_f32_16x16x32_bf16 v[88:91], v[20:23], a[72:75], v[88:91]
ds_read_b64_tr_b16 v[34:35], v37 offset:29184
buffer_store_dwordx4 v[200:203], v1, s[12:15], s61 offen offset:0 sc1
v_mfma_f32_16x16x32_bf16 v[88:91], v[24:27], a[88:91], v[88:91]
buffer_load_dwordx4 v10, s[8:11], s60 offen offset:0 lds
v_mfma_f32_16x16x32_bf16 v[92:95], v[24:27], a[92:95], v[92:95]
v_mfma_f32_16x16x32_bf16 v[92:95], v[20:23], a[76:79], v[92:95]
s_waitcnt vmcnt(10) lgkmcnt(4)
s_barrier
v_mfma_f32_16x16x32_bf16 v[64:67], v[48:51], a[96:99], v[64:67]
ds_read_b64_tr_b16 v[24:25], v36 offset:32768
v_mfma_f32_16x16x32_bf16 v[64:67], v[52:55], a[112:115], v[64:67]
ds_read_b64_tr_b16 v[26:27], v36 offset:33280
v_mfma_f32_16x16x32_bf16 v[68:71], v[52:55], a[116:119], v[68:71]
ds_read_b64_tr_b16 v[20:21], v36 offset:36864
v_mfma_f32_16x16x32_bf16 v[68:71], v[48:51], a[100:103], v[68:71]
buffer_load_dwordx4 v11, s[8:11], s60 offen offset:1024 lds
v_mfma_f32_16x16x32_bf16 v[72:75], v[48:51], a[104:107], v[72:75]
ds_read_b64_tr_b16 v[22:23], v36 offset:37376
v_mfma_f32_16x16x32_bf16 v[72:75], v[52:55], a[120:123], v[72:75]
buffer_load_dwordx4 v12, s[8:11], s60 offen offset:2048 lds
v_mfma_f32_16x16x32_bf16 v[76:79], v[52:55], a[124:127], v[76:79]
v_pk_mul_f32 v[204:205], v[204:205], s[34:35]
v_pk_mul_f32 v[206:207], v[206:207], s[34:35]
v_mfma_f32_16x16x32_bf16 v[76:79], v[48:51], a[108:111], v[76:79]
v_pk_mul_f32 v[220:221], v[220:221], s[34:35]
v_pk_mul_f32 v[222:223], v[222:223], s[34:35]
s_waitcnt lgkmcnt(4)
v_mfma_f32_16x16x32_bf16 v[80:83], v[28:31], a[96:99], v[80:83]
ds_read_b64_tr_b16 v[52:53], v37 offset:32768
v_cvt_pk_bf16_f32 v204, v204, v205
v_mfma_f32_16x16x32_bf16 v[80:83], v[32:35], a[112:115], v[80:83]
ds_read_b64_tr_b16 v[54:55], v37 offset:33280
v_cvt_pk_bf16_f32 v205, v206, v207
v_mfma_f32_16x16x32_bf16 v[84:87], v[32:35], a[116:119], v[84:87]
ds_read_b64_tr_b16 v[48:49], v37 offset:36864
v_cvt_pk_bf16_f32 v206, v220, v221
v_mfma_f32_16x16x32_bf16 v[84:87], v[28:31], a[100:103], v[84:87]
v_cvt_pk_bf16_f32 v207, v222, v223
s_add_u32 s61, s33, 12288
v_mfma_f32_16x16x32_bf16 v[88:91], v[28:31], a[104:107], v[88:91]
ds_read_b64_tr_b16 v[50:51], v37 offset:37376
buffer_store_dwordx4 v[204:207], v1, s[12:15], s61 offen offset:0 sc1
v_mfma_f32_16x16x32_bf16 v[88:91], v[32:35], a[120:123], v[88:91]
buffer_load_dwordx4 v13, s[8:11], s60 offen offset:3072 lds
v_mfma_f32_16x16x32_bf16 v[92:95], v[32:35], a[124:127], v[92:95]
s_add_u32 s60, s56, 524288
s_add_u32 m0, s57, 81920
v_mfma_f32_16x16x32_bf16 v[92:95], v[28:31], a[108:111], v[92:95]
s_waitcnt lgkmcnt(4)
v_mfma_f32_16x16x32_bf16 v[64:67], v[24:27], a[128:131], v[64:67]
ds_read_b64_tr_b16 v[32:33], v36 offset:40960
v_mfma_f32_16x16x32_bf16 v[64:67], v[20:23], a[144:147], v[64:67]
ds_read_b64_tr_b16 v[34:35], v36 offset:41472
v_mfma_f32_16x16x32_bf16 v[68:71], v[20:23], a[148:151], v[68:71]
ds_read_b64_tr_b16 v[28:29], v36 offset:45056
v_mfma_f32_16x16x32_bf16 v[68:71], v[24:27], a[132:135], v[68:71]
buffer_load_dwordx4 v10, s[8:11], s60 offen offset:0 lds
v_mfma_f32_16x16x32_bf16 v[72:75], v[24:27], a[136:139], v[72:75]
ds_read_b64_tr_b16 v[30:31], v36 offset:45568
v_mfma_f32_16x16x32_bf16 v[72:75], v[20:23], a[152:155], v[72:75]
buffer_load_dwordx4 v11, s[8:11], s60 offen offset:1024 lds
v_mfma_f32_16x16x32_bf16 v[76:79], v[20:23], a[156:159], v[76:79]
v_pk_mul_f32 v[224:225], v[224:225], s[34:35]
v_pk_mul_f32 v[226:227], v[226:227], s[34:35]
v_mfma_f32_16x16x32_bf16 v[76:79], v[24:27], a[140:143], v[76:79]
v_pk_mul_f32 v[240:241], v[240:241], s[34:35]
v_pk_mul_f32 v[242:243], v[242:243], s[34:35]
s_waitcnt lgkmcnt(4)
v_mfma_f32_16x16x32_bf16 v[80:83], v[52:55], a[128:131], v[80:83]
ds_read_b64_tr_b16 v[20:21], v37 offset:40960
v_cvt_pk_bf16_f32 v224, v224, v225
v_mfma_f32_16x16x32_bf16 v[80:83], v[48:51], a[144:147], v[80:83]
ds_read_b64_tr_b16 v[22:23], v37 offset:41472
v_cvt_pk_bf16_f32 v225, v226, v227
v_mfma_f32_16x16x32_bf16 v[84:87], v[48:51], a[148:151], v[84:87]
ds_read_b64_tr_b16 v[24:25], v37 offset:45056
v_cvt_pk_bf16_f32 v226, v240, v241
v_mfma_f32_16x16x32_bf16 v[84:87], v[52:55], a[132:135], v[84:87]
v_cvt_pk_bf16_f32 v227, v242, v243
s_add_u32 s61, s33, 0
v_mfma_f32_16x16x32_bf16 v[88:91], v[52:55], a[136:139], v[88:91]
ds_read_b64_tr_b16 v[26:27], v37 offset:45568
buffer_store_dwordx4 v[224:227], v1, s[12:15], s61 offen offset:1024 sc1
v_mfma_f32_16x16x32_bf16 v[88:91], v[48:51], a[152:155], v[88:91]
buffer_load_dwordx4 v12, s[8:11], s60 offen offset:2048 lds
v_mfma_f32_16x16x32_bf16 v[92:95], v[48:51], a[156:159], v[92:95]
buffer_load_dwordx4 v13, s[8:11], s60 offen offset:3072 lds
v_mfma_f32_16x16x32_bf16 v[92:95], v[52:55], a[140:143], v[92:95]
s_waitcnt vmcnt(14) lgkmcnt(4)
s_barrier
v_mfma_f32_16x16x32_bf16 v[64:67], v[32:35], a[160:163], v[64:67]
ds_read_b64_tr_b16 v[48:49], v36 offset:49152
v_mfma_f32_16x16x32_bf16 v[64:67], v[28:31], a[176:179], v[64:67]
ds_read_b64_tr_b16 v[50:51], v36 offset:49664
v_mfma_f32_16x16x32_bf16 v[68:71], v[28:31], a[180:183], v[68:71]
ds_read_b64_tr_b16 v[52:53], v36 offset:53248
s_add_u32 s60, s56, 1048576
v_mfma_f32_16x16x32_bf16 v[68:71], v[32:35], a[164:167], v[68:71]
s_add_u32 m0, s57, 98304
v_mfma_f32_16x16x32_bf16 v[72:75], v[32:35], a[168:171], v[72:75]
ds_read_b64_tr_b16 v[54:55], v36 offset:53760
v_mfma_f32_16x16x32_bf16 v[72:75], v[28:31], a[184:187], v[72:75]
buffer_load_dwordx4 v10, s[8:11], s60 offen offset:0 lds
v_mfma_f32_16x16x32_bf16 v[76:79], v[28:31], a[188:191], v[76:79]
v_pk_mul_f32 v[228:229], v[228:229], s[34:35]
v_pk_mul_f32 v[230:231], v[230:231], s[34:35]
v_mfma_f32_16x16x32_bf16 v[76:79], v[32:35], a[172:175], v[76:79]
buffer_load_dwordx4 v11, s[8:11], s60 offen offset:1024 lds
v_pk_mul_f32 v[244:245], v[244:245], s[34:35]
v_pk_mul_f32 v[246:247], v[246:247], s[34:35]
s_waitcnt lgkmcnt(4)
v_mfma_f32_16x16x32_bf16 v[80:83], v[20:23], a[160:163], v[80:83]
ds_read_b64_tr_b16 v[28:29], v37 offset:49152
v_cvt_pk_bf16_f32 v228, v228, v229
v_mfma_f32_16x16x32_bf16 v[80:83], v[24:27], a[176:179], v[80:83]
ds_read_b64_tr_b16 v[30:31], v37 offset:49664
v_cvt_pk_bf16_f32 v229, v230, v231
v_mfma_f32_16x16x32_bf16 v[84:87], v[24:27], a[180:183], v[84:87]
ds_read_b64_tr_b16 v[32:33], v37 offset:53248
v_cvt_pk_bf16_f32 v230, v244, v245
v_mfma_f32_16x16x32_bf16 v[84:87], v[20:23], a[164:167], v[84:87]
v_cvt_pk_bf16_f32 v231, v246, v247
s_add_u32 s61, s33, 4096
v_mfma_f32_16x16x32_bf16 v[88:91], v[20:23], a[168:171], v[88:91]
ds_read_b64_tr_b16 v[34:35], v37 offset:53760
buffer_store_dwordx4 v[228:231], v1, s[12:15], s61 offen offset:1024 sc1
v_mfma_f32_16x16x32_bf16 v[88:91], v[24:27], a[184:187], v[88:91]
buffer_load_dwordx4 v12, s[8:11], s60 offen offset:2048 lds
v_mfma_f32_16x16x32_bf16 v[92:95], v[24:27], a[188:191], v[92:95]
v_mov_b32 v56, 0
v_mov_b32 v57, 0
v_mfma_f32_16x16x32_bf16 v[92:95], v[20:23], a[172:175], v[92:95]
v_mov_b32 v58, 0
s_waitcnt lgkmcnt(4)
v_mfma_f32_16x16x32_bf16 v[64:67], v[48:51], a[192:195], v[64:67]
ds_read_b64_tr_b16 v[24:25], v36 offset:57344
v_mov_b32 v59, 0
v_mfma_f32_16x16x32_bf16 v[64:67], v[52:55], a[208:211], v[64:67]
ds_read_b64_tr_b16 v[26:27], v36 offset:57856
v_mov_b32 v62, 0
v_mfma_f32_16x16x32_bf16 v[68:71], v[52:55], a[212:215], v[68:71]
ds_read_b64_tr_b16 v[20:21], v36 offset:61440
v_mfma_f32_16x16x32_bf16 v[68:71], v[48:51], a[196:199], v[68:71]
buffer_load_dwordx4 v13, s[8:11], s60 offen offset:3072 lds
v_mfma_f32_16x16x32_bf16 v[72:75], v[48:51], a[200:203], v[72:75]
ds_read_b64_tr_b16 v[22:23], v36 offset:61952
v_mfma_f32_16x16x32_bf16 v[72:75], v[52:55], a[216:219], v[72:75]
v_mfma_f32_16x16x32_bf16 v[76:79], v[52:55], a[220:223], v[76:79]
s_add_u32 s60, s56, 1572864
s_add_u32 m0, s57, 114688
s_nop 0
buffer_load_dwordx4 v10, s[8:11], s60 offen offset:0 lds
v_pk_mul_f32 v[232:233], v[232:233], s[34:35]
v_pk_mul_f32 v[234:235], v[234:235], s[34:35]
v_mfma_f32_16x16x32_bf16 v[76:79], v[48:51], a[204:207], v[76:79]
v_pk_mul_f32 v[248:249], v[248:249], s[34:35]
v_pk_mul_f32 v[250:251], v[250:251], s[34:35]
s_waitcnt lgkmcnt(4)
v_mfma_f32_16x16x32_bf16 v[80:83], v[28:31], a[192:195], v[80:83]
ds_read_b64_tr_b16 v[52:53], v37 offset:57344
v_cvt_pk_bf16_f32 v232, v232, v233
v_mfma_f32_16x16x32_bf16 v[80:83], v[32:35], a[208:211], v[80:83]
ds_read_b64_tr_b16 v[54:55], v37 offset:57856
v_cvt_pk_bf16_f32 v233, v234, v235
v_mfma_f32_16x16x32_bf16 v[84:87], v[32:35], a[212:215], v[84:87]
ds_read_b64_tr_b16 v[48:49], v37 offset:61440
v_cvt_pk_bf16_f32 v234, v248, v249
v_mfma_f32_16x16x32_bf16 v[84:87], v[28:31], a[196:199], v[84:87]
v_cvt_pk_bf16_f32 v235, v250, v251
s_add_u32 s61, s33, 8192
v_mfma_f32_16x16x32_bf16 v[88:91], v[28:31], a[200:203], v[88:91]
ds_read_b64_tr_b16 v[50:51], v37 offset:61952
buffer_store_dwordx4 v[232:235], v1, s[12:15], s61 offen offset:1024 sc1
v_mfma_f32_16x16x32_bf16 v[88:91], v[32:35], a[216:219], v[88:91]
buffer_load_dwordx4 v11, s[8:11], s60 offen offset:1024 lds
v_mfma_f32_16x16x32_bf16 v[92:95], v[32:35], a[220:223], v[92:95]
v_mfma_f32_16x16x32_bf16 v[92:95], v[28:31], a[204:207], v[92:95]
s_waitcnt lgkmcnt(4)
v_mfma_f32_16x16x32_bf16 v[64:67], v[24:27], a[224:227], v[64:67]
ds_read_b64_tr_b16 v[32:33], v38 offset:0
s_waitcnt vmcnt(19)
v_mfma_f32_16x16x32_bf16 v[64:67], v[20:23], a[240:243], v[64:67]
ds_read_b64_tr_b16 v[34:35], v38 offset:512
v_cmp_ne_u32 vcc, s82, v7
v_mfma_f32_16x16x32_bf16 v[68:71], v[20:23], a[244:247], v[68:71]
ds_read_b64_tr_b16 v[28:29], v38 offset:4096
v_mfma_f32_16x16x32_bf16 v[68:71], v[24:27], a[228:231], v[68:71]
s_nop 1
s_cbranch_vccnz L_xsp0
L_xsr0:
v_mfma_f32_16x16x32_bf16 v[72:75], v[24:27], a[232:235], v[72:75]
ds_read_b64_tr_b16 v[30:31], v38 offset:4608
v_mfma_f32_16x16x32_bf16 v[72:75], v[20:23], a[248:251], v[72:75]
buffer_load_dwordx4 v12, s[8:11], s60 offen offset:2048 lds
v_mfma_f32_16x16x32_bf16 v[76:79], v[20:23], a[252:255], v[76:79]
buffer_load_dwordx4 v13, s[8:11], s60 offen offset:3072 lds
s_add_u32 s44, s30, 0
s_add_u32 s45, s30, 18432
s_add_u32 s46, s30, 36864
v_pk_mul_f32 v[236:237], v[236:237], s[34:35]
v_pk_mul_f32 v[238:239], v[238:239], s[34:35]
v_mfma_f32_16x16x32_bf16 v[76:79], v[24:27], a[236:239], v[76:79]
s_add_u32 s47, s30, 55296
v_pk_mul_f32 v[252:253], v[252:253], s[34:35]
v_pk_mul_f32 v[254:255], v[254:255], s[34:35]
s_waitcnt lgkmcnt(4)
v_mfma_f32_16x16x32_bf16 v[80:83], v[52:55], a[224:227], v[80:83]
ds_read_b64_tr_b16 v[20:21], v39 offset:0
v_cvt_pk_bf16_f32 v236, v236, v237
v_mfma_f32_16x16x32_bf16 v[80:83], v[48:51], a[240:243], v[80:83]
ds_read_b64_tr_b16 v[22:23], v39 offset:512
v_cvt_pk_bf16_f32 v237, v238, v239
v_mfma_f32_16x16x32_bf16 v[84:87], v[48:51], a[244:247], v[84:87]
ds_read_b64_tr_b16 v[24:25], v39 offset:4096
v_cvt_pk_bf16_f32 v238, v252, v253
v_mfma_f32_16x16x32_bf16 v[84:87], v[52:55], a[228:231], v[84:87]
v_cvt_pk_bf16_f32 v239, v254, v255
s_add_u32 s61, s33, 12288
v_mfma_f32_16x16x32_bf16 v[88:91], v[52:55], a[232:235], v[88:91]
ds_read_b64_tr_b16 v[26:27], v39 offset:4608
buffer_store_dwordx4 v[236:239], v1, s[12:15], s61 offen offset:1024 sc1
v_mfma_f32_16x16x32_bf16 v[88:91], v[48:51], a[248:251], v[88:91]
v_mfma_f32_16x16x32_bf16 v[92:95], v[48:51], a[252:255], v[92:95]
v_mfma_f32_16x16x32_bf16 v[92:95], v[52:55], a[236:239], v[92:95]
s_waitcnt lgkmcnt(4)
v_mfma_f32_16x16x32_bf16 v[96:99], v[32:35], a[0:3], 0
ds_read_b64_tr_b16 v[48:49], v38 offset:8192
v_mfma_f32_16x16x32_bf16 v[96:99], v[28:31], a[16:19], v[96:99]
ds_read_b64_tr_b16 v[50:51], v38 offset:8704
v_mfma_f32_16x16x32_bf16 v[100:103], v[28:31], a[20:23], 0
ds_read_b64_tr_b16 v[52:53], v38 offset:12288
v_mfma_f32_16x16x32_bf16 v[100:103], v[32:35], a[4:7], v[100:103]
v_mfma_f32_16x16x32_bf16 v[104:107], v[32:35], a[8:11], 0
ds_read_b64_tr_b16 v[54:55], v38 offset:12800
v_mfma_f32_16x16x32_bf16 v[104:107], v[28:31], a[24:27], v[104:107]
v_mfma_f32_16x16x32_bf16 v[108:111], v[28:31], a[28:31], 0
v_pk_mul_f32 v[64:65], v[64:65], s[34:35]
v_pk_mul_f32 v[66:67], v[66:67], s[34:35]
v_mfma_f32_16x16x32_bf16 v[108:111], v[32:35], a[12:15], v[108:111]
v_pk_mul_f32 v[80:81], v[80:81], s[34:35]
v_pk_mul_f32 v[82:83], v[82:83], s[34:35]
s_waitcnt lgkmcnt(4)
v_mfma_f32_16x16x32_bf16 v[112:115], v[20:23], a[0:3], 0
ds_read_b64_tr_b16 v[28:29], v39 offset:8192
v_cvt_pk_bf16_f32 v64, v64, v65
v_mfma_f32_16x16x32_bf16 v[112:115], v[24:27], a[16:19], v[112:115]
ds_read_b64_tr_b16 v[30:31], v39 offset:8704
v_cvt_pk_bf16_f32 v65, v66, v67
v_mfma_f32_16x16x32_bf16 v[116:119], v[24:27], a[20:23], 0
ds_read_b64_tr_b16 v[32:33], v39 offset:12288
v_cvt_pk_bf16_f32 v66, v80, v81
v_mfma_f32_16x16x32_bf16 v[116:119], v[20:23], a[4:7], v[116:119]
v_cvt_pk_bf16_f32 v67, v82, v83
s_add_u32 s61, s33, 0
v_mfma_f32_16x16x32_bf16 v[120:123], v[20:23], a[8:11], 0
ds_read_b64_tr_b16 v[34:35], v39 offset:12800
buffer_store_dwordx4 v[64:67], v1, s[12:15], s61 offen offset:2048 sc1
v_mfma_f32_16x16x32_bf16 v[120:123], v[24:27], a[24:27], v[120:123]
v_mfma_f32_16x16x32_bf16 v[124:127], v[24:27], a[28:31], 0
v_mfma_f32_16x16x32_bf16 v[124:127], v[20:23], a[12:15], v[124:127]
s_waitcnt lgkmcnt(4)
v_mfma_f32_16x16x32_bf16 v[96:99], v[48:51], a[32:35], v[96:99]
ds_read_b64_tr_b16 v[24:25], v38 offset:16384
v_mfma_f32_16x16x32_bf16 v[96:99], v[52:55], a[48:51], v[96:99]
ds_read_b64_tr_b16 v[26:27], v38 offset:16896
v_mfma_f32_16x16x32_bf16 v[100:103], v[52:55], a[52:55], v[100:103]
ds_read_b64_tr_b16 v[20:21], v38 offset:20480
v_mfma_f32_16x16x32_bf16 v[100:103], v[48:51], a[36:39], v[100:103]
buffer_load_dwordx4 a[0:3], v1, s[12:15], s44 offen offset:0 sc1
v_mfma_f32_16x16x32_bf16 v[104:107], v[48:51], a[40:43], v[104:107]
ds_read_b64_tr_b16 v[22:23], v38 offset:20992
v_mfma_f32_16x16x32_bf16 v[104:107], v[52:55], a[56:59], v[104:107]
v_mfma_f32_16x16x32_bf16 v[108:111], v[52:55], a[60:63], v[108:111]
buffer_load_dwordx4 a[4:7], v1, s[12:15], s45 offen offset:0 sc1
v_mfma_f32_16x16x32_bf16 v[108:111], v[48:51], a[44:47], v[108:111]
s_waitcnt lgkmcnt(4)
v_mfma_f32_16x16x32_bf16 v[112:115], v[28:31], a[32:35], v[112:115]
ds_read_b64_tr_b16 v[52:53], v39 offset:16384
v_mfma_f32_16x16x32_bf16 v[112:115], v[32:35], a[48:51], v[112:115]
ds_read_b64_tr_b16 v[54:55], v39 offset:16896
v_mfma_f32_16x16x32_bf16 v[116:119], v[32:35], a[52:55], v[116:119]
ds_read_b64_tr_b16 v[48:49], v39 offset:20480
v_pk_mul_f32 v[68:69], v[68:69], s[34:35]
v_mfma_f32_16x16x32_bf16 v[116:119], v[28:31], a[36:39], v[116:119]
buffer_load_dwordx4 a[8:11], v1, s[12:15], s46 offen offset:0 sc1
v_pk_mul_f32 v[70:71], v[70:71], s[34:35]
v_pk_mul_f32 v[84:85], v[84:85], s[34:35]
v_mfma_f32_16x16x32_bf16 v[120:123], v[28:31], a[40:43], v[120:123]
ds_read_b64_tr_b16 v[50:51], v39 offset:20992
v_pk_mul_f32 v[86:87], v[86:87], s[34:35]
v_mfma_f32_16x16x32_bf16 v[120:123], v[32:35], a[56:59], v[120:123]
v_cvt_pk_bf16_f32 v68, v68, v69
v_cvt_pk_bf16_f32 v69, v70, v71
v_mfma_f32_16x16x32_bf16 v[124:127], v[32:35], a[60:63], v[124:127]
v_cvt_pk_bf16_f32 v70, v84, v85
v_cvt_pk_bf16_f32 v71, v86, v87
v_mfma_f32_16x16x32_bf16 v[124:127], v[28:31], a[44:47], v[124:127]
s_add_u32 s61, s33, 4096
buffer_store_dwordx4 v[68:71], v1, s[12:15], s61 offen offset:2048 sc1
s_waitcnt lgkmcnt(4)
v_mfma_f32_16x16x32_bf16 v[96:99], v[24:27], a[64:67], v[96:99]
ds_read_b64_tr_b16 v[32:33], v38 offset:24576
v_mfma_f32_16x16x32_bf16 v[96:99], v[20:23], a[80:83], v[96:99]
ds_read_b64_tr_b16 v[34:35], v38 offset:25088
v_mfma_f32_16x16x32_bf16 v[100:103], v[20:23], a[84:87], v[100:103]
ds_read_b64_tr_b16 v[28:29], v38 offset:28672
v_mfma_f32_16x16x32_bf16 v[100:103], v[24:27], a[68:71], v[100:103]
buffer_load_dwordx4 a[12:15], v1, s[12:15], s47 offen offset:0 sc1
v_mfma_f32_16x16x32_bf16 v[104:107], v[24:27], a[72:75], v[104:107]
ds_read_b64_tr_b16 v[30:31], v38 offset:29184
v_mfma_f32_16x16x32_bf16 v[104:107], v[20:23], a[88:91], v[104:107]
buffer_load_dwordx4 a[16:19], v1, s[12:15], s44 offen offset:1024 sc1
v_mfma_f32_16x16x32_bf16 v[108:111], v[20:23], a[92:95], v[108:111]
v_mfma_f32_16x16x32_bf16 v[108:111], v[24:27], a[76:79], v[108:111]
s_waitcnt lgkmcnt(4)
v_mfma_f32_16x16x32_bf16 v[112:115], v[52:55], a[64:67], v[112:115]
ds_read_b64_tr_b16 v[20:21], v39 offset:24576
v_mfma_f32_16x16x32_bf16 v[112:115], v[48:51], a[80:83], v[112:115]
ds_read_b64_tr_b16 v[22:23], v39 offset:25088
v_mfma_f32_16x16x32_bf16 v[116:119], v[48:51], a[84:87], v[116:119]
ds_read_b64_tr_b16 v[24:25], v39 offset:28672
v_mfma_f32_16x16x32_bf16 v[116:119], v[52:55], a[68:71], v[116:119]
buffer_load_dwordx4 a[20:23], v1, s[12:15], s45 offen offset:1024 sc1
v_mfma_f32_16x16x32_bf16 v[120:123], v[52:55], a[72:75], v[120:123]
ds_read_b64_tr_b16 v[26:27], v39 offset:29184
v_mfma_f32_16x16x32_bf16 v[120:123], v[48:51], a[88:91], v[120:123]
v_mfma_f32_16x16x32_bf16 v[124:127], v[48:51], a[92:95], v[124:127]
v_pk_mul_f32 v[72:73], v[72:73], s[34:35]
v_pk_mul_f32 v[74:75], v[74:75], s[34:35]
v_mfma_f32_16x16x32_bf16 v[124:127], v[52:55], a[76:79], v[124:127]
buffer_load_dwordx4 a[24:27], v1, s[12:15], s46 offen offset:1024 sc1
v_pk_mul_f32 v[88:89], v[88:89], s[34:35]
v_pk_mul_f32 v[90:91], v[90:91], s[34:35]
s_waitcnt lgkmcnt(4)
v_mfma_f32_16x16x32_bf16 v[96:99], v[32:35], a[96:99], v[96:99]
ds_read_b64_tr_b16 v[48:49], v38 offset:32768
v_cvt_pk_bf16_f32 v72, v72, v73
v_mfma_f32_16x16x32_bf16 v[96:99], v[28:31], a[112:115], v[96:99]
ds_read_b64_tr_b16 v[50:51], v38 offset:33280
v_cvt_pk_bf16_f32 v73, v74, v75
v_mfma_f32_16x16x32_bf16 v[100:103], v[28:31], a[116:119], v[100:103]
ds_read_b64_tr_b16 v[52:53], v38 offset:36864
v_cvt_pk_bf16_f32 v74, v88, v89
v_mfma_f32_16x16x32_bf16 v[100:103], v[32:35], a[100:103], v[100:103]
v_cvt_pk_bf16_f32 v75, v90, v91
s_add_u32 s61, s33, 8192
v_mfma_f32_16x16x32_bf16 v[104:107], v[32:35], a[104:107], v[104:107]
ds_read_b64_tr_b16 v[54:55], v38 offset:37376
buffer_store_dwordx4 v[72:75], v1, s[12:15], s61 offen offset:2048 sc1
v_mfma_f32_16x16x32_bf16 v[104:107], v[28:31], a[120:123], v[104:107]
buffer_load_dwordx4 a[28:31], v1, s[12:15], s47 offen offset:1024 sc1
v_mfma_f32_16x16x32_bf16 v[108:111], v[28:31], a[124:127], v[108:111]
v_mfma_f32_16x16x32_bf16 v[108:111], v[32:35], a[108:111], v[108:111]
s_waitcnt lgkmcnt(4)
v_mfma_f32_16x16x32_bf16 v[112:115], v[20:23], a[96:99], v[112:115]
ds_read_b64_tr_b16 v[28:29], v39 offset:32768
v_mfma_f32_16x16x32_bf16 v[112:115], v[24:27], a[112:115], v[112:115]
ds_read_b64_tr_b16 v[30:31], v39 offset:33280
v_mfma_f32_16x16x32_bf16 v[116:119], v[24:27], a[116:119], v[116:119]
ds_read_b64_tr_b16 v[32:33], v39 offset:36864
v_mfma_f32_16x16x32_bf16 v[116:119], v[20:23], a[100:103], v[116:119]
buffer_load_dwordx4 a[32:35], v1, s[12:15], s44 offen offset:2048 sc1
v_mfma_f32_16x16x32_bf16 v[120:123], v[20:23], a[104:107], v[120:123]
ds_read_b64_tr_b16 v[34:35], v39 offset:37376
v_mfma_f32_16x16x32_bf16 v[120:123], v[24:27], a[120:123], v[120:123]
v_mfma_f32_16x16x32_bf16 v[124:127], v[24:27], a[124:127], v[124:127]
buffer_load_dwordx4 a[36:39], v1, s[12:15], s45 offen offset:2048 sc1
v_mfma_f32_16x16x32_bf16 v[124:127], v[20:23], a[108:111], v[124:127]
s_waitcnt lgkmcnt(4)
v_mfma_f32_16x16x32_bf16 v[96:99], v[48:51], a[128:131], v[96:99]
ds_read_b64_tr_b16 v[24:25], v38 offset:40960
v_mfma_f32_16x16x32_bf16 v[96:99], v[52:55], a[144:147], v[96:99]
ds_read_b64_tr_b16 v[26:27], v38 offset:41472
v_mfma_f32_16x16x32_bf16 v[100:103], v[52:55], a[148:151], v[100:103]
ds_read_b64_tr_b16 v[20:21], v38 offset:45056
v_pk_mul_f32 v[76:77], v[76:77], s[34:35]
v_mfma_f32_16x16x32_bf16 v[100:103], v[48:51], a[132:135], v[100:103]
buffer_load_dwordx4 a[40:43], v1, s[12:15], s46 offen offset:2048 sc1
v_pk_mul_f32 v[78:79], v[78:79], s[34:35]
v_pk_mul_f32 v[92:93], v[92:93], s[34:35]
v_mfma_f32_16x16x32_bf16 v[104:107], v[48:51], a[136:139], v[104:107]
ds_read_b64_tr_b16 v[22:23], v38 offset:45568
v_pk_mul_f32 v[94:95], v[94:95], s[34:35]
v_mfma_f32_16x16x32_bf16 v[104:107], v[52:55], a[152:155], v[104:107]
v_cvt_pk_bf16_f32 v76, v76, v77
v_cvt_pk_bf16_f32 v77, v78, v79
v_mfma_f32_16x16x32_bf16 v[108:111], v[52:55], a[156:159], v[108:111]
v_cvt_pk_bf16_f32 v78, v92, v93
v_cvt_pk_bf16_f32 v79, v94, v95
v_mfma_f32_16x16x32_bf16 v[108:111], v[48:51], a[140:143], v[108:111]
s_add_u32 s61, s33, 12288
buffer_store_dwordx4 v[76:79], v1, s[12:15], s61 offen offset:2048 sc1
s_waitcnt lgkmcnt(4)
v_mfma_f32_16x16x32_bf16 v[112:115], v[28:31], a[128:131], v[112:115]
ds_read_b64_tr_b16 v[52:53], v39 offset:40960
v_mfma_f32_16x16x32_bf16 v[112:115], v[32:35], a[144:147], v[112:115]
ds_read_b64_tr_b16 v[54:55], v39 offset:41472
v_mfma_f32_16x16x32_bf16 v[116:119], v[32:35], a[148:151], v[116:119]
ds_read_b64_tr_b16 v[48:49], v39 offset:45056
v_mfma_f32_16x16x32_bf16 v[116:119], v[28:31], a[132:135], v[116:119]
buffer_load_dwordx4 a[44:47], v1, s[12:15], s47 offen offset:2048 sc1
v_mfma_f32_16x16x32_bf16 v[120:123], v[28:31], a[136:139], v[120:123]
ds_read_b64_tr_b16 v[50:51], v39 offset:45568
v_mfma_f32_16x16x32_bf16 v[120:123], v[32:35], a[152:155], v[120:123]
buffer_load_dwordx4 a[48:51], v1, s[12:15], s44 offen offset:3072 sc1
v_mfma_f32_16x16x32_bf16 v[124:127], v[32:35], a[156:159], v[124:127]
v_mfma_f32_16x16x32_bf16 v[124:127], v[28:31], a[140:143], v[124:127]
s_waitcnt lgkmcnt(4)
v_mfma_f32_16x16x32_bf16 v[96:99], v[24:27], a[160:163], v[96:99]
ds_read_b64_tr_b16 v[32:33], v38 offset:49152
v_mfma_f32_16x16x32_bf16 v[96:99], v[20:23], a[176:179], v[96:99]
ds_read_b64_tr_b16 v[34:35], v38 offset:49664
v_mfma_f32_16x16x32_bf16 v[100:103], v[20:23], a[180:183], v[100:103]
ds_read_b64_tr_b16 v[28:29], v38 offset:53248
v_mfma_f32_16x16x32_bf16 v[100:103], v[24:27], a[164:167], v[100:103]
buffer_load_dwordx4 a[52:55], v1, s[12:15], s45 offen offset:3072 sc1
v_mfma_f32_16x16x32_bf16 v[104:107], v[24:27], a[168:171], v[104:107]
ds_read_b64_tr_b16 v[30:31], v38 offset:53760
v_mfma_f32_16x16x32_bf16 v[104:107], v[20:23], a[184:187], v[104:107]
v_mfma_f32_16x16x32_bf16 v[108:111], v[20:23], a[188:191], v[108:111]
v_mfma_f32_16x16x32_bf16 v[108:111], v[24:27], a[172:175], v[108:111]
s_waitcnt lgkmcnt(4)
v_mfma_f32_16x16x32_bf16 v[112:115], v[52:55], a[160:163], v[112:115]
ds_read_b64_tr_b16 v[20:21], v39 offset:49152
v_mfma_f32_16x16x32_bf16 v[112:115], v[48:51], a[176:179], v[112:115]
ds_read_b64_tr_b16 v[22:23], v39 offset:49664
v_mfma_f32_16x16x32_bf16 v[116:119], v[48:51], a[180:183], v[116:119]
ds_read_b64_tr_b16 v[24:25], v39 offset:53248
buffer_load_dwordx4 a[56:59], v1, s[12:15], s46 offen offset:3072 sc1
v_mfma_f32_16x16x32_bf16 v[116:119], v[52:55], a[164:167], v[116:119]
v_mfma_f32_16x16x32_bf16 v[120:123], v[52:55], a[168:171], v[120:123]
ds_read_b64_tr_b16 v[26:27], v39 offset:53760
v_mfma_f32_16x16x32_bf16 v[120:123], v[48:51], a[184:187], v[120:123]
buffer_load_dwordx4 a[60:63], v1, s[12:15], s47 offen offset:3072 sc1
v_mfma_f32_16x16x32_bf16 v[124:127], v[48:51], a[188:191], v[124:127]
s_add_u32 s44, s30, 4096
s_add_u32 s45, s30, 22528
s_add_u32 s46, s30, 40960
v_mfma_f32_16x16x32_bf16 v[124:127], v[52:55], a[172:175], v[124:127]
s_add_u32 s47, s30, 59392
s_waitcnt lgkmcnt(4)
v_mfma_f32_16x16x32_bf16 v[96:99], v[32:35], a[192:195], v[96:99]
ds_read_b64_tr_b16 v[48:49], v38 offset:57344
v_mfma_f32_16x16x32_bf16 v[96:99], v[28:31], a[208:211], v[96:99]
ds_read_b64_tr_b16 v[50:51], v38 offset:57856
v_mfma_f32_16x16x32_bf16 v[100:103], v[28:31], a[212:215], v[100:103]
ds_read_b64_tr_b16 v[52:53], v38 offset:61440
v_mfma_f32_16x16x32_bf16 v[100:103], v[32:35], a[196:199], v[100:103]
buffer_load_dwordx4 a[64:67], v1, s[12:15], s44 offen offset:0 sc1
v_mfma_f32_16x16x32_bf16 v[104:107], v[32:35], a[200:203], v[104:107]
ds_read_b64_tr_b16 v[54:55], v38 offset:61952
v_mfma_f32_16x16x32_bf16 v[104:107], v[28:31], a[216:219], v[104:107]
v_mfma_f32_16x16x32_bf16 v[108:111], v[28:31], a[220:223], v[108:111]
ds_read_b64_tr_b16 v[28:29], v39 offset:57344
v_mfma_f32_16x16x32_bf16 v[108:111], v[32:35], a[204:207], v[108:111]
s_waitcnt lgkmcnt(5)
v_mfma_f32_16x16x32_bf16 v[112:115], v[20:23], a[192:195], v[112:115]
ds_read_b64_tr_b16 v[30:31], v39 offset:57856
v_mfma_f32_16x16x32_bf16 v[112:115], v[24:27], a[208:211], v[112:115]
ds_read_b64_tr_b16 v[32:33], v39 offset:61440
buffer_load_dwordx4 a[68:71], v1, s[12:15], s45 offen offset:0 sc1
v_mfma_f32_16x16x32_bf16 v[116:119], v[24:27], a[212:215], v[116:119]
ds_read_b64_tr_b16 v[34:35], v39 offset:61952
v_mfma_f32_16x16x32_bf16 v[116:119], v[20:23], a[196:199], v[116:119]
s_waitcnt vmcnt(38)
s_barrier
v_mfma_f32_16x16x32_bf16 v[120:123], v[20:23], a[200:203], v[120:123]
buffer_load_dwordx4 a[72:75], v1, s[12:15], s46 offen offset:0 sc1
v_mfma_f32_16x16x32_bf16 v[120:123], v[24:27], a[216:219], v[120:123]
v_mfma_f32_16x16x32_bf16 v[124:127], v[24:27], a[220:223], v[124:127]
ds_read_b64_tr_b16 v[64:65], v40 offset:0
ds_read_b64_tr_b16 v[66:67], v40 offset:512
v_mfma_f32_16x16x32_bf16 v[124:127], v[20:23], a[204:207], v[124:127]
ds_read_b64_tr_b16 v[68:69], v40 offset:4096
s_waitcnt lgkmcnt(7)
v_mfma_f32_16x16x32_bf16 v[96:99], v[48:51], a[224:227], v[96:99]
buffer_load_dwordx4 a[76:79], v1, s[12:15], s47 offen offset:0 sc1
v_mfma_f32_16x16x32_bf16 v[96:99], v[52:55], a[240:243], v[96:99]
ds_read_b64_tr_b16 v[70:71], v40 offset:4608
s_waitcnt lgkmcnt(4)
v_mfma_f32_16x16x32_bf16 v[112:115], v[28:31], a[224:227], v[112:115]
ds_read_b64_tr_b16 v[72:73], v41 offset:0
ds_read_b64_tr_b16 v[74:75], v41 offset:512
v_mfma_f32_16x16x32_bf16 v[112:115], v[32:35], a[240:243], v[112:115]
ds_read_b64_tr_b16 v[76:77], v41 offset:4096
ds_read_b64_tr_b16 v[78:79], v41 offset:4608
v_mfma_f32_16x16x32_bf16 v[100:103], v[52:55], a[244:247], v[100:103]
v_mfma_f32_16x16x32_bf16 v[100:103], v[48:51], a[228:231], v[100:103]
v_mfma_f32_16x16x32_bf16 v[116:119], v[32:35], a[244:247], v[116:119]
v_pk_mul_f32 v[96:97], v[96:97], s[34:35]
v_pk_mul_f32 v[98:99], v[98:99], s[34:35]
s_nop 0
v_pk_mul_f32 v[112:113], v[112:113], s[34:35]
v_pk_mul_f32 v[114:115], v[114:115], s[34:35]
v_cvt_pk_bf16_f32 v96, v96, v97
v_mfma_f32_16x16x32_bf16 v[116:119], v[28:31], a[228:231], v[116:119]
v_cvt_pk_bf16_f32 v97, v98, v99
v_cvt_pk_bf16_f32 v98, v112, v113
v_cvt_pk_bf16_f32 v99, v114, v115
s_add_u32 s61, s33, 0
v_mfma_f32_16x16x32_bf16 v[104:107], v[48:51], a[232:235], v[104:107]
v_mfma_f32_16x16x32_bf16 v[104:107], v[52:55], a[248:251], v[104:107]
v_mfma_f32_16x16x32_bf16 v[120:123], v[28:31], a[232:235], v[120:123]
v_mfma_f32_16x16x32_bf16 v[120:123], v[32:35], a[248:251], v[120:123]
v_mfma_f32_16x16x32_bf16 v[108:111], v[52:55], a[252:255], v[108:111]
v_mfma_f32_16x16x32_bf16 v[108:111], v[48:51], a[236:239], v[108:111]
v_mfma_f32_16x16x32_bf16 v[124:127], v[32:35], a[252:255], v[124:127]
v_mfma_f32_16x16x32_bf16 v[124:127], v[28:31], a[236:239], v[124:127]
s_waitcnt vmcnt(13) lgkmcnt(4)
v_mfma_f32_16x16x32_bf16 v[128:131], v[64:67], a[0:3], 0
ds_read_b64_tr_b16 v[80:81], v42 offset:0
buffer_store_dwordx4 v[96:99], v1, s[12:15], s61 offen offset:3072 sc1
v_pk_mul_f32 v[100:101], v[100:101], s[34:35]
v_pk_mul_f32 v[102:103], v[102:103], s[34:35]
v_pk_mul_f32 v[116:117], v[116:117], s[34:35]
v_pk_mul_f32 v[118:119], v[118:119], s[34:35]
v_cvt_pk_bf16_f32 v100, v100, v101
v_cvt_pk_bf16_f32 v101, v102, v103
v_cvt_pk_bf16_f32 v102, v116, v117
v_cvt_pk_bf16_f32 v103, v118, v119
s_add_u32 s61, s33, 4096
buffer_store_dwordx4 v[100:103], v1, s[12:15], s61 offen offset:3072 sc1
v_pk_mul_f32 v[104:105], v[104:105], s[34:35]
v_mfma_f32_16x16x32_bf16 v[128:131], v[68:71], a[16:19], v[128:131]
ds_read_b64_tr_b16 v[82:83], v42 offset:512
v_pk_mul_f32 v[106:107], v[106:107], s[34:35]
v_mfma_f32_16x16x32_bf16 v[160:163], v[68:71], a[20:23], 0
ds_read_b64_tr_b16 v[84:85], v42 offset:4096
v_pk_mul_f32 v[120:121], v[120:121], s[34:35]
v_mfma_f32_16x16x32_bf16 v[160:163], v[64:67], a[4:7], v[160:163]
v_pk_mul_f32 v[122:123], v[122:123], s[34:35]
v_mfma_f32_16x16x32_bf16 v[192:195], v[64:67], a[8:11], 0
ds_read_b64_tr_b16 v[86:87], v42 offset:4608
v_cvt_pk_bf16_f32 v104, v104, v105
v_cvt_pk_bf16_f32 v105, v106, v107
v_cvt_pk_bf16_f32 v106, v120, v121
v_mfma_f32_16x16x32_bf16 v[192:195], v[68:71], a[24:27], v[192:195]
v_cvt_pk_bf16_f32 v107, v122, v123
s_add_u32 s61, s33, 8192
buffer_store_dwordx4 v[104:107], v1, s[12:15], s61 offen offset:3072 sc1
v_mfma_f32_16x16x32_bf16 v[224:227], v[68:71], a[28:31], 0
v_pk_mul_f32 v[108:109], v[108:109], s[34:35]
v_mfma_f32_16x16x32_bf16 v[224:227], v[64:67], a[12:15], v[224:227]
s_waitcnt lgkmcnt(4)
v_pk_mul_f32 v[110:111], v[110:111], s[34:35]
v_mfma_f32_16x16x32_bf16 v[132:135], v[72:75], a[0:3], 0
ds_read_b64_tr_b16 v[64:65], v43 offset:0
v_pk_mul_f32 v[124:125], v[124:125], s[34:35]
v_mfma_f32_16x16x32_bf16 v[132:135], v[76:79], a[16:19], v[132:135]
ds_read_b64_tr_b16 v[66:67], v43 offset:512
v_pk_mul_f32 v[126:127], v[126:127], s[34:35]
v_mfma_f32_16x16x32_bf16 v[164:167], v[76:79], a[20:23], 0
ds_read_b64_tr_b16 v[68:69], v43 offset:4096
v_cvt_pk_bf16_f32 v108, v108, v109
v_mfma_f32_16x16x32_bf16 v[164:167], v[72:75], a[4:7], v[164:167]
v_cvt_pk_bf16_f32 v109, v110, v111
v_cvt_pk_bf16_f32 v110, v124, v125
v_cvt_pk_bf16_f32 v111, v126, v127
v_mfma_f32_16x16x32_bf16 v[196:199], v[72:75], a[8:11], 0
ds_read_b64_tr_b16 v[70:71], v43 offset:4608
s_add_u32 s61, s33, 12288
buffer_store_dwordx4 v[108:111], v1, s[12:15], s61 offen offset:3072 sc1
v_mfma_f32_16x16x32_bf16 v[196:199], v[76:79], a[24:27], v[196:199]
v_mov_b32 v48, 0
v_mov_b32 v49, 0
v_mov_b32 v50, 0
v_mov_b32 v51, 0
v_mfma_f32_16x16x32_bf16 v[228:231], v[76:79], a[28:31], 0
v_mov_b32 v52, 0
v_mov_b32 v53, 0
v_mov_b32 v54, 0
v_mfma_f32_16x16x32_bf16 v[228:231], v[72:75], a[12:15], v[228:231]
s_waitcnt lgkmcnt(4)
v_mov_b32 v55, 0
v_mov_b32 v60, 0
v_mov_b32 v61, 0
v_mov_b32 v63, 0
L_qj:
v_mfma_f32_16x16x32_bf16 v[136:139], v[80:83], a[0:3], 0
ds_read_b64_tr_b16 v[72:73], v40 offset:8192
v_mfma_f32_16x16x32_bf16 v[136:139], v[84:87], a[16:19], v[136:139]
ds_read_b64_tr_b16 v[74:75], v40 offset:8704
v_mfma_f32_16x16x32_bf16 v[168:171], v[84:87], a[20:23], 0
ds_read_b64_tr_b16 v[76:77], v40 offset:12288
v_mfma_f32_16x16x32_bf16 v[168:171], v[80:83], a[4:7], v[168:171]
buffer_load_dwordx4 a[80:83], v1, s[12:15], s44 offen offset:1024 sc1
v_mfma_f32_16x16x32_bf16 v[200:203], v[80:83], a[8:11], 0
ds_read_b64_tr_b16 v[78:79], v40 offset:12800
v_mov_b32 v5, 0xf149f2ca
v_mfma_f32_16x16x32_bf16 v[200:203], v[84:87], a[24:27], v[200:203]
buffer_load_dwordx4 a[84:87], v1, s[12:15], s45 offen offset:1024 sc1
v_mfma_f32_16x16x32_bf16 v[232:235], v[84:87], a[28:31], 0
v_lshrrev_b32 v18, 4, v0
v_lshlrev_b32 v18, 2, v18
v_mfma_f32_16x16x32_bf16 v[232:235], v[80:83], a[12:15], v[232:235]
s_waitcnt lgkmcnt(4)
v_and_b32 v19, 15, v0
v_sub_u32 v18, v19, v18
v_mfma_f32_16x16x32_bf16 v[140:143], v[64:67], a[0:3], 0
ds_read_b64_tr_b16 v[80:81], v41 offset:8192
v_cmp_gt_i32 s[34:35], 0, v18
v_mfma_f32_16x16x32_bf16 v[140:143], v[68:71], a[16:19], v[140:143]
ds_read_b64_tr_b16 v[82:83], v41 offset:8704
v_cmp_gt_i32 s[36:37], 1, v18
v_mfma_f32_16x16x32_bf16 v[172:175], v[68:71], a[20:23], 0
ds_read_b64_tr_b16 v[84:85], v41 offset:12288
v_cmp_gt_i32 s[38:39], 2, v18
v_mfma_f32_16x16x32_bf16 v[172:175], v[64:67], a[4:7], v[172:175]
v_cmp_gt_i32 s[40:41], 3, v18
v_mov_b32 v2, v1
v_mfma_f32_16x16x32_bf16 v[204:207], v[64:67], a[8:11], 0
ds_read_b64_tr_b16 v[86:87], v41 offset:12800
v_mov_b32 v3, v1
v_mfma_f32_16x16x32_bf16 v[204:207], v[68:71], a[24:27], v[204:207]
v_mov_b32 v20, 0
v_mov_b32 v21, 0
v_mfma_f32_16x16x32_bf16 v[236:239], v[68:71], a[28:31], 0
v_mov_b32 v22, 0
v_mov_b32 v23, 0
v_mfma_f32_16x16x32_bf16 v[236:239], v[64:67], a[12:15], v[236:239]
s_waitcnt lgkmcnt(4)
v_mov_b32 v18, 0x3f803f80
v_lshlrev_b32 v19, 7, v0
v_mfma_f32_16x16x32_bf16 v[144:147], v[72:75], a[0:3], 0
ds_read_b64_tr_b16 v[64:65], v42 offset:8192
v_cmp_gt_u32 s[50:51], 24, v0
v_mfma_f32_16x16x32_bf16 v[144:147], v[76:79], a[16:19], v[144:147]
ds_read_b64_tr_b16 v[66:67], v42 offset:8704
v_cndmask_b32 v19, v5, v19, s[50:51]
v_mfma_f32_16x16x32_bf16 v[176:179], v[76:79], a[20:23], 0
ds_read_b64_tr_b16 v[68:69], v42 offset:12288
s_lshl_b32 s4, s3, 13
v_mfma_f32_16x16x32_bf16 v[176:179], v[72:75], a[4:7], v[176:179]
s_sub_u32 s5, 0, s4
s_add_u32 s4, s4, 245760
v_mfma_f32_16x16x32_bf16 v[208:211], v[72:75], a[8:11], 0
ds_read_b64_tr_b16 v[70:71], v42 offset:12800
v_mfma_f32_16x16x32_bf16 v[208:211], v[76:79], a[24:27], v[208:211]
s_cmp_lt_u32 s3, 2
s_cselect_b32 s20, s5, s4
s_cselect_b32 s33, s22, 8192
v_mfma_f32_16x16x32_bf16 v[240:243], v[76:79], a[28:31], 0
s_cmp_lt_u32 s3, 2
s_cselect_b32 s42, s22, -8192
s_cselect_b32 s26, 8, s25
v_mfma_f32_16x16x32_bf16 v[240:243], v[72:75], a[12:15], v[240:243]
s_waitcnt lgkmcnt(4)
s_mul_i32 s98, s21, 34
s_add_u32 s98, s98, s20
v_mfma_f32_16x16x32_bf16 v[148:151], v[80:83], a[0:3], 0
ds_read_b64_tr_b16 v[72:73], v43 offset:8192
s_mov_b32 s99, 4096
v_mfma_f32_16x16x32_bf16 v[148:151], v[84:87], a[16:19], v[148:151]
ds_read_b64_tr_b16 v[74:75], v43 offset:8704
s_mov_b64 s[54:55], 0
v_mfma_f32_16x16x32_bf16 v[180:183], v[84:87], a[20:23], 0
ds_read_b64_tr_b16 v[76:77], v43 offset:12288
s_sub_u32 s4, 4, s3
v_mfma_f32_16x16x32_bf16 v[180:183], v[80:83], a[4:7], v[180:183]
s_cmp_lt_u32 s3, 2
s_cselect_b32 s27, 0, s4
s_lshl_b32 s4, s3, 3
v_mfma_f32_16x16x32_bf16 v[212:215], v[80:83], a[8:11], 0
ds_read_b64_tr_b16 v[78:79], v43 offset:12800
s_add_u32 s4, s4, s25
v_mfma_f32_16x16x32_bf16 v[212:215], v[84:87], a[24:27], v[212:215]
s_cmp_eq_u32 s4, 7
s_cselect_b32 s28, 1, -1
v_mfma_f32_16x16x32_bf16 v[244:247], v[84:87], a[28:31], 0
s_cmp_eq_u32 s3, 3
s_cselect_b32 s28, 1, s28
v_mfma_f32_16x16x32_bf16 v[244:247], v[80:83], a[12:15], v[244:247]
s_waitcnt lgkmcnt(4)
s_barrier
v_mfma_f32_16x16x32_bf16 v[152:155], v[64:67], a[0:3], 0
s_cmp_eq_u32 s4, 24
s_cselect_b64 s[50:51], -1, 0
ds_read_b64_tr_b16 v[80:81], v40 offset:16384
v_mfma_f32_16x16x32_bf16 v[152:155], v[68:71], a[16:19], v[152:155]
ds_read_b64_tr_b16 v[82:83], v40 offset:16896
s_and_b32 s4, s3, 1
v_mfma_f32_16x16x32_bf16 v[184:187], v[68:71], a[20:23], 0
ds_read_b64_tr_b16 v[84:85], v40 offset:20480
s_lshl_b32 s4, s4, 14
v_mfma_f32_16x16x32_bf16 v[184:187], v[64:67], a[4:7], v[184:187]
s_add_u32 s4, s4, 131072
v_add_u32 v4, s4, v1
s_add_u32 s86, s6, 65536
v_mfma_f32_16x16x32_bf16 v[216:219], v[64:67], a[8:11], 0
ds_read_b64_tr_b16 v[86:87], v40 offset:20992
v_mfma_f32_16x16x32_bf16 v[216:219], v[68:71], a[24:27], v[216:219]
buffer_load_dwordx4 a[88:91], v1, s[12:15], s46 offen offset:1024 sc1
v_mfma_f32_16x16x32_bf16 v[248:251], v[68:71], a[28:31], 0
buffer_load_dwordx4 a[92:95], v1, s[12:15], s47 offen offset:1024 sc1
v_mfma_f32_16x16x32_bf16 v[248:251], v[64:67], a[12:15], v[248:251]
s_waitcnt lgkmcnt(4)
v_mfma_f32_16x16x32_bf16 v[156:159], v[72:75], a[0:3], 0
ds_read_b64_tr_b16 v[64:65], v41 offset:16384
v_mfma_f32_16x16x32_bf16 v[156:159], v[76:79], a[16:19], v[156:159]
ds_read_b64_tr_b16 v[66:67], v41 offset:16896
v_mfma_f32_16x16x32_bf16 v[188:191], v[76:79], a[20:23], 0
ds_read_b64_tr_b16 v[68:69], v41 offset:20480
v_mfma_f32_16x16x32_bf16 v[188:191], v[72:75], a[4:7], v[188:191]
buffer_load_dwordx4 a[96:99], v1, s[12:15], s44 offen offset:2048 sc1
v_mfma_f32_16x16x32_bf16 v[220:223], v[72:75], a[8:11], 0
ds_read_b64_tr_b16 v[70:71], v41 offset:20992
v_mfma_f32_16x16x32_bf16 v[220:223], v[76:79], a[24:27], v[220:223]
buffer_load_dwordx4 a[100:103], v1, s[12:15], s45 offen offset:2048 sc1
v_mfma_f32_16x16x32_bf16 v[252:255], v[76:79], a[28:31], 0
buffer_load_dwordx4 a[104:107], v1, s[12:15], s46 offen offset:2048 sc1
v_mfma_f32_16x16x32_bf16 v[252:255], v[72:75], a[12:15], v[252:255]
s_waitcnt vmcnt(15) lgkmcnt(4)
v_mfma_f32_16x16x32_bf16 v[128:131], v[80:83], a[32:35], v[128:131]
ds_read_b64_tr_b16 v[72:73], v42 offset:16384
v_mfma_f32_16x16x32_bf16 v[128:131], v[84:87], a[48:51], v[128:131]
ds_read_b64_tr_b16 v[74:75], v42 offset:16896
v_mfma_f32_16x16x32_bf16 v[160:163], v[84:87], a[52:55], v[160:163]
ds_read_b64_tr_b16 v[76:77], v42 offset:20480
v_mfma_f32_16x16x32_bf16 v[160:163], v[80:83], a[36:39], v[160:163]
buffer_load_dwordx4 a[108:111], v1, s[12:15], s47 offen offset:2048 sc1
v_mfma_f32_16x16x32_bf16 v[192:195], v[80:83], a[40:43], v[192:195]
ds_read_b64_tr_b16 v[78:79], v42 offset:20992
v_mfma_f32_16x16x32_bf16 v[192:195], v[84:87], a[56:59], v[192:195]
buffer_load_dwordx4 a[112:115], v1, s[12:15], s44 offen offset:3072 sc1
v_mfma_f32_16x16x32_bf16 v[224:227], v[84:87], a[60:63], v[224:227]
buffer_load_dwordx4 a[116:119], v1, s[12:15], s45 offen offset:3072 sc1
v_mfma_f32_16x16x32_bf16 v[224:227], v[80:83], a[44:47], v[224:227]
s_waitcnt lgkmcnt(4)
v_mfma_f32_16x16x32_bf16 v[132:135], v[64:67], a[32:35], v[132:135]
ds_read_b64_tr_b16 v[80:81], v43 offset:16384
v_mfma_f32_16x16x32_bf16 v[132:135], v[68:71], a[48:51], v[132:135]
ds_read_b64_tr_b16 v[82:83], v43 offset:16896
v_mfma_f32_16x16x32_bf16 v[164:167], v[68:71], a[52:55], v[164:167]
ds_read_b64_tr_b16 v[84:85], v43 offset:20480
v_mfma_f32_16x16x32_bf16 v[164:167], v[64:67], a[36:39], v[164:167]
buffer_load_dwordx4 a[120:123], v1, s[12:15], s46 offen offset:3072 sc1
v_mfma_f32_16x16x32_bf16 v[196:199], v[64:67], a[40:43], v[196:199]
ds_read_b64_tr_b16 v[86:87], v43 offset:20992
v_mfma_f32_16x16x32_bf16 v[196:199], v[68:71], a[56:59], v[196:199]
buffer_load_dwordx4 a[124:127], v1, s[12:15], s47 offen offset:3072 sc1
v_mfma_f32_16x16x32_bf16 v[228:231], v[68:71], a[60:63], v[228:231]
s_add_u32 s60, s56, 2097152
s_add_u32 m0, s57, 131072
v_mfma_f32_16x16x32_bf16 v[228:231], v[64:67], a[44:47], v[228:231]
s_waitcnt lgkmcnt(4)
v_mfma_f32_16x16x32_bf16 v[136:139], v[72:75], a[32:35], v[136:139]
ds_read_b64_tr_b16 v[64:65], v40 offset:24576
v_mfma_f32_16x16x32_bf16 v[136:139], v[76:79], a[48:51], v[136:139]
ds_read_b64_tr_b16 v[66:67], v40 offset:25088
v_mfma_f32_16x16x32_bf16 v[168:171], v[76:79], a[52:55], v[168:171]
ds_read_b64_tr_b16 v[68:69], v40 offset:28672
v_mfma_f32_16x16x32_bf16 v[168:171], v[72:75], a[36:39], v[168:171]
buffer_load_dwordx4 v10, s[8:11], s60 offen offset:0 lds
v_mfma_f32_16x16x32_bf16 v[200:203], v[72:75], a[40:43], v[200:203]
ds_read_b64_tr_b16 v[70:71], v40 offset:29184
v_mfma_f32_16x16x32_bf16 v[200:203], v[76:79], a[56:59], v[200:203]
buffer_load_dwordx4 v11, s[8:11], s60 offen offset:1024 lds
v_mfma_f32_16x16x32_bf16 v[232:235], v[76:79], a[60:63], v[232:235]
buffer_load_dwordx4 v12, s[8:11], s60 offen offset:2048 lds
v_mfma_f32_16x16x32_bf16 v[232:235], v[72:75], a[44:47], v[232:235]
s_waitcnt lgkmcnt(4)
v_mfma_f32_16x16x32_bf16 v[140:143], v[80:83], a[32:35], v[140:143]
ds_read_b64_tr_b16 v[72:73], v41 offset:24576
v_mfma_f32_16x16x32_bf16 v[140:143], v[84:87], a[48:51], v[140:143]
ds_read_b64_tr_b16 v[74:75], v41 offset:25088
v_mfma_f32_16x16x32_bf16 v[172:175], v[84:87], a[52:55], v[172:175]
ds_read_b64_tr_b16 v[76:77], v41 offset:28672
v_mfma_f32_16x16x32_bf16 v[172:175], v[80:83], a[36:39], v[172:175]
buffer_load_dwordx4 v13, s[8:11], s60 offen offset:3072 lds
v_mfma_f32_16x16x32_bf16 v[204:207], v[80:83], a[40:43], v[204:207]
ds_read_b64_tr_b16 v[78:79], v41 offset:29184
s_add_u32 s44, s30, 8192
v_mfma_f32_16x16x32_bf16 v[204:207], v[84:87], a[56:59], v[204:207]
s_add_u32 s45, s30, 26624
s_add_u32 s46, s30, 45056
s_add_u32 s47, s30, 63488
v_mfma_f32_16x16x32_bf16 v[236:239], v[84:87], a[60:63], v[236:239]
buffer_load_dwordx4 a[128:131], v1, s[12:15], s44 offen offset:0 sc1
v_mfma_f32_16x16x32_bf16 v[236:239], v[80:83], a[44:47], v[236:239]
s_waitcnt lgkmcnt(4)
v_mfma_f32_16x16x32_bf16 v[144:147], v[64:67], a[32:35], v[144:147]
ds_read_b64_tr_b16 v[80:81], v42 offset:24576
v_mfma_f32_16x16x32_bf16 v[144:147], v[68:71], a[48:51], v[144:147]
ds_read_b64_tr_b16 v[82:83], v42 offset:25088
v_mfma_f32_16x16x32_bf16 v[176:179], v[68:71], a[52:55], v[176:179]
ds_read_b64_tr_b16 v[84:85], v42 offset:28672
v_mfma_f32_16x16x32_bf16 v[176:179], v[64:67], a[36:39], v[176:179]
buffer_load_dwordx4 a[132:135], v1, s[12:15], s45 offen offset:0 sc1
v_mfma_f32_16x16x32_bf16 v[208:211], v[64:67], a[40:43], v[208:211]
ds_read_b64_tr_b16 v[86:87], v42 offset:29184
v_mfma_f32_16x16x32_bf16 v[208:211], v[68:71], a[56:59], v[208:211]
buffer_load_dwordx4 a[136:139], v1, s[12:15], s46 offen offset:0 sc1
v_mfma_f32_16x16x32_bf16 v[240:243], v[68:71], a[60:63], v[240:243]
v_mfma_f32_16x16x32_bf16 v[240:243], v[64:67], a[44:47], v[240:243]
s_waitcnt lgkmcnt(4)
v_mfma_f32_16x16x32_bf16 v[148:151], v[72:75], a[32:35], v[148:151]
ds_read_b64_tr_b16 v[64:65], v43 offset:24576
v_mfma_f32_16x16x32_bf16 v[148:151], v[76:79], a[48:51], v[148:151]
ds_read_b64_tr_b16 v[66:67], v43 offset:25088
v_mfma_f32_16x16x32_bf16 v[180:183], v[76:79], a[52:55], v[180:183]
ds_read_b64_tr_b16 v[68:69], v43 offset:28672
v_mfma_f32_16x16x32_bf16 v[180:183], v[72:75], a[36:39], v[180:183]
buffer_load_dwordx4 a[140:143], v1, s[12:15], s47 offen offset:0 sc1
v_mfma_f32_16x16x32_bf16 v[212:215], v[72:75], a[40:43], v[212:215]
ds_read_b64_tr_b16 v[70:71], v43 offset:29184
s_waitcnt vmcnt(20)
v_mfma_f32_16x16x32_bf16 v[212:215], v[76:79], a[56:59], v[212:215]
s_add_u32 s62, s6, 32768
v_mfma_f32_16x16x32_bf16 v[244:247], v[76:79], a[60:63], v[244:247]
s_mov_b64 exec, 1
buffer_store_dword v8, off, s[12:15], s62 offset:0 sc1
s_mov_b64 exec, -1
v_mfma_f32_16x16x32_bf16 v[244:247], v[72:75], a[44:47], v[244:247]
s_waitcnt lgkmcnt(4)
s_barrier
v_mfma_f32_16x16x32_bf16 v[152:155], v[80:83], a[32:35], v[152:155]
ds_read_b64_tr_b16 v[72:73], v40 offset:32768
v_mfma_f32_16x16x32_bf16 v[152:155], v[84:87], a[48:51], v[152:155]
ds_read_b64_tr_b16 v[74:75], v40 offset:33280
v_mfma_f32_16x16x32_bf16 v[184:187], v[84:87], a[52:55], v[184:187]
ds_read_b64_tr_b16 v[76:77], v40 offset:36864
v_mfma_f32_16x16x32_bf16 v[184:187], v[80:83], a[36:39], v[184:187]
buffer_load_dwordx4 a[144:147], v1, s[12:15], s44 offen offset:1024 sc1
v_mfma_f32_16x16x32_bf16 v[216:219], v[80:83], a[40:43], v[216:219]
ds_read_b64_tr_b16 v[78:79], v40 offset:37376
v_mfma_f32_16x16x32_bf16 v[216:219], v[84:87], a[56:59], v[216:219]
buffer_load_dwordx4 a[148:151], v1, s[12:15], s45 offen offset:1024 sc1
v_mfma_f32_16x16x32_bf16 v[248:251], v[84:87], a[60:63], v[248:251]
buffer_load_dwordx4 a[152:155], v1, s[12:15], s46 offen offset:1024 sc1
v_mfma_f32_16x16x32_bf16 v[248:251], v[80:83], a[44:47], v[248:251]
s_waitcnt lgkmcnt(4)
v_mfma_f32_16x16x32_bf16 v[156:159], v[64:67], a[32:35], v[156:159]
ds_read_b64_tr_b16 v[80:81], v41 offset:32768
v_mfma_f32_16x16x32_bf16 v[156:159], v[68:71], a[48:51], v[156:159]
ds_read_b64_tr_b16 v[82:83], v41 offset:33280
v_mfma_f32_16x16x32_bf16 v[188:191], v[68:71], a[52:55], v[188:191]
ds_read_b64_tr_b16 v[84:85], v41 offset:36864
v_mfma_f32_16x16x32_bf16 v[188:191], v[64:67], a[36:39], v[188:191]
buffer_load_dwordx4 a[156:159], v1, s[12:15], s47 offen offset:1024 sc1
v_mfma_f32_16x16x32_bf16 v[220:223], v[64:67], a[40:43], v[220:223]
ds_read_b64_tr_b16 v[86:87], v41 offset:37376
v_mfma_f32_16x16x32_bf16 v[220:223], v[68:71], a[56:59], v[220:223]
v_mfma_f32_16x16x32_bf16 v[252:255], v[68:71], a[60:63], v[252:255]
s_add_u32 s60, s56, 2621440
s_add_u32 m0, s57, 147456
v_mfma_f32_16x16x32_bf16 v[252:255], v[64:67], a[44:47], v[252:255]
s_waitcnt vmcnt(21) lgkmcnt(4)
v_mfma_f32_16x16x32_bf16 v[128:131], v[72:75], a[64:67], v[128:131]
ds_read_b64_tr_b16 v[64:65], v42 offset:32768
v_mfma_f32_16x16x32_bf16 v[128:131], v[76:79], a[80:83], v[128:131]
ds_read_b64_tr_b16 v[66:67], v42 offset:33280
v_mfma_f32_16x16x32_bf16 v[160:163], v[76:79], a[84:87], v[160:163]
ds_read_b64_tr_b16 v[68:69], v42 offset:36864
v_mfma_f32_16x16x32_bf16 v[160:163], v[72:75], a[68:71], v[160:163]
buffer_load_dwordx4 v10, s[8:11], s60 offen offset:0 lds
v_mfma_f32_16x16x32_bf16 v[192:195], v[72:75], a[72:75], v[192:195]
ds_read_b64_tr_b16 v[70:71], v42 offset:37376
v_mfma_f32_16x16x32_bf16 v[192:195], v[76:79], a[88:91], v[192:195]
buffer_load_dwordx4 v11, s[8:11], s60 offen offset:1024 lds
v_mfma_f32_16x16x32_bf16 v[224:227], v[76:79], a[92:95], v[224:227]
v_mfma_f32_16x16x32_bf16 v[224:227], v[72:75], a[76:79], v[224:227]
s_waitcnt lgkmcnt(4)
v_mfma_f32_16x16x32_bf16 v[132:135], v[80:83], a[64:67], v[132:135]
ds_read_b64_tr_b16 v[72:73], v43 offset:32768
v_mfma_f32_16x16x32_bf16 v[132:135], v[84:87], a[80:83], v[132:135]
ds_read_b64_tr_b16 v[74:75], v43 offset:33280
v_mfma_f32_16x16x32_bf16 v[164:167], v[84:87], a[84:87], v[164:167]
ds_read_b64_tr_b16 v[76:77], v43 offset:36864
v_mfma_f32_16x16x32_bf16 v[164:167], v[80:83], a[68:71], v[164:167]
buffer_load_dwordx4 v12, s[8:11], s60 offen offset:2048 lds
v_mfma_f32_16x16x32_bf16 v[196:199], v[80:83], a[72:75], v[196:199]
ds_read_b64_tr_b16 v[78:79], v43 offset:37376
v_mfma_f32_16x16x32_bf16 v[196:199], v[84:87], a[88:91], v[196:199]
buffer_load_dwordx4 v13, s[8:11], s60 offen offset:3072 lds
v_mfma_f32_16x16x32_bf16 v[228:231], v[84:87], a[92:95], v[228:231]
v_mfma_f32_16x16x32_bf16 v[228:231], v[80:83], a[76:79], v[228:231]
s_waitcnt lgkmcnt(4)
v_mfma_f32_16x16x32_bf16 v[136:139], v[64:67], a[64:67], v[136:139]
ds_read_b64_tr_b16 v[80:81], v40 offset:40960
v_mfma_f32_16x16x32_bf16 v[136:139], v[68:71], a[80:83], v[136:139]
ds_read_b64_tr_b16 v[82:83], v40 offset:41472
v_mfma_f32_16x16x32_bf16 v[168:171], v[68:71], a[84:87], v[168:171]
ds_read_b64_tr_b16 v[84:85], v40 offset:45056
v_mfma_f32_16x16x32_bf16 v[168:171], v[64:67], a[68:71], v[168:171]
buffer_load_dwordx4 a[160:163], v1, s[12:15], s44 offen offset:2048 sc1
v_mfma_f32_16x16x32_bf16 v[200:203], v[64:67], a[72:75], v[200:203]
ds_read_b64_tr_b16 v[86:87], v40 offset:45568
v_mfma_f32_16x16x32_bf16 v[200:203], v[68:71], a[88:91], v[200:203]
buffer_load_dwordx4 a[164:167], v1, s[12:15], s45 offen offset:2048 sc1
v_mfma_f32_16x16x32_bf16 v[232:235], v[68:71], a[92:95], v[232:235]
v_mfma_f32_16x16x32_bf16 v[232:235], v[64:67], a[76:79], v[232:235]
s_waitcnt lgkmcnt(4)
v_mfma_f32_16x16x32_bf16 v[140:143], v[72:75], a[64:67], v[140:143]
ds_read_b64_tr_b16 v[64:65], v41 offset:40960
v_mfma_f32_16x16x32_bf16 v[140:143], v[76:79], a[80:83], v[140:143]
ds_read_b64_tr_b16 v[66:67], v41 offset:41472
v_mfma_f32_16x16x32_bf16 v[172:175], v[76:79], a[84:87], v[172:175]
ds_read_b64_tr_b16 v[68:69], v41 offset:45056
v_mfma_f32_16x16x32_bf16 v[172:175], v[72:75], a[68:71], v[172:175]
buffer_load_dwordx4 a[168:171], v1, s[12:15], s46 offen offset:2048 sc1
v_mfma_f32_16x16x32_bf16 v[204:207], v[72:75], a[72:75], v[204:207]
ds_read_b64_tr_b16 v[70:71], v41 offset:45568
v_mfma_f32_16x16x32_bf16 v[204:207], v[76:79], a[88:91], v[204:207]
v_mfma_f32_16x16x32_bf16 v[236:239], v[76:79], a[92:95], v[236:239]
buffer_load_dwordx4 a[172:175], v1, s[12:15], s47 offen offset:2048 sc1
v_mfma_f32_16x16x32_bf16 v[236:239], v[72:75], a[76:79], v[236:239]
s_waitcnt lgkmcnt(4)
v_mfma_f32_16x16x32_bf16 v[144:147], v[80:83], a[64:67], v[144:147]
ds_read_b64_tr_b16 v[72:73], v42 offset:40960
v_mfma_f32_16x16x32_bf16 v[144:147], v[84:87], a[80:83], v[144:147]
ds_read_b64_tr_b16 v[74:75], v42 offset:41472
v_mfma_f32_16x16x32_bf16 v[176:179], v[84:87], a[84:87], v[176:179]
ds_read_b64_tr_b16 v[76:77], v42 offset:45056
v_mfma_f32_16x16x32_bf16 v[176:179], v[80:83], a[68:71], v[176:179]
buffer_load_dwordx4 a[176:179], v1, s[12:15], s44 offen offset:3072 sc1
v_mfma_f32_16x16x32_bf16 v[208:211], v[80:83], a[72:75], v[208:211]
ds_read_b64_tr_b16 v[78:79], v42 offset:45568
v_mfma_f32_16x16x32_bf16 v[208:211], v[84:87], a[88:91], v[208:211]
v_mfma_f32_16x16x32_bf16 v[240:243], v[84:87], a[92:95], v[240:243]
v_mfma_f32_16x16x32_bf16 v[240:243], v[80:83], a[76:79], v[240:243]
s_waitcnt lgkmcnt(4)
v_mfma_f32_16x16x32_bf16 v[148:151], v[64:67], a[64:67], v[148:151]
ds_read_b64_tr_b16 v[80:81], v43 offset:40960
v_mfma_f32_16x16x32_bf16 v[148:151], v[68:71], a[80:83], v[148:151]
ds_read_b64_tr_b16 v[82:83], v43 offset:41472
v_mfma_f32_16x16x32_bf16 v[180:183], v[68:71], a[84:87], v[180:183]
ds_read_b64_tr_b16 v[84:85], v43 offset:45056
v_mfma_f32_16x16x32_bf16 v[180:183], v[64:67], a[68:71], v[180:183]
buffer_load_dwordx4 a[180:183], v1, s[12:15], s45 offen offset:3072 sc1
v_mfma_f32_16x16x32_bf16 v[212:215], v[64:67], a[72:75], v[212:215]
ds_read_b64_tr_b16 v[86:87], v43 offset:45568
v_mfma_f32_16x16x32_bf16 v[212:215], v[68:71], a[88:91], v[212:215]
buffer_load_dwordx4 a[184:187], v1, s[12:15], s46 offen offset:3072 sc1
v_mfma_f32_16x16x32_bf16 v[244:247], v[68:71], a[92:95], v[244:247]
v_mfma_f32_16x16x32_bf16 v[244:247], v[64:67], a[76:79], v[244:247]
s_waitcnt lgkmcnt(4)
s_barrier
v_mfma_f32_16x16x32_bf16 v[152:155], v[72:75], a[64:67], v[152:155]
ds_read_b64_tr_b16 v[64:65], v40 offset:49152
v_mfma_f32_16x16x32_bf16 v[152:155], v[76:79], a[80:83], v[152:155]
ds_read_b64_tr_b16 v[66:67], v40 offset:49664
v_mfma_f32_16x16x32_bf16 v[184:187], v[76:79], a[84:87], v[184:187]
ds_read_b64_tr_b16 v[68:69], v40 offset:53248
v_mfma_f32_16x16x32_bf16 v[184:187], v[72:75], a[68:71], v[184:187]
buffer_load_dwordx4 a[188:191], v1, s[12:15], s47 offen offset:3072 sc1
v_mfma_f32_16x16x32_bf16 v[216:219], v[72:75], a[72:75], v[216:219]
ds_read_b64_tr_b16 v[70:71], v40 offset:53760
v_mfma_f32_16x16x32_bf16 v[216:219], v[76:79], a[88:91], v[216:219]
s_add_u32 s60, s56, 3145728
s_add_u32 m0, s57, 0
v_mfma_f32_16x16x32_bf16 v[248:251], v[76:79], a[92:95], v[248:251]
buffer_load_dwordx4 v10, s[8:11], s60 offen offset:0 lds
v_mfma_f32_16x16x32_bf16 v[248:251], v[72:75], a[76:79], v[248:251]
s_waitcnt lgkmcnt(4)
v_mfma_f32_16x16x32_bf16 v[156:159], v[80:83], a[64:67], v[156:159]
ds_read_b64_tr_b16 v[72:73], v41 offset:49152
v_mfma_f32_16x16x32_bf16 v[156:159], v[84:87], a[80:83], v[156:159]
ds_read_b64_tr_b16 v[74:75], v41 offset:49664
v_mfma_f32_16x16x32_bf16 v[188:191], v[84:87], a[84:87], v[188:191]
ds_read_b64_tr_b16 v[76:77], v41 offset:53248
v_mfma_f32_16x16x32_bf16 v[188:191], v[80:83], a[68:71], v[188:191]
buffer_load_dwordx4 v11, s[8:11], s60 offen offset:1024 lds
v_mfma_f32_16x16x32_bf16 v[220:223], v[80:83], a[72:75], v[220:223]
ds_read_b64_tr_b16 v[78:79], v41 offset:53760
v_mfma_f32_16x16x32_bf16 v[220:223], v[84:87], a[88:91], v[220:223]
v_mfma_f32_16x16x32_bf16 v[252:255], v[84:87], a[92:95], v[252:255]
buffer_load_dwordx4 v12, s[8:11], s60 offen offset:2048 lds
v_mfma_f32_16x16x32_bf16 v[252:255], v[80:83], a[76:79], v[252:255]
s_waitcnt vmcnt(28) lgkmcnt(4)
v_mfma_f32_16x16x32_bf16 v[128:131], v[64:67], a[96:99], v[128:131]
ds_read_b64_tr_b16 v[80:81], v42 offset:49152
v_mfma_f32_16x16x32_bf16 v[128:131], v[68:71], a[112:115], v[128:131]
ds_read_b64_tr_b16 v[82:83], v42 offset:49664
v_mfma_f32_16x16x32_bf16 v[160:163], v[68:71], a[116:119], v[160:163]
ds_read_b64_tr_b16 v[84:85], v42 offset:53248
v_mfma_f32_16x16x32_bf16 v[160:163], v[64:67], a[100:103], v[160:163]
buffer_load_dwordx4 v13, s[8:11], s60 offen offset:3072 lds
v_mfma_f32_16x16x32_bf16 v[192:195], v[64:67], a[104:107], v[192:195]
ds_read_b64_tr_b16 v[86:87], v42 offset:53760
v_mfma_f32_16x16x32_bf16 v[192:195], v[68:71], a[120:123], v[192:195]
v_mfma_f32_16x16x32_bf16 v[224:227], v[68:71], a[124:127], v[224:227]
v_mfma_f32_16x16x32_bf16 v[224:227], v[64:67], a[108:111], v[224:227]
s_waitcnt lgkmcnt(4)
s_add_u32 s44, s30, 12288
s_add_u32 s45, s30, 30720
v_mfma_f32_16x16x32_bf16 v[132:135], v[72:75], a[96:99], v[132:135]
ds_read_b64_tr_b16 v[64:65], v43 offset:49152
s_add_u32 s46, s30, 49152
v_mfma_f32_16x16x32_bf16 v[132:135], v[76:79], a[112:115], v[132:135]
ds_read_b64_tr_b16 v[66:67], v43 offset:49664
s_add_u32 s47, s30, 67584
v_mfma_f32_16x16x32_bf16 v[164:167], v[76:79], a[116:119], v[164:167]
ds_read_b64_tr_b16 v[68:69], v43 offset:53248
v_accvgpr_write_b32 a32, 0
v_mfma_f32_16x16x32_bf16 v[164:167], v[72:75], a[100:103], v[164:167]
buffer_load_dwordx4 a[192:195], v1, s[12:15], s44 offen offset:0 sc1
v_mfma_f32_16x16x32_bf16 v[196:199], v[72:75], a[104:107], v[196:199]
ds_read_b64_tr_b16 v[70:71], v43 offset:53760
v_accvgpr_write_b32 a33, 0
v_mfma_f32_16x16x32_bf16 v[196:199], v[76:79], a[120:123], v[196:199]
v_accvgpr_write_b32 a34, 0
v_accvgpr_write_b32 a35, 0
v_mfma_f32_16x16x32_bf16 v[228:231], v[76:79], a[124:127], v[228:231]
v_accvgpr_write_b32 a36, v18
v_accvgpr_write_b32 a37, v18
v_mfma_f32_16x16x32_bf16 v[228:231], v[72:75], a[108:111], v[228:231]
s_waitcnt lgkmcnt(4)
v_accvgpr_write_b32 a38, v18
v_accvgpr_write_b32 a39, v18
v_mfma_f32_16x16x32_bf16 v[136:139], v[80:83], a[96:99], v[136:139]
ds_read_b64_tr_b16 v[72:73], v40 offset:57344
v_accvgpr_write_b32 a48, -1
v_mfma_f32_16x16x32_bf16 v[136:139], v[84:87], a[112:115], v[136:139]
ds_read_b64_tr_b16 v[74:75], v40 offset:57856
v_accvgpr_write_b32 a49, -1
v_mfma_f32_16x16x32_bf16 v[168:171], v[84:87], a[116:119], v[168:171]
ds_read_b64_tr_b16 v[76:77], v40 offset:61440
v_accvgpr_write_b32 a50, -1
v_mfma_f32_16x16x32_bf16 v[168:171], v[80:83], a[100:103], v[168:171]
v_accvgpr_write_b32 a51, -1
v_accvgpr_write_b32 a41, v8
v_mfma_f32_16x16x32_bf16 v[200:203], v[80:83], a[104:107], v[200:203]
ds_read_b64_tr_b16 v[78:79], v40 offset:61952
s_lshr_b32 s4, s2, 1
v_mfma_f32_16x16x32_bf16 v[200:203], v[84:87], a[120:123], v[200:203]
s_and_b32 s4, s4, 12
s_add_u32 s4, s4, s3
s_lshl_b32 s5, s25, 3
v_mfma_f32_16x16x32_bf16 v[232:235], v[84:87], a[124:127], v[232:235]
s_sub_u32 s87, 112, s5
s_cmp_lt_u32 s4, 8
s_cselect_b32 s87, s5, s87
v_mfma_f32_16x16x32_bf16 v[232:235], v[80:83], a[108:111], v[232:235]
s_waitcnt lgkmcnt(4)
s_add_u32 s4, s4, s87
s_and_b32 s87, s2, 7
v_mfma_f32_16x16x32_bf16 v[140:143], v[64:67], a[96:99], v[140:143]
ds_read_b64_tr_b16 v[80:81], v41 offset:57344
s_lshl_b32 s88, s87, 7
v_mfma_f32_16x16x32_bf16 v[140:143], v[68:71], a[112:115], v[140:143]
ds_read_b64_tr_b16 v[82:83], v41 offset:57856
s_add_u32 s4, s4, s88
v_mfma_f32_16x16x32_bf16 v[172:175], v[68:71], a[116:119], v[172:175]
ds_read_b64_tr_b16 v[84:85], v41 offset:61440
s_mul_i32 s100, s4, 18432
v_mfma_f32_16x16x32_bf16 v[172:175], v[64:67], a[100:103], v[172:175]
s_add_u32 s100, s100, 100663296
s_sub_u32 s4, 120, s5
v_mfma_f32_16x16x32_bf16 v[204:207], v[64:67], a[104:107], v[204:207]
s_bitcmp1_b32 s2, 4
s_cselect_b32 s4, s4, s5
ds_read_b64_tr_b16 v[86:87], v41 offset:61952
v_mfma_f32_16x16x32_bf16 v[204:207], v[68:71], a[120:123], v[204:207]
s_add_u32 s4, s4, s87
s_lshl_b32 s4, s4, 1
s_bfe_u32 s5, s2, 0x10003
v_mfma_f32_16x16x32_bf16 v[236:239], v[68:71], a[124:127], v[236:239]
s_add_u32 s4, s4, s5
s_mul_i32 s4, s4, 3
s_min_u32 s5, s3, 2
v_mfma_f32_16x16x32_bf16 v[236:239], v[64:67], a[108:111], v[236:239]
s_waitcnt lgkmcnt(4)
s_add_u32 s4, s4, s5
s_mul_i32 s101, s4, 3072
v_mfma_f32_16x16x32_bf16 v[144:147], v[72:75], a[96:99], v[144:147]
ds_read_b64_tr_b16 v[64:65], v42 offset:57344
s_add_u32 s101, s101, 119537664
v_mfma_f32_16x16x32_bf16 v[144:147], v[76:79], a[112:115], v[144:147]
ds_read_b64_tr_b16 v[66:67], v42 offset:57856
s_mov_b32 s88, s12
v_mfma_f32_16x16x32_bf16 v[176:179], v[76:79], a[116:119], v[176:179]
ds_read_b64_tr_b16 v[68:69], v42 offset:61440
s_mov_b32 s89, s13
v_mfma_f32_16x16x32_bf16 v[176:179], v[72:75], a[100:103], v[176:179]
s_mov_b32 s90, 268435456
s_mov_b32 s91, 0x20000
v_mfma_f32_16x16x32_bf16 v[208:211], v[72:75], a[104:107], v[208:211]
ds_read_b64_tr_b16 v[70:71], v42 offset:61952
v_mfma_f32_16x16x32_bf16 v[208:211], v[76:79], a[120:123], v[208:211]
buffer_load_dwordx4 a[196:199], v1, s[12:15], s45 offen offset:0 sc1
v_mfma_f32_16x16x32_bf16 v[240:243], v[76:79], a[124:127], v[240:243]
buffer_load_dwordx4 a[200:203], v1, s[12:15], s46 offen offset:0 sc1
v_mfma_f32_16x16x32_bf16 v[240:243], v[72:75], a[108:111], v[240:243]
s_waitcnt lgkmcnt(4)
v_lshrrev_b32 v24, 4, v0
v_mfma_f32_16x16x32_bf16 v[148:151], v[80:83], a[96:99], v[148:151]
ds_read_b64_tr_b16 v[72:73], v43 offset:57344
v_mfma_f32_16x16x32_bf16 v[148:151], v[84:87], a[112:115], v[148:151]
ds_read_b64_tr_b16 v[74:75], v43 offset:57856
v_and_b32 v25, 15, v0
v_mfma_f32_16x16x32_bf16 v[180:183], v[84:87], a[116:119], v[180:183]
ds_read_b64_tr_b16 v[76:77], v43 offset:61440
v_mfma_f32_16x16x32_bf16 v[180:183], v[80:83], a[100:103], v[180:183]
buffer_load_dwordx4 a[204:207], v1, s[12:15], s47 offen offset:0 sc1
v_mfma_f32_16x16x32_bf16 v[212:215], v[80:83], a[104:107], v[212:215]
ds_read_b64_tr_b16 v[78:79], v43 offset:61952
v_mfma_f32_16x16x32_bf16 v[212:215], v[84:87], a[120:123], v[212:215]
buffer_load_dwordx4 a[208:211], v1, s[12:15], s44 offen offset:1024 sc1
v_mfma_f32_16x16x32_bf16 v[244:247], v[84:87], a[124:127], v[244:247]
buffer_load_dwordx4 a[212:215], v1, s[12:15], s45 offen offset:1024 sc1
v_mfma_f32_16x16x32_bf16 v[244:247], v[80:83], a[108:111], v[244:247]
s_waitcnt vmcnt(31) lgkmcnt(4)
s_barrier
v_mfma_f32_16x16x32_bf16 v[152:155], v[64:67], a[96:99], v[152:155]
ds_read_b64_tr_b16 v[80:81], v44 offset:0
v_lshlrev_b32 v26, 1, v24
v_mfma_f32_16x16x32_bf16 v[152:155], v[68:71], a[112:115], v[152:155]
ds_read_b64_tr_b16 v[82:83], v44 offset:512
v_xor_b32 v25, v25, v26
v_mfma_f32_16x16x32_bf16 v[184:187], v[68:71], a[116:119], v[184:187]
ds_read_b64_tr_b16 v[84:85], v44 offset:4096
v_mfma_f32_16x16x32_bf16 v[184:187], v[64:67], a[100:103], v[184:187]
buffer_load_dwordx4 a[216:219], v1, s[12:15], s46 offen offset:1024 sc1
v_mfma_f32_16x16x32_bf16 v[216:219], v[64:67], a[104:107], v[216:219]
ds_read_b64_tr_b16 v[86:87], v44 offset:4608
v_lshlrev_b32 v25, 4, v25
v_mfma_f32_16x16x32_bf16 v[216:219], v[68:71], a[120:123], v[216:219]
buffer_load_dwordx4 a[220:223], v1, s[12:15], s47 offen offset:1024 sc1
v_mfma_f32_16x16x32_bf16 v[248:251], v[68:71], a[124:127], v[248:251]
s_add_u32 s60, s56, 3670016
s_add_u32 m0, s57, 16384
v_mfma_f32_16x16x32_bf16 v[248:251], v[64:67], a[108:111], v[248:251]
s_waitcnt lgkmcnt(4)
v_mul_u32_u24 v24, 1152, v24
v_mfma_f32_16x16x32_bf16 v[156:159], v[72:75], a[96:99], v[156:159]
ds_read_b64_tr_b16 v[64:65], v45 offset:0
v_mfma_f32_16x16x32_bf16 v[156:159], v[76:79], a[112:115], v[156:159]
ds_read_b64_tr_b16 v[66:67], v45 offset:512
v_mfma_f32_16x16x32_bf16 v[188:191], v[76:79], a[116:119], v[188:191]
ds_read_b64_tr_b16 v[68:69], v45 offset:4096
v_mfma_f32_16x16x32_bf16 v[188:191], v[72:75], a[100:103], v[188:191]
buffer_load_dwordx4 v10, s[8:11], s60 offen offset:0 lds
v_mfma_f32_16x16x32_bf16 v[220:223], v[72:75], a[104:107], v[220:223]
ds_read_b64_tr_b16 v[70:71], v45 offset:4608
v_xor_b32 v26, 128, v25
v_mfma_f32_16x16x32_bf16 v[220:223], v[76:79], a[120:123], v[220:223]
buffer_load_dwordx4 v11, s[8:11], s60 offen offset:1024 lds
v_mfma_f32_16x16x32_bf16 v[252:255], v[76:79], a[124:127], v[252:255]
buffer_load_dwordx4 v12, s[8:11], s60 offen offset:2048 lds
v_mfma_f32_16x16x32_bf16 v[252:255], v[72:75], a[108:111], v[252:255]
s_waitcnt vmcnt(27) lgkmcnt(4)
v_add_u32 v25, v25, v24
v_mfma_f32_16x16x32_bf16 v[128:131], v[80:83], a[128:131], v[128:131]
ds_read_b64_tr_b16 v[72:73], v46 offset:0
v_mfma_f32_16x16x32_bf16 v[128:131], v[84:87], a[144:147], v[128:131]
ds_read_b64_tr_b16 v[74:75], v46 offset:512
v_mfma_f32_16x16x32_bf16 v[160:163], v[84:87], a[148:151], v[160:163]
ds_read_b64_tr_b16 v[76:77], v46 offset:4096
v_add3_u32 v26, v26, v24, 0
v_mfma_f32_16x16x32_bf16 v[160:163], v[80:83], a[132:135], v[160:163]
buffer_load_dwordx4 v13, s[8:11], s60 offen offset:3072 lds
v_mfma_f32_16x16x32_bf16 v[192:195], v[80:83], a[136:139], v[192:195]
ds_read_b64_tr_b16 v[78:79], v46 offset:4608
s_and_b32 s62, s2, 0x17
v_mfma_f32_16x16x32_bf16 v[192:195], v[84:87], a[152:155], v[192:195]
s_bfe_u32 s63, s62, 0x10004
s_lshl_b32 s63, s63, 3
s_sub_u32 s62, s62, s63
v_mfma_f32_16x16x32_bf16 v[224:227], v[84:87], a[156:159], v[224:227]
s_lshl_b32 s62, s62, 7
s_add_u32 s7, s62, 123764736
v_accvgpr_write_b32 a53, v25
v_mfma_f32_16x16x32_bf16 v[224:227], v[80:83], a[140:143], v[224:227]
s_waitcnt lgkmcnt(4)
v_mfma_f32_16x16x32_bf16 v[132:135], v[64:67], a[128:131], v[132:135]
ds_read_b64_tr_b16 v[80:81], v47 offset:0
v_mfma_f32_16x16x32_bf16 v[132:135], v[68:71], a[144:147], v[132:135]
ds_read_b64_tr_b16 v[82:83], v47 offset:512
v_add_u32 v26, 3584, v26
v_mfma_f32_16x16x32_bf16 v[164:167], v[68:71], a[148:151], v[164:167]
ds_read_b64_tr_b16 v[84:85], v47 offset:4096
v_mfma_f32_16x16x32_bf16 v[164:167], v[64:67], a[132:135], v[164:167]
buffer_load_dword v7, v9, s[12:15], s7 offen sc1
v_mfma_f32_16x16x32_bf16 v[196:199], v[64:67], a[136:139], v[196:199]
ds_read_b64_tr_b16 v[86:87], v47 offset:4608
s_add_u32 s60, s56, 4194304
v_mfma_f32_16x16x32_bf16 v[196:199], v[68:71], a[152:155], v[196:199]
s_add_u32 m0, s57, 98304
v_add_u32 v25, 7168, v25
v_mfma_f32_16x16x32_bf16 v[228:231], v[68:71], a[156:159], v[228:231]
buffer_load_dwordx4 v10, s[8:11], s60 offen offset:0 lds
v_mfma_f32_16x16x32_bf16 v[228:231], v[64:67], a[140:143], v[228:231]
s_waitcnt lgkmcnt(4)
v_mfma_f32_16x16x32_bf16 v[136:139], v[72:75], a[128:131], v[136:139]
ds_read_b64_tr_b16 v[64:65], v44 offset:8192
v_accvgpr_write_b32 a54, v26
v_mfma_f32_16x16x32_bf16 v[136:139], v[76:79], a[144:147], v[136:139]
ds_read_b64_tr_b16 v[66:67], v44 offset:8704
v_mfma_f32_16x16x32_bf16 v[168:171], v[76:79], a[148:151], v[168:171]
ds_read_b64_tr_b16 v[68:69], v44 offset:12288
v_mfma_f32_16x16x32_bf16 v[168:171], v[72:75], a[132:135], v[168:171]
buffer_load_dwordx4 v11, s[8:11], s60 offen offset:1024 lds
v_mfma_f32_16x16x32_bf16 v[200:203], v[72:75], a[136:139], v[200:203]
ds_read_b64_tr_b16 v[70:71], v44 offset:12800
v_add_u32 v26, 7168, v26
v_mfma_f32_16x16x32_bf16 v[200:203], v[76:79], a[152:155], v[200:203]
buffer_load_dwordx4 v12, s[8:11], s60 offen offset:2048 lds
v_mfma_f32_16x16x32_bf16 v[232:235], v[76:79], a[156:159], v[232:235]
buffer_load_dwordx4 v13, s[8:11], s60 offen offset:3072 lds
v_mfma_f32_16x16x32_bf16 v[232:235], v[72:75], a[140:143], v[232:235]
s_waitcnt lgkmcnt(4)
v_accvgpr_write_b32 a55, v25
v_mfma_f32_16x16x32_bf16 v[140:143], v[80:83], a[128:131], v[140:143]
ds_read_b64_tr_b16 v[72:73], v45 offset:8192
v_mfma_f32_16x16x32_bf16 v[140:143], v[84:87], a[144:147], v[140:143]
ds_read_b64_tr_b16 v[74:75], v45 offset:8704
v_mfma_f32_16x16x32_bf16 v[172:175], v[84:87], a[148:151], v[172:175]
ds_read_b64_tr_b16 v[76:77], v45 offset:12288
v_accvgpr_write_b32 a56, v26
v_mfma_f32_16x16x32_bf16 v[172:175], v[80:83], a[132:135], v[172:175]
buffer_load_dwordx4 a[224:227], v1, s[12:15], s44 offen offset:2048 sc1
v_mfma_f32_16x16x32_bf16 v[204:207], v[80:83], a[136:139], v[204:207]
ds_read_b64_tr_b16 v[78:79], v45 offset:12800
v_mfma_f32_16x16x32_bf16 v[204:207], v[84:87], a[152:155], v[204:207]
buffer_load_dwordx4 a[228:231], v1, s[12:15], s45 offen offset:2048 sc1
v_mfma_f32_16x16x32_bf16 v[236:239], v[84:87], a[156:159], v[236:239]
buffer_load_dwordx4 a[232:235], v1, s[12:15], s46 offen offset:2048 sc1
v_mfma_f32_16x16x32_bf16 v[236:239], v[80:83], a[140:143], v[236:239]
s_waitcnt lgkmcnt(4)
s_lshl_b32 s4, s24, 2
v_mfma_f32_16x16x32_bf16 v[144:147], v[64:67], a[128:131], v[144:147]
ds_read_b64_tr_b16 v[80:81], v46 offset:8192
v_mfma_f32_16x16x32_bf16 v[144:147], v[68:71], a[144:147], v[144:147]
ds_read_b64_tr_b16 v[82:83], v46 offset:8704
s_add_u32 s4, s4, s3
v_mfma_f32_16x16x32_bf16 v[176:179], v[68:71], a[148:151], v[176:179]
ds_read_b64_tr_b16 v[84:85], v46 offset:12288
v_mfma_f32_16x16x32_bf16 v[176:179], v[64:67], a[132:135], v[176:179]
buffer_load_dwordx4 a[236:239], v1, s[12:15], s47 offen offset:2048 sc1
v_mfma_f32_16x16x32_bf16 v[208:211], v[64:67], a[136:139], v[208:211]
ds_read_b64_tr_b16 v[86:87], v46 offset:12800
v_mfma_f32_16x16x32_bf16 v[208:211], v[68:71], a[152:155], v[208:211]
buffer_load_dwordx4 a[240:243], v1, s[12:15], s44 offen offset:3072 sc1
v_mfma_f32_16x16x32_bf16 v[240:243], v[68:71], a[156:159], v[240:243]
s_mul_i32 s4, s4, 36864
v_mfma_f32_16x16x32_bf16 v[240:243], v[64:67], a[140:143], v[240:243]
s_waitcnt lgkmcnt(4)
v_mfma_f32_16x16x32_bf16 v[148:151], v[72:75], a[128:131], v[148:151]
ds_read_b64_tr_b16 v[64:65], v47 offset:8192
s_and_b32 s5, s24, 3
v_mfma_f32_16x16x32_bf16 v[148:151], v[76:79], a[144:147], v[148:151]
ds_read_b64_tr_b16 v[66:67], v47 offset:8704
v_mfma_f32_16x16x32_bf16 v[180:183], v[76:79], a[148:151], v[180:183]
ds_read_b64_tr_b16 v[68:69], v47 offset:12288
v_mfma_f32_16x16x32_bf16 v[180:183], v[72:75], a[132:135], v[180:183]
buffer_load_dwordx4 a[244:247], v1, s[12:15], s45 offen offset:3072 sc1
v_mfma_f32_16x16x32_bf16 v[212:215], v[72:75], a[136:139], v[212:215]
ds_read_b64_tr_b16 v[70:71], v47 offset:12800
s_lshl_b32 s5, s5, 8
v_mfma_f32_16x16x32_bf16 v[212:215], v[76:79], a[152:155], v[212:215]
buffer_load_dwordx4 a[248:251], v1, s[12:15], s46 offen offset:3072 sc1
v_mfma_f32_16x16x32_bf16 v[244:247], v[76:79], a[156:159], v[244:247]
v_mfma_f32_16x16x32_bf16 v[244:247], v[72:75], a[140:143], v[244:247]
s_waitcnt vmcnt(36) lgkmcnt(4)
s_barrier
v_mfma_f32_16x16x32_bf16 v[152:155], v[80:83], a[128:131], v[152:155]
ds_read_b64_tr_b16 v[72:73], v44 offset:16384
s_add_u32 s87, s4, s5
v_mfma_f32_16x16x32_bf16 v[152:155], v[84:87], a[144:147], v[152:155]
ds_read_b64_tr_b16 v[74:75], v44 offset:16896
v_mfma_f32_16x16x32_bf16 v[184:187], v[84:87], a[148:151], v[184:187]
ds_read_b64_tr_b16 v[76:77], v44 offset:20480
v_mfma_f32_16x16x32_bf16 v[184:187], v[80:83], a[132:135], v[184:187]
buffer_load_dwordx4 a[252:255], v1, s[12:15], s47 offen offset:3072 sc1
v_mfma_f32_16x16x32_bf16 v[216:219], v[80:83], a[136:139], v[216:219]
ds_read_b64_tr_b16 v[78:79], v44 offset:20992
s_lshr_b32 s4, s2, 3
v_mfma_f32_16x16x32_bf16 v[216:219], v[84:87], a[152:155], v[216:219]
v_mfma_f32_16x16x32_bf16 v[248:251], v[84:87], a[156:159], v[248:251]
s_waitcnt vmcnt(12)
s_lshl_b32 s4, s4, 2
v_mfma_f32_16x16x32_bf16 v[248:251], v[80:83], a[140:143], v[248:251]
s_waitcnt lgkmcnt(4)
v_cmp_ne_u32 vcc, s82, v7
v_mfma_f32_16x16x32_bf16 v[156:159], v[64:67], a[128:131], v[156:159]
ds_read_b64_tr_b16 v[80:81], v45 offset:16384
s_nop 0
v_mfma_f32_16x16x32_bf16 v[156:159], v[68:71], a[144:147], v[156:159]
ds_read_b64_tr_b16 v[82:83], v45 offset:16896
s_nop 0
v_mfma_f32_16x16x32_bf16 v[188:191], v[68:71], a[148:151], v[188:191]
s_add_u32 s4, s4, s3
ds_read_b64_tr_b16 v[84:85], v45 offset:20480
s_cbranch_vccnz L_ksp
L_ksr:
v_mfma_f32_16x16x32_bf16 v[188:191], v[64:67], a[132:135], v[188:191]
s_add_u32 s44, s30, 16384
s_add_u32 s45, s30, 34816
s_add_u32 s46, s30, 53248
v_mfma_f32_16x16x32_bf16 v[220:223], v[64:67], a[136:139], v[220:223]
ds_read_b64_tr_b16 v[86:87], v45 offset:20992
s_add_u32 s47, s30, 71680
v_mfma_f32_16x16x32_bf16 v[220:223], v[68:71], a[152:155], v[220:223]
buffer_load_dwordx4 a[0:3], v1, s[12:15], s44 offen offset:0 sc1
v_mfma_f32_16x16x32_bf16 v[252:255], v[68:71], a[156:159], v[252:255]
buffer_load_dwordx4 a[4:7], v1, s[12:15], s45 offen offset:0 sc1
v_mfma_f32_16x16x32_bf16 v[252:255], v[64:67], a[140:143], v[252:255]
s_waitcnt lgkmcnt(4)
s_and_b32 s5, s2, 7
v_mfma_f32_16x16x32_bf16 v[128:131], v[72:75], a[160:163], v[128:131]
ds_read_b64_tr_b16 v[64:65], v46 offset:16384
v_mfma_f32_16x16x32_bf16 v[128:131], v[76:79], a[176:179], v[128:131]
ds_read_b64_tr_b16 v[66:67], v46 offset:16896
s_mul_i32 s92, s5, 589824
v_mfma_f32_16x16x32_bf16 v[160:163], v[76:79], a[180:183], v[160:163]
ds_read_b64_tr_b16 v[68:69], v46 offset:20480
v_mfma_f32_16x16x32_bf16 v[160:163], v[72:75], a[164:167], v[160:163]
buffer_load_dwordx4 a[8:11], v1, s[12:15], s46 offen offset:0 sc1
v_mfma_f32_16x16x32_bf16 v[192:195], v[72:75], a[168:171], v[192:195]
ds_read_b64_tr_b16 v[70:71], v46 offset:20992
s_mul_i32 s93, s4, 4608
v_mfma_f32_16x16x32_bf16 v[192:195], v[76:79], a[184:187], v[192:195]
buffer_load_dwordx4 a[12:15], v1, s[12:15], s47 offen offset:0 sc1
v_mfma_f32_16x16x32_bf16 v[224:227], v[76:79], a[188:191], v[224:227]
v_mfma_f32_16x16x32_bf16 v[224:227], v[72:75], a[172:175], v[224:227]
s_waitcnt lgkmcnt(4)
v_mfma_f32_16x16x32_bf16 v[132:135], v[80:83], a[160:163], v[132:135]
s_add_u32 s92, s92, s93
ds_read_b64_tr_b16 v[72:73], v47 offset:16384
s_add_u32 m0, s33, 32768
v_mfma_f32_16x16x32_bf16 v[132:135], v[84:87], a[176:179], v[132:135]
ds_read_b64_tr_b16 v[74:75], v47 offset:16896
s_add_u32 s23, s20, 4096
v_mfma_f32_16x16x32_bf16 v[164:167], v[84:87], a[180:183], v[164:167]
ds_read_b64_tr_b16 v[76:77], v47 offset:20480
v_mfma_f32_16x16x32_bf16 v[164:167], v[80:83], a[164:167], v[164:167]
buffer_load_dwordx4 v1, s[16:19], s20 offen offset:0 sc1 lds
v_mfma_f32_16x16x32_bf16 v[196:199], v[80:83], a[168:171], v[196:199]
ds_read_b64_tr_b16 v[78:79], v47 offset:20992
s_mul_i32 s93, s5, 73728
v_mfma_f32_16x16x32_bf16 v[196:199], v[84:87], a[184:187], v[196:199]
buffer_load_dwordx4 v1, s[16:19], s20 offen offset:1024 sc1 lds
v_mfma_f32_16x16x32_bf16 v[228:231], v[84:87], a[188:191], v[228:231]
v_mfma_f32_16x16x32_bf16 v[228:231], v[80:83], a[172:175], v[228:231]
s_waitcnt lgkmcnt(4)
s_add_u32 s93, s93, 4718592
v_mfma_f32_16x16x32_bf16 v[136:139], v[64:67], a[160:163], v[136:139]
ds_read_b64_tr_b16 v[80:81], v44 offset:24576
v_mfma_f32_16x16x32_bf16 v[136:139], v[68:71], a[176:179], v[136:139]
ds_read_b64_tr_b16 v[82:83], v44 offset:25088
v_mfma_f32_16x16x32_bf16 v[168:171], v[68:71], a[180:183], v[168:171]
ds_read_b64_tr_b16 v[84:85], v44 offset:28672
s_mul_i32 s94, s4, 5
v_mfma_f32_16x16x32_bf16 v[168:171], v[64:67], a[164:167], v[168:171]
buffer_load_dwordx4 v1, s[16:19], s20 offen offset:2048 sc1 lds
v_mfma_f32_16x16x32_bf16 v[200:203], v[64:67], a[168:171], v[200:203]
ds_read_b64_tr_b16 v[86:87], v44 offset:29184
v_mfma_f32_16x16x32_bf16 v[200:203], v[68:71], a[184:187], v[200:203]
v_mfma_f32_16x16x32_bf16 v[232:235], v[68:71], a[188:191], v[232:235]
buffer_load_dwordx4 v1, s[16:19], s20 offen offset:3072 sc1 lds
v_mfma_f32_16x16x32_bf16 v[232:235], v[64:67], a[172:175], v[232:235]
s_waitcnt lgkmcnt(4)
s_sub_u32 s94, s94, 36
v_mfma_f32_16x16x32_bf16 v[140:143], v[72:75], a[160:163], v[140:143]
ds_read_b64_tr_b16 v[64:65], v45 offset:24576
v_mfma_f32_16x16x32_bf16 v[140:143], v[76:79], a[176:179], v[140:143]
ds_read_b64_tr_b16 v[66:67], v45 offset:25088
v_min_u32 v24, 40, v0
v_mfma_f32_16x16x32_bf16 v[172:175], v[76:79], a[180:183], v[172:175]
ds_read_b64_tr_b16 v[68:69], v45 offset:28672
v_mfma_f32_16x16x32_bf16 v[172:175], v[72:75], a[164:167], v[172:175]
s_add_u32 m0, s33, 36864
s_add_u32 s20, s20, s21
v_mfma_f32_16x16x32_bf16 v[204:207], v[72:75], a[168:171], v[204:207]
ds_read_b64_tr_b16 v[70:71], v45 offset:29184
v_mfma_f32_16x16x32_bf16 v[204:207], v[76:79], a[184:187], v[204:207]
buffer_load_dwordx4 v1, s[16:19], s23 offen offset:0 sc1 lds
v_mfma_f32_16x16x32_bf16 v[236:239], v[76:79], a[188:191], v[236:239]
v_add_u32 v24, s94, v24
v_mfma_f32_16x16x32_bf16 v[236:239], v[72:75], a[172:175], v[236:239]
s_waitcnt lgkmcnt(4)
v_mfma_f32_16x16x32_bf16 v[144:147], v[80:83], a[160:163], v[144:147]
ds_read_b64_tr_b16 v[72:73], v46 offset:24576
v_min_u32 v24, 575, v24
v_mfma_f32_16x16x32_bf16 v[144:147], v[84:87], a[176:179], v[144:147]
ds_read_b64_tr_b16 v[74:75], v46 offset:25088
v_mfma_f32_16x16x32_bf16 v[176:179], v[84:87], a[180:183], v[176:179]
ds_read_b64_tr_b16 v[76:77], v46 offset:28672
v_mfma_f32_16x16x32_bf16 v[176:179], v[80:83], a[164:167], v[176:179]
buffer_load_dwordx4 v1, s[16:19], s23 offen offset:1024 sc1 lds
v_mfma_f32_16x16x32_bf16 v[208:211], v[80:83], a[168:171], v[208:211]
ds_read_b64_tr_b16 v[78:79], v46 offset:29184
v_lshl_add_u32 v24, v24, 7, s93
v_mfma_f32_16x16x32_bf16 v[208:211], v[84:87], a[184:187], v[208:211]
buffer_load_dwordx4 v1, s[16:19], s23 offen offset:2048 sc1 lds
v_mfma_f32_16x16x32_bf16 v[240:243], v[84:87], a[188:191], v[240:243]
v_mfma_f32_16x16x32_bf16 v[240:243], v[80:83], a[172:175], v[240:243]
s_waitcnt lgkmcnt(4)
v_lshl_add_u32 v25, v0, 7, s92
v_mfma_f32_16x16x32_bf16 v[148:151], v[64:67], a[160:163], v[148:151]
ds_read_b64_tr_b16 v[80:81], v47 offset:24576
v_mfma_f32_16x16x32_bf16 v[148:151], v[68:71], a[176:179], v[148:151]
ds_read_b64_tr_b16 v[82:83], v47 offset:25088
v_mfma_f32_16x16x32_bf16 v[180:183], v[68:71], a[180:183], v[180:183]
ds_read_b64_tr_b16 v[84:85], v47 offset:28672
v_mfma_f32_16x16x32_bf16 v[180:183], v[64:67], a[164:167], v[180:183]
buffer_load_dwordx4 v1, s[16:19], s23 offen offset:3072 sc1 lds
v_mfma_f32_16x16x32_bf16 v[212:215], v[64:67], a[168:171], v[212:215]
ds_read_b64_tr_b16 v[86:87], v47 offset:29184
v_cmp_gt_u32 s[96:97], 36, v0
v_mfma_f32_16x16x32_bf16 v[212:215], v[68:71], a[184:187], v[212:215]
s_add_u32 m0, s42, 49152
s_add_u32 s23, s20, 4096
v_mfma_f32_16x16x32_bf16 v[244:247], v[68:71], a[188:191], v[244:247]
buffer_load_dwordx4 v1, s[16:19], s20 offen offset:0 sc1 lds
v_mfma_f32_16x16x32_bf16 v[244:247], v[64:67], a[172:175], v[244:247]
s_waitcnt lgkmcnt(4)
s_barrier
v_mfma_f32_16x16x32_bf16 v[152:155], v[72:75], a[160:163], v[152:155]
ds_read_b64_tr_b16 v[64:65], v36 offset:0
s_mul_i32 s92, s4, 46080
v_mfma_f32_16x16x32_bf16 v[152:155], v[76:79], a[176:179], v[152:155]
ds_read_b64_tr_b16 v[66:67], v36 offset:512
v_mfma_f32_16x16x32_bf16 v[184:187], v[76:79], a[180:183], v[184:187]
ds_read_b64_tr_b16 v[68:69], v36 offset:4096
s_lshl_b32 s93, s5, 10
v_mfma_f32_16x16x32_bf16 v[184:187], v[72:75], a[164:167], v[184:187]
buffer_load_dwordx4 v1, s[16:19], s20 offen offset:1024 sc1 lds
v_mfma_f32_16x16x32_bf16 v[216:219], v[72:75], a[168:171], v[216:219]
ds_read_b64_tr_b16 v[70:71], v36 offset:4608
v_mfma_f32_16x16x32_bf16 v[216:219], v[76:79], a[184:187], v[216:219]
v_cndmask_b32 v24, v24, v25, s[96:97]
v_mfma_f32_16x16x32_bf16 v[248:251], v[76:79], a[188:191], v[248:251]
buffer_load_dwordx4 v1, s[16:19], s20 offen offset:2048 sc1 lds
v_mfma_f32_16x16x32_bf16 v[248:251], v[72:75], a[172:175], v[248:251]
s_waitcnt lgkmcnt(4)
v_mfma_f32_16x16x32_bf16 v[156:159], v[80:83], a[160:163], v[156:159]
ds_read_b64_tr_b16 v[72:73], v37 offset:0
v_mfma_f32_16x16x32_bf16 v[156:159], v[84:87], a[176:179], v[156:159]
ds_read_b64_tr_b16 v[74:75], v37 offset:512
s_add_u32 s93, s92, s93
v_mfma_f32_16x16x32_bf16 v[188:191], v[84:87], a[180:183], v[188:191]
ds_read_b64_tr_b16 v[76:77], v37 offset:4096
v_mfma_f32_16x16x32_bf16 v[188:191], v[80:83], a[164:167], v[188:191]
buffer_load_dwordx4 v1, s[16:19], s20 offen offset:3072 sc1 lds
v_mfma_f32_16x16x32_bf16 v[220:223], v[80:83], a[168:171], v[220:223]
ds_read_b64_tr_b16 v[78:79], v37 offset:4608
v_accvgpr_write_b32 a57, v24
v_mfma_f32_16x16x32_bf16 v[220:223], v[84:87], a[184:187], v[220:223]
v_mfma_f32_16x16x32_bf16 v[252:255], v[84:87], a[188:191], v[252:255]
v_mfma_f32_16x16x32_bf16 v[252:255], v[80:83], a[172:175], v[252:255]
s_waitcnt lgkmcnt(4)
v_mfma_f32_16x16x32_bf16 v[128:131], v[64:67], a[192:195], v[128:131]
s_lshl_b32 s5, s5, 7
ds_read_b64_tr_b16 v[80:81], v38 offset:0
s_add_u32 m0, s42, 53248
v_mfma_f32_16x16x32_bf16 v[128:131], v[68:71], a[208:211], v[128:131]
ds_read_b64_tr_b16 v[82:83], v38 offset:512
s_add_u32 s20, s20, s21
v_mfma_f32_16x16x32_bf16 v[160:163], v[68:71], a[212:215], v[160:163]
ds_read_b64_tr_b16 v[84:85], v38 offset:4096
v_mfma_f32_16x16x32_bf16 v[160:163], v[64:67], a[196:199], v[160:163]
buffer_load_dwordx4 v1, s[16:19], s23 offen offset:0 sc1 lds
v_mfma_f32_16x16x32_bf16 v[192:195], v[64:67], a[200:203], v[192:195]
ds_read_b64_tr_b16 v[86:87], v38 offset:4608
s_add_u32 s92, s92, s5
v_mfma_f32_16x16x32_bf16 v[192:195], v[68:71], a[216:219], v[192:195]
buffer_load_dwordx4 v1, s[16:19], s23 offen offset:1024 sc1 lds
v_mfma_f32_16x16x32_bf16 v[224:227], v[68:71], a[220:223], v[224:227]
v_mfma_f32_16x16x32_bf16 v[224:227], v[64:67], a[204:207], v[224:227]
s_waitcnt lgkmcnt(4)
s_sub_u32 s92, s92, 360448
v_mfma_f32_16x16x32_bf16 v[132:135], v[72:75], a[192:195], v[132:135]
ds_read_b64_tr_b16 v[64:65], v39 offset:0
v_mfma_f32_16x16x32_bf16 v[132:135], v[76:79], a[208:211], v[132:135]
ds_read_b64_tr_b16 v[66:67], v39 offset:512
v_mfma_f32_16x16x32_bf16 v[164:167], v[76:79], a[212:215], v[164:167]
ds_read_b64_tr_b16 v[68:69], v39 offset:4096
v_min_u32 v24, 44, v0
v_mfma_f32_16x16x32_bf16 v[164:167], v[72:75], a[196:199], v[164:167]
buffer_load_dwordx4 v1, s[16:19], s23 offen offset:2048 sc1 lds
v_mfma_f32_16x16x32_bf16 v[196:199], v[72:75], a[200:203], v[196:199]
ds_read_b64_tr_b16 v[70:71], v39 offset:4608
v_mfma_f32_16x16x32_bf16 v[196:199], v[76:79], a[216:219], v[196:199]
buffer_load_dwordx4 v1, s[16:19], s23 offen offset:3072 sc1 lds
v_mfma_f32_16x16x32_bf16 v[228:231], v[76:79], a[220:223], v[228:231]
v_cmp_gt_u32 s[96:97], 40, v0
v_mfma_f32_16x16x32_bf16 v[228:231], v[72:75], a[204:207], v[228:231]
s_waitcnt lgkmcnt(4)
v_mfma_f32_16x16x32_bf16 v[136:139], v[80:83], a[192:195], v[136:139]
ds_read_b64_tr_b16 v[72:73], v36 offset:8192
v_mfma_f32_16x16x32_bf16 v[136:139], v[84:87], a[208:211], v[136:139]
ds_read_b64_tr_b16 v[74:75], v36 offset:8704
v_mul_u32_u24 v24, 9216, v24
v_mfma_f32_16x16x32_bf16 v[168:171], v[84:87], a[212:215], v[168:171]
ds_read_b64_tr_b16 v[76:77], v36 offset:12288
v_mfma_f32_16x16x32_bf16 v[168:171], v[80:83], a[196:199], v[168:171]
buffer_load_dwordx4 a[16:19], v1, s[12:15], s44 offen offset:1024 sc1
v_mfma_f32_16x16x32_bf16 v[200:203], v[80:83], a[200:203], v[200:203]
ds_read_b64_tr_b16 v[78:79], v36 offset:12800
v_mfma_f32_16x16x32_bf16 v[200:203], v[84:87], a[216:219], v[200:203]
v_lshrrev_b32 v25, 3, v0
v_mfma_f32_16x16x32_bf16 v[232:235], v[84:87], a[220:223], v[232:235]
v_mfma_f32_16x16x32_bf16 v[232:235], v[80:83], a[204:207], v[232:235]
s_waitcnt lgkmcnt(4)
v_mfma_f32_16x16x32_bf16 v[140:143], v[64:67], a[192:195], v[140:143]
ds_read_b64_tr_b16 v[80:81], v37 offset:8192
v_mul_u32_u24 v25, 72, v25
v_mfma_f32_16x16x32_bf16 v[140:143], v[68:71], a[208:211], v[140:143]
ds_read_b64_tr_b16 v[82:83], v37 offset:8704
v_mfma_f32_16x16x32_bf16 v[172:175], v[68:71], a[212:215], v[172:175]
ds_read_b64_tr_b16 v[84:85], v37 offset:12288
v_mfma_f32_16x16x32_bf16 v[172:175], v[64:67], a[196:199], v[172:175]
buffer_load_dwordx4 a[20:23], v1, s[12:15], s45 offen offset:1024 sc1
v_mfma_f32_16x16x32_bf16 v[204:207], v[64:67], a[200:203], v[204:207]
ds_read_b64_tr_b16 v[86:87], v37 offset:12800
v_and_b32 v26, 7, v0
v_mfma_f32_16x16x32_bf16 v[204:207], v[68:71], a[216:219], v[204:207]
buffer_load_dwordx4 a[24:27], v1, s[12:15], s46 offen offset:1024 sc1
v_mfma_f32_16x16x32_bf16 v[236:239], v[68:71], a[220:223], v[236:239]
v_mfma_f32_16x16x32_bf16 v[236:239], v[64:67], a[204:207], v[236:239]
s_waitcnt lgkmcnt(4)
v_add_lshl_u32 v25, v25, v26, 7
v_mfma_f32_16x16x32_bf16 v[144:147], v[72:75], a[192:195], v[144:147]
ds_read_b64_tr_b16 v[64:65], v38 offset:8192
v_mfma_f32_16x16x32_bf16 v[144:147], v[76:79], a[208:211], v[144:147]
ds_read_b64_tr_b16 v[66:67], v38 offset:8704
v_mfma_f32_16x16x32_bf16 v[176:179], v[76:79], a[212:215], v[176:179]
ds_read_b64_tr_b16 v[68:69], v38 offset:12288
v_mfma_f32_16x16x32_bf16 v[176:179], v[72:75], a[196:199], v[176:179]
buffer_load_dwordx4 a[28:31], v1, s[12:15], s47 offen offset:1024 sc1
v_mfma_f32_16x16x32_bf16 v[208:211], v[72:75], a[200:203], v[208:211]
ds_read_b64_tr_b16 v[70:71], v38 offset:12800
v_add_u32 v24, s92, v24
v_mfma_f32_16x16x32_bf16 v[208:211], v[76:79], a[216:219], v[208:211]
v_mfma_f32_16x16x32_bf16 v[240:243], v[76:79], a[220:223], v[240:243]
v_add_u32 v25, s93, v25
v_mfma_f32_16x16x32_bf16 v[240:243], v[72:75], a[204:207], v[240:243]
s_waitcnt lgkmcnt(4)
v_mfma_f32_16x16x32_bf16 v[148:151], v[80:83], a[192:195], v[148:151]
ds_read_b64_tr_b16 v[72:73], v39 offset:8192
v_mfma_f32_16x16x32_bf16 v[148:151], v[84:87], a[208:211], v[148:151]
ds_read_b64_tr_b16 v[74:75], v39 offset:8704
v_mfma_f32_16x16x32_bf16 v[180:183], v[84:87], a[212:215], v[180:183]
ds_read_b64_tr_b16 v[76:77], v39 offset:12288
v_cndmask_b32 v25, v24, v25, s[96:97]
v_mfma_f32_16x16x32_bf16 v[180:183], v[80:83], a[196:199], v[180:183]
v_mfma_f32_16x16x32_bf16 v[212:215], v[80:83], a[200:203], v[212:215]
ds_read_b64_tr_b16 v[78:79], v39 offset:12800
v_mfma_f32_16x16x32_bf16 v[212:215], v[84:87], a[216:219], v[212:215]
v_accvgpr_write_b32 a58, v25
v_mfma_f32_16x16x32_bf16 v[244:247], v[84:87], a[220:223], v[244:247]
v_mfma_f32_16x16x32_bf16 v[244:247], v[80:83], a[204:207], v[244:247]
s_waitcnt lgkmcnt(4)
s_barrier
v_mfma_f32_16x16x32_bf16 v[152:155], v[64:67], a[192:195], v[152:155]
ds_read_b64_tr_b16 v[80:81], v36 offset:16384
v_mfma_f32_16x16x32_bf16 v[152:155], v[68:71], a[208:211], v[152:155]
ds_read_b64_tr_b16 v[82:83], v36 offset:16896
v_and_b32 v24, 3, v0
v_mfma_f32_16x16x32_bf16 v[184:187], v[68:71], a[212:215], v[184:187]
ds_read_b64_tr_b16 v[84:85], v36 offset:20480
v_mfma_f32_16x16x32_bf16 v[184:187], v[64:67], a[196:199], v[184:187]
v_mfma_f32_16x16x32_bf16 v[216:219], v[64:67], a[200:203], v[216:219]
ds_read_b64_tr_b16 v[86:87], v36 offset:20992
v_lshlrev_b32 v24, 10, v24
v_mfma_f32_16x16x32_bf16 v[216:219], v[68:71], a[216:219], v[216:219]
v_mfma_f32_16x16x32_bf16 v[248:251], v[68:71], a[220:223], v[248:251]
v_mfma_f32_16x16x32_bf16 v[248:251], v[64:67], a[204:207], v[248:251]
s_waitcnt lgkmcnt(4)
v_mfma_f32_16x16x32_bf16 v[156:159], v[72:75], a[192:195], v[156:159]
ds_read_b64_tr_b16 v[64:65], v37 offset:16384
v_and_b32 v25, 4, v0
v_mfma_f32_16x16x32_bf16 v[156:159], v[76:79], a[208:211], v[156:159]
ds_read_b64_tr_b16 v[66:67], v37 offset:16896
v_mfma_f32_16x16x32_bf16 v[188:191], v[76:79], a[212:215], v[188:191]
ds_read_b64_tr_b16 v[68:69], v37 offset:20480
v_mfma_f32_16x16x32_bf16 v[188:191], v[72:75], a[196:199], v[188:191]
v_add3_u32 v24, v24, v25, 8
v_mfma_f32_16x16x32_bf16 v[220:223], v[72:75], a[200:203], v[220:223]
ds_read_b64_tr_b16 v[70:71], v37 offset:20992
v_mfma_f32_16x16x32_bf16 v[220:223], v[76:79], a[216:219], v[220:223]
v_mfma_f32_16x16x32_bf16 v[252:255], v[76:79], a[220:223], v[252:255]
v_mfma_f32_16x16x32_bf16 v[252:255], v[72:75], a[204:207], v[252:255]
s_waitcnt vmcnt(24) lgkmcnt(4)
s_barrier
v_mfma_f32_16x16x32_bf16 v[128:131], v[80:83], a[224:227], v[128:131]
ds_read_b64_tr_b16 v[72:73], v38 offset:16384
v_accvgpr_write_b32 a59, v24
v_mfma_f32_16x16x32_bf16 v[128:131], v[84:87], a[240:243], v[128:131]
ds_read_b64_tr_b16 v[74:75], v38 offset:16896
ds_read_b64_tr_b16 a[128:129], v40 offset:32768
v_mfma_f32_16x16x32_bf16 v[160:163], v[84:87], a[244:247], v[160:163]
s_lshl_b32 s4, s2, 11
ds_read_b64_tr_b16 v[76:77], v38 offset:20480
ds_read_b64_tr_b16 a[130:131], v40 offset:33280
v_mfma_f32_16x16x32_bf16 v[160:163], v[80:83], a[228:231], v[160:163]
ds_read_b64_tr_b16 a[132:133], v41 offset:32768
ds_read_b64_tr_b16 a[134:135], v41 offset:33280
v_mfma_f32_16x16x32_bf16 v[192:195], v[80:83], a[232:235], v[192:195]
s_add_u32 m0, s22, 0
ds_read_b64_tr_b16 v[78:79], v38 offset:20992
ds_read_b64_tr_b16 a[136:137], v42 offset:32768
v_mfma_f32_16x16x32_bf16 v[192:195], v[84:87], a[248:251], v[192:195]
s_add_u32 s23, s20, 4096
ds_read_b64_tr_b16 a[138:139], v42 offset:33280
ds_read_b64_tr_b16 a[140:141], v43 offset:32768
v_mfma_f32_16x16x32_bf16 v[224:227], v[84:87], a[252:255], v[224:227]
s_and_b32 s4, s4, 0xc000
ds_read_b64_tr_b16 a[142:143], v43 offset:33280
ds_read_b64_tr_b16 a[144:145], v40 offset:40960
v_mfma_f32_16x16x32_bf16 v[224:227], v[80:83], a[236:239], v[224:227]
s_waitcnt lgkmcnt(13)
ds_read_b64_tr_b16 a[146:147], v40 offset:41472
ds_read_b64_tr_b16 a[148:149], v41 offset:40960
v_mfma_f32_16x16x32_bf16 v[132:135], v[64:67], a[224:227], v[132:135]
ds_read_b64_tr_b16 v[80:81], v39 offset:16384
ds_read_b64_tr_b16 a[150:151], v41 offset:41472
v_mfma_f32_16x16x32_bf16 v[132:135], v[68:71], a[240:243], v[132:135]
s_lshl_b32 s5, s3, 12
ds_read_b64_tr_b16 v[82:83], v39 offset:16896
ds_read_b64_tr_b16 a[152:153], v42 offset:40960
v_mfma_f32_16x16x32_bf16 v[164:167], v[68:71], a[244:247], v[164:167]
ds_read_b64_tr_b16 v[84:85], v39 offset:20480
ds_read_b64_tr_b16 a[154:155], v42 offset:41472
v_mfma_f32_16x16x32_bf16 v[164:167], v[64:67], a[228:231], v[164:167]
ds_read_b64_tr_b16 a[156:157], v43 offset:40960
ds_read_b64_tr_b16 a[158:159], v43 offset:41472
v_mfma_f32_16x16x32_bf16 v[196:199], v[64:67], a[232:235], v[196:199]
ds_read_b64_tr_b16 v[86:87], v39 offset:20992
ds_read_b64_tr_b16 a[160:161], v40 offset:36864
v_mfma_f32_16x16x32_bf16 v[196:199], v[68:71], a[248:251], v[196:199]
s_or_b32 s4, s4, s5
ds_read_b64_tr_b16 a[162:163], v40 offset:37376
ds_read_b64_tr_b16 a[164:165], v41 offset:36864
v_mfma_f32_16x16x32_bf16 v[228:231], v[68:71], a[252:255], v[228:231]
ds_read_b64_tr_b16 a[166:167], v41 offset:37376
ds_read_b64_tr_b16 a[168:169], v42 offset:36864
v_mfma_f32_16x16x32_bf16 v[228:231], v[64:67], a[236:239], v[228:231]
s_waitcnt lgkmcnt(15)
ds_read_b64_tr_b16 a[170:171], v42 offset:37376
ds_read_b64_tr_b16 a[172:173], v43 offset:36864
v_mfma_f32_16x16x32_bf16 v[136:139], v[72:75], a[224:227], v[136:139]
ds_read_b64_tr_b16 v[64:65], v36 offset:24576
ds_read_b64_tr_b16 a[174:175], v43 offset:37376
v_mfma_f32_16x16x32_bf16 v[136:139], v[76:79], a[240:243], v[136:139]
ds_read_b64_tr_b16 v[66:67], v36 offset:25088
ds_read_b64_tr_b16 a[176:177], v40 offset:45056
v_mfma_f32_16x16x32_bf16 v[168:171], v[76:79], a[244:247], v[168:171]
ds_read_b64_tr_b16 v[68:69], v36 offset:28672
ds_read_b64_tr_b16 a[178:179], v40 offset:45568
v_mfma_f32_16x16x32_bf16 v[168:171], v[72:75], a[228:231], v[168:171]
ds_read_b64_tr_b16 a[180:181], v41 offset:45056
ds_read_b64_tr_b16 a[182:183], v41 offset:45568
v_mfma_f32_16x16x32_bf16 v[200:203], v[72:75], a[232:235], v[200:203]
ds_read_b64_tr_b16 v[70:71], v36 offset:29184
ds_read_b64_tr_b16 a[184:185], v42 offset:45056
v_mfma_f32_16x16x32_bf16 v[200:203], v[76:79], a[248:251], v[200:203]
ds_read_b64_tr_b16 a[186:187], v42 offset:45568
ds_read_b64_tr_b16 a[188:189], v43 offset:45056
v_mfma_f32_16x16x32_bf16 v[232:235], v[76:79], a[252:255], v[232:235]
ds_read_b64_tr_b16 a[190:191], v43 offset:45568
v_lshl_add_u32 v24, v1, 2, s4
v_mfma_f32_16x16x32_bf16 v[232:235], v[72:75], a[236:239], v[232:235]
s_waitcnt lgkmcnt(15)
v_min_u32 v24, L_kt_last-L_kt_entry, v24
v_accvgpr_write_b32 a60, v24
v_mfma_f32_16x16x32_bf16 v[140:143], v[80:83], a[224:227], v[140:143]
ds_read_b64_tr_b16 v[72:73], v37 offset:24576
v_mfma_f32_16x16x32_bf16 v[140:143], v[84:87], a[240:243], v[140:143]
ds_read_b64_tr_b16 v[74:75], v37 offset:25088
v_mfma_f32_16x16x32_bf16 v[172:175], v[84:87], a[244:247], v[172:175]
ds_read_b64_tr_b16 v[76:77], v37 offset:28672
v_mfma_f32_16x16x32_bf16 v[172:175], v[80:83], a[228:231], v[172:175]
buffer_load_dwordx4 v1, s[16:19], s20 offen offset:0 sc1 lds
v_mfma_f32_16x16x32_bf16 v[204:207], v[80:83], a[232:235], v[204:207]
ds_read_b64_tr_b16 v[78:79], v37 offset:29184
v_accvgpr_write_b32 a40, 0
v_mfma_f32_16x16x32_bf16 v[204:207], v[84:87], a[248:251], v[204:207]
buffer_load_dwordx4 v1, s[16:19], s20 offen offset:1024 sc1 lds
v_mfma_f32_16x16x32_bf16 v[236:239], v[84:87], a[252:255], v[236:239]
buffer_load_dwordx4 v1, s[16:19], s20 offen offset:2048 sc1 lds
v_mfma_f32_16x16x32_bf16 v[236:239], v[80:83], a[236:239], v[236:239]
s_waitcnt lgkmcnt(8)
s_mov_b32 s94, 5308416
v_mfma_f32_16x16x32_bf16 v[144:147], v[64:67], a[224:227], v[144:147]
ds_read_b64_tr_b16 v[80:81], v38 offset:24576
v_mfma_f32_16x16x32_bf16 v[144:147], v[68:71], a[240:243], v[144:147]
ds_read_b64_tr_b16 v[82:83], v38 offset:25088
v_mfma_f32_16x16x32_bf16 v[176:179], v[68:71], a[244:247], v[176:179]
ds_read_b64_tr_b16 v[84:85], v38 offset:28672
s_mov_b32 s95, 0x20000
v_mfma_f32_16x16x32_bf16 v[176:179], v[64:67], a[228:231], v[176:179]
s_andn2_b32 s7, s2, 24
s_lshl_b32 s7, s7, 7
s_add_u32 s7, s7, 123797504
v_mfma_f32_16x16x32_bf16 v[208:211], v[64:67], a[232:235], v[208:211]
ds_read_b64_tr_b16 v[86:87], v38 offset:29184
v_mfma_f32_16x16x32_bf16 v[208:211], v[68:71], a[248:251], v[208:211]
buffer_load_dwordx4 v1, s[16:19], s20 offen offset:3072 sc1 lds
v_mfma_f32_16x16x32_bf16 v[240:243], v[68:71], a[252:255], v[240:243]
s_add_u32 m0, s22, 4096
s_add_u32 s20, s20, s21
v_mfma_f32_16x16x32_bf16 v[240:243], v[64:67], a[236:239], v[240:243]
s_waitcnt lgkmcnt(4)
v_mfma_f32_16x16x32_bf16 v[148:151], v[72:75], a[224:227], v[148:151]
ds_read_b64_tr_b16 v[64:65], v39 offset:24576
v_mfma_f32_16x16x32_bf16 v[148:151], v[76:79], a[240:243], v[148:151]
ds_read_b64_tr_b16 v[66:67], v39 offset:25088
v_mfma_f32_16x16x32_bf16 v[180:183], v[76:79], a[244:247], v[180:183]
ds_read_b64_tr_b16 v[68:69], v39 offset:28672
v_mfma_f32_16x16x32_bf16 v[180:183], v[72:75], a[228:231], v[180:183]
buffer_load_dwordx4 v1, s[16:19], s23 offen offset:0 sc1 lds
v_mfma_f32_16x16x32_bf16 v[212:215], v[72:75], a[232:235], v[212:215]
ds_read_b64_tr_b16 v[70:71], v39 offset:29184
v_mfma_f32_16x16x32_bf16 v[212:215], v[76:79], a[248:251], v[212:215]
buffer_load_dwordx4 v1, s[16:19], s23 offen offset:1024 sc1 lds
v_mfma_f32_16x16x32_bf16 v[244:247], v[76:79], a[252:255], v[244:247]
buffer_load_dwordx4 v1, s[16:19], s23 offen offset:2048 sc1 lds
v_mfma_f32_16x16x32_bf16 v[244:247], v[72:75], a[236:239], v[244:247]
s_waitcnt lgkmcnt(4)
v_mfma_f32_16x16x32_bf16 v[152:155], v[80:83], a[224:227], v[152:155]
buffer_load_dwordx4 v1, s[16:19], s23 offen offset:3072 sc1 lds
v_mfma_f32_16x16x32_bf16 v[152:155], v[84:87], a[240:243], v[152:155]
v_mfma_f32_16x16x32_bf16 v[184:187], v[84:87], a[244:247], v[184:187]
v_mfma_f32_16x16x32_bf16 v[184:187], v[80:83], a[228:231], v[184:187]
v_mfma_f32_16x16x32_bf16 v[216:219], v[80:83], a[232:235], v[216:219]
v_mfma_f32_16x16x32_bf16 v[216:219], v[84:87], a[248:251], v[216:219]
v_mfma_f32_16x16x32_bf16 v[248:251], v[84:87], a[252:255], v[248:251]
v_mfma_f32_16x16x32_bf16 v[248:251], v[80:83], a[236:239], v[248:251]
s_waitcnt lgkmcnt(0)
v_mfma_f32_16x16x32_bf16 v[156:159], v[64:67], a[224:227], v[156:159]
v_mfma_f32_16x16x32_bf16 v[156:159], v[68:71], a[240:243], v[156:159]
v_mfma_f32_16x16x32_bf16 v[188:191], v[68:71], a[244:247], v[188:191]
v_mfma_f32_16x16x32_bf16 v[188:191], v[64:67], a[228:231], v[188:191]
v_mfma_f32_16x16x32_bf16 v[220:223], v[64:67], a[232:235], v[220:223]
v_mfma_f32_16x16x32_bf16 v[220:223], v[68:71], a[248:251], v[220:223]
v_mfma_f32_16x16x32_bf16 v[252:255], v[68:71], a[252:255], v[252:255]
v_mfma_f32_16x16x32_bf16 v[252:255], v[64:67], a[236:239], v[252:255]
s_waitcnt vmcnt(8)
s_barrier
v_mfma_f32_16x16x32_bf16 v[128:131], a[128:131], a[0:3], v[128:131]
s_add_u32 m0, s22, 16384
ds_read_b128 a[64:67], v2 offset:32768
ds_read_b128 a[80:83], v2 offset:36864
v_mfma_f32_16x16x32_bf16 v[128:131], a[160:163], a[16:19], v[128:131]
s_and_b64 s[60:61], s[34:35], s[50:51]
ds_read_b128 a[68:71], v2 offset:33792
ds_read_b128 a[84:87], v2 offset:37888
v_mfma_f32_16x16x32_bf16 v[132:135], a[132:135], a[0:3], v[132:135]
ds_read_b128 a[72:75], v2 offset:34816
ds_read_b128 a[88:91], v2 offset:38912
v_mfma_f32_16x16x32_bf16 v[132:135], a[164:167], a[16:19], v[132:135]
s_add_u32 s23, s20, 4096
ds_read_b128 a[76:79], v2 offset:35840
ds_read_b128 a[92:95], v2 offset:39936
v_mfma_f32_16x16x32_bf16 v[136:139], a[136:139], a[0:3], v[136:139]
v_cndmask_b32 v36, v48, v5, s[60:61]
v_cndmask_b32 v44, v52, v5, s[60:61]
v_mfma_f32_16x16x32_bf16 v[136:139], a[168:171], a[16:19], v[136:139]
v_cndmask_b32 v40, v48, v5, s[50:51]
s_and_b64 s[62:63], s[36:37], s[50:51]
v_mfma_f32_16x16x32_bf16 v[140:143], a[140:143], a[0:3], v[140:143]
v_cndmask_b32 v37, v49, v5, s[62:63]
v_cndmask_b32 v45, v53, v5, s[62:63]
v_mfma_f32_16x16x32_bf16 v[140:143], a[172:175], a[16:19], v[140:143]
v_cndmask_b32 v41, v49, v5, s[50:51]
s_and_b64 s[60:61], s[38:39], s[50:51]
v_mfma_f32_16x16x32_bf16 v[144:147], a[144:147], a[0:3], v[144:147]
v_cndmask_b32 v38, v50, v5, s[60:61]
v_cndmask_b32 v46, v54, v5, s[60:61]
v_mfma_f32_16x16x32_bf16 v[144:147], a[176:179], a[16:19], v[144:147]
v_cndmask_b32 v42, v50, v5, s[50:51]
s_and_b64 s[62:63], s[40:41], s[50:51]
v_mfma_f32_16x16x32_bf16 v[148:151], a[148:151], a[0:3], v[148:151]
v_cndmask_b32 v39, v51, v5, s[62:63]
v_cndmask_b32 v47, v55, v5, s[62:63]
v_mfma_f32_16x16x32_bf16 v[148:151], a[180:183], a[16:19], v[148:151]
v_cndmask_b32 v43, v51, v5, s[50:51]
v_mfma_f32_16x16x32_bf16 v[152:155], a[152:155], a[0:3], v[152:155]
buffer_load_dwordx4 v1, s[16:19], s20 offen offset:0 sc1 lds
v_mfma_f32_16x16x32_bf16 v[152:155], a[184:187], a[16:19], v[152:155]
buffer_load_dwordx4 v1, s[16:19], s20 offen offset:1024 sc1 lds
v_mfma_f32_16x16x32_bf16 v[156:159], a[156:159], a[0:3], v[156:159]
buffer_load_dwordx4 v1, s[16:19], s20 offen offset:2048 sc1 lds
v_mfma_f32_16x16x32_bf16 v[156:159], a[188:191], a[16:19], v[156:159]
v_mfma_f32_16x16x32_bf16 v[160:163], a[128:131], a[4:7], v[160:163]
v_mfma_f32_16x16x32_bf16 v[160:163], a[160:163], a[20:23], v[160:163]
v_cvt_pk_bf16_f32 v128, v128, v129
v_cvt_pk_bf16_f32 v129, v130, v131
v_mfma_f32_16x16x32_bf16 v[164:167], a[132:135], a[4:7], v[164:167]
v_cvt_pk_bf16_f32 v130, v132, v133
v_cvt_pk_bf16_f32 v131, v134, v135
v_mfma_f32_16x16x32_bf16 v[164:167], a[164:167], a[20:23], v[164:167]
v_accvgpr_write_b32 a192, v128
v_accvgpr_write_b32 a193, v129
v_mfma_f32_16x16x32_bf16 v[168:171], a[136:139], a[4:7], v[168:171]
v_accvgpr_write_b32 a194, v130
v_accvgpr_write_b32 a195, v131
v_mfma_f32_16x16x32_bf16 v[168:171], a[168:171], a[20:23], v[168:171]
v_cvt_pk_bf16_f32 v136, v136, v137
v_cvt_pk_bf16_f32 v137, v138, v139
v_mfma_f32_16x16x32_bf16 v[172:175], a[140:143], a[4:7], v[172:175]
v_cvt_pk_bf16_f32 v138, v140, v141
v_cvt_pk_bf16_f32 v139, v142, v143
v_mfma_f32_16x16x32_bf16 v[172:175], a[172:175], a[20:23], v[172:175]
v_accvgpr_write_b32 a196, v136
v_accvgpr_write_b32 a197, v137
v_mfma_f32_16x16x32_bf16 v[176:179], a[144:147], a[4:7], v[176:179]
v_accvgpr_write_b32 a198, v138
v_accvgpr_write_b32 a199, v139
v_mfma_f32_16x16x32_bf16 v[176:179], a[176:179], a[20:23], v[176:179]
v_cvt_pk_bf16_f32 v144, v144, v145
v_cvt_pk_bf16_f32 v145, v146, v147
v_mfma_f32_16x16x32_bf16 v[180:183], a[148:151], a[4:7], v[180:183]
v_cvt_pk_bf16_f32 v146, v148, v149
v_cvt_pk_bf16_f32 v147, v150, v151
v_mfma_f32_16x16x32_bf16 v[180:183], a[180:183], a[20:23], v[180:183]
v_accvgpr_write_b32 a200, v144
v_accvgpr_write_b32 a201, v145
v_mfma_f32_16x16x32_bf16 v[184:187], a[152:155], a[4:7], v[184:187]
v_accvgpr_write_b32 a202, v146
v_accvgpr_write_b32 a203, v147
v_mfma_f32_16x16x32_bf16 v[184:187], a[184:187], a[20:23], v[184:187]
v_cvt_pk_bf16_f32 v152, v152, v153
v_cvt_pk_bf16_f32 v153, v154, v155
v_mfma_f32_16x16x32_bf16 v[188:191], a[156:159], a[4:7], v[188:191]
v_cvt_pk_bf16_f32 v154, v156, v157
v_cvt_pk_bf16_f32 v155, v158, v159
v_mfma_f32_16x16x32_bf16 v[188:191], a[188:191], a[20:23], v[188:191]
v_accvgpr_write_b32 a204, v152
v_accvgpr_write_b32 a205, v153
v_mfma_f32_16x16x32_bf16 v[192:195], a[128:131], a[8:11], v[192:195]
v_accvgpr_write_b32 a206, v154
v_accvgpr_write_b32 a207, v155
v_mfma_f32_16x16x32_bf16 v[192:195], a[160:163], a[24:27], v[192:195]
buffer_load_dwordx4 v1, s[16:19], s20 offen offset:3072 sc1 lds
v_mfma_f32_16x16x32_bf16 v[196:199], a[132:135], a[8:11], v[196:199]
s_add_u32 m0, s22, 20480
s_add_u32 s20, s20, s21
v_cvt_pk_bf16_f32 v160, v160, v161
v_mfma_f32_16x16x32_bf16 v[196:199], a[164:167], a[24:27], v[196:199]
buffer_load_dwordx4 v1, s[16:19], s23 offen offset:0 sc1 lds
v_mfma_f32_16x16x32_bf16 v[200:203], a[136:139], a[8:11], v[200:203]
buffer_load_dwordx4 v1, s[16:19], s23 offen offset:1024 sc1 lds
v_mfma_f32_16x16x32_bf16 v[200:203], a[168:171], a[24:27], v[200:203]
v_cvt_pk_bf16_f32 v161, v162, v163
v_cvt_pk_bf16_f32 v162, v164, v165
v_mfma_f32_16x16x32_bf16 v[204:207], a[140:143], a[8:11], v[204:207]
v_cvt_pk_bf16_f32 v163, v166, v167
v_accvgpr_write_b32 a208, v160
v_mfma_f32_16x16x32_bf16 v[204:207], a[172:175], a[24:27], v[204:207]
v_accvgpr_write_b32 a209, v161
v_accvgpr_write_b32 a210, v162
v_mfma_f32_16x16x32_bf16 v[208:211], a[144:147], a[8:11], v[208:211]
v_accvgpr_write_b32 a211, v163
v_cvt_pk_bf16_f32 v168, v168, v169
v_mfma_f32_16x16x32_bf16 v[208:211], a[176:179], a[24:27], v[208:211]
v_cvt_pk_bf16_f32 v169, v170, v171
v_cvt_pk_bf16_f32 v170, v172, v173
v_mfma_f32_16x16x32_bf16 v[212:215], a[148:151], a[8:11], v[212:215]
v_cvt_pk_bf16_f32 v171, v174, v175
v_accvgpr_write_b32 a212, v168
v_mfma_f32_16x16x32_bf16 v[212:215], a[180:183], a[24:27], v[212:215]
v_accvgpr_write_b32 a213, v169
v_accvgpr_write_b32 a214, v170
v_mfma_f32_16x16x32_bf16 v[216:219], a[152:155], a[8:11], v[216:219]
v_accvgpr_write_b32 a215, v171
v_cvt_pk_bf16_f32 v176, v176, v177
v_mfma_f32_16x16x32_bf16 v[216:219], a[184:187], a[24:27], v[216:219]
v_cvt_pk_bf16_f32 v177, v178, v179
v_cvt_pk_bf16_f32 v178, v180, v181
v_mfma_f32_16x16x32_bf16 v[220:223], a[156:159], a[8:11], v[220:223]
v_cvt_pk_bf16_f32 v179, v182, v183
v_accvgpr_write_b32 a216, v176
v_mfma_f32_16x16x32_bf16 v[220:223], a[188:191], a[24:27], v[220:223]
v_accvgpr_write_b32 a217, v177
v_accvgpr_write_b32 a218, v178
v_mfma_f32_16x16x32_bf16 v[224:227], a[128:131], a[12:15], v[224:227]
v_accvgpr_write_b32 a219, v179
v_cvt_pk_bf16_f32 v184, v184, v185
v_mfma_f32_16x16x32_bf16 v[224:227], a[160:163], a[28:31], v[224:227]
v_cvt_pk_bf16_f32 v185, v186, v187
v_cvt_pk_bf16_f32 v186, v188, v189
v_mfma_f32_16x16x32_bf16 v[228:231], a[132:135], a[12:15], v[228:231]
v_cvt_pk_bf16_f32 v187, v190, v191
v_accvgpr_write_b32 a220, v184
v_mfma_f32_16x16x32_bf16 v[228:231], a[164:167], a[28:31], v[228:231]
v_accvgpr_write_b32 a221, v185
v_accvgpr_write_b32 a222, v186
v_mfma_f32_16x16x32_bf16 v[232:235], a[136:139], a[12:15], v[232:235]
v_accvgpr_write_b32 a223, v187
v_cvt_pk_bf16_f32 v192, v192, v193
v_mfma_f32_16x16x32_bf16 v[232:235], a[168:171], a[28:31], v[232:235]
buffer_load_dwordx4 v1, s[16:19], s23 offen offset:2048 sc1 lds
v_mfma_f32_16x16x32_bf16 v[236:239], a[140:143], a[12:15], v[236:239]
buffer_load_dwordx4 v1, s[16:19], s23 offen offset:3072 sc1 lds
v_mfma_f32_16x16x32_bf16 v[236:239], a[172:175], a[28:31], v[236:239]
v_cvt_pk_bf16_f32 v193, v194, v195
v_cvt_pk_bf16_f32 v194, v196, v197
v_mfma_f32_16x16x32_bf16 v[240:243], a[144:147], a[12:15], v[240:243]
v_cvt_pk_bf16_f32 v195, v198, v199
v_accvgpr_write_b32 a224, v192
v_mfma_f32_16x16x32_bf16 v[240:243], a[176:179], a[28:31], v[240:243]
v_accvgpr_write_b32 a225, v193
v_accvgpr_write_b32 a226, v194
v_mfma_f32_16x16x32_bf16 v[244:247], a[148:151], a[12:15], v[244:247]
v_accvgpr_write_b32 a227, v195
v_cvt_pk_bf16_f32 v200, v200, v201
v_mfma_f32_16x16x32_bf16 v[244:247], a[180:183], a[28:31], v[244:247]
v_cvt_pk_bf16_f32 v201, v202, v203
v_cvt_pk_bf16_f32 v202, v204, v205
v_mfma_f32_16x16x32_bf16 v[248:251], a[152:155], a[12:15], v[248:251]
v_cvt_pk_bf16_f32 v203, v206, v207
v_accvgpr_write_b32 a228, v200
v_mfma_f32_16x16x32_bf16 v[248:251], a[184:187], a[28:31], v[248:251]
v_accvgpr_write_b32 a229, v201
v_accvgpr_write_b32 a230, v202
v_mfma_f32_16x16x32_bf16 v[252:255], a[156:159], a[12:15], v[252:255]
v_accvgpr_write_b32 a231, v203
v_cvt_pk_bf16_f32 v208, v208, v209
v_mfma_f32_16x16x32_bf16 v[252:255], a[188:191], a[28:31], v[252:255]
s_waitcnt lgkmcnt(0)
s_barrier
v_mfma_f32_16x16x32_bf16 v[96:99], a[64:67], a[192:195], v[36:39]
s_add_u32 m0, s22, 32768
ds_read_b128 a[96:99], v2 offset:49152
v_cvt_pk_bf16_f32 v209, v210, v211
v_cvt_pk_bf16_f32 v210, v212, v213
v_mov_b32 v28, 0
v_mfma_f32_16x16x32_bf16 v[96:99], a[68:71], a[196:199], v[96:99]
v_cvt_pk_bf16_f32 v211, v214, v215
v_accvgpr_write_b32 a232, v208
v_mov_b32 v29, 0
v_mov_b32 v30, 0
v_mov_b32 v31, 0
v_mfma_f32_16x16x32_bf16 v[96:99], a[72:75], a[200:203], v[96:99]
s_add_u32 s23, s20, 4096
v_accvgpr_write_b32 a233, v209
v_accvgpr_write_b32 a234, v210
v_mov_b32 v32, 0
v_mov_b32 v33, 0
v_mfma_f32_16x16x32_bf16 v[96:99], a[76:79], a[204:207], v[96:99]
v_accvgpr_write_b32 a235, v211
v_cvt_pk_bf16_f32 v216, v216, v217
v_mov_b32 v34, 0
v_mov_b32 v35, 0
v_mov_b32 v10, v1
v_mfma_f32_16x16x32_bf16 v[100:103], a[80:83], a[192:195], v[40:43]
v_cvt_pk_bf16_f32 v217, v218, v219
v_cvt_pk_bf16_f32 v218, v220, v221
v_mov_b32 v11, v1
v_mov_b32 v12, v1
v_mfma_f32_16x16x32_bf16 v[100:103], a[84:87], a[196:199], v[100:103]
ds_read_b128 a[128:131], v3 offset:57344
ds_read_b128 a[112:115], v2 offset:53248
v_cvt_pk_bf16_f32 v219, v222, v223
v_accvgpr_write_b32 a236, v216
v_mov_b32 v13, v1
v_mfma_f32_16x16x32_bf16 v[100:103], a[88:91], a[200:203], v[100:103]
ds_read_b128 a[132:135], v3 offset:58368
ds_read_b128 a[100:103], v2 offset:50176
v_accvgpr_write_b32 a237, v217
v_accvgpr_write_b32 a238, v218
v_mfma_f32_16x16x32_bf16 v[100:103], a[92:95], a[204:207], v[100:103]
buffer_load_dwordx4 v1, s[16:19], s20 offen offset:0 sc1 lds
ds_read_b128 a[136:139], v3 offset:59392
v_accvgpr_write_b32 a239, v219
v_cvt_pk_bf16_f32 v224, v224, v225
v_mfma_f32_16x16x32_bf16 v[104:107], a[64:67], a[208:211], v[52:55]
v_cvt_pk_bf16_f32 v225, v226, v227
v_cvt_pk_bf16_f32 v226, v228, v229
v_exp_f32 v96, v96
v_mfma_f32_16x16x32_bf16 v[104:107], a[68:71], a[212:215], v[104:107]
ds_read_b128 a[116:119], v2 offset:54272
v_cvt_pk_bf16_f32 v227, v230, v231
v_accvgpr_write_b32 a240, v224
v_exp_f32 v97, v97
v_mfma_f32_16x16x32_bf16 v[104:107], a[72:75], a[216:219], v[104:107]
v_accvgpr_write_b32 a241, v225
v_accvgpr_write_b32 a242, v226
v_exp_f32 v98, v98
v_mfma_f32_16x16x32_bf16 v[104:107], a[76:79], a[220:223], v[104:107]
v_accvgpr_write_b32 a243, v227
v_cvt_pk_bf16_f32 v232, v232, v233
v_exp_f32 v99, v99
v_cvt_pk_bf16_f32 v64, v96, v97
v_mfma_f32_16x16x32_bf16 v[108:111], a[80:83], a[208:211], v[44:47]
buffer_load_dwordx4 v1, s[16:19], s20 offen offset:1024 sc1 lds
v_cvt_pk_bf16_f32 v233, v234, v235
v_cvt_pk_bf16_f32 v234, v236, v237
v_mfma_f32_16x16x32_bf16 v[108:111], a[84:87], a[212:215], v[108:111]
ds_read_b128 a[140:143], v3 offset:60416
ds_read_b128 a[104:107], v2 offset:51200
v_cvt_pk_bf16_f32 v235, v238, v239
v_accvgpr_write_b32 a244, v232
v_cvt_pk_bf16_f32 v65, v98, v99
v_mfma_f32_16x16x32_bf16 v[108:111], a[88:91], a[216:219], v[108:111]
buffer_load_dwordx4 v1, s[16:19], s20 offen offset:2048 sc1 lds
v_accvgpr_write_b32 a245, v233
v_accvgpr_write_b32 a246, v234
v_mfma_f32_16x16x32_bf16 v[108:111], a[92:95], a[220:223], v[108:111]
v_accvgpr_write_b32 a247, v235
v_cvt_pk_bf16_f32 v240, v240, v241
v_exp_f32 v100, v100
v_add_f32 v24, v96, v98
v_mfma_f32_16x16x32_bf16 v[112:115], a[64:67], a[224:227], v[56:59]
v_cvt_pk_bf16_f32 v241, v242, v243
v_cvt_pk_bf16_f32 v242, v244, v245
v_exp_f32 v101, v101
v_mfma_f32_16x16x32_bf16 v[112:115], a[68:71], a[228:231], v[112:115]
v_cvt_pk_bf16_f32 v243, v246, v247
v_accvgpr_write_b32 a248, v240
v_exp_f32 v102, v102
v_add_f32 v25, v97, v99
v_mfma_f32_16x16x32_bf16 v[112:115], a[72:75], a[232:235], v[112:115]
v_accvgpr_write_b32 a249, v241
v_accvgpr_write_b32 a250, v242
v_exp_f32 v103, v103
v_mfma_f32_16x16x32_bf16 v[112:115], a[76:79], a[236:239], v[112:115]
ds_read_b128 a[144:147], v3 offset:61440
buffer_load_dwordx4 v1, s[16:19], s20 offen offset:3072 sc1 lds
v_accvgpr_write_b32 a251, v243
v_cvt_pk_bf16_f32 v248, v248, v249
v_mfma_f32_16x16x32_bf16 v[116:119], a[80:83], a[224:227], v[56:59]
s_add_u32 m0, s22, 36864
v_cvt_pk_bf16_f32 v249, v250, v251
v_cvt_pk_bf16_f32 v250, v252, v253
v_cvt_pk_bf16_f32 v66, v100, v101
v_cvt_pk_bf16_f32 v67, v102, v103
v_mfma_f32_16x16x32_bf16 v[116:119], a[84:87], a[228:231], v[116:119]
s_add_u32 s20, s20, s21
v_cvt_pk_bf16_f32 v251, v254, v255
v_accvgpr_write_b32 a252, v248
v_accvgpr_write_b32 a253, v249
v_accvgpr_write_b32 a254, v250
v_accvgpr_write_b32 a255, v251
v_mfma_f32_16x16x32_bf16 v[116:119], a[88:91], a[232:235], v[116:119]
ds_read_b128 a[120:123], v2 offset:55296
ds_read_b128 a[148:151], v3 offset:62464
v_exp_f32 v104, v104
v_mfma_f32_16x16x32_bf16 v[116:119], a[92:95], a[236:239], v[116:119]
v_exp_f32 v105, v105
v_exp_f32 v106, v106
v_add_f32 v24, v24, v100
v_mfma_f32_16x16x32_bf16 v[120:123], a[64:67], a[240:243], v[60:63]
v_exp_f32 v107, v107
v_add_f32 v25, v25, v101
v_add_f32 v24, v24, v102
v_mfma_f32_16x16x32_bf16 v[120:123], a[68:71], a[244:247], v[120:123]
ds_read_b128 a[108:111], v2 offset:52224
ds_read_b128 a[152:155], v3 offset:63488
v_add_f32 v25, v25, v103
v_cvt_pk_bf16_f32 v68, v104, v105
v_cvt_pk_bf16_f32 v69, v106, v107
v_mfma_f32_16x16x32_bf16 v[120:123], a[72:75], a[248:251], v[120:123]
ds_read_b128 a[124:127], v2 offset:56320
ds_read_b128 a[156:159], v3 offset:64512
buffer_load_dwordx4 v1, s[16:19], s23 offen offset:0 sc1 lds
v_mfma_f32_16x16x32_bf16 v[120:123], a[76:79], a[252:255], v[120:123]
v_exp_f32 v108, v108
v_exp_f32 v109, v109
v_add_f32 v26, v104, v106
v_mfma_f32_16x16x32_bf16 v[124:127], a[80:83], a[240:243], v[60:63]
v_exp_f32 v110, v110
v_exp_f32 v111, v111
v_mfma_f32_16x16x32_bf16 v[124:127], a[84:87], a[244:247], v[124:127]
buffer_load_dwordx4 v1, s[16:19], s23 offen offset:1024 sc1 lds
v_add_f32 v27, v105, v107
v_cvt_pk_bf16_f32 v70, v108, v109
v_cvt_pk_bf16_f32 v71, v110, v111
v_mfma_f32_16x16x32_bf16 v[124:127], a[88:91], a[248:251], v[124:127]
v_exp_f32 v112, v112
v_exp_f32 v113, v113
v_mfma_f32_16x16x32_bf16 v[124:127], a[92:95], a[252:255], v[124:127]
v_exp_f32 v114, v114
v_exp_f32 v115, v115
v_add_f32 v26, v26, v108
v_mfma_f32_32x32x16_bf16 v[128:143], a[32:35], a[32:35], 0
buffer_load_dwordx4 v1, s[16:19], s23 offen offset:2048 sc1 lds
v_add_f32 v27, v27, v109
v_add_f32 v26, v26, v110
v_add_f32 v27, v27, v111
v_cvt_pk_bf16_f32 v72, v112, v113
v_cvt_pk_bf16_f32 v73, v114, v115
v_mfma_f32_32x32x16_bf16 v[144:159], a[32:35], a[32:35], 0
buffer_load_dwordx4 v1, s[16:19], s23 offen offset:3072 sc1 lds
v_exp_f32 v116, v116
v_exp_f32 v117, v117
v_exp_f32 v118, v118
v_mfma_f32_32x32x16_bf16 v[160:175], a[32:35], a[32:35], 0
v_exp_f32 v119, v119
v_cvt_pk_bf16_f32 v74, v116, v117
v_exp_f32 v120, v120
v_exp_f32 v121, v121
v_mfma_f32_32x32x16_bf16 v[176:191], a[32:35], a[32:35], 0
v_cvt_pk_bf16_f32 v75, v118, v119
v_exp_f32 v122, v122
v_exp_f32 v123, v123
v_cvt_pk_bf16_f32 v76, v120, v121
v_exp_f32 v124, v124
v_mfma_f32_32x32x16_bf16 v[192:207], a[32:35], a[32:35], 0
v_cvt_pk_bf16_f32 v77, v122, v123
v_exp_f32 v125, v125
v_exp_f32 v126, v126
v_exp_f32 v127, v127
v_mfma_f32_32x32x16_bf16 v[208:223], a[32:35], a[32:35], 0
s_mov_b64 exec, s[52:53]
ds_write_b128 v4, a[192:195] offset:0
ds_write_b128 v4, a[196:199] offset:1024
ds_write_b128 v4, a[200:203] offset:2048
ds_write_b128 v4, a[204:207] offset:3072
s_mov_b64 exec, -1
v_mfma_f32_32x32x16_bf16 v[224:239], a[32:35], a[32:35], 0
s_mov_b64 exec, s[52:53]
ds_write_b128 v4, a[208:211] offset:4096
ds_write_b128 v4, a[212:215] offset:5120
ds_write_b128 v4, a[216:219] offset:6144
ds_write_b128 v4, a[220:223] offset:7168
s_mov_b64 exec, -1
v_mfma_f32_32x32x16_bf16 v[240:255], a[32:35], a[32:35], 0
v_cvt_pk_bf16_f32 v78, v124, v125
v_cvt_pk_bf16_f32 v79, v126, v127
s_mov_b64 exec, s[52:53]
ds_write_b128 v4, a[224:227] offset:8192
ds_write_b128 v4, a[228:231] offset:9216
ds_write_b128 v4, a[232:235] offset:10240
ds_write_b128 v4, a[236:239] offset:11264
s_mov_b64 exec, -1
s_mov_b64 exec, s[52:53]
ds_write_b128 v4, a[240:243] offset:12288
ds_write_b128 v4, a[244:247] offset:13312
ds_write_b128 v4, a[248:251] offset:14336
ds_write_b128 v4, a[252:255] offset:15360
s_mov_b64 exec, -1
s_cmp_eq_u32 s29, 1
s_cbranch_scc1 L_k2_maxp
s_load_dwordx2 s[8:9], s[0:1], 56
s_load_dwordx2 s[92:93], s[0:1], 64
s_load_dwordx2 s[96:97], s[0:1], 40
s_mov_b32 s10, 5308416
s_mov_b32 s44, s48
s_mov_b32 s45, s49
s_mov_b32 s46, s43
s_mov_b32 s47, 0x20000
s_mul_i32 s50, s2, 3072
s_mov_b32 s51, 0
L_k2_disp:
s_cmp_eq_u32 s26, 0
s_cbranch_scc1 L_k2_exit
L_k2_loop:
s_waitcnt vmcnt(16) lgkmcnt(0)
s_barrier
v_mfma_f32_16x16x32_bf16 v[96:99], a[96:99], a[192:195], v[48:51]
ds_read_b128 a[64:67], v2 offset:0
ds_read_b128 a[160:163], v3 offset:8192
v_mfma_f32_16x16x32_bf16 v[96:99], a[100:103], a[196:199], v[96:99]
buffer_load_dword a44, v19, s[44:47], s50 offen
v_mfma_f32_16x16x32_bf16 v[96:99], a[104:107], a[200:203], v[96:99]
s_add_u32 m0, s22, 49152
s_add_u32 s23, s20, s99
ds_read_b128 a[80:83], v2 offset:4096
v_mfma_f32_16x16x32_bf16 v[96:99], a[108:111], a[204:207], v[96:99]
buffer_load_dwordx4 v10, s[16:19], s20 offen offset:0 sc1 lds
v_mfma_f32_16x16x32_bf16 v[100:103], a[112:115], a[192:195], v[48:51]
ds_read_b128 a[164:167], v3 offset:9216
ds_read_b128 a[68:71], v2 offset:1024
v_mfma_f32_16x16x32_bf16 v[100:103], a[116:119], a[196:199], v[100:103]
buffer_load_dwordx4 v11, s[16:19], s20 offen offset:1024 sc1 lds
v_mfma_f32_16x16x32_bf16 v[100:103], a[120:123], a[200:203], v[100:103]
ds_read_b128 a[168:171], v3 offset:10240
ds_read_b128 a[84:87], v2 offset:5120
v_mfma_f32_16x16x32_bf16 v[100:103], a[124:127], a[204:207], v[100:103]
buffer_load_dwordx4 v12, s[16:19], s20 offen offset:2048 sc1 lds
v_mfma_f32_16x16x32_bf16 v[104:107], a[96:99], a[208:211], v[52:55]
ds_read_b128 a[172:175], v3 offset:11264
ds_read_b128 a[72:75], v2 offset:2048
v_mfma_f32_16x16x32_bf16 v[104:107], a[100:103], a[212:215], v[104:107]
v_exp_f32 v96, v96
v_mfma_f32_16x16x32_bf16 v[104:107], a[104:107], a[216:219], v[104:107]
v_exp_f32 v97, v97
v_mfma_f32_16x16x32_bf16 v[104:107], a[108:111], a[220:223], v[104:107]
v_exp_f32 v98, v98
v_mfma_f32_16x16x32_bf16 v[108:111], a[112:115], a[208:211], v[52:55]
v_exp_f32 v99, v99
v_mfma_f32_16x16x32_bf16 v[108:111], a[116:119], a[212:215], v[108:111]
buffer_load_dwordx4 v13, s[16:19], s20 offen offset:3072 sc1 lds
v_mfma_f32_16x16x32_bf16 v[108:111], a[120:123], a[216:219], v[108:111]
s_add_u32 m0, s22, 53248
s_add_u32 s20, s20, s21
v_cvt_pk_bf16_f32 v80, v96, v97
v_mfma_f32_16x16x32_bf16 v[108:111], a[124:127], a[220:223], v[108:111]
ds_read_b128 a[176:179], v3 offset:12288
v_cvt_pk_bf16_f32 v81, v98, v99
v_mfma_f32_16x16x32_bf16 v[128:131], a[128:131], v[64:67], v[128:131]
buffer_load_dwordx4 v10, s[16:19], s23 offen offset:0 sc1 lds
v_mfma_f32_16x16x32_bf16 v[132:135], a[132:135], v[64:67], v[132:135]
v_exp_f32 v100, v100
v_mfma_f32_16x16x32_bf16 v[136:139], a[136:139], v[64:67], v[136:139]
v_exp_f32 v101, v101
v_mfma_f32_16x16x32_bf16 v[140:143], a[140:143], v[64:67], v[140:143]
v_exp_f32 v102, v102
v_add_f32 v24, v24, v96
v_mfma_f32_16x16x32_bf16 v[144:147], a[144:147], v[64:67], v[144:147]
v_exp_f32 v103, v103
v_mfma_f32_16x16x32_bf16 v[148:151], a[148:151], v[64:67], v[148:151]
v_add_f32 v25, v25, v97
v_add_f32 v24, v24, v98
v_mfma_f32_16x16x32_bf16 v[152:155], a[152:155], v[64:67], v[152:155]
v_add_f32 v25, v25, v99
v_cvt_pk_bf16_f32 v82, v100, v101
v_mfma_f32_16x16x32_bf16 v[156:159], a[156:159], v[64:67], v[156:159]
ds_read_b128 a[88:91], v2 offset:6144
v_cvt_pk_bf16_f32 v83, v102, v103
v_mfma_f32_16x16x32_bf16 v[112:115], a[96:99], a[224:227], v[56:59]
v_exp_f32 v104, v104
v_mfma_f32_16x16x32_bf16 v[112:115], a[100:103], a[228:231], v[112:115]
v_exp_f32 v105, v105
v_mfma_f32_16x16x32_bf16 v[112:115], a[104:107], a[232:235], v[112:115]
v_exp_f32 v106, v106
v_mfma_f32_16x16x32_bf16 v[112:115], a[108:111], a[236:239], v[112:115]
v_exp_f32 v107, v107
v_mfma_f32_16x16x32_bf16 v[116:119], a[112:115], a[224:227], v[56:59]
v_add_f32 v24, v24, v100
v_add_f32 v25, v25, v101
v_mfma_f32_16x16x32_bf16 v[116:119], a[116:119], a[228:231], v[116:119]
v_add_f32 v24, v24, v102
v_add_f32 v25, v25, v103
v_mfma_f32_16x16x32_bf16 v[116:119], a[120:123], a[232:235], v[116:119]
s_add_u32 s50, s50, 786432
v_cvt_pk_bf16_f32 v84, v104, v105
v_cvt_pk_bf16_f32 v85, v106, v107
v_mfma_f32_16x16x32_bf16 v[116:119], a[124:127], a[236:239], v[116:119]
v_exp_f32 v108, v108
v_mfma_f32_16x16x32_bf16 v[160:163], a[128:131], v[68:71], v[160:163]
v_exp_f32 v109, v109
v_mfma_f32_16x16x32_bf16 v[164:167], a[132:135], v[68:71], v[164:167]
v_exp_f32 v110, v110
v_mfma_f32_16x16x32_bf16 v[168:171], a[136:139], v[68:71], v[168:171]
v_exp_f32 v111, v111
v_mfma_f32_16x16x32_bf16 v[172:175], a[140:143], v[68:71], v[172:175]
v_add_f32 v26, v26, v104
v_add_f32 v27, v27, v105
v_mfma_f32_16x16x32_bf16 v[176:179], a[144:147], v[68:71], v[176:179]
v_add_f32 v26, v26, v106
v_add_f32 v27, v27, v107
v_mfma_f32_16x16x32_bf16 v[180:183], a[148:151], v[68:71], v[180:183]
v_cvt_pk_bf16_f32 v86, v108, v109
v_cvt_pk_bf16_f32 v87, v110, v111
v_mfma_f32_16x16x32_bf16 v[184:187], a[152:155], v[68:71], v[184:187]
ds_read_b128 a[180:183], v3 offset:13312
v_add_f32 v26, v26, v108
v_mfma_f32_16x16x32_bf16 v[188:191], a[156:159], v[68:71], v[188:191]
v_add_f32 v27, v27, v109
v_add_f32 v26, v26, v110
v_add_f32 v27, v27, v111
v_mfma_f32_16x16x32_bf16 v[120:123], a[96:99], a[240:243], v[60:63]
buffer_load_dwordx4 v11, s[16:19], s23 offen offset:1024 sc1 lds
v_mfma_f32_16x16x32_bf16 v[120:123], a[100:103], a[244:247], v[120:123]
ds_read_b128 a[76:79], v2 offset:3072
ds_read_b128 a[184:187], v3 offset:14336
v_mfma_f32_16x16x32_bf16 v[120:123], a[104:107], a[248:251], v[120:123]
buffer_store_dwordx4 a[48:51], v1, s[88:91], s100 offen offset:0 sc1
v_mfma_f32_16x16x32_bf16 v[120:123], a[108:111], a[252:255], v[120:123]
v_exp_f32 v112, v112
v_mfma_f32_16x16x32_bf16 v[124:127], a[112:115], a[240:243], v[60:63]
v_exp_f32 v113, v113
v_mfma_f32_16x16x32_bf16 v[124:127], a[116:119], a[244:247], v[124:127]
v_exp_f32 v114, v114
v_mfma_f32_16x16x32_bf16 v[124:127], a[120:123], a[248:251], v[124:127]
v_exp_f32 v115, v115
v_mfma_f32_16x16x32_bf16 v[124:127], a[124:127], a[252:255], v[124:127]
v_cvt_pk_bf16_f32 v88, v112, v113
v_cvt_pk_bf16_f32 v89, v114, v115
v_mfma_f32_16x16x32_bf16 v[192:195], a[128:131], v[72:75], v[192:195]
v_exp_f32 v116, v116
v_mfma_f32_16x16x32_bf16 v[196:199], a[132:135], v[72:75], v[196:199]
v_exp_f32 v117, v117
v_mfma_f32_16x16x32_bf16 v[200:203], a[136:139], v[72:75], v[200:203]
v_exp_f32 v118, v118
v_mfma_f32_16x16x32_bf16 v[204:207], a[140:143], v[72:75], v[204:207]
v_exp_f32 v119, v119
v_mfma_f32_16x16x32_bf16 v[28:31], a[36:39], v[72:75], v[28:31]
v_cvt_pk_bf16_f32 v90, v116, v117
v_cvt_pk_bf16_f32 v91, v118, v119
v_mfma_f32_16x16x32_bf16 v[208:211], a[144:147], v[72:75], v[208:211]
ds_read_b128 a[92:95], v2 offset:7168
ds_read_b128 a[188:191], v3 offset:15360
v_mfma_f32_16x16x32_bf16 v[212:215], a[148:151], v[72:75], v[212:215]
buffer_load_dwordx4 v12, s[16:19], s23 offen offset:2048 sc1 lds
v_mfma_f32_16x16x32_bf16 v[216:219], a[152:155], v[72:75], v[216:219]
v_exp_f32 v120, v120
v_mfma_f32_16x16x32_bf16 v[220:223], a[156:159], v[72:75], v[220:223]
v_exp_f32 v121, v121
v_mfma_f32_16x16x32_bf16 v[224:227], a[128:131], v[76:79], v[224:227]
v_exp_f32 v122, v122
v_mfma_f32_16x16x32_bf16 v[228:231], a[132:135], v[76:79], v[228:231]
v_exp_f32 v123, v123
v_mfma_f32_16x16x32_bf16 v[232:235], a[136:139], v[76:79], v[232:235]
v_cvt_pk_bf16_f32 v92, v120, v121
v_cvt_pk_bf16_f32 v93, v122, v123
v_mfma_f32_16x16x32_bf16 v[236:239], a[140:143], v[76:79], v[236:239]
v_exp_f32 v124, v124
v_mfma_f32_16x16x32_bf16 v[32:35], a[36:39], v[76:79], v[32:35]
v_exp_f32 v125, v125
v_mfma_f32_16x16x32_bf16 v[240:243], a[144:147], v[76:79], v[240:243]
s_cmp_eq_u32 s20, s98
v_exp_f32 v126, v126
v_mfma_f32_16x16x32_bf16 v[244:247], a[148:151], v[76:79], v[244:247]
v_exp_f32 v127, v127
v_mfma_f32_16x16x32_bf16 v[248:251], a[152:155], v[76:79], v[248:251]
v_cvt_pk_bf16_f32 v94, v124, v125
v_cvt_pk_bf16_f32 v95, v126, v127
v_mfma_f32_16x16x32_bf16 v[252:255], a[156:159], v[76:79], v[252:255]
buffer_load_dwordx4 v13, s[16:19], s23 offen offset:3072 sc1 lds
s_cbranch_scc1 L_k2_sw
L_k2_swr0:
s_waitcnt vmcnt(18) lgkmcnt(0)
s_barrier
v_mfma_f32_16x16x32_bf16 v[96:99], a[64:67], a[192:195], v[48:51]
s_add_u32 m0, s22, 0
ds_read_b128 a[96:99], v2 offset:16384
ds_read_b128 a[128:131], v3 offset:24576
v_mfma_f32_16x16x32_bf16 v[96:99], a[68:71], a[196:199], v[96:99]
s_add_u32 s23, s20, s99
v_mfma_f32_16x16x32_bf16 v[96:99], a[72:75], a[200:203], v[96:99]
buffer_load_dwordx4 v10, s[16:19], s20 offen offset:0 sc1 lds
v_mfma_f32_16x16x32_bf16 v[96:99], a[76:79], a[204:207], v[96:99]
ds_read_b128 a[112:115], v2 offset:20480
ds_read_b128 a[132:135], v3 offset:25600
v_mfma_f32_16x16x32_bf16 v[100:103], a[80:83], a[192:195], v[48:51]
buffer_load_dwordx4 v11, s[16:19], s20 offen offset:1024 sc1 lds
v_mfma_f32_16x16x32_bf16 v[100:103], a[84:87], a[196:199], v[100:103]
ds_read_b128 a[100:103], v2 offset:17408
ds_read_b128 a[136:139], v3 offset:26624
v_mfma_f32_16x16x32_bf16 v[100:103], a[88:91], a[200:203], v[100:103]
buffer_load_dwordx4 v12, s[16:19], s20 offen offset:2048 sc1 lds
v_mfma_f32_16x16x32_bf16 v[100:103], a[92:95], a[204:207], v[100:103]
ds_read_b128 a[116:119], v2 offset:21504
ds_read_b128 a[140:143], v3 offset:27648
v_mfma_f32_16x16x32_bf16 v[104:107], a[64:67], a[208:211], v[52:55]
v_exp_f32 v96, v96
v_mfma_f32_16x16x32_bf16 v[104:107], a[68:71], a[212:215], v[104:107]
v_exp_f32 v97, v97
v_mfma_f32_16x16x32_bf16 v[104:107], a[72:75], a[216:219], v[104:107]
v_exp_f32 v98, v98
v_mfma_f32_16x16x32_bf16 v[104:107], a[76:79], a[220:223], v[104:107]
v_exp_f32 v99, v99
v_mfma_f32_16x16x32_bf16 v[108:111], a[80:83], a[208:211], v[52:55]
buffer_load_dwordx4 v13, s[16:19], s20 offen offset:3072 sc1 lds
v_mfma_f32_16x16x32_bf16 v[108:111], a[84:87], a[212:215], v[108:111]
s_add_u32 m0, s22, 4096
s_add_u32 s20, s20, s21
v_cvt_pk_bf16_f32 v64, v96, v97
v_mfma_f32_16x16x32_bf16 v[108:111], a[88:91], a[216:219], v[108:111]
ds_read_b128 a[104:107], v2 offset:18432
v_cvt_pk_bf16_f32 v65, v98, v99
v_mfma_f32_16x16x32_bf16 v[108:111], a[92:95], a[220:223], v[108:111]
ds_read_b128 a[144:147], v3 offset:28672
v_add_f32 v24, v24, v96
v_mfma_f32_16x16x32_bf16 v[128:131], a[160:163], v[80:83], v[128:131]
buffer_load_dwordx4 v10, s[16:19], s23 offen offset:0 sc1 lds
v_mfma_f32_16x16x32_bf16 v[132:135], a[164:167], v[80:83], v[132:135]
v_exp_f32 v100, v100
v_mfma_f32_16x16x32_bf16 v[136:139], a[168:171], v[80:83], v[136:139]
v_exp_f32 v101, v101
v_mfma_f32_16x16x32_bf16 v[140:143], a[172:175], v[80:83], v[140:143]
v_exp_f32 v102, v102
v_add_f32 v25, v25, v97
v_mfma_f32_16x16x32_bf16 v[144:147], a[176:179], v[80:83], v[144:147]
v_exp_f32 v103, v103
v_mfma_f32_16x16x32_bf16 v[148:151], a[180:183], v[80:83], v[148:151]
v_add_f32 v24, v24, v98
v_add_f32 v25, v25, v99
v_mfma_f32_16x16x32_bf16 v[152:155], a[184:187], v[80:83], v[152:155]
v_cvt_pk_bf16_f32 v66, v100, v101
v_cvt_pk_bf16_f32 v67, v102, v103
v_mfma_f32_16x16x32_bf16 v[156:159], a[188:191], v[80:83], v[156:159]
ds_read_b128 a[120:123], v2 offset:22528
v_add_f32 v24, v24, v100
v_mfma_f32_16x16x32_bf16 v[112:115], a[64:67], a[224:227], v[56:59]
v_exp_f32 v104, v104
v_mfma_f32_16x16x32_bf16 v[112:115], a[68:71], a[228:231], v[112:115]
v_exp_f32 v105, v105
v_mfma_f32_16x16x32_bf16 v[112:115], a[72:75], a[232:235], v[112:115]
v_exp_f32 v106, v106
v_mfma_f32_16x16x32_bf16 v[112:115], a[76:79], a[236:239], v[112:115]
v_exp_f32 v107, v107
v_mfma_f32_16x16x32_bf16 v[116:119], a[80:83], a[224:227], v[56:59]
v_add_f32 v25, v25, v101
v_add_f32 v24, v24, v102
v_mfma_f32_16x16x32_bf16 v[116:119], a[84:87], a[228:231], v[116:119]
v_add_f32 v25, v25, v103
v_cvt_pk_bf16_f32 v68, v104, v105
v_mfma_f32_16x16x32_bf16 v[116:119], a[88:91], a[232:235], v[116:119]
v_cvt_pk_bf16_f32 v69, v106, v107
v_add_f32 v26, v26, v104
v_mfma_f32_16x16x32_bf16 v[116:119], a[92:95], a[236:239], v[116:119]
v_exp_f32 v108, v108
v_mfma_f32_16x16x32_bf16 v[160:163], a[160:163], v[84:87], v[160:163]
v_exp_f32 v109, v109
v_mfma_f32_16x16x32_bf16 v[164:167], a[164:167], v[84:87], v[164:167]
v_exp_f32 v110, v110
v_mfma_f32_16x16x32_bf16 v[168:171], a[168:171], v[84:87], v[168:171]
v_exp_f32 v111, v111
v_mfma_f32_16x16x32_bf16 v[172:175], a[172:175], v[84:87], v[172:175]
v_add_f32 v27, v27, v105
v_add_f32 v26, v26, v106
v_mfma_f32_16x16x32_bf16 v[176:179], a[176:179], v[84:87], v[176:179]
v_add_f32 v27, v27, v107
v_cvt_pk_bf16_f32 v70, v108, v109
v_mfma_f32_16x16x32_bf16 v[180:183], a[180:183], v[84:87], v[180:183]
ds_read_b128 a[148:151], v3 offset:29696
v_cvt_pk_bf16_f32 v71, v110, v111
v_mfma_f32_16x16x32_bf16 v[184:187], a[184:187], v[84:87], v[184:187]
v_add_f32 v26, v26, v108
v_add_f32 v27, v27, v109
v_mfma_f32_16x16x32_bf16 v[188:191], a[188:191], v[84:87], v[188:191]
ds_read_b128 a[108:111], v2 offset:19456
v_add_f32 v26, v26, v110
v_add_f32 v27, v27, v111
v_mfma_f32_16x16x32_bf16 v[120:123], a[64:67], a[240:243], v[60:63]
buffer_load_dwordx4 v11, s[16:19], s23 offen offset:1024 sc1 lds
v_mfma_f32_16x16x32_bf16 v[120:123], a[68:71], a[244:247], v[120:123]
buffer_store_dwordx4 a[48:51], v1, s[88:91], s100 offen offset:1024 sc1
v_mfma_f32_16x16x32_bf16 v[120:123], a[72:75], a[248:251], v[120:123]
v_exp_f32 v112, v112
v_mfma_f32_16x16x32_bf16 v[120:123], a[76:79], a[252:255], v[120:123]
v_exp_f32 v113, v113
v_mfma_f32_16x16x32_bf16 v[124:127], a[80:83], a[240:243], v[60:63]
v_exp_f32 v114, v114
v_mfma_f32_16x16x32_bf16 v[124:127], a[84:87], a[244:247], v[124:127]
v_exp_f32 v115, v115
v_mfma_f32_16x16x32_bf16 v[124:127], a[88:91], a[248:251], v[124:127]
v_cvt_pk_bf16_f32 v72, v112, v113
v_cvt_pk_bf16_f32 v73, v114, v115
v_mfma_f32_16x16x32_bf16 v[124:127], a[92:95], a[252:255], v[124:127]
ds_read_b128 a[152:155], v3 offset:30720
ds_read_b128 a[124:127], v2 offset:23552
v_mfma_f32_16x16x32_bf16 v[192:195], a[160:163], v[88:91], v[192:195]
v_exp_f32 v116, v116
v_mfma_f32_16x16x32_bf16 v[196:199], a[164:167], v[88:91], v[196:199]
v_exp_f32 v117, v117
v_mfma_f32_16x16x32_bf16 v[200:203], a[168:171], v[88:91], v[200:203]
v_exp_f32 v118, v118
v_mfma_f32_16x16x32_bf16 v[204:207], a[172:175], v[88:91], v[204:207]
v_exp_f32 v119, v119
v_mfma_f32_16x16x32_bf16 v[28:31], a[36:39], v[88:91], v[28:31]
v_cvt_pk_bf16_f32 v74, v116, v117
v_cvt_pk_bf16_f32 v75, v118, v119
v_mfma_f32_16x16x32_bf16 v[208:211], a[176:179], v[88:91], v[208:211]
buffer_load_dwordx4 v12, s[16:19], s23 offen offset:2048 sc1 lds
v_mfma_f32_16x16x32_bf16 v[212:215], a[180:183], v[88:91], v[212:215]
ds_read_b128 a[156:159], v3 offset:31744
v_mfma_f32_16x16x32_bf16 v[216:219], a[184:187], v[88:91], v[216:219]
v_exp_f32 v120, v120
v_mfma_f32_16x16x32_bf16 v[220:223], a[188:191], v[88:91], v[220:223]
v_exp_f32 v121, v121
v_mfma_f32_16x16x32_bf16 v[224:227], a[160:163], v[92:95], v[224:227]
v_exp_f32 v122, v122
v_mfma_f32_16x16x32_bf16 v[228:231], a[164:167], v[92:95], v[228:231]
v_exp_f32 v123, v123
v_mfma_f32_16x16x32_bf16 v[232:235], a[168:171], v[92:95], v[232:235]
v_cvt_pk_bf16_f32 v76, v120, v121
v_cvt_pk_bf16_f32 v77, v122, v123
v_mfma_f32_16x16x32_bf16 v[236:239], a[172:175], v[92:95], v[236:239]
v_exp_f32 v124, v124
v_mfma_f32_16x16x32_bf16 v[32:35], a[36:39], v[92:95], v[32:35]
v_exp_f32 v125, v125
v_mfma_f32_16x16x32_bf16 v[240:243], a[176:179], v[92:95], v[240:243]
v_exp_f32 v126, v126
v_mfma_f32_16x16x32_bf16 v[244:247], a[180:183], v[92:95], v[244:247]
v_exp_f32 v127, v127
v_mfma_f32_16x16x32_bf16 v[248:251], a[184:187], v[92:95], v[248:251]
v_cvt_pk_bf16_f32 v78, v124, v125
v_cvt_pk_bf16_f32 v79, v126, v127
v_mfma_f32_16x16x32_bf16 v[252:255], a[188:191], v[92:95], v[252:255]
buffer_load_dwordx4 v13, s[16:19], s23 offen offset:3072 sc1 lds
s_waitcnt vmcnt(19) lgkmcnt(0)
s_barrier
v_mfma_f32_16x16x32_bf16 v[96:99], a[96:99], a[192:195], v[48:51]
s_add_u32 m0, s22, 16384
ds_read_b128 a[64:67], v2 offset:32768
ds_read_b128 a[160:163], v3 offset:40960
v_mfma_f32_16x16x32_bf16 v[96:99], a[100:103], a[196:199], v[96:99]
s_add_u32 s23, s20, s99
v_mfma_f32_16x16x32_bf16 v[96:99], a[104:107], a[200:203], v[96:99]
buffer_load_dwordx4 v10, s[16:19], s20 offen offset:0 sc1 lds
v_mfma_f32_16x16x32_bf16 v[96:99], a[108:111], a[204:207], v[96:99]
ds_read_b128 a[80:83], v2 offset:36864
ds_read_b128 a[164:167], v3 offset:41984
v_mfma_f32_16x16x32_bf16 v[100:103], a[112:115], a[192:195], v[48:51]
buffer_load_dwordx4 v11, s[16:19], s20 offen offset:1024 sc1 lds
v_mfma_f32_16x16x32_bf16 v[100:103], a[116:119], a[196:199], v[100:103]
ds_read_b128 a[68:71], v2 offset:33792
ds_read_b128 a[168:171], v3 offset:43008
v_mfma_f32_16x16x32_bf16 v[100:103], a[120:123], a[200:203], v[100:103]
buffer_load_dwordx4 v12, s[16:19], s20 offen offset:2048 sc1 lds
v_mfma_f32_16x16x32_bf16 v[100:103], a[124:127], a[204:207], v[100:103]
ds_read_b128 a[84:87], v2 offset:37888
ds_read_b128 a[172:175], v3 offset:44032
v_mfma_f32_16x16x32_bf16 v[104:107], a[96:99], a[208:211], v[52:55]
v_exp_f32 v96, v96
v_mfma_f32_16x16x32_bf16 v[104:107], a[100:103], a[212:215], v[104:107]
v_exp_f32 v97, v97
v_mfma_f32_16x16x32_bf16 v[104:107], a[104:107], a[216:219], v[104:107]
v_exp_f32 v98, v98
v_mfma_f32_16x16x32_bf16 v[104:107], a[108:111], a[220:223], v[104:107]
v_exp_f32 v99, v99
v_mfma_f32_16x16x32_bf16 v[108:111], a[112:115], a[208:211], v[52:55]
buffer_load_dwordx4 v13, s[16:19], s20 offen offset:3072 sc1 lds
v_mfma_f32_16x16x32_bf16 v[108:111], a[116:119], a[212:215], v[108:111]
s_add_u32 m0, s22, 20480
s_add_u32 s20, s20, s21
v_cvt_pk_bf16_f32 v80, v96, v97
v_mfma_f32_16x16x32_bf16 v[108:111], a[120:123], a[216:219], v[108:111]
ds_read_b128 a[72:75], v2 offset:34816
v_cvt_pk_bf16_f32 v81, v98, v99
v_mfma_f32_16x16x32_bf16 v[108:111], a[124:127], a[220:223], v[108:111]
ds_read_b128 a[176:179], v3 offset:45056
v_add_f32 v24, v24, v96
v_mfma_f32_16x16x32_bf16 v[128:131], a[128:131], v[64:67], v[128:131]
buffer_load_dwordx4 v10, s[16:19], s23 offen offset:0 sc1 lds
v_mfma_f32_16x16x32_bf16 v[132:135], a[132:135], v[64:67], v[132:135]
v_exp_f32 v100, v100
v_mfma_f32_16x16x32_bf16 v[136:139], a[136:139], v[64:67], v[136:139]
v_exp_f32 v101, v101
v_mfma_f32_16x16x32_bf16 v[140:143], a[140:143], v[64:67], v[140:143]
v_exp_f32 v102, v102
v_add_f32 v25, v25, v97
v_mfma_f32_16x16x32_bf16 v[144:147], a[144:147], v[64:67], v[144:147]
v_exp_f32 v103, v103
v_mfma_f32_16x16x32_bf16 v[148:151], a[148:151], v[64:67], v[148:151]
v_add_f32 v24, v24, v98
v_add_f32 v25, v25, v99
v_mfma_f32_16x16x32_bf16 v[152:155], a[152:155], v[64:67], v[152:155]
v_cvt_pk_bf16_f32 v82, v100, v101
v_cvt_pk_bf16_f32 v83, v102, v103
v_mfma_f32_16x16x32_bf16 v[156:159], a[156:159], v[64:67], v[156:159]
ds_read_b128 a[88:91], v2 offset:38912
v_add_f32 v24, v24, v100
v_mfma_f32_16x16x32_bf16 v[112:115], a[96:99], a[224:227], v[56:59]
v_exp_f32 v104, v104
v_mfma_f32_16x16x32_bf16 v[112:115], a[100:103], a[228:231], v[112:115]
v_exp_f32 v105, v105
v_mfma_f32_16x16x32_bf16 v[112:115], a[104:107], a[232:235], v[112:115]
v_exp_f32 v106, v106
v_mfma_f32_16x16x32_bf16 v[112:115], a[108:111], a[236:239], v[112:115]
v_exp_f32 v107, v107
v_mfma_f32_16x16x32_bf16 v[116:119], a[112:115], a[224:227], v[56:59]
v_add_f32 v25, v25, v101
v_add_f32 v24, v24, v102
v_mfma_f32_16x16x32_bf16 v[116:119], a[116:119], a[228:231], v[116:119]
v_add_f32 v25, v25, v103
v_cvt_pk_bf16_f32 v84, v104, v105
v_mfma_f32_16x16x32_bf16 v[116:119], a[120:123], a[232:235], v[116:119]
v_cvt_pk_bf16_f32 v85, v106, v107
v_add_f32 v26, v26, v104
v_mfma_f32_16x16x32_bf16 v[116:119], a[124:127], a[236:239], v[116:119]
v_exp_f32 v108, v108
v_mfma_f32_16x16x32_bf16 v[160:163], a[128:131], v[68:71], v[160:163]
v_exp_f32 v109, v109
v_mfma_f32_16x16x32_bf16 v[164:167], a[132:135], v[68:71], v[164:167]
v_exp_f32 v110, v110
v_mfma_f32_16x16x32_bf16 v[168:171], a[136:139], v[68:71], v[168:171]
v_exp_f32 v111, v111
v_mfma_f32_16x16x32_bf16 v[172:175], a[140:143], v[68:71], v[172:175]
v_add_f32 v27, v27, v105
v_add_f32 v26, v26, v106
v_mfma_f32_16x16x32_bf16 v[176:179], a[144:147], v[68:71], v[176:179]
v_add_f32 v27, v27, v107
v_cvt_pk_bf16_f32 v86, v108, v109
v_mfma_f32_16x16x32_bf16 v[180:183], a[148:151], v[68:71], v[180:183]
ds_read_b128 a[180:183], v3 offset:46080
v_cvt_pk_bf16_f32 v87, v110, v111
v_mfma_f32_16x16x32_bf16 v[184:187], a[152:155], v[68:71], v[184:187]
v_add_f32 v26, v26, v108
v_add_f32 v27, v27, v109
v_mfma_f32_16x16x32_bf16 v[188:191], a[156:159], v[68:71], v[188:191]
ds_read_b128 a[76:79], v2 offset:35840
v_add_f32 v26, v26, v110
v_add_f32 v27, v27, v111
v_mfma_f32_16x16x32_bf16 v[120:123], a[96:99], a[240:243], v[60:63]
buffer_load_dwordx4 v11, s[16:19], s23 offen offset:1024 sc1 lds
v_mfma_f32_16x16x32_bf16 v[120:123], a[100:103], a[244:247], v[120:123]
buffer_store_dwordx4 a[48:51], v1, s[88:91], s100 offen offset:2048 sc1
v_mfma_f32_16x16x32_bf16 v[120:123], a[104:107], a[248:251], v[120:123]
v_exp_f32 v112, v112
v_mfma_f32_16x16x32_bf16 v[120:123], a[108:111], a[252:255], v[120:123]
v_exp_f32 v113, v113
v_mfma_f32_16x16x32_bf16 v[124:127], a[112:115], a[240:243], v[60:63]
v_exp_f32 v114, v114
v_mfma_f32_16x16x32_bf16 v[124:127], a[116:119], a[244:247], v[124:127]
v_exp_f32 v115, v115
v_mfma_f32_16x16x32_bf16 v[124:127], a[120:123], a[248:251], v[124:127]
v_cvt_pk_bf16_f32 v88, v112, v113
v_cvt_pk_bf16_f32 v89, v114, v115
v_mfma_f32_16x16x32_bf16 v[124:127], a[124:127], a[252:255], v[124:127]
ds_read_b128 a[184:187], v3 offset:47104
ds_read_b128 a[92:95], v2 offset:39936
v_mfma_f32_16x16x32_bf16 v[192:195], a[128:131], v[72:75], v[192:195]
v_exp_f32 v116, v116
v_mfma_f32_16x16x32_bf16 v[196:199], a[132:135], v[72:75], v[196:199]
v_exp_f32 v117, v117
v_mfma_f32_16x16x32_bf16 v[200:203], a[136:139], v[72:75], v[200:203]
v_exp_f32 v118, v118
v_mfma_f32_16x16x32_bf16 v[204:207], a[140:143], v[72:75], v[204:207]
v_exp_f32 v119, v119
v_mfma_f32_16x16x32_bf16 v[28:31], a[36:39], v[72:75], v[28:31]
v_cvt_pk_bf16_f32 v90, v116, v117
v_cvt_pk_bf16_f32 v91, v118, v119
v_mfma_f32_16x16x32_bf16 v[208:211], a[144:147], v[72:75], v[208:211]
buffer_load_dwordx4 v12, s[16:19], s23 offen offset:2048 sc1 lds
v_mfma_f32_16x16x32_bf16 v[212:215], a[148:151], v[72:75], v[212:215]
ds_read_b128 a[188:191], v3 offset:48128
v_mfma_f32_16x16x32_bf16 v[216:219], a[152:155], v[72:75], v[216:219]
v_exp_f32 v120, v120
v_mfma_f32_16x16x32_bf16 v[220:223], a[156:159], v[72:75], v[220:223]
v_exp_f32 v121, v121
v_mfma_f32_16x16x32_bf16 v[224:227], a[128:131], v[76:79], v[224:227]
v_exp_f32 v122, v122
v_mfma_f32_16x16x32_bf16 v[228:231], a[132:135], v[76:79], v[228:231]
v_exp_f32 v123, v123
v_mfma_f32_16x16x32_bf16 v[232:235], a[136:139], v[76:79], v[232:235]
v_cvt_pk_bf16_f32 v92, v120, v121
v_cvt_pk_bf16_f32 v93, v122, v123
v_mfma_f32_16x16x32_bf16 v[236:239], a[140:143], v[76:79], v[236:239]
v_exp_f32 v124, v124
v_mfma_f32_16x16x32_bf16 v[32:35], a[36:39], v[76:79], v[32:35]
v_exp_f32 v125, v125
v_mfma_f32_16x16x32_bf16 v[240:243], a[144:147], v[76:79], v[240:243]
s_cmp_eq_u32 s26, s28
v_exp_f32 v126, v126
v_mfma_f32_16x16x32_bf16 v[244:247], a[148:151], v[76:79], v[244:247]
v_exp_f32 v127, v127
v_mfma_f32_16x16x32_bf16 v[248:251], a[152:155], v[76:79], v[248:251]
v_cvt_pk_bf16_f32 v94, v124, v125
v_cvt_pk_bf16_f32 v95, v126, v127
v_mfma_f32_16x16x32_bf16 v[252:255], a[156:159], v[76:79], v[252:255]
buffer_load_dwordx4 v13, s[16:19], s23 offen offset:3072 sc1 lds
s_cbranch_scc1 L_k2_mask
L_k2_maskret:
s_waitcnt vmcnt(18) lgkmcnt(0)
s_barrier
v_mfma_f32_16x16x32_bf16 v[96:99], a[64:67], a[192:195], v[36:39]
s_add_u32 m0, s22, 32768
ds_read_b128 a[96:99], v2 offset:49152
ds_read_b128 a[128:131], v3 offset:57344
v_mfma_f32_16x16x32_bf16 v[96:99], a[68:71], a[196:199], v[96:99]
s_add_u32 s23, s20, s99
v_mfma_f32_16x16x32_bf16 v[96:99], a[72:75], a[200:203], v[96:99]
buffer_load_dwordx4 v10, s[16:19], s20 offen offset:0 sc1 lds
v_mfma_f32_16x16x32_bf16 v[96:99], a[76:79], a[204:207], v[96:99]
ds_read_b128 a[112:115], v2 offset:53248
ds_read_b128 a[132:135], v3 offset:58368
v_mfma_f32_16x16x32_bf16 v[100:103], a[80:83], a[192:195], v[40:43]
buffer_load_dwordx4 v11, s[16:19], s20 offen offset:1024 sc1 lds
v_mfma_f32_16x16x32_bf16 v[100:103], a[84:87], a[196:199], v[100:103]
ds_read_b128 a[100:103], v2 offset:50176
ds_read_b128 a[136:139], v3 offset:59392
v_mfma_f32_16x16x32_bf16 v[100:103], a[88:91], a[200:203], v[100:103]
buffer_load_dwordx4 v12, s[16:19], s20 offen offset:2048 sc1 lds
v_mfma_f32_16x16x32_bf16 v[100:103], a[92:95], a[204:207], v[100:103]
ds_read_b128 a[116:119], v2 offset:54272
ds_read_b128 a[140:143], v3 offset:60416
v_mfma_f32_16x16x32_bf16 v[104:107], a[64:67], a[208:211], v[52:55]
v_exp_f32 v96, v96
v_mfma_f32_16x16x32_bf16 v[104:107], a[68:71], a[212:215], v[104:107]
ds_read_b128 a[104:107], v2 offset:51200
v_exp_f32 v97, v97
v_mfma_f32_16x16x32_bf16 v[104:107], a[72:75], a[216:219], v[104:107]
s_add_u32 s100, s100, 3072
v_exp_f32 v98, v98
v_mfma_f32_16x16x32_bf16 v[104:107], a[76:79], a[220:223], v[104:107]
v_exp_f32 v99, v99
v_mfma_f32_16x16x32_bf16 v[108:111], a[80:83], a[208:211], v[44:47]
buffer_load_dwordx4 v13, s[16:19], s20 offen offset:3072 sc1 lds
v_mfma_f32_16x16x32_bf16 v[108:111], a[84:87], a[212:215], v[108:111]
s_add_u32 m0, s22, 36864
s_add_u32 s20, s20, s21
v_cvt_pk_bf16_f32 v64, v96, v97
v_mfma_f32_16x16x32_bf16 v[108:111], a[88:91], a[216:219], v[108:111]
s_add_u32 s51, s51, 1
ds_read_b128 a[144:147], v3 offset:61440
v_cvt_pk_bf16_f32 v65, v98, v99
v_mfma_f32_16x16x32_bf16 v[108:111], a[92:95], a[220:223], v[108:111]
buffer_load_dwordx4 v10, s[16:19], s23 offen offset:0 sc1 lds
v_mfma_f32_16x16x32_bf16 v[128:131], a[160:163], v[80:83], v[128:131]
v_exp_f32 v100, v100
v_mfma_f32_16x16x32_bf16 v[132:135], a[164:167], v[80:83], v[132:135]
v_exp_f32 v101, v101
v_mfma_f32_16x16x32_bf16 v[136:139], a[168:171], v[80:83], v[136:139]
v_exp_f32 v102, v102
v_mfma_f32_16x16x32_bf16 v[140:143], a[172:175], v[80:83], v[140:143]
v_exp_f32 v103, v103
v_add_f32 v24, v24, v96
v_mfma_f32_16x16x32_bf16 v[144:147], a[176:179], v[80:83], v[144:147]
v_add_f32 v25, v25, v97
v_add_f32 v24, v24, v98
v_mfma_f32_16x16x32_bf16 v[148:151], a[180:183], v[80:83], v[148:151]
v_add_f32 v25, v25, v99
v_cvt_pk_bf16_f32 v66, v100, v101
v_mfma_f32_16x16x32_bf16 v[152:155], a[184:187], v[80:83], v[152:155]
ds_read_b128 a[120:123], v2 offset:55296
v_cvt_pk_bf16_f32 v67, v102, v103
v_mfma_f32_16x16x32_bf16 v[156:159], a[188:191], v[80:83], v[156:159]
v_exp_f32 v104, v104
v_mfma_f32_16x16x32_bf16 v[112:115], a[64:67], a[224:227], v[56:59]
v_exp_f32 v105, v105
v_mfma_f32_16x16x32_bf16 v[112:115], a[68:71], a[228:231], v[112:115]
v_exp_f32 v106, v106
v_mfma_f32_16x16x32_bf16 v[112:115], a[72:75], a[232:235], v[112:115]
v_exp_f32 v107, v107
v_mfma_f32_16x16x32_bf16 v[112:115], a[76:79], a[236:239], v[112:115]
v_add_f32 v24, v24, v100
v_add_f32 v25, v25, v101
v_mfma_f32_16x16x32_bf16 v[116:119], a[80:83], a[224:227], v[56:59]
v_add_f32 v24, v24, v102
v_add_f32 v25, v25, v103
v_mfma_f32_16x16x32_bf16 v[116:119], a[84:87], a[228:231], v[116:119]
s_cmp_eq_u32 s51, 6
s_cselect_b32 s100, s101, s100
v_cvt_pk_bf16_f32 v68, v104, v105
v_cvt_pk_bf16_f32 v69, v106, v107
v_mfma_f32_16x16x32_bf16 v[116:119], a[88:91], a[232:235], v[116:119]
buffer_load_dword a40, v18, s[12:15], s7 offen sc1
v_mfma_f32_16x16x32_bf16 v[116:119], a[92:95], a[236:239], v[116:119]
v_exp_f32 v108, v108
v_mfma_f32_16x16x32_bf16 v[160:163], a[160:163], v[84:87], v[160:163]
v_exp_f32 v109, v109
v_mfma_f32_16x16x32_bf16 v[164:167], a[164:167], v[84:87], v[164:167]
v_exp_f32 v110, v110
v_mfma_f32_16x16x32_bf16 v[168:171], a[168:171], v[84:87], v[168:171]
v_exp_f32 v111, v111
v_mfma_f32_16x16x32_bf16 v[172:175], a[172:175], v[84:87], v[172:175]
v_add_f32 v26, v26, v104
v_add_f32 v27, v27, v105
v_mfma_f32_16x16x32_bf16 v[176:179], a[176:179], v[84:87], v[176:179]
v_add_f32 v26, v26, v106
v_add_f32 v27, v27, v107
v_mfma_f32_16x16x32_bf16 v[180:183], a[180:183], v[84:87], v[180:183]
v_cvt_pk_bf16_f32 v70, v108, v109
v_cvt_pk_bf16_f32 v71, v110, v111
v_mfma_f32_16x16x32_bf16 v[184:187], a[184:187], v[84:87], v[184:187]
s_cmp_lt_u32 s51, 7
s_cselect_b32 s90, 268435456, 0
ds_read_b128 a[148:151], v3 offset:62464
v_mfma_f32_16x16x32_bf16 v[188:191], a[188:191], v[84:87], v[188:191]
v_add_f32 v26, v26, v108
v_add_f32 v27, v27, v109
v_add_f32 v26, v26, v110
v_mfma_f32_16x16x32_bf16 v[120:123], a[64:67], a[240:243], v[60:63]
s_sub_u32 s26, s26, 1
ds_read_b128 a[108:111], v2 offset:52224
v_add_f32 v27, v27, v111
v_mfma_f32_16x16x32_bf16 v[120:123], a[68:71], a[244:247], v[120:123]
buffer_load_dwordx4 v11, s[16:19], s23 offen offset:1024 sc1 lds
v_mfma_f32_16x16x32_bf16 v[120:123], a[72:75], a[248:251], v[120:123]
v_exp_f32 v112, v112
v_mfma_f32_16x16x32_bf16 v[120:123], a[76:79], a[252:255], v[120:123]
v_exp_f32 v113, v113
v_mfma_f32_16x16x32_bf16 v[124:127], a[80:83], a[240:243], v[60:63]
v_exp_f32 v114, v114
v_mfma_f32_16x16x32_bf16 v[124:127], a[84:87], a[244:247], v[124:127]
v_exp_f32 v115, v115
v_mfma_f32_16x16x32_bf16 v[124:127], a[88:91], a[248:251], v[124:127]
v_cvt_pk_bf16_f32 v72, v112, v113
v_cvt_pk_bf16_f32 v73, v114, v115
v_mfma_f32_16x16x32_bf16 v[124:127], a[92:95], a[252:255], v[124:127]
ds_read_b128 a[152:155], v3 offset:63488
ds_read_b128 a[124:127], v2 offset:56320
v_mfma_f32_16x16x32_bf16 v[192:195], a[160:163], v[88:91], v[192:195]
v_exp_f32 v116, v116
v_mfma_f32_16x16x32_bf16 v[196:199], a[164:167], v[88:91], v[196:199]
ds_read_b128 a[156:159], v3 offset:64512
v_exp_f32 v117, v117
v_mfma_f32_16x16x32_bf16 v[200:203], a[168:171], v[88:91], v[200:203]
v_exp_f32 v118, v118
v_mfma_f32_16x16x32_bf16 v[204:207], a[172:175], v[88:91], v[204:207]
v_exp_f32 v119, v119
v_mfma_f32_16x16x32_bf16 v[28:31], a[36:39], v[88:91], v[28:31]
v_cvt_pk_bf16_f32 v74, v116, v117
v_cvt_pk_bf16_f32 v75, v118, v119
v_mfma_f32_16x16x32_bf16 v[208:211], a[176:179], v[88:91], v[208:211]
buffer_load_dwordx4 v12, s[16:19], s23 offen offset:2048 sc1 lds
v_mfma_f32_16x16x32_bf16 v[212:215], a[180:183], v[88:91], v[212:215]
v_exp_f32 v120, v120
v_mfma_f32_16x16x32_bf16 v[216:219], a[184:187], v[88:91], v[216:219]
v_exp_f32 v121, v121
v_mfma_f32_16x16x32_bf16 v[220:223], a[188:191], v[88:91], v[220:223]
v_exp_f32 v122, v122
v_mfma_f32_16x16x32_bf16 v[224:227], a[160:163], v[92:95], v[224:227]
v_exp_f32 v123, v123
v_mfma_f32_16x16x32_bf16 v[228:231], a[164:167], v[92:95], v[228:231]
v_cvt_pk_bf16_f32 v76, v120, v121
v_cvt_pk_bf16_f32 v77, v122, v123
v_mfma_f32_16x16x32_bf16 v[232:235], a[168:171], v[92:95], v[232:235]
v_exp_f32 v124, v124
v_mfma_f32_16x16x32_bf16 v[236:239], a[172:175], v[92:95], v[236:239]
v_exp_f32 v125, v125
v_mfma_f32_16x16x32_bf16 v[32:35], a[36:39], v[92:95], v[32:35]
v_exp_f32 v126, v126
v_mfma_f32_16x16x32_bf16 v[240:243], a[176:179], v[92:95], v[240:243]
s_cmp_lg_u32 s26, 0
v_exp_f32 v127, v127
v_mfma_f32_16x16x32_bf16 v[244:247], a[180:183], v[92:95], v[244:247]
v_cvt_pk_bf16_f32 v78, v124, v125
v_cvt_pk_bf16_f32 v79, v126, v127
v_mfma_f32_16x16x32_bf16 v[248:251], a[184:187], v[92:95], v[248:251]
buffer_load_dwordx4 v13, s[16:19], s23 offen offset:3072 sc1 lds
v_mfma_f32_16x16x32_bf16 v[252:255], a[188:191], v[92:95], v[252:255]
s_cbranch_scc1 L_k2_loop
L_k2_exit:
s_cmp_eq_u32 s27, 0
s_cbranch_scc1 L_k2_tail01
s_cmp_eq_u32 s27, 3
s_cbranch_scc1 L_k2_tail23
s_cmp_eq_u32 s27, 2
s_cbranch_scc1 L_k2_sp2
v_cndmask_b32 v36, v56, v5, s[34:35]
v_cndmask_b32 v37, v57, v5, s[36:37]
v_cndmask_b32 v38, v58, v5, s[38:39]
v_cndmask_b32 v39, v59, v5, s[40:41]
v_cndmask_b32 v44, v60, v5, s[34:35]
v_cndmask_b32 v45, v61, v5, s[36:37]
v_cndmask_b32 v46, v62, v5, s[38:39]
v_cndmask_b32 v47, v63, v5, s[40:41]
v_add_u32 v2, 0x10000, v2
s_waitcnt vmcnt(16) lgkmcnt(0)
s_barrier
v_mfma_f32_16x16x32_bf16 v[120:123], a[96:99], a[240:243], v[60:63]
ds_read_b128 a[64:67], v2 offset:0
s_add_u32 m0, s22, 49152
ds_read_b128 a[192:195], v4 offset:0
ds_read_b128 a[196:199], v4 offset:1024
v_mfma_f32_16x16x32_bf16 v[120:123], a[100:103], a[244:247], v[120:123]
ds_read_b128 a[200:203], v4 offset:2048
ds_read_b128 a[204:207], v4 offset:3072
v_add_f32 v6, v24, v25
v_mov_b32 v7, v6
v_mfma_f32_16x16x32_bf16 v[120:123], a[104:107], a[248:251], v[120:123]
s_nop 0
v_permlane16_swap_b32 v6, v7
v_add_f32 v6, v6, v7
v_mov_b32 v7, v6
s_nop 1
v_permlane32_swap_b32 v6, v7
v_mfma_f32_16x16x32_bf16 v[120:123], a[108:111], a[252:255], v[120:123]
s_add_u32 s23, s20, s99
ds_read_b128 a[160:163], v3 offset:8192
ds_read_b128 a[208:211], v4 offset:4096
v_add_f32 v6, v6, v7
v_add_u32 v7, 0xde800000, v6
v_mfma_f32_16x16x32_bf16 v[124:127], a[112:115], a[240:243], v[44:47]
v_cmp_lt_u32 vcc, 0x3c000000, v7
v_rcp_f32 v6, v6
s_or_b64 s[54:55], s[54:55], vcc
v_mfma_f32_16x16x32_bf16 v[124:127], a[116:119], a[244:247], v[124:127]
v_add_f32 v8, v26, v27
v_mov_b32 v9, v8
s_nop 1
v_permlane16_swap_b32 v8, v9
v_add_f32 v8, v8, v9
v_mfma_f32_16x16x32_bf16 v[124:127], a[120:123], a[248:251], v[124:127]
v_mov_b32 v9, v8
s_nop 1
v_permlane32_swap_b32 v8, v9
v_add_f32 v8, v8, v9
v_add_u32 v9, 0xde800000, v8
v_mfma_f32_16x16x32_bf16 v[124:127], a[124:127], a[252:255], v[124:127]
v_cmp_lt_u32 vcc, 0x3c000000, v9
v_rcp_f32 v8, v8
s_or_b64 s[54:55], s[54:55], vcc
v_mfma_f32_16x16x32_bf16 v[112:115], a[96:99], a[224:227], v[36:39]
v_mov_b32 v48, v14
v_mov_b32 v49, v14
v_mov_b32 v50, v14
v_mov_b32 v51, v14
v_mfma_f32_16x16x32_bf16 v[112:115], a[100:103], a[228:231], v[112:115]
v_mov_b32 v52, v15
v_mov_b32 v53, v15
v_mov_b32 v54, v15
v_mov_b32 v55, v15
v_mfma_f32_16x16x32_bf16 v[112:115], a[104:107], a[232:235], v[112:115]
ds_read_b128 a[212:215], v4 offset:5120
ds_read_b128 a[216:219], v4 offset:6144
ds_read_b128 a[220:223], v4 offset:7168
ds_read_b128 a[80:83], v2 offset:4096
v_mfma_f32_16x16x32_bf16 v[112:115], a[108:111], a[236:239], v[112:115]
ds_read_b128 a[164:167], v3 offset:9216
ds_read_b128 a[68:71], v2 offset:1024
v_exp_f32 v120, v120
v_mfma_f32_16x16x32_bf16 v[128:131], a[128:131], v[64:67], v[128:131]
v_exp_f32 v121, v121
v_exp_f32 v122, v122
v_mfma_f32_16x16x32_bf16 v[132:135], a[132:135], v[64:67], v[132:135]
buffer_load_dwordx4 v10, s[16:19], s20 offen offset:0 sc1 lds
v_exp_f32 v123, v123
v_mfma_f32_16x16x32_bf16 v[136:139], a[136:139], v[64:67], v[136:139]
ds_read_b128 a[168:171], v3 offset:10240
ds_read_b128 a[240:243], v4 offset:12288
v_cvt_pk_bf16_f32 v92, v120, v121
v_cvt_pk_bf16_f32 v93, v122, v123
v_mfma_f32_16x16x32_bf16 v[140:143], a[140:143], v[64:67], v[140:143]
ds_read_b128 a[244:247], v4 offset:13312
ds_read_b128 a[248:251], v4 offset:14336
ds_read_b128 a[252:255], v4 offset:15360
ds_read_b128 a[84:87], v2 offset:5120
v_mfma_f32_16x16x32_bf16 v[144:147], a[144:147], v[64:67], v[144:147]
buffer_load_dwordx4 v11, s[16:19], s20 offen offset:1024 sc1 lds
v_mov_b32 v60, v17
v_mov_b32 v61, v17
v_mfma_f32_16x16x32_bf16 v[148:151], a[148:151], v[64:67], v[148:151]
v_mov_b32 v62, v17
v_mov_b32 v63, v17
v_exp_f32 v124, v124
v_mfma_f32_16x16x32_bf16 v[152:155], a[152:155], v[64:67], v[152:155]
v_exp_f32 v125, v125
v_exp_f32 v126, v126
v_mfma_f32_16x16x32_bf16 v[156:159], a[156:159], v[64:67], v[156:159]
ds_read_b128 a[172:175], v3 offset:11264
v_exp_f32 v127, v127
v_cvt_pk_bf16_f32 v94, v124, v125
v_mfma_f32_16x16x32_bf16 v[160:163], a[128:131], v[68:71], v[160:163]
ds_read_b128 a[224:227], v4 offset:8192
ds_read_b128 a[228:231], v4 offset:9216
ds_read_b128 a[232:235], v4 offset:10240
v_cvt_pk_bf16_f32 v95, v126, v127
v_mfma_f32_16x16x32_bf16 v[164:167], a[132:135], v[68:71], v[164:167]
ds_read_b128 a[236:239], v4 offset:11264
v_mov_b32 v56, v16
v_mov_b32 v57, v16
v_mov_b32 v58, v16
v_mfma_f32_16x16x32_bf16 v[168:171], a[136:139], v[68:71], v[168:171]
v_mov_b32 v59, v16
v_cndmask_b32 v36, v56, v5, s[34:35]
v_cndmask_b32 v37, v57, v5, s[36:37]
v_cndmask_b32 v38, v58, v5, s[38:39]
v_mfma_f32_16x16x32_bf16 v[172:175], a[140:143], v[68:71], v[172:175]
v_cndmask_b32 v39, v59, v5, s[40:41]
v_cndmask_b32 v44, v60, v5, s[34:35]
v_cndmask_b32 v45, v61, v5, s[36:37]
v_cndmask_b32 v46, v62, v5, s[38:39]
v_mfma_f32_16x16x32_bf16 v[176:179], a[144:147], v[68:71], v[176:179]
ds_read_b128 a[72:75], v2 offset:2048
buffer_load_dwordx4 v12, s[16:19], s20 offen offset:2048 sc1 lds
v_cndmask_b32 v47, v63, v5, s[40:41]
v_mfma_f32_16x16x32_bf16 v[180:183], a[148:151], v[68:71], v[180:183]
s_add_u32 s63, s31, 0
v_exp_f32 v112, v112
v_exp_f32 v113, v113
v_mfma_f32_16x16x32_bf16 v[184:187], a[152:155], v[68:71], v[184:187]
v_exp_f32 v114, v114
v_exp_f32 v115, v115
v_mfma_f32_16x16x32_bf16 v[188:191], a[156:159], v[68:71], v[188:191]
v_cvt_pk_bf16_f32 v88, v112, v113
v_cvt_pk_bf16_f32 v89, v114, v115
v_mov_b32 v90, 0
v_mov_b32 v91, 0
v_mfma_f32_16x16x32_bf16 v[192:195], a[128:131], v[72:75], v[192:195]
ds_read_b128 a[176:179], v3 offset:12288
ds_read_b128 a[88:91], v2 offset:6144
buffer_load_dwordx4 v13, s[16:19], s20 offen offset:3072 sc1 lds
v_mfma_f32_16x16x32_bf16 v[196:199], a[132:135], v[72:75], v[196:199]
s_add_u32 m0, s22, 53248
ds_read_b128 a[180:183], v3 offset:13312
ds_read_b128 a[76:79], v2 offset:3072
v_mul_f32 v128, v128, v6
v_mul_f32 v129, v129, v6
v_mfma_f32_16x16x32_bf16 v[200:203], a[136:139], v[72:75], v[200:203]
s_add_u32 s20, s20, s21
v_mul_f32 v130, v130, v6
v_mul_f32 v131, v131, v6
v_mul_f32 v132, v132, v6
v_mul_f32 v133, v133, v6
v_mfma_f32_16x16x32_bf16 v[204:207], a[140:143], v[72:75], v[204:207]
v_mul_f32 v134, v134, v6
v_mul_f32 v135, v135, v6
v_cvt_pk_bf16_f32 v128, v128, v129
v_cvt_pk_bf16_f32 v129, v130, v131
v_mfma_f32_16x16x32_bf16 v[28:31], a[36:39], v[72:75], v[28:31]
ds_read_b128 a[184:187], v3 offset:14336
ds_read_b128 a[92:95], v2 offset:7168
v_cvt_pk_bf16_f32 v130, v132, v133
v_cvt_pk_bf16_f32 v131, v134, v135
v_mfma_f32_16x16x32_bf16 v[208:211], a[144:147], v[72:75], v[208:211]
buffer_store_dwordx4 v[128:131], v1, s[12:15], s63 offen offset:0 sc1
v_mfma_f32_16x16x32_bf16 v[212:215], a[148:151], v[72:75], v[212:215]
ds_read_b128 a[188:191], v3 offset:15360
v_mfma_f32_16x16x32_bf16 v[20:23], a[32:35], v[128:131], v[20:23]
v_mul_f32 v136, v136, v6
v_mul_f32 v137, v137, v6
v_mfma_f32_16x16x32_bf16 v[216:219], a[152:155], v[72:75], v[216:219]
v_mul_f32 v138, v138, v6
v_mul_f32 v139, v139, v6
v_mul_f32 v140, v140, v6
v_mul_f32 v141, v141, v6
v_mfma_f32_16x16x32_bf16 v[220:223], a[156:159], v[72:75], v[220:223]
v_mul_f32 v142, v142, v6
v_mul_f32 v143, v143, v6
v_cvt_pk_bf16_f32 v136, v136, v137
v_cvt_pk_bf16_f32 v137, v138, v139
v_mfma_f32_16x16x32_bf16 v[224:227], a[128:131], v[76:79], v[224:227]
buffer_load_dwordx4 v10, s[16:19], s23 offen offset:0 sc1 lds
v_cvt_pk_bf16_f32 v138, v140, v141
v_cvt_pk_bf16_f32 v139, v142, v143
v_mfma_f32_16x16x32_bf16 v[228:231], a[132:135], v[76:79], v[228:231]
buffer_store_dwordx4 v[136:139], v1, s[12:15], s63 offen offset:1024 sc1
v_mfma_f32_16x16x32_bf16 v[232:235], a[136:139], v[76:79], v[232:235]
buffer_load_dwordx4 v11, s[16:19], s23 offen offset:1024 sc1 lds
v_mfma_f32_16x16x32_bf16 v[20:23], a[32:35], v[136:139], v[20:23]
v_mul_f32 v144, v144, v6
v_mul_f32 v145, v145, v6
v_mfma_f32_16x16x32_bf16 v[236:239], a[140:143], v[76:79], v[236:239]
v_mul_f32 v146, v146, v6
v_mul_f32 v147, v147, v6
v_mul_f32 v148, v148, v6
v_mul_f32 v149, v149, v6
v_mfma_f32_16x16x32_bf16 v[32:35], a[36:39], v[76:79], v[32:35]
v_mul_f32 v150, v150, v6
v_mul_f32 v151, v151, v6
v_cvt_pk_bf16_f32 v144, v144, v145
v_cvt_pk_bf16_f32 v145, v146, v147
v_mfma_f32_16x16x32_bf16 v[240:243], a[144:147], v[76:79], v[240:243]
buffer_load_dwordx4 v12, s[16:19], s23 offen offset:2048 sc1 lds
v_cvt_pk_bf16_f32 v146, v148, v149
v_cvt_pk_bf16_f32 v147, v150, v151
v_mfma_f32_16x16x32_bf16 v[244:247], a[148:151], v[76:79], v[244:247]
buffer_store_dwordx4 v[144:147], v1, s[12:15], s63 offen offset:2048 sc1
v_mfma_f32_16x16x32_bf16 v[248:251], a[152:155], v[76:79], v[248:251]
buffer_load_dwordx4 v13, s[16:19], s23 offen offset:3072 sc1 lds
v_mfma_f32_16x16x32_bf16 v[20:23], a[32:35], v[144:147], v[20:23]
v_mul_f32 v152, v152, v6
v_mul_f32 v153, v153, v6
v_mfma_f32_16x16x32_bf16 v[252:255], a[156:159], v[76:79], v[252:255]
v_mul_f32 v154, v154, v6
v_mul_f32 v155, v155, v6
v_mul_f32 v156, v156, v6
v_mul_f32 v157, v157, v6
v_mul_f32 v158, v158, v6
v_mul_f32 v159, v159, v6
v_cvt_pk_bf16_f32 v152, v152, v153
v_cvt_pk_bf16_f32 v153, v154, v155
v_cvt_pk_bf16_f32 v154, v156, v157
v_cvt_pk_bf16_f32 v155, v158, v159
buffer_store_dwordx4 v[152:155], v1, s[12:15], s63 offen offset:3072 sc1
s_nop 0
v_mfma_f32_16x16x32_bf16 v[20:23], a[32:35], v[152:155], v[20:23]
s_cmp_eq_u32 s20, s98
s_nop 4
s_cbranch_scc1 L_k2_sw
L_k2_swr1:
v_add_u32 v3, 0x10000, v3
s_waitcnt vmcnt(20) lgkmcnt(0)
s_barrier
v_mfma_f32_16x16x32_bf16 v[192:195], a[160:163], v[88:91], v[192:195]
ds_read_b128 a[96:99], v2 offset:16384
s_add_u32 m0, s22, 0
v_mfma_f32_16x16x32_bf16 v[196:199], a[164:167], v[88:91], v[196:199]
ds_read_b128 a[128:131], v3 offset:24576
v_mfma_f32_16x16x32_bf16 v[200:203], a[168:171], v[88:91], v[200:203]
ds_read_b128 a[112:115], v2 offset:20480
s_add_u32 s23, s20, s99
v_mfma_f32_16x16x32_bf16 v[204:207], a[172:175], v[88:91], v[204:207]
ds_read_b128 a[132:135], v3 offset:25600
v_mfma_f32_16x16x32_bf16 v[28:31], a[36:39], v[88:91], v[28:31]
ds_read_b128 a[100:103], v2 offset:17408
buffer_load_dwordx4 v10, s[16:19], s20 offen offset:0 sc1 lds
v_mfma_f32_16x16x32_bf16 v[208:211], a[176:179], v[88:91], v[208:211]
ds_read_b128 a[136:139], v3 offset:26624
v_mfma_f32_16x16x32_bf16 v[212:215], a[180:183], v[88:91], v[212:215]
buffer_load_dwordx4 v11, s[16:19], s20 offen offset:1024 sc1 lds
v_mfma_f32_16x16x32_bf16 v[216:219], a[184:187], v[88:91], v[216:219]
ds_read_b128 a[116:119], v2 offset:21504
v_mfma_f32_16x16x32_bf16 v[220:223], a[188:191], v[88:91], v[220:223]
v_mov_b32 v6, v28
v_add_u32 v7, 0xde800000, v6
v_cmp_lt_u32 vcc, 0x3c000000, v7
v_rcp_f32 v6, v6
s_or_b64 s[54:55], s[54:55], vcc
ds_read_b128 a[140:143], v3 offset:27648
buffer_load_dwordx4 v12, s[16:19], s20 offen offset:2048 sc1 lds
v_mfma_f32_16x16x32_bf16 v[224:227], a[160:163], v[92:95], v[224:227]
ds_read_b128 a[104:107], v2 offset:18432
v_mfma_f32_16x16x32_bf16 v[228:231], a[164:167], v[92:95], v[228:231]
ds_read_b128 a[144:147], v3 offset:28672
buffer_load_dwordx4 v13, s[16:19], s20 offen offset:3072 sc1 lds
v_mfma_f32_16x16x32_bf16 v[232:235], a[168:171], v[92:95], v[232:235]
s_add_u32 s63, s31, 36864
v_mul_f32 v192, v192, v6
v_mul_f32 v193, v193, v6
v_mul_f32 v194, v194, v6
v_mul_f32 v195, v195, v6
v_mul_f32 v196, v196, v6
v_mul_f32 v197, v197, v6
v_mul_f32 v198, v198, v6
v_mul_f32 v199, v199, v6
v_cvt_pk_bf16_f32 v192, v192, v193
v_cvt_pk_bf16_f32 v193, v194, v195
v_mfma_f32_16x16x32_bf16 v[236:239], a[172:175], v[92:95], v[236:239]
v_cvt_pk_bf16_f32 v194, v196, v197
v_cvt_pk_bf16_f32 v195, v198, v199
buffer_store_dwordx4 v[192:195], v1, s[12:15], s63 offen offset:0 sc1
v_mfma_f32_16x16x32_bf16 v[32:35], a[36:39], v[92:95], v[32:35]
ds_read_b128 a[120:123], v2 offset:22528
ds_read_b128 a[148:151], v3 offset:29696
v_mfma_f32_16x16x32_bf16 v[20:23], a[32:35], v[192:195], v[20:23]
s_add_u32 m0, s22, 4096
v_mul_f32 v200, v200, v6
v_mul_f32 v201, v201, v6
v_mul_f32 v202, v202, v6
v_mul_f32 v203, v203, v6
v_mul_f32 v204, v204, v6
v_mul_f32 v205, v205, v6
v_mfma_f32_16x16x32_bf16 v[240:243], a[176:179], v[92:95], v[240:243]
ds_read_b128 a[108:111], v2 offset:19456
v_mul_f32 v206, v206, v6
v_mul_f32 v207, v207, v6
v_cvt_pk_bf16_f32 v200, v200, v201
v_cvt_pk_bf16_f32 v201, v202, v203
v_cvt_pk_bf16_f32 v202, v204, v205
v_cvt_pk_bf16_f32 v203, v206, v207
v_mfma_f32_16x16x32_bf16 v[244:247], a[180:183], v[92:95], v[244:247]
buffer_store_dwordx4 v[200:203], v1, s[12:15], s63 offen offset:1024 sc1
v_mfma_f32_16x16x32_bf16 v[20:23], a[32:35], v[200:203], v[20:23]
s_add_u32 s20, s20, s21
v_mul_f32 v208, v208, v6
v_mul_f32 v209, v209, v6
v_mfma_f32_16x16x32_bf16 v[248:251], a[184:187], v[92:95], v[248:251]
v_mul_f32 v210, v210, v6
v_mul_f32 v211, v211, v6
v_mul_f32 v212, v212, v6
v_mul_f32 v213, v213, v6
v_mul_f32 v214, v214, v6
v_mul_f32 v215, v215, v6
v_cvt_pk_bf16_f32 v208, v208, v209
v_cvt_pk_bf16_f32 v209, v210, v211
v_cvt_pk_bf16_f32 v210, v212, v213
v_cvt_pk_bf16_f32 v211, v214, v215
v_mfma_f32_16x16x32_bf16 v[252:255], a[188:191], v[92:95], v[252:255]
buffer_store_dwordx4 v[208:211], v1, s[12:15], s63 offen offset:2048 sc1
v_mfma_f32_16x16x32_bf16 v[20:23], a[32:35], v[208:211], v[20:23]
v_mul_f32 v216, v216, v6
v_mul_f32 v217, v217, v6
v_mfma_f32_16x16x32_bf16 v[120:123], a[64:67], a[240:243], v[60:63]
v_mul_f32 v218, v218, v6
v_mul_f32 v219, v219, v6
v_mul_f32 v220, v220, v6
v_mul_f32 v221, v221, v6
v_mul_f32 v222, v222, v6
v_mul_f32 v223, v223, v6
v_cvt_pk_bf16_f32 v216, v216, v217
v_cvt_pk_bf16_f32 v217, v218, v219
v_cvt_pk_bf16_f32 v218, v220, v221
v_cvt_pk_bf16_f32 v219, v222, v223
v_mfma_f32_16x16x32_bf16 v[120:123], a[68:71], a[244:247], v[120:123]
buffer_store_dwordx4 v[216:219], v1, s[12:15], s63 offen offset:3072 sc1
v_mfma_f32_16x16x32_bf16 v[20:23], a[32:35], v[216:219], v[20:23]
ds_read_b128 a[152:155], v3 offset:30720
ds_read_b128 a[124:127], v2 offset:23552
v_mfma_f32_16x16x32_bf16 v[120:123], a[72:75], a[248:251], v[120:123]
v_mov_b32 v6, v32
v_add_u32 v7, 0xde800000, v6
v_cmp_lt_u32 vcc, 0x3c000000, v7
v_rcp_f32 v6, v6
s_or_b64 s[54:55], s[54:55], vcc
ds_read_b128 a[156:159], v3 offset:31744
buffer_load_dwordx4 v10, s[16:19], s23 offen offset:0 sc1 lds
s_add_u32 s63, s31, 55296
v_mfma_f32_16x16x32_bf16 v[120:123], a[76:79], a[252:255], v[120:123]
buffer_load_dwordx4 v11, s[16:19], s23 offen offset:1024 sc1 lds
v_mul_f32 v224, v224, v6
v_mul_f32 v225, v225, v6
v_mul_f32 v226, v226, v6
v_mul_f32 v227, v227, v6
v_mul_f32 v228, v228, v6
v_mul_f32 v229, v229, v6
v_mul_f32 v230, v230, v6
v_mul_f32 v231, v231, v6
v_mfma_f32_16x16x32_bf16 v[124:127], a[80:83], a[240:243], v[44:47]
buffer_load_dwordx4 v12, s[16:19], s23 offen offset:2048 sc1 lds
v_cvt_pk_bf16_f32 v224, v224, v225
v_cvt_pk_bf16_f32 v225, v226, v227
v_cvt_pk_bf16_f32 v226, v228, v229
v_cvt_pk_bf16_f32 v227, v230, v231
v_mfma_f32_16x16x32_bf16 v[124:127], a[84:87], a[244:247], v[124:127]
buffer_store_dwordx4 v[224:227], v1, s[12:15], s63 offen offset:0 sc1
v_mfma_f32_16x16x32_bf16 v[20:23], a[32:35], v[224:227], v[20:23]
v_mul_f32 v232, v232, v6
v_mul_f32 v233, v233, v6
v_mfma_f32_16x16x32_bf16 v[124:127], a[88:91], a[248:251], v[124:127]
v_mul_f32 v234, v234, v6
v_mul_f32 v235, v235, v6
v_mul_f32 v236, v236, v6
v_mul_f32 v237, v237, v6
v_mul_f32 v238, v238, v6
v_mul_f32 v239, v239, v6
v_cvt_pk_bf16_f32 v232, v232, v233
v_cvt_pk_bf16_f32 v233, v234, v235
v_cvt_pk_bf16_f32 v234, v236, v237
v_cvt_pk_bf16_f32 v235, v238, v239
v_mfma_f32_16x16x32_bf16 v[124:127], a[92:95], a[252:255], v[124:127]
buffer_store_dwordx4 v[232:235], v1, s[12:15], s63 offen offset:1024 sc1
v_mfma_f32_16x16x32_bf16 v[20:23], a[32:35], v[232:235], v[20:23]
v_mul_f32 v240, v240, v6
v_mul_f32 v241, v241, v6
v_mfma_f32_16x16x32_bf16 v[112:115], a[64:67], a[224:227], v[36:39]
v_mul_f32 v242, v242, v6
v_mul_f32 v243, v243, v6
v_mul_f32 v244, v244, v6
v_mul_f32 v245, v245, v6
v_mul_f32 v246, v246, v6
v_mul_f32 v247, v247, v6
v_cvt_pk_bf16_f32 v240, v240, v241
v_cvt_pk_bf16_f32 v241, v242, v243
v_cvt_pk_bf16_f32 v242, v244, v245
v_cvt_pk_bf16_f32 v243, v246, v247
v_mfma_f32_16x16x32_bf16 v[112:115], a[68:71], a[228:231], v[112:115]
buffer_store_dwordx4 v[240:243], v1, s[12:15], s63 offen offset:2048 sc1
v_mfma_f32_16x16x32_bf16 v[20:23], a[32:35], v[240:243], v[20:23]
v_mul_f32 v248, v248, v6
v_mul_f32 v249, v249, v6
v_mfma_f32_16x16x32_bf16 v[112:115], a[72:75], a[232:235], v[112:115]
v_mul_f32 v250, v250, v6
v_mul_f32 v251, v251, v6
v_mul_f32 v252, v252, v6
v_mul_f32 v253, v253, v6
v_mul_f32 v254, v254, v6
v_mul_f32 v255, v255, v6
v_cvt_pk_bf16_f32 v248, v248, v249
v_cvt_pk_bf16_f32 v249, v250, v251
v_cvt_pk_bf16_f32 v250, v252, v253
v_cvt_pk_bf16_f32 v251, v254, v255
v_mfma_f32_16x16x32_bf16 v[112:115], a[76:79], a[236:239], v[112:115]
buffer_load_dwordx4 v13, s[16:19], s23 offen offset:3072 sc1 lds
v_exp_f32 v120, v120
v_cndmask_b32 v36, v48, v5, s[34:35]
buffer_store_dwordx4 v[248:251], v1, s[12:15], s63 offen offset:3072 sc1
v_exp_f32 v121, v121
s_nop 0
v_cvt_pk_bf16_f32 v76, v120, v121
v_cndmask_b32 v37, v49, v5, s[36:37]
v_mfma_f32_16x16x32_bf16 v[20:23], a[32:35], v[248:251], v[20:23]
v_exp_f32 v122, v122
v_cndmask_b32 v38, v50, v5, s[38:39]
v_exp_f32 v123, v123
s_nop 0
v_cvt_pk_bf16_f32 v77, v122, v123
v_cndmask_b32 v39, v51, v5, s[40:41]
v_exp_f32 v124, v124
v_cndmask_b32 v44, v52, v5, s[34:35]
v_exp_f32 v125, v125
s_nop 0
v_cvt_pk_bf16_f32 v78, v124, v125
v_cndmask_b32 v45, v53, v5, s[36:37]
v_exp_f32 v126, v126
v_cndmask_b32 v46, v54, v5, s[38:39]
v_exp_f32 v127, v127
s_nop 0
v_cvt_pk_bf16_f32 v79, v126, v127
v_cndmask_b32 v47, v55, v5, s[40:41]
v_exp_f32 v112, v112
v_exp_f32 v113, v113
s_nop 0
v_cvt_pk_bf16_f32 v72, v112, v113
v_exp_f32 v114, v114
v_exp_f32 v115, v115
s_nop 0
v_cvt_pk_bf16_f32 v73, v114, v115
v_mov_b32 v74, 0
v_mov_b32 v75, 0
s_waitcnt vmcnt(28) lgkmcnt(0)
s_barrier
v_mfma_f32_16x16x32_bf16 v[96:99], a[96:99], a[192:195], v[36:39]
s_add_u32 s63, s31, 18432
ds_read_b128 a[64:67], v2 offset:32768
s_add_u32 m0, s22, 16384
v_mul_f32 v160, v160, v8
v_mul_f32 v161, v161, v8
v_mfma_f32_16x16x32_bf16 v[96:99], a[100:103], a[196:199], v[96:99]
v_mul_f32 v162, v162, v8
v_mul_f32 v163, v163, v8
v_mul_f32 v164, v164, v8
v_mul_f32 v165, v165, v8
v_mul_f32 v166, v166, v8
v_mfma_f32_16x16x32_bf16 v[96:99], a[104:107], a[200:203], v[96:99]
v_mul_f32 v167, v167, v8
v_cvt_pk_bf16_f32 v160, v160, v161
v_cvt_pk_bf16_f32 v161, v162, v163
v_cvt_pk_bf16_f32 v162, v164, v165
v_mfma_f32_16x16x32_bf16 v[96:99], a[108:111], a[204:207], v[96:99]
s_add_u32 s23, s20, s99
ds_read_b128 a[160:163], v3 offset:40960
ds_read_b128 a[80:83], v2 offset:36864
v_cvt_pk_bf16_f32 v163, v166, v167
v_mfma_f32_16x16x32_bf16 v[104:107], a[96:99], a[208:211], v[52:55]
buffer_store_dwordx4 v[160:163], v1, s[12:15], s63 offen offset:0 sc1
v_mfma_f32_16x16x32_bf16 v[104:107], a[100:103], a[212:215], v[104:107]
ds_read_b128 a[164:167], v3 offset:41984
v_mfma_f32_16x16x32_bf16 v[20:23], a[32:35], v[160:163], v[20:23]
v_mul_f32 v168, v168, v8
v_mul_f32 v169, v169, v8
v_mfma_f32_16x16x32_bf16 v[104:107], a[104:107], a[216:219], v[104:107]
v_mul_f32 v170, v170, v8
v_mul_f32 v171, v171, v8
v_mul_f32 v172, v172, v8
v_mul_f32 v173, v173, v8
v_mfma_f32_16x16x32_bf16 v[104:107], a[108:111], a[220:223], v[104:107]
v_mul_f32 v174, v174, v8
v_mul_f32 v175, v175, v8
v_cvt_pk_bf16_f32 v168, v168, v169
v_cvt_pk_bf16_f32 v169, v170, v171
v_cvt_pk_bf16_f32 v170, v172, v173
v_mfma_f32_16x16x32_bf16 v[108:111], a[112:115], a[208:211], v[44:47]
ds_read_b128 a[68:71], v2 offset:33792
v_cvt_pk_bf16_f32 v171, v174, v175
v_exp_f32 v96, v96
v_mfma_f32_16x16x32_bf16 v[108:111], a[116:119], a[212:215], v[108:111]
buffer_store_dwordx4 v[168:171], v1, s[12:15], s63 offen offset:1024 sc1
v_mfma_f32_16x16x32_bf16 v[108:111], a[120:123], a[216:219], v[108:111]
v_exp_f32 v97, v97
v_mfma_f32_16x16x32_bf16 v[20:23], a[32:35], v[168:171], v[20:23]
v_mul_f32 v176, v176, v8
v_mul_f32 v177, v177, v8
v_mfma_f32_16x16x32_bf16 v[108:111], a[124:127], a[220:223], v[108:111]
v_mul_f32 v178, v178, v8
v_mul_f32 v179, v179, v8
v_mul_f32 v180, v180, v8
v_mul_f32 v181, v181, v8
v_mul_f32 v182, v182, v8
v_mfma_f32_16x16x32_bf16 v[112:115], a[96:99], a[224:227], v[56:59]
v_mul_f32 v183, v183, v8
v_cvt_pk_bf16_f32 v176, v176, v177
v_cvt_pk_bf16_f32 v177, v178, v179
v_cvt_pk_bf16_f32 v178, v180, v181
v_mfma_f32_16x16x32_bf16 v[112:115], a[100:103], a[228:231], v[112:115]
v_cvt_pk_bf16_f32 v179, v182, v183
v_exp_f32 v98, v98
v_exp_f32 v99, v99
v_mfma_f32_16x16x32_bf16 v[112:115], a[104:107], a[232:235], v[112:115]
buffer_store_dwordx4 v[176:179], v1, s[12:15], s63 offen offset:2048 sc1
v_mfma_f32_16x16x32_bf16 v[112:115], a[108:111], a[236:239], v[112:115]
buffer_load_dwordx4 v10, s[16:19], s20 offen offset:0 sc1 lds
v_mfma_f32_16x16x32_bf16 v[20:23], a[32:35], v[176:179], v[20:23]
v_mul_f32 v184, v184, v8
v_mul_f32 v185, v185, v8
v_mfma_f32_16x16x32_bf16 v[116:119], a[112:115], a[224:227], v[56:59]
v_mul_f32 v186, v186, v8
v_mul_f32 v187, v187, v8
v_mul_f32 v188, v188, v8
v_mul_f32 v189, v189, v8
v_mfma_f32_16x16x32_bf16 v[116:119], a[116:119], a[228:231], v[116:119]
v_mul_f32 v190, v190, v8
v_mul_f32 v191, v191, v8
v_cvt_pk_bf16_f32 v184, v184, v185
v_cvt_pk_bf16_f32 v185, v186, v187
v_cvt_pk_bf16_f32 v186, v188, v189
v_mfma_f32_16x16x32_bf16 v[116:119], a[120:123], a[232:235], v[116:119]
v_cvt_pk_bf16_f32 v187, v190, v191
v_cvt_pk_bf16_f32 v80, v96, v97
v_cvt_pk_bf16_f32 v81, v98, v99
v_mov_b32 v82, 0
v_mfma_f32_16x16x32_bf16 v[116:119], a[124:127], a[236:239], v[116:119]
ds_read_b128 a[168:171], v3 offset:43008
ds_read_b128 a[84:87], v2 offset:37888
buffer_load_dwordx4 v11, s[16:19], s20 offen offset:1024 sc1 lds
v_mov_b32 v83, 0
v_mfma_f32_16x16x32_bf16 v[120:123], a[96:99], a[240:243], v[60:63]
buffer_store_dwordx4 v[184:187], v1, s[12:15], s63 offen offset:3072 sc1
v_mfma_f32_16x16x32_bf16 v[120:123], a[100:103], a[244:247], v[120:123]
v_add_f32 v24, v96, v98
v_add_f32 v25, v97, v99
v_mfma_f32_16x16x32_bf16 v[20:23], a[32:35], v[184:187], v[20:23]
v_exp_f32 v104, v104
v_mfma_f32_16x16x32_bf16 v[120:123], a[104:107], a[248:251], v[120:123]
v_exp_f32 v105, v105
v_exp_f32 v106, v106
v_mfma_f32_16x16x32_bf16 v[120:123], a[108:111], a[252:255], v[120:123]
ds_read_b128 a[172:175], v3 offset:44032
ds_read_b128 a[72:75], v2 offset:34816
v_exp_f32 v107, v107
v_cvt_pk_bf16_f32 v84, v104, v105
v_mfma_f32_16x16x32_bf16 v[124:127], a[112:115], a[240:243], v[60:63]
buffer_load_dwordx4 v12, s[16:19], s20 offen offset:2048 sc1 lds
v_cvt_pk_bf16_f32 v85, v106, v107
v_add_f32 v26, v104, v106
v_mfma_f32_16x16x32_bf16 v[124:127], a[116:119], a[244:247], v[124:127]
v_exp_f32 v108, v108
v_exp_f32 v109, v109
v_add_f32 v27, v105, v107
v_mfma_f32_16x16x32_bf16 v[124:127], a[120:123], a[248:251], v[124:127]
v_exp_f32 v110, v110
v_exp_f32 v111, v111
v_mfma_f32_16x16x32_bf16 v[124:127], a[124:127], a[252:255], v[124:127]
ds_read_b128 a[176:179], v3 offset:45056
v_cvt_pk_bf16_f32 v86, v108, v109
v_cvt_pk_bf16_f32 v87, v110, v111
v_mov_b32 v36, v48
v_mov_b32 v37, v48
v_mfma_f32_16x16x32_bf16 v[192:195], a[128:131], v[72:75], 0
v_mov_b32 v38, v48
v_mov_b32 v39, v48
v_mov_b32 v40, v48
v_mov_b32 v41, v48
v_mfma_f32_16x16x32_bf16 v[196:199], a[132:135], v[72:75], 0
v_mov_b32 v42, v48
v_mov_b32 v43, v48
v_mov_b32 v44, v52
v_mov_b32 v45, v52
v_mov_b32 v46, v52
v_mfma_f32_16x16x32_bf16 v[200:203], a[136:139], v[72:75], 0
ds_read_b128 a[88:91], v2 offset:38912
buffer_load_dwordx4 v13, s[16:19], s20 offen offset:3072 sc1 lds
v_mov_b32 v47, v52
v_mfma_f32_16x16x32_bf16 v[204:207], a[140:143], v[72:75], 0
s_add_u32 m0, s22, 20480
v_exp_f32 v112, v112
v_exp_f32 v113, v113
v_add_f32 v26, v26, v108
v_mfma_f32_16x16x32_bf16 v[28:31], a[36:39], v[72:75], 0
s_add_u32 s20, s20, s21
v_exp_f32 v114, v114
v_exp_f32 v115, v115
v_mfma_f32_16x16x32_bf16 v[208:211], a[144:147], v[72:75], 0
ds_read_b128 a[180:183], v3 offset:46080
v_add_f32 v27, v27, v109
v_add_f32 v26, v26, v110
v_add_f32 v27, v27, v111
v_cvt_pk_bf16_f32 v88, v112, v113
v_mfma_f32_16x16x32_bf16 v[212:215], a[148:151], v[72:75], 0
ds_read_b128 a[76:79], v2 offset:35840
v_cvt_pk_bf16_f32 v89, v114, v115
v_exp_f32 v116, v116
v_mfma_f32_16x16x32_bf16 v[216:219], a[152:155], v[72:75], 0
ds_read_b128 a[184:187], v3 offset:47104
v_exp_f32 v117, v117
v_exp_f32 v118, v118
v_mfma_f32_16x16x32_bf16 v[220:223], a[156:159], v[72:75], 0
ds_read_b128 a[92:95], v2 offset:39936
v_exp_f32 v119, v119
v_cvt_pk_bf16_f32 v90, v116, v117
v_mfma_f32_16x16x32_bf16 v[224:227], a[128:131], v[76:79], 0
ds_read_b128 a[188:191], v3 offset:48128
v_cvt_pk_bf16_f32 v91, v118, v119
v_exp_f32 v120, v120
v_mfma_f32_16x16x32_bf16 v[228:231], a[132:135], v[76:79], 0
v_exp_f32 v121, v121
v_exp_f32 v122, v122
v_mfma_f32_16x16x32_bf16 v[232:235], a[136:139], v[76:79], 0
buffer_load_dwordx4 v10, s[16:19], s23 offen offset:0 sc1 lds
v_exp_f32 v123, v123
v_cvt_pk_bf16_f32 v92, v120, v121
v_mfma_f32_16x16x32_bf16 v[236:239], a[140:143], v[76:79], 0
v_cvt_pk_bf16_f32 v93, v122, v123
v_exp_f32 v124, v124
v_mfma_f32_16x16x32_bf16 v[32:35], a[36:39], v[76:79], 0
v_exp_f32 v125, v125
v_exp_f32 v126, v126
v_mfma_f32_16x16x32_bf16 v[240:243], a[144:147], v[76:79], 0
buffer_load_dwordx4 v11, s[16:19], s23 offen offset:1024 sc1 lds
v_exp_f32 v127, v127
v_mfma_f32_16x16x32_bf16 v[244:247], a[148:151], v[76:79], 0
buffer_load_dwordx4 v12, s[16:19], s23 offen offset:2048 sc1 lds
v_cvt_pk_bf16_f32 v94, v124, v125
v_cvt_pk_bf16_f32 v95, v126, v127
v_mfma_f32_16x16x32_bf16 v[248:251], a[152:155], v[76:79], 0
buffer_load_dwordx4 v13, s[16:19], s23 offen offset:3072 sc1 lds
v_mfma_f32_16x16x32_bf16 v[252:255], a[156:159], v[76:79], 0
s_waitcnt vmcnt(29) lgkmcnt(0)
s_barrier
v_mfma_f32_16x16x32_bf16 v[96:99], a[64:67], a[192:195], v[48:51]
s_add_u32 m0, s22, 32768
ds_read_b128 a[96:99], v2 offset:49152
ds_read_b128 a[128:131], v3 offset:57344
v_mfma_f32_16x16x32_bf16 v[96:99], a[68:71], a[196:199], v[96:99]
s_add_u32 s23, s20, s99
v_mfma_f32_16x16x32_bf16 v[96:99], a[72:75], a[200:203], v[96:99]
buffer_load_dwordx4 v10, s[16:19], s20 offen offset:0 sc1 lds
v_mfma_f32_16x16x32_bf16 v[96:99], a[76:79], a[204:207], v[96:99]
ds_read_b128 a[112:115], v2 offset:53248
ds_read_b128 a[132:135], v3 offset:58368
v_mfma_f32_16x16x32_bf16 v[100:103], a[80:83], a[192:195], v[48:51]
buffer_load_dwordx4 v11, s[16:19], s20 offen offset:1024 sc1 lds
v_mfma_f32_16x16x32_bf16 v[100:103], a[84:87], a[196:199], v[100:103]
ds_read_b128 a[100:103], v2 offset:50176
ds_read_b128 a[136:139], v3 offset:59392
v_mfma_f32_16x16x32_bf16 v[100:103], a[88:91], a[200:203], v[100:103]
buffer_load_dwordx4 v12, s[16:19], s20 offen offset:2048 sc1 lds
v_mfma_f32_16x16x32_bf16 v[100:103], a[92:95], a[204:207], v[100:103]
ds_read_b128 a[116:119], v2 offset:54272
ds_read_b128 a[140:143], v3 offset:60416
v_mfma_f32_16x16x32_bf16 v[104:107], a[64:67], a[208:211], v[52:55]
v_exp_f32 v96, v96
v_mfma_f32_16x16x32_bf16 v[104:107], a[68:71], a[212:215], v[104:107]
v_exp_f32 v97, v97
v_mfma_f32_16x16x32_bf16 v[104:107], a[72:75], a[216:219], v[104:107]
v_exp_f32 v98, v98
v_mfma_f32_16x16x32_bf16 v[104:107], a[76:79], a[220:223], v[104:107]
v_exp_f32 v99, v99
v_mfma_f32_16x16x32_bf16 v[108:111], a[80:83], a[208:211], v[52:55]
buffer_load_dwordx4 v13, s[16:19], s20 offen offset:3072 sc1 lds
v_mfma_f32_16x16x32_bf16 v[108:111], a[84:87], a[212:215], v[108:111]
s_add_u32 m0, s22, 36864
s_add_u32 s20, s20, s21
v_cvt_pk_bf16_f32 v64, v96, v97
v_mfma_f32_16x16x32_bf16 v[108:111], a[88:91], a[216:219], v[108:111]
ds_read_b128 a[104:107], v2 offset:51200
v_cvt_pk_bf16_f32 v65, v98, v99
v_mfma_f32_16x16x32_bf16 v[108:111], a[92:95], a[220:223], v[108:111]
ds_read_b128 a[144:147], v3 offset:61440
v_add_f32 v24, v24, v96
v_mfma_f32_16x16x32_bf16 v[128:131], a[160:163], v[80:83], 0
buffer_load_dwordx4 v10, s[16:19], s23 offen offset:0 sc1 lds
v_mfma_f32_16x16x32_bf16 v[132:135], a[164:167], v[80:83], 0
v_exp_f32 v100, v100
v_mfma_f32_16x16x32_bf16 v[136:139], a[168:171], v[80:83], 0
v_exp_f32 v101, v101
v_mfma_f32_16x16x32_bf16 v[140:143], a[172:175], v[80:83], 0
v_exp_f32 v102, v102
v_add_f32 v25, v25, v97
v_mfma_f32_16x16x32_bf16 v[144:147], a[176:179], v[80:83], 0
v_exp_f32 v103, v103
v_mfma_f32_16x16x32_bf16 v[148:151], a[180:183], v[80:83], 0
v_add_f32 v24, v24, v98
v_add_f32 v25, v25, v99
v_mfma_f32_16x16x32_bf16 v[152:155], a[184:187], v[80:83], 0
v_cvt_pk_bf16_f32 v66, v100, v101
v_cvt_pk_bf16_f32 v67, v102, v103
v_mfma_f32_16x16x32_bf16 v[156:159], a[188:191], v[80:83], 0
ds_read_b128 a[120:123], v2 offset:55296
v_add_f32 v24, v24, v100
v_mfma_f32_16x16x32_bf16 v[112:115], a[64:67], a[224:227], v[56:59]
v_exp_f32 v104, v104
v_mfma_f32_16x16x32_bf16 v[112:115], a[68:71], a[228:231], v[112:115]
v_exp_f32 v105, v105
v_mfma_f32_16x16x32_bf16 v[112:115], a[72:75], a[232:235], v[112:115]
v_exp_f32 v106, v106
v_mfma_f32_16x16x32_bf16 v[112:115], a[76:79], a[236:239], v[112:115]
v_exp_f32 v107, v107
v_mfma_f32_16x16x32_bf16 v[116:119], a[80:83], a[224:227], v[56:59]
v_add_f32 v25, v25, v101
v_add_f32 v24, v24, v102
v_mfma_f32_16x16x32_bf16 v[116:119], a[84:87], a[228:231], v[116:119]
v_add_f32 v25, v25, v103
v_cvt_pk_bf16_f32 v68, v104, v105
v_mfma_f32_16x16x32_bf16 v[116:119], a[88:91], a[232:235], v[116:119]
v_cvt_pk_bf16_f32 v69, v106, v107
v_add_f32 v26, v26, v104
v_mfma_f32_16x16x32_bf16 v[116:119], a[92:95], a[236:239], v[116:119]
v_exp_f32 v108, v108
v_mfma_f32_16x16x32_bf16 v[160:163], a[160:163], v[84:87], 0
v_exp_f32 v109, v109
v_mfma_f32_16x16x32_bf16 v[164:167], a[164:167], v[84:87], 0
v_exp_f32 v110, v110
v_mfma_f32_16x16x32_bf16 v[168:171], a[168:171], v[84:87], 0
v_exp_f32 v111, v111
v_mfma_f32_16x16x32_bf16 v[172:175], a[172:175], v[84:87], 0
v_add_f32 v27, v27, v105
v_add_f32 v26, v26, v106
v_mfma_f32_16x16x32_bf16 v[176:179], a[176:179], v[84:87], 0
v_add_f32 v27, v27, v107
v_cvt_pk_bf16_f32 v70, v108, v109
v_mfma_f32_16x16x32_bf16 v[180:183], a[180:183], v[84:87], 0
ds_read_b128 a[148:151], v3 offset:62464
v_cvt_pk_bf16_f32 v71, v110, v111
v_mfma_f32_16x16x32_bf16 v[184:187], a[184:187], v[84:87], 0
v_add_f32 v26, v26, v108
v_add_f32 v27, v27, v109
v_mfma_f32_16x16x32_bf16 v[188:191], a[188:191], v[84:87], 0
ds_read_b128 a[108:111], v2 offset:52224
v_add_f32 v26, v26, v110
v_add_f32 v27, v27, v111
v_mfma_f32_16x16x32_bf16 v[120:123], a[64:67], a[240:243], v[60:63]
buffer_load_dwordx4 v11, s[16:19], s23 offen offset:1024 sc1 lds
v_mfma_f32_16x16x32_bf16 v[120:123], a[68:71], a[244:247], v[120:123]
v_exp_f32 v112, v112
v_mfma_f32_16x16x32_bf16 v[120:123], a[72:75], a[248:251], v[120:123]
v_exp_f32 v113, v113
v_mfma_f32_16x16x32_bf16 v[120:123], a[76:79], a[252:255], v[120:123]
v_exp_f32 v114, v114
v_mfma_f32_16x16x32_bf16 v[124:127], a[80:83], a[240:243], v[60:63]
v_exp_f32 v115, v115
v_mfma_f32_16x16x32_bf16 v[124:127], a[84:87], a[244:247], v[124:127]
v_cvt_pk_bf16_f32 v72, v112, v113
v_cvt_pk_bf16_f32 v73, v114, v115
v_mfma_f32_16x16x32_bf16 v[124:127], a[88:91], a[248:251], v[124:127]
ds_read_b128 a[152:155], v3 offset:63488
ds_read_b128 a[124:127], v2 offset:56320
v_mfma_f32_16x16x32_bf16 v[124:127], a[92:95], a[252:255], v[124:127]
v_exp_f32 v116, v116
v_mfma_f32_16x16x32_bf16 v[192:195], a[160:163], v[88:91], v[192:195]
v_exp_f32 v117, v117
v_mfma_f32_16x16x32_bf16 v[196:199], a[164:167], v[88:91], v[196:199]
v_exp_f32 v118, v118
v_mfma_f32_16x16x32_bf16 v[200:203], a[168:171], v[88:91], v[200:203]
v_exp_f32 v119, v119
v_mfma_f32_16x16x32_bf16 v[204:207], a[172:175], v[88:91], v[204:207]
v_cvt_pk_bf16_f32 v74, v116, v117
v_cvt_pk_bf16_f32 v75, v118, v119
v_mfma_f32_16x16x32_bf16 v[28:31], a[36:39], v[88:91], v[28:31]
buffer_load_dwordx4 v12, s[16:19], s23 offen offset:2048 sc1 lds
v_mfma_f32_16x16x32_bf16 v[208:211], a[176:179], v[88:91], v[208:211]
ds_read_b128 a[156:159], v3 offset:64512
v_mfma_f32_16x16x32_bf16 v[212:215], a[180:183], v[88:91], v[212:215]
v_exp_f32 v120, v120
v_mfma_f32_16x16x32_bf16 v[216:219], a[184:187], v[88:91], v[216:219]
v_exp_f32 v121, v121
v_mfma_f32_16x16x32_bf16 v[220:223], a[188:191], v[88:91], v[220:223]
v_exp_f32 v122, v122
v_mfma_f32_16x16x32_bf16 v[224:227], a[160:163], v[92:95], v[224:227]
v_exp_f32 v123, v123
v_mfma_f32_16x16x32_bf16 v[228:231], a[164:167], v[92:95], v[228:231]
v_cvt_pk_bf16_f32 v76, v120, v121
v_cvt_pk_bf16_f32 v77, v122, v123
v_mfma_f32_16x16x32_bf16 v[232:235], a[168:171], v[92:95], v[232:235]
v_exp_f32 v124, v124
v_mfma_f32_16x16x32_bf16 v[236:239], a[172:175], v[92:95], v[236:239]
v_exp_f32 v125, v125
v_mfma_f32_16x16x32_bf16 v[32:35], a[36:39], v[92:95], v[32:35]
v_exp_f32 v126, v126
v_mfma_f32_16x16x32_bf16 v[240:243], a[176:179], v[92:95], v[240:243]
v_exp_f32 v127, v127
v_mfma_f32_16x16x32_bf16 v[244:247], a[180:183], v[92:95], v[244:247]
v_cvt_pk_bf16_f32 v78, v124, v125
v_cvt_pk_bf16_f32 v79, v126, v127
v_mfma_f32_16x16x32_bf16 v[248:251], a[184:187], v[92:95], v[248:251]
buffer_load_dwordx4 v13, s[16:19], s23 offen offset:3072 sc1 lds
v_mfma_f32_16x16x32_bf16 v[252:255], a[188:191], v[92:95], v[252:255]
s_sub_u32 s26, 7, s25
s_mov_b32 s27, 3
s_mov_b32 s28, -1
s_branch L_k2_disp
L_k2_sp2:
s_waitcnt vmcnt(16) lgkmcnt(0)
s_barrier
v_mfma_f32_16x16x32_bf16 v[96:99], a[96:99], a[192:195], v[48:51]
s_add_u32 m0, s22, 49152
ds_read_b128 a[64:67], v2 offset:0
ds_read_b128 a[160:163], v3 offset:8192
v_mfma_f32_16x16x32_bf16 v[96:99], a[100:103], a[196:199], v[96:99]
s_add_u32 s23, s20, s99
v_mfma_f32_16x16x32_bf16 v[96:99], a[104:107], a[200:203], v[96:99]
buffer_load_dwordx4 v10, s[16:19], s20 offen offset:0 sc1 lds
v_mfma_f32_16x16x32_bf16 v[96:99], a[108:111], a[204:207], v[96:99]
ds_read_b128 a[80:83], v2 offset:4096
ds_read_b128 a[164:167], v3 offset:9216
v_mfma_f32_16x16x32_bf16 v[100:103], a[112:115], a[192:195], v[48:51]
buffer_load_dwordx4 v11, s[16:19], s20 offen offset:1024 sc1 lds
ds_read_b128 a[68:71], v2 offset:1024
v_mfma_f32_16x16x32_bf16 v[100:103], a[116:119], a[196:199], v[100:103]
ds_read_b128 a[168:171], v3 offset:10240
v_cndmask_b32 v36, v48, v5, s[34:35]
v_mfma_f32_16x16x32_bf16 v[100:103], a[120:123], a[200:203], v[100:103]
buffer_load_dwordx4 v12, s[16:19], s20 offen offset:2048 sc1 lds
v_mfma_f32_16x16x32_bf16 v[100:103], a[124:127], a[204:207], v[100:103]
ds_read_b128 a[84:87], v2 offset:5120
ds_read_b128 a[172:175], v3 offset:11264
v_mfma_f32_16x16x32_bf16 v[104:107], a[96:99], a[208:211], v[52:55]
v_exp_f32 v96, v96
v_mfma_f32_16x16x32_bf16 v[104:107], a[100:103], a[212:215], v[104:107]
ds_read_b128 a[72:75], v2 offset:2048
v_exp_f32 v97, v97
v_mfma_f32_16x16x32_bf16 v[104:107], a[104:107], a[216:219], v[104:107]
v_exp_f32 v98, v98
v_mfma_f32_16x16x32_bf16 v[104:107], a[108:111], a[220:223], v[104:107]
v_exp_f32 v99, v99
v_mfma_f32_16x16x32_bf16 v[108:111], a[112:115], a[208:211], v[52:55]
buffer_load_dwordx4 v13, s[16:19], s20 offen offset:3072 sc1 lds
v_mfma_f32_16x16x32_bf16 v[108:111], a[116:119], a[212:215], v[108:111]
s_add_u32 m0, s22, 53248
s_add_u32 s20, s20, s21
v_cvt_pk_bf16_f32 v80, v96, v97
v_mfma_f32_16x16x32_bf16 v[108:111], a[120:123], a[216:219], v[108:111]
ds_read_b128 a[176:179], v3 offset:12288
v_cvt_pk_bf16_f32 v81, v98, v99
v_cndmask_b32 v37, v49, v5, s[36:37]
v_mfma_f32_16x16x32_bf16 v[108:111], a[124:127], a[220:223], v[108:111]
buffer_load_dwordx4 v10, s[16:19], s23 offen offset:0 sc1 lds
v_mfma_f32_16x16x32_bf16 v[128:131], a[128:131], v[64:67], v[128:131]
v_exp_f32 v100, v100
v_mfma_f32_16x16x32_bf16 v[132:135], a[132:135], v[64:67], v[132:135]
v_exp_f32 v101, v101
v_mfma_f32_16x16x32_bf16 v[136:139], a[136:139], v[64:67], v[136:139]
v_exp_f32 v102, v102
v_mfma_f32_16x16x32_bf16 v[140:143], a[140:143], v[64:67], v[140:143]
v_exp_f32 v103, v103
v_add_f32 v24, v24, v96
v_mfma_f32_16x16x32_bf16 v[144:147], a[144:147], v[64:67], v[144:147]
v_add_f32 v25, v25, v97
v_add_f32 v24, v24, v98
v_mfma_f32_16x16x32_bf16 v[148:151], a[148:151], v[64:67], v[148:151]
v_add_f32 v25, v25, v99
v_cvt_pk_bf16_f32 v82, v100, v101
v_mfma_f32_16x16x32_bf16 v[152:155], a[152:155], v[64:67], v[152:155]
ds_read_b128 a[88:91], v2 offset:6144
v_cvt_pk_bf16_f32 v83, v102, v103
v_mfma_f32_16x16x32_bf16 v[156:159], a[156:159], v[64:67], v[156:159]
v_exp_f32 v104, v104
v_mfma_f32_16x16x32_bf16 v[112:115], a[96:99], a[224:227], v[56:59]
v_exp_f32 v105, v105
v_add_f32 v24, v24, v100
v_mfma_f32_16x16x32_bf16 v[112:115], a[100:103], a[228:231], v[112:115]
v_exp_f32 v106, v106
v_mfma_f32_16x16x32_bf16 v[112:115], a[104:107], a[232:235], v[112:115]
v_exp_f32 v107, v107
v_mfma_f32_16x16x32_bf16 v[112:115], a[108:111], a[236:239], v[112:115]
v_add_f32 v25, v25, v101
v_add_f32 v24, v24, v102
v_mfma_f32_16x16x32_bf16 v[116:119], a[112:115], a[224:227], v[56:59]
v_add_f32 v25, v25, v103
v_cvt_pk_bf16_f32 v84, v104, v105
v_mfma_f32_16x16x32_bf16 v[116:119], a[116:119], a[228:231], v[116:119]
v_cvt_pk_bf16_f32 v85, v106, v107
v_cndmask_b32 v38, v50, v5, s[38:39]
v_add_f32 v26, v26, v104
v_mfma_f32_16x16x32_bf16 v[116:119], a[120:123], a[232:235], v[116:119]
v_exp_f32 v108, v108
v_mfma_f32_16x16x32_bf16 v[116:119], a[124:127], a[236:239], v[116:119]
v_exp_f32 v109, v109
v_mfma_f32_16x16x32_bf16 v[160:163], a[128:131], v[68:71], v[160:163]
v_exp_f32 v110, v110
v_mfma_f32_16x16x32_bf16 v[164:167], a[132:135], v[68:71], v[164:167]
v_exp_f32 v111, v111
v_mfma_f32_16x16x32_bf16 v[168:171], a[136:139], v[68:71], v[168:171]
v_add_f32 v27, v27, v105
v_add_f32 v26, v26, v106
v_add_f32 v27, v27, v107
v_mfma_f32_16x16x32_bf16 v[172:175], a[140:143], v[68:71], v[172:175]
v_cvt_pk_bf16_f32 v86, v108, v109
v_cvt_pk_bf16_f32 v87, v110, v111
v_mfma_f32_16x16x32_bf16 v[176:179], a[144:147], v[68:71], v[176:179]
ds_read_b128 a[180:183], v3 offset:13312
v_cndmask_b32 v39, v51, v5, s[40:41]
v_mfma_f32_16x16x32_bf16 v[180:183], a[148:151], v[68:71], v[180:183]
v_add_f32 v26, v26, v108
v_add_f32 v27, v27, v109
v_mfma_f32_16x16x32_bf16 v[184:187], a[152:155], v[68:71], v[184:187]
v_add_f32 v26, v26, v110
v_add_f32 v27, v27, v111
v_mfma_f32_16x16x32_bf16 v[188:191], a[156:159], v[68:71], v[188:191]
buffer_load_dwordx4 v11, s[16:19], s23 offen offset:1024 sc1 lds
ds_read_b128 a[76:79], v2 offset:3072
v_mfma_f32_16x16x32_bf16 v[120:123], a[96:99], a[240:243], v[60:63]
ds_read_b128 a[184:187], v3 offset:14336
v_cndmask_b32 v44, v52, v5, s[34:35]
v_mfma_f32_16x16x32_bf16 v[120:123], a[100:103], a[244:247], v[120:123]
v_exp_f32 v112, v112
v_mfma_f32_16x16x32_bf16 v[120:123], a[104:107], a[248:251], v[120:123]
v_exp_f32 v113, v113
v_mfma_f32_16x16x32_bf16 v[120:123], a[108:111], a[252:255], v[120:123]
v_exp_f32 v114, v114
v_mfma_f32_16x16x32_bf16 v[124:127], a[112:115], a[240:243], v[60:63]
v_exp_f32 v115, v115
v_cvt_pk_bf16_f32 v88, v112, v113
v_mfma_f32_16x16x32_bf16 v[124:127], a[116:119], a[244:247], v[124:127]
v_cvt_pk_bf16_f32 v89, v114, v115
v_cndmask_b32 v45, v53, v5, s[36:37]
v_mfma_f32_16x16x32_bf16 v[124:127], a[120:123], a[248:251], v[124:127]
v_exp_f32 v116, v116
v_mfma_f32_16x16x32_bf16 v[124:127], a[124:127], a[252:255], v[124:127]
v_exp_f32 v117, v117
v_mfma_f32_16x16x32_bf16 v[192:195], a[128:131], v[72:75], v[192:195]
v_exp_f32 v118, v118
v_mfma_f32_16x16x32_bf16 v[196:199], a[132:135], v[72:75], v[196:199]
v_exp_f32 v119, v119
v_cvt_pk_bf16_f32 v90, v116, v117
v_mfma_f32_16x16x32_bf16 v[200:203], a[136:139], v[72:75], v[200:203]
ds_read_b128 a[92:95], v2 offset:7168
v_cvt_pk_bf16_f32 v91, v118, v119
v_mfma_f32_16x16x32_bf16 v[204:207], a[140:143], v[72:75], v[204:207]
buffer_load_dwordx4 v12, s[16:19], s23 offen offset:2048 sc1 lds
v_mfma_f32_16x16x32_bf16 v[28:31], a[36:39], v[72:75], v[28:31]
ds_read_b128 a[188:191], v3 offset:15360
v_cndmask_b32 v46, v54, v5, s[38:39]
v_mfma_f32_16x16x32_bf16 v[208:211], a[144:147], v[72:75], v[208:211]
v_cndmask_b32 v47, v55, v5, s[40:41]
v_mfma_f32_16x16x32_bf16 v[212:215], a[148:151], v[72:75], v[212:215]
v_exp_f32 v120, v120
v_mfma_f32_16x16x32_bf16 v[216:219], a[152:155], v[72:75], v[216:219]
v_exp_f32 v121, v121
v_mfma_f32_16x16x32_bf16 v[220:223], a[156:159], v[72:75], v[220:223]
v_exp_f32 v122, v122
v_mfma_f32_16x16x32_bf16 v[224:227], a[128:131], v[76:79], v[224:227]
v_exp_f32 v123, v123
v_mfma_f32_16x16x32_bf16 v[228:231], a[132:135], v[76:79], v[228:231]
v_cvt_pk_bf16_f32 v92, v120, v121
v_cvt_pk_bf16_f32 v93, v122, v123
v_mfma_f32_16x16x32_bf16 v[232:235], a[136:139], v[76:79], v[232:235]
v_exp_f32 v124, v124
v_mfma_f32_16x16x32_bf16 v[236:239], a[140:143], v[76:79], v[236:239]
v_exp_f32 v125, v125
v_mfma_f32_16x16x32_bf16 v[32:35], a[36:39], v[76:79], v[32:35]
v_exp_f32 v126, v126
v_mfma_f32_16x16x32_bf16 v[240:243], a[144:147], v[76:79], v[240:243]
v_exp_f32 v127, v127
v_mfma_f32_16x16x32_bf16 v[244:247], a[148:151], v[76:79], v[244:247]
v_cvt_pk_bf16_f32 v94, v124, v125
v_cvt_pk_bf16_f32 v95, v126, v127
v_mfma_f32_16x16x32_bf16 v[248:251], a[152:155], v[76:79], v[248:251]
buffer_load_dwordx4 v13, s[16:19], s23 offen offset:3072 sc1 lds
v_mfma_f32_16x16x32_bf16 v[252:255], a[156:159], v[76:79], v[252:255]
s_cmp_eq_u32 s20, s98
s_cbranch_scc1 L_k2_sw
L_k2_swr2:
s_waitcnt vmcnt(16) lgkmcnt(0)
s_barrier
v_mfma_f32_16x16x32_bf16 v[96:99], a[64:67], a[192:195], v[36:39]
s_add_u32 m0, s22, 0
ds_read_b128 a[96:99], v2 offset:16384
ds_read_b128 a[128:131], v3 offset:24576
v_mfma_f32_16x16x32_bf16 v[96:99], a[68:71], a[196:199], v[96:99]
s_add_u32 s23, s20, s99
v_mfma_f32_16x16x32_bf16 v[96:99], a[72:75], a[200:203], v[96:99]
buffer_load_dwordx4 v10, s[16:19], s20 offen offset:0 sc1 lds
v_mfma_f32_16x16x32_bf16 v[96:99], a[76:79], a[204:207], v[96:99]
ds_read_b128 a[112:115], v2 offset:20480
ds_read_b128 a[132:135], v3 offset:25600
v_mfma_f32_16x16x32_bf16 v[104:107], a[64:67], a[208:211], v[52:55]
buffer_load_dwordx4 v11, s[16:19], s20 offen offset:1024 sc1 lds
v_mfma_f32_16x16x32_bf16 v[104:107], a[68:71], a[212:215], v[104:107]
ds_read_b128 a[100:103], v2 offset:17408
ds_read_b128 a[136:139], v3 offset:26624
v_mfma_f32_16x16x32_bf16 v[104:107], a[72:75], a[216:219], v[104:107]
buffer_load_dwordx4 v12, s[16:19], s20 offen offset:2048 sc1 lds
v_mfma_f32_16x16x32_bf16 v[104:107], a[76:79], a[220:223], v[104:107]
ds_read_b128 a[116:119], v2 offset:21504
ds_read_b128 a[140:143], v3 offset:27648
v_mfma_f32_16x16x32_bf16 v[108:111], a[80:83], a[208:211], v[44:47]
v_exp_f32 v96, v96
v_mfma_f32_16x16x32_bf16 v[108:111], a[84:87], a[212:215], v[108:111]
v_exp_f32 v97, v97
v_mfma_f32_16x16x32_bf16 v[108:111], a[88:91], a[216:219], v[108:111]
v_exp_f32 v98, v98
v_mfma_f32_16x16x32_bf16 v[108:111], a[92:95], a[220:223], v[108:111]
v_exp_f32 v99, v99
v_mfma_f32_16x16x32_bf16 v[128:131], a[160:163], v[80:83], v[128:131]
buffer_load_dwordx4 v13, s[16:19], s20 offen offset:3072 sc1 lds
v_mfma_f32_16x16x32_bf16 v[132:135], a[164:167], v[80:83], v[132:135]
s_add_u32 m0, s22, 4096
s_add_u32 s20, s20, s21
v_cvt_pk_bf16_f32 v64, v96, v97
v_mfma_f32_16x16x32_bf16 v[136:139], a[168:171], v[80:83], v[136:139]
v_cvt_pk_bf16_f32 v65, v98, v99
v_mov_b32 v66, 0
v_mfma_f32_16x16x32_bf16 v[140:143], a[172:175], v[80:83], v[140:143]
ds_read_b128 a[104:107], v2 offset:18432
v_mov_b32 v67, 0
v_mfma_f32_16x16x32_bf16 v[144:147], a[176:179], v[80:83], v[144:147]
ds_read_b128 a[144:147], v3 offset:28672
v_add_f32 v24, v24, v96
v_mfma_f32_16x16x32_bf16 v[148:151], a[180:183], v[80:83], v[148:151]
buffer_load_dwordx4 v10, s[16:19], s23 offen offset:0 sc1 lds
v_mfma_f32_16x16x32_bf16 v[152:155], a[184:187], v[80:83], v[152:155]
v_exp_f32 v104, v104
v_mfma_f32_16x16x32_bf16 v[156:159], a[188:191], v[80:83], v[156:159]
v_exp_f32 v105, v105
v_mfma_f32_16x16x32_bf16 v[112:115], a[64:67], a[224:227], v[56:59]
v_exp_f32 v106, v106
v_mfma_f32_16x16x32_bf16 v[112:115], a[68:71], a[228:231], v[112:115]
v_exp_f32 v107, v107
v_mfma_f32_16x16x32_bf16 v[112:115], a[72:75], a[232:235], v[112:115]
v_add_f32 v25, v25, v97
v_add_f32 v24, v24, v98
v_mfma_f32_16x16x32_bf16 v[112:115], a[76:79], a[236:239], v[112:115]
v_add_f32 v25, v25, v99
v_cvt_pk_bf16_f32 v68, v104, v105
v_mfma_f32_16x16x32_bf16 v[116:119], a[80:83], a[224:227], v[56:59]
ds_read_b128 a[120:123], v2 offset:22528
v_cvt_pk_bf16_f32 v69, v106, v107
v_mfma_f32_16x16x32_bf16 v[116:119], a[84:87], a[228:231], v[116:119]
v_exp_f32 v108, v108
v_mfma_f32_16x16x32_bf16 v[116:119], a[88:91], a[232:235], v[116:119]
v_exp_f32 v109, v109
v_mfma_f32_16x16x32_bf16 v[116:119], a[92:95], a[236:239], v[116:119]
v_exp_f32 v110, v110
v_mfma_f32_16x16x32_bf16 v[160:163], a[160:163], v[84:87], v[160:163]
v_exp_f32 v111, v111
v_mfma_f32_16x16x32_bf16 v[164:167], a[164:167], v[84:87], v[164:167]
v_add_f32 v26, v26, v104
v_add_f32 v27, v27, v105
v_mfma_f32_16x16x32_bf16 v[168:171], a[168:171], v[84:87], v[168:171]
v_add_f32 v26, v26, v106
v_add_f32 v27, v27, v107
v_mfma_f32_16x16x32_bf16 v[172:175], a[172:175], v[84:87], v[172:175]
v_cvt_pk_bf16_f32 v70, v108, v109
v_cvt_pk_bf16_f32 v71, v110, v111
v_mfma_f32_16x16x32_bf16 v[176:179], a[176:179], v[84:87], v[176:179]
v_add_f32 v26, v26, v108
v_add_f32 v27, v27, v109
v_mfma_f32_16x16x32_bf16 v[180:183], a[180:183], v[84:87], v[180:183]
v_add_f32 v26, v26, v110
v_add_f32 v27, v27, v111
v_mfma_f32_16x16x32_bf16 v[184:187], a[184:187], v[84:87], v[184:187]
ds_read_b128 a[148:151], v3 offset:29696
ds_read_b128 a[108:111], v2 offset:19456
v_mfma_f32_16x16x32_bf16 v[188:191], a[188:191], v[84:87], v[188:191]
buffer_load_dwordx4 v11, s[16:19], s23 offen offset:1024 sc1 lds
v_mfma_f32_16x16x32_bf16 v[120:123], a[64:67], a[240:243], v[60:63]
v_exp_f32 v112, v112
v_mfma_f32_16x16x32_bf16 v[120:123], a[68:71], a[244:247], v[120:123]
v_exp_f32 v113, v113
v_mfma_f32_16x16x32_bf16 v[120:123], a[72:75], a[248:251], v[120:123]
v_exp_f32 v114, v114
v_mfma_f32_16x16x32_bf16 v[120:123], a[76:79], a[252:255], v[120:123]
v_exp_f32 v115, v115
v_mfma_f32_16x16x32_bf16 v[124:127], a[80:83], a[240:243], v[60:63]
v_cvt_pk_bf16_f32 v72, v112, v113
v_cvt_pk_bf16_f32 v73, v114, v115
v_mfma_f32_16x16x32_bf16 v[124:127], a[84:87], a[244:247], v[124:127]
v_exp_f32 v116, v116
v_mfma_f32_16x16x32_bf16 v[124:127], a[88:91], a[248:251], v[124:127]
v_exp_f32 v117, v117
v_mfma_f32_16x16x32_bf16 v[124:127], a[92:95], a[252:255], v[124:127]
v_exp_f32 v118, v118
v_mfma_f32_16x16x32_bf16 v[192:195], a[160:163], v[88:91], v[192:195]
v_exp_f32 v119, v119
v_mfma_f32_16x16x32_bf16 v[196:199], a[164:167], v[88:91], v[196:199]
v_cvt_pk_bf16_f32 v74, v116, v117
v_cvt_pk_bf16_f32 v75, v118, v119
v_mfma_f32_16x16x32_bf16 v[200:203], a[168:171], v[88:91], v[200:203]
ds_read_b128 a[152:155], v3 offset:30720
ds_read_b128 a[124:127], v2 offset:23552
v_mfma_f32_16x16x32_bf16 v[204:207], a[172:175], v[88:91], v[204:207]
buffer_load_dwordx4 v12, s[16:19], s23 offen offset:2048 sc1 lds
v_mfma_f32_16x16x32_bf16 v[28:31], a[36:39], v[88:91], v[28:31]
v_exp_f32 v120, v120
v_mfma_f32_16x16x32_bf16 v[208:211], a[176:179], v[88:91], v[208:211]
v_exp_f32 v121, v121
v_mfma_f32_16x16x32_bf16 v[212:215], a[180:183], v[88:91], v[212:215]
v_exp_f32 v122, v122
v_mfma_f32_16x16x32_bf16 v[216:219], a[184:187], v[88:91], v[216:219]
v_exp_f32 v123, v123
v_mfma_f32_16x16x32_bf16 v[220:223], a[188:191], v[88:91], v[220:223]
v_cvt_pk_bf16_f32 v76, v120, v121
v_cvt_pk_bf16_f32 v77, v122, v123
v_mfma_f32_16x16x32_bf16 v[224:227], a[160:163], v[92:95], v[224:227]
ds_read_b128 a[156:159], v3 offset:31744
v_mfma_f32_16x16x32_bf16 v[228:231], a[164:167], v[92:95], v[228:231]
v_exp_f32 v124, v124
v_mfma_f32_16x16x32_bf16 v[232:235], a[168:171], v[92:95], v[232:235]
v_exp_f32 v125, v125
v_mfma_f32_16x16x32_bf16 v[236:239], a[172:175], v[92:95], v[236:239]
v_exp_f32 v126, v126
v_mfma_f32_16x16x32_bf16 v[32:35], a[36:39], v[92:95], v[32:35]
v_exp_f32 v127, v127
v_mfma_f32_16x16x32_bf16 v[240:243], a[176:179], v[92:95], v[240:243]
v_cvt_pk_bf16_f32 v78, v124, v125
v_cvt_pk_bf16_f32 v79, v126, v127
v_mfma_f32_16x16x32_bf16 v[244:247], a[180:183], v[92:95], v[244:247]
buffer_load_dwordx4 v13, s[16:19], s23 offen offset:3072 sc1 lds
v_mfma_f32_16x16x32_bf16 v[248:251], a[184:187], v[92:95], v[248:251]
v_mfma_f32_16x16x32_bf16 v[252:255], a[188:191], v[92:95], v[252:255]
v_cndmask_b32 v36, v56, v5, s[34:35]
v_cndmask_b32 v37, v57, v5, s[36:37]
v_cndmask_b32 v38, v58, v5, s[38:39]
v_cndmask_b32 v39, v59, v5, s[40:41]
v_cndmask_b32 v44, v60, v5, s[34:35]
v_cndmask_b32 v45, v61, v5, s[36:37]
v_cndmask_b32 v46, v62, v5, s[38:39]
v_cndmask_b32 v47, v63, v5, s[40:41]
v_add_u32 v2, 0x10000, v2
s_waitcnt vmcnt(16) lgkmcnt(0)
s_barrier
v_mfma_f32_16x16x32_bf16 v[120:123], a[96:99], a[240:243], v[60:63]
ds_read_b128 a[64:67], v2 offset:32768
s_add_u32 m0, s22, 16384
ds_read_b128 a[192:195], v4 offset:0
ds_read_b128 a[196:199], v4 offset:1024
v_mfma_f32_16x16x32_bf16 v[120:123], a[100:103], a[244:247], v[120:123]
ds_read_b128 a[200:203], v4 offset:2048
ds_read_b128 a[204:207], v4 offset:3072
v_add_f32 v6, v24, v25
v_mov_b32 v7, v6
v_mfma_f32_16x16x32_bf16 v[120:123], a[104:107], a[248:251], v[120:123]
s_nop 0
v_permlane16_swap_b32 v6, v7
v_add_f32 v6, v6, v7
v_mov_b32 v7, v6
s_nop 1
v_permlane32_swap_b32 v6, v7
v_mfma_f32_16x16x32_bf16 v[120:123], a[108:111], a[252:255], v[120:123]
s_add_u32 s23, s20, s99
ds_read_b128 a[160:163], v3 offset:40960
ds_read_b128 a[208:211], v4 offset:4096
v_add_f32 v6, v6, v7
v_add_u32 v7, 0xde800000, v6
v_mfma_f32_16x16x32_bf16 v[124:127], a[112:115], a[240:243], v[44:47]
v_cmp_lt_u32 vcc, 0x3c000000, v7
v_rcp_f32 v6, v6
s_or_b64 s[54:55], s[54:55], vcc
v_mfma_f32_16x16x32_bf16 v[124:127], a[116:119], a[244:247], v[124:127]
v_add_f32 v8, v26, v27
v_mov_b32 v9, v8
s_nop 1
v_permlane16_swap_b32 v8, v9
v_add_f32 v8, v8, v9
v_mfma_f32_16x16x32_bf16 v[124:127], a[120:123], a[248:251], v[124:127]
v_mov_b32 v9, v8
s_nop 1
v_permlane32_swap_b32 v8, v9
v_add_f32 v8, v8, v9
v_add_u32 v9, 0xde800000, v8
v_mfma_f32_16x16x32_bf16 v[124:127], a[124:127], a[252:255], v[124:127]
v_cmp_lt_u32 vcc, 0x3c000000, v9
v_rcp_f32 v8, v8
s_or_b64 s[54:55], s[54:55], vcc
v_mfma_f32_16x16x32_bf16 v[112:115], a[96:99], a[224:227], v[36:39]
v_mov_b32 v48, v14
v_mov_b32 v49, v14
v_mov_b32 v50, v14
v_mov_b32 v51, v14
v_mfma_f32_16x16x32_bf16 v[112:115], a[100:103], a[228:231], v[112:115]
v_mov_b32 v52, v15
v_mov_b32 v53, v15
v_mov_b32 v54, v15
v_mov_b32 v55, v15
v_mfma_f32_16x16x32_bf16 v[112:115], a[104:107], a[232:235], v[112:115]
ds_read_b128 a[212:215], v4 offset:5120
ds_read_b128 a[216:219], v4 offset:6144
ds_read_b128 a[220:223], v4 offset:7168
ds_read_b128 a[80:83], v2 offset:36864
v_mfma_f32_16x16x32_bf16 v[112:115], a[108:111], a[236:239], v[112:115]
ds_read_b128 a[164:167], v3 offset:41984
ds_read_b128 a[68:71], v2 offset:33792
v_exp_f32 v120, v120
v_mfma_f32_16x16x32_bf16 v[128:131], a[128:131], v[64:67], v[128:131]
v_exp_f32 v121, v121
v_exp_f32 v122, v122
v_mfma_f32_16x16x32_bf16 v[132:135], a[132:135], v[64:67], v[132:135]
buffer_load_dwordx4 v10, s[16:19], s20 offen offset:0 sc1 lds
v_exp_f32 v123, v123
v_mfma_f32_16x16x32_bf16 v[136:139], a[136:139], v[64:67], v[136:139]
ds_read_b128 a[168:171], v3 offset:43008
ds_read_b128 a[240:243], v4 offset:12288
v_cvt_pk_bf16_f32 v92, v120, v121
v_cvt_pk_bf16_f32 v93, v122, v123
v_mfma_f32_16x16x32_bf16 v[140:143], a[140:143], v[64:67], v[140:143]
ds_read_b128 a[244:247], v4 offset:13312
ds_read_b128 a[248:251], v4 offset:14336
ds_read_b128 a[252:255], v4 offset:15360
ds_read_b128 a[84:87], v2 offset:37888
v_mfma_f32_16x16x32_bf16 v[144:147], a[144:147], v[64:67], v[144:147]
buffer_load_dwordx4 v11, s[16:19], s20 offen offset:1024 sc1 lds
v_mov_b32 v60, v17
v_mov_b32 v61, v17
v_mfma_f32_16x16x32_bf16 v[148:151], a[148:151], v[64:67], v[148:151]
v_mov_b32 v62, v17
v_mov_b32 v63, v17
v_exp_f32 v124, v124
v_mfma_f32_16x16x32_bf16 v[152:155], a[152:155], v[64:67], v[152:155]
v_exp_f32 v125, v125
v_exp_f32 v126, v126
v_mfma_f32_16x16x32_bf16 v[156:159], a[156:159], v[64:67], v[156:159]
ds_read_b128 a[172:175], v3 offset:44032
v_exp_f32 v127, v127
v_cvt_pk_bf16_f32 v94, v124, v125
v_mfma_f32_16x16x32_bf16 v[160:163], a[128:131], v[68:71], v[160:163]
ds_read_b128 a[224:227], v4 offset:8192
ds_read_b128 a[228:231], v4 offset:9216
ds_read_b128 a[232:235], v4 offset:10240
v_cvt_pk_bf16_f32 v95, v126, v127
v_mfma_f32_16x16x32_bf16 v[164:167], a[132:135], v[68:71], v[164:167]
ds_read_b128 a[236:239], v4 offset:11264
v_mov_b32 v56, v16
v_mov_b32 v57, v16
v_mov_b32 v58, v16
v_mfma_f32_16x16x32_bf16 v[168:171], a[136:139], v[68:71], v[168:171]
v_mov_b32 v59, v16
v_cndmask_b32 v36, v56, v5, s[34:35]
v_cndmask_b32 v37, v57, v5, s[36:37]
v_cndmask_b32 v38, v58, v5, s[38:39]
v_mfma_f32_16x16x32_bf16 v[172:175], a[140:143], v[68:71], v[172:175]
v_cndmask_b32 v39, v59, v5, s[40:41]
v_cndmask_b32 v44, v60, v5, s[34:35]
v_cndmask_b32 v45, v61, v5, s[36:37]
v_cndmask_b32 v46, v62, v5, s[38:39]
v_mfma_f32_16x16x32_bf16 v[176:179], a[144:147], v[68:71], v[176:179]
ds_read_b128 a[72:75], v2 offset:34816
buffer_load_dwordx4 v12, s[16:19], s20 offen offset:2048 sc1 lds
v_cndmask_b32 v47, v63, v5, s[40:41]
v_mfma_f32_16x16x32_bf16 v[180:183], a[148:151], v[68:71], v[180:183]
s_add_u32 s63, s31, 0
v_exp_f32 v112, v112
v_exp_f32 v113, v113
v_mfma_f32_16x16x32_bf16 v[184:187], a[152:155], v[68:71], v[184:187]
v_exp_f32 v114, v114
v_exp_f32 v115, v115
v_mfma_f32_16x16x32_bf16 v[188:191], a[156:159], v[68:71], v[188:191]
v_cvt_pk_bf16_f32 v88, v112, v113
v_cvt_pk_bf16_f32 v89, v114, v115
v_mov_b32 v90, 0
v_mov_b32 v91, 0
v_mfma_f32_16x16x32_bf16 v[192:195], a[128:131], v[72:75], v[192:195]
ds_read_b128 a[176:179], v3 offset:45056
ds_read_b128 a[88:91], v2 offset:38912
buffer_load_dwordx4 v13, s[16:19], s20 offen offset:3072 sc1 lds
v_mfma_f32_16x16x32_bf16 v[196:199], a[132:135], v[72:75], v[196:199]
s_add_u32 m0, s22, 20480
ds_read_b128 a[180:183], v3 offset:46080
ds_read_b128 a[76:79], v2 offset:35840
v_mul_f32 v128, v128, v6
v_mul_f32 v129, v129, v6
v_mfma_f32_16x16x32_bf16 v[200:203], a[136:139], v[72:75], v[200:203]
s_add_u32 s20, s20, s21
v_mul_f32 v130, v130, v6
v_mul_f32 v131, v131, v6
v_mul_f32 v132, v132, v6
v_mul_f32 v133, v133, v6
v_mfma_f32_16x16x32_bf16 v[204:207], a[140:143], v[72:75], v[204:207]
v_mul_f32 v134, v134, v6
v_mul_f32 v135, v135, v6
v_cvt_pk_bf16_f32 v128, v128, v129
v_cvt_pk_bf16_f32 v129, v130, v131
v_mfma_f32_16x16x32_bf16 v[28:31], a[36:39], v[72:75], v[28:31]
ds_read_b128 a[184:187], v3 offset:47104
ds_read_b128 a[92:95], v2 offset:39936
v_cvt_pk_bf16_f32 v130, v132, v133
v_cvt_pk_bf16_f32 v131, v134, v135
v_mfma_f32_16x16x32_bf16 v[208:211], a[144:147], v[72:75], v[208:211]
buffer_store_dwordx4 v[128:131], v1, s[12:15], s63 offen offset:0 sc1
v_mfma_f32_16x16x32_bf16 v[212:215], a[148:151], v[72:75], v[212:215]
ds_read_b128 a[188:191], v3 offset:48128
v_mfma_f32_16x16x32_bf16 v[20:23], a[32:35], v[128:131], v[20:23]
v_mul_f32 v136, v136, v6
v_mul_f32 v137, v137, v6
v_mfma_f32_16x16x32_bf16 v[216:219], a[152:155], v[72:75], v[216:219]
v_mul_f32 v138, v138, v6
v_mul_f32 v139, v139, v6
v_mul_f32 v140, v140, v6
v_mul_f32 v141, v141, v6
v_mfma_f32_16x16x32_bf16 v[220:223], a[156:159], v[72:75], v[220:223]
v_mul_f32 v142, v142, v6
v_mul_f32 v143, v143, v6
v_cvt_pk_bf16_f32 v136, v136, v137
v_cvt_pk_bf16_f32 v137, v138, v139
v_mfma_f32_16x16x32_bf16 v[224:227], a[128:131], v[76:79], v[224:227]
buffer_load_dwordx4 v10, s[16:19], s23 offen offset:0 sc1 lds
v_cvt_pk_bf16_f32 v138, v140, v141
v_cvt_pk_bf16_f32 v139, v142, v143
v_mfma_f32_16x16x32_bf16 v[228:231], a[132:135], v[76:79], v[228:231]
buffer_store_dwordx4 v[136:139], v1, s[12:15], s63 offen offset:1024 sc1
v_mfma_f32_16x16x32_bf16 v[232:235], a[136:139], v[76:79], v[232:235]
buffer_load_dwordx4 v11, s[16:19], s23 offen offset:1024 sc1 lds
v_mfma_f32_16x16x32_bf16 v[20:23], a[32:35], v[136:139], v[20:23]
v_mul_f32 v144, v144, v6
v_mul_f32 v145, v145, v6
v_mfma_f32_16x16x32_bf16 v[236:239], a[140:143], v[76:79], v[236:239]
v_mul_f32 v146, v146, v6
v_mul_f32 v147, v147, v6
v_mul_f32 v148, v148, v6
v_mul_f32 v149, v149, v6
v_mfma_f32_16x16x32_bf16 v[32:35], a[36:39], v[76:79], v[32:35]
v_mul_f32 v150, v150, v6
v_mul_f32 v151, v151, v6
v_cvt_pk_bf16_f32 v144, v144, v145
v_cvt_pk_bf16_f32 v145, v146, v147
v_mfma_f32_16x16x32_bf16 v[240:243], a[144:147], v[76:79], v[240:243]
buffer_load_dwordx4 v12, s[16:19], s23 offen offset:2048 sc1 lds
v_cvt_pk_bf16_f32 v146, v148, v149
v_cvt_pk_bf16_f32 v147, v150, v151
v_mfma_f32_16x16x32_bf16 v[244:247], a[148:151], v[76:79], v[244:247]
buffer_store_dwordx4 v[144:147], v1, s[12:15], s63 offen offset:2048 sc1
v_mfma_f32_16x16x32_bf16 v[248:251], a[152:155], v[76:79], v[248:251]
buffer_load_dwordx4 v13, s[16:19], s23 offen offset:3072 sc1 lds
v_mfma_f32_16x16x32_bf16 v[20:23], a[32:35], v[144:147], v[20:23]
v_mul_f32 v152, v152, v6
v_mul_f32 v153, v153, v6
v_mfma_f32_16x16x32_bf16 v[252:255], a[156:159], v[76:79], v[252:255]
v_mul_f32 v154, v154, v6
v_mul_f32 v155, v155, v6
v_mul_f32 v156, v156, v6
v_mul_f32 v157, v157, v6
v_mul_f32 v158, v158, v6
v_mul_f32 v159, v159, v6
v_cvt_pk_bf16_f32 v152, v152, v153
v_cvt_pk_bf16_f32 v153, v154, v155
v_cvt_pk_bf16_f32 v154, v156, v157
v_cvt_pk_bf16_f32 v155, v158, v159
buffer_store_dwordx4 v[152:155], v1, s[12:15], s63 offen offset:3072 sc1
s_nop 0
v_mfma_f32_16x16x32_bf16 v[20:23], a[32:35], v[152:155], v[20:23]
v_add_u32 v3, 0x10000, v3
s_waitcnt vmcnt(20) lgkmcnt(0)
s_barrier
v_mfma_f32_16x16x32_bf16 v[192:195], a[160:163], v[88:91], v[192:195]
ds_read_b128 a[96:99], v2 offset:49152
s_add_u32 m0, s22, 32768
v_mfma_f32_16x16x32_bf16 v[196:199], a[164:167], v[88:91], v[196:199]
ds_read_b128 a[128:131], v3 offset:57344
v_mfma_f32_16x16x32_bf16 v[200:203], a[168:171], v[88:91], v[200:203]
ds_read_b128 a[112:115], v2 offset:53248
s_add_u32 s23, s20, s99
v_mfma_f32_16x16x32_bf16 v[204:207], a[172:175], v[88:91], v[204:207]
ds_read_b128 a[132:135], v3 offset:58368
v_mfma_f32_16x16x32_bf16 v[28:31], a[36:39], v[88:91], v[28:31]
ds_read_b128 a[100:103], v2 offset:50176
buffer_load_dwordx4 v10, s[16:19], s20 offen offset:0 sc1 lds
v_mfma_f32_16x16x32_bf16 v[208:211], a[176:179], v[88:91], v[208:211]
ds_read_b128 a[136:139], v3 offset:59392
v_mfma_f32_16x16x32_bf16 v[212:215], a[180:183], v[88:91], v[212:215]
buffer_load_dwordx4 v11, s[16:19], s20 offen offset:1024 sc1 lds
v_mfma_f32_16x16x32_bf16 v[216:219], a[184:187], v[88:91], v[216:219]
ds_read_b128 a[116:119], v2 offset:54272
v_mfma_f32_16x16x32_bf16 v[220:223], a[188:191], v[88:91], v[220:223]
v_mov_b32 v6, v28
v_add_u32 v7, 0xde800000, v6
v_cmp_lt_u32 vcc, 0x3c000000, v7
v_rcp_f32 v6, v6
s_or_b64 s[54:55], s[54:55], vcc
ds_read_b128 a[140:143], v3 offset:60416
buffer_load_dwordx4 v12, s[16:19], s20 offen offset:2048 sc1 lds
v_mfma_f32_16x16x32_bf16 v[224:227], a[160:163], v[92:95], v[224:227]
ds_read_b128 a[104:107], v2 offset:51200
v_mfma_f32_16x16x32_bf16 v[228:231], a[164:167], v[92:95], v[228:231]
ds_read_b128 a[144:147], v3 offset:61440
buffer_load_dwordx4 v13, s[16:19], s20 offen offset:3072 sc1 lds
v_mfma_f32_16x16x32_bf16 v[232:235], a[168:171], v[92:95], v[232:235]
s_add_u32 s63, s31, 36864
v_mul_f32 v192, v192, v6
v_mul_f32 v193, v193, v6
v_mul_f32 v194, v194, v6
v_mul_f32 v195, v195, v6
v_mul_f32 v196, v196, v6
v_mul_f32 v197, v197, v6
v_mul_f32 v198, v198, v6
v_mul_f32 v199, v199, v6
v_cvt_pk_bf16_f32 v192, v192, v193
v_cvt_pk_bf16_f32 v193, v194, v195
v_mfma_f32_16x16x32_bf16 v[236:239], a[172:175], v[92:95], v[236:239]
v_cvt_pk_bf16_f32 v194, v196, v197
v_cvt_pk_bf16_f32 v195, v198, v199
buffer_store_dwordx4 v[192:195], v1, s[12:15], s63 offen offset:0 sc1
v_mfma_f32_16x16x32_bf16 v[32:35], a[36:39], v[92:95], v[32:35]
ds_read_b128 a[120:123], v2 offset:55296
ds_read_b128 a[148:151], v3 offset:62464
v_mfma_f32_16x16x32_bf16 v[20:23], a[32:35], v[192:195], v[20:23]
s_add_u32 m0, s22, 36864
v_mul_f32 v200, v200, v6
v_mul_f32 v201, v201, v6
v_mul_f32 v202, v202, v6
v_mul_f32 v203, v203, v6
v_mul_f32 v204, v204, v6
v_mul_f32 v205, v205, v6
v_mfma_f32_16x16x32_bf16 v[240:243], a[176:179], v[92:95], v[240:243]
ds_read_b128 a[108:111], v2 offset:52224
v_mul_f32 v206, v206, v6
v_mul_f32 v207, v207, v6
v_cvt_pk_bf16_f32 v200, v200, v201
v_cvt_pk_bf16_f32 v201, v202, v203
v_cvt_pk_bf16_f32 v202, v204, v205
v_cvt_pk_bf16_f32 v203, v206, v207
v_mfma_f32_16x16x32_bf16 v[244:247], a[180:183], v[92:95], v[244:247]
buffer_store_dwordx4 v[200:203], v1, s[12:15], s63 offen offset:1024 sc1
v_mfma_f32_16x16x32_bf16 v[20:23], a[32:35], v[200:203], v[20:23]
s_add_u32 s20, s20, s21
v_mul_f32 v208, v208, v6
v_mul_f32 v209, v209, v6
v_mfma_f32_16x16x32_bf16 v[248:251], a[184:187], v[92:95], v[248:251]
v_mul_f32 v210, v210, v6
v_mul_f32 v211, v211, v6
v_mul_f32 v212, v212, v6
v_mul_f32 v213, v213, v6
v_mul_f32 v214, v214, v6
v_mul_f32 v215, v215, v6
v_cvt_pk_bf16_f32 v208, v208, v209
v_cvt_pk_bf16_f32 v209, v210, v211
v_cvt_pk_bf16_f32 v210, v212, v213
v_cvt_pk_bf16_f32 v211, v214, v215
v_mfma_f32_16x16x32_bf16 v[252:255], a[188:191], v[92:95], v[252:255]
buffer_store_dwordx4 v[208:211], v1, s[12:15], s63 offen offset:2048 sc1
v_mfma_f32_16x16x32_bf16 v[20:23], a[32:35], v[208:211], v[20:23]
v_mul_f32 v216, v216, v6
v_mul_f32 v217, v217, v6
v_mfma_f32_16x16x32_bf16 v[120:123], a[64:67], a[240:243], v[60:63]
v_mul_f32 v218, v218, v6
v_mul_f32 v219, v219, v6
v_mul_f32 v220, v220, v6
v_mul_f32 v221, v221, v6
v_mul_f32 v222, v222, v6
v_mul_f32 v223, v223, v6
v_cvt_pk_bf16_f32 v216, v216, v217
v_cvt_pk_bf16_f32 v217, v218, v219
v_cvt_pk_bf16_f32 v218, v220, v221
v_cvt_pk_bf16_f32 v219, v222, v223
v_mfma_f32_16x16x32_bf16 v[120:123], a[68:71], a[244:247], v[120:123]
buffer_store_dwordx4 v[216:219], v1, s[12:15], s63 offen offset:3072 sc1
v_mfma_f32_16x16x32_bf16 v[20:23], a[32:35], v[216:219], v[20:23]
ds_read_b128 a[152:155], v3 offset:63488
ds_read_b128 a[124:127], v2 offset:56320
v_mfma_f32_16x16x32_bf16 v[120:123], a[72:75], a[248:251], v[120:123]
v_mov_b32 v6, v32
v_add_u32 v7, 0xde800000, v6
v_cmp_lt_u32 vcc, 0x3c000000, v7
v_rcp_f32 v6, v6
s_or_b64 s[54:55], s[54:55], vcc
ds_read_b128 a[156:159], v3 offset:64512
buffer_load_dwordx4 v10, s[16:19], s23 offen offset:0 sc1 lds
s_add_u32 s63, s31, 55296
v_mfma_f32_16x16x32_bf16 v[120:123], a[76:79], a[252:255], v[120:123]
buffer_load_dwordx4 v11, s[16:19], s23 offen offset:1024 sc1 lds
v_mul_f32 v224, v224, v6
v_mul_f32 v225, v225, v6
v_mul_f32 v226, v226, v6
v_mul_f32 v227, v227, v6
v_mul_f32 v228, v228, v6
v_mul_f32 v229, v229, v6
v_mul_f32 v230, v230, v6
v_mul_f32 v231, v231, v6
v_mfma_f32_16x16x32_bf16 v[124:127], a[80:83], a[240:243], v[44:47]
buffer_load_dwordx4 v12, s[16:19], s23 offen offset:2048 sc1 lds
v_cvt_pk_bf16_f32 v224, v224, v225
v_cvt_pk_bf16_f32 v225, v226, v227
v_cvt_pk_bf16_f32 v226, v228, v229
v_cvt_pk_bf16_f32 v227, v230, v231
v_mfma_f32_16x16x32_bf16 v[124:127], a[84:87], a[244:247], v[124:127]
buffer_store_dwordx4 v[224:227], v1, s[12:15], s63 offen offset:0 sc1
v_mfma_f32_16x16x32_bf16 v[20:23], a[32:35], v[224:227], v[20:23]
v_mul_f32 v232, v232, v6
v_mul_f32 v233, v233, v6
v_mfma_f32_16x16x32_bf16 v[124:127], a[88:91], a[248:251], v[124:127]
v_mul_f32 v234, v234, v6
v_mul_f32 v235, v235, v6
v_mul_f32 v236, v236, v6
v_mul_f32 v237, v237, v6
v_mul_f32 v238, v238, v6
v_mul_f32 v239, v239, v6
v_cvt_pk_bf16_f32 v232, v232, v233
v_cvt_pk_bf16_f32 v233, v234, v235
v_cvt_pk_bf16_f32 v234, v236, v237
v_cvt_pk_bf16_f32 v235, v238, v239
v_mfma_f32_16x16x32_bf16 v[124:127], a[92:95], a[252:255], v[124:127]
buffer_store_dwordx4 v[232:235], v1, s[12:15], s63 offen offset:1024 sc1
v_mfma_f32_16x16x32_bf16 v[20:23], a[32:35], v[232:235], v[20:23]
v_mul_f32 v240, v240, v6
v_mul_f32 v241, v241, v6
v_mfma_f32_16x16x32_bf16 v[112:115], a[64:67], a[224:227], v[36:39]
v_mul_f32 v242, v242, v6
v_mul_f32 v243, v243, v6
v_mul_f32 v244, v244, v6
v_mul_f32 v245, v245, v6
v_mul_f32 v246, v246, v6
v_mul_f32 v247, v247, v6
v_cvt_pk_bf16_f32 v240, v240, v241
v_cvt_pk_bf16_f32 v241, v242, v243
v_cvt_pk_bf16_f32 v242, v244, v245
v_cvt_pk_bf16_f32 v243, v246, v247
v_mfma_f32_16x16x32_bf16 v[112:115], a[68:71], a[228:231], v[112:115]
buffer_store_dwordx4 v[240:243], v1, s[12:15], s63 offen offset:2048 sc1
v_mfma_f32_16x16x32_bf16 v[20:23], a[32:35], v[240:243], v[20:23]
v_mul_f32 v248, v248, v6
v_mul_f32 v249, v249, v6
v_mfma_f32_16x16x32_bf16 v[112:115], a[72:75], a[232:235], v[112:115]
v_mul_f32 v250, v250, v6
v_mul_f32 v251, v251, v6
v_mul_f32 v252, v252, v6
v_mul_f32 v253, v253, v6
v_mul_f32 v254, v254, v6
v_mul_f32 v255, v255, v6
v_cvt_pk_bf16_f32 v248, v248, v249
v_cvt_pk_bf16_f32 v249, v250, v251
v_cvt_pk_bf16_f32 v250, v252, v253
v_cvt_pk_bf16_f32 v251, v254, v255
v_mfma_f32_16x16x32_bf16 v[112:115], a[76:79], a[236:239], v[112:115]
buffer_load_dwordx4 v13, s[16:19], s23 offen offset:3072 sc1 lds
v_exp_f32 v120, v120
v_cndmask_b32 v36, v48, v5, s[34:35]
buffer_store_dwordx4 v[248:251], v1, s[12:15], s63 offen offset:3072 sc1
v_exp_f32 v121, v121
s_nop 0
v_cvt_pk_bf16_f32 v76, v120, v121
v_cndmask_b32 v37, v49, v5, s[36:37]
v_mfma_f32_16x16x32_bf16 v[20:23], a[32:35], v[248:251], v[20:23]
v_exp_f32 v122, v122
v_cndmask_b32 v38, v50, v5, s[38:39]
v_exp_f32 v123, v123
s_nop 0
v_cvt_pk_bf16_f32 v77, v122, v123
v_cndmask_b32 v39, v51, v5, s[40:41]
v_exp_f32 v124, v124
v_cndmask_b32 v44, v52, v5, s[34:35]
v_exp_f32 v125, v125
s_nop 0
v_cvt_pk_bf16_f32 v78, v124, v125
v_cndmask_b32 v45, v53, v5, s[36:37]
v_exp_f32 v126, v126
v_cndmask_b32 v46, v54, v5, s[38:39]
v_exp_f32 v127, v127
s_nop 0
v_cvt_pk_bf16_f32 v79, v126, v127
v_cndmask_b32 v47, v55, v5, s[40:41]
v_exp_f32 v112, v112
v_exp_f32 v113, v113
s_nop 0
v_cvt_pk_bf16_f32 v72, v112, v113
v_exp_f32 v114, v114
v_exp_f32 v115, v115
s_nop 0
v_cvt_pk_bf16_f32 v73, v114, v115
v_mov_b32 v74, 0
v_mov_b32 v75, 0
s_cmp_eq_u32 s25, 7
s_cbranch_scc1 L_k2_tail2x
s_waitcnt vmcnt(28) lgkmcnt(0)
s_barrier
v_mfma_f32_16x16x32_bf16 v[96:99], a[96:99], a[192:195], v[36:39]
s_add_u32 s63, s31, 18432
ds_read_b128 a[64:67], v2 offset:0
s_add_u32 m0, s22, 49152
v_mul_f32 v160, v160, v8
v_mul_f32 v161, v161, v8
v_mfma_f32_16x16x32_bf16 v[96:99], a[100:103], a[196:199], v[96:99]
v_mul_f32 v162, v162, v8
v_mul_f32 v163, v163, v8
v_mul_f32 v164, v164, v8
v_mul_f32 v165, v165, v8
v_mul_f32 v166, v166, v8
v_mfma_f32_16x16x32_bf16 v[96:99], a[104:107], a[200:203], v[96:99]
v_mul_f32 v167, v167, v8
v_cvt_pk_bf16_f32 v160, v160, v161
v_cvt_pk_bf16_f32 v161, v162, v163
v_cvt_pk_bf16_f32 v162, v164, v165
v_mfma_f32_16x16x32_bf16 v[96:99], a[108:111], a[204:207], v[96:99]
s_add_u32 s23, s20, s99
ds_read_b128 a[160:163], v3 offset:8192
ds_read_b128 a[80:83], v2 offset:4096
v_cvt_pk_bf16_f32 v163, v166, v167
v_mfma_f32_16x16x32_bf16 v[104:107], a[96:99], a[208:211], v[52:55]
buffer_store_dwordx4 v[160:163], v1, s[12:15], s63 offen offset:0 sc1
v_mfma_f32_16x16x32_bf16 v[104:107], a[100:103], a[212:215], v[104:107]
ds_read_b128 a[164:167], v3 offset:9216
v_mfma_f32_16x16x32_bf16 v[20:23], a[32:35], v[160:163], v[20:23]
v_mul_f32 v168, v168, v8
v_mul_f32 v169, v169, v8
v_mfma_f32_16x16x32_bf16 v[104:107], a[104:107], a[216:219], v[104:107]
v_mul_f32 v170, v170, v8
v_mul_f32 v171, v171, v8
v_mul_f32 v172, v172, v8
v_mul_f32 v173, v173, v8
v_mfma_f32_16x16x32_bf16 v[104:107], a[108:111], a[220:223], v[104:107]
v_mul_f32 v174, v174, v8
v_mul_f32 v175, v175, v8
v_cvt_pk_bf16_f32 v168, v168, v169
v_cvt_pk_bf16_f32 v169, v170, v171
v_cvt_pk_bf16_f32 v170, v172, v173
v_mfma_f32_16x16x32_bf16 v[108:111], a[112:115], a[208:211], v[44:47]
ds_read_b128 a[68:71], v2 offset:1024
v_cvt_pk_bf16_f32 v171, v174, v175
v_exp_f32 v96, v96
v_mfma_f32_16x16x32_bf16 v[108:111], a[116:119], a[212:215], v[108:111]
buffer_store_dwordx4 v[168:171], v1, s[12:15], s63 offen offset:1024 sc1
v_mfma_f32_16x16x32_bf16 v[108:111], a[120:123], a[216:219], v[108:111]
v_exp_f32 v97, v97
v_mfma_f32_16x16x32_bf16 v[20:23], a[32:35], v[168:171], v[20:23]
v_mul_f32 v176, v176, v8
v_mul_f32 v177, v177, v8
v_mfma_f32_16x16x32_bf16 v[108:111], a[124:127], a[220:223], v[108:111]
v_mul_f32 v178, v178, v8
v_mul_f32 v179, v179, v8
v_mul_f32 v180, v180, v8
v_mul_f32 v181, v181, v8
v_mul_f32 v182, v182, v8
v_mfma_f32_16x16x32_bf16 v[112:115], a[96:99], a[224:227], v[56:59]
v_mul_f32 v183, v183, v8
v_cvt_pk_bf16_f32 v176, v176, v177
v_cvt_pk_bf16_f32 v177, v178, v179
v_cvt_pk_bf16_f32 v178, v180, v181
v_mfma_f32_16x16x32_bf16 v[112:115], a[100:103], a[228:231], v[112:115]
v_cvt_pk_bf16_f32 v179, v182, v183
v_exp_f32 v98, v98
v_exp_f32 v99, v99
v_mfma_f32_16x16x32_bf16 v[112:115], a[104:107], a[232:235], v[112:115]
buffer_store_dwordx4 v[176:179], v1, s[12:15], s63 offen offset:2048 sc1
v_mfma_f32_16x16x32_bf16 v[112:115], a[108:111], a[236:239], v[112:115]
buffer_load_dwordx4 v10, s[16:19], s20 offen offset:0 sc1 lds
v_mfma_f32_16x16x32_bf16 v[20:23], a[32:35], v[176:179], v[20:23]
v_mul_f32 v184, v184, v8
v_mul_f32 v185, v185, v8
v_mfma_f32_16x16x32_bf16 v[116:119], a[112:115], a[224:227], v[56:59]
v_mul_f32 v186, v186, v8
v_mul_f32 v187, v187, v8
v_mul_f32 v188, v188, v8
v_mul_f32 v189, v189, v8
v_mfma_f32_16x16x32_bf16 v[116:119], a[116:119], a[228:231], v[116:119]
v_mul_f32 v190, v190, v8
v_mul_f32 v191, v191, v8
v_cvt_pk_bf16_f32 v184, v184, v185
v_cvt_pk_bf16_f32 v185, v186, v187
v_cvt_pk_bf16_f32 v186, v188, v189
v_mfma_f32_16x16x32_bf16 v[116:119], a[120:123], a[232:235], v[116:119]
v_cvt_pk_bf16_f32 v187, v190, v191
v_cvt_pk_bf16_f32 v80, v96, v97
v_cvt_pk_bf16_f32 v81, v98, v99
v_mov_b32 v82, 0
v_mfma_f32_16x16x32_bf16 v[116:119], a[124:127], a[236:239], v[116:119]
ds_read_b128 a[168:171], v3 offset:10240
ds_read_b128 a[84:87], v2 offset:5120
buffer_load_dwordx4 v11, s[16:19], s20 offen offset:1024 sc1 lds
v_mov_b32 v83, 0
v_mfma_f32_16x16x32_bf16 v[120:123], a[96:99], a[240:243], v[60:63]
buffer_store_dwordx4 v[184:187], v1, s[12:15], s63 offen offset:3072 sc1
v_mfma_f32_16x16x32_bf16 v[120:123], a[100:103], a[244:247], v[120:123]
v_add_f32 v24, v96, v98
v_add_f32 v25, v97, v99
v_mfma_f32_16x16x32_bf16 v[20:23], a[32:35], v[184:187], v[20:23]
v_exp_f32 v104, v104
v_mfma_f32_16x16x32_bf16 v[120:123], a[104:107], a[248:251], v[120:123]
v_exp_f32 v105, v105
v_exp_f32 v106, v106
v_mfma_f32_16x16x32_bf16 v[120:123], a[108:111], a[252:255], v[120:123]
ds_read_b128 a[172:175], v3 offset:11264
ds_read_b128 a[72:75], v2 offset:2048
v_exp_f32 v107, v107
v_cvt_pk_bf16_f32 v84, v104, v105
v_mfma_f32_16x16x32_bf16 v[124:127], a[112:115], a[240:243], v[60:63]
buffer_load_dwordx4 v12, s[16:19], s20 offen offset:2048 sc1 lds
v_cvt_pk_bf16_f32 v85, v106, v107
v_add_f32 v26, v104, v106
v_mfma_f32_16x16x32_bf16 v[124:127], a[116:119], a[244:247], v[124:127]
v_exp_f32 v108, v108
v_exp_f32 v109, v109
v_add_f32 v27, v105, v107
v_mfma_f32_16x16x32_bf16 v[124:127], a[120:123], a[248:251], v[124:127]
v_exp_f32 v110, v110
v_exp_f32 v111, v111
v_mfma_f32_16x16x32_bf16 v[124:127], a[124:127], a[252:255], v[124:127]
ds_read_b128 a[176:179], v3 offset:12288
v_cvt_pk_bf16_f32 v86, v108, v109
v_cvt_pk_bf16_f32 v87, v110, v111
v_mov_b32 v36, v48
v_mov_b32 v37, v48
v_mfma_f32_16x16x32_bf16 v[192:195], a[128:131], v[72:75], 0
v_mov_b32 v38, v48
v_mov_b32 v39, v48
v_mov_b32 v40, v48
v_mov_b32 v41, v48
v_mfma_f32_16x16x32_bf16 v[196:199], a[132:135], v[72:75], 0
v_mov_b32 v42, v48
v_mov_b32 v43, v48
v_mov_b32 v44, v52
v_mov_b32 v45, v52
v_mov_b32 v46, v52
v_mfma_f32_16x16x32_bf16 v[200:203], a[136:139], v[72:75], 0
ds_read_b128 a[88:91], v2 offset:6144
buffer_load_dwordx4 v13, s[16:19], s20 offen offset:3072 sc1 lds
v_mov_b32 v47, v52
v_mfma_f32_16x16x32_bf16 v[204:207], a[140:143], v[72:75], 0
s_add_u32 m0, s22, 53248
v_exp_f32 v112, v112
v_exp_f32 v113, v113
v_add_f32 v26, v26, v108
v_mfma_f32_16x16x32_bf16 v[28:31], a[36:39], v[72:75], 0
s_add_u32 s20, s20, s21
v_exp_f32 v114, v114
v_exp_f32 v115, v115
v_mfma_f32_16x16x32_bf16 v[208:211], a[144:147], v[72:75], 0
ds_read_b128 a[180:183], v3 offset:13312
v_add_f32 v27, v27, v109
v_add_f32 v26, v26, v110
v_add_f32 v27, v27, v111
v_cvt_pk_bf16_f32 v88, v112, v113
v_mfma_f32_16x16x32_bf16 v[212:215], a[148:151], v[72:75], 0
ds_read_b128 a[76:79], v2 offset:3072
v_cvt_pk_bf16_f32 v89, v114, v115
v_exp_f32 v116, v116
v_mfma_f32_16x16x32_bf16 v[216:219], a[152:155], v[72:75], 0
ds_read_b128 a[184:187], v3 offset:14336
v_exp_f32 v117, v117
v_exp_f32 v118, v118
v_mfma_f32_16x16x32_bf16 v[220:223], a[156:159], v[72:75], 0
ds_read_b128 a[92:95], v2 offset:7168
v_exp_f32 v119, v119
v_cvt_pk_bf16_f32 v90, v116, v117
v_mfma_f32_16x16x32_bf16 v[224:227], a[128:131], v[76:79], 0
ds_read_b128 a[188:191], v3 offset:15360
v_cvt_pk_bf16_f32 v91, v118, v119
v_exp_f32 v120, v120
v_mfma_f32_16x16x32_bf16 v[228:231], a[132:135], v[76:79], 0
v_exp_f32 v121, v121
v_exp_f32 v122, v122
v_mfma_f32_16x16x32_bf16 v[232:235], a[136:139], v[76:79], 0
buffer_load_dwordx4 v10, s[16:19], s23 offen offset:0 sc1 lds
v_exp_f32 v123, v123
v_cvt_pk_bf16_f32 v92, v120, v121
v_mfma_f32_16x16x32_bf16 v[236:239], a[140:143], v[76:79], 0
v_cvt_pk_bf16_f32 v93, v122, v123
v_exp_f32 v124, v124
v_mfma_f32_16x16x32_bf16 v[32:35], a[36:39], v[76:79], 0
v_exp_f32 v125, v125
v_exp_f32 v126, v126
v_mfma_f32_16x16x32_bf16 v[240:243], a[144:147], v[76:79], 0
buffer_load_dwordx4 v11, s[16:19], s23 offen offset:1024 sc1 lds
v_exp_f32 v127, v127
v_mfma_f32_16x16x32_bf16 v[244:247], a[148:151], v[76:79], 0
buffer_load_dwordx4 v12, s[16:19], s23 offen offset:2048 sc1 lds
v_cvt_pk_bf16_f32 v94, v124, v125
v_cvt_pk_bf16_f32 v95, v126, v127
v_mfma_f32_16x16x32_bf16 v[248:251], a[152:155], v[76:79], 0
buffer_load_dwordx4 v13, s[16:19], s23 offen offset:3072 sc1 lds
v_mfma_f32_16x16x32_bf16 v[252:255], a[156:159], v[76:79], 0
s_cmp_eq_u32 s20, s98
s_cbranch_scc1 L_k2_sw
L_k2_swr3:
s_waitcnt vmcnt(29) lgkmcnt(0)
s_barrier
v_mfma_f32_16x16x32_bf16 v[96:99], a[64:67], a[192:195], v[48:51]
s_add_u32 m0, s22, 0
ds_read_b128 a[96:99], v2 offset:16384
ds_read_b128 a[128:131], v3 offset:24576
v_mfma_f32_16x16x32_bf16 v[96:99], a[68:71], a[196:199], v[96:99]
s_add_u32 s23, s20, s99
v_mfma_f32_16x16x32_bf16 v[96:99], a[72:75], a[200:203], v[96:99]
buffer_load_dwordx4 v10, s[16:19], s20 offen offset:0 sc1 lds
v_mfma_f32_16x16x32_bf16 v[96:99], a[76:79], a[204:207], v[96:99]
ds_read_b128 a[112:115], v2 offset:20480
ds_read_b128 a[132:135], v3 offset:25600
v_mfma_f32_16x16x32_bf16 v[100:103], a[80:83], a[192:195], v[48:51]
buffer_load_dwordx4 v11, s[16:19], s20 offen offset:1024 sc1 lds
v_mfma_f32_16x16x32_bf16 v[100:103], a[84:87], a[196:199], v[100:103]
ds_read_b128 a[100:103], v2 offset:17408
ds_read_b128 a[136:139], v3 offset:26624
v_mfma_f32_16x16x32_bf16 v[100:103], a[88:91], a[200:203], v[100:103]
buffer_load_dwordx4 v12, s[16:19], s20 offen offset:2048 sc1 lds
v_mfma_f32_16x16x32_bf16 v[100:103], a[92:95], a[204:207], v[100:103]
ds_read_b128 a[116:119], v2 offset:21504
ds_read_b128 a[140:143], v3 offset:27648
v_mfma_f32_16x16x32_bf16 v[104:107], a[64:67], a[208:211], v[52:55]
v_exp_f32 v96, v96
v_mfma_f32_16x16x32_bf16 v[104:107], a[68:71], a[212:215], v[104:107]
v_exp_f32 v97, v97
v_mfma_f32_16x16x32_bf16 v[104:107], a[72:75], a[216:219], v[104:107]
v_exp_f32 v98, v98
v_mfma_f32_16x16x32_bf16 v[104:107], a[76:79], a[220:223], v[104:107]
v_exp_f32 v99, v99
v_mfma_f32_16x16x32_bf16 v[108:111], a[80:83], a[208:211], v[52:55]
buffer_load_dwordx4 v13, s[16:19], s20 offen offset:3072 sc1 lds
v_mfma_f32_16x16x32_bf16 v[108:111], a[84:87], a[212:215], v[108:111]
s_add_u32 m0, s22, 4096
s_add_u32 s20, s20, s21
v_cvt_pk_bf16_f32 v64, v96, v97
v_mfma_f32_16x16x32_bf16 v[108:111], a[88:91], a[216:219], v[108:111]
ds_read_b128 a[104:107], v2 offset:18432
v_cvt_pk_bf16_f32 v65, v98, v99
v_mfma_f32_16x16x32_bf16 v[108:111], a[92:95], a[220:223], v[108:111]
ds_read_b128 a[144:147], v3 offset:28672
v_add_f32 v24, v24, v96
v_mfma_f32_16x16x32_bf16 v[128:131], a[160:163], v[80:83], 0
buffer_load_dwordx4 v10, s[16:19], s23 offen offset:0 sc1 lds
v_mfma_f32_16x16x32_bf16 v[132:135], a[164:167], v[80:83], 0
v_exp_f32 v100, v100
v_mfma_f32_16x16x32_bf16 v[136:139], a[168:171], v[80:83], 0
v_exp_f32 v101, v101
v_mfma_f32_16x16x32_bf16 v[140:143], a[172:175], v[80:83], 0
v_exp_f32 v102, v102
v_add_f32 v25, v25, v97
v_mfma_f32_16x16x32_bf16 v[144:147], a[176:179], v[80:83], 0
v_exp_f32 v103, v103
v_mfma_f32_16x16x32_bf16 v[148:151], a[180:183], v[80:83], 0
v_add_f32 v24, v24, v98
v_add_f32 v25, v25, v99
v_mfma_f32_16x16x32_bf16 v[152:155], a[184:187], v[80:83], 0
v_cvt_pk_bf16_f32 v66, v100, v101
v_cvt_pk_bf16_f32 v67, v102, v103
v_mfma_f32_16x16x32_bf16 v[156:159], a[188:191], v[80:83], 0
ds_read_b128 a[120:123], v2 offset:22528
v_add_f32 v24, v24, v100
v_mfma_f32_16x16x32_bf16 v[112:115], a[64:67], a[224:227], v[56:59]
v_exp_f32 v104, v104
v_mfma_f32_16x16x32_bf16 v[112:115], a[68:71], a[228:231], v[112:115]
v_exp_f32 v105, v105
v_mfma_f32_16x16x32_bf16 v[112:115], a[72:75], a[232:235], v[112:115]
v_exp_f32 v106, v106
v_mfma_f32_16x16x32_bf16 v[112:115], a[76:79], a[236:239], v[112:115]
v_exp_f32 v107, v107
v_mfma_f32_16x16x32_bf16 v[116:119], a[80:83], a[224:227], v[56:59]
v_add_f32 v25, v25, v101
v_add_f32 v24, v24, v102
v_mfma_f32_16x16x32_bf16 v[116:119], a[84:87], a[228:231], v[116:119]
v_add_f32 v25, v25, v103
v_cvt_pk_bf16_f32 v68, v104, v105
v_mfma_f32_16x16x32_bf16 v[116:119], a[88:91], a[232:235], v[116:119]
v_cvt_pk_bf16_f32 v69, v106, v107
v_add_f32 v26, v26, v104
v_mfma_f32_16x16x32_bf16 v[116:119], a[92:95], a[236:239], v[116:119]
v_exp_f32 v108, v108
v_mfma_f32_16x16x32_bf16 v[160:163], a[160:163], v[84:87], 0
v_exp_f32 v109, v109
v_mfma_f32_16x16x32_bf16 v[164:167], a[164:167], v[84:87], 0
v_exp_f32 v110, v110
v_mfma_f32_16x16x32_bf16 v[168:171], a[168:171], v[84:87], 0
v_exp_f32 v111, v111
v_mfma_f32_16x16x32_bf16 v[172:175], a[172:175], v[84:87], 0
v_add_f32 v27, v27, v105
v_add_f32 v26, v26, v106
v_mfma_f32_16x16x32_bf16 v[176:179], a[176:179], v[84:87], 0
v_add_f32 v27, v27, v107
v_cvt_pk_bf16_f32 v70, v108, v109
v_mfma_f32_16x16x32_bf16 v[180:183], a[180:183], v[84:87], 0
ds_read_b128 a[148:151], v3 offset:29696
v_cvt_pk_bf16_f32 v71, v110, v111
v_mfma_f32_16x16x32_bf16 v[184:187], a[184:187], v[84:87], 0
v_add_f32 v26, v26, v108
v_add_f32 v27, v27, v109
v_mfma_f32_16x16x32_bf16 v[188:191], a[188:191], v[84:87], 0
ds_read_b128 a[108:111], v2 offset:19456
v_add_f32 v26, v26, v110
v_add_f32 v27, v27, v111
v_mfma_f32_16x16x32_bf16 v[120:123], a[64:67], a[240:243], v[60:63]
buffer_load_dwordx4 v11, s[16:19], s23 offen offset:1024 sc1 lds
v_mfma_f32_16x16x32_bf16 v[120:123], a[68:71], a[244:247], v[120:123]
v_exp_f32 v112, v112
v_mfma_f32_16x16x32_bf16 v[120:123], a[72:75], a[248:251], v[120:123]
v_exp_f32 v113, v113
v_mfma_f32_16x16x32_bf16 v[120:123], a[76:79], a[252:255], v[120:123]
v_exp_f32 v114, v114
v_mfma_f32_16x16x32_bf16 v[124:127], a[80:83], a[240:243], v[60:63]
v_exp_f32 v115, v115
v_mfma_f32_16x16x32_bf16 v[124:127], a[84:87], a[244:247], v[124:127]
v_cvt_pk_bf16_f32 v72, v112, v113
v_cvt_pk_bf16_f32 v73, v114, v115
v_mfma_f32_16x16x32_bf16 v[124:127], a[88:91], a[248:251], v[124:127]
ds_read_b128 a[152:155], v3 offset:30720
ds_read_b128 a[124:127], v2 offset:23552
v_mfma_f32_16x16x32_bf16 v[124:127], a[92:95], a[252:255], v[124:127]
v_exp_f32 v116, v116
v_mfma_f32_16x16x32_bf16 v[192:195], a[160:163], v[88:91], v[192:195]
v_exp_f32 v117, v117
v_mfma_f32_16x16x32_bf16 v[196:199], a[164:167], v[88:91], v[196:199]
v_exp_f32 v118, v118
v_mfma_f32_16x16x32_bf16 v[200:203], a[168:171], v[88:91], v[200:203]
v_exp_f32 v119, v119
v_mfma_f32_16x16x32_bf16 v[204:207], a[172:175], v[88:91], v[204:207]
v_cvt_pk_bf16_f32 v74, v116, v117
v_cvt_pk_bf16_f32 v75, v118, v119
v_mfma_f32_16x16x32_bf16 v[28:31], a[36:39], v[88:91], v[28:31]
buffer_load_dwordx4 v12, s[16:19], s23 offen offset:2048 sc1 lds
v_mfma_f32_16x16x32_bf16 v[208:211], a[176:179], v[88:91], v[208:211]
ds_read_b128 a[156:159], v3 offset:31744
v_mfma_f32_16x16x32_bf16 v[212:215], a[180:183], v[88:91], v[212:215]
v_exp_f32 v120, v120
v_mfma_f32_16x16x32_bf16 v[216:219], a[184:187], v[88:91], v[216:219]
v_exp_f32 v121, v121
v_mfma_f32_16x16x32_bf16 v[220:223], a[188:191], v[88:91], v[220:223]
v_exp_f32 v122, v122
v_mfma_f32_16x16x32_bf16 v[224:227], a[160:163], v[92:95], v[224:227]
v_exp_f32 v123, v123
v_mfma_f32_16x16x32_bf16 v[228:231], a[164:167], v[92:95], v[228:231]
v_cvt_pk_bf16_f32 v76, v120, v121
v_cvt_pk_bf16_f32 v77, v122, v123
v_mfma_f32_16x16x32_bf16 v[232:235], a[168:171], v[92:95], v[232:235]
v_exp_f32 v124, v124
v_mfma_f32_16x16x32_bf16 v[236:239], a[172:175], v[92:95], v[236:239]
v_exp_f32 v125, v125
v_mfma_f32_16x16x32_bf16 v[32:35], a[36:39], v[92:95], v[32:35]
v_exp_f32 v126, v126
v_mfma_f32_16x16x32_bf16 v[240:243], a[176:179], v[92:95], v[240:243]
v_exp_f32 v127, v127
v_mfma_f32_16x16x32_bf16 v[244:247], a[180:183], v[92:95], v[244:247]
v_cvt_pk_bf16_f32 v78, v124, v125
v_cvt_pk_bf16_f32 v79, v126, v127
v_mfma_f32_16x16x32_bf16 v[248:251], a[184:187], v[92:95], v[248:251]
buffer_load_dwordx4 v13, s[16:19], s23 offen offset:3072 sc1 lds
v_mfma_f32_16x16x32_bf16 v[252:255], a[188:191], v[92:95], v[252:255]
s_waitcnt vmcnt(21) lgkmcnt(0)
s_barrier
v_mfma_f32_16x16x32_bf16 v[96:99], a[96:99], a[192:195], v[48:51]
s_add_u32 m0, s22, 16384
ds_read_b128 a[64:67], v2 offset:32768
ds_read_b128 a[160:163], v3 offset:40960
v_mfma_f32_16x16x32_bf16 v[96:99], a[100:103], a[196:199], v[96:99]
s_add_u32 s23, s20, s99
v_mfma_f32_16x16x32_bf16 v[96:99], a[104:107], a[200:203], v[96:99]
buffer_load_dwordx4 v10, s[16:19], s20 offen offset:0 sc1 lds
v_mfma_f32_16x16x32_bf16 v[96:99], a[108:111], a[204:207], v[96:99]
ds_read_b128 a[80:83], v2 offset:36864
ds_read_b128 a[164:167], v3 offset:41984
v_mfma_f32_16x16x32_bf16 v[100:103], a[112:115], a[192:195], v[48:51]
buffer_load_dwordx4 v11, s[16:19], s20 offen offset:1024 sc1 lds
v_mfma_f32_16x16x32_bf16 v[100:103], a[116:119], a[196:199], v[100:103]
ds_read_b128 a[68:71], v2 offset:33792
ds_read_b128 a[168:171], v3 offset:43008
v_mfma_f32_16x16x32_bf16 v[100:103], a[120:123], a[200:203], v[100:103]
buffer_load_dwordx4 v12, s[16:19], s20 offen offset:2048 sc1 lds
v_mfma_f32_16x16x32_bf16 v[100:103], a[124:127], a[204:207], v[100:103]
ds_read_b128 a[84:87], v2 offset:37888
ds_read_b128 a[172:175], v3 offset:44032
v_mfma_f32_16x16x32_bf16 v[104:107], a[96:99], a[208:211], v[52:55]
v_exp_f32 v96, v96
v_mfma_f32_16x16x32_bf16 v[104:107], a[100:103], a[212:215], v[104:107]
v_exp_f32 v97, v97
v_mfma_f32_16x16x32_bf16 v[104:107], a[104:107], a[216:219], v[104:107]
s_waitcnt vmcnt(17)
v_exp_f32 v98, v98
v_mfma_f32_16x16x32_bf16 v[104:107], a[108:111], a[220:223], v[104:107]
v_exp_f32 v99, v99
v_mfma_f32_16x16x32_bf16 v[108:111], a[112:115], a[208:211], v[52:55]
buffer_load_dwordx4 v13, s[16:19], s20 offen offset:3072 sc1 lds
v_mfma_f32_16x16x32_bf16 v[108:111], a[116:119], a[212:215], v[108:111]
s_add_u32 m0, s22, 20480
s_add_u32 s20, s20, s21
v_cvt_pk_bf16_f32 v80, v96, v97
v_mfma_f32_16x16x32_bf16 v[108:111], a[120:123], a[216:219], v[108:111]
ds_read_b128 a[72:75], v2 offset:34816
v_cvt_pk_bf16_f32 v81, v98, v99
v_mfma_f32_16x16x32_bf16 v[108:111], a[124:127], a[220:223], v[108:111]
ds_read_b128 a[176:179], v3 offset:45056
v_cmp_u_f32 s[84:85], v20, v20
v_mfma_f32_16x16x32_bf16 v[128:131], a[128:131], v[64:67], v[128:131]
buffer_load_dwordx4 v10, s[16:19], s23 offen offset:0 sc1 lds
v_mfma_f32_16x16x32_bf16 v[132:135], a[132:135], v[64:67], v[132:135]
s_or_b64 s[54:55], s[54:55], s[84:85]
v_exp_f32 v100, v100
v_mfma_f32_16x16x32_bf16 v[136:139], a[136:139], v[64:67], v[136:139]
s_cmp_eq_u64 s[54:55], 0
s_cselect_b64 s[84:85], 1, 0
s_mov_b64 exec, s[84:85]
buffer_store_dword a41, off, s[12:15], s86 offset:0 sc1
s_mov_b64 exec, -1
v_mfma_f32_16x16x32_bf16 v[140:143], a[140:143], v[64:67], v[140:143]
v_exp_f32 v101, v101
v_add_f32 v24, v24, v96
v_mfma_f32_16x16x32_bf16 v[144:147], a[144:147], v[64:67], v[144:147]
v_exp_f32 v102, v102
v_mfma_f32_16x16x32_bf16 v[148:151], a[148:151], v[64:67], v[148:151]
v_exp_f32 v103, v103
v_mfma_f32_16x16x32_bf16 v[152:155], a[152:155], v[64:67], v[152:155]
v_add_f32 v25, v25, v97
v_add_f32 v24, v24, v98
v_mfma_f32_16x16x32_bf16 v[156:159], a[156:159], v[64:67], v[156:159]
v_add_f32 v25, v25, v99
v_cvt_pk_bf16_f32 v82, v100, v101
v_mfma_f32_16x16x32_bf16 v[112:115], a[96:99], a[224:227], v[56:59]
ds_read_b128 a[88:91], v2 offset:38912
v_cvt_pk_bf16_f32 v83, v102, v103
v_mfma_f32_16x16x32_bf16 v[112:115], a[100:103], a[228:231], v[112:115]
v_exp_f32 v104, v104
v_mfma_f32_16x16x32_bf16 v[112:115], a[104:107], a[232:235], v[112:115]
v_exp_f32 v105, v105
v_mfma_f32_16x16x32_bf16 v[112:115], a[108:111], a[236:239], v[112:115]
v_exp_f32 v106, v106
v_mfma_f32_16x16x32_bf16 v[116:119], a[112:115], a[224:227], v[56:59]
v_exp_f32 v107, v107
v_mfma_f32_16x16x32_bf16 v[116:119], a[116:119], a[228:231], v[116:119]
v_add_f32 v24, v24, v100
v_add_f32 v25, v25, v101
v_mfma_f32_16x16x32_bf16 v[116:119], a[120:123], a[232:235], v[116:119]
v_add_f32 v24, v24, v102
v_add_f32 v25, v25, v103
v_mfma_f32_16x16x32_bf16 v[116:119], a[124:127], a[236:239], v[116:119]
v_cvt_pk_bf16_f32 v84, v104, v105
v_cvt_pk_bf16_f32 v85, v106, v107
v_mfma_f32_16x16x32_bf16 v[160:163], a[128:131], v[68:71], v[160:163]
v_exp_f32 v108, v108
v_mfma_f32_16x16x32_bf16 v[164:167], a[132:135], v[68:71], v[164:167]
v_exp_f32 v109, v109
v_mfma_f32_16x16x32_bf16 v[168:171], a[136:139], v[68:71], v[168:171]
v_exp_f32 v110, v110
v_mfma_f32_16x16x32_bf16 v[172:175], a[140:143], v[68:71], v[172:175]
v_exp_f32 v111, v111
v_mfma_f32_16x16x32_bf16 v[176:179], a[144:147], v[68:71], v[176:179]
v_add_f32 v26, v26, v104
v_add_f32 v27, v27, v105
v_mfma_f32_16x16x32_bf16 v[180:183], a[148:151], v[68:71], v[180:183]
v_add_f32 v26, v26, v106
v_add_f32 v27, v27, v107
v_mfma_f32_16x16x32_bf16 v[184:187], a[152:155], v[68:71], v[184:187]
v_cvt_pk_bf16_f32 v86, v108, v109
v_cvt_pk_bf16_f32 v87, v110, v111
v_mfma_f32_16x16x32_bf16 v[188:191], a[156:159], v[68:71], v[188:191]
ds_read_b128 a[180:183], v3 offset:46080
v_add_f32 v26, v26, v108
v_add_f32 v27, v27, v109
v_mfma_f32_16x16x32_bf16 v[120:123], a[96:99], a[240:243], v[60:63]
v_add_f32 v26, v26, v110
v_add_f32 v27, v27, v111
v_mfma_f32_16x16x32_bf16 v[120:123], a[100:103], a[244:247], v[120:123]
buffer_load_dwordx4 v11, s[16:19], s23 offen offset:1024 sc1 lds
v_mfma_f32_16x16x32_bf16 v[120:123], a[104:107], a[248:251], v[120:123]
ds_read_b128 a[76:79], v2 offset:35840
ds_read_b128 a[184:187], v3 offset:47104
v_mfma_f32_16x16x32_bf16 v[120:123], a[108:111], a[252:255], v[120:123]
v_exp_f32 v112, v112
v_mfma_f32_16x16x32_bf16 v[124:127], a[112:115], a[240:243], v[60:63]
v_exp_f32 v113, v113
v_mfma_f32_16x16x32_bf16 v[124:127], a[116:119], a[244:247], v[124:127]
v_exp_f32 v114, v114
v_mfma_f32_16x16x32_bf16 v[124:127], a[120:123], a[248:251], v[124:127]
v_exp_f32 v115, v115
v_mfma_f32_16x16x32_bf16 v[124:127], a[124:127], a[252:255], v[124:127]
v_cvt_pk_bf16_f32 v88, v112, v113
v_cvt_pk_bf16_f32 v89, v114, v115
v_mfma_f32_16x16x32_bf16 v[192:195], a[128:131], v[72:75], v[192:195]
v_exp_f32 v116, v116
v_mfma_f32_16x16x32_bf16 v[196:199], a[132:135], v[72:75], v[196:199]
v_exp_f32 v117, v117
v_mfma_f32_16x16x32_bf16 v[200:203], a[136:139], v[72:75], v[200:203]
v_exp_f32 v118, v118
v_mfma_f32_16x16x32_bf16 v[204:207], a[140:143], v[72:75], v[204:207]
v_exp_f32 v119, v119
v_mfma_f32_16x16x32_bf16 v[28:31], a[36:39], v[72:75], v[28:31]
v_cvt_pk_bf16_f32 v90, v116, v117
v_cvt_pk_bf16_f32 v91, v118, v119
v_mfma_f32_16x16x32_bf16 v[208:211], a[144:147], v[72:75], v[208:211]
ds_read_b128 a[92:95], v2 offset:39936
ds_read_b128 a[188:191], v3 offset:48128
v_mfma_f32_16x16x32_bf16 v[212:215], a[148:151], v[72:75], v[212:215]
buffer_load_dwordx4 v12, s[16:19], s23 offen offset:2048 sc1 lds
v_mfma_f32_16x16x32_bf16 v[216:219], a[152:155], v[72:75], v[216:219]
v_exp_f32 v120, v120
v_mfma_f32_16x16x32_bf16 v[220:223], a[156:159], v[72:75], v[220:223]
v_exp_f32 v121, v121
v_mfma_f32_16x16x32_bf16 v[224:227], a[128:131], v[76:79], v[224:227]
v_exp_f32 v122, v122
v_mfma_f32_16x16x32_bf16 v[228:231], a[132:135], v[76:79], v[228:231]
v_exp_f32 v123, v123
v_mfma_f32_16x16x32_bf16 v[232:235], a[136:139], v[76:79], v[232:235]
v_cvt_pk_bf16_f32 v92, v120, v121
v_cvt_pk_bf16_f32 v93, v122, v123
v_mfma_f32_16x16x32_bf16 v[236:239], a[140:143], v[76:79], v[236:239]
v_exp_f32 v124, v124
v_mfma_f32_16x16x32_bf16 v[32:35], a[36:39], v[76:79], v[32:35]
v_exp_f32 v125, v125
v_mfma_f32_16x16x32_bf16 v[240:243], a[144:147], v[76:79], v[240:243]
v_exp_f32 v126, v126
v_mfma_f32_16x16x32_bf16 v[244:247], a[148:151], v[76:79], v[244:247]
v_exp_f32 v127, v127
v_mfma_f32_16x16x32_bf16 v[248:251], a[152:155], v[76:79], v[248:251]
v_cvt_pk_bf16_f32 v94, v124, v125
v_cvt_pk_bf16_f32 v95, v126, v127
v_mfma_f32_16x16x32_bf16 v[252:255], a[156:159], v[76:79], v[252:255]
buffer_load_dwordx4 v13, s[16:19], s23 offen offset:3072 sc1 lds
s_waitcnt vmcnt(17) lgkmcnt(0)
s_barrier
v_mfma_f32_16x16x32_bf16 v[96:99], a[64:67], a[192:195], v[48:51]
s_add_u32 m0, s22, 32768
ds_read_b128 a[96:99], v2 offset:49152
ds_read_b128 a[128:131], v3 offset:57344
v_mfma_f32_16x16x32_bf16 v[96:99], a[68:71], a[196:199], v[96:99]
s_add_u32 s23, s20, s99
v_mfma_f32_16x16x32_bf16 v[96:99], a[72:75], a[200:203], v[96:99]
buffer_load_dwordx4 v10, s[16:19], s20 offen offset:0 sc1 lds
v_mfma_f32_16x16x32_bf16 v[96:99], a[76:79], a[204:207], v[96:99]
ds_read_b128 a[112:115], v2 offset:53248
ds_read_b128 a[132:135], v3 offset:58368
v_mfma_f32_16x16x32_bf16 v[100:103], a[80:83], a[192:195], v[48:51]
buffer_load_dwordx4 v11, s[16:19], s20 offen offset:1024 sc1 lds
v_mfma_f32_16x16x32_bf16 v[100:103], a[84:87], a[196:199], v[100:103]
ds_read_b128 a[100:103], v2 offset:50176
ds_read_b128 a[136:139], v3 offset:59392
v_mfma_f32_16x16x32_bf16 v[100:103], a[88:91], a[200:203], v[100:103]
buffer_load_dwordx4 v12, s[16:19], s20 offen offset:2048 sc1 lds
v_mfma_f32_16x16x32_bf16 v[100:103], a[92:95], a[204:207], v[100:103]
ds_read_b128 a[116:119], v2 offset:54272
ds_read_b128 a[140:143], v3 offset:60416
v_mfma_f32_16x16x32_bf16 v[104:107], a[64:67], a[208:211], v[52:55]
v_exp_f32 v96, v96
v_mfma_f32_16x16x32_bf16 v[104:107], a[68:71], a[212:215], v[104:107]
v_exp_f32 v97, v97
v_mfma_f32_16x16x32_bf16 v[104:107], a[72:75], a[216:219], v[104:107]
v_exp_f32 v98, v98
v_mfma_f32_16x16x32_bf16 v[104:107], a[76:79], a[220:223], v[104:107]
v_exp_f32 v99, v99
v_mfma_f32_16x16x32_bf16 v[108:111], a[80:83], a[208:211], v[52:55]
buffer_load_dwordx4 v13, s[16:19], s20 offen offset:3072 sc1 lds
v_mfma_f32_16x16x32_bf16 v[108:111], a[84:87], a[212:215], v[108:111]
s_add_u32 m0, s22, 36864
s_add_u32 s20, s20, s21
v_cvt_pk_bf16_f32 v64, v96, v97
v_mfma_f32_16x16x32_bf16 v[108:111], a[88:91], a[216:219], v[108:111]
ds_read_b128 a[104:107], v2 offset:51200
v_cvt_pk_bf16_f32 v65, v98, v99
v_mfma_f32_16x16x32_bf16 v[108:111], a[92:95], a[220:223], v[108:111]
ds_read_b128 a[144:147], v3 offset:61440
v_add_f32 v24, v24, v96
v_mfma_f32_16x16x32_bf16 v[128:131], a[160:163], v[80:83], v[128:131]
buffer_load_dwordx4 v10, s[16:19], s23 offen offset:0 sc1 lds
v_mfma_f32_16x16x32_bf16 v[132:135], a[164:167], v[80:83], v[132:135]
v_exp_f32 v100, v100
v_mfma_f32_16x16x32_bf16 v[136:139], a[168:171], v[80:83], v[136:139]
v_exp_f32 v101, v101
v_mfma_f32_16x16x32_bf16 v[140:143], a[172:175], v[80:83], v[140:143]
v_exp_f32 v102, v102
v_add_f32 v25, v25, v97
v_mfma_f32_16x16x32_bf16 v[144:147], a[176:179], v[80:83], v[144:147]
v_exp_f32 v103, v103
v_mfma_f32_16x16x32_bf16 v[148:151], a[180:183], v[80:83], v[148:151]
v_add_f32 v24, v24, v98
v_add_f32 v25, v25, v99
v_mfma_f32_16x16x32_bf16 v[152:155], a[184:187], v[80:83], v[152:155]
v_cvt_pk_bf16_f32 v66, v100, v101
v_cvt_pk_bf16_f32 v67, v102, v103
v_mfma_f32_16x16x32_bf16 v[156:159], a[188:191], v[80:83], v[156:159]
ds_read_b128 a[120:123], v2 offset:55296
v_add_f32 v24, v24, v100
v_mfma_f32_16x16x32_bf16 v[112:115], a[64:67], a[224:227], v[56:59]
v_exp_f32 v104, v104
v_mfma_f32_16x16x32_bf16 v[112:115], a[68:71], a[228:231], v[112:115]
v_exp_f32 v105, v105
v_mfma_f32_16x16x32_bf16 v[112:115], a[72:75], a[232:235], v[112:115]
v_exp_f32 v106, v106
v_mfma_f32_16x16x32_bf16 v[112:115], a[76:79], a[236:239], v[112:115]
v_exp_f32 v107, v107
v_mfma_f32_16x16x32_bf16 v[116:119], a[80:83], a[224:227], v[56:59]
v_add_f32 v25, v25, v101
v_add_f32 v24, v24, v102
v_mfma_f32_16x16x32_bf16 v[116:119], a[84:87], a[228:231], v[116:119]
v_add_f32 v25, v25, v103
v_cvt_pk_bf16_f32 v68, v104, v105
v_mfma_f32_16x16x32_bf16 v[116:119], a[88:91], a[232:235], v[116:119]
v_cvt_pk_bf16_f32 v69, v106, v107
v_add_f32 v26, v26, v104
v_mfma_f32_16x16x32_bf16 v[116:119], a[92:95], a[236:239], v[116:119]
buffer_load_dword a40, v18, s[12:15], s7 offen sc1
v_mfma_f32_16x16x32_bf16 v[160:163], a[160:163], v[84:87], v[160:163]
v_exp_f32 v108, v108
v_mfma_f32_16x16x32_bf16 v[164:167], a[164:167], v[84:87], v[164:167]
v_exp_f32 v109, v109
v_mfma_f32_16x16x32_bf16 v[168:171], a[168:171], v[84:87], v[168:171]
v_exp_f32 v110, v110
v_mfma_f32_16x16x32_bf16 v[172:175], a[172:175], v[84:87], v[172:175]
v_exp_f32 v111, v111
v_mfma_f32_16x16x32_bf16 v[176:179], a[176:179], v[84:87], v[176:179]
v_add_f32 v27, v27, v105
v_add_f32 v26, v26, v106
v_mfma_f32_16x16x32_bf16 v[180:183], a[180:183], v[84:87], v[180:183]
v_add_f32 v27, v27, v107
v_cvt_pk_bf16_f32 v70, v108, v109
v_mfma_f32_16x16x32_bf16 v[184:187], a[184:187], v[84:87], v[184:187]
ds_read_b128 a[148:151], v3 offset:62464
v_cvt_pk_bf16_f32 v71, v110, v111
v_mfma_f32_16x16x32_bf16 v[188:191], a[188:191], v[84:87], v[188:191]
v_add_f32 v26, v26, v108
v_add_f32 v27, v27, v109
v_add_f32 v26, v26, v110
v_mfma_f32_16x16x32_bf16 v[120:123], a[64:67], a[240:243], v[60:63]
ds_read_b128 a[108:111], v2 offset:52224
v_add_f32 v27, v27, v111
v_mfma_f32_16x16x32_bf16 v[120:123], a[68:71], a[244:247], v[120:123]
buffer_load_dwordx4 v11, s[16:19], s23 offen offset:1024 sc1 lds
v_mfma_f32_16x16x32_bf16 v[120:123], a[72:75], a[248:251], v[120:123]
v_exp_f32 v112, v112
v_mfma_f32_16x16x32_bf16 v[120:123], a[76:79], a[252:255], v[120:123]
v_exp_f32 v113, v113
v_mfma_f32_16x16x32_bf16 v[124:127], a[80:83], a[240:243], v[60:63]
v_exp_f32 v114, v114
v_mfma_f32_16x16x32_bf16 v[124:127], a[84:87], a[244:247], v[124:127]
v_exp_f32 v115, v115
v_mfma_f32_16x16x32_bf16 v[124:127], a[88:91], a[248:251], v[124:127]
v_cvt_pk_bf16_f32 v72, v112, v113
v_cvt_pk_bf16_f32 v73, v114, v115
v_mfma_f32_16x16x32_bf16 v[124:127], a[92:95], a[252:255], v[124:127]
ds_read_b128 a[152:155], v3 offset:63488
ds_read_b128 a[124:127], v2 offset:56320
v_mfma_f32_16x16x32_bf16 v[192:195], a[160:163], v[88:91], v[192:195]
v_exp_f32 v116, v116
v_mfma_f32_16x16x32_bf16 v[196:199], a[164:167], v[88:91], v[196:199]
v_exp_f32 v117, v117
v_mfma_f32_16x16x32_bf16 v[200:203], a[168:171], v[88:91], v[200:203]
v_exp_f32 v118, v118
v_mfma_f32_16x16x32_bf16 v[204:207], a[172:175], v[88:91], v[204:207]
v_exp_f32 v119, v119
v_mfma_f32_16x16x32_bf16 v[28:31], a[36:39], v[88:91], v[28:31]
v_cvt_pk_bf16_f32 v74, v116, v117
v_cvt_pk_bf16_f32 v75, v118, v119
v_mfma_f32_16x16x32_bf16 v[208:211], a[176:179], v[88:91], v[208:211]
buffer_load_dwordx4 v12, s[16:19], s23 offen offset:2048 sc1 lds
v_mfma_f32_16x16x32_bf16 v[212:215], a[180:183], v[88:91], v[212:215]
ds_read_b128 a[156:159], v3 offset:64512
v_mfma_f32_16x16x32_bf16 v[216:219], a[184:187], v[88:91], v[216:219]
v_exp_f32 v120, v120
v_mfma_f32_16x16x32_bf16 v[220:223], a[188:191], v[88:91], v[220:223]
v_exp_f32 v121, v121
v_mfma_f32_16x16x32_bf16 v[224:227], a[160:163], v[92:95], v[224:227]
v_exp_f32 v122, v122
v_mfma_f32_16x16x32_bf16 v[228:231], a[164:167], v[92:95], v[228:231]
v_exp_f32 v123, v123
v_mfma_f32_16x16x32_bf16 v[232:235], a[168:171], v[92:95], v[232:235]
v_cvt_pk_bf16_f32 v76, v120, v121
v_cvt_pk_bf16_f32 v77, v122, v123
v_mfma_f32_16x16x32_bf16 v[236:239], a[172:175], v[92:95], v[236:239]
v_exp_f32 v124, v124
v_mfma_f32_16x16x32_bf16 v[32:35], a[36:39], v[92:95], v[32:35]
v_exp_f32 v125, v125
v_mfma_f32_16x16x32_bf16 v[240:243], a[176:179], v[92:95], v[240:243]
v_exp_f32 v126, v126
v_mfma_f32_16x16x32_bf16 v[244:247], a[180:183], v[92:95], v[244:247]
v_exp_f32 v127, v127
v_mfma_f32_16x16x32_bf16 v[248:251], a[184:187], v[92:95], v[248:251]
v_cvt_pk_bf16_f32 v78, v124, v125
v_cvt_pk_bf16_f32 v79, v126, v127
v_mfma_f32_16x16x32_bf16 v[252:255], a[188:191], v[92:95], v[252:255]
buffer_load_dwordx4 v13, s[16:19], s23 offen offset:3072 sc1 lds
s_sub_u32 s26, 6, s25
s_mov_b32 s27, 3
s_branch L_k2_disp
L_k2_mask:
v_cndmask_b32 v36, v48, v5, s[34:35]
v_cndmask_b32 v37, v49, v5, s[36:37]
v_cndmask_b32 v38, v50, v5, s[38:39]
v_cndmask_b32 v39, v51, v5, s[40:41]
v_mov_b32 v40, v5
v_mov_b32 v41, v5
v_mov_b32 v42, v5
v_mov_b32 v43, v5
v_cndmask_b32 v44, v52, v5, s[34:35]
v_cndmask_b32 v45, v53, v5, s[36:37]
v_cndmask_b32 v46, v54, v5, s[38:39]
v_cndmask_b32 v47, v55, v5, s[40:41]
s_branch L_k2_maskret
L_k2_sw:
s_waitcnt vmcnt(16)
v_cmp_u_f32 s[84:85], v20, v20
s_nop 0
s_or_b64 s[54:55], s[54:55], s[84:85]
s_cmp_eq_u64 s[54:55], 0
s_cselect_b64 s[84:85], 1, 0
s_cmp_eq_u32 s27, 3
s_cselect_b64 s[84:85], s[84:85], 0
s_mov_b64 exec, s[84:85]
buffer_store_dword a41, off, s[12:15], s86 offset:0 sc1
s_mov_b64 exec, -1
s_getpc_b64 s[4:5]
L_k2_pcs:
s_add_u32 s4, s4, L_kt_entry-L_k2_pcs
s_addc_u32 s5, s5, 0
v_accvgpr_read_b32 v18, a60
v_mov_b32 v19, 0
s_mov_b32 s16, s96
s_mov_b32 s17, s97
s_mov_b32 s18, 4718592
v_lshl_add_u64 v[18:19], v[18:19], 0, s[4:5]
v_accvgpr_read_b32 v10, a57
v_accvgpr_read_b32 v11, a58
global_load_dword a44, v[18:19], off
buffer_load_dword a45, v10, s[16:19], 0 offen
buffer_load_dword a46, v11, s[8:11], 0 offen
buffer_load_dword a47, v10, s[92:95], 0 offen
s_mov_b32 s20, s87
s_mov_b32 s99, 18432
s_bitcmp1_b32 s2, 4
s_cselect_b32 s21, -1, 1
s_mul_i32 s21, s21, 147456
v_accvgpr_read_b32 v10, a53
v_accvgpr_read_b32 v11, a54
v_accvgpr_read_b32 v12, a55
v_accvgpr_read_b32 v13, a56
v_accvgpr_read_b32 v18, a59
s_cmp_eq_u32 s27, 1
s_cbranch_scc1 L_k2_swr1
s_cmp_lg_u32 s27, 2
s_cbranch_scc1 L_k2_swr0
s_cmp_eq_u32 s25, 7
s_cbranch_scc1 L_k2_swr2
s_branch L_k2_swr3
L_k2_tail2x:
s_waitcnt vmcnt(17) lgkmcnt(0)
s_barrier
v_mfma_f32_16x16x32_bf16 v[192:195], a[128:131], v[72:75], 0
s_and_b32 s60, s3, 1
s_lshl_b32 s61, s60, 16
s_lshl_b32 s60, s60, 14
s_add_u32 s61, s61, 49152
s_add_u32 s60, s60, 131072
v_add_u32 v2, s60, v1
v_add_u32 v3, s61, v1
s_lshl_b32 s60, s3, 10
s_add_u32 s60, s60, 106496
v_add_u32 v14, s60, v1
v_xor_b32 v15, 0x800, v14
v_mfma_f32_16x16x32_bf16 v[196:199], a[132:135], v[72:75], 0
s_add_u32 s63, s31, 18432
v_mov_b32 v96, 0
v_mov_b32 v97, 0
v_mov_b32 v98, 0
v_mov_b32 v99, 0
v_mul_f32 v160, v160, v8
v_mul_f32 v161, v161, v8
v_mul_f32 v162, v162, v8
v_mul_f32 v163, v163, v8
v_mul_f32 v164, v164, v8
v_mul_f32 v165, v165, v8
v_mfma_f32_16x16x32_bf16 v[200:203], a[136:139], v[72:75], 0
ds_write_b64 v14, v[96:97]
ds_write_b128 v2, v[96:99] offset:0
v_mfma_f32_16x16x32_bf16 v[204:207], a[140:143], v[72:75], 0
ds_write_b128 v2, v[96:99] offset:1024
ds_write_b128 v2, v[96:99] offset:2048
v_mfma_f32_16x16x32_bf16 v[28:31], a[36:39], v[72:75], 0
ds_write_b128 v2, v[96:99] offset:3072
ds_write_b128 v2, v[96:99] offset:4096
v_mfma_f32_16x16x32_bf16 v[208:211], a[144:147], v[72:75], 0
ds_write_b128 v2, v[96:99] offset:5120
ds_write_b128 v2, v[96:99] offset:6144
v_mfma_f32_16x16x32_bf16 v[212:215], a[148:151], v[72:75], 0
ds_write_b128 v2, v[96:99] offset:7168
ds_write_b128 v2, v[96:99] offset:8192
v_mfma_f32_16x16x32_bf16 v[216:219], a[152:155], v[72:75], 0
ds_write_b128 v2, v[96:99] offset:9216
ds_write_b128 v2, v[96:99] offset:10240
v_mfma_f32_16x16x32_bf16 v[220:223], a[156:159], v[72:75], 0
ds_write_b128 v2, v[96:99] offset:11264
ds_write_b128 v2, v[96:99] offset:12288
v_mfma_f32_16x16x32_bf16 v[224:227], a[128:131], v[76:79], 0
ds_write_b128 v2, v[96:99] offset:13312
ds_write_b128 v2, v[96:99] offset:14336
v_mfma_f32_16x16x32_bf16 v[228:231], a[132:135], v[76:79], 0
ds_write_b128 v2, v[96:99] offset:15360
v_mul_f32 v166, v166, v8
v_mul_f32 v167, v167, v8
v_cvt_pk_bf16_f32 v160, v160, v161
v_cvt_pk_bf16_f32 v161, v162, v163
v_cvt_pk_bf16_f32 v162, v164, v165
v_mfma_f32_16x16x32_bf16 v[232:235], a[136:139], v[76:79], 0
v_cvt_pk_bf16_f32 v163, v166, v167
buffer_store_dwordx4 v[160:163], v1, s[12:15], s63 offen offset:0 sc1
v_accvgpr_mov_b32 a249, a57
v_mfma_f32_16x16x32_bf16 v[236:239], a[140:143], v[76:79], 0
s_cmp_eq_u32 s29, 0
s_cselect_b32 s59, 1, 0
v_accvgpr_mov_b32 a250, a58
v_mfma_f32_16x16x32_bf16 v[20:23], a[32:35], v[160:163], v[20:23]
s_load_dwordx2 s[24:25], s[0:1], 0
v_mul_f32 v168, v168, v8
v_mul_f32 v169, v169, v8
v_mul_f32 v170, v170, v8
v_mul_f32 v171, v171, v8
v_mul_f32 v172, v172, v8
v_mul_f32 v173, v173, v8
v_mfma_f32_16x16x32_bf16 v[32:35], a[36:39], v[76:79], 0
s_load_dwordx2 s[28:29], s[0:1], 72
v_mul_f32 v174, v174, v8
v_mul_f32 v175, v175, v8
v_cvt_pk_bf16_f32 v168, v168, v169
v_cvt_pk_bf16_f32 v169, v170, v171
v_cvt_pk_bf16_f32 v170, v172, v173
v_cvt_pk_bf16_f32 v171, v174, v175
v_mfma_f32_16x16x32_bf16 v[240:243], a[144:147], v[76:79], 0
buffer_store_dwordx4 v[168:171], v1, s[12:15], s63 offen offset:1024 sc1
v_mfma_f32_16x16x32_bf16 v[20:23], a[32:35], v[168:171], v[20:23]
v_mul_f32 v176, v176, v8
v_mul_f32 v177, v177, v8
v_mfma_f32_16x16x32_bf16 v[244:247], a[148:151], v[76:79], 0
v_mul_f32 v178, v178, v8
v_mul_f32 v179, v179, v8
v_mul_f32 v180, v180, v8
v_mul_f32 v181, v181, v8
v_mul_f32 v182, v182, v8
v_mul_f32 v183, v183, v8
v_cvt_pk_bf16_f32 v176, v176, v177
v_cvt_pk_bf16_f32 v177, v178, v179
v_cvt_pk_bf16_f32 v178, v180, v181
v_cvt_pk_bf16_f32 v179, v182, v183
v_mfma_f32_16x16x32_bf16 v[248:251], a[152:155], v[76:79], 0
buffer_store_dwordx4 v[176:179], v1, s[12:15], s63 offen offset:2048 sc1
v_mfma_f32_16x16x32_bf16 v[20:23], a[32:35], v[176:179], v[20:23]
v_mul_f32 v184, v184, v8
v_mul_f32 v185, v185, v8
v_mfma_f32_16x16x32_bf16 v[252:255], a[156:159], v[76:79], 0
v_mul_f32 v186, v186, v8
v_mul_f32 v187, v187, v8
v_mul_f32 v188, v188, v8
v_mul_f32 v189, v189, v8
v_mul_f32 v190, v190, v8
v_mul_f32 v191, v191, v8
v_cvt_pk_bf16_f32 v184, v184, v185
v_cvt_pk_bf16_f32 v185, v186, v187
v_cvt_pk_bf16_f32 v186, v188, v189
v_cvt_pk_bf16_f32 v187, v190, v191
buffer_store_dwordx4 v[184:187], v1, s[12:15], s63 offen offset:3072 sc1
s_nop 0
v_mfma_f32_16x16x32_bf16 v[20:23], a[32:35], v[184:187], v[20:23]
s_and_b32 s32, s2, 7
s_bfe_u32 s33, s2, 0x20003
s_lshr_b32 s34, s2, 5
s_and_b32 s41, s2, 24
s_lshr_b32 s41, 0x1bc639e4, s41
s_lshl_b32 s35, s34, 2
s_add_u32 s35, s35, s3
s_lshl_b32 s35, s35, 1
s_mul_i32 s42, s32, 2359296
s_add_u32 s42, s42, 167772160
s_mul_i32 s85, s35, 18432
s_add_u32 s85, s85, s42
v_mov_b32 v37, 0
s_lshl_b32 s37, s41, 12
s_and_b32 s37, s37, 0x3000
s_add_u32 s37, s37, s85
s_add_u32 s38, s37, 18432
v_bfe_u32 v54, v0, 2, 4
v_and_b32 v55, 3, v0
v_and_b32 v56, 7, v54
v_lshlrev_b32 v38, 8, v54
v_lshl_add_u32 v38, v55, 3, v38
v_lshl_add_u32 v38, v56, 5, v38
v_xor_b32 v39, 32, v38
v_xor_b32 v40, 64, v38
v_xor_b32 v41, 96, v38
v_xor_b32 v42, 128, v38
v_xor_b32 v43, 160, v38
v_xor_b32 v44, 192, v38
v_xor_b32 v45, 224, v38
v_lshlrev_b32 v62, 5, v54
v_lshl_add_u32 v62, v55, 3, v62
v_add_u32 v62, 147456, v62
s_branch L_k2_tail23b
L_k2_tail23:
s_waitcnt vmcnt(3) lgkmcnt(0)
s_barrier
v_mfma_f32_16x16x32_bf16 v[128:131], a[128:131], v[64:67], v[128:131]
s_and_b32 s60, s3, 1
s_lshl_b32 s61, s60, 16
s_lshl_b32 s60, s60, 14
v_mfma_f32_16x16x32_bf16 v[132:135], a[132:135], v[64:67], v[132:135]
s_add_u32 s61, s61, 49152
s_add_u32 s60, s60, 131072
v_add_u32 v2, s60, v1
v_mfma_f32_16x16x32_bf16 v[136:139], a[136:139], v[64:67], v[136:139]
v_add_u32 v3, s61, v1
s_lshl_b32 s60, s3, 10
v_mfma_f32_16x16x32_bf16 v[140:143], a[140:143], v[64:67], v[140:143]
s_add_u32 s60, s60, 106496
v_add_u32 v14, s60, v1
v_xor_b32 v15, 0x800, v14
v_mfma_f32_16x16x32_bf16 v[144:147], a[144:147], v[64:67], v[144:147]
v_add_f32 v24, v24, v25
v_add_f32 v26, v26, v27
v_cmp_u_f32 s[84:85], v20, v20
v_mfma_f32_16x16x32_bf16 v[148:151], a[148:151], v[64:67], v[148:151]
s_or_b64 s[54:55], s[54:55], s[84:85]
v_accvgpr_mov_b32 a249, a57
v_accvgpr_mov_b32 a250, a58
v_mfma_f32_16x16x32_bf16 v[152:155], a[152:155], v[64:67], v[152:155]
s_cmp_eq_u64 s[54:55], 0
s_cselect_b64 s[84:85], 1, 0
s_mov_b64 exec, s[84:85]
buffer_store_dword a41, off, s[12:15], s86 offset:0 sc1
s_mov_b64 exec, -1
v_mfma_f32_16x16x32_bf16 v[156:159], a[156:159], v[64:67], v[156:159]
s_and_b32 s32, s2, 7
s_bfe_u32 s33, s2, 0x20003
s_lshr_b32 s34, s2, 5
v_mfma_f32_16x16x32_bf16 v[160:163], a[128:131], v[68:71], v[160:163]
s_and_b32 s41, s2, 24
s_lshr_b32 s41, 0x1bc639e4, s41
s_lshl_b32 s35, s34, 2
v_mfma_f32_16x16x32_bf16 v[164:167], a[132:135], v[68:71], v[164:167]
s_add_u32 s35, s35, s3
s_lshl_b32 s35, s35, 1
s_mul_i32 s42, s32, 2359296
s_add_u32 s42, s42, 167772160
v_mfma_f32_16x16x32_bf16 v[168:171], a[136:139], v[68:71], v[168:171]
s_mul_i32 s85, s35, 18432
s_add_u32 s85, s85, s42
v_accvgpr_read_b32 v37, a40
v_mfma_f32_16x16x32_bf16 v[172:175], a[140:143], v[68:71], v[172:175]
s_lshl_b32 s37, s41, 12
s_and_b32 s37, s37, 0x3000
s_add_u32 s37, s37, s85
v_mfma_f32_16x16x32_bf16 v[176:179], a[144:147], v[68:71], v[176:179]
buffer_load_dwordx4 a[216:219], v1, s[12:15], s37 offen offset:0 sc1
v_mfma_f32_16x16x32_bf16 v[180:183], a[148:151], v[68:71], v[180:183]
s_add_u32 s38, s37, 18432
s_cmp_eq_u32 s29, 0
s_cselect_b32 s59, 1, 0
v_mfma_f32_16x16x32_bf16 v[184:187], a[152:155], v[68:71], v[184:187]
buffer_load_dwordx4 a[220:223], v1, s[12:15], s38 offen offset:0 sc1
s_load_dwordx2 s[24:25], s[0:1], 0
v_mfma_f32_16x16x32_bf16 v[188:191], a[156:159], v[68:71], v[188:191]
buffer_load_dwordx4 a[224:227], v1, s[12:15], s37 offen offset:1024 sc1
v_mfma_f32_16x16x32_bf16 v[192:195], a[128:131], v[72:75], v[192:195]
buffer_load_dwordx4 a[228:231], v1, s[12:15], s38 offen offset:1024 sc1
v_mfma_f32_16x16x32_bf16 v[196:199], a[132:135], v[72:75], v[196:199]
buffer_load_dwordx4 a[232:235], v1, s[12:15], s37 offen offset:2048 sc1
v_mfma_f32_16x16x32_bf16 v[200:203], a[136:139], v[72:75], v[200:203]
buffer_load_dwordx4 a[236:239], v1, s[12:15], s38 offen offset:2048 sc1
v_mfma_f32_16x16x32_bf16 v[204:207], a[140:143], v[72:75], v[204:207]
buffer_load_dwordx4 a[240:243], v1, s[12:15], s37 offen offset:3072 sc1
s_load_dwordx2 s[28:29], s[0:1], 72
v_mfma_f32_16x16x32_bf16 v[28:31], a[36:39], v[72:75], v[28:31]
buffer_load_dwordx4 a[244:247], v1, s[12:15], s38 offen offset:3072 sc1
v_mfma_f32_16x16x32_bf16 v[208:211], a[144:147], v[72:75], v[208:211]
ds_write_b128 v2, v[128:131] offset:0
v_mfma_f32_16x16x32_bf16 v[212:215], a[148:151], v[72:75], v[212:215]
ds_write_b128 v2, v[132:135] offset:1024
v_mfma_f32_16x16x32_bf16 v[216:219], a[152:155], v[72:75], v[216:219]
ds_write_b128 v2, v[136:139] offset:2048
v_mfma_f32_16x16x32_bf16 v[220:223], a[156:159], v[72:75], v[220:223]
ds_write_b128 v2, v[140:143] offset:3072
v_mfma_f32_16x16x32_bf16 v[224:227], a[128:131], v[76:79], v[224:227]
ds_write_b128 v2, v[144:147] offset:4096
v_mfma_f32_16x16x32_bf16 v[228:231], a[132:135], v[76:79], v[228:231]
ds_write_b128 v2, v[148:151] offset:5120
v_mfma_f32_16x16x32_bf16 v[232:235], a[136:139], v[76:79], v[232:235]
ds_write_b128 v2, v[152:155] offset:6144
v_mfma_f32_16x16x32_bf16 v[236:239], a[140:143], v[76:79], v[236:239]
ds_write_b128 v2, v[156:159] offset:7168
v_mfma_f32_16x16x32_bf16 v[32:35], a[36:39], v[76:79], v[32:35]
v_mov_b32 v25, v26
v_mfma_f32_16x16x32_bf16 v[240:243], a[144:147], v[76:79], v[240:243]
ds_write_b64 v14, v[24:25]
v_mfma_f32_16x16x32_bf16 v[244:247], a[148:151], v[76:79], v[244:247]
ds_write_b128 v2, v[160:163] offset:8192
v_mfma_f32_16x16x32_bf16 v[248:251], a[152:155], v[76:79], v[248:251]
ds_write_b128 v2, v[164:167] offset:9216
v_mfma_f32_16x16x32_bf16 v[252:255], a[156:159], v[76:79], v[252:255]
ds_write_b128 v2, v[168:171] offset:10240
ds_write_b128 v2, v[172:175] offset:11264
ds_write_b128 v2, v[176:179] offset:12288
ds_write_b128 v2, v[180:183] offset:13312
ds_write_b128 v2, v[184:187] offset:14336
ds_write_b128 v2, v[188:191] offset:15360
v_bfe_u32 v54, v0, 2, 4
v_and_b32 v55, 3, v0
v_and_b32 v56, 7, v54
v_lshlrev_b32 v38, 8, v54
v_lshl_add_u32 v38, v55, 3, v38
v_lshl_add_u32 v38, v56, 5, v38
v_xor_b32 v39, 32, v38
v_xor_b32 v40, 64, v38
v_xor_b32 v41, 96, v38
v_xor_b32 v42, 128, v38
v_xor_b32 v43, 160, v38
v_xor_b32 v44, 192, v38
v_xor_b32 v45, 224, v38
v_lshlrev_b32 v62, 5, v54
v_lshl_add_u32 v62, v55, 3, v62
v_add_u32 v62, 147456, v62
L_k2_tail23b:
s_waitcnt lgkmcnt(0)
s_barrier
ds_read_b64 v[16:17], v15
ds_read_b128 v[64:67], v3 offset:0
ds_read_b128 v[68:71], v3 offset:1024
ds_read_b128 v[72:75], v3 offset:2048
ds_read_b128 v[76:79], v3 offset:3072
ds_read_b128 v[80:83], v3 offset:4096
ds_read_b128 v[84:87], v3 offset:5120
ds_read_b128 v[88:91], v3 offset:6144
ds_read_b128 v[92:95], v3 offset:7168
ds_read_b128 v[96:99], v3 offset:8192
ds_read_b128 v[100:103], v3 offset:9216
ds_read_b128 v[104:107], v3 offset:10240
ds_read_b128 v[108:111], v3 offset:11264
ds_read_b128 v[112:115], v3 offset:12288
ds_read_b128 v[116:119], v3 offset:13312
s_waitcnt lgkmcnt(14)
v_add_f32 v6, v28, v16
v_add_u32 v7, 0xde800000, v6
v_cmp_lt_u32 vcc, 0x3c000000, v7
v_rcp_f32 v6, v6
s_or_b64 s[54:55], s[54:55], vcc
v_add_f32 v8, v32, v17
v_add_u32 v9, 0xde800000, v8
v_cmp_lt_u32 vcc, 0x3c000000, v9
v_rcp_f32 v8, v8
s_or_b64 s[54:55], s[54:55], vcc
ds_read_b128 v[120:123], v3 offset:14336
ds_read_b128 v[124:127], v3 offset:15360
s_waitcnt lgkmcnt(14)
v_pk_add_f32 v[192:193], v[192:193], v[64:65]
v_pk_add_f32 v[194:195], v[194:195], v[66:67]
v_pk_add_f32 v[196:197], v[196:197], v[68:69]
v_pk_add_f32 v[198:199], v[198:199], v[70:71]
v_pk_mul_f32 v[192:193], v[192:193], v[6:7] op_sel_hi:[1,0]
v_pk_mul_f32 v[194:195], v[194:195], v[6:7] op_sel_hi:[1,0]
v_pk_mul_f32 v[196:197], v[196:197], v[6:7] op_sel_hi:[1,0]
v_pk_mul_f32 v[198:199], v[198:199], v[6:7] op_sel_hi:[1,0]
v_cvt_pk_bf16_f32 v192, v192, v193
v_cvt_pk_bf16_f32 v193, v194, v195
v_cvt_pk_bf16_f32 v194, v196, v197
v_cvt_pk_bf16_f32 v195, v198, v199
s_lshl_b32 s37, s41, 10
s_and_b32 s37, s37, 0x3000
s_add_u32 s37, s37, s85
buffer_load_dwordx4 a[0:3], v1, s[12:15], s37 offen offset:0 sc1
s_waitcnt lgkmcnt(12)
v_pk_add_f32 v[200:201], v[200:201], v[72:73]
v_pk_add_f32 v[202:203], v[202:203], v[74:75]
v_pk_add_f32 v[204:205], v[204:205], v[76:77]
v_pk_add_f32 v[206:207], v[206:207], v[78:79]
v_pk_mul_f32 v[200:201], v[200:201], v[6:7] op_sel_hi:[1,0]
v_pk_mul_f32 v[202:203], v[202:203], v[6:7] op_sel_hi:[1,0]
v_pk_mul_f32 v[204:205], v[204:205], v[6:7] op_sel_hi:[1,0]
v_pk_mul_f32 v[206:207], v[206:207], v[6:7] op_sel_hi:[1,0]
v_cvt_pk_bf16_f32 v200, v200, v201
v_cvt_pk_bf16_f32 v201, v202, v203
v_cvt_pk_bf16_f32 v202, v204, v205
v_cvt_pk_bf16_f32 v203, v206, v207
s_add_u32 s38, s37, 18432
buffer_load_dwordx4 a[4:7], v1, s[12:15], s38 offen offset:0 sc1
s_waitcnt lgkmcnt(10)
v_pk_add_f32 v[208:209], v[208:209], v[80:81]
v_pk_add_f32 v[210:211], v[210:211], v[82:83]
v_pk_add_f32 v[212:213], v[212:213], v[84:85]
v_pk_add_f32 v[214:215], v[214:215], v[86:87]
v_pk_mul_f32 v[208:209], v[208:209], v[6:7] op_sel_hi:[1,0]
v_pk_mul_f32 v[210:211], v[210:211], v[6:7] op_sel_hi:[1,0]
v_pk_mul_f32 v[212:213], v[212:213], v[6:7] op_sel_hi:[1,0]
v_pk_mul_f32 v[214:215], v[214:215], v[6:7] op_sel_hi:[1,0]
v_cvt_pk_bf16_f32 v208, v208, v209
v_cvt_pk_bf16_f32 v209, v210, v211
v_cvt_pk_bf16_f32 v210, v212, v213
v_cvt_pk_bf16_f32 v211, v214, v215
buffer_load_dwordx4 a[8:11], v1, s[12:15], s37 offen offset:1024 sc1
s_waitcnt lgkmcnt(8)
v_pk_add_f32 v[216:217], v[216:217], v[88:89]
v_pk_add_f32 v[218:219], v[218:219], v[90:91]
v_pk_add_f32 v[220:221], v[220:221], v[92:93]
v_pk_add_f32 v[222:223], v[222:223], v[94:95]
v_pk_mul_f32 v[216:217], v[216:217], v[6:7] op_sel_hi:[1,0]
v_pk_mul_f32 v[218:219], v[218:219], v[6:7] op_sel_hi:[1,0]
v_pk_mul_f32 v[220:221], v[220:221], v[6:7] op_sel_hi:[1,0]
v_pk_mul_f32 v[222:223], v[222:223], v[6:7] op_sel_hi:[1,0]
v_cvt_pk_bf16_f32 v216, v216, v217
v_cvt_pk_bf16_f32 v217, v218, v219
v_cvt_pk_bf16_f32 v218, v220, v221
v_cvt_pk_bf16_f32 v219, v222, v223
buffer_load_dwordx4 a[12:15], v1, s[12:15], s38 offen offset:1024 sc1
s_cmp_lg_u32 s35, 60
s_cbranch_scc1 L_k2_ecp
s_waitcnt vmcnt(4)
v_cmp_u_f32 vcc, v20, v20
s_nop 0
s_or_b64 s[54:55], s[54:55], vcc
s_cmp_eq_u64 s[54:55], 0
s_cselect_b64 exec, 1, 0
buffer_store_dword a41, off, s[12:15], s86 sc1
s_mov_b64 exec, -1
L_k2_ecp:
s_waitcnt lgkmcnt(6)
v_pk_add_f32 v[224:225], v[224:225], v[96:97]
v_pk_add_f32 v[226:227], v[226:227], v[98:99]
v_pk_add_f32 v[228:229], v[228:229], v[100:101]
v_pk_add_f32 v[230:231], v[230:231], v[102:103]
v_pk_mul_f32 v[224:225], v[224:225], v[8:9] op_sel_hi:[1,0]
v_pk_mul_f32 v[226:227], v[226:227], v[8:9] op_sel_hi:[1,0]
v_pk_mul_f32 v[228:229], v[228:229], v[8:9] op_sel_hi:[1,0]
v_pk_mul_f32 v[230:231], v[230:231], v[8:9] op_sel_hi:[1,0]
v_cvt_pk_bf16_f32 v196, v224, v225
v_cvt_pk_bf16_f32 v197, v226, v227
v_cvt_pk_bf16_f32 v198, v228, v229
v_cvt_pk_bf16_f32 v199, v230, v231
buffer_load_dwordx4 a[16:19], v1, s[12:15], s37 offen offset:2048 sc1
s_waitcnt lgkmcnt(4)
v_pk_add_f32 v[232:233], v[232:233], v[104:105]
v_pk_add_f32 v[234:235], v[234:235], v[106:107]
v_pk_add_f32 v[236:237], v[236:237], v[108:109]
v_pk_add_f32 v[238:239], v[238:239], v[110:111]
v_pk_mul_f32 v[232:233], v[232:233], v[8:9] op_sel_hi:[1,0]
v_pk_mul_f32 v[234:235], v[234:235], v[8:9] op_sel_hi:[1,0]
v_pk_mul_f32 v[236:237], v[236:237], v[8:9] op_sel_hi:[1,0]
v_pk_mul_f32 v[238:239], v[238:239], v[8:9] op_sel_hi:[1,0]
v_cvt_pk_bf16_f32 v204, v232, v233
v_cvt_pk_bf16_f32 v205, v234, v235
v_cvt_pk_bf16_f32 v206, v236, v237
v_cvt_pk_bf16_f32 v207, v238, v239
buffer_load_dwordx4 a[20:23], v1, s[12:15], s38 offen offset:2048 sc1
s_waitcnt lgkmcnt(2)
v_pk_add_f32 v[240:241], v[240:241], v[112:113]
v_pk_add_f32 v[242:243], v[242:243], v[114:115]
v_pk_add_f32 v[244:245], v[244:245], v[116:117]
v_pk_add_f32 v[246:247], v[246:247], v[118:119]
v_pk_mul_f32 v[240:241], v[240:241], v[8:9] op_sel_hi:[1,0]
v_pk_mul_f32 v[242:243], v[242:243], v[8:9] op_sel_hi:[1,0]
v_pk_mul_f32 v[244:245], v[244:245], v[8:9] op_sel_hi:[1,0]
v_pk_mul_f32 v[246:247], v[246:247], v[8:9] op_sel_hi:[1,0]
v_cvt_pk_bf16_f32 v212, v240, v241
v_cvt_pk_bf16_f32 v213, v242, v243
v_cvt_pk_bf16_f32 v214, v244, v245
v_cvt_pk_bf16_f32 v215, v246, v247
buffer_load_dwordx4 a[24:27], v1, s[12:15], s37 offen offset:3072 sc1
s_waitcnt lgkmcnt(0)
v_pk_add_f32 v[248:249], v[248:249], v[120:121]
v_pk_add_f32 v[250:251], v[250:251], v[122:123]
v_pk_add_f32 v[252:253], v[252:253], v[124:125]
v_pk_add_f32 v[254:255], v[254:255], v[126:127]
v_pk_mul_f32 v[248:249], v[248:249], v[8:9] op_sel_hi:[1,0]
v_pk_mul_f32 v[250:251], v[250:251], v[8:9] op_sel_hi:[1,0]
v_pk_mul_f32 v[252:253], v[252:253], v[8:9] op_sel_hi:[1,0]
v_pk_mul_f32 v[254:255], v[254:255], v[8:9] op_sel_hi:[1,0]
v_cvt_pk_bf16_f32 v220, v248, v249
v_cvt_pk_bf16_f32 v221, v250, v251
v_cvt_pk_bf16_f32 v222, v252, v253
v_cvt_pk_bf16_f32 v223, v254, v255
buffer_load_dwordx4 a[28:31], v1, s[12:15], s38 offen offset:3072 sc1
v_mfma_f32_16x16x32_bf16 v[20:23], a[32:35], v[192:195], v[20:23]
v_mfma_f32_16x16x32_bf16 v[20:23], a[32:35], v[200:203], v[20:23]
v_mfma_f32_16x16x32_bf16 v[20:23], a[32:35], v[208:211], v[20:23]
v_mfma_f32_16x16x32_bf16 v[20:23], a[32:35], v[216:219], v[20:23]
v_mfma_f32_16x16x32_bf16 v[20:23], a[32:35], v[196:199], v[20:23]
v_mfma_f32_16x16x32_bf16 v[20:23], a[32:35], v[204:207], v[20:23]
v_mfma_f32_16x16x32_bf16 v[20:23], a[32:35], v[212:215], v[20:23]
v_mfma_f32_16x16x32_bf16 v[20:23], a[32:35], v[220:223], v[20:23]
s_lshl_b32 s60, s3, 2
s_add_u32 s60, s60, 110592
v_mov_b32 v17, s60
s_branch L_k2_check
L_k2_tail01:
s_waitcnt vmcnt(3) lgkmcnt(0)
s_barrier
v_mfma_f32_16x16x32_bf16 v[192:195], a[128:131], v[72:75], v[192:195]
s_and_b32 s60, s3, 1
s_lshl_b32 s61, s60, 16
s_lshl_b32 s60, s60, 14
v_mfma_f32_16x16x32_bf16 v[196:199], a[132:135], v[72:75], v[196:199]
s_add_u32 s61, s61, 49152
s_add_u32 s60, s60, 131072
v_add_u32 v2, s61, v1
v_mfma_f32_16x16x32_bf16 v[200:203], a[136:139], v[72:75], v[200:203]
s_and_b32 s32, s2, 7
v_add_u32 v3, s60, v1
s_lshl_b32 s60, s3, 10
v_mfma_f32_16x16x32_bf16 v[204:207], a[140:143], v[72:75], v[204:207]
s_add_u32 s60, s60, 106496
v_add_u32 v14, s60, v1
v_xor_b32 v15, 0x800, v14
v_mfma_f32_16x16x32_bf16 v[28:31], a[36:39], v[72:75], v[28:31]
s_bfe_u32 s33, s2, 0x20003
v_add_f32 v24, v24, v25
v_add_f32 v26, v26, v27
v_mfma_f32_16x16x32_bf16 v[208:211], a[144:147], v[72:75], v[208:211]
s_lshr_b32 s34, s2, 5
s_and_b32 s41, s2, 24
s_lshr_b32 s41, 0x1bc639e4, s41
v_mfma_f32_16x16x32_bf16 v[212:215], a[148:151], v[72:75], v[212:215]
s_lshl_b32 s35, s34, 2
s_add_u32 s35, s35, s3
s_lshl_b32 s35, s35, 1
v_mfma_f32_16x16x32_bf16 v[216:219], a[152:155], v[72:75], v[216:219]
s_mul_i32 s42, s32, 2359296
s_add_u32 s42, s42, 167772160
s_mul_i32 s85, s35, 18432
v_mfma_f32_16x16x32_bf16 v[220:223], a[156:159], v[72:75], v[220:223]
s_add_u32 s85, s85, s42
v_accvgpr_read_b32 v37, a40
s_lshl_b32 s37, s41, 12
v_mfma_f32_16x16x32_bf16 v[224:227], a[128:131], v[76:79], v[224:227]
s_and_b32 s37, s37, 0x3000
s_add_u32 s37, s37, s85
v_accvgpr_mov_b32 a249, a57
v_mfma_f32_16x16x32_bf16 v[228:231], a[132:135], v[76:79], v[228:231]
buffer_load_dwordx4 a[216:219], v1, s[12:15], s37 offen offset:0 sc1
v_mfma_f32_16x16x32_bf16 v[232:235], a[136:139], v[76:79], v[232:235]
s_add_u32 s38, s37, 18432
v_accvgpr_mov_b32 a250, a58
v_mfma_f32_16x16x32_bf16 v[236:239], a[140:143], v[76:79], v[236:239]
buffer_load_dwordx4 a[220:223], v1, s[12:15], s38 offen offset:0 sc1
v_mfma_f32_16x16x32_bf16 v[32:35], a[36:39], v[76:79], v[32:35]
buffer_load_dwordx4 a[224:227], v1, s[12:15], s37 offen offset:1024 sc1
v_mfma_f32_16x16x32_bf16 v[240:243], a[144:147], v[76:79], v[240:243]
buffer_load_dwordx4 a[228:231], v1, s[12:15], s38 offen offset:1024 sc1
v_mfma_f32_16x16x32_bf16 v[244:247], a[148:151], v[76:79], v[244:247]
buffer_load_dwordx4 a[232:235], v1, s[12:15], s37 offen offset:2048 sc1
v_mfma_f32_16x16x32_bf16 v[248:251], a[152:155], v[76:79], v[248:251]
buffer_load_dwordx4 a[236:239], v1, s[12:15], s38 offen offset:2048 sc1
v_mfma_f32_16x16x32_bf16 v[252:255], a[156:159], v[76:79], v[252:255]
buffer_load_dwordx4 a[240:243], v1, s[12:15], s37 offen offset:3072 sc1
v_mfma_f32_16x16x32_bf16 v[128:131], a[128:131], v[64:67], v[128:131]
buffer_load_dwordx4 a[244:247], v1, s[12:15], s38 offen offset:3072 sc1
v_mfma_f32_16x16x32_bf16 v[132:135], a[132:135], v[64:67], v[132:135]
s_cmp_eq_u32 s29, 0
s_cselect_b32 s59, 1, 0
s_load_dwordx2 s[24:25], s[0:1], 0
s_load_dwordx2 s[28:29], s[0:1], 72
v_mfma_f32_16x16x32_bf16 v[136:139], a[136:139], v[64:67], v[136:139]
ds_write_b128 v2, v[192:195] offset:0
v_mfma_f32_16x16x32_bf16 v[140:143], a[140:143], v[64:67], v[140:143]
ds_write_b128 v2, v[196:199] offset:1024
v_mfma_f32_16x16x32_bf16 v[144:147], a[144:147], v[64:67], v[144:147]
ds_write_b128 v2, v[200:203] offset:2048
v_mfma_f32_16x16x32_bf16 v[148:151], a[148:151], v[64:67], v[148:151]
ds_write_b128 v2, v[204:207] offset:3072
v_mfma_f32_16x16x32_bf16 v[152:155], a[152:155], v[64:67], v[152:155]
ds_write_b128 v2, v[208:211] offset:4096
v_mfma_f32_16x16x32_bf16 v[156:159], a[156:159], v[64:67], v[156:159]
ds_write_b128 v2, v[212:215] offset:5120
v_mfma_f32_16x16x32_bf16 v[160:163], a[128:131], v[68:71], v[160:163]
ds_write_b128 v2, v[216:219] offset:6144
v_mfma_f32_16x16x32_bf16 v[164:167], a[132:135], v[68:71], v[164:167]
ds_write_b128 v2, v[220:223] offset:7168
v_mfma_f32_16x16x32_bf16 v[168:171], a[136:139], v[68:71], v[168:171]
v_mov_b32 v29, v32
v_mfma_f32_16x16x32_bf16 v[172:175], a[140:143], v[68:71], v[172:175]
ds_write_b64 v14, v[28:29]
v_mfma_f32_16x16x32_bf16 v[176:179], a[144:147], v[68:71], v[176:179]
ds_write_b128 v2, v[224:227] offset:8192
v_mfma_f32_16x16x32_bf16 v[180:183], a[148:151], v[68:71], v[180:183]
ds_write_b128 v2, v[228:231] offset:9216
v_mfma_f32_16x16x32_bf16 v[184:187], a[152:155], v[68:71], v[184:187]
ds_write_b128 v2, v[232:235] offset:10240
v_mfma_f32_16x16x32_bf16 v[188:191], a[156:159], v[68:71], v[188:191]
ds_write_b128 v2, v[236:239] offset:11264
ds_write_b128 v2, v[240:243] offset:12288
ds_write_b128 v2, v[244:247] offset:13312
ds_write_b128 v2, v[248:251] offset:14336
ds_write_b128 v2, v[252:255] offset:15360
v_bfe_u32 v54, v0, 2, 4
v_and_b32 v55, 3, v0
v_and_b32 v56, 7, v54
v_lshlrev_b32 v38, 8, v54
v_lshl_add_u32 v38, v55, 3, v38
v_lshl_add_u32 v38, v56, 5, v38
v_xor_b32 v39, 32, v38
v_xor_b32 v40, 64, v38
v_xor_b32 v41, 96, v38
v_xor_b32 v42, 128, v38
v_xor_b32 v43, 160, v38
v_xor_b32 v44, 192, v38
v_xor_b32 v45, 224, v38
v_lshlrev_b32 v62, 5, v54
v_lshl_add_u32 v62, v55, 3, v62
v_add_u32 v62, 147456, v62
s_waitcnt lgkmcnt(0)
s_barrier
ds_read_b64 v[16:17], v15
ds_read_b128 v[64:67], v3 offset:0
ds_read_b128 v[68:71], v3 offset:1024
ds_read_b128 v[72:75], v3 offset:2048
ds_read_b128 v[76:79], v3 offset:3072
ds_read_b128 v[80:83], v3 offset:4096
ds_read_b128 v[84:87], v3 offset:5120
ds_read_b128 v[88:91], v3 offset:6144
ds_read_b128 v[92:95], v3 offset:7168
ds_read_b128 v[96:99], v3 offset:8192
ds_read_b128 v[100:103], v3 offset:9216
ds_read_b128 v[104:107], v3 offset:10240
ds_read_b128 v[108:111], v3 offset:11264
ds_read_b128 v[112:115], v3 offset:12288
ds_read_b128 v[116:119], v3 offset:13312
s_waitcnt lgkmcnt(14)
v_add_f32 v6, v24, v16
v_mov_b32 v7, v6
s_nop 1
v_permlane16_swap_b32 v6, v7
v_add_f32 v6, v6, v7
v_mov_b32 v7, v6
s_nop 1
v_permlane32_swap_b32 v6, v7
v_add_f32 v6, v6, v7
v_add_u32 v7, 0xde800000, v6
v_cmp_lt_u32 vcc, 0x3c000000, v7
v_rcp_f32 v6, v6
s_or_b64 s[54:55], s[54:55], vcc
v_add_f32 v8, v26, v17
v_mov_b32 v9, v8
s_nop 1
v_permlane16_swap_b32 v8, v9
v_add_f32 v8, v8, v9
v_mov_b32 v9, v8
s_nop 1
v_permlane32_swap_b32 v8, v9
v_add_f32 v8, v8, v9
v_add_u32 v9, 0xde800000, v8
v_cmp_lt_u32 vcc, 0x3c000000, v9
v_rcp_f32 v8, v8
s_or_b64 s[54:55], s[54:55], vcc
ds_read_b128 v[120:123], v3 offset:14336
ds_read_b128 v[124:127], v3 offset:15360
s_waitcnt lgkmcnt(14)
v_pk_add_f32 v[128:129], v[128:129], v[64:65]
v_pk_add_f32 v[130:131], v[130:131], v[66:67]
v_pk_add_f32 v[132:133], v[132:133], v[68:69]
v_pk_add_f32 v[134:135], v[134:135], v[70:71]
v_pk_mul_f32 v[128:129], v[128:129], v[6:7] op_sel_hi:[1,0]
v_pk_mul_f32 v[130:131], v[130:131], v[6:7] op_sel_hi:[1,0]
v_pk_mul_f32 v[132:133], v[132:133], v[6:7] op_sel_hi:[1,0]
v_pk_mul_f32 v[134:135], v[134:135], v[6:7] op_sel_hi:[1,0]
v_cvt_pk_bf16_f32 v192, v128, v129
v_cvt_pk_bf16_f32 v193, v130, v131
v_cvt_pk_bf16_f32 v194, v132, v133
v_cvt_pk_bf16_f32 v195, v134, v135
s_lshl_b32 s37, s41, 10
s_and_b32 s37, s37, 0x3000
s_add_u32 s37, s37, s85
buffer_load_dwordx4 a[0:3], v1, s[12:15], s37 offen offset:0 sc1
s_waitcnt lgkmcnt(12)
v_pk_add_f32 v[136:137], v[136:137], v[72:73]
v_pk_add_f32 v[138:139], v[138:139], v[74:75]
v_pk_add_f32 v[140:141], v[140:141], v[76:77]
v_pk_add_f32 v[142:143], v[142:143], v[78:79]
v_pk_mul_f32 v[136:137], v[136:137], v[6:7] op_sel_hi:[1,0]
v_pk_mul_f32 v[138:139], v[138:139], v[6:7] op_sel_hi:[1,0]
v_pk_mul_f32 v[140:141], v[140:141], v[6:7] op_sel_hi:[1,0]
v_pk_mul_f32 v[142:143], v[142:143], v[6:7] op_sel_hi:[1,0]
v_cvt_pk_bf16_f32 v200, v136, v137
v_cvt_pk_bf16_f32 v201, v138, v139
v_cvt_pk_bf16_f32 v202, v140, v141
v_cvt_pk_bf16_f32 v203, v142, v143
s_add_u32 s38, s37, 18432
buffer_load_dwordx4 a[4:7], v1, s[12:15], s38 offen offset:0 sc1
s_waitcnt lgkmcnt(10)
v_pk_add_f32 v[144:145], v[144:145], v[80:81]
v_pk_add_f32 v[146:147], v[146:147], v[82:83]
v_pk_add_f32 v[148:149], v[148:149], v[84:85]
v_pk_add_f32 v[150:151], v[150:151], v[86:87]
v_pk_mul_f32 v[144:145], v[144:145], v[6:7] op_sel_hi:[1,0]
v_pk_mul_f32 v[146:147], v[146:147], v[6:7] op_sel_hi:[1,0]
v_pk_mul_f32 v[148:149], v[148:149], v[6:7] op_sel_hi:[1,0]
v_pk_mul_f32 v[150:151], v[150:151], v[6:7] op_sel_hi:[1,0]
v_cvt_pk_bf16_f32 v208, v144, v145
v_cvt_pk_bf16_f32 v209, v146, v147
v_cvt_pk_bf16_f32 v210, v148, v149
v_cvt_pk_bf16_f32 v211, v150, v151
buffer_load_dwordx4 a[8:11], v1, s[12:15], s37 offen offset:1024 sc1
s_waitcnt lgkmcnt(8)
v_pk_add_f32 v[152:153], v[152:153], v[88:89]
v_pk_add_f32 v[154:155], v[154:155], v[90:91]
v_pk_add_f32 v[156:157], v[156:157], v[92:93]
v_pk_add_f32 v[158:159], v[158:159], v[94:95]
v_pk_mul_f32 v[152:153], v[152:153], v[6:7] op_sel_hi:[1,0]
v_pk_mul_f32 v[154:155], v[154:155], v[6:7] op_sel_hi:[1,0]
v_pk_mul_f32 v[156:157], v[156:157], v[6:7] op_sel_hi:[1,0]
v_pk_mul_f32 v[158:159], v[158:159], v[6:7] op_sel_hi:[1,0]
v_cvt_pk_bf16_f32 v216, v152, v153
v_cvt_pk_bf16_f32 v217, v154, v155
v_cvt_pk_bf16_f32 v218, v156, v157
v_cvt_pk_bf16_f32 v219, v158, v159
buffer_load_dwordx4 a[12:15], v1, s[12:15], s38 offen offset:1024 sc1
s_waitcnt lgkmcnt(6)
v_pk_add_f32 v[160:161], v[160:161], v[96:97]
v_pk_add_f32 v[162:163], v[162:163], v[98:99]
v_pk_add_f32 v[164:165], v[164:165], v[100:101]
v_pk_add_f32 v[166:167], v[166:167], v[102:103]
v_pk_mul_f32 v[160:161], v[160:161], v[8:9] op_sel_hi:[1,0]
v_pk_mul_f32 v[162:163], v[162:163], v[8:9] op_sel_hi:[1,0]
v_pk_mul_f32 v[164:165], v[164:165], v[8:9] op_sel_hi:[1,0]
v_pk_mul_f32 v[166:167], v[166:167], v[8:9] op_sel_hi:[1,0]
v_cvt_pk_bf16_f32 v196, v160, v161
v_cvt_pk_bf16_f32 v197, v162, v163
v_cvt_pk_bf16_f32 v198, v164, v165
v_cvt_pk_bf16_f32 v199, v166, v167
buffer_load_dwordx4 a[16:19], v1, s[12:15], s37 offen offset:2048 sc1
s_waitcnt lgkmcnt(4)
v_pk_add_f32 v[168:169], v[168:169], v[104:105]
v_pk_add_f32 v[170:171], v[170:171], v[106:107]
v_pk_add_f32 v[172:173], v[172:173], v[108:109]
v_pk_add_f32 v[174:175], v[174:175], v[110:111]
v_pk_mul_f32 v[168:169], v[168:169], v[8:9] op_sel_hi:[1,0]
v_pk_mul_f32 v[170:171], v[170:171], v[8:9] op_sel_hi:[1,0]
v_pk_mul_f32 v[172:173], v[172:173], v[8:9] op_sel_hi:[1,0]
v_pk_mul_f32 v[174:175], v[174:175], v[8:9] op_sel_hi:[1,0]
v_cvt_pk_bf16_f32 v204, v168, v169
v_cvt_pk_bf16_f32 v205, v170, v171
v_cvt_pk_bf16_f32 v206, v172, v173
v_cvt_pk_bf16_f32 v207, v174, v175
buffer_load_dwordx4 a[20:23], v1, s[12:15], s38 offen offset:2048 sc1
s_waitcnt lgkmcnt(2)
v_pk_add_f32 v[176:177], v[176:177], v[112:113]
v_pk_add_f32 v[178:179], v[178:179], v[114:115]
v_pk_add_f32 v[180:181], v[180:181], v[116:117]
v_pk_add_f32 v[182:183], v[182:183], v[118:119]
v_pk_mul_f32 v[176:177], v[176:177], v[8:9] op_sel_hi:[1,0]
v_pk_mul_f32 v[178:179], v[178:179], v[8:9] op_sel_hi:[1,0]
v_pk_mul_f32 v[180:181], v[180:181], v[8:9] op_sel_hi:[1,0]
v_pk_mul_f32 v[182:183], v[182:183], v[8:9] op_sel_hi:[1,0]
v_cvt_pk_bf16_f32 v212, v176, v177
v_cvt_pk_bf16_f32 v213, v178, v179
v_cvt_pk_bf16_f32 v214, v180, v181
v_cvt_pk_bf16_f32 v215, v182, v183
buffer_load_dwordx4 a[24:27], v1, s[12:15], s37 offen offset:3072 sc1
s_waitcnt lgkmcnt(0)
v_pk_add_f32 v[184:185], v[184:185], v[120:121]
v_pk_add_f32 v[186:187], v[186:187], v[122:123]
v_pk_add_f32 v[188:189], v[188:189], v[124:125]
v_pk_add_f32 v[190:191], v[190:191], v[126:127]
v_pk_mul_f32 v[184:185], v[184:185], v[8:9] op_sel_hi:[1,0]
v_pk_mul_f32 v[186:187], v[186:187], v[8:9] op_sel_hi:[1,0]
v_pk_mul_f32 v[188:189], v[188:189], v[8:9] op_sel_hi:[1,0]
v_pk_mul_f32 v[190:191], v[190:191], v[8:9] op_sel_hi:[1,0]
v_cvt_pk_bf16_f32 v220, v184, v185
v_cvt_pk_bf16_f32 v221, v186, v187
v_cvt_pk_bf16_f32 v222, v188, v189
v_cvt_pk_bf16_f32 v223, v190, v191
buffer_load_dwordx4 a[28:31], v1, s[12:15], s38 offen offset:3072 sc1
v_mfma_f32_16x16x32_bf16 v[20:23], a[32:35], v[192:195], v[20:23]
v_mfma_f32_16x16x32_bf16 v[20:23], a[32:35], v[200:203], v[20:23]
v_mfma_f32_16x16x32_bf16 v[20:23], a[32:35], v[208:211], v[20:23]
v_mfma_f32_16x16x32_bf16 v[20:23], a[32:35], v[216:219], v[20:23]
v_mfma_f32_16x16x32_bf16 v[20:23], a[32:35], v[196:199], v[20:23]
v_mfma_f32_16x16x32_bf16 v[20:23], a[32:35], v[204:207], v[20:23]
v_mfma_f32_16x16x32_bf16 v[20:23], a[32:35], v[212:215], v[20:23]
v_mfma_f32_16x16x32_bf16 v[20:23], a[32:35], v[220:223], v[20:23]
s_lshl_b32 s60, s3, 2
s_add_u32 s60, s60, 110592
v_mov_b32 v17, s60
L_k2_check:
s_nop 4
v_cmp_u_f32 vcc, v20, v20
s_nop 0
s_or_b64 s[54:55], s[54:55], vcc
s_cmp_lg_u64 s[54:55], 0
s_cselect_b32 s60, s59, 0
v_mov_b32 v16, s60
ds_write_b32 v17, v16
L_k2_last:
L_kt_entry:
s_mov_b32 s60, s82
s_mov_b32 s61, s82
s_mov_b32 s58, s83
ds_read_b64_tr_b16 a[48:49], v38 offset:0
ds_read_b64_tr_b16 a[50:51], v38 offset:4096
ds_read_b64_tr_b16 a[52:53], v39 offset:0
ds_read_b64_tr_b16 a[54:55], v39 offset:4096
ds_read_b64_tr_b16 a[56:57], v40 offset:0
ds_read_b64_tr_b16 a[58:59], v40 offset:4096
ds_read_b64_tr_b16 a[60:61], v41 offset:0
ds_read_b64_tr_b16 a[62:63], v41 offset:4096
ds_read_b64_tr_b16 a[64:65], v42 offset:0
ds_read_b64_tr_b16 a[66:67], v42 offset:4096
v_lshrrev_b32 v20, 4, v0
v_and_b32 v21, 15, v0
v_lshlrev_b32 v22, 1, v20
v_xor_b32 v22, v21, v22
v_lshlrev_b32 v22, 4, v22
v_lshrrev_b32 v25, 1, v0
v_and_b32 v26, 1, v0
v_lshlrev_b32 v26, 5, v26
v_mul_u32_u24 v27, 1152, v25
v_add_u32 v6, v27, v26
s_lshl_b32 s20, s32, 9
s_lshl_b32 s21, s3, 3
s_add_u32 s21, s21, s20
s_mul_i32 s21, s21, 1152
s_lshl_b32 s22, s33, 8
s_add_u32 s21, s21, s22
s_bfe_u32 s80, s41, 131072
s_mul_i32 s80, s80, 147456
s_add_u32 s80, s80, s21
s_bfe_u32 s81, s41, 131074
s_mul_i32 s81, s81, 147456
s_add_u32 s81, s81, s21
s_bfe_u32 s82, s41, 131076
s_mul_i32 s82, s82, 147456
s_add_u32 s82, s82, s21
s_bfe_u32 s83, s41, 131078
s_mul_i32 s83, s83, 147456
s_add_u32 s83, s83, s21
s_lshr_b32 s4, s33, 1
s_lshl_b32 s4, s4, 6
s_and_b32 s20, s33, 1
s_lshl_b32 s20, s20, 4
s_add_u32 s4, s4, s20
s_mul_i32 s20, s3, 27648
s_add_u32 s20, s20, s4
s_sub_u32 s20, s20, s22
s_add_u32 s84, s20, 1024
s_lshl_b32 s50, s3, 10
s_add_u32 s50, s50, 147456
v_mov_b32 v64, 110592
v_mov_b32 v27, s60
v_accvgpr_write_b32 a248, v27
s_add_u32 s72, s6, 131072
s_and_b32 s23, s3, 1
s_lshr_b32 s5, s3, 1
s_lshl_b32 s20, s23, 1
s_add_u32 s20, s20, s5
s_lshl_b32 s21, s34, 2
s_sub_u32 s20, s20, s21
s_lshl_b32 s20, s20, 1
s_add_u32 s36, s20, 120
s_mul_i32 s53, s36, 18432
s_lshl_b32 s20, s33, 12
s_add_u32 s53, s53, s42
s_add_u32 s53, s53, s20
s_add_u32 s54, s53, 18432
v_add_u32 v46, 65536, v38
v_add_u32 v47, 65536, v39
v_add_u32 v48, 65536, v40
v_add_u32 v49, 65536, v41
v_add_u32 v50, 65536, v42
v_add_u32 v51, 65536, v43
v_add_u32 v52, 65536, v44
v_add_u32 v53, 65536, v45
s_lshl_b32 s49, s3, 11
v_mul_u32_u24 v23, 1152, v20
v_add_u32 v2, v23, v22
v_xor_b32 v24, 128, v22
v_add_u32 v3, v23, v24
s_waitcnt lgkmcnt(10)
s_barrier
ds_read_b128 v[64:67], v64
s_add_u32 s52, s80, s84
s_add_u32 m0, s50, 0
s_nop 0
buffer_load_dwordx4 v6, s[16:19], s52 offen lds
v_cmp_ne_u32 vcc, s60, v37
s_waitcnt lgkmcnt(0)
v_or_b32 v64, v64, v65
v_or3_b32 v64, v64, v66, v67
s_mov_b64 exec, 1
v_readfirstlane_b32 s20, v64
s_nop 0
s_cmp_lg_u32 s20, 0
s_cbranch_scc1 L_k2_redo
buffer_store_dword a248, off, s[12:15], s72 sc1
s_mov_b64 exec, -1
s_cbranch_vccnz L_kt_pas
L_kt_par:
s_waitcnt vmcnt(16)
v_mfma_f32_16x16x32_bf16 v[88:91], a[48:51], a[216:219], 0
ds_read_b64_tr_b16 a[68:69], v43 offset:0
ds_read_b64_tr_b16 a[70:71], v43 offset:4096
v_mfma_f32_16x16x32_bf16 v[92:95], a[48:51], a[220:223], 0
buffer_store_dwordx4 v[192:195], v1, s[12:15], s53 offen offset:0 sc1
v_mfma_f32_16x16x32_bf16 v[96:99], a[52:55], a[216:219], 0
ds_read_b64_tr_b16 a[72:73], v44 offset:0
ds_read_b64_tr_b16 a[74:75], v44 offset:4096
v_mfma_f32_16x16x32_bf16 v[100:103], a[52:55], a[220:223], 0
v_mul_u32_u24 v23, 9216, v20
v_add_u32 v4, v23, v22
v_mfma_f32_16x16x32_bf16 v[104:107], a[56:59], a[216:219], 0
ds_read_b64_tr_b16 a[76:77], v45 offset:0
ds_read_b64_tr_b16 a[78:79], v45 offset:4096
v_mfma_f32_16x16x32_bf16 v[108:111], a[56:59], a[220:223], 0
buffer_store_dwordx4 v[196:199], v1, s[12:15], s54 offen offset:0 sc1
v_mfma_f32_16x16x32_bf16 v[112:115], a[60:63], a[216:219], 0
ds_read_b64_tr_b16 a[48:49], v38 offset:8192
ds_read_b64_tr_b16 a[50:51], v38 offset:12288
v_mfma_f32_16x16x32_bf16 v[116:119], a[60:63], a[220:223], 0
v_add_u32 v5, v23, v24
s_lshl_b32 s20, s32, 10
v_mfma_f32_16x16x32_bf16 v[120:123], a[64:67], a[216:219], 0
s_waitcnt lgkmcnt(6)
ds_read_b64_tr_b16 a[52:53], v39 offset:8192
ds_read_b64_tr_b16 a[54:55], v39 offset:12288
v_mfma_f32_16x16x32_bf16 v[124:127], a[64:67], a[220:223], 0
buffer_store_dwordx4 v[200:203], v1, s[12:15], s53 offen offset:1024 sc1
v_mfma_f32_16x16x32_bf16 v[128:131], a[68:71], a[216:219], 0
s_waitcnt lgkmcnt(6)
ds_read_b64_tr_b16 a[56:57], v40 offset:8192
ds_read_b64_tr_b16 a[58:59], v40 offset:12288
v_mfma_f32_16x16x32_bf16 v[132:135], a[68:71], a[220:223], 0
s_add_u32 s20, s20, s22
s_lshl_b32 s21, s23, 8
s_lshl_b32 s22, s5, 4
v_mfma_f32_16x16x32_bf16 v[136:139], a[72:75], a[216:219], 0
s_waitcnt lgkmcnt(6)
ds_read_b64_tr_b16 a[60:61], v41 offset:8192
ds_read_b64_tr_b16 a[62:63], v41 offset:12288
v_mfma_f32_16x16x32_bf16 v[140:143], a[72:75], a[220:223], 0
buffer_store_dwordx4 v[204:207], v1, s[12:15], s54 offen offset:1024 sc1
v_mfma_f32_16x16x32_bf16 v[144:147], a[76:79], a[216:219], 0
s_waitcnt vmcnt(18) lgkmcnt(6)
ds_read_b64_tr_b16 a[64:65], v42 offset:8192
ds_read_b64_tr_b16 a[66:67], v42 offset:12288
v_mfma_f32_16x16x32_bf16 v[148:151], a[76:79], a[220:223], 0
s_add_u32 s21, s21, s22
s_mul_i32 s21, s21, 9216
s_add_u32 s43, s21, s20
v_mfma_f32_16x16x32_bf16 v[88:91], a[48:51], a[224:227], v[88:91]
s_waitcnt lgkmcnt(6)
ds_read_b64_tr_b16 a[68:69], v43 offset:8192
ds_read_b64_tr_b16 a[70:71], v43 offset:12288
v_mfma_f32_16x16x32_bf16 v[92:95], a[48:51], a[228:231], v[92:95]
buffer_store_dwordx4 v[208:211], v1, s[12:15], s53 offen offset:2048 sc1
v_mfma_f32_16x16x32_bf16 v[96:99], a[52:55], a[224:227], v[96:99]
s_waitcnt lgkmcnt(6)
ds_read_b64_tr_b16 a[72:73], v44 offset:8192
ds_read_b64_tr_b16 a[74:75], v44 offset:12288
v_mfma_f32_16x16x32_bf16 v[100:103], a[52:55], a[228:231], v[100:103]
s_add_u32 s52, s81, s84
s_mul_i32 s21, s3, 73728
s_add_u32 m0, s50, 4096
v_mfma_f32_16x16x32_bf16 v[104:107], a[56:59], a[224:227], v[104:107]
s_waitcnt lgkmcnt(6)
ds_read_b64_tr_b16 a[76:77], v45 offset:8192
ds_read_b64_tr_b16 a[78:79], v45 offset:12288
v_mfma_f32_16x16x32_bf16 v[108:111], a[56:59], a[228:231], v[108:111]
s_add_u32 s44, s21, s20
v_and_b32 v28, 3, v0
v_bfe_u32 v27, v0, 2, 2
v_mfma_f32_16x16x32_bf16 v[112:115], a[60:63], a[224:227], v[112:115]
s_waitcnt lgkmcnt(6)
ds_read_b64_tr_b16 a[48:49], v46 offset:0
ds_read_b64_tr_b16 a[50:51], v46 offset:4096
v_mfma_f32_16x16x32_bf16 v[116:119], a[60:63], a[228:231], v[116:119]
buffer_load_dwordx4 v6, s[16:19], s52 offen lds
buffer_store_dwordx4 v[212:215], v1, s[12:15], s54 offen offset:2048 sc1
v_mfma_f32_16x16x32_bf16 v[120:123], a[64:67], a[224:227], v[120:123]
s_waitcnt lgkmcnt(6)
ds_read_b64_tr_b16 a[52:53], v47 offset:0
ds_read_b64_tr_b16 a[54:55], v47 offset:4096
v_lshrrev_b32 v30, 5, v0
v_mfma_f32_16x16x32_bf16 v[124:127], a[64:67], a[228:231], v[124:127]
s_lshl_b32 s37, s41, 8
s_and_b32 s37, s37, 0x3000
s_add_u32 s37, s37, s85
v_and_b32 v31, 1, v20
v_mfma_f32_16x16x32_bf16 v[128:131], a[68:71], a[224:227], v[128:131]
s_waitcnt lgkmcnt(6)
ds_read_b64_tr_b16 a[56:57], v48 offset:0
ds_read_b64_tr_b16 a[58:59], v48 offset:4096
buffer_load_dwordx4 v[160:163], v1, s[12:15], s37 offen offset:0 sc1
v_mul_u32_u24 v29, 1152, v28
v_mfma_f32_16x16x32_bf16 v[132:135], a[68:71], a[228:231], v[132:135]
buffer_store_dwordx4 v[216:219], v1, s[12:15], s53 offen offset:3072 sc1
v_lshl_add_u32 v33, v20, 5, v29
v_mfma_f32_16x16x32_bf16 v[136:139], a[72:75], a[224:227], v[136:139]
s_waitcnt lgkmcnt(6)
ds_read_b64_tr_b16 a[60:61], v49 offset:0
ds_read_b64_tr_b16 a[62:63], v49 offset:4096
v_lshl_add_u32 v14, v27, 3, v33
v_mfma_f32_16x16x32_bf16 v[140:143], a[72:75], a[228:231], v[140:143]
s_add_u32 s38, s37, 18432
v_bfe_u32 v32, v0, 2, 1
v_lshl_add_u32 v33, v30, 5, v29
v_mfma_f32_16x16x32_bf16 v[144:147], a[76:79], a[224:227], v[144:147]
s_waitcnt vmcnt(21) lgkmcnt(6)
ds_read_b64_tr_b16 a[64:65], v50 offset:0
ds_read_b64_tr_b16 a[66:67], v50 offset:4096
buffer_load_dwordx4 v[164:167], v1, s[12:15], s38 offen offset:0 sc1
v_mfma_f32_16x16x32_bf16 v[148:151], a[76:79], a[228:231], v[148:151]
s_add_u32 s52, s82, 110592
s_add_u32 m0, s49, 49152
buffer_store_dwordx4 v[220:223], v1, s[12:15], s54 offen offset:3072 sc1
v_lshl_add_u32 v33, v32, 3, v33
v_mfma_f32_16x16x32_bf16 v[88:91], a[48:51], a[232:235], v[88:91]
s_waitcnt lgkmcnt(6)
ds_read_b64_tr_b16 a[68:69], v51 offset:0
ds_read_b64_tr_b16 a[70:71], v51 offset:4096
v_lshl_add_u32 v15, v31, 2, v33
v_mfma_f32_16x16x32_bf16 v[92:95], a[48:51], a[236:239], v[92:95]
buffer_load_dwordx4 v2, s[16:19], s52 offen lds
s_mov_b32 s26, 2359296
v_mfma_f32_16x16x32_bf16 v[96:99], a[52:55], a[232:235], v[96:99]
s_waitcnt lgkmcnt(6)
ds_read_b64_tr_b16 a[72:73], v52 offset:0
ds_read_b64_tr_b16 a[74:75], v52 offset:4096
s_mov_b32 s27, 0x20000
v_mfma_f32_16x16x32_bf16 v[100:103], a[52:55], a[236:239], v[100:103]
s_add_u32 s52, s82, 115200
s_add_u32 m0, s49, 50176
s_mov_b32 s30, 2359296
v_mfma_f32_16x16x32_bf16 v[104:107], a[56:59], a[232:235], v[104:107]
s_waitcnt lgkmcnt(6)
ds_read_b64_tr_b16 a[76:77], v53 offset:0
ds_read_b64_tr_b16 a[78:79], v53 offset:4096
s_mov_b32 s31, 0x20000
v_mfma_f32_16x16x32_bf16 v[108:111], a[56:59], a[236:239], v[108:111]
s_waitcnt vmcnt(13)
s_barrier
buffer_load_dwordx4 v3, s[16:19], s52 offen lds
s_lshl_b32 s21, s34, 3
v_mfma_f32_16x16x32_bf16 v[112:115], a[60:63], a[232:235], v[112:115]
s_waitcnt lgkmcnt(6)
ds_read_b64_tr_b16 a[48:49], v46 offset:8192
ds_read_b64_tr_b16 a[50:51], v46 offset:12288
s_add_u32 s66, s21, s32
v_mfma_f32_16x16x32_bf16 v[116:119], a[60:63], a[236:239], v[116:119]
s_add_u32 s52, s83, 0
s_add_u32 m0, s49, 57344
s_sub_u32 s21, 120, s21
v_mfma_f32_16x16x32_bf16 v[120:123], a[64:67], a[232:235], v[120:123]
s_waitcnt lgkmcnt(6)
ds_read_b64_tr_b16 a[52:53], v47 offset:8192
ds_read_b64_tr_b16 a[54:55], v47 offset:12288
buffer_load_dwordx4 v2, s[16:19], s52 offen lds
s_add_u32 s67, s21, s32
v_mfma_f32_16x16x32_bf16 v[124:127], a[64:67], a[236:239], v[124:127]
s_mul_i32 s21, s33, 4608
s_add_u32 s52, s83, 4608
s_add_u32 m0, s49, 58368
v_mfma_f32_16x16x32_bf16 v[128:131], a[68:71], a[232:235], v[128:131]
s_waitcnt lgkmcnt(6)
ds_read_b64_tr_b16 a[56:57], v48 offset:8192
ds_read_b64_tr_b16 a[58:59], v48 offset:12288
s_mul_i32 s86, s3, 1152
v_mfma_f32_16x16x32_bf16 v[132:135], a[68:71], a[236:239], v[132:135]
s_add_u32 s86, s86, s21
s_lshl_b32 s22, s3, 8
s_add_u32 s87, s21, s22
v_mfma_f32_16x16x32_bf16 v[136:139], a[72:75], a[232:235], v[136:139]
s_waitcnt lgkmcnt(6)
ds_read_b64_tr_b16 a[60:61], v49 offset:8192
ds_read_b64_tr_b16 a[62:63], v49 offset:12288
buffer_load_dwordx4 v3, s[16:19], s52 offen lds
v_mfma_f32_16x16x32_bf16 v[140:143], a[72:75], a[236:239], v[140:143]
s_add_u32 s52, s82, s84
s_add_u32 m0, s50, 8192
s_lshl_b32 s88, s5, 6
v_mfma_f32_16x16x32_bf16 v[144:147], a[76:79], a[232:235], v[144:147]
s_waitcnt lgkmcnt(6)
ds_read_b64_tr_b16 a[64:65], v50 offset:8192
ds_read_b64_tr_b16 a[66:67], v50 offset:12288
v_mfma_f32_16x16x32_bf16 v[148:151], a[76:79], a[236:239], v[148:151]
buffer_load_dwordx4 v6, s[16:19], s52 offen lds
s_add_u32 s88, s88, s21
v_mfma_f32_16x16x32_bf16 v[88:91], a[48:51], a[240:243], v[88:91]
s_waitcnt lgkmcnt(6)
ds_read_b64_tr_b16 a[68:69], v51 offset:8192
ds_read_b64_tr_b16 a[70:71], v51 offset:12288
s_lshl_b32 s21, s23, 4
v_mfma_f32_16x16x32_bf16 v[92:95], a[48:51], a[244:247], v[92:95]
s_add_u32 s88, s88, s21
s_add_u32 s88, s88, 1024
s_lshl_b32 s21, s33, 6
v_mfma_f32_16x16x32_bf16 v[96:99], a[52:55], a[240:243], v[96:99]
s_waitcnt lgkmcnt(6)
ds_read_b64_tr_b16 a[72:73], v52 offset:8192
ds_read_b64_tr_b16 a[74:75], v52 offset:12288
v_mfma_f32_16x16x32_bf16 v[100:103], a[52:55], a[244:247], v[100:103]
buffer_load_dwordx4 v[168:171], v1, s[12:15], s37 offen offset:1024 sc1
v_mfma_f32_16x16x32_bf16 v[104:107], a[56:59], a[240:243], v[104:107]
s_waitcnt lgkmcnt(6)
ds_read_b64_tr_b16 a[76:77], v53 offset:8192
ds_read_b64_tr_b16 a[78:79], v53 offset:12288
s_add_u32 s89, s21, s22
v_mfma_f32_16x16x32_bf16 v[108:111], a[56:59], a[244:247], v[108:111]
s_add_u32 s89, s89, 119537664
s_add_u32 s90, s89, s22
s_add_u32 s90, s90, 16384
v_mfma_f32_16x16x32_bf16 v[112:115], a[60:63], a[240:243], v[112:115]
s_waitcnt lgkmcnt(6)
ds_read_b64_tr_b16 a[48:49], v38 offset:16384
ds_read_b64_tr_b16 a[50:51], v38 offset:20480
buffer_load_dwordx4 v[172:175], v1, s[12:15], s38 offen offset:1024 sc1
v_mfma_f32_16x16x32_bf16 v[116:119], a[60:63], a[244:247], v[116:119]
v_lshl_add_u32 v33, v31, 1, v30
v_lshl_add_u32 v33, v33, 2, v27
v_mfma_f32_16x16x32_bf16 v[120:123], a[64:67], a[240:243], v[120:123]
s_waitcnt lgkmcnt(6)
ds_read_b64_tr_b16 a[52:53], v39 offset:16384
ds_read_b64_tr_b16 a[54:55], v39 offset:20480
v_mfma_f32_16x16x32_bf16 v[124:127], a[64:67], a[244:247], v[124:127]
buffer_load_dwordx4 v[176:179], v1, s[12:15], s37 offen offset:2048 sc1
v_mfma_f32_16x16x32_bf16 v[128:131], a[68:71], a[240:243], v[128:131]
s_waitcnt lgkmcnt(6)
ds_read_b64_tr_b16 a[56:57], v40 offset:16384
ds_read_b64_tr_b16 a[58:59], v40 offset:20480
v_lshlrev_b32 v33, 10, v33
v_mfma_f32_16x16x32_bf16 v[132:135], a[68:71], a[244:247], v[132:135]
v_lshl_add_u32 v16, v28, 4, v33
v_lshlrev_b32 v33, 8, v32
v_mfma_f32_16x16x32_bf16 v[136:139], a[72:75], a[240:243], v[136:139]
s_waitcnt lgkmcnt(6)
ds_read_b64_tr_b16 a[60:61], v41 offset:16384
ds_read_b64_tr_b16 a[62:63], v41 offset:20480
v_mfma_f32_16x16x32_bf16 v[140:143], a[72:75], a[244:247], v[140:143]
buffer_load_dwordx4 v[180:183], v1, s[12:15], s38 offen offset:2048 sc1
v_lshl_add_u32 v33, v28, 4, v33
v_mfma_f32_16x16x32_bf16 v[144:147], a[76:79], a[240:243], v[144:147]
s_waitcnt lgkmcnt(6)
ds_read_b64_tr_b16 a[64:65], v42 offset:16384
ds_read_b64_tr_b16 a[66:67], v42 offset:20480
v_bfrev_b32 v34, -2
v_mfma_f32_16x16x32_bf16 v[148:151], a[76:79], a[244:247], v[148:151]
v_cmp_gt_u32 vcc, 8, v0
s_nop 1
v_cndmask_b32 v17, v34, v33, vcc
v_mfma_f32_16x16x32_bf16 v[88:91], a[48:51], a[0:3], v[88:91]
s_waitcnt lgkmcnt(6)
ds_read_b64_tr_b16 a[68:69], v43 offset:16384
ds_read_b64_tr_b16 a[70:71], v43 offset:20480
v_mfma_f32_16x16x32_bf16 v[92:95], a[48:51], a[4:7], v[92:95]
buffer_load_dwordx4 v[184:187], v1, s[12:15], s37 offen offset:3072 sc1
v_mul_u32_u24 v29, 4608, v27
v_mfma_f32_16x16x32_bf16 v[96:99], a[52:55], a[0:3], v[96:99]
s_waitcnt lgkmcnt(6)
ds_read_b64_tr_b16 a[72:73], v44 offset:16384
ds_read_b64_tr_b16 a[74:75], v44 offset:20480
v_lshl_add_u32 v29, v28, 4, v29
v_mfma_f32_16x16x32_bf16 v[100:103], a[52:55], a[4:7], v[100:103]
v_lshl_add_u32 v9, v20, 6, v29
v_mul_u32_u24 v32, 18432, v30
v_mfma_f32_16x16x32_bf16 v[104:107], a[56:59], a[0:3], v[104:107]
s_waitcnt lgkmcnt(6)
ds_read_b64_tr_b16 a[76:77], v45 offset:16384
ds_read_b64_tr_b16 a[78:79], v45 offset:20480
buffer_load_dwordx4 v[188:191], v1, s[12:15], s38 offen offset:3072 sc1
v_mfma_f32_16x16x32_bf16 v[108:111], a[56:59], a[4:7], v[108:111]
s_lshl_b32 s37, s41, 6
v_lshl_add_u32 v29, v31, 6, v29
s_and_b32 s37, s37, 0x3000
v_mfma_f32_16x16x32_bf16 v[112:115], a[60:63], a[0:3], v[112:115]
s_waitcnt lgkmcnt(6)
ds_read_b64_tr_b16 a[48:49], v38 offset:24576
ds_read_b64_tr_b16 a[50:51], v38 offset:28672
v_add_u32 v10, v29, v32
v_mfma_f32_16x16x32_bf16 v[116:119], a[60:63], a[4:7], v[116:119]
s_add_u32 s37, s37, s85
ds_read_b64_tr_b16 a[80:81], v62 offset:0
v_and_b32 v29, 31, v0
v_mfma_f32_16x16x32_bf16 v[120:123], a[64:67], a[0:3], v[120:123]
s_waitcnt lgkmcnt(7)
ds_read_b64_tr_b16 a[52:53], v39 offset:24576
ds_read_b64_tr_b16 a[54:55], v39 offset:28672
buffer_load_dwordx4 a[164:167], v1, s[12:15], s37 offen offset:0 sc1
v_lshl_add_u32 v11, v29, 4, v32
v_mfma_f32_16x16x32_bf16 v[124:127], a[64:67], a[4:7], v[124:127]
s_mul_i32 s21, s32, 2359296
ds_read_b64_tr_b16 a[82:83], v62 offset:512
s_add_u32 s38, s37, 18432
v_mfma_f32_16x16x32_bf16 v[128:131], a[68:71], a[0:3], v[128:131]
s_waitcnt lgkmcnt(8)
ds_read_b64_tr_b16 a[56:57], v40 offset:24576
ds_read_b64_tr_b16 a[58:59], v40 offset:28672
s_add_u32 s76, s21, 100663296
v_mfma_f32_16x16x32_bf16 v[132:135], a[68:71], a[4:7], v[132:135]
s_mul_i32 s75, s33, 1152
ds_read_b64_tr_b16 a[84:85], v62 offset:1024
ds_read_b64_tr_b16 a[86:87], v62 offset:1536
buffer_load_dwordx4 a[168:171], v1, s[12:15], s38 offen offset:0 sc1
v_mfma_f32_16x16x32_bf16 v[136:139], a[72:75], a[0:3], v[136:139]
s_waitcnt lgkmcnt(10)
ds_read_b64_tr_b16 a[60:61], v41 offset:24576
ds_read_b64_tr_b16 a[62:63], v41 offset:28672
s_add_u32 s75, s75, s21
v_mfma_f32_16x16x32_bf16 v[140:143], a[72:75], a[4:7], v[140:143]
s_add_u32 s52, s83, 36864
ds_read_b64_tr_b16 a[88:89], v62 offset:2048
ds_read_b64_tr_b16 a[90:91], v62 offset:2560
v_add_u32 v54, 131072, v38
v_mfma_f32_16x16x32_bf16 v[144:147], a[76:79], a[0:3], v[144:147]
s_waitcnt lgkmcnt(12)
ds_read_b64_tr_b16 a[64:65], v42 offset:24576
ds_read_b64_tr_b16 a[66:67], v42 offset:28672
ds_read_b64_tr_b16 a[92:93], v62 offset:3072
ds_read_b64_tr_b16 a[94:95], v62 offset:3584
v_add_u32 v55, 131072, v39
v_mfma_f32_16x16x32_bf16 v[148:151], a[76:79], a[4:7], v[148:151]
v_lshrrev_b32 v72, 1, v0
s_add_u32 m0, s49, 114688
s_nop 0
buffer_load_dwordx4 v2, s[16:19], s52 offen lds
v_add_u32 v56, 131072, v40
v_mfma_f32_16x16x32_bf16 v[88:91], a[48:51], a[8:11], v[88:91]
s_waitcnt lgkmcnt(13)
ds_read_b64_tr_b16 a[68:69], v43 offset:24576
ds_read_b64_tr_b16 a[70:71], v43 offset:28672
v_add_u32 v57, 131072, v41
v_mfma_f32_16x16x32_bf16 v[92:95], a[48:51], a[12:15], v[92:95]
s_add_u32 s52, s83, 41472
v_and_b32 v74, 1, v0
v_lshlrev_b32 v74, 3, v74
v_lshl_add_u32 v72, v72, 7, v74
v_add_u32 v58, 131072, v42
v_mfma_f32_16x16x32_bf16 v[96:99], a[52:55], a[8:11], v[96:99]
s_waitcnt lgkmcnt(12)
ds_read_b64_tr_b16 a[72:73], v44 offset:24576
ds_read_b64_tr_b16 a[74:75], v44 offset:28672
s_lshl_b32 s91, s34, 12
s_add_u32 m0, s49, 115712
s_add_u32 s91, s91, 123863040
buffer_load_dwordx4 v3, s[16:19], s52 offen lds
buffer_load_dwordx2 v[74:75], v72, s[12:15], s91 offen sc1
v_add_u32 v59, 131072, v43
v_mfma_f32_16x16x32_bf16 v[100:103], a[52:55], a[12:15], v[100:103]
v_add_u32 v60, 131072, v44
s_add_u32 s52, s83, 73728
v_mfma_f32_16x16x32_bf16 v[104:107], a[56:59], a[8:11], v[104:107]
s_waitcnt lgkmcnt(10)
ds_read_b64_tr_b16 a[76:77], v45 offset:24576
ds_read_b64_tr_b16 a[78:79], v45 offset:28672
v_add_u32 v61, 131072, v45
v_mfma_f32_16x16x32_bf16 v[108:111], a[56:59], a[12:15], v[108:111]
s_add_u32 m0, s49, 122880
v_mul_u32_u24 v27, 9216, v25
v_add_u32 v8, v27, v26
v_mfma_f32_16x16x32_bf16 v[112:115], a[60:63], a[8:11], v[112:115]
s_waitcnt lgkmcnt(8)
buffer_load_dwordx4 v2, s[16:19], s52 offen lds
v_mfma_f32_16x16x32_bf16 v[116:119], a[60:63], a[12:15], v[116:119]
s_add_u32 s52, s83, 78336
s_add_u32 m0, s49, 123904
v_bfe_u32 v27, v25, 2, 2
v_mfma_f32_16x16x32_bf16 v[120:123], a[64:67], a[8:11], v[120:123]
s_waitcnt lgkmcnt(4)
v_lshlrev_b32 v27, 7, v27
v_and_b32 v29, 19, v25
v_mfma_f32_16x16x32_bf16 v[124:127], a[64:67], a[12:15], v[124:127]
s_waitcnt vmcnt(22)
s_barrier
buffer_load_dwordx4 v3, s[16:19], s52 offen lds
v_mfma_f32_16x16x32_bf16 v[128:131], a[68:71], a[8:11], v[128:131]
s_waitcnt lgkmcnt(2)
ds_read_b64_tr_b16 a[48:49], v46 offset:16384
ds_read_b64_tr_b16 a[50:51], v46 offset:20480
v_add_u32 v27, v27, v29
v_mfma_f32_16x16x32_bf16 v[132:135], a[68:71], a[12:15], v[132:135]
s_add_u32 s52, s83, s84
s_add_u32 m0, s50, 0
v_mul_u32_u24 v27, 9216, v27
v_mfma_f32_16x16x32_bf16 v[136:139], a[72:75], a[8:11], v[136:139]
s_waitcnt lgkmcnt(2)
ds_read_b64_tr_b16 a[52:53], v47 offset:16384
ds_read_b64_tr_b16 a[54:55], v47 offset:20480
v_add_u32 v7, v27, v26
v_mfma_f32_16x16x32_bf16 v[140:143], a[72:75], a[12:15], v[140:143]
buffer_load_dwordx4 v6, s[16:19], s52 offen lds
s_lshl_b32 s21, s32, 7
v_mfma_f32_16x16x32_bf16 v[144:147], a[76:79], a[8:11], v[144:147]
ds_read_b64_tr_b16 a[56:57], v48 offset:16384
ds_read_b64_tr_b16 a[58:59], v48 offset:20480
s_add_u32 s21, s21, s4
v_mfma_f32_16x16x32_bf16 v[148:151], a[76:79], a[12:15], v[148:151]
s_add_u32 s52, s83, 110592
s_add_u32 m0, s49, 106496
s_add_u32 s21, s21, 8192
v_mfma_f32_16x16x32_bf16 v[152:155], a[80:83], a[216:219], 0
ds_read_b64_tr_b16 a[60:61], v49 offset:16384
ds_read_b64_tr_b16 a[62:63], v49 offset:20480
buffer_load_dwordx4 v2, s[16:19], s52 offen lds
s_mul_i32 s22, s3, 36864
v_mfma_f32_16x16x32_bf16 v[156:159], a[80:83], a[220:223], 0
s_add_u32 s45, s21, s22
s_add_u32 s52, s83, 115200
s_add_u32 m0, s49, 107520
v_mfma_f32_16x16x32_bf16 v[152:155], a[84:87], a[224:227], v[152:155]
s_waitcnt lgkmcnt(6)
ds_read_b64_tr_b16 a[64:65], v50 offset:16384
ds_read_b64_tr_b16 a[66:67], v50 offset:20480
s_mul_i32 s22, s23, 294912
v_mfma_f32_16x16x32_bf16 v[156:159], a[84:87], a[228:231], v[156:159]
s_add_u32 s21, s21, s22
s_add_u32 s46, s21, 4718592
v_mul_u32_u24 v29, 2359296, v20
v_mfma_f32_16x16x32_bf16 v[88:91], a[48:51], a[16:19], v[88:91]
s_waitcnt lgkmcnt(6)
ds_read_b64_tr_b16 a[68:69], v51 offset:16384
ds_read_b64_tr_b16 a[70:71], v51 offset:20480
buffer_load_dwordx4 v3, s[16:19], s52 offen lds
v_mfma_f32_16x16x32_bf16 v[92:95], a[48:51], a[20:23], v[92:95]
s_add_u32 s72, s6, 98304
v_lshl_add_u32 v12, v21, 4, v29
v_bfe_u32 v32, v0, 3, 1
v_mfma_f32_16x16x32_bf16 v[96:99], a[52:55], a[16:19], v[96:99]
s_waitcnt lgkmcnt(6)
ds_read_b64_tr_b16 a[72:73], v52 offset:16384
ds_read_b64_tr_b16 a[74:75], v52 offset:20480
v_mfma_f32_16x16x32_bf16 v[100:103], a[52:55], a[20:23], v[100:103]
buffer_load_dwordx4 a[172:175], v1, s[12:15], s37 offen offset:1024 sc1
v_mfma_f32_16x16x32_bf16 v[104:107], a[56:59], a[16:19], v[104:107]
s_waitcnt lgkmcnt(6)
ds_read_b64_tr_b16 a[76:77], v53 offset:16384
ds_read_b64_tr_b16 a[78:79], v53 offset:20480
v_mul_u32_u24 v33, 9437184, v32
v_mfma_f32_16x16x32_bf16 v[108:111], a[56:59], a[20:23], v[108:111]
s_lshl_b32 s73, s33, 10
v_and_b32 v34, 7, v0
v_lshl_add_u32 v33, v34, 4, v33
v_mfma_f32_16x16x32_bf16 v[112:115], a[60:63], a[16:19], v[112:115]
s_waitcnt lgkmcnt(6)
v_add_u32 v13, v33, v29
v_cmp_eq_u32 s[64:65], 1, v32
v_mfma_f32_16x16x32_bf16 v[116:119], a[60:63], a[20:23], v[116:119]
buffer_load_dwordx4 a[176:179], v1, s[12:15], s38 offen offset:1024 sc1
v_mfma_f32_16x16x32_bf16 v[120:123], a[64:67], a[16:19], v[120:123]
s_waitcnt lgkmcnt(4)
v_lshlrev_b32 v33, 5, v28
v_add_u32 v19, 159744, v33
v_mfma_f32_16x16x32_bf16 v[124:127], a[64:67], a[20:23], v[124:127]
buffer_load_dwordx4 a[180:183], v1, s[12:15], s37 offen offset:2048 sc1
v_mfma_f32_16x16x32_bf16 v[128:131], a[68:71], a[16:19], v[128:131]
s_waitcnt lgkmcnt(2)
ds_read_b64_tr_b16 a[48:49], v46 offset:24576
ds_read_b64_tr_b16 a[50:51], v46 offset:28672
v_mfma_f32_16x16x32_bf16 v[132:135], a[68:71], a[20:23], v[132:135]
s_lshl_b32 s20, s3, 3
v_add_u32 v18, s20, v19
v_and_b32 v29, 1, v0
v_mfma_f32_16x16x32_bf16 v[136:139], a[72:75], a[16:19], v[136:139]
s_waitcnt lgkmcnt(2)
ds_read_b64_tr_b16 a[52:53], v47 offset:24576
ds_read_b64_tr_b16 a[54:55], v47 offset:28672
v_mfma_f32_16x16x32_bf16 v[140:143], a[72:75], a[20:23], v[140:143]
buffer_load_dwordx4 a[184:187], v1, s[12:15], s38 offen offset:2048 sc1
v_mfma_f32_16x16x32_bf16 v[144:147], a[76:79], a[16:19], v[144:147]
ds_read_b64_tr_b16 a[56:57], v48 offset:24576
ds_read_b64_tr_b16 a[58:59], v48 offset:28672
v_mov_b32 v33, 0x3f80
v_mfma_f32_16x16x32_bf16 v[148:151], a[76:79], a[20:23], v[148:151]
s_sub_u32 s73, s72, s73
v_lshlrev_b32 v29, 4, v29
v_lshlrev_b32 v33, v29, v33
v_mfma_f32_16x16x32_bf16 v[152:155], a[88:91], a[232:235], v[152:155]
ds_read_b64_tr_b16 a[60:61], v49 offset:24576
ds_read_b64_tr_b16 a[62:63], v49 offset:28672
v_mfma_f32_16x16x32_bf16 v[156:159], a[88:91], a[236:239], v[156:159]
buffer_load_dwordx4 a[188:191], v1, s[12:15], s37 offen offset:3072 sc1
v_lshrrev_b32 v34, 1, v21
v_mfma_f32_16x16x32_bf16 v[152:155], a[92:95], a[240:243], v[152:155]
s_waitcnt lgkmcnt(6)
ds_read_b64_tr_b16 a[64:65], v50 offset:24576
ds_read_b64_tr_b16 a[66:67], v50 offset:28672
v_cmp_eq_u32 vcc, 0, v34
v_mfma_f32_16x16x32_bf16 v[156:159], a[92:95], a[244:247], v[156:159]
v_and_b32 v70, 3, v0
v_lshlrev_b32 v70, 10, v70
v_cndmask_b32 v35, 0, v33, vcc
v_mfma_f32_16x16x32_bf16 v[88:91], a[48:51], a[24:27], v[88:91]
s_waitcnt lgkmcnt(6)
ds_read_b64_tr_b16 a[68:69], v51 offset:24576
ds_read_b64_tr_b16 a[70:71], v51 offset:28672
v_accvgpr_write_b32 a152, v35
v_mfma_f32_16x16x32_bf16 v[92:95], a[48:51], a[28:31], v[92:95]
s_waitcnt vmcnt(26)
ds_read_b64_tr_b16 a[96:97], v62 offset:4096
buffer_load_dwordx4 a[192:195], v1, s[12:15], s38 offen offset:3072 sc1
v_accvgpr_write_b32 a160, v35
v_mfma_f32_16x16x32_bf16 v[96:99], a[52:55], a[24:27], v[96:99]
s_waitcnt lgkmcnt(7)
ds_read_b64_tr_b16 a[72:73], v52 offset:24576
ds_read_b64_tr_b16 a[74:75], v52 offset:28672
s_mov_b64 exec, 1
buffer_store_dword a248, off, s[12:15], s72 sc1
s_mov_b64 exec, -1
v_cmp_eq_u32 vcc, 1, v34
v_mfma_f32_16x16x32_bf16 v[100:103], a[52:55], a[28:31], v[100:103]
ds_read_b64_tr_b16 a[98:99], v62 offset:4608
ds_read_b64_tr_b16 a[100:101], v62 offset:5120
v_cndmask_b32 v35, 0, v33, vcc
v_mfma_f32_16x16x32_bf16 v[104:107], a[56:59], a[24:27], v[104:107]
s_waitcnt lgkmcnt(9)
ds_read_b64_tr_b16 a[76:77], v53 offset:24576
ds_read_b64_tr_b16 a[78:79], v53 offset:28672
v_accvgpr_write_b32 a153, v35
v_mfma_f32_16x16x32_bf16 v[108:111], a[56:59], a[28:31], v[108:111]
ds_read_b64_tr_b16 a[102:103], v62 offset:5632
ds_read_b64_tr_b16 a[104:105], v62 offset:6144
v_cmp_eq_u32 vcc, 2, v34
v_mfma_f32_16x16x32_bf16 v[112:115], a[60:63], a[24:27], v[112:115]
s_waitcnt lgkmcnt(11)
ds_read_b64_tr_b16 a[106:107], v62 offset:6656
v_cndmask_b32 v35, 0, v33, vcc
v_mfma_f32_16x16x32_bf16 v[116:119], a[60:63], a[28:31], v[116:119]
ds_read_b64_tr_b16 a[108:109], v62 offset:7168
v_accvgpr_write_b32 a154, v35
v_mfma_f32_16x16x32_bf16 v[120:123], a[64:67], a[24:27], v[120:123]
s_waitcnt lgkmcnt(11)
ds_read_b64_tr_b16 a[110:111], v62 offset:7680
v_accvgpr_write_b32 a161, v35
v_mfma_f32_16x16x32_bf16 v[124:127], a[64:67], a[28:31], v[124:127]
s_mul_i32 s68, s66, 18432
v_cmp_eq_u32 vcc, 3, v34
s_add_u32 s69, s68, s88
v_mfma_f32_16x16x32_bf16 v[128:131], a[68:71], a[24:27], v[128:131]
s_waitcnt lgkmcnt(9)
ds_read_b64_tr_b16 a[48:49], v38 offset:32768
ds_read_b64_tr_b16 a[50:51], v38 offset:36864
v_cndmask_b32 v35, 0, v33, vcc
v_mfma_f32_16x16x32_bf16 v[132:135], a[68:71], a[28:31], v[132:135]
s_add_u32 s70, s68, s89
s_add_u32 s71, s68, s90
s_add_u32 s68, s68, s87
v_accvgpr_write_b32 a155, v35
v_mfma_f32_16x16x32_bf16 v[136:139], a[72:75], a[24:27], v[136:139]
s_waitcnt lgkmcnt(7)
ds_read_b64_tr_b16 a[52:53], v39 offset:32768
ds_read_b64_tr_b16 a[54:55], v39 offset:36864
v_cmp_eq_u32 vcc, 4, v34
v_mfma_f32_16x16x32_bf16 v[140:143], a[72:75], a[28:31], v[140:143]
buffer_load_dwordx2 a[200:201], v14, s[24:27], s68 offen
v_cndmask_b32 v35, 0, v33, vcc
v_mfma_f32_16x16x32_bf16 v[144:147], a[76:79], a[24:27], v[144:147]
ds_read_b64_tr_b16 a[56:57], v40 offset:32768
ds_read_b64_tr_b16 a[58:59], v40 offset:36864
v_accvgpr_write_b32 a156, v35
v_mfma_f32_16x16x32_bf16 v[148:151], a[76:79], a[28:31], v[148:151]
v_accvgpr_write_b32 a162, v35
v_cmp_eq_u32 vcc, 5, v34
v_mfma_f32_16x16x32_bf16 v[152:155], a[96:99], a[0:3], v[152:155]
s_waitcnt lgkmcnt(10)
ds_read_b64_tr_b16 a[60:61], v41 offset:32768
ds_read_b64_tr_b16 a[62:63], v41 offset:36864
v_mfma_f32_16x16x32_bf16 v[156:159], a[96:99], a[4:7], v[156:159]
v_cndmask_b32 v35, 0, v33, vcc
v_accvgpr_write_b32 a157, v35
v_mfma_f32_16x16x32_bf16 v[152:155], a[100:103], a[8:11], v[152:155]
s_waitcnt lgkmcnt(6)
ds_read_b64_tr_b16 a[64:65], v42 offset:32768
ds_read_b64_tr_b16 a[66:67], v42 offset:36864
buffer_load_dwordx2 a[202:203], v14, s[24:27], s68 offen offset:128
v_mfma_f32_16x16x32_bf16 v[156:159], a[100:103], a[12:15], v[156:159]
v_cmp_eq_u32 vcc, 6, v34
s_nop 1
v_cndmask_b32 v35, 0, v33, vcc
v_mfma_f32_16x16x32_bf16 v[88:91], a[48:51], v[160:163], v[88:91]
s_waitcnt lgkmcnt(6)
ds_read_b64_tr_b16 a[68:69], v43 offset:32768
ds_read_b64_tr_b16 a[70:71], v43 offset:36864
v_mfma_f32_16x16x32_bf16 v[92:95], a[48:51], v[164:167], v[92:95]
v_accvgpr_write_b32 a158, v35
v_accvgpr_write_b32 a163, v35
v_mfma_f32_16x16x32_bf16 v[96:99], a[52:55], v[160:163], v[96:99]
s_waitcnt lgkmcnt(6)
ds_read_b64_tr_b16 a[72:73], v44 offset:32768
ds_read_b64_tr_b16 a[74:75], v44 offset:36864
v_mfma_f32_16x16x32_bf16 v[100:103], a[52:55], v[164:167], v[100:103]
buffer_load_dword a204, v15, s[24:27], s69 offen
v_cmp_eq_u32 vcc, 7, v34
v_mfma_f32_16x16x32_bf16 v[104:107], a[56:59], v[160:163], v[104:107]
s_waitcnt lgkmcnt(6)
ds_read_b64_tr_b16 a[76:77], v45 offset:32768
ds_read_b64_tr_b16 a[78:79], v45 offset:36864
v_cndmask_b32 v35, 0, v33, vcc
v_mfma_f32_16x16x32_bf16 v[108:111], a[56:59], v[164:167], v[108:111]
s_mul_i32 s68, s67, 18432
s_add_u32 s69, s68, s88
s_add_u32 s70, s68, s89
v_accvgpr_write_b32 a159, v35
v_mfma_f32_16x16x32_bf16 v[112:115], a[60:63], v[160:163], v[112:115]
s_waitcnt lgkmcnt(6)
s_add_u32 s71, s68, s90
s_add_u32 s68, s68, s87
s_lshl_b32 s21, s32, 6
v_mfma_f32_16x16x32_bf16 v[116:119], a[60:63], v[164:167], v[116:119]
s_add_u32 s21, s21, 4096
s_add_u32 s22, s20, s21
s_mul_i32 s22, s22, 1152
v_mfma_f32_16x16x32_bf16 v[120:123], a[64:67], v[160:163], v[120:123]
s_waitcnt lgkmcnt(4)
buffer_load_dwordx2 a[206:207], v14, s[24:27], s68 offen
v_mfma_f32_16x16x32_bf16 v[124:127], a[64:67], v[164:167], v[124:127]
s_waitcnt vmcnt(13)
s_barrier
v_mfma_f32_16x16x32_bf16 v[128:131], a[68:71], v[160:163], v[128:131]
s_waitcnt lgkmcnt(2)
ds_read_b64_tr_b16 a[48:49], v38 offset:40960
ds_read_b64_tr_b16 a[50:51], v38 offset:45056
s_lshl_b32 s20, s33, 8
v_mfma_f32_16x16x32_bf16 v[132:135], a[68:71], v[164:167], v[132:135]
v_cmp_ne_u64 s[62:63], s[60:61], v[74:75]
s_add_u32 s47, s22, s20
v_mfma_f32_16x16x32_bf16 v[136:139], a[72:75], v[160:163], v[136:139]
s_waitcnt lgkmcnt(2)
ds_read_b64_tr_b16 a[52:53], v39 offset:40960
ds_read_b64_tr_b16 a[54:55], v39 offset:45056
s_lshl_b32 s22, s23, 5
v_mfma_f32_16x16x32_bf16 v[140:143], a[72:75], v[164:167], v[140:143]
buffer_load_dwordx2 a[208:209], v14, s[24:27], s68 offen offset:128
s_cmp_lg_u64 s[62:63], 0
s_cbranch_scc1 L_kt_pcs
L_kt_pcr:
s_add_u32 s22, s22, s21
v_mfma_f32_16x16x32_bf16 v[144:147], a[76:79], v[160:163], v[144:147]
ds_read_b64_tr_b16 a[56:57], v40 offset:40960
ds_read_b64_tr_b16 a[58:59], v40 offset:45056
s_mul_i32 s22, s22, 1152
v_mfma_f32_16x16x32_bf16 v[148:151], a[76:79], v[164:167], v[148:151]
s_add_u32 s22, s22, s4
s_add_u32 s48, s22, 1024
s_lshl_b32 s51, s23, 10
v_mfma_f32_16x16x32_bf16 v[152:155], a[104:107], a[16:19], v[152:155]
ds_read_b64_tr_b16 a[60:61], v41 offset:40960
ds_read_b64_tr_b16 a[62:63], v41 offset:45056
v_mfma_f32_16x16x32_bf16 v[156:159], a[104:107], a[20:23], v[156:159]
buffer_load_dword a210, v15, s[24:27], s69 offen
v_mfma_f32_16x16x32_bf16 v[152:155], a[108:111], a[24:27], v[152:155]
s_waitcnt lgkmcnt(6)
ds_read_b64_tr_b16 a[64:65], v42 offset:40960
ds_read_b64_tr_b16 a[66:67], v42 offset:45056
s_add_u32 s51, s51, 147456
v_mfma_f32_16x16x32_bf16 v[156:159], a[108:111], a[28:31], v[156:159]
s_mul_i32 s100, s36, 18432
s_add_u32 s100, s100, s75
s_add_u32 s52, s45, 0
v_mfma_f32_16x16x32_bf16 v[88:91], a[48:51], v[168:171], v[88:91]
s_waitcnt lgkmcnt(6)
ds_read_b64_tr_b16 a[68:69], v43 offset:40960
ds_read_b64_tr_b16 a[70:71], v43 offset:45056
v_mfma_f32_16x16x32_bf16 v[92:95], a[48:51], v[172:175], v[92:95]
s_add_u32 m0, s50, 4096
ds_read_b64_tr_b16 a[112:113], v62 offset:8192
s_add_u32 s100, s100, 167772160
v_mfma_f32_16x16x32_bf16 v[96:99], a[52:55], v[168:171], v[96:99]
s_waitcnt lgkmcnt(7)
ds_read_b64_tr_b16 a[72:73], v44 offset:40960
ds_read_b64_tr_b16 a[74:75], v44 offset:45056
s_add_u32 s101, s100, 18432
v_mfma_f32_16x16x32_bf16 v[100:103], a[52:55], v[172:175], v[100:103]
ds_read_b64_tr_b16 a[114:115], v62 offset:8704
buffer_load_dwordx4 v7, s[8:11], s52 offen lds
v_accvgpr_write_b32 a212, -1
v_mfma_f32_16x16x32_bf16 v[104:107], a[56:59], v[168:171], v[104:107]
s_waitcnt lgkmcnt(8)
ds_read_b64_tr_b16 a[76:77], v45 offset:40960
ds_read_b64_tr_b16 a[78:79], v45 offset:45056
v_accvgpr_write_b32 a213, -1
v_mfma_f32_16x16x32_bf16 v[108:111], a[56:59], v[172:175], v[108:111]
s_add_u32 s52, s43, 0
ds_read_b64_tr_b16 a[116:117], v62 offset:9216
ds_read_b64_tr_b16 a[118:119], v62 offset:9728
v_accvgpr_write_b32 a214, -1
v_mfma_f32_16x16x32_bf16 v[112:115], a[60:63], v[168:171], v[112:115]
s_waitcnt lgkmcnt(10)
ds_read_b64_tr_b16 a[120:121], v62 offset:10240
s_add_u32 m0, s49, 131072
v_accvgpr_write_b32 a215, -1
v_mfma_f32_16x16x32_bf16 v[116:119], a[60:63], v[172:175], v[116:119]
ds_read_b64_tr_b16 a[122:123], v62 offset:10752
ds_read_b64_tr_b16 a[124:125], v62 offset:11264
v_mfma_f32_16x16x32_bf16 v[120:123], a[64:67], v[168:171], v[120:123]
s_waitcnt lgkmcnt(11)
ds_read_b64_tr_b16 a[126:127], v62 offset:11776
buffer_load_dwordx4 v4, s[8:11], s52 offen lds
v_mfma_f32_16x16x32_bf16 v[124:127], a[64:67], v[172:175], v[124:127]
s_add_u32 s52, s43, 1179648
s_add_u32 m0, s49, 132096
ds_read_b64_tr_b16 a[128:129], v62 offset:0
v_mfma_f32_16x16x32_bf16 v[128:131], a[68:71], v[168:171], v[128:131]
s_waitcnt lgkmcnt(10)
ds_read_b64_tr_b16 a[130:131], v62 offset:512
ds_read_b64_tr_b16 a[132:133], v62 offset:1024
v_mfma_f32_16x16x32_bf16 v[132:135], a[68:71], v[172:175], v[132:135]
buffer_load_dwordx4 v5, s[8:11], s52 offen lds
v_mfma_f32_16x16x32_bf16 v[136:139], a[72:75], v[168:171], v[136:139]
s_waitcnt lgkmcnt(9)
ds_read_b64_tr_b16 a[48:49], v46 offset:32768
ds_read_b64_tr_b16 a[50:51], v46 offset:36864
v_mfma_f32_16x16x32_bf16 v[140:143], a[72:75], v[172:175], v[140:143]
s_add_u32 s52, s43, 36864
s_add_u32 m0, s49, 139264
ds_read_b64_tr_b16 a[134:135], v62 offset:1536
v_mfma_f32_16x16x32_bf16 v[144:147], a[76:79], v[168:171], v[144:147]
ds_read_b64_tr_b16 a[52:53], v47 offset:32768
ds_read_b64_tr_b16 a[54:55], v47 offset:36864
v_mfma_f32_16x16x32_bf16 v[148:151], a[76:79], v[172:175], v[148:151]
buffer_load_dwordx4 v4, s[8:11], s52 offen lds
v_mfma_f32_16x16x32_bf16 v[152:155], a[112:115], v[160:163], v[152:155]
s_waitcnt lgkmcnt(12)
ds_read_b64_tr_b16 a[56:57], v48 offset:32768
ds_read_b64_tr_b16 a[58:59], v48 offset:36864
v_mfma_f32_16x16x32_bf16 v[156:159], a[112:115], v[164:167], v[156:159]
ds_read_b64_tr_b16 a[136:137], v62 offset:2048
ds_read_b64_tr_b16 a[138:139], v62 offset:2560
v_mfma_f32_16x16x32_bf16 v[152:155], a[116:119], v[168:171], v[152:155]
s_waitcnt lgkmcnt(14)
ds_read_b64_tr_b16 a[60:61], v49 offset:32768
ds_read_b64_tr_b16 a[62:63], v49 offset:36864
v_mfma_f32_16x16x32_bf16 v[156:159], a[116:119], v[172:175], v[156:159]
s_add_u32 s52, s43, 1216512
s_add_u32 m0, s49, 140288
ds_read_b64_tr_b16 a[140:141], v62 offset:3072
v_mfma_f32_16x16x32_bf16 v[152:155], a[120:123], v[176:179], v[152:155]
s_waitcnt lgkmcnt(10)
ds_read_b64_tr_b16 a[64:65], v50 offset:32768
ds_read_b64_tr_b16 a[66:67], v50 offset:36864
v_mfma_f32_16x16x32_bf16 v[156:159], a[120:123], v[180:183], v[156:159]
buffer_load_dwordx4 v5, s[8:11], s52 offen lds
v_mfma_f32_16x16x32_bf16 v[88:91], a[48:51], v[176:179], v[88:91]
s_waitcnt lgkmcnt(9)
ds_read_b64_tr_b16 a[68:69], v51 offset:32768
ds_read_b64_tr_b16 a[70:71], v51 offset:36864
v_mfma_f32_16x16x32_bf16 v[92:95], a[48:51], v[180:183], v[92:95]
ds_read_b64_tr_b16 a[142:143], v62 offset:3584
v_mfma_f32_16x16x32_bf16 v[96:99], a[52:55], v[176:179], v[96:99]
s_waitcnt lgkmcnt(10)
ds_read_b64_tr_b16 a[72:73], v52 offset:32768
ds_read_b64_tr_b16 a[74:75], v52 offset:36864
v_mfma_f32_16x16x32_bf16 v[100:103], a[52:55], v[180:183], v[100:103]
v_mfma_f32_16x16x32_bf16 v[104:107], a[56:59], v[176:179], v[104:107]
s_waitcnt lgkmcnt(8)
ds_read_b64_tr_b16 a[76:77], v53 offset:32768
ds_read_b64_tr_b16 a[78:79], v53 offset:36864
v_mfma_f32_16x16x32_bf16 v[108:111], a[56:59], v[180:183], v[108:111]
v_mfma_f32_16x16x32_bf16 v[112:115], a[60:63], v[176:179], v[112:115]
s_waitcnt lgkmcnt(7)
v_mfma_f32_16x16x32_bf16 v[116:119], a[60:63], v[180:183], v[116:119]
v_mfma_f32_16x16x32_bf16 v[120:123], a[64:67], v[176:179], v[120:123]
s_waitcnt lgkmcnt(5)
ds_read_b64_tr_b16 a[48:49], v38 offset:49152
ds_read_b64_tr_b16 a[50:51], v38 offset:53248
v_mfma_f32_16x16x32_bf16 v[124:127], a[64:67], v[180:183], v[124:127]
buffer_load_dword v71, v70, s[12:15], s73 offen sc1
v_mfma_f32_16x16x32_bf16 v[128:131], a[68:71], v[176:179], v[128:131]
s_waitcnt lgkmcnt(4)
ds_read_b64_tr_b16 a[52:53], v39 offset:49152
ds_read_b64_tr_b16 a[54:55], v39 offset:53248
v_mfma_f32_16x16x32_bf16 v[132:135], a[68:71], v[180:183], v[132:135]
v_mfma_f32_16x16x32_bf16 v[136:139], a[72:75], v[176:179], v[136:139]
s_waitcnt lgkmcnt(4)
ds_read_b64_tr_b16 a[56:57], v40 offset:49152
ds_read_b64_tr_b16 a[58:59], v40 offset:53248
v_mfma_f32_16x16x32_bf16 v[140:143], a[72:75], v[180:183], v[140:143]
v_mfma_f32_16x16x32_bf16 v[144:147], a[76:79], v[176:179], v[144:147]
ds_read_b64_tr_b16 a[60:61], v41 offset:49152
ds_read_b64_tr_b16 a[62:63], v41 offset:53248
v_mfma_f32_16x16x32_bf16 v[148:151], a[76:79], v[180:183], v[148:151]
v_mfma_f32_16x16x32_bf16 v[152:155], a[124:127], v[184:187], v[152:155]
s_waitcnt lgkmcnt(6)
ds_read_b64_tr_b16 a[64:65], v42 offset:49152
ds_read_b64_tr_b16 a[66:67], v42 offset:53248
v_mfma_f32_16x16x32_bf16 v[156:159], a[124:127], v[188:191], v[156:159]
v_mfma_f32_16x16x32_bf16 v[88:91], a[48:51], v[184:187], v[88:91]
s_waitcnt lgkmcnt(6)
ds_read_b64_tr_b16 a[68:69], v43 offset:49152
ds_read_b64_tr_b16 a[70:71], v43 offset:53248
v_mfma_f32_16x16x32_bf16 v[92:95], a[48:51], v[188:191], v[92:95]
v_mfma_f32_16x16x32_bf16 v[96:99], a[52:55], v[184:187], v[96:99]
s_waitcnt lgkmcnt(6)
ds_read_b64_tr_b16 a[72:73], v44 offset:49152
ds_read_b64_tr_b16 a[74:75], v44 offset:53248
v_mfma_f32_16x16x32_bf16 v[100:103], a[52:55], v[188:191], v[100:103]
v_mfma_f32_16x16x32_bf16 v[104:107], a[56:59], v[184:187], v[104:107]
s_waitcnt lgkmcnt(6)
ds_read_b64_tr_b16 a[76:77], v45 offset:49152
ds_read_b64_tr_b16 a[78:79], v45 offset:53248
v_mfma_f32_16x16x32_bf16 v[108:111], a[56:59], v[188:191], v[108:111]
v_mfma_f32_16x16x32_bf16 v[112:115], a[60:63], v[184:187], v[112:115]
s_waitcnt lgkmcnt(6)
s_mul_i32 s53, s35, 18432
s_add_u32 s53, s53, s75
v_mfma_f32_16x16x32_bf16 v[116:119], a[60:63], v[188:191], v[116:119]
s_add_u32 s53, s53, 100663296
s_add_u32 s54, s53, 18432
v_mfma_f32_16x16x32_bf16 v[120:123], a[64:67], v[184:187], v[120:123]
s_waitcnt lgkmcnt(4)
v_mfma_f32_16x16x32_bf16 v[124:127], a[64:67], v[188:191], v[124:127]
v_mfma_f32_16x16x32_bf16 v[128:131], a[68:71], v[184:187], v[128:131]
s_waitcnt lgkmcnt(2)
v_mfma_f32_16x16x32_bf16 v[132:135], a[68:71], v[188:191], v[132:135]
v_mfma_f32_16x16x32_bf16 v[136:139], a[72:75], v[184:187], v[136:139]
s_waitcnt lgkmcnt(0)
v_mfma_f32_16x16x32_bf16 v[140:143], a[72:75], v[188:191], v[140:143]
v_mfma_f32_16x16x32_bf16 v[144:147], a[76:79], v[184:187], v[144:147]
ds_read_b64_tr_b16 a[48:49], v38 offset:57344
ds_read_b64_tr_b16 a[50:51], v38 offset:61440
v_mfma_f32_16x16x32_bf16 v[148:151], a[76:79], v[188:191], v[148:151]
s_waitcnt vmcnt(19)
s_barrier
v_mfma_f32_16x16x32_bf16 v[152:155], a[128:131], a[164:167], v[152:155]
s_waitcnt vmcnt(17)
ds_read_b64_tr_b16 a[52:53], v39 offset:57344
ds_read_b64_tr_b16 a[54:55], v39 offset:61440
v_mfma_f32_16x16x32_bf16 v[156:159], a[128:131], a[168:171], v[156:159]
s_add_u32 s52, s45, 294912
s_add_u32 m0, s50, 8192
v_mfma_f32_16x16x32_bf16 v[152:155], a[132:135], a[172:175], v[152:155]
s_waitcnt vmcnt(15)
ds_read_b64_tr_b16 a[56:57], v46 offset:49152
ds_read_b64_tr_b16 a[58:59], v46 offset:53248
v_mfma_f32_16x16x32_bf16 v[156:159], a[132:135], a[176:179], v[156:159]
buffer_load_dwordx4 v7, s[8:11], s52 offen lds
v_mfma_f32_16x16x32_bf16 v[152:155], a[136:139], a[180:183], v[152:155]
s_waitcnt vmcnt(14)
ds_read_b64_tr_b16 a[60:61], v47 offset:49152
ds_read_b64_tr_b16 a[62:63], v47 offset:53248
v_mfma_f32_16x16x32_bf16 v[156:159], a[136:139], a[184:187], v[156:159]
s_add_u32 s52, s45, 589824
s_add_u32 m0, s50, 0
v_mfma_f32_16x16x32_bf16 v[152:155], a[140:143], a[188:191], v[152:155]
s_waitcnt lgkmcnt(6)
ds_read_b64_tr_b16 a[64:65], v46 offset:57344
ds_read_b64_tr_b16 a[66:67], v46 offset:61440
v_mfma_f32_16x16x32_bf16 v[156:159], a[140:143], a[192:195], v[156:159]
buffer_load_dwordx4 v7, s[8:11], s52 offen lds
v_mfma_f32_16x16x32_bf16 v[88:91], a[48:51], a[164:167], v[88:91]
s_waitcnt lgkmcnt(6)
ds_read_b64_tr_b16 a[68:69], v47 offset:57344
ds_read_b64_tr_b16 a[70:71], v47 offset:61440
v_mfma_f32_16x16x32_bf16 v[92:95], a[48:51], a[168:171], v[92:95]
v_mfma_f32_16x16x32_bf16 v[96:99], a[52:55], a[164:167], v[96:99]
s_waitcnt lgkmcnt(6)
ds_read_b64_tr_b16 a[72:73], v46 offset:40960
ds_read_b64_tr_b16 a[74:75], v46 offset:45056
v_mfma_f32_16x16x32_bf16 v[100:103], a[52:55], a[168:171], v[100:103]
v_cvt_pk_bf16_f32 v152, v152, v153
v_cvt_pk_bf16_f32 v153, v154, v155
v_mfma_f32_16x16x32_bf16 v[88:91], a[56:59], a[172:175], v[88:91]
s_waitcnt lgkmcnt(6)
ds_read_b64_tr_b16 a[76:77], v47 offset:40960
ds_read_b64_tr_b16 a[78:79], v47 offset:45056
v_mfma_f32_16x16x32_bf16 v[92:95], a[56:59], a[176:179], v[92:95]
v_cvt_pk_bf16_f32 v154, v156, v157
v_cvt_pk_bf16_f32 v155, v158, v159
v_mfma_f32_16x16x32_bf16 v[96:99], a[60:63], a[172:175], v[96:99]
s_waitcnt lgkmcnt(6)
ds_read_b64_tr_b16 a[48:49], v40 offset:57344
ds_read_b64_tr_b16 a[50:51], v40 offset:61440
v_mfma_f32_16x16x32_bf16 v[100:103], a[60:63], a[176:179], v[100:103]
v_permlane32_swap_b32 v152, v154
v_permlane32_swap_b32 v153, v155
buffer_store_dwordx4 v[152:155], v10, s[12:15], s53 offen offset:1024 sc1
v_mfma_f32_16x16x32_bf16 v[88:91], a[64:67], a[180:183], v[88:91]
s_waitcnt lgkmcnt(6)
ds_read_b64_tr_b16 a[52:53], v41 offset:57344
ds_read_b64_tr_b16 a[54:55], v41 offset:61440
v_mfma_f32_16x16x32_bf16 v[92:95], a[64:67], a[184:187], v[92:95]
v_mfma_f32_16x16x32_bf16 v[96:99], a[68:71], a[180:183], v[96:99]
s_waitcnt lgkmcnt(6)
ds_read_b64_tr_b16 a[56:57], v48 offset:49152
ds_read_b64_tr_b16 a[58:59], v48 offset:53248
v_mfma_f32_16x16x32_bf16 v[100:103], a[68:71], a[184:187], v[100:103]
v_mfma_f32_16x16x32_bf16 v[88:91], a[72:75], a[188:191], v[88:91]
s_waitcnt lgkmcnt(6)
ds_read_b64_tr_b16 a[60:61], v49 offset:49152
ds_read_b64_tr_b16 a[62:63], v49 offset:53248
v_mfma_f32_16x16x32_bf16 v[92:95], a[72:75], a[192:195], v[92:95]
v_mfma_f32_16x16x32_bf16 v[96:99], a[76:79], a[188:191], v[96:99]
s_waitcnt lgkmcnt(6)
ds_read_b64_tr_b16 a[64:65], v48 offset:57344
ds_read_b64_tr_b16 a[66:67], v48 offset:61440
v_mfma_f32_16x16x32_bf16 v[100:103], a[76:79], a[192:195], v[100:103]
v_mfma_f32_16x16x32_bf16 v[104:107], a[48:51], a[164:167], v[104:107]
s_waitcnt lgkmcnt(6)
ds_read_b64_tr_b16 a[68:69], v49 offset:57344
ds_read_b64_tr_b16 a[70:71], v49 offset:61440
v_mfma_f32_16x16x32_bf16 v[108:111], a[48:51], a[168:171], v[108:111]
v_cvt_pk_bf16_f32 v160, v88, v89
v_cvt_pk_bf16_f32 v161, v90, v91
v_mfma_f32_16x16x32_bf16 v[112:115], a[52:55], a[164:167], v[112:115]
s_waitcnt lgkmcnt(6)
ds_read_b64_tr_b16 a[72:73], v48 offset:40960
ds_read_b64_tr_b16 a[74:75], v48 offset:45056
v_mfma_f32_16x16x32_bf16 v[116:119], a[52:55], a[168:171], v[116:119]
v_cvt_pk_bf16_f32 v162, v96, v97
v_cvt_pk_bf16_f32 v163, v98, v99
v_mfma_f32_16x16x32_bf16 v[104:107], a[56:59], a[172:175], v[104:107]
s_waitcnt lgkmcnt(6)
ds_read_b64_tr_b16 a[76:77], v49 offset:40960
ds_read_b64_tr_b16 a[78:79], v49 offset:45056
v_mfma_f32_16x16x32_bf16 v[108:111], a[56:59], a[176:179], v[108:111]
buffer_store_dwordx4 v[160:163], v9, s[12:15], s53 offen offset:0 sc1
v_mfma_f32_16x16x32_bf16 v[112:115], a[60:63], a[172:175], v[112:115]
s_waitcnt lgkmcnt(6)
ds_read_b64_tr_b16 a[48:49], v42 offset:57344
ds_read_b64_tr_b16 a[50:51], v42 offset:61440
v_mfma_f32_16x16x32_bf16 v[116:119], a[60:63], a[176:179], v[116:119]
v_cvt_pk_bf16_f32 v164, v92, v93
v_cvt_pk_bf16_f32 v165, v94, v95
v_mfma_f32_16x16x32_bf16 v[104:107], a[64:67], a[180:183], v[104:107]
s_waitcnt lgkmcnt(6)
ds_read_b64_tr_b16 a[52:53], v43 offset:57344
ds_read_b64_tr_b16 a[54:55], v43 offset:61440
v_mfma_f32_16x16x32_bf16 v[108:111], a[64:67], a[184:187], v[108:111]
v_cvt_pk_bf16_f32 v166, v100, v101
v_cvt_pk_bf16_f32 v167, v102, v103
buffer_store_dwordx4 v[164:167], v9, s[12:15], s54 offen offset:0 sc1
v_mfma_f32_16x16x32_bf16 v[112:115], a[68:71], a[180:183], v[112:115]
s_waitcnt lgkmcnt(6)
ds_read_b64_tr_b16 a[56:57], v50 offset:49152
ds_read_b64_tr_b16 a[58:59], v50 offset:53248
s_waitcnt vmcnt(5)
v_mfma_f32_16x16x32_bf16 v[116:119], a[68:71], a[184:187], v[116:119]
v_cmp_ne_u32 s[62:63], s60, v71
v_mfma_f32_16x16x32_bf16 v[104:107], a[72:75], a[188:191], v[104:107]
s_waitcnt lgkmcnt(6)
ds_read_b64_tr_b16 a[60:61], v51 offset:49152
ds_read_b64_tr_b16 a[62:63], v51 offset:53248
v_mfma_f32_16x16x32_bf16 v[108:111], a[72:75], a[192:195], v[108:111]
s_cmp_lg_u64 s[62:63], 0
s_cbranch_scc1 L_kt_pls
L_kt_plr:
v_mfma_f32_16x16x32_bf16 v[112:115], a[76:79], a[188:191], v[112:115]
s_waitcnt lgkmcnt(6)
ds_read_b64_tr_b16 a[64:65], v50 offset:57344
ds_read_b64_tr_b16 a[66:67], v50 offset:61440
v_mfma_f32_16x16x32_bf16 v[116:119], a[76:79], a[192:195], v[116:119]
s_mul_i32 s85, s36, 18432
s_add_u32 s85, s85, s42
s_lshl_b32 s37, s41, 10
v_mfma_f32_16x16x32_bf16 v[120:123], a[48:51], a[164:167], v[120:123]
s_waitcnt lgkmcnt(6)
ds_read_b64_tr_b16 a[68:69], v51 offset:57344
ds_read_b64_tr_b16 a[70:71], v51 offset:61440
v_mfma_f32_16x16x32_bf16 v[124:127], a[48:51], a[168:171], v[124:127]
s_and_b32 s37, s37, 0x3000
s_add_u32 s37, s37, s85
v_cvt_pk_bf16_f32 v168, v104, v105
v_mfma_f32_16x16x32_bf16 v[128:131], a[52:55], a[164:167], v[128:131]
s_waitcnt lgkmcnt(6)
ds_read_b64_tr_b16 a[72:73], v50 offset:40960
ds_read_b64_tr_b16 a[74:75], v50 offset:45056
v_mfma_f32_16x16x32_bf16 v[132:135], a[52:55], a[168:171], v[132:135]
buffer_load_dwordx4 v[224:227], v1, s[12:15], s37 offen offset:0 sc1
v_mfma_f32_16x16x32_bf16 v[120:123], a[56:59], a[172:175], v[120:123]
s_waitcnt lgkmcnt(6)
ds_read_b64_tr_b16 a[76:77], v51 offset:40960
ds_read_b64_tr_b16 a[78:79], v51 offset:45056
v_mfma_f32_16x16x32_bf16 v[124:127], a[56:59], a[176:179], v[124:127]
s_add_u32 s38, s37, 18432
v_cvt_pk_bf16_f32 v169, v106, v107
v_cvt_pk_bf16_f32 v170, v112, v113
v_mfma_f32_16x16x32_bf16 v[128:131], a[60:63], a[172:175], v[128:131]
s_waitcnt lgkmcnt(6)
ds_read_b64_tr_b16 a[48:49], v44 offset:57344
ds_read_b64_tr_b16 a[50:51], v44 offset:61440
v_mfma_f32_16x16x32_bf16 v[132:135], a[60:63], a[176:179], v[132:135]
buffer_load_dwordx4 v[228:231], v1, s[12:15], s38 offen offset:0 sc1
v_mfma_f32_16x16x32_bf16 v[120:123], a[64:67], a[180:183], v[120:123]
s_waitcnt lgkmcnt(6)
ds_read_b64_tr_b16 a[52:53], v45 offset:57344
ds_read_b64_tr_b16 a[54:55], v45 offset:61440
v_mfma_f32_16x16x32_bf16 v[124:127], a[64:67], a[184:187], v[124:127]
v_cvt_pk_bf16_f32 v171, v114, v115
buffer_store_dwordx4 v[168:171], v9, s[12:15], s53 offen offset:256 sc1
v_mfma_f32_16x16x32_bf16 v[128:131], a[68:71], a[180:183], v[128:131]
s_waitcnt lgkmcnt(6)
ds_read_b64_tr_b16 a[56:57], v52 offset:49152
ds_read_b64_tr_b16 a[58:59], v52 offset:53248
v_mfma_f32_16x16x32_bf16 v[132:135], a[68:71], a[184:187], v[132:135]
buffer_load_dwordx4 v[232:235], v1, s[12:15], s37 offen offset:1024 sc1
v_mfma_f32_16x16x32_bf16 v[120:123], a[72:75], a[188:191], v[120:123]
s_waitcnt lgkmcnt(6)
ds_read_b64_tr_b16 a[60:61], v53 offset:49152
ds_read_b64_tr_b16 a[62:63], v53 offset:53248
v_mfma_f32_16x16x32_bf16 v[124:127], a[72:75], a[192:195], v[124:127]
s_barrier
v_mfma_f32_16x16x32_bf16 v[128:131], a[76:79], a[188:191], v[128:131]
s_waitcnt lgkmcnt(6)
ds_read_b64_tr_b16 a[64:65], v52 offset:57344
ds_read_b64_tr_b16 a[66:67], v52 offset:61440
v_mfma_f32_16x16x32_bf16 v[132:135], a[76:79], a[192:195], v[132:135]
buffer_load_dwordx4 v[236:239], v1, s[12:15], s38 offen offset:1024 sc1
v_mfma_f32_16x16x32_bf16 v[136:139], a[48:51], a[164:167], v[136:139]
s_waitcnt lgkmcnt(6)
ds_read_b64_tr_b16 a[68:69], v53 offset:57344
ds_read_b64_tr_b16 a[70:71], v53 offset:61440
v_mfma_f32_16x16x32_bf16 v[140:143], a[48:51], a[168:171], v[140:143]
v_cvt_pk_bf16_f32 v172, v108, v109
v_cvt_pk_bf16_f32 v173, v110, v111
v_mfma_f32_16x16x32_bf16 v[144:147], a[52:55], a[164:167], v[144:147]
s_waitcnt lgkmcnt(6)
ds_read_b64_tr_b16 a[72:73], v52 offset:40960
ds_read_b64_tr_b16 a[74:75], v52 offset:45056
v_mfma_f32_16x16x32_bf16 v[148:151], a[52:55], a[168:171], v[148:151]
v_cvt_pk_bf16_f32 v174, v116, v117
v_cvt_pk_bf16_f32 v175, v118, v119
buffer_store_dwordx4 v[172:175], v9, s[12:15], s54 offen offset:256 sc1
v_mfma_f32_16x16x32_bf16 v[136:139], a[56:59], a[172:175], v[136:139]
s_waitcnt lgkmcnt(6)
ds_read_b64_tr_b16 a[76:77], v53 offset:40960
ds_read_b64_tr_b16 a[78:79], v53 offset:45056
v_mfma_f32_16x16x32_bf16 v[140:143], a[56:59], a[176:179], v[140:143]
buffer_load_dwordx4 v[240:243], v1, s[12:15], s37 offen offset:2048 sc1
v_mfma_f32_16x16x32_bf16 v[144:147], a[60:63], a[172:175], v[144:147]
s_waitcnt lgkmcnt(6)
v_cvt_pk_bf16_f32 v176, v120, v121
v_cvt_pk_bf16_f32 v177, v122, v123
v_mfma_f32_16x16x32_bf16 v[148:151], a[60:63], a[176:179], v[148:151]
v_cvt_pk_bf16_f32 v178, v128, v129
v_cvt_pk_bf16_f32 v179, v130, v131
buffer_store_dwordx4 v[176:179], v9, s[12:15], s53 offen offset:512 sc1
v_mfma_f32_16x16x32_bf16 v[136:139], a[64:67], a[180:183], v[136:139]
s_waitcnt lgkmcnt(4)
v_cvt_pk_bf16_f32 v180, v124, v125
v_cvt_pk_bf16_f32 v181, v126, v127
v_mfma_f32_16x16x32_bf16 v[140:143], a[64:67], a[184:187], v[140:143]
buffer_load_dwordx4 v[244:247], v1, s[12:15], s38 offen offset:2048 sc1
v_mfma_f32_16x16x32_bf16 v[144:147], a[68:71], a[180:183], v[144:147]
s_waitcnt lgkmcnt(2)
ds_read_b64_tr_b16 a[48:49], v38 offset:0
ds_read_b64_tr_b16 a[50:51], v38 offset:4096
v_mfma_f32_16x16x32_bf16 v[148:151], a[68:71], a[184:187], v[148:151]
v_cvt_pk_bf16_f32 v182, v132, v133
v_cvt_pk_bf16_f32 v183, v134, v135
buffer_store_dwordx4 v[180:183], v9, s[12:15], s54 offen offset:512 sc1
v_mfma_f32_16x16x32_bf16 v[136:139], a[72:75], a[188:191], v[136:139]
s_waitcnt lgkmcnt(2)
ds_read_b64_tr_b16 a[52:53], v39 offset:0
ds_read_b64_tr_b16 a[54:55], v39 offset:4096
v_mfma_f32_16x16x32_bf16 v[140:143], a[72:75], a[192:195], v[140:143]
v_mfma_f32_16x16x32_bf16 v[144:147], a[76:79], a[188:191], v[144:147]
ds_read_b64_tr_b16 a[56:57], v38 offset:8192
ds_read_b64_tr_b16 a[58:59], v38 offset:12288
v_mfma_f32_16x16x32_bf16 v[148:151], a[76:79], a[192:195], v[148:151]
s_barrier
v_mfma_f32_16x16x32_bf16 v[152:155], a[80:83], v[192:195], 0
ds_read_b64_tr_b16 a[60:61], v39 offset:8192
ds_read_b64_tr_b16 a[62:63], v39 offset:12288
v_mfma_f32_16x16x32_bf16 v[156:159], a[80:83], v[196:199], 0
buffer_load_dwordx4 v[248:251], v1, s[12:15], s37 offen offset:3072 sc1
v_mfma_f32_16x16x32_bf16 v[152:155], a[84:87], v[200:203], v[152:155]
s_waitcnt lgkmcnt(6)
ds_read_b64_tr_b16 a[64:65], v40 offset:0
ds_read_b64_tr_b16 a[66:67], v40 offset:4096
v_mfma_f32_16x16x32_bf16 v[156:159], a[84:87], v[204:207], v[156:159]
buffer_load_dwordx4 v[252:255], v1, s[12:15], s38 offen offset:3072 sc1
v_mfma_f32_16x16x32_bf16 v[88:91], a[48:51], v[192:195], 0
s_waitcnt lgkmcnt(6)
ds_read_b64_tr_b16 a[68:69], v41 offset:0
ds_read_b64_tr_b16 a[70:71], v41 offset:4096
v_mfma_f32_16x16x32_bf16 v[92:95], a[48:51], v[196:199], 0
v_cvt_pk_bf16_f32 v184, v136, v137
v_cvt_pk_bf16_f32 v185, v138, v139
v_mfma_f32_16x16x32_bf16 v[96:99], a[52:55], v[192:195], 0
s_waitcnt lgkmcnt(6)
ds_read_b64_tr_b16 a[72:73], v40 offset:8192
ds_read_b64_tr_b16 a[74:75], v40 offset:12288
v_mfma_f32_16x16x32_bf16 v[100:103], a[52:55], v[196:199], 0
s_lshl_b32 s37, s41, 8
s_and_b32 s37, s37, 0x3000
s_add_u32 s37, s37, s85
v_mfma_f32_16x16x32_bf16 v[88:91], a[56:59], v[200:203], v[88:91]
s_waitcnt lgkmcnt(6)
ds_read_b64_tr_b16 a[76:77], v41 offset:8192
ds_read_b64_tr_b16 a[78:79], v41 offset:12288
v_mfma_f32_16x16x32_bf16 v[92:95], a[56:59], v[204:207], v[92:95]
buffer_load_dwordx4 a[0:3], v1, s[12:15], s37 offen offset:0 sc1
v_mfma_f32_16x16x32_bf16 v[96:99], a[60:63], v[200:203], v[96:99]
s_waitcnt lgkmcnt(6)
ds_read_b64_tr_b16 a[48:49], v42 offset:0
ds_read_b64_tr_b16 a[50:51], v42 offset:4096
v_mfma_f32_16x16x32_bf16 v[100:103], a[60:63], v[204:207], v[100:103]
s_add_u32 s38, s37, 18432
v_cvt_pk_bf16_f32 v186, v144, v145
v_cvt_pk_bf16_f32 v187, v146, v147
buffer_store_dwordx4 v[184:187], v9, s[12:15], s53 offen offset:768 sc1
v_mfma_f32_16x16x32_bf16 v[104:107], a[64:67], v[192:195], 0
s_waitcnt lgkmcnt(6)
ds_read_b64_tr_b16 a[52:53], v43 offset:0
ds_read_b64_tr_b16 a[54:55], v43 offset:4096
v_mfma_f32_16x16x32_bf16 v[108:111], a[64:67], v[196:199], 0
buffer_load_dwordx4 a[4:7], v1, s[12:15], s38 offen offset:0 sc1
v_mfma_f32_16x16x32_bf16 v[112:115], a[68:71], v[192:195], 0
s_waitcnt lgkmcnt(6)
ds_read_b64_tr_b16 a[56:57], v42 offset:8192
ds_read_b64_tr_b16 a[58:59], v42 offset:12288
v_mfma_f32_16x16x32_bf16 v[116:119], a[68:71], v[196:199], 0
v_cvt_pk_bf16_f32 v188, v140, v141
v_cvt_pk_bf16_f32 v189, v142, v143
v_mfma_f32_16x16x32_bf16 v[104:107], a[72:75], v[200:203], v[104:107]
s_waitcnt lgkmcnt(6)
ds_read_b64_tr_b16 a[60:61], v43 offset:8192
ds_read_b64_tr_b16 a[62:63], v43 offset:12288
v_mfma_f32_16x16x32_bf16 v[108:111], a[72:75], v[204:207], v[108:111]
v_cvt_pk_bf16_f32 v190, v148, v149
v_cvt_pk_bf16_f32 v191, v150, v151
buffer_store_dwordx4 v[188:191], v9, s[12:15], s54 offen offset:768 sc1
v_mfma_f32_16x16x32_bf16 v[112:115], a[76:79], v[200:203], v[112:115]
s_waitcnt lgkmcnt(6)
ds_read_b64_tr_b16 a[64:65], v44 offset:0
ds_read_b64_tr_b16 a[66:67], v44 offset:4096
v_mfma_f32_16x16x32_bf16 v[116:119], a[76:79], v[204:207], v[116:119]
buffer_load_dwordx4 a[8:11], v1, s[12:15], s37 offen offset:1024 sc1
v_mfma_f32_16x16x32_bf16 v[120:123], a[48:51], v[192:195], 0
s_waitcnt lgkmcnt(6)
ds_read_b64_tr_b16 a[68:69], v45 offset:0
ds_read_b64_tr_b16 a[70:71], v45 offset:4096
v_mfma_f32_16x16x32_bf16 v[124:127], a[48:51], v[196:199], 0
v_mfma_f32_16x16x32_bf16 v[128:131], a[52:55], v[192:195], 0
s_waitcnt lgkmcnt(6)
ds_read_b64_tr_b16 a[72:73], v44 offset:8192
ds_read_b64_tr_b16 a[74:75], v44 offset:12288
v_mfma_f32_16x16x32_bf16 v[132:135], a[52:55], v[196:199], 0
buffer_load_dwordx4 a[12:15], v1, s[12:15], s38 offen offset:1024 sc1
v_mfma_f32_16x16x32_bf16 v[120:123], a[56:59], v[200:203], v[120:123]
s_waitcnt lgkmcnt(6)
ds_read_b64_tr_b16 a[76:77], v45 offset:8192
ds_read_b64_tr_b16 a[78:79], v45 offset:12288
v_mfma_f32_16x16x32_bf16 v[124:127], a[56:59], v[204:207], v[124:127]
v_mfma_f32_16x16x32_bf16 v[128:131], a[60:63], v[200:203], v[128:131]
s_waitcnt lgkmcnt(6)
v_mfma_f32_16x16x32_bf16 v[132:135], a[60:63], v[204:207], v[132:135]
v_mfma_f32_16x16x32_bf16 v[136:139], a[64:67], v[192:195], 0
s_waitcnt lgkmcnt(4)
ds_read_b64_tr_b16 a[48:49], v46 offset:0
ds_read_b64_tr_b16 a[50:51], v46 offset:4096
v_mfma_f32_16x16x32_bf16 v[140:143], a[64:67], v[196:199], 0
buffer_load_dwordx4 a[16:19], v1, s[12:15], s37 offen offset:2048 sc1
v_mfma_f32_16x16x32_bf16 v[144:147], a[68:71], v[192:195], 0
s_waitcnt lgkmcnt(4)
ds_read_b64_tr_b16 a[52:53], v47 offset:0
ds_read_b64_tr_b16 a[54:55], v47 offset:4096
v_mfma_f32_16x16x32_bf16 v[148:151], a[68:71], v[196:199], 0
v_mfma_f32_16x16x32_bf16 v[136:139], a[72:75], v[200:203], v[136:139]
s_waitcnt lgkmcnt(4)
ds_read_b64_tr_b16 a[56:57], v48 offset:0
ds_read_b64_tr_b16 a[58:59], v48 offset:4096
v_mfma_f32_16x16x32_bf16 v[140:143], a[72:75], v[204:207], v[140:143]
buffer_load_dwordx4 a[20:23], v1, s[12:15], s38 offen offset:2048 sc1
v_mfma_f32_16x16x32_bf16 v[144:147], a[76:79], v[200:203], v[144:147]
ds_read_b64_tr_b16 a[60:61], v49 offset:0
ds_read_b64_tr_b16 a[62:63], v49 offset:4096
v_mfma_f32_16x16x32_bf16 v[148:151], a[76:79], v[204:207], v[148:151]
v_mfma_f32_16x16x32_bf16 v[152:155], a[88:91], v[208:211], v[152:155]
s_waitcnt lgkmcnt(6)
ds_read_b64_tr_b16 a[64:65], v50 offset:0
ds_read_b64_tr_b16 a[66:67], v50 offset:4096
v_mfma_f32_16x16x32_bf16 v[156:159], a[88:91], v[212:215], v[156:159]
v_mfma_f32_16x16x32_bf16 v[88:91], a[48:51], v[208:211], v[88:91]
s_waitcnt lgkmcnt(6)
ds_read_b64_tr_b16 a[68:69], v51 offset:0
ds_read_b64_tr_b16 a[70:71], v51 offset:4096
v_mfma_f32_16x16x32_bf16 v[92:95], a[48:51], v[212:215], v[92:95]
buffer_load_dwordx4 a[24:27], v1, s[12:15], s37 offen offset:3072 sc1
v_mfma_f32_16x16x32_bf16 v[96:99], a[52:55], v[208:211], v[96:99]
s_waitcnt lgkmcnt(6)
ds_read_b64_tr_b16 a[72:73], v52 offset:0
ds_read_b64_tr_b16 a[74:75], v52 offset:4096
v_mfma_f32_16x16x32_bf16 v[100:103], a[52:55], v[212:215], v[100:103]
v_mfma_f32_16x16x32_bf16 v[104:107], a[56:59], v[208:211], v[104:107]
s_waitcnt lgkmcnt(6)
ds_read_b64_tr_b16 a[76:77], v53 offset:0
ds_read_b64_tr_b16 a[78:79], v53 offset:4096
v_mfma_f32_16x16x32_bf16 v[108:111], a[56:59], v[212:215], v[108:111]
buffer_load_dwordx4 a[28:31], v1, s[12:15], s38 offen offset:3072 sc1
v_mfma_f32_16x16x32_bf16 v[112:115], a[60:63], v[208:211], v[112:115]
s_waitcnt lgkmcnt(6)
v_mfma_f32_16x16x32_bf16 v[116:119], a[60:63], v[212:215], v[116:119]
v_mfma_f32_16x16x32_bf16 v[120:123], a[64:67], v[208:211], v[120:123]
s_waitcnt lgkmcnt(4)
ds_read_b64_tr_b16 a[48:49], v46 offset:8192
ds_read_b64_tr_b16 a[50:51], v46 offset:12288
v_mfma_f32_16x16x32_bf16 v[124:127], a[64:67], v[212:215], v[124:127]
s_lshl_b32 s37, s41, 6
s_and_b32 s37, s37, 0x3000
s_add_u32 s37, s37, s85
v_mfma_f32_16x16x32_bf16 v[128:131], a[68:71], v[208:211], v[128:131]
s_waitcnt lgkmcnt(4)
ds_read_b64_tr_b16 a[52:53], v47 offset:8192
ds_read_b64_tr_b16 a[54:55], v47 offset:12288
v_mfma_f32_16x16x32_bf16 v[132:135], a[68:71], v[212:215], v[132:135]
buffer_load_dwordx4 a[32:35], v1, s[12:15], s37 offen offset:0 sc1
v_mfma_f32_16x16x32_bf16 v[136:139], a[72:75], v[208:211], v[136:139]
s_waitcnt lgkmcnt(4)
ds_read_b64_tr_b16 a[56:57], v48 offset:8192
ds_read_b64_tr_b16 a[58:59], v48 offset:12288
v_mfma_f32_16x16x32_bf16 v[140:143], a[72:75], v[212:215], v[140:143]
s_add_u32 s38, s37, 18432
v_mfma_f32_16x16x32_bf16 v[144:147], a[76:79], v[208:211], v[144:147]
ds_read_b64_tr_b16 a[60:61], v49 offset:8192
ds_read_b64_tr_b16 a[62:63], v49 offset:12288
v_mfma_f32_16x16x32_bf16 v[148:151], a[76:79], v[212:215], v[148:151]
s_barrier
v_mfma_f32_16x16x32_bf16 v[152:155], a[92:95], v[216:219], v[152:155]
s_waitcnt lgkmcnt(6)
ds_read_b64_tr_b16 a[64:65], v50 offset:8192
ds_read_b64_tr_b16 a[66:67], v50 offset:12288
v_mfma_f32_16x16x32_bf16 v[156:159], a[92:95], v[220:223], v[156:159]
buffer_load_dwordx4 a[36:39], v1, s[12:15], s38 offen offset:0 sc1
v_mfma_f32_16x16x32_bf16 v[88:91], a[48:51], v[216:219], v[88:91]
s_waitcnt lgkmcnt(6)
ds_read_b64_tr_b16 a[68:69], v51 offset:8192
ds_read_b64_tr_b16 a[70:71], v51 offset:12288
v_mfma_f32_16x16x32_bf16 v[92:95], a[48:51], v[220:223], v[92:95]
v_mfma_f32_16x16x32_bf16 v[96:99], a[52:55], v[216:219], v[96:99]
s_waitcnt lgkmcnt(6)
ds_read_b64_tr_b16 a[72:73], v52 offset:8192
ds_read_b64_tr_b16 a[74:75], v52 offset:12288
v_mfma_f32_16x16x32_bf16 v[100:103], a[52:55], v[220:223], v[100:103]
buffer_load_dwordx4 a[40:43], v1, s[12:15], s37 offen offset:1024 sc1
v_mfma_f32_16x16x32_bf16 v[104:107], a[56:59], v[216:219], v[104:107]
s_waitcnt lgkmcnt(6)
ds_read_b64_tr_b16 a[76:77], v53 offset:8192
ds_read_b64_tr_b16 a[78:79], v53 offset:12288
v_mfma_f32_16x16x32_bf16 v[108:111], a[56:59], v[220:223], v[108:111]
v_mfma_f32_16x16x32_bf16 v[112:115], a[60:63], v[216:219], v[112:115]
s_waitcnt lgkmcnt(6)
v_mfma_f32_16x16x32_bf16 v[116:119], a[60:63], v[220:223], v[116:119]
buffer_load_dwordx4 a[44:47], v1, s[12:15], s38 offen offset:1024 sc1
v_mfma_f32_16x16x32_bf16 v[120:123], a[64:67], v[216:219], v[120:123]
s_waitcnt lgkmcnt(4)
ds_read_b64_tr_b16 a[48:49], v38 offset:16384
ds_read_b64_tr_b16 a[50:51], v38 offset:20480
v_mfma_f32_16x16x32_bf16 v[124:127], a[64:67], v[220:223], v[124:127]
v_mfma_f32_16x16x32_bf16 v[128:131], a[68:71], v[216:219], v[128:131]
s_waitcnt lgkmcnt(4)
ds_read_b64_tr_b16 a[52:53], v39 offset:16384
ds_read_b64_tr_b16 a[54:55], v39 offset:20480
v_mfma_f32_16x16x32_bf16 v[132:135], a[68:71], v[220:223], v[132:135]
s_mul_i32 s56, s66, 18432
s_add_u32 s56, s56, s86
s_add_u32 s56, s56, 100663296
v_mfma_f32_16x16x32_bf16 v[136:139], a[72:75], v[216:219], v[136:139]
s_waitcnt lgkmcnt(4)
ds_read_b64_tr_b16 a[56:57], v40 offset:16384
ds_read_b64_tr_b16 a[58:59], v40 offset:20480
v_mfma_f32_16x16x32_bf16 v[140:143], a[72:75], v[220:223], v[140:143]
s_add_u32 s57, s56, 9437184
v_mfma_f32_16x16x32_bf16 v[144:147], a[76:79], v[216:219], v[144:147]
s_waitcnt vmcnt(24)
ds_read_b64_tr_b16 a[60:61], v41 offset:16384
ds_read_b64_tr_b16 a[62:63], v41 offset:20480
v_mfma_f32_16x16x32_bf16 v[148:151], a[76:79], v[220:223], v[148:151]
buffer_load_dwordx4 a[196:199], v13, s[12:15], s56 offen offset:1024 sc1
v_mfma_f32_16x16x32_bf16 v[152:155], a[96:99], v[224:227], v[152:155]
s_waitcnt lgkmcnt(6)
ds_read_b64_tr_b16 a[64:65], v42 offset:16384
ds_read_b64_tr_b16 a[66:67], v42 offset:20480
v_mfma_f32_16x16x32_bf16 v[156:159], a[96:99], v[228:231], v[156:159]
buffer_load_dwordx4 a[164:167], v12, s[12:15], s56 offen offset:0 sc1
v_mfma_f32_16x16x32_bf16 v[88:91], a[48:51], v[224:227], v[88:91]
s_waitcnt lgkmcnt(6)
ds_read_b64_tr_b16 a[68:69], v43 offset:16384
ds_read_b64_tr_b16 a[70:71], v43 offset:20480
v_mfma_f32_16x16x32_bf16 v[92:95], a[48:51], v[228:231], v[92:95]
v_mfma_f32_16x16x32_bf16 v[96:99], a[52:55], v[224:227], v[96:99]
s_waitcnt lgkmcnt(6)
ds_read_b64_tr_b16 a[72:73], v44 offset:16384
ds_read_b64_tr_b16 a[74:75], v44 offset:20480
v_mfma_f32_16x16x32_bf16 v[100:103], a[52:55], v[228:231], v[100:103]
v_mfma_f32_16x16x32_bf16 v[104:107], a[56:59], v[224:227], v[104:107]
s_waitcnt lgkmcnt(6)
ds_read_b64_tr_b16 a[76:77], v45 offset:16384
ds_read_b64_tr_b16 a[78:79], v45 offset:20480
v_mfma_f32_16x16x32_bf16 v[108:111], a[56:59], v[228:231], v[108:111]
buffer_load_dwordx4 a[168:171], v12, s[12:15], s57 offen offset:0 sc1
v_mfma_f32_16x16x32_bf16 v[112:115], a[60:63], v[224:227], v[112:115]
s_waitcnt lgkmcnt(6)
v_mfma_f32_16x16x32_bf16 v[116:119], a[60:63], v[228:231], v[116:119]
v_mfma_f32_16x16x32_bf16 v[120:123], a[64:67], v[224:227], v[120:123]
s_waitcnt lgkmcnt(4)
ds_read_b64_tr_b16 a[48:49], v38 offset:24576
ds_read_b64_tr_b16 a[50:51], v38 offset:28672
v_mfma_f32_16x16x32_bf16 v[124:127], a[64:67], v[228:231], v[124:127]
buffer_load_dwordx4 a[172:175], v12, s[12:15], s56 offen offset:256 sc1
v_mfma_f32_16x16x32_bf16 v[128:131], a[68:71], v[224:227], v[128:131]
s_waitcnt lgkmcnt(4)
ds_read_b64_tr_b16 a[52:53], v39 offset:24576
ds_read_b64_tr_b16 a[54:55], v39 offset:28672
v_mfma_f32_16x16x32_bf16 v[132:135], a[68:71], v[228:231], v[132:135]
v_mfma_f32_16x16x32_bf16 v[136:139], a[72:75], v[224:227], v[136:139]
s_waitcnt lgkmcnt(4)
ds_read_b64_tr_b16 a[56:57], v40 offset:24576
ds_read_b64_tr_b16 a[58:59], v40 offset:28672
v_mfma_f32_16x16x32_bf16 v[140:143], a[72:75], v[228:231], v[140:143]
v_mfma_f32_16x16x32_bf16 v[144:147], a[76:79], v[224:227], v[144:147]
s_waitcnt vmcnt(25)
ds_read_b64_tr_b16 a[60:61], v41 offset:24576
ds_read_b64_tr_b16 a[62:63], v41 offset:28672
v_mfma_f32_16x16x32_bf16 v[148:151], a[76:79], v[228:231], v[148:151]
buffer_load_dwordx4 a[176:179], v12, s[12:15], s57 offen offset:256 sc1
v_mfma_f32_16x16x32_bf16 v[152:155], a[100:103], v[232:235], v[152:155]
s_waitcnt lgkmcnt(6)
ds_read_b64_tr_b16 a[64:65], v42 offset:24576
ds_read_b64_tr_b16 a[66:67], v42 offset:28672
v_mfma_f32_16x16x32_bf16 v[156:159], a[100:103], v[236:239], v[156:159]
v_mfma_f32_16x16x32_bf16 v[88:91], a[48:51], v[232:235], v[88:91]
s_waitcnt lgkmcnt(6)
ds_read_b64_tr_b16 a[68:69], v43 offset:24576
ds_read_b64_tr_b16 a[70:71], v43 offset:28672
v_mfma_f32_16x16x32_bf16 v[92:95], a[48:51], v[236:239], v[92:95]
buffer_load_dwordx4 a[180:183], v12, s[12:15], s56 offen offset:512 sc1
v_mfma_f32_16x16x32_bf16 v[96:99], a[52:55], v[232:235], v[96:99]
s_waitcnt lgkmcnt(6)
ds_read_b64_tr_b16 a[72:73], v44 offset:24576
ds_read_b64_tr_b16 a[74:75], v44 offset:28672
v_mfma_f32_16x16x32_bf16 v[100:103], a[52:55], v[236:239], v[100:103]
v_mfma_f32_16x16x32_bf16 v[104:107], a[56:59], v[232:235], v[104:107]
s_waitcnt lgkmcnt(6)
ds_read_b64_tr_b16 a[76:77], v45 offset:24576
ds_read_b64_tr_b16 a[78:79], v45 offset:28672
v_mfma_f32_16x16x32_bf16 v[108:111], a[56:59], v[236:239], v[108:111]
v_mfma_f32_16x16x32_bf16 v[112:115], a[60:63], v[232:235], v[112:115]
s_waitcnt lgkmcnt(6)
v_mfma_f32_16x16x32_bf16 v[116:119], a[60:63], v[236:239], v[116:119]
buffer_load_dwordx4 a[184:187], v12, s[12:15], s57 offen offset:512 sc1
v_mfma_f32_16x16x32_bf16 v[120:123], a[64:67], v[232:235], v[120:123]
s_waitcnt lgkmcnt(4)
ds_read_b64_tr_b16 a[48:49], v46 offset:16384
ds_read_b64_tr_b16 a[50:51], v46 offset:20480
v_mfma_f32_16x16x32_bf16 v[124:127], a[64:67], v[236:239], v[124:127]
v_mfma_f32_16x16x32_bf16 v[128:131], a[68:71], v[232:235], v[128:131]
s_waitcnt lgkmcnt(4)
ds_read_b64_tr_b16 a[52:53], v47 offset:16384
ds_read_b64_tr_b16 a[54:55], v47 offset:20480
v_mfma_f32_16x16x32_bf16 v[132:135], a[68:71], v[236:239], v[132:135]
buffer_load_dwordx4 a[188:191], v12, s[12:15], s56 offen offset:768 sc1
v_mfma_f32_16x16x32_bf16 v[136:139], a[72:75], v[232:235], v[136:139]
s_waitcnt lgkmcnt(4)
ds_read_b64_tr_b16 a[56:57], v48 offset:16384
ds_read_b64_tr_b16 a[58:59], v48 offset:20480
v_mfma_f32_16x16x32_bf16 v[140:143], a[72:75], v[236:239], v[140:143]
v_mfma_f32_16x16x32_bf16 v[144:147], a[76:79], v[232:235], v[144:147]
s_waitcnt vmcnt(25)
ds_read_b64_tr_b16 a[60:61], v49 offset:16384
ds_read_b64_tr_b16 a[62:63], v49 offset:20480
v_mfma_f32_16x16x32_bf16 v[148:151], a[76:79], v[236:239], v[148:151]
s_barrier
v_mfma_f32_16x16x32_bf16 v[152:155], a[104:107], v[240:243], v[152:155]
s_waitcnt lgkmcnt(6)
ds_read_b64_tr_b16 a[64:65], v50 offset:16384
ds_read_b64_tr_b16 a[66:67], v50 offset:20480
v_mfma_f32_16x16x32_bf16 v[156:159], a[104:107], v[244:247], v[156:159]
buffer_load_dwordx4 a[192:195], v12, s[12:15], s57 offen offset:768 sc1
v_mfma_f32_16x16x32_bf16 v[88:91], a[48:51], v[240:243], v[88:91]
s_waitcnt lgkmcnt(6)
ds_read_b64_tr_b16 a[68:69], v51 offset:16384
ds_read_b64_tr_b16 a[70:71], v51 offset:20480
v_mfma_f32_16x16x32_bf16 v[92:95], a[48:51], v[244:247], v[92:95]
v_accvgpr_read_b32 v30, a200
v_accvgpr_read_b32 v31, a201
v_mfma_f32_16x16x32_bf16 v[96:99], a[52:55], v[240:243], v[96:99]
s_waitcnt lgkmcnt(6)
ds_read_b64_tr_b16 a[72:73], v52 offset:16384
ds_read_b64_tr_b16 a[74:75], v52 offset:20480
v_mfma_f32_16x16x32_bf16 v[100:103], a[52:55], v[244:247], v[100:103]
v_accvgpr_read_b32 v32, a202
v_accvgpr_read_b32 v33, a203
v_mfma_f32_16x16x32_bf16 v[104:107], a[56:59], v[240:243], v[104:107]
s_waitcnt lgkmcnt(6)
ds_read_b64_tr_b16 a[76:77], v53 offset:16384
ds_read_b64_tr_b16 a[78:79], v53 offset:20480
v_mfma_f32_16x16x32_bf16 v[108:111], a[56:59], v[244:247], v[108:111]
v_accvgpr_read_b32 v34, a204
v_lshlrev_b32 v20, 16, v30
v_mfma_f32_16x16x32_bf16 v[112:115], a[60:63], v[240:243], v[112:115]
s_waitcnt lgkmcnt(6)
ds_read_b64_tr_b16 a[80:81], v62 offset:4096
buffer_load_dwordx4 a[216:219], v1, s[12:15], s37 offen offset:2048 sc1
v_and_b32 v21, 0xffff0000, v30
v_lshlrev_b32 v22, 16, v31
v_mfma_f32_16x16x32_bf16 v[116:119], a[60:63], v[244:247], v[116:119]
v_and_b32 v23, 0xffff0000, v31
v_lshlrev_b32 v24, 16, v32
v_mfma_f32_16x16x32_bf16 v[120:123], a[64:67], v[240:243], v[120:123]
s_waitcnt lgkmcnt(5)
ds_read_b64_tr_b16 a[48:49], v46 offset:24576
ds_read_b64_tr_b16 a[50:51], v46 offset:28672
v_mfma_f32_16x16x32_bf16 v[124:127], a[64:67], v[244:247], v[124:127]
v_and_b32 v25, 0xffff0000, v32
v_lshlrev_b32 v26, 16, v33
v_mfma_f32_16x16x32_bf16 v[128:131], a[68:71], v[240:243], v[128:131]
s_waitcnt lgkmcnt(5)
ds_read_b64_tr_b16 a[52:53], v47 offset:24576
ds_read_b64_tr_b16 a[54:55], v47 offset:28672
v_mfma_f32_16x16x32_bf16 v[132:135], a[68:71], v[244:247], v[132:135]
buffer_load_dwordx4 a[220:223], v1, s[12:15], s38 offen offset:2048 sc1
v_and_b32 v27, 0xffff0000, v33
v_lshlrev_b32 v28, 16, v34
v_mfma_f32_16x16x32_bf16 v[136:139], a[72:75], v[240:243], v[136:139]
s_waitcnt lgkmcnt(5)
ds_read_b64_tr_b16 a[56:57], v48 offset:24576
ds_read_b64_tr_b16 a[58:59], v48 offset:28672
v_mfma_f32_16x16x32_bf16 v[140:143], a[72:75], v[244:247], v[140:143]
v_and_b32 v29, 0xffff0000, v34
s_mul_i32 s68, s66, 18432
v_mfma_f32_16x16x32_bf16 v[144:147], a[76:79], v[240:243], v[144:147]
s_waitcnt vmcnt(25)
ds_read_b64_tr_b16 a[60:61], v49 offset:24576
ds_read_b64_tr_b16 a[62:63], v49 offset:28672
v_mfma_f32_16x16x32_bf16 v[148:151], a[76:79], v[244:247], v[148:151]
s_add_u32 s69, s68, s88
s_add_u32 s70, s68, s89
s_add_u32 s71, s68, s90
v_mfma_f32_16x16x32_bf16 v[152:155], a[108:111], v[248:251], v[152:155]
s_waitcnt lgkmcnt(6)
ds_read_b64_tr_b16 a[64:65], v50 offset:24576
ds_read_b64_tr_b16 a[66:67], v50 offset:28672
buffer_load_dwordx4 a[224:227], v1, s[12:15], s37 offen offset:3072 sc1
v_mfma_f32_16x16x32_bf16 v[156:159], a[108:111], v[252:255], v[156:159]
s_add_u32 s68, s68, s87
ds_read_b64_tr_b16 a[82:83], v62 offset:4608
ds_read_b64_tr_b16 a[84:85], v62 offset:5120
v_mfma_f32_16x16x32_bf16 v[88:91], a[48:51], v[248:251], v[88:91]
s_waitcnt lgkmcnt(8)
ds_read_b64_tr_b16 a[68:69], v51 offset:24576
ds_read_b64_tr_b16 a[70:71], v51 offset:28672
v_mfma_f32_16x16x32_bf16 v[92:95], a[48:51], v[252:255], v[92:95]
buffer_load_dwordx4 a[228:231], v1, s[12:15], s38 offen offset:3072 sc1
v_mfma_f32_16x16x32_bf16 v[96:99], a[52:55], v[248:251], v[96:99]
s_waitcnt lgkmcnt(8)
ds_read_b64_tr_b16 a[72:73], v52 offset:24576
ds_read_b64_tr_b16 a[74:75], v52 offset:28672
v_mfma_f32_16x16x32_bf16 v[100:103], a[52:55], v[252:255], v[100:103]
s_add_u32 s52, s43, 73728
s_add_u32 m0, s49, 0
ds_read_b64_tr_b16 a[86:87], v62 offset:5632
v_mfma_f32_16x16x32_bf16 v[104:107], a[56:59], v[248:251], v[104:107]
s_waitcnt lgkmcnt(9)
ds_read_b64_tr_b16 a[76:77], v53 offset:24576
ds_read_b64_tr_b16 a[78:79], v53 offset:28672
v_mfma_f32_16x16x32_bf16 v[108:111], a[56:59], v[252:255], v[108:111]
buffer_load_dwordx4 v4, s[8:11], s52 offen lds
v_mfma_f32_16x16x32_bf16 v[112:115], a[60:63], v[248:251], v[112:115]
s_waitcnt lgkmcnt(9)
ds_read_b64_tr_b16 a[88:89], v62 offset:6144
ds_read_b64_tr_b16 a[90:91], v62 offset:6656
v_mfma_f32_16x16x32_bf16 v[116:119], a[60:63], v[252:255], v[116:119]
ds_read_b64_tr_b16 a[92:93], v62 offset:7168
ds_read_b64_tr_b16 a[94:95], v62 offset:7680
v_mfma_f32_16x16x32_bf16 v[120:123], a[64:67], v[248:251], v[120:123]
s_waitcnt lgkmcnt(9)
ds_read_b64_tr_b16 a[48:49], v38 offset:32768
ds_read_b64_tr_b16 a[50:51], v38 offset:36864
v_mfma_f32_16x16x32_bf16 v[124:127], a[64:67], v[252:255], v[124:127]
s_add_u32 s52, s43, 1253376
s_add_u32 m0, s49, 1024
v_mfma_f32_16x16x32_bf16 v[128:131], a[68:71], v[248:251], v[128:131]
s_waitcnt lgkmcnt(9)
ds_read_b64_tr_b16 a[52:53], v39 offset:32768
ds_read_b64_tr_b16 a[54:55], v39 offset:36864
v_mfma_f32_16x16x32_bf16 v[132:135], a[68:71], v[252:255], v[132:135]
buffer_load_dwordx4 v5, s[8:11], s52 offen lds
v_mfma_f32_16x16x32_bf16 v[136:139], a[72:75], v[248:251], v[136:139]
s_waitcnt lgkmcnt(8)
ds_read_b64_tr_b16 a[56:57], v40 offset:32768
ds_read_b64_tr_b16 a[58:59], v40 offset:36864
v_mfma_f32_16x16x32_bf16 v[140:143], a[72:75], v[252:255], v[140:143]
s_add_u32 s52, s43, 110592
s_add_u32 m0, s49, 8192
v_mfma_f32_16x16x32_bf16 v[144:147], a[76:79], v[248:251], v[144:147]
s_waitcnt vmcnt(26)
ds_read_b64_tr_b16 a[60:61], v41 offset:32768
ds_read_b64_tr_b16 a[62:63], v41 offset:36864
v_mfma_f32_16x16x32_bf16 v[148:151], a[76:79], v[252:255], v[148:151]
buffer_load_dwordx4 v4, s[8:11], s52 offen lds
v_mfma_f32_16x16x32_bf16 v[152:155], a[112:115], a[0:3], v[152:155]
s_waitcnt lgkmcnt(6)
ds_read_b64_tr_b16 a[64:65], v42 offset:32768
ds_read_b64_tr_b16 a[66:67], v42 offset:36864
v_mfma_f32_16x16x32_bf16 v[156:159], a[112:115], a[4:7], v[156:159]
v_mfma_f32_16x16x32_bf16 v[88:91], a[48:51], a[0:3], v[88:91]
s_waitcnt lgkmcnt(6)
ds_read_b64_tr_b16 a[68:69], v43 offset:32768
ds_read_b64_tr_b16 a[70:71], v43 offset:36864
v_mfma_f32_16x16x32_bf16 v[92:95], a[48:51], a[4:7], v[92:95]
s_add_u32 s52, s43, 1290240
s_add_u32 m0, s49, 9216
v_mfma_f32_16x16x32_bf16 v[96:99], a[52:55], a[0:3], v[96:99]
s_waitcnt lgkmcnt(6)
ds_read_b64_tr_b16 a[72:73], v44 offset:32768
ds_read_b64_tr_b16 a[74:75], v44 offset:36864
v_mfma_f32_16x16x32_bf16 v[100:103], a[52:55], a[4:7], v[100:103]
buffer_load_dwordx4 v5, s[8:11], s52 offen lds
v_mfma_f32_16x16x32_bf16 v[104:107], a[56:59], a[0:3], v[104:107]
s_waitcnt lgkmcnt(6)
ds_read_b64_tr_b16 a[76:77], v45 offset:32768
ds_read_b64_tr_b16 a[78:79], v45 offset:36864
s_waitcnt vmcnt(8)
v_mfma_f32_16x16x32_bf16 v[84:87], a[160:163], a[196:199], 0
v_mfma_f32_16x16x32_bf16 v[76:79], a[152:155], a[164:167], 0
v_mfma_f32_16x16x32_bf16 v[80:83], a[152:155], a[180:183], 0
v_mfma_f32_16x16x32_bf16 v[76:79], a[152:155], a[168:171], v[76:79]
v_mfma_f32_16x16x32_bf16 v[80:83], a[152:155], a[184:187], v[80:83]
v_mfma_f32_16x16x32_bf16 v[76:79], a[156:159], a[172:175], v[76:79]
v_mfma_f32_16x16x32_bf16 v[80:83], a[156:159], a[188:191], v[80:83]
v_mfma_f32_16x16x32_bf16 v[76:79], a[156:159], a[176:179], v[76:79]
v_mfma_f32_16x16x32_bf16 v[80:83], a[156:159], a[192:195], v[80:83]
s_nop 6
v_add_f32 v64, v84, v76
v_add_f32 v64, v64, v80
v_cmp_u_f32 s[62:63], v64, v64
s_nop 0
s_cmp_lg_u64 s[62:63], 0
s_cbranch_scc1 L_kt_rt00
L_kt_rr00:
v_add_f32_dpp v84, v84, v84 row_ror:8 row_mask:0xf bank_mask:0xf
v_add_f32_dpp v85, v85, v85 row_ror:8 row_mask:0xf bank_mask:0xf
v_cvt_pk_bf16_f32 v30, v76, v77
v_cvt_pk_bf16_f32 v31, v78, v79
v_cvt_pk_bf16_f32 v32, v80, v81
v_cvt_pk_bf16_f32 v33, v82, v83
v_cvt_pk_bf16_f32 v34, v84, v85
v_lshlrev_b32 v76, 16, v30
v_and_b32 v77, 0xffff0000, v30
v_lshlrev_b32 v78, 16, v31
v_and_b32 v79, 0xffff0000, v31
v_lshlrev_b32 v80, 16, v32
v_and_b32 v81, 0xffff0000, v32
v_lshlrev_b32 v82, 16, v33
v_and_b32 v83, 0xffff0000, v33
v_lshlrev_b32 v84, 16, v34
v_and_b32 v85, 0xffff0000, v34
v_add_f32 v76, v76, v20
v_add_f32 v77, v77, v21
v_add_f32 v78, v78, v22
v_add_f32 v79, v79, v23
v_add_f32 v80, v80, v24
v_add_f32 v81, v81, v25
v_add_f32 v82, v82, v26
v_add_f32 v83, v83, v27
v_add_f32 v84, v84, v28
v_add_f32 v85, v85, v29
v_cvt_pk_bf16_f32 v30, v76, v77
v_cvt_pk_bf16_f32 v31, v78, v79
v_cvt_pk_bf16_f32 v32, v80, v81
v_cvt_pk_bf16_f32 v33, v82, v83
v_cvt_pk_bf16_f32 v34, v84, v85
v_lshlrev_b32 v76, 16, v30
v_and_b32 v77, 0xffff0000, v30
v_lshlrev_b32 v78, 16, v31
v_and_b32 v79, 0xffff0000, v31
v_lshlrev_b32 v80, 16, v32
v_and_b32 v81, 0xffff0000, v32
v_lshlrev_b32 v82, 16, v33
v_and_b32 v83, 0xffff0000, v33
v_lshlrev_b32 v84, 16, v34
v_mfma_f32_16x16x32_bf16 v[108:111], a[56:59], a[4:7], v[108:111]
s_add_u32 s52, s43, 294912
v_and_b32 v85, 0xffff0000, v34
v_cndmask_b32 v64, v84, v85, s[64:65]
v_add_f32 v66, v76, v77
v_mfma_f32_16x16x32_bf16 v[112:115], a[60:63], a[0:3], v[112:115]
s_waitcnt lgkmcnt(6)
v_add_f32 v67, v78, v79
v_add_f32 v68, v80, v81
v_add_f32 v66, v66, v82
v_mfma_f32_16x16x32_bf16 v[116:119], a[60:63], a[4:7], v[116:119]
s_add_u32 m0, s49, 65536
v_add_f32 v67, v67, v83
v_add_f32 v68, v68, v64
v_add_f32 v66, v66, v67
v_mfma_f32_16x16x32_bf16 v[120:123], a[64:67], a[0:3], v[120:123]
s_waitcnt lgkmcnt(4)
ds_read_b64_tr_b16 a[48:49], v38 offset:40960
ds_read_b64_tr_b16 a[50:51], v38 offset:45056
v_add_f32 v66, v66, v68
v_accvgpr_write_b32 a200, v30
v_accvgpr_write_b32 a201, v31
v_mfma_f32_16x16x32_bf16 v[124:127], a[64:67], a[4:7], v[124:127]
v_add_f32_dpp v66, v66, v66 row_ror:4 row_mask:0xf bank_mask:0xf
v_accvgpr_write_b32 a202, v32
v_accvgpr_write_b32 a203, v33
v_mfma_f32_16x16x32_bf16 v[128:131], a[68:71], a[0:3], v[128:131]
s_waitcnt lgkmcnt(4)
ds_read_b64_tr_b16 a[52:53], v39 offset:40960
ds_read_b64_tr_b16 a[54:55], v39 offset:45056
buffer_load_dwordx4 v4, s[8:11], s52 offen lds
v_add_f32_dpp v66, v66, v66 row_ror:8 row_mask:0xf bank_mask:0xf
v_mov_b32 v68, v66
v_accvgpr_write_b32 a204, v34
v_mfma_f32_16x16x32_bf16 v[132:135], a[68:71], a[4:7], v[132:135]
s_add_u32 s52, s43, 1474560
v_permlane16_swap_b32 v66, v68
v_add_f32 v66, v66, v68
v_mov_b32 v68, v66
v_mfma_f32_16x16x32_bf16 v[136:139], a[72:75], a[0:3], v[136:139]
s_waitcnt lgkmcnt(4)
ds_read_b64_tr_b16 a[56:57], v40 offset:40960
ds_read_b64_tr_b16 a[58:59], v40 offset:45056
v_permlane32_swap_b32 v66, v68
v_add_f32 v66, v66, v68
v_mul_f32 v66, 0.006944444444444444, v66
v_mfma_f32_16x16x32_bf16 v[140:143], a[72:75], a[4:7], v[140:143]
s_add_u32 m0, s49, 66560
v_sub_f32 v20, v76, v66
v_sub_f32 v21, v77, v66
v_sub_f32 v22, v78, v66
v_mfma_f32_16x16x32_bf16 v[144:147], a[76:79], a[0:3], v[144:147]
ds_read_b64_tr_b16 a[60:61], v41 offset:40960
ds_read_b64_tr_b16 a[62:63], v41 offset:45056
v_sub_f32 v23, v79, v66
v_sub_f32 v24, v80, v66
v_sub_f32 v25, v81, v66
v_mfma_f32_16x16x32_bf16 v[148:151], a[76:79], a[4:7], v[148:151]
s_barrier
buffer_load_dwordx4 v5, s[8:11], s52 offen lds
v_sub_f32 v26, v82, v66
v_sub_f32 v27, v83, v66
v_sub_f32 v28, v64, v66
v_mfma_f32_16x16x32_bf16 v[152:155], a[116:119], a[8:11], v[152:155]
s_waitcnt lgkmcnt(6)
ds_read_b64_tr_b16 a[64:65], v42 offset:40960
ds_read_b64_tr_b16 a[66:67], v42 offset:45056
v_mul_f32 v67, v20, v20
v_mul_f32 v68, v21, v21
v_fmac_f32 v67, v22, v22
v_mfma_f32_16x16x32_bf16 v[156:159], a[116:119], a[12:15], v[156:159]
s_add_u32 s52, s43, 331776
v_fmac_f32 v68, v23, v23
v_fmac_f32 v67, v24, v24
v_fmac_f32 v68, v25, v25
v_mfma_f32_16x16x32_bf16 v[88:91], a[48:51], a[8:11], v[88:91]
s_waitcnt lgkmcnt(6)
ds_read_b64_tr_b16 a[68:69], v43 offset:40960
ds_read_b64_tr_b16 a[70:71], v43 offset:45056
v_fmac_f32 v67, v26, v26
v_fmac_f32 v68, v27, v27
v_mfma_f32_16x16x32_bf16 v[92:95], a[48:51], a[12:15], v[92:95]
s_add_u32 m0, s49, 73728
v_fmac_f32 v67, v28, v28
v_add_f32 v67, v67, v68
s_nop 1
v_add_f32_dpp v67, v67, v67 row_ror:4 row_mask:0xf bank_mask:0xf
v_mfma_f32_16x16x32_bf16 v[96:99], a[52:55], a[8:11], v[96:99]
s_waitcnt lgkmcnt(6)
ds_read_b64_tr_b16 a[72:73], v44 offset:40960
ds_read_b64_tr_b16 a[74:75], v44 offset:45056
buffer_load_dwordx4 v4, s[8:11], s52 offen lds
v_add_f32_dpp v67, v67, v67 row_ror:8 row_mask:0xf bank_mask:0xf
v_mov_b32 v68, v67
s_nop 1
v_permlane16_swap_b32 v67, v68
v_mfma_f32_16x16x32_bf16 v[100:103], a[52:55], a[12:15], v[100:103]
s_add_u32 s52, s43, 1511424
v_add_f32 v67, v67, v68
v_mov_b32 v68, v67
s_nop 1
v_permlane32_swap_b32 v67, v68
v_mfma_f32_16x16x32_bf16 v[104:107], a[56:59], a[8:11], v[104:107]
s_waitcnt lgkmcnt(6)
ds_read_b64_tr_b16 a[76:77], v45 offset:40960
ds_read_b64_tr_b16 a[78:79], v45 offset:45056
v_add_f32 v67, v67, v68
s_add_u32 m0, s49, 74752
ds_write_b64 v18, v[66:67] offset:0
v_mfma_f32_16x16x32_bf16 v[108:111], a[56:59], a[12:15], v[108:111]
s_waitcnt lgkmcnt(0)
s_barrier
ds_read_b128 v[20:23], v19 offset:0
v_mfma_f32_16x16x32_bf16 v[112:115], a[60:63], a[8:11], v[112:115]
ds_read_b128 v[24:27], v19 offset:16
s_waitcnt lgkmcnt(0)
v_add_f32 v66, v20, v22
v_mfma_f32_16x16x32_bf16 v[116:119], a[60:63], a[12:15], v[116:119]
buffer_load_dwordx4 v5, s[8:11], s52 offen lds
v_add_f32 v68, v24, v26
v_add_f32 v67, v21, v23
v_add_f32 v66, v66, v68
v_mfma_f32_16x16x32_bf16 v[120:123], a[64:67], a[8:11], v[120:123]
v_add_f32 v68, v25, v27
v_mul_f32 v66, 0.25, v66
v_add_f32 v67, v67, v68
v_mfma_f32_16x16x32_bf16 v[124:127], a[64:67], a[12:15], v[124:127]
s_add_u32 s52, s43, 368640
v_sub_f32 v20, v20, v66
v_sub_f32 v22, v22, v66
v_sub_f32 v24, v24, v66
v_mfma_f32_16x16x32_bf16 v[128:131], a[68:71], a[8:11], v[128:131]
v_sub_f32 v26, v26, v66
v_mul_f32 v68, v20, v20
v_cvt_pk_bf16_f32 v69, v66, v66
v_mfma_f32_16x16x32_bf16 v[132:135], a[68:71], a[12:15], v[132:135]
s_add_u32 m0, s49, 16384
v_fmac_f32 v68, v22, v22
v_fmac_f32 v68, v24, v24
v_fmac_f32 v68, v26, v26
v_mfma_f32_16x16x32_bf16 v[136:139], a[72:75], a[8:11], v[136:139]
ds_read_b64_tr_b16 a[96:97], v62 offset:8192
buffer_load_dwordx4 v4, s[8:11], s52 offen lds
v_lshlrev_b32 v69, 16, v69
v_mul_f32 v67, 0.001736111111111111, v67
v_fmac_f32 v67, 0.25, v68
v_mfma_f32_16x16x32_bf16 v[140:143], a[72:75], a[12:15], v[140:143]
s_add_u32 s52, s43, 1548288
v_cvt_pk_bf16_f32 v67, v67, v67
v_sub_f32 v76, v76, v69
v_sub_f32 v77, v77, v69
v_mfma_f32_16x16x32_bf16 v[144:147], a[76:79], a[8:11], v[144:147]
v_lshlrev_b32 v67, 16, v67
v_sub_f32 v78, v78, v69
v_sub_f32 v79, v79, v69
v_mfma_f32_16x16x32_bf16 v[148:151], a[76:79], a[12:15], v[148:151]
s_add_u32 m0, s49, 17408
v_add_f32 v67, 0x3727c5ac, v67
v_sub_f32 v80, v80, v69
v_sub_f32 v81, v81, v69
v_mfma_f32_16x16x32_bf16 v[152:155], a[120:123], a[16:19], v[152:155]
v_cvt_pk_bf16_f32 v67, v67, v67
v_sub_f32 v82, v82, v69
v_sub_f32 v83, v83, v69
v_mfma_f32_16x16x32_bf16 v[156:159], a[120:123], a[20:23], v[156:159]
buffer_load_dwordx4 v5, s[8:11], s52 offen lds
v_lshlrev_b32 v67, 16, v67
v_sub_f32 v84, v84, v69
v_mfma_f32_16x16x32_bf16 v[152:155], a[124:127], a[24:27], v[152:155]
ds_read_b64_tr_b16 a[48:49], v46 offset:32768
ds_read_b64_tr_b16 a[50:51], v46 offset:36864
v_sub_f32 v85, v85, v69
v_sqrt_f32 v67, v67
v_mfma_f32_16x16x32_bf16 v[156:159], a[124:127], a[28:31], v[156:159]
s_add_u32 s52, s45, 884736
v_cvt_pk_bf16_f32 v30, v76, v77
v_cvt_pk_bf16_f32 v31, v78, v79
v_cvt_pk_bf16_f32 v67, v67, v67
v_mfma_f32_16x16x32_bf16 v[152:155], a[128:131], a[32:35], v[152:155]
ds_read_b64_tr_b16 a[52:53], v47 offset:32768
ds_read_b64_tr_b16 a[54:55], v47 offset:36864
v_cvt_pk_bf16_f32 v32, v80, v81
v_cvt_pk_bf16_f32 v33, v82, v83
v_lshlrev_b32 v67, 16, v67
v_mfma_f32_16x16x32_bf16 v[156:159], a[128:131], a[36:39], v[156:159]
s_add_u32 m0, s50, 4096
v_cvt_pk_bf16_f32 v34, v84, v85
v_lshlrev_b32 v76, 16, v30
v_mfma_f32_16x16x32_bf16 v[152:155], a[132:135], a[40:43], v[152:155]
s_waitcnt vmcnt(12)
ds_read_b64_tr_b16 a[56:57], v38 offset:49152
ds_read_b64_tr_b16 a[58:59], v38 offset:53248
buffer_load_dwordx4 v7, s[8:11], s52 offen lds
v_rcp_f32 v67, v67
v_and_b32 v77, 0xffff0000, v30
v_lshlrev_b32 v78, 16, v31
v_mfma_f32_16x16x32_bf16 v[156:159], a[132:135], a[44:47], v[156:159]
s_add_u32 s52, s43, 405504
v_and_b32 v79, 0xffff0000, v31
v_lshlrev_b32 v80, 16, v32
v_and_b32 v81, 0xffff0000, v32
v_mfma_f32_16x16x32_bf16 v[152:155], a[136:139], a[216:219], v[152:155]
s_waitcnt vmcnt(11)
ds_read_b64_tr_b16 a[60:61], v39 offset:49152
ds_read_b64_tr_b16 a[62:63], v39 offset:53248
v_lshlrev_b32 v82, 16, v33
v_and_b32 v83, 0xffff0000, v33
v_lshlrev_b32 v84, 16, v34
v_mfma_f32_16x16x32_bf16 v[156:159], a[136:139], a[220:223], v[156:159]
s_add_u32 m0, s49, 24576
v_and_b32 v85, 0xffff0000, v34
v_mul_f32 v84, v84, v67
v_mul_f32 v85, v85, v67
v_mfma_f32_16x16x32_bf16 v[152:155], a[140:143], a[224:227], v[152:155]
s_waitcnt lgkmcnt(6)
ds_read_b64_tr_b16 a[64:65], v38 offset:57344
ds_read_b64_tr_b16 a[66:67], v38 offset:61440
v_mul_f32 v76, v76, v67
v_mul_f32 v77, v77, v67
v_mul_f32 v78, v78, v67
v_mfma_f32_16x16x32_bf16 v[156:159], a[140:143], a[228:231], v[156:159]
buffer_load_dwordx4 v4, s[8:11], s52 offen lds
v_mul_f32 v79, v79, v67
v_mul_f32 v80, v80, v67
v_mul_f32 v81, v81, v67
v_mfma_f32_16x16x32_bf16 v[88:91], a[48:51], a[16:19], v[88:91]
s_waitcnt lgkmcnt(6)
ds_read_b64_tr_b16 a[68:69], v39 offset:57344
ds_read_b64_tr_b16 a[70:71], v39 offset:61440
v_mul_f32 v82, v82, v67
v_mul_f32 v83, v83, v67
v_cvt_pk_bf16_f32 v20, v84, v85
v_mfma_f32_16x16x32_bf16 v[92:95], a[48:51], a[20:23], v[92:95]
s_add_u32 s52, s43, 1585152
v_cvt_pk_bf16_f32 v21, v84, v85
v_cvt_pk_bf16_f32 v30, v76, v77
v_cvt_pk_bf16_f32 v32, v80, v81
v_mfma_f32_16x16x32_bf16 v[96:99], a[52:55], a[16:19], v[96:99]
s_waitcnt lgkmcnt(6)
ds_read_b64_tr_b16 a[72:73], v46 offset:49152
ds_read_b64_tr_b16 a[74:75], v46 offset:53248
v_permlane16_swap_b32 v20, v21
v_mov_b32 v22, v20
v_mov_b32 v23, v21
v_mfma_f32_16x16x32_bf16 v[100:103], a[52:55], a[20:23], v[100:103]
s_add_u32 m0, s49, 25600
v_cvt_pk_bf16_f32 v31, v78, v79
v_cvt_pk_bf16_f32 v33, v82, v83
v_permlane32_swap_b32 v20, v22
v_mfma_f32_16x16x32_bf16 v[88:91], a[56:59], a[24:27], v[88:91]
s_waitcnt lgkmcnt(6)
ds_read_b64_tr_b16 a[76:77], v47 offset:49152
ds_read_b64_tr_b16 a[78:79], v47 offset:53248
buffer_load_dwordx4 v5, s[8:11], s52 offen lds
v_permlane32_swap_b32 v21, v23
v_permlane16_swap_b32 v30, v32
v_min_u32 v20, -2, v20
v_mfma_f32_16x16x32_bf16 v[92:95], a[56:59], a[28:31], v[92:95]
s_add_u32 s52, s43, 589824
v_permlane16_swap_b32 v31, v33
v_min_u32 v30, -2, v30
v_mfma_f32_16x16x32_bf16 v[96:99], a[60:63], a[24:27], v[96:99]
s_waitcnt lgkmcnt(6)
ds_read_b64_tr_b16 a[48:49], v46 offset:57344
ds_read_b64_tr_b16 a[50:51], v46 offset:61440
buffer_store_dwordx4 v[20:23], v17, s[12:15], s71 offen sc1
buffer_store_dwordx4 v[30:33], v16, s[12:15], s70 offen sc1
v_mfma_f32_16x16x32_bf16 v[100:103], a[60:63], a[28:31], v[100:103]
s_add_u32 m0, s49, 81920
ds_read_b64_tr_b16 a[98:99], v62 offset:8704
ds_read_b64_tr_b16 a[100:101], v62 offset:9216
v_mfma_f32_16x16x32_bf16 v[88:91], a[64:67], a[32:35], v[88:91]
s_waitcnt lgkmcnt(8)
ds_read_b64_tr_b16 a[52:53], v47 offset:57344
ds_read_b64_tr_b16 a[54:55], v47 offset:61440
v_mfma_f32_16x16x32_bf16 v[92:95], a[64:67], a[36:39], v[92:95]
s_mul_i32 s53, s36, 18432
ds_read_b64_tr_b16 a[102:103], v62 offset:9728
ds_read_b64_tr_b16 a[104:105], v62 offset:10240
buffer_load_dwordx4 v4, s[8:11], s52 offen lds
v_mfma_f32_16x16x32_bf16 v[96:99], a[68:71], a[32:35], v[96:99]
s_waitcnt lgkmcnt(10)
ds_read_b64_tr_b16 a[56:57], v46 offset:40960
ds_read_b64_tr_b16 a[58:59], v46 offset:45056
ds_read_b64_tr_b16 a[106:107], v62 offset:10752
ds_read_b64_tr_b16 a[108:109], v62 offset:11264
ds_read_b64_tr_b16 a[110:111], v62 offset:11776
v_mfma_f32_16x16x32_bf16 v[100:103], a[68:71], a[36:39], v[100:103]
s_add_u32 s52, s43, 1769472
s_add_u32 m0, s49, 82944
s_add_u32 s53, s53, s75
v_mfma_f32_16x16x32_bf16 v[88:91], a[72:75], a[40:43], v[88:91]
s_waitcnt lgkmcnt(13)
ds_read_b64_tr_b16 a[60:61], v47 offset:40960
ds_read_b64_tr_b16 a[62:63], v47 offset:45056
v_mfma_f32_16x16x32_bf16 v[92:95], a[72:75], a[44:47], v[92:95]
buffer_load_dwordx4 v5, s[8:11], s52 offen lds
v_mfma_f32_16x16x32_bf16 v[96:99], a[76:79], a[40:43], v[96:99]
s_waitcnt lgkmcnt(13)
ds_read_b64_tr_b16 a[64:65], v48 offset:32768
ds_read_b64_tr_b16 a[66:67], v48 offset:36864
v_mfma_f32_16x16x32_bf16 v[100:103], a[76:79], a[44:47], v[100:103]
s_add_u32 s52, s43, 626688
s_add_u32 m0, s49, 90112
s_add_u32 s53, s53, 100663296
v_mfma_f32_16x16x32_bf16 v[88:91], a[48:51], a[216:219], v[88:91]
s_waitcnt lgkmcnt(11)
ds_read_b64_tr_b16 a[68:69], v49 offset:32768
ds_read_b64_tr_b16 a[70:71], v49 offset:36864
v_mfma_f32_16x16x32_bf16 v[92:95], a[48:51], a[220:223], v[92:95]
buffer_load_dwordx4 v4, s[8:11], s52 offen lds
v_mfma_f32_16x16x32_bf16 v[96:99], a[52:55], a[216:219], v[96:99]
s_waitcnt lgkmcnt(9)
ds_read_b64_tr_b16 a[72:73], v40 offset:49152
ds_read_b64_tr_b16 a[74:75], v40 offset:53248
v_mfma_f32_16x16x32_bf16 v[100:103], a[52:55], a[220:223], v[100:103]
s_add_u32 s52, s43, 1806336
s_add_u32 m0, s49, 91136
s_add_u32 s54, s53, 18432
v_mfma_f32_16x16x32_bf16 v[88:91], a[56:59], a[224:227], v[88:91]
s_waitcnt lgkmcnt(6)
ds_read_b64_tr_b16 a[76:77], v41 offset:49152
ds_read_b64_tr_b16 a[78:79], v41 offset:53248
v_mfma_f32_16x16x32_bf16 v[92:95], a[56:59], a[228:231], v[92:95]
buffer_load_dwordx4 v5, s[8:11], s52 offen lds
v_mfma_f32_16x16x32_bf16 v[96:99], a[60:63], a[224:227], v[96:99]
s_waitcnt lgkmcnt(6)
ds_read_b64_tr_b16 a[48:49], v40 offset:57344
ds_read_b64_tr_b16 a[50:51], v40 offset:61440
v_mfma_f32_16x16x32_bf16 v[100:103], a[60:63], a[228:231], v[100:103]
s_barrier
v_mfma_f32_16x16x32_bf16 v[104:107], a[64:67], a[16:19], v[104:107]
s_waitcnt lgkmcnt(6)
ds_read_b64_tr_b16 a[52:53], v41 offset:57344
ds_read_b64_tr_b16 a[54:55], v41 offset:61440
v_mfma_f32_16x16x32_bf16 v[108:111], a[64:67], a[20:23], v[108:111]
s_add_u32 s52, s46, 0
s_add_u32 m0, s51, 8192
ds_read_b64_tr_b16 a[112:113], v62 offset:0
v_mfma_f32_16x16x32_bf16 v[112:115], a[68:71], a[16:19], v[112:115]
s_waitcnt lgkmcnt(7)
ds_read_b64_tr_b16 a[56:57], v48 offset:49152
ds_read_b64_tr_b16 a[58:59], v48 offset:53248
v_mfma_f32_16x16x32_bf16 v[116:119], a[68:71], a[20:23], v[116:119]
buffer_load_dwordx4 v8, s[8:11], s52 offen lds
v_mfma_f32_16x16x32_bf16 v[104:107], a[72:75], a[24:27], v[104:107]
s_waitcnt lgkmcnt(7)
ds_read_b64_tr_b16 a[60:61], v49 offset:49152
ds_read_b64_tr_b16 a[62:63], v49 offset:53248
v_mfma_f32_16x16x32_bf16 v[108:111], a[72:75], a[28:31], v[108:111]
s_add_u32 s52, s43, 663552
s_add_u32 m0, s49, 32768
v_cvt_pk_bf16_f32 v152, v152, v153
v_mfma_f32_16x16x32_bf16 v[112:115], a[76:79], a[24:27], v[112:115]
s_waitcnt lgkmcnt(7)
ds_read_b64_tr_b16 a[64:65], v48 offset:57344
ds_read_b64_tr_b16 a[66:67], v48 offset:61440
v_mfma_f32_16x16x32_bf16 v[116:119], a[76:79], a[28:31], v[116:119]
buffer_load_dwordx4 v4, s[8:11], s52 offen lds
v_mfma_f32_16x16x32_bf16 v[104:107], a[48:51], a[32:35], v[104:107]
s_waitcnt lgkmcnt(7)
ds_read_b64_tr_b16 a[68:69], v49 offset:57344
ds_read_b64_tr_b16 a[70:71], v49 offset:61440
v_mfma_f32_16x16x32_bf16 v[108:111], a[48:51], a[36:39], v[108:111]
ds_read_b64_tr_b16 a[114:115], v62 offset:512
v_cvt_pk_bf16_f32 v153, v154, v155
v_mfma_f32_16x16x32_bf16 v[112:115], a[52:55], a[32:35], v[112:115]
s_waitcnt lgkmcnt(7)
ds_read_b64_tr_b16 a[72:73], v48 offset:40960
ds_read_b64_tr_b16 a[74:75], v48 offset:45056
v_mfma_f32_16x16x32_bf16 v[116:119], a[52:55], a[36:39], v[116:119]
s_add_u32 s52, s43, 1843200
s_add_u32 m0, s49, 33792
ds_read_b64_tr_b16 a[116:117], v62 offset:1024
v_mfma_f32_16x16x32_bf16 v[104:107], a[56:59], a[40:43], v[104:107]
s_waitcnt lgkmcnt(8)
ds_read_b64_tr_b16 a[76:77], v49 offset:40960
ds_read_b64_tr_b16 a[78:79], v49 offset:45056
v_mfma_f32_16x16x32_bf16 v[108:111], a[56:59], a[44:47], v[108:111]
buffer_load_dwordx4 v5, s[8:11], s52 offen lds
v_mfma_f32_16x16x32_bf16 v[112:115], a[60:63], a[40:43], v[112:115]
s_waitcnt lgkmcnt(8)
ds_read_b64_tr_b16 a[48:49], v50 offset:32768
ds_read_b64_tr_b16 a[50:51], v50 offset:36864
v_mfma_f32_16x16x32_bf16 v[116:119], a[60:63], a[44:47], v[116:119]
s_add_u32 s52, s43, 700416
s_add_u32 m0, s49, 40960
v_cvt_pk_bf16_f32 v154, v156, v157
v_mfma_f32_16x16x32_bf16 v[104:107], a[64:67], a[216:219], v[104:107]
s_waitcnt lgkmcnt(8)
ds_read_b64_tr_b16 a[52:53], v51 offset:32768
ds_read_b64_tr_b16 a[54:55], v51 offset:36864
v_mfma_f32_16x16x32_bf16 v[108:111], a[64:67], a[220:223], v[108:111]
buffer_load_dwordx4 v4, s[8:11], s52 offen lds
v_mfma_f32_16x16x32_bf16 v[112:115], a[68:71], a[216:219], v[112:115]
s_waitcnt lgkmcnt(7)
ds_read_b64_tr_b16 a[56:57], v42 offset:49152
ds_read_b64_tr_b16 a[58:59], v42 offset:53248
v_mfma_f32_16x16x32_bf16 v[116:119], a[68:71], a[220:223], v[116:119]
ds_read_b64_tr_b16 a[118:119], v62 offset:1536
v_cvt_pk_bf16_f32 v155, v158, v159
v_mfma_f32_16x16x32_bf16 v[104:107], a[72:75], a[224:227], v[104:107]
s_waitcnt lgkmcnt(7)
ds_read_b64_tr_b16 a[60:61], v43 offset:49152
ds_read_b64_tr_b16 a[62:63], v43 offset:53248
v_mfma_f32_16x16x32_bf16 v[108:111], a[72:75], a[228:231], v[108:111]
s_add_u32 s52, s43, 1880064
s_add_u32 m0, s49, 41984
ds_read_b64_tr_b16 a[120:121], v62 offset:2048
v_mfma_f32_16x16x32_bf16 v[112:115], a[76:79], a[224:227], v[112:115]
s_waitcnt lgkmcnt(8)
ds_read_b64_tr_b16 a[64:65], v42 offset:57344
ds_read_b64_tr_b16 a[66:67], v42 offset:61440
v_mfma_f32_16x16x32_bf16 v[116:119], a[76:79], a[228:231], v[116:119]
buffer_load_dwordx4 v5, s[8:11], s52 offen lds
v_mfma_f32_16x16x32_bf16 v[120:123], a[48:51], a[16:19], v[120:123]
s_waitcnt lgkmcnt(8)
ds_read_b64_tr_b16 a[68:69], v43 offset:57344
ds_read_b64_tr_b16 a[70:71], v43 offset:61440
v_mfma_f32_16x16x32_bf16 v[124:127], a[48:51], a[20:23], v[124:127]
ds_read_b64_tr_b16 a[122:123], v62 offset:2560
v_permlane32_swap_b32 v152, v154
v_mfma_f32_16x16x32_bf16 v[128:131], a[52:55], a[16:19], v[128:131]
s_waitcnt lgkmcnt(9)
ds_read_b64_tr_b16 a[72:73], v50 offset:49152
ds_read_b64_tr_b16 a[74:75], v50 offset:53248
v_mfma_f32_16x16x32_bf16 v[132:135], a[52:55], a[20:23], v[132:135]
v_permlane32_swap_b32 v153, v155
buffer_store_dwordx4 v[152:155], v10, s[12:15], s53 offen offset:1024 sc1
v_mfma_f32_16x16x32_bf16 v[120:123], a[56:59], a[24:27], v[120:123]
s_waitcnt lgkmcnt(8)
ds_read_b64_tr_b16 a[76:77], v51 offset:49152
ds_read_b64_tr_b16 a[78:79], v51 offset:53248
v_mfma_f32_16x16x32_bf16 v[124:127], a[56:59], a[28:31], v[124:127]
ds_read_b64_tr_b16 a[124:125], v62 offset:3072
v_cvt_pk_bf16_f32 v192, v88, v89
v_mfma_f32_16x16x32_bf16 v[128:131], a[60:63], a[24:27], v[128:131]
s_waitcnt lgkmcnt(8)
ds_read_b64_tr_b16 a[48:49], v50 offset:57344
ds_read_b64_tr_b16 a[50:51], v50 offset:61440
v_mfma_f32_16x16x32_bf16 v[132:135], a[60:63], a[28:31], v[132:135]
ds_read_b64_tr_b16 a[126:127], v62 offset:3584
v_cvt_pk_bf16_f32 v193, v90, v91
v_mfma_f32_16x16x32_bf16 v[120:123], a[64:67], a[32:35], v[120:123]
s_waitcnt lgkmcnt(9)
ds_read_b64_tr_b16 a[52:53], v51 offset:57344
ds_read_b64_tr_b16 a[54:55], v51 offset:61440
v_mfma_f32_16x16x32_bf16 v[124:127], a[64:67], a[36:39], v[124:127]
v_cvt_pk_bf16_f32 v194, v96, v97
v_cvt_pk_bf16_f32 v195, v98, v99
buffer_store_dwordx4 v[192:195], v9, s[12:15], s53 offen offset:0 sc1
v_mfma_f32_16x16x32_bf16 v[128:131], a[68:71], a[32:35], v[128:131]
s_waitcnt lgkmcnt(8)
ds_read_b64_tr_b16 a[56:57], v50 offset:40960
ds_read_b64_tr_b16 a[58:59], v50 offset:45056
v_mfma_f32_16x16x32_bf16 v[132:135], a[68:71], a[36:39], v[132:135]
v_cvt_pk_bf16_f32 v196, v92, v93
v_cvt_pk_bf16_f32 v197, v94, v95
v_mfma_f32_16x16x32_bf16 v[120:123], a[72:75], a[40:43], v[120:123]
s_waitcnt lgkmcnt(8)
ds_read_b64_tr_b16 a[60:61], v51 offset:40960
ds_read_b64_tr_b16 a[62:63], v51 offset:45056
v_mfma_f32_16x16x32_bf16 v[124:127], a[72:75], a[44:47], v[124:127]
v_cvt_pk_bf16_f32 v198, v100, v101
v_cvt_pk_bf16_f32 v199, v102, v103
buffer_store_dwordx4 v[196:199], v9, s[12:15], s54 offen offset:0 sc1
v_mfma_f32_16x16x32_bf16 v[128:131], a[76:79], a[40:43], v[128:131]
s_waitcnt lgkmcnt(7)
ds_read_b64_tr_b16 a[64:65], v52 offset:32768
ds_read_b64_tr_b16 a[66:67], v52 offset:36864
v_mfma_f32_16x16x32_bf16 v[132:135], a[76:79], a[44:47], v[132:135]
v_cvt_pk_bf16_f32 v200, v104, v105
v_cvt_pk_bf16_f32 v201, v106, v107
v_mfma_f32_16x16x32_bf16 v[120:123], a[48:51], a[216:219], v[120:123]
s_waitcnt lgkmcnt(6)
ds_read_b64_tr_b16 a[68:69], v53 offset:32768
ds_read_b64_tr_b16 a[70:71], v53 offset:36864
v_mfma_f32_16x16x32_bf16 v[124:127], a[48:51], a[220:223], v[124:127]
v_cvt_pk_bf16_f32 v202, v112, v113
v_cvt_pk_bf16_f32 v203, v114, v115
buffer_store_dwordx4 v[200:203], v9, s[12:15], s53 offen offset:256 sc1
v_mfma_f32_16x16x32_bf16 v[128:131], a[52:55], a[216:219], v[128:131]
s_waitcnt lgkmcnt(6)
ds_read_b64_tr_b16 a[72:73], v44 offset:49152
ds_read_b64_tr_b16 a[74:75], v44 offset:53248
v_mfma_f32_16x16x32_bf16 v[132:135], a[52:55], a[220:223], v[132:135]
v_cvt_pk_bf16_f32 v204, v108, v109
v_cvt_pk_bf16_f32 v205, v110, v111
v_mfma_f32_16x16x32_bf16 v[120:123], a[56:59], a[224:227], v[120:123]
s_waitcnt lgkmcnt(6)
ds_read_b64_tr_b16 a[76:77], v45 offset:49152
ds_read_b64_tr_b16 a[78:79], v45 offset:53248
v_mfma_f32_16x16x32_bf16 v[124:127], a[56:59], a[228:231], v[124:127]
v_cvt_pk_bf16_f32 v206, v116, v117
v_cvt_pk_bf16_f32 v207, v118, v119
buffer_store_dwordx4 v[204:207], v9, s[12:15], s54 offen offset:256 sc1
v_mfma_f32_16x16x32_bf16 v[128:131], a[60:63], a[224:227], v[128:131]
s_waitcnt lgkmcnt(6)
ds_read_b64_tr_b16 a[48:49], v44 offset:57344
ds_read_b64_tr_b16 a[50:51], v44 offset:61440
v_mfma_f32_16x16x32_bf16 v[132:135], a[60:63], a[228:231], v[132:135]
v_mfma_f32_16x16x32_bf16 v[136:139], a[64:67], a[16:19], v[136:139]
s_waitcnt lgkmcnt(6)
ds_read_b64_tr_b16 a[52:53], v45 offset:57344
ds_read_b64_tr_b16 a[54:55], v45 offset:61440
v_mfma_f32_16x16x32_bf16 v[140:143], a[64:67], a[20:23], v[140:143]
v_cvt_pk_bf16_f32 v208, v120, v121
v_cvt_pk_bf16_f32 v209, v122, v123
v_mfma_f32_16x16x32_bf16 v[144:147], a[68:71], a[16:19], v[144:147]
s_waitcnt lgkmcnt(6)
ds_read_b64_tr_b16 a[56:57], v52 offset:49152
ds_read_b64_tr_b16 a[58:59], v52 offset:53248
v_mfma_f32_16x16x32_bf16 v[148:151], a[68:71], a[20:23], v[148:151]
v_cvt_pk_bf16_f32 v210, v128, v129
v_cvt_pk_bf16_f32 v211, v130, v131
v_mfma_f32_16x16x32_bf16 v[136:139], a[72:75], a[24:27], v[136:139]
s_waitcnt lgkmcnt(6)
ds_read_b64_tr_b16 a[60:61], v53 offset:49152
ds_read_b64_tr_b16 a[62:63], v53 offset:53248
v_mfma_f32_16x16x32_bf16 v[140:143], a[72:75], a[28:31], v[140:143]
s_barrier
buffer_store_dwordx4 v[208:211], v9, s[12:15], s53 offen offset:512 sc1
v_mfma_f32_16x16x32_bf16 v[144:147], a[76:79], a[24:27], v[144:147]
s_waitcnt lgkmcnt(6)
ds_read_b64_tr_b16 a[64:65], v52 offset:57344
ds_read_b64_tr_b16 a[66:67], v52 offset:61440
v_mfma_f32_16x16x32_bf16 v[148:151], a[76:79], a[28:31], v[148:151]
s_add_u32 s52, s43, 884736
s_add_u32 m0, s49, 98304
v_cvt_pk_bf16_f32 v212, v124, v125
v_mfma_f32_16x16x32_bf16 v[136:139], a[48:51], a[32:35], v[136:139]
s_waitcnt lgkmcnt(6)
ds_read_b64_tr_b16 a[68:69], v53 offset:57344
ds_read_b64_tr_b16 a[70:71], v53 offset:61440
v_mfma_f32_16x16x32_bf16 v[140:143], a[48:51], a[36:39], v[140:143]
buffer_load_dwordx4 v4, s[8:11], s52 offen lds
v_mfma_f32_16x16x32_bf16 v[144:147], a[52:55], a[32:35], v[144:147]
s_waitcnt lgkmcnt(6)
ds_read_b64_tr_b16 a[72:73], v52 offset:40960
ds_read_b64_tr_b16 a[74:75], v52 offset:45056
v_mfma_f32_16x16x32_bf16 v[148:151], a[52:55], a[36:39], v[148:151]
s_add_u32 s52, s43, 2064384
s_add_u32 m0, s49, 99328
v_cvt_pk_bf16_f32 v213, v126, v127
v_mfma_f32_16x16x32_bf16 v[136:139], a[56:59], a[40:43], v[136:139]
s_waitcnt lgkmcnt(6)
ds_read_b64_tr_b16 a[76:77], v53 offset:40960
ds_read_b64_tr_b16 a[78:79], v53 offset:45056
v_mfma_f32_16x16x32_bf16 v[140:143], a[56:59], a[44:47], v[140:143]
v_cvt_pk_bf16_f32 v214, v132, v133
v_cvt_pk_bf16_f32 v215, v134, v135
buffer_store_dwordx4 v[212:215], v9, s[12:15], s54 offen offset:512 sc1
v_mfma_f32_16x16x32_bf16 v[144:147], a[60:63], a[40:43], v[144:147]
s_waitcnt lgkmcnt(6)
buffer_load_dwordx4 v5, s[8:11], s52 offen lds
v_mfma_f32_16x16x32_bf16 v[148:151], a[60:63], a[44:47], v[148:151]
s_add_u32 s52, s43, 921600
s_add_u32 m0, s49, 49152
v_mfma_f32_16x16x32_bf16 v[136:139], a[64:67], a[216:219], v[136:139]
s_waitcnt lgkmcnt(4)
ds_read_b64_tr_b16 a[48:49], v54 offset:0
ds_read_b64_tr_b16 a[50:51], v54 offset:4096
v_mfma_f32_16x16x32_bf16 v[140:143], a[64:67], a[220:223], v[140:143]
buffer_load_dwordx4 v4, s[8:11], s52 offen lds
v_mfma_f32_16x16x32_bf16 v[144:147], a[68:71], a[216:219], v[144:147]
s_waitcnt lgkmcnt(4)
ds_read_b64_tr_b16 a[52:53], v55 offset:0
ds_read_b64_tr_b16 a[54:55], v55 offset:4096
v_mfma_f32_16x16x32_bf16 v[148:151], a[68:71], a[220:223], v[148:151]
s_add_u32 s52, s43, 2101248
s_add_u32 m0, s49, 50176
v_mfma_f32_16x16x32_bf16 v[136:139], a[72:75], a[224:227], v[136:139]
s_waitcnt lgkmcnt(4)
ds_read_b64_tr_b16 a[56:57], v56 offset:0
ds_read_b64_tr_b16 a[58:59], v56 offset:4096
v_mfma_f32_16x16x32_bf16 v[140:143], a[72:75], a[228:231], v[140:143]
buffer_load_dwordx4 v5, s[8:11], s52 offen lds
v_mfma_f32_16x16x32_bf16 v[144:147], a[76:79], a[224:227], v[144:147]
ds_read_b64_tr_b16 a[60:61], v57 offset:0
ds_read_b64_tr_b16 a[62:63], v57 offset:4096
v_mfma_f32_16x16x32_bf16 v[148:151], a[76:79], a[228:231], v[148:151]
s_waitcnt vmcnt(31)
s_barrier
v_cvt_pk_bf16_f32 v216, v136, v137
v_cvt_pk_bf16_f32 v217, v138, v139
s_nop 0
v_cvt_pk_bf16_f32 v218, v144, v145
v_cvt_pk_bf16_f32 v219, v146, v147
v_cvt_pk_bf16_f32 v220, v140, v141
v_cvt_pk_bf16_f32 v221, v142, v143
buffer_store_dwordx4 v[216:219], v9, s[12:15], s53 offen offset:768 sc1
v_cvt_pk_bf16_f32 v222, v148, v149
v_cvt_pk_bf16_f32 v223, v150, v151
buffer_store_dwordx4 v[220:223], v9, s[12:15], s54 offen offset:768 sc1
s_mul_i32 s39, s35, 18432
s_add_u32 s39, s39, 119537664
s_add_u32 s40, s39, 18432
L_kt_spin:
s_mul_i32 s37, s35, 18432
s_add_u32 s37, s37, 119537664
s_add_u32 s38, s37, 18432
buffer_load_dwordx4 v[160:163], v1, s[12:15], s37 offen offset:0 sc1
buffer_load_dwordx4 v[164:167], v1, s[12:15], s38 offen offset:0 sc1
buffer_load_dwordx4 v[168:171], v1, s[12:15], s37 offen offset:1024 sc1
buffer_load_dwordx4 v[172:175], v1, s[12:15], s38 offen offset:1024 sc1
s_waitcnt vmcnt(0)
v_max3_u32 v35, v160, v164, v168
v_max_u32 v35, v35, v172
v_cmp_eq_u32 vcc, -1, v35
s_sub_u32 s58, s58, 1
s_cselect_b32 s58, 0, s58
s_cselect_b64 vcc, 0, vcc
s_nop 1
s_cbranch_vccnz L_kt_spin
buffer_load_dwordx4 v[176:179], v1, s[12:15], s37 offen offset:2048 sc1
buffer_load_dwordx4 v[180:183], v1, s[12:15], s38 offen offset:2048 sc1
buffer_load_dwordx4 v[184:187], v1, s[12:15], s37 offen offset:3072 sc1
buffer_load_dwordx4 v[188:191], v1, s[12:15], s38 offen offset:3072 sc1
s_add_u32 s37, s37, 4096
buffer_load_dwordx4 v[224:227], v1, s[12:15], s37 offen offset:0 sc1
s_add_u32 s38, s38, 4096
buffer_load_dwordx4 v[228:231], v1, s[12:15], s38 offen offset:0 sc1
buffer_load_dwordx4 v[232:235], v1, s[12:15], s37 offen offset:1024 sc1
buffer_load_dwordx4 v[236:239], v1, s[12:15], s38 offen offset:1024 sc1
v_mfma_f32_16x16x32_bf16 v[152:155], a[80:83], v[160:163], 0
s_waitcnt lgkmcnt(6)
ds_read_b64_tr_b16 a[64:65], v58 offset:0
ds_read_b64_tr_b16 a[66:67], v58 offset:4096
v_mfma_f32_16x16x32_bf16 v[156:159], a[80:83], v[164:167], 0
s_mul_i32 s56, s67, 18432
s_add_u32 s56, s56, s86
s_add_u32 s56, s56, 100663296
v_mfma_f32_16x16x32_bf16 v[88:91], a[48:51], v[160:163], 0
s_waitcnt lgkmcnt(6)
ds_read_b64_tr_b16 a[68:69], v59 offset:0
ds_read_b64_tr_b16 a[70:71], v59 offset:4096
v_mfma_f32_16x16x32_bf16 v[92:95], a[48:51], v[164:167], 0
s_add_u32 s57, s56, 9437184
v_mfma_f32_16x16x32_bf16 v[96:99], a[52:55], v[160:163], 0
s_waitcnt lgkmcnt(6)
ds_read_b64_tr_b16 a[72:73], v60 offset:0
ds_read_b64_tr_b16 a[74:75], v60 offset:4096
v_mfma_f32_16x16x32_bf16 v[100:103], a[52:55], v[164:167], 0
buffer_load_dwordx4 a[196:199], v13, s[12:15], s56 offen offset:1024 sc1
v_mfma_f32_16x16x32_bf16 v[104:107], a[56:59], v[160:163], 0
s_waitcnt lgkmcnt(6)
ds_read_b64_tr_b16 a[76:77], v61 offset:0
ds_read_b64_tr_b16 a[78:79], v61 offset:4096
v_mfma_f32_16x16x32_bf16 v[108:111], a[56:59], v[164:167], 0
buffer_load_dwordx4 a[164:167], v12, s[12:15], s56 offen offset:0 sc1
v_mfma_f32_16x16x32_bf16 v[112:115], a[60:63], v[160:163], 0
s_waitcnt lgkmcnt(6)
v_mfma_f32_16x16x32_bf16 v[116:119], a[60:63], v[164:167], 0
v_mfma_f32_16x16x32_bf16 v[120:123], a[64:67], v[160:163], 0
s_waitcnt lgkmcnt(4)
ds_read_b64_tr_b16 a[48:49], v54 offset:8192
ds_read_b64_tr_b16 a[50:51], v54 offset:12288
v_mfma_f32_16x16x32_bf16 v[124:127], a[64:67], v[164:167], 0
v_mfma_f32_16x16x32_bf16 v[128:131], a[68:71], v[160:163], 0
s_waitcnt lgkmcnt(4)
ds_read_b64_tr_b16 a[52:53], v55 offset:8192
ds_read_b64_tr_b16 a[54:55], v55 offset:12288
v_mfma_f32_16x16x32_bf16 v[132:135], a[68:71], v[164:167], 0
buffer_load_dwordx4 a[168:171], v12, s[12:15], s57 offen offset:0 sc1
v_mfma_f32_16x16x32_bf16 v[136:139], a[72:75], v[160:163], 0
s_waitcnt lgkmcnt(4)
ds_read_b64_tr_b16 a[56:57], v56 offset:8192
ds_read_b64_tr_b16 a[58:59], v56 offset:12288
v_mfma_f32_16x16x32_bf16 v[140:143], a[72:75], v[164:167], 0
v_mfma_f32_16x16x32_bf16 v[144:147], a[76:79], v[160:163], 0
ds_read_b64_tr_b16 a[60:61], v57 offset:8192
ds_read_b64_tr_b16 a[62:63], v57 offset:12288
v_mfma_f32_16x16x32_bf16 v[148:151], a[76:79], v[164:167], 0
buffer_load_dwordx4 a[172:175], v12, s[12:15], s56 offen offset:256 sc1
v_mfma_f32_16x16x32_bf16 v[152:155], a[84:87], v[168:171], v[152:155]
s_waitcnt lgkmcnt(6)
ds_read_b64_tr_b16 a[64:65], v58 offset:8192
ds_read_b64_tr_b16 a[66:67], v58 offset:12288
v_mfma_f32_16x16x32_bf16 v[156:159], a[84:87], v[172:175], v[156:159]
v_mfma_f32_16x16x32_bf16 v[88:91], a[48:51], v[168:171], v[88:91]
s_waitcnt lgkmcnt(6)
ds_read_b64_tr_b16 a[68:69], v59 offset:8192
ds_read_b64_tr_b16 a[70:71], v59 offset:12288
v_mfma_f32_16x16x32_bf16 v[92:95], a[48:51], v[172:175], v[92:95]
v_accvgpr_read_b32 v30, a206
v_accvgpr_read_b32 v31, a207
v_mfma_f32_16x16x32_bf16 v[96:99], a[52:55], v[168:171], v[96:99]
s_waitcnt lgkmcnt(6)
ds_read_b64_tr_b16 a[72:73], v60 offset:8192
ds_read_b64_tr_b16 a[74:75], v60 offset:12288
v_mfma_f32_16x16x32_bf16 v[100:103], a[52:55], v[172:175], v[100:103]
v_accvgpr_read_b32 v32, a208
v_accvgpr_read_b32 v33, a209
v_mfma_f32_16x16x32_bf16 v[104:107], a[56:59], v[168:171], v[104:107]
s_waitcnt lgkmcnt(6)
ds_read_b64_tr_b16 a[76:77], v61 offset:8192
ds_read_b64_tr_b16 a[78:79], v61 offset:12288
v_mfma_f32_16x16x32_bf16 v[108:111], a[56:59], v[172:175], v[108:111]
buffer_load_dwordx4 a[176:179], v12, s[12:15], s57 offen offset:256 sc1
v_accvgpr_read_b32 v34, a210
v_lshlrev_b32 v20, 16, v30
v_mfma_f32_16x16x32_bf16 v[112:115], a[60:63], v[168:171], v[112:115]
s_waitcnt lgkmcnt(6)
v_and_b32 v21, 0xffff0000, v30
v_lshlrev_b32 v22, 16, v31
v_mfma_f32_16x16x32_bf16 v[116:119], a[60:63], v[172:175], v[116:119]
s_waitcnt vmcnt(9)
v_and_b32 v23, 0xffff0000, v31
v_lshlrev_b32 v24, 16, v32
v_mfma_f32_16x16x32_bf16 v[120:123], a[64:67], v[168:171], v[120:123]
s_waitcnt lgkmcnt(4)
ds_read_b64_tr_b16 a[48:49], v38 offset:0
ds_read_b64_tr_b16 a[50:51], v38 offset:4096
v_mfma_f32_16x16x32_bf16 v[124:127], a[64:67], v[172:175], v[124:127]
v_and_b32 v25, 0xffff0000, v32
v_lshlrev_b32 v26, 16, v33
v_mfma_f32_16x16x32_bf16 v[128:131], a[68:71], v[168:171], v[128:131]
s_waitcnt lgkmcnt(4)
ds_read_b64_tr_b16 a[52:53], v39 offset:0
ds_read_b64_tr_b16 a[54:55], v39 offset:4096
buffer_load_dwordx4 a[180:183], v12, s[12:15], s56 offen offset:512 sc1
v_mfma_f32_16x16x32_bf16 v[132:135], a[68:71], v[172:175], v[132:135]
v_and_b32 v27, 0xffff0000, v33
v_lshlrev_b32 v28, 16, v34
v_mfma_f32_16x16x32_bf16 v[136:139], a[72:75], v[168:171], v[136:139]
s_waitcnt lgkmcnt(4)
ds_read_b64_tr_b16 a[56:57], v40 offset:0
ds_read_b64_tr_b16 a[58:59], v40 offset:4096
v_mfma_f32_16x16x32_bf16 v[140:143], a[72:75], v[172:175], v[140:143]
v_and_b32 v29, 0xffff0000, v34
s_mul_i32 s68, s67, 18432
v_max3_u32 v35, v176, v180, v184
v_max_u32 v35, v35, v188
v_cmp_eq_u32 vcc, -1, v35
v_mfma_f32_16x16x32_bf16 v[144:147], a[76:79], v[168:171], v[144:147]
s_add_u32 s69, s68, s88
ds_read_b64_tr_b16 a[60:61], v41 offset:0
ds_read_b64_tr_b16 a[62:63], v41 offset:4096
v_mfma_f32_16x16x32_bf16 v[148:151], a[76:79], v[172:175], v[148:151]
s_add_u32 s70, s68, s89
s_add_u32 s71, s68, s90
s_add_u32 s68, s68, s87
s_cbranch_vccnz L_kt_t2_2
L_kt_r2_2:
buffer_load_dwordx4 a[184:187], v12, s[12:15], s57 offen offset:512 sc1
v_mfma_f32_16x16x32_bf16 v[152:155], a[88:91], v[176:179], v[152:155]
s_waitcnt lgkmcnt(6)
ds_read_b64_tr_b16 a[64:65], v42 offset:0
ds_read_b64_tr_b16 a[66:67], v42 offset:4096
v_mfma_f32_16x16x32_bf16 v[156:159], a[88:91], v[180:183], v[156:159]
buffer_load_dwordx4 a[188:191], v12, s[12:15], s56 offen offset:768 sc1
v_mfma_f32_16x16x32_bf16 v[88:91], a[48:51], v[176:179], v[88:91]
s_waitcnt lgkmcnt(6)
ds_read_b64_tr_b16 a[68:69], v43 offset:0
ds_read_b64_tr_b16 a[70:71], v43 offset:4096
v_mfma_f32_16x16x32_bf16 v[92:95], a[48:51], v[180:183], v[92:95]
v_mfma_f32_16x16x32_bf16 v[96:99], a[52:55], v[176:179], v[96:99]
s_waitcnt lgkmcnt(6)
ds_read_b64_tr_b16 a[72:73], v44 offset:0
ds_read_b64_tr_b16 a[74:75], v44 offset:4096
v_mfma_f32_16x16x32_bf16 v[100:103], a[52:55], v[180:183], v[100:103]
v_mfma_f32_16x16x32_bf16 v[104:107], a[56:59], v[176:179], v[104:107]
s_waitcnt lgkmcnt(6)
ds_read_b64_tr_b16 a[76:77], v45 offset:0
ds_read_b64_tr_b16 a[78:79], v45 offset:4096
v_mfma_f32_16x16x32_bf16 v[108:111], a[56:59], v[180:183], v[108:111]
buffer_load_dwordx4 a[192:195], v12, s[12:15], s57 offen offset:768 sc1
v_mfma_f32_16x16x32_bf16 v[112:115], a[60:63], v[176:179], v[112:115]
s_waitcnt lgkmcnt(6)
v_mfma_f32_16x16x32_bf16 v[116:119], a[60:63], v[180:183], v[116:119]
v_mfma_f32_16x16x32_bf16 v[120:123], a[64:67], v[176:179], v[120:123]
s_waitcnt lgkmcnt(4)
ds_read_b64_tr_b16 a[48:49], v38 offset:8192
ds_read_b64_tr_b16 a[50:51], v38 offset:12288
v_mfma_f32_16x16x32_bf16 v[124:127], a[64:67], v[180:183], v[124:127]
buffer_load_dwordx4 v[240:243], v1, s[12:15], s37 offen offset:2048 sc1
v_mfma_f32_16x16x32_bf16 v[128:131], a[68:71], v[176:179], v[128:131]
s_waitcnt lgkmcnt(4)
ds_read_b64_tr_b16 a[52:53], v39 offset:8192
ds_read_b64_tr_b16 a[54:55], v39 offset:12288
v_mfma_f32_16x16x32_bf16 v[132:135], a[68:71], v[180:183], v[132:135]
v_mfma_f32_16x16x32_bf16 v[136:139], a[72:75], v[176:179], v[136:139]
s_waitcnt lgkmcnt(4)
ds_read_b64_tr_b16 a[56:57], v40 offset:8192
ds_read_b64_tr_b16 a[58:59], v40 offset:12288
v_mfma_f32_16x16x32_bf16 v[140:143], a[72:75], v[180:183], v[140:143]
v_mfma_f32_16x16x32_bf16 v[144:147], a[76:79], v[176:179], v[144:147]
ds_read_b64_tr_b16 a[60:61], v41 offset:8192
ds_read_b64_tr_b16 a[62:63], v41 offset:12288
v_mfma_f32_16x16x32_bf16 v[148:151], a[76:79], v[180:183], v[148:151]
s_barrier
v_mfma_f32_16x16x32_bf16 v[152:155], a[92:95], v[184:187], v[152:155]
s_waitcnt lgkmcnt(6)
ds_read_b64_tr_b16 a[64:65], v42 offset:8192
ds_read_b64_tr_b16 a[66:67], v42 offset:12288
v_mfma_f32_16x16x32_bf16 v[156:159], a[92:95], v[188:191], v[156:159]
buffer_load_dwordx4 v[244:247], v1, s[12:15], s38 offen offset:2048 sc1
v_mfma_f32_16x16x32_bf16 v[88:91], a[48:51], v[184:187], v[88:91]
s_waitcnt lgkmcnt(6)
ds_read_b64_tr_b16 a[68:69], v43 offset:8192
ds_read_b64_tr_b16 a[70:71], v43 offset:12288
v_mfma_f32_16x16x32_bf16 v[92:95], a[48:51], v[188:191], v[92:95]
buffer_load_dwordx4 v[248:251], v1, s[12:15], s37 offen offset:3072 sc1
v_mfma_f32_16x16x32_bf16 v[96:99], a[52:55], v[184:187], v[96:99]
s_waitcnt lgkmcnt(6)
ds_read_b64_tr_b16 a[72:73], v44 offset:8192
ds_read_b64_tr_b16 a[74:75], v44 offset:12288
v_mfma_f32_16x16x32_bf16 v[100:103], a[52:55], v[188:191], v[100:103]
ds_read_b64_tr_b16 a[128:129], v62 offset:4096
ds_read_b64_tr_b16 a[130:131], v62 offset:4608
v_mfma_f32_16x16x32_bf16 v[104:107], a[56:59], v[184:187], v[104:107]
s_waitcnt lgkmcnt(8)
ds_read_b64_tr_b16 a[76:77], v45 offset:8192
ds_read_b64_tr_b16 a[78:79], v45 offset:12288
s_waitcnt vmcnt(3)
v_mfma_f32_16x16x32_bf16 v[84:87], a[160:163], a[196:199], 0
v_mfma_f32_16x16x32_bf16 v[76:79], a[152:155], a[164:167], 0
v_mfma_f32_16x16x32_bf16 v[80:83], a[152:155], a[180:183], 0
v_mfma_f32_16x16x32_bf16 v[76:79], a[152:155], a[168:171], v[76:79]
v_mfma_f32_16x16x32_bf16 v[80:83], a[152:155], a[184:187], v[80:83]
v_mfma_f32_16x16x32_bf16 v[76:79], a[156:159], a[172:175], v[76:79]
v_mfma_f32_16x16x32_bf16 v[80:83], a[156:159], a[188:191], v[80:83]
v_mfma_f32_16x16x32_bf16 v[76:79], a[156:159], a[176:179], v[76:79]
ds_read_b64_tr_b16 a[132:133], v62 offset:5120
ds_read_b64_tr_b16 a[134:135], v62 offset:5632
v_mfma_f32_16x16x32_bf16 v[80:83], a[156:159], a[192:195], v[80:83]
s_nop 4
v_add_f32 v64, v84, v76
s_nop 1
v_add_f32 v64, v64, v80
v_cmp_u_f32 s[62:63], v64, v64
s_nop 0
s_cmp_lg_u64 s[62:63], 0
s_cbranch_scc1 L_kt_rt01
L_kt_rr01:
v_add_f32_dpp v84, v84, v84 row_ror:8 row_mask:0xf bank_mask:0xf
v_add_f32_dpp v85, v85, v85 row_ror:8 row_mask:0xf bank_mask:0xf
v_cvt_pk_bf16_f32 v30, v76, v77
v_cvt_pk_bf16_f32 v31, v78, v79
v_cvt_pk_bf16_f32 v32, v80, v81
v_cvt_pk_bf16_f32 v33, v82, v83
v_cvt_pk_bf16_f32 v34, v84, v85
v_lshlrev_b32 v76, 16, v30
v_and_b32 v77, 0xffff0000, v30
v_lshlrev_b32 v78, 16, v31
v_and_b32 v79, 0xffff0000, v31
v_lshlrev_b32 v80, 16, v32
v_and_b32 v81, 0xffff0000, v32
v_lshlrev_b32 v82, 16, v33
v_and_b32 v83, 0xffff0000, v33
v_lshlrev_b32 v84, 16, v34
v_and_b32 v85, 0xffff0000, v34
v_add_f32 v76, v76, v20
v_add_f32 v77, v77, v21
v_add_f32 v78, v78, v22
v_add_f32 v79, v79, v23
v_add_f32 v80, v80, v24
v_add_f32 v81, v81, v25
v_add_f32 v82, v82, v26
v_add_f32 v83, v83, v27
v_add_f32 v84, v84, v28
v_add_f32 v85, v85, v29
v_cvt_pk_bf16_f32 v30, v76, v77
v_cvt_pk_bf16_f32 v31, v78, v79
v_cvt_pk_bf16_f32 v32, v80, v81
v_cvt_pk_bf16_f32 v33, v82, v83
v_cvt_pk_bf16_f32 v34, v84, v85
v_lshlrev_b32 v76, 16, v30
v_and_b32 v77, 0xffff0000, v30
v_lshlrev_b32 v78, 16, v31
v_and_b32 v79, 0xffff0000, v31
v_lshlrev_b32 v80, 16, v32
v_and_b32 v81, 0xffff0000, v32
v_lshlrev_b32 v82, 16, v33
v_and_b32 v83, 0xffff0000, v33
v_lshlrev_b32 v84, 16, v34
v_mfma_f32_16x16x32_bf16 v[108:111], a[56:59], v[188:191], v[108:111]
v_and_b32 v85, 0xffff0000, v34
v_cndmask_b32 v64, v84, v85, s[64:65]
v_add_f32 v66, v76, v77
v_mfma_f32_16x16x32_bf16 v[112:115], a[60:63], v[184:187], v[112:115]
s_waitcnt lgkmcnt(10)
v_add_f32 v67, v78, v79
v_add_f32 v68, v80, v81
v_add_f32 v66, v66, v82
v_mfma_f32_16x16x32_bf16 v[116:119], a[60:63], v[188:191], v[116:119]
v_add_f32 v67, v67, v83
v_add_f32 v68, v68, v64
v_add_f32 v66, v66, v67
v_mfma_f32_16x16x32_bf16 v[120:123], a[64:67], v[184:187], v[120:123]
s_waitcnt lgkmcnt(8)
ds_read_b64_tr_b16 a[48:49], v46 offset:0
ds_read_b64_tr_b16 a[50:51], v46 offset:4096
v_add_f32 v66, v66, v68
v_accvgpr_write_b32 a206, v30
v_accvgpr_write_b32 a207, v31
v_mfma_f32_16x16x32_bf16 v[124:127], a[64:67], v[188:191], v[124:127]
buffer_load_dwordx4 v[252:255], v1, s[12:15], s38 offen offset:3072 sc1
v_add_f32_dpp v66, v66, v66 row_ror:4 row_mask:0xf bank_mask:0xf
v_accvgpr_write_b32 a208, v32
v_accvgpr_write_b32 a209, v33
v_mfma_f32_16x16x32_bf16 v[128:131], a[68:71], v[184:187], v[128:131]
s_waitcnt lgkmcnt(8)
ds_read_b64_tr_b16 a[52:53], v47 offset:0
ds_read_b64_tr_b16 a[54:55], v47 offset:4096
v_add_f32_dpp v66, v66, v66 row_ror:8 row_mask:0xf bank_mask:0xf
v_mov_b32 v68, v66
v_accvgpr_write_b32 a210, v34
v_mfma_f32_16x16x32_bf16 v[132:135], a[68:71], v[188:191], v[132:135]
s_add_u32 s37, s37, 4096
v_permlane16_swap_b32 v66, v68
v_add_f32 v66, v66, v68
v_mov_b32 v68, v66
v_mfma_f32_16x16x32_bf16 v[136:139], a[72:75], v[184:187], v[136:139]
s_waitcnt lgkmcnt(6)
ds_read_b64_tr_b16 a[56:57], v48 offset:0
ds_read_b64_tr_b16 a[58:59], v48 offset:4096
v_permlane32_swap_b32 v66, v68
v_add_f32 v66, v66, v68
v_mul_f32 v66, 0.006944444444444444, v66
v_mfma_f32_16x16x32_bf16 v[140:143], a[72:75], v[188:191], v[140:143]
v_sub_f32 v20, v76, v66
v_sub_f32 v21, v77, v66
v_sub_f32 v22, v78, v66
v_max3_u32 v35, v224, v228, v232
v_max_u32 v35, v35, v236
v_cmp_eq_u32 vcc, -1, v35
v_mfma_f32_16x16x32_bf16 v[144:147], a[76:79], v[184:187], v[144:147]
ds_read_b64_tr_b16 a[60:61], v49 offset:0
ds_read_b64_tr_b16 a[62:63], v49 offset:4096
buffer_load_dwordx4 a[0:3], v1, s[12:15], s37 offen offset:0 sc1
v_sub_f32 v23, v79, v66
v_sub_f32 v24, v80, v66
v_sub_f32 v25, v81, v66
v_mfma_f32_16x16x32_bf16 v[148:151], a[76:79], v[188:191], v[148:151]
s_cbranch_vccnz L_kt_t2_4
L_kt_r2_4:
v_sub_f32 v26, v82, v66
v_sub_f32 v27, v83, v66
v_sub_f32 v28, v64, v66
v_mfma_f32_16x16x32_bf16 v[152:155], a[96:99], v[224:227], v[152:155]
s_waitcnt lgkmcnt(6)
ds_read_b64_tr_b16 a[64:65], v50 offset:0
ds_read_b64_tr_b16 a[66:67], v50 offset:4096
v_mul_f32 v67, v20, v20
v_mul_f32 v68, v21, v21
v_fmac_f32 v67, v22, v22
v_mfma_f32_16x16x32_bf16 v[156:159], a[96:99], v[228:231], v[156:159]
s_add_u32 s38, s38, 4096
v_fmac_f32 v68, v23, v23
v_fmac_f32 v67, v24, v24
v_fmac_f32 v68, v25, v25
v_mfma_f32_16x16x32_bf16 v[88:91], a[48:51], v[224:227], v[88:91]
s_waitcnt lgkmcnt(6)
ds_read_b64_tr_b16 a[68:69], v51 offset:0
ds_read_b64_tr_b16 a[70:71], v51 offset:4096
v_fmac_f32 v67, v26, v26
v_fmac_f32 v68, v27, v27
v_fmac_f32 v67, v28, v28
v_mfma_f32_16x16x32_bf16 v[92:95], a[48:51], v[228:231], v[92:95]
buffer_load_dwordx4 a[4:7], v1, s[12:15], s38 offen offset:0 sc1
v_add_f32 v67, v67, v68
s_nop 1
v_add_f32_dpp v67, v67, v67 row_ror:4 row_mask:0xf bank_mask:0xf
v_mfma_f32_16x16x32_bf16 v[96:99], a[52:55], v[224:227], v[96:99]
s_waitcnt lgkmcnt(6)
ds_read_b64_tr_b16 a[72:73], v52 offset:0
ds_read_b64_tr_b16 a[74:75], v52 offset:4096
v_add_f32_dpp v67, v67, v67 row_ror:8 row_mask:0xf bank_mask:0xf
v_mov_b32 v68, v67
s_nop 1
v_permlane16_swap_b32 v67, v68
v_mfma_f32_16x16x32_bf16 v[100:103], a[52:55], v[228:231], v[100:103]
v_add_f32 v67, v67, v68
v_mov_b32 v68, v67
s_nop 1
v_permlane32_swap_b32 v67, v68
v_mfma_f32_16x16x32_bf16 v[104:107], a[56:59], v[224:227], v[104:107]
s_waitcnt lgkmcnt(6)
ds_read_b64_tr_b16 a[76:77], v53 offset:0
ds_read_b64_tr_b16 a[78:79], v53 offset:4096
v_add_f32 v67, v67, v68
ds_write_b64 v18, v[66:67] offset:128
v_mfma_f32_16x16x32_bf16 v[108:111], a[56:59], v[228:231], v[108:111]
s_waitcnt lgkmcnt(0)
s_barrier
ds_read_b128 v[20:23], v19 offset:128
v_mfma_f32_16x16x32_bf16 v[112:115], a[60:63], v[224:227], v[112:115]
ds_read_b128 v[24:27], v19 offset:144
buffer_load_dwordx4 a[8:11], v1, s[12:15], s37 offen offset:1024 sc1
s_waitcnt lgkmcnt(0)
v_add_f32 v66, v20, v22
v_mfma_f32_16x16x32_bf16 v[116:119], a[60:63], v[228:231], v[116:119]
v_add_f32 v68, v24, v26
v_add_f32 v67, v21, v23
v_add_f32 v66, v66, v68
v_mfma_f32_16x16x32_bf16 v[120:123], a[64:67], v[224:227], v[120:123]
ds_read_b64_tr_b16 a[48:49], v46 offset:8192
ds_read_b64_tr_b16 a[50:51], v46 offset:12288
v_add_f32 v68, v25, v27
v_mul_f32 v66, 0.25, v66
v_add_f32 v67, v67, v68
v_mfma_f32_16x16x32_bf16 v[124:127], a[64:67], v[228:231], v[124:127]
v_sub_f32 v20, v20, v66
v_sub_f32 v22, v22, v66
v_sub_f32 v24, v24, v66
v_mfma_f32_16x16x32_bf16 v[128:131], a[68:71], v[224:227], v[128:131]
ds_read_b64_tr_b16 a[52:53], v47 offset:8192
ds_read_b64_tr_b16 a[54:55], v47 offset:12288
v_sub_f32 v26, v26, v66
v_mul_f32 v68, v20, v20
v_cvt_pk_bf16_f32 v69, v66, v66
v_mfma_f32_16x16x32_bf16 v[132:135], a[68:71], v[228:231], v[132:135]
buffer_load_dwordx4 a[12:15], v1, s[12:15], s38 offen offset:1024 sc1
v_fmac_f32 v68, v22, v22
v_fmac_f32 v68, v24, v24
v_fmac_f32 v68, v26, v26
v_mfma_f32_16x16x32_bf16 v[136:139], a[72:75], v[224:227], v[136:139]
ds_read_b64_tr_b16 a[56:57], v48 offset:8192
ds_read_b64_tr_b16 a[58:59], v48 offset:12288
v_lshlrev_b32 v69, 16, v69
v_mul_f32 v67, 0.001736111111111111, v67
v_fmac_f32 v67, 0.25, v68
v_mfma_f32_16x16x32_bf16 v[140:143], a[72:75], v[228:231], v[140:143]
v_cvt_pk_bf16_f32 v67, v67, v67
v_sub_f32 v76, v76, v69
v_sub_f32 v77, v77, v69
v_mfma_f32_16x16x32_bf16 v[144:147], a[76:79], v[224:227], v[144:147]
ds_read_b64_tr_b16 a[60:61], v49 offset:8192
ds_read_b64_tr_b16 a[62:63], v49 offset:12288
v_lshlrev_b32 v67, 16, v67
v_sub_f32 v78, v78, v69
v_sub_f32 v79, v79, v69
v_mfma_f32_16x16x32_bf16 v[148:151], a[76:79], v[228:231], v[148:151]
v_add_f32 v67, 0x3727c5ac, v67
v_sub_f32 v80, v80, v69
v_sub_f32 v81, v81, v69
v_mfma_f32_16x16x32_bf16 v[152:155], a[100:103], v[232:235], v[152:155]
s_waitcnt lgkmcnt(6)
ds_read_b64_tr_b16 a[64:65], v50 offset:8192
ds_read_b64_tr_b16 a[66:67], v50 offset:12288
buffer_load_dwordx4 a[16:19], v1, s[12:15], s37 offen offset:2048 sc1
v_cvt_pk_bf16_f32 v67, v67, v67
v_sub_f32 v82, v82, v69
v_sub_f32 v83, v83, v69
v_mfma_f32_16x16x32_bf16 v[156:159], a[100:103], v[236:239], v[156:159]
v_lshlrev_b32 v67, 16, v67
v_sub_f32 v84, v84, v69
v_sub_f32 v85, v85, v69
v_mfma_f32_16x16x32_bf16 v[88:91], a[48:51], v[232:235], v[88:91]
s_waitcnt lgkmcnt(6)
ds_read_b64_tr_b16 a[68:69], v51 offset:8192
ds_read_b64_tr_b16 a[70:71], v51 offset:12288
v_sqrt_f32 v67, v67
v_mfma_f32_16x16x32_bf16 v[92:95], a[48:51], v[236:239], v[92:95]
ds_read_b64_tr_b16 a[136:137], v62 offset:6144
v_cvt_pk_bf16_f32 v30, v76, v77
v_cvt_pk_bf16_f32 v31, v78, v79
v_cvt_pk_bf16_f32 v67, v67, v67
v_mfma_f32_16x16x32_bf16 v[96:99], a[52:55], v[232:235], v[96:99]
s_waitcnt lgkmcnt(7)
ds_read_b64_tr_b16 a[72:73], v52 offset:8192
ds_read_b64_tr_b16 a[74:75], v52 offset:12288
ds_read_b64_tr_b16 a[138:139], v62 offset:6656
ds_read_b64_tr_b16 a[140:141], v62 offset:7168
ds_read_b64_tr_b16 a[142:143], v62 offset:7680
v_cvt_pk_bf16_f32 v32, v80, v81
v_cvt_pk_bf16_f32 v33, v82, v83
v_lshlrev_b32 v67, 16, v67
v_mfma_f32_16x16x32_bf16 v[100:103], a[52:55], v[236:239], v[100:103]
buffer_load_dwordx4 a[20:23], v1, s[12:15], s38 offen offset:2048 sc1
v_cvt_pk_bf16_f32 v34, v84, v85
v_lshlrev_b32 v76, 16, v30
v_mfma_f32_16x16x32_bf16 v[104:107], a[56:59], v[232:235], v[104:107]
s_waitcnt lgkmcnt(10)
ds_read_b64_tr_b16 a[76:77], v53 offset:8192
ds_read_b64_tr_b16 a[78:79], v53 offset:12288
v_rcp_f32 v67, v67
v_and_b32 v77, 0xffff0000, v30
v_lshlrev_b32 v78, 16, v31
v_mfma_f32_16x16x32_bf16 v[108:111], a[56:59], v[236:239], v[108:111]
v_and_b32 v79, 0xffff0000, v31
v_lshlrev_b32 v80, 16, v32
v_and_b32 v81, 0xffff0000, v32
v_mfma_f32_16x16x32_bf16 v[112:115], a[60:63], v[232:235], v[112:115]
s_waitcnt lgkmcnt(10)
v_lshlrev_b32 v82, 16, v33
v_and_b32 v83, 0xffff0000, v33
v_lshlrev_b32 v84, 16, v34
v_mfma_f32_16x16x32_bf16 v[116:119], a[60:63], v[236:239], v[116:119]
s_waitcnt vmcnt(6)
v_and_b32 v85, 0xffff0000, v34
v_mul_f32 v84, v84, v67
v_mul_f32 v85, v85, v67
v_mfma_f32_16x16x32_bf16 v[120:123], a[64:67], v[232:235], v[120:123]
s_waitcnt lgkmcnt(8)
ds_read_b64_tr_b16 a[48:49], v38 offset:16384
ds_read_b64_tr_b16 a[50:51], v38 offset:20480
buffer_load_dwordx4 a[24:27], v1, s[12:15], s37 offen offset:3072 sc1
v_mul_f32 v76, v76, v67
v_mul_f32 v77, v77, v67
v_mul_f32 v78, v78, v67
v_mfma_f32_16x16x32_bf16 v[124:127], a[64:67], v[236:239], v[124:127]
v_mul_f32 v79, v79, v67
v_mul_f32 v80, v80, v67
v_mul_f32 v81, v81, v67
v_mfma_f32_16x16x32_bf16 v[128:131], a[68:71], v[232:235], v[128:131]
s_waitcnt lgkmcnt(7)
ds_read_b64_tr_b16 a[52:53], v39 offset:16384
ds_read_b64_tr_b16 a[54:55], v39 offset:20480
v_mul_f32 v82, v82, v67
v_mul_f32 v83, v83, v67
v_cvt_pk_bf16_f32 v20, v84, v85
v_mfma_f32_16x16x32_bf16 v[132:135], a[68:71], v[236:239], v[132:135]
v_cvt_pk_bf16_f32 v21, v84, v85
v_cvt_pk_bf16_f32 v30, v76, v77
v_cvt_pk_bf16_f32 v32, v80, v81
v_mfma_f32_16x16x32_bf16 v[136:139], a[72:75], v[232:235], v[136:139]
s_waitcnt lgkmcnt(4)
ds_read_b64_tr_b16 a[56:57], v40 offset:16384
ds_read_b64_tr_b16 a[58:59], v40 offset:20480
v_permlane16_swap_b32 v20, v21
v_mov_b32 v22, v20
v_mov_b32 v23, v21
v_mfma_f32_16x16x32_bf16 v[140:143], a[72:75], v[236:239], v[140:143]
buffer_load_dwordx4 a[28:31], v1, s[12:15], s38 offen offset:3072 sc1
v_cvt_pk_bf16_f32 v31, v78, v79
v_cvt_pk_bf16_f32 v33, v82, v83
v_permlane32_swap_b32 v20, v22
v_max3_u32 v35, v240, v244, v248
v_max_u32 v35, v35, v252
v_cmp_eq_u32 vcc, -1, v35
v_mfma_f32_16x16x32_bf16 v[144:147], a[76:79], v[232:235], v[144:147]
s_add_u32 s37, s37, 4096
ds_read_b64_tr_b16 a[60:61], v41 offset:16384
ds_read_b64_tr_b16 a[62:63], v41 offset:20480
v_permlane32_swap_b32 v21, v23
v_permlane16_swap_b32 v30, v32
v_min_u32 v20, -2, v20
v_mfma_f32_16x16x32_bf16 v[148:151], a[76:79], v[236:239], v[148:151]
s_barrier
v_permlane16_swap_b32 v31, v33
v_min_u32 v30, -2, v30
s_cbranch_vccnz L_kt_t2_6
L_kt_r2_6:
v_mfma_f32_16x16x32_bf16 v[152:155], a[104:107], v[240:243], v[152:155]
s_waitcnt lgkmcnt(6)
ds_read_b64_tr_b16 a[64:65], v42 offset:16384
ds_read_b64_tr_b16 a[66:67], v42 offset:20480
buffer_store_dwordx4 v[20:23], v17, s[12:15], s71 offen sc1
buffer_store_dwordx4 v[30:33], v16, s[12:15], s70 offen sc1
v_mfma_f32_16x16x32_bf16 v[156:159], a[104:107], v[244:247], v[156:159]
buffer_load_dwordx4 a[32:35], v1, s[12:15], s37 offen offset:0 sc1
v_mfma_f32_16x16x32_bf16 v[88:91], a[48:51], v[240:243], v[88:91]
s_waitcnt lgkmcnt(6)
ds_read_b64_tr_b16 a[68:69], v43 offset:16384
ds_read_b64_tr_b16 a[70:71], v43 offset:20480
v_mfma_f32_16x16x32_bf16 v[92:95], a[48:51], v[244:247], v[92:95]
s_add_u32 s38, s38, 4096
ds_read_b64_tr_b16 a[144:145], v62 offset:8192
ds_read_b64_tr_b16 a[146:147], v62 offset:8704
v_mfma_f32_16x16x32_bf16 v[96:99], a[52:55], v[240:243], v[96:99]
s_waitcnt lgkmcnt(8)
ds_read_b64_tr_b16 a[72:73], v44 offset:16384
ds_read_b64_tr_b16 a[74:75], v44 offset:20480
v_mfma_f32_16x16x32_bf16 v[100:103], a[52:55], v[244:247], v[100:103]
buffer_load_dwordx4 a[36:39], v1, s[12:15], s38 offen offset:0 sc1
v_mfma_f32_16x16x32_bf16 v[104:107], a[56:59], v[240:243], v[104:107]
s_waitcnt lgkmcnt(8)
ds_read_b64_tr_b16 a[76:77], v45 offset:16384
ds_read_b64_tr_b16 a[78:79], v45 offset:20480
v_mfma_f32_16x16x32_bf16 v[108:111], a[56:59], v[244:247], v[108:111]
ds_read_b64_tr_b16 a[148:149], v62 offset:9216
ds_read_b64_tr_b16 a[150:151], v62 offset:9728
v_mfma_f32_16x16x32_bf16 v[112:115], a[60:63], v[240:243], v[112:115]
s_waitcnt lgkmcnt(10)
v_mfma_f32_16x16x32_bf16 v[116:119], a[60:63], v[244:247], v[116:119]
buffer_load_dwordx4 a[40:43], v1, s[12:15], s37 offen offset:1024 sc1
v_mfma_f32_16x16x32_bf16 v[120:123], a[64:67], v[240:243], v[120:123]
s_waitcnt lgkmcnt(8)
ds_read_b64_tr_b16 a[48:49], v38 offset:24576
ds_read_b64_tr_b16 a[50:51], v38 offset:28672
v_mfma_f32_16x16x32_bf16 v[124:127], a[64:67], v[244:247], v[124:127]
v_mfma_f32_16x16x32_bf16 v[128:131], a[68:71], v[240:243], v[128:131]
s_waitcnt lgkmcnt(6)
ds_read_b64_tr_b16 a[52:53], v39 offset:24576
ds_read_b64_tr_b16 a[54:55], v39 offset:28672
v_mfma_f32_16x16x32_bf16 v[132:135], a[68:71], v[244:247], v[132:135]
v_mfma_f32_16x16x32_bf16 v[136:139], a[72:75], v[240:243], v[136:139]
s_waitcnt lgkmcnt(6)
ds_read_b64_tr_b16 a[56:57], v40 offset:24576
ds_read_b64_tr_b16 a[58:59], v40 offset:28672
v_mfma_f32_16x16x32_bf16 v[140:143], a[72:75], v[244:247], v[140:143]
buffer_load_dwordx4 a[44:47], v1, s[12:15], s38 offen offset:1024 sc1
v_mfma_f32_16x16x32_bf16 v[144:147], a[76:79], v[240:243], v[144:147]
ds_read_b64_tr_b16 a[60:61], v41 offset:24576
ds_read_b64_tr_b16 a[62:63], v41 offset:28672
v_mfma_f32_16x16x32_bf16 v[148:151], a[76:79], v[244:247], v[148:151]
s_add_u32 s52, s43, 958464
s_add_u32 m0, s49, 57344
v_mfma_f32_16x16x32_bf16 v[152:155], a[108:111], v[248:251], v[152:155]
s_waitcnt lgkmcnt(6)
ds_read_b64_tr_b16 a[64:65], v42 offset:24576
ds_read_b64_tr_b16 a[66:67], v42 offset:28672
v_mfma_f32_16x16x32_bf16 v[156:159], a[108:111], v[252:255], v[156:159]
buffer_load_dwordx4 v4, s[8:11], s52 offen lds
v_mfma_f32_16x16x32_bf16 v[88:91], a[48:51], v[248:251], v[88:91]
s_waitcnt lgkmcnt(6)
ds_read_b64_tr_b16 a[68:69], v43 offset:24576
ds_read_b64_tr_b16 a[70:71], v43 offset:28672
v_mfma_f32_16x16x32_bf16 v[92:95], a[48:51], v[252:255], v[92:95]
v_mfma_f32_16x16x32_bf16 v[96:99], a[52:55], v[248:251], v[96:99]
s_waitcnt lgkmcnt(6)
ds_read_b64_tr_b16 a[72:73], v44 offset:24576
ds_read_b64_tr_b16 a[74:75], v44 offset:28672
v_mfma_f32_16x16x32_bf16 v[100:103], a[52:55], v[252:255], v[100:103]
s_add_u32 s52, s43, 2138112
s_add_u32 m0, s49, 58368
s_waitcnt vmcnt(11)
v_mfma_f32_16x16x32_bf16 v[104:107], a[56:59], v[248:251], v[104:107]
s_waitcnt lgkmcnt(6)
ds_read_b64_tr_b16 a[76:77], v45 offset:24576
ds_read_b64_tr_b16 a[78:79], v45 offset:28672
v_mfma_f32_16x16x32_bf16 v[108:111], a[56:59], v[252:255], v[108:111]
v_accvgpr_read_b32 v35, a0
v_accvgpr_read_b32 v36, a4
v_mfma_f32_16x16x32_bf16 v[112:115], a[60:63], v[248:251], v[112:115]
s_waitcnt lgkmcnt(6)
v_accvgpr_read_b32 v37, a8
v_accvgpr_read_b32 v74, a12
v_mfma_f32_16x16x32_bf16 v[116:119], a[60:63], v[252:255], v[116:119]
buffer_load_dwordx4 v5, s[8:11], s52 offen lds
v_mfma_f32_16x16x32_bf16 v[120:123], a[64:67], v[248:251], v[120:123]
s_waitcnt lgkmcnt(4)
ds_read_b64_tr_b16 a[48:49], v46 offset:16384
ds_read_b64_tr_b16 a[50:51], v46 offset:20480
v_mfma_f32_16x16x32_bf16 v[124:127], a[64:67], v[252:255], v[124:127]
s_add_u32 s52, s43, 995328
s_add_u32 m0, s49, 114688
v_max3_u32 v35, v35, v36, v37
v_mfma_f32_16x16x32_bf16 v[128:131], a[68:71], v[248:251], v[128:131]
s_waitcnt lgkmcnt(4)
ds_read_b64_tr_b16 a[52:53], v47 offset:16384
ds_read_b64_tr_b16 a[54:55], v47 offset:20480
v_mfma_f32_16x16x32_bf16 v[132:135], a[68:71], v[252:255], v[132:135]
v_max_u32 v35, v35, v74
v_cmp_eq_u32 vcc, -1, v35
v_mfma_f32_16x16x32_bf16 v[136:139], a[72:75], v[248:251], v[136:139]
s_waitcnt lgkmcnt(4)
ds_read_b64_tr_b16 a[56:57], v48 offset:16384
ds_read_b64_tr_b16 a[58:59], v48 offset:20480
buffer_load_dwordx4 v4, s[8:11], s52 offen lds
v_mfma_f32_16x16x32_bf16 v[140:143], a[72:75], v[252:255], v[140:143]
s_add_u32 s52, s43, 2174976
s_cbranch_vccnz L_kt_t2_8
L_kt_r2_8:
s_add_u32 m0, s49, 115712
v_mfma_f32_16x16x32_bf16 v[144:147], a[76:79], v[248:251], v[144:147]
ds_read_b64_tr_b16 a[60:61], v49 offset:16384
ds_read_b64_tr_b16 a[62:63], v49 offset:20480
v_mfma_f32_16x16x32_bf16 v[148:151], a[76:79], v[252:255], v[148:151]
buffer_load_dwordx4 v5, s[8:11], s52 offen lds
v_mfma_f32_16x16x32_bf16 v[152:155], a[112:115], a[0:3], v[152:155]
s_waitcnt lgkmcnt(6)
ds_read_b64_tr_b16 a[64:65], v50 offset:16384
ds_read_b64_tr_b16 a[66:67], v50 offset:20480
v_mfma_f32_16x16x32_bf16 v[156:159], a[112:115], a[4:7], v[156:159]
v_mfma_f32_16x16x32_bf16 v[88:91], a[48:51], a[0:3], v[88:91]
s_waitcnt lgkmcnt(6)
ds_read_b64_tr_b16 a[68:69], v51 offset:16384
ds_read_b64_tr_b16 a[70:71], v51 offset:20480
v_mfma_f32_16x16x32_bf16 v[92:95], a[48:51], a[4:7], v[92:95]
buffer_load_dwordx4 a[216:219], v1, s[12:15], s37 offen offset:2048 sc1
v_mfma_f32_16x16x32_bf16 v[96:99], a[52:55], a[0:3], v[96:99]
s_waitcnt lgkmcnt(6)
ds_read_b64_tr_b16 a[72:73], v52 offset:16384
ds_read_b64_tr_b16 a[74:75], v52 offset:20480
v_mfma_f32_16x16x32_bf16 v[100:103], a[52:55], a[4:7], v[100:103]
v_mfma_f32_16x16x32_bf16 v[104:107], a[56:59], a[0:3], v[104:107]
s_waitcnt lgkmcnt(6)
ds_read_b64_tr_b16 a[76:77], v53 offset:16384
ds_read_b64_tr_b16 a[78:79], v53 offset:20480
v_mfma_f32_16x16x32_bf16 v[108:111], a[56:59], a[4:7], v[108:111]
v_mfma_f32_16x16x32_bf16 v[112:115], a[60:63], a[0:3], v[112:115]
s_waitcnt lgkmcnt(6)
v_mfma_f32_16x16x32_bf16 v[116:119], a[60:63], a[4:7], v[116:119]
buffer_load_dwordx4 a[220:223], v1, s[12:15], s38 offen offset:2048 sc1
v_mfma_f32_16x16x32_bf16 v[120:123], a[64:67], a[0:3], v[120:123]
s_waitcnt lgkmcnt(4)
ds_read_b64_tr_b16 a[48:49], v46 offset:24576
ds_read_b64_tr_b16 a[50:51], v46 offset:28672
v_mfma_f32_16x16x32_bf16 v[124:127], a[64:67], a[4:7], v[124:127]
v_mfma_f32_16x16x32_bf16 v[128:131], a[68:71], a[0:3], v[128:131]
s_waitcnt lgkmcnt(4)
ds_read_b64_tr_b16 a[52:53], v47 offset:24576
ds_read_b64_tr_b16 a[54:55], v47 offset:28672
v_mfma_f32_16x16x32_bf16 v[132:135], a[68:71], a[4:7], v[132:135]
buffer_load_dwordx4 a[224:227], v1, s[12:15], s37 offen offset:3072 sc1
v_mfma_f32_16x16x32_bf16 v[136:139], a[72:75], a[0:3], v[136:139]
s_waitcnt lgkmcnt(4)
ds_read_b64_tr_b16 a[56:57], v48 offset:24576
ds_read_b64_tr_b16 a[58:59], v48 offset:28672
v_mfma_f32_16x16x32_bf16 v[140:143], a[72:75], a[4:7], v[140:143]
v_mfma_f32_16x16x32_bf16 v[144:147], a[76:79], a[0:3], v[144:147]
ds_read_b64_tr_b16 a[60:61], v49 offset:24576
ds_read_b64_tr_b16 a[62:63], v49 offset:28672
v_mfma_f32_16x16x32_bf16 v[148:151], a[76:79], a[4:7], v[148:151]
s_barrier
v_mfma_f32_16x16x32_bf16 v[152:155], a[116:119], a[8:11], v[152:155]
s_waitcnt lgkmcnt(6)
ds_read_b64_tr_b16 a[64:65], v50 offset:24576
ds_read_b64_tr_b16 a[66:67], v50 offset:28672
v_mfma_f32_16x16x32_bf16 v[156:159], a[116:119], a[12:15], v[156:159]
buffer_load_dwordx4 a[228:231], v1, s[12:15], s38 offen offset:3072 sc1
v_mfma_f32_16x16x32_bf16 v[88:91], a[48:51], a[8:11], v[88:91]
s_waitcnt lgkmcnt(6)
ds_read_b64_tr_b16 a[68:69], v51 offset:24576
ds_read_b64_tr_b16 a[70:71], v51 offset:28672
v_mfma_f32_16x16x32_bf16 v[92:95], a[48:51], a[12:15], v[92:95]
s_add_u32 s37, s37, 4096
v_mfma_f32_16x16x32_bf16 v[96:99], a[52:55], a[8:11], v[96:99]
s_waitcnt lgkmcnt(6)
ds_read_b64_tr_b16 a[72:73], v52 offset:24576
ds_read_b64_tr_b16 a[74:75], v52 offset:28672
v_mfma_f32_16x16x32_bf16 v[100:103], a[52:55], a[12:15], v[100:103]
s_waitcnt vmcnt(14)
v_accvgpr_read_b32 v35, a16
v_accvgpr_read_b32 v36, a20
v_mfma_f32_16x16x32_bf16 v[104:107], a[56:59], a[8:11], v[104:107]
s_waitcnt lgkmcnt(6)
ds_read_b64_tr_b16 a[76:77], v53 offset:24576
ds_read_b64_tr_b16 a[78:79], v53 offset:28672
v_mfma_f32_16x16x32_bf16 v[108:111], a[56:59], a[12:15], v[108:111]
buffer_load_dwordx4 a[232:235], v1, s[12:15], s37 offen offset:0 sc1
v_mfma_f32_16x16x32_bf16 v[112:115], a[60:63], a[8:11], v[112:115]
s_waitcnt lgkmcnt(6)
v_accvgpr_read_b32 v37, a24
s_add_u32 s38, s38, 4096
v_mfma_f32_16x16x32_bf16 v[116:119], a[60:63], a[12:15], v[116:119]
v_accvgpr_read_b32 v74, a28
v_max3_u32 v35, v35, v36, v37
v_mfma_f32_16x16x32_bf16 v[120:123], a[64:67], a[8:11], v[120:123]
s_waitcnt lgkmcnt(4)
ds_read_b64_tr_b16 a[48:49], v38 offset:32768
ds_read_b64_tr_b16 a[50:51], v38 offset:36864
v_mfma_f32_16x16x32_bf16 v[124:127], a[64:67], a[12:15], v[124:127]
buffer_load_dwordx4 a[236:239], v1, s[12:15], s38 offen offset:0 sc1
v_mfma_f32_16x16x32_bf16 v[128:131], a[68:71], a[8:11], v[128:131]
s_waitcnt lgkmcnt(4)
ds_read_b64_tr_b16 a[52:53], v39 offset:32768
ds_read_b64_tr_b16 a[54:55], v39 offset:36864
v_mfma_f32_16x16x32_bf16 v[132:135], a[68:71], a[12:15], v[132:135]
v_max_u32 v35, v35, v74
v_cmp_eq_u32 vcc, -1, v35
v_mfma_f32_16x16x32_bf16 v[136:139], a[72:75], a[8:11], v[136:139]
s_waitcnt lgkmcnt(4)
ds_read_b64_tr_b16 a[56:57], v40 offset:32768
ds_read_b64_tr_b16 a[58:59], v40 offset:36864
v_mfma_f32_16x16x32_bf16 v[140:143], a[72:75], a[12:15], v[140:143]
s_cbranch_vccnz L_kt_t2_10
L_kt_r2_10:
v_mfma_f32_16x16x32_bf16 v[144:147], a[76:79], a[8:11], v[144:147]
ds_read_b64_tr_b16 a[60:61], v41 offset:32768
ds_read_b64_tr_b16 a[62:63], v41 offset:36864
v_mfma_f32_16x16x32_bf16 v[148:151], a[76:79], a[12:15], v[148:151]
buffer_load_dwordx4 a[240:243], v1, s[12:15], s37 offen offset:1024 sc1
v_mfma_f32_16x16x32_bf16 v[152:155], a[120:123], a[16:19], v[152:155]
s_waitcnt lgkmcnt(6)
ds_read_b64_tr_b16 a[64:65], v42 offset:32768
ds_read_b64_tr_b16 a[66:67], v42 offset:36864
v_mfma_f32_16x16x32_bf16 v[156:159], a[120:123], a[20:23], v[156:159]
v_mfma_f32_16x16x32_bf16 v[88:91], a[48:51], a[16:19], v[88:91]
s_waitcnt lgkmcnt(6)
ds_read_b64_tr_b16 a[68:69], v43 offset:32768
ds_read_b64_tr_b16 a[70:71], v43 offset:36864
v_mfma_f32_16x16x32_bf16 v[92:95], a[48:51], a[20:23], v[92:95]
buffer_load_dwordx4 a[244:247], v1, s[12:15], s38 offen offset:1024 sc1
v_mfma_f32_16x16x32_bf16 v[96:99], a[52:55], a[16:19], v[96:99]
s_waitcnt lgkmcnt(6)
ds_read_b64_tr_b16 a[72:73], v44 offset:32768
ds_read_b64_tr_b16 a[74:75], v44 offset:36864
v_mfma_f32_16x16x32_bf16 v[100:103], a[52:55], a[20:23], v[100:103]
s_add_u32 s52, s44, 4718592
s_add_u32 m0, s49, 122880
v_mfma_f32_16x16x32_bf16 v[104:107], a[56:59], a[16:19], v[104:107]
s_waitcnt lgkmcnt(6)
ds_read_b64_tr_b16 a[76:77], v45 offset:32768
ds_read_b64_tr_b16 a[78:79], v45 offset:36864
v_mfma_f32_16x16x32_bf16 v[108:111], a[56:59], a[20:23], v[108:111]
buffer_load_dwordx4 v4, s[8:11], s52 offen lds
v_mfma_f32_16x16x32_bf16 v[112:115], a[60:63], a[16:19], v[112:115]
s_waitcnt lgkmcnt(6)
v_mfma_f32_16x16x32_bf16 v[116:119], a[60:63], a[20:23], v[116:119]
v_mfma_f32_16x16x32_bf16 v[120:123], a[64:67], a[16:19], v[120:123]
s_waitcnt lgkmcnt(4)
ds_read_b64_tr_b16 a[48:49], v38 offset:40960
ds_read_b64_tr_b16 a[50:51], v38 offset:45056
v_mfma_f32_16x16x32_bf16 v[124:127], a[64:67], a[20:23], v[124:127]
s_add_u32 s52, s44, 4755456
s_add_u32 m0, s49, 123904
v_mfma_f32_16x16x32_bf16 v[128:131], a[68:71], a[16:19], v[128:131]
s_waitcnt lgkmcnt(4)
ds_read_b64_tr_b16 a[52:53], v39 offset:40960
ds_read_b64_tr_b16 a[54:55], v39 offset:45056
v_mfma_f32_16x16x32_bf16 v[132:135], a[68:71], a[20:23], v[132:135]
buffer_load_dwordx4 v5, s[8:11], s52 offen lds
v_mfma_f32_16x16x32_bf16 v[136:139], a[72:75], a[16:19], v[136:139]
s_waitcnt lgkmcnt(4)
ds_read_b64_tr_b16 a[56:57], v40 offset:40960
ds_read_b64_tr_b16 a[58:59], v40 offset:45056
v_mfma_f32_16x16x32_bf16 v[140:143], a[72:75], a[20:23], v[140:143]
s_add_u32 s52, s44, 5013504
s_add_u32 m0, s49, 106496
v_mfma_f32_16x16x32_bf16 v[144:147], a[76:79], a[16:19], v[144:147]
ds_read_b64_tr_b16 a[60:61], v41 offset:40960
ds_read_b64_tr_b16 a[62:63], v41 offset:45056
v_mfma_f32_16x16x32_bf16 v[148:151], a[76:79], a[20:23], v[148:151]
buffer_load_dwordx4 v4, s[8:11], s52 offen lds
v_mfma_f32_16x16x32_bf16 v[152:155], a[124:127], a[24:27], v[152:155]
s_waitcnt lgkmcnt(6)
ds_read_b64_tr_b16 a[64:65], v42 offset:40960
ds_read_b64_tr_b16 a[66:67], v42 offset:45056
v_mfma_f32_16x16x32_bf16 v[156:159], a[124:127], a[28:31], v[156:159]
v_mfma_f32_16x16x32_bf16 v[88:91], a[48:51], a[24:27], v[88:91]
s_waitcnt lgkmcnt(6)
ds_read_b64_tr_b16 a[68:69], v43 offset:40960
ds_read_b64_tr_b16 a[70:71], v43 offset:45056
v_mfma_f32_16x16x32_bf16 v[92:95], a[48:51], a[28:31], v[92:95]
s_add_u32 s52, s44, 5050368
s_add_u32 m0, s49, 107520
v_mfma_f32_16x16x32_bf16 v[96:99], a[52:55], a[24:27], v[96:99]
s_waitcnt lgkmcnt(6)
ds_read_b64_tr_b16 a[72:73], v44 offset:40960
ds_read_b64_tr_b16 a[74:75], v44 offset:45056
v_mfma_f32_16x16x32_bf16 v[100:103], a[52:55], a[28:31], v[100:103]
buffer_load_dwordx4 v5, s[8:11], s52 offen lds
v_mfma_f32_16x16x32_bf16 v[104:107], a[56:59], a[24:27], v[104:107]
s_waitcnt lgkmcnt(6)
ds_read_b64_tr_b16 a[76:77], v45 offset:40960
ds_read_b64_tr_b16 a[78:79], v45 offset:45056
v_mfma_f32_16x16x32_bf16 v[108:111], a[56:59], a[28:31], v[108:111]
s_waitcnt vmcnt(16)
v_accvgpr_read_b32 v35, a32
s_add_u32 s52, s80, s84
v_mfma_f32_16x16x32_bf16 v[112:115], a[60:63], a[24:27], v[112:115]
s_waitcnt lgkmcnt(6)
v_accvgpr_read_b32 v36, a36
s_add_u32 m0, s50, 0
v_mfma_f32_16x16x32_bf16 v[116:119], a[60:63], a[28:31], v[116:119]
v_accvgpr_read_b32 v37, a40
v_accvgpr_read_b32 v74, a44
v_mfma_f32_16x16x32_bf16 v[120:123], a[64:67], a[24:27], v[120:123]
s_waitcnt lgkmcnt(4)
ds_read_b64_tr_b16 a[48:49], v46 offset:32768
ds_read_b64_tr_b16 a[50:51], v46 offset:36864
v_mfma_f32_16x16x32_bf16 v[124:127], a[64:67], a[28:31], v[124:127]
buffer_load_dwordx4 v6, s[92:95], s52 offen lds
v_mfma_f32_16x16x32_bf16 v[128:131], a[68:71], a[24:27], v[128:131]
s_waitcnt lgkmcnt(4)
ds_read_b64_tr_b16 a[52:53], v47 offset:32768
ds_read_b64_tr_b16 a[54:55], v47 offset:36864
v_mfma_f32_16x16x32_bf16 v[132:135], a[68:71], a[28:31], v[132:135]
s_add_u32 s52, s81, s84
v_max3_u32 v35, v35, v36, v37
v_max_u32 v35, v35, v74
v_mfma_f32_16x16x32_bf16 v[136:139], a[72:75], a[24:27], v[136:139]
s_waitcnt lgkmcnt(4)
ds_read_b64_tr_b16 a[56:57], v48 offset:32768
ds_read_b64_tr_b16 a[58:59], v48 offset:36864
v_mfma_f32_16x16x32_bf16 v[140:143], a[72:75], a[28:31], v[140:143]
v_cmp_eq_u32 vcc, -1, v35
s_add_u32 m0, s50, 4096
v_mfma_f32_16x16x32_bf16 v[144:147], a[76:79], a[24:27], v[144:147]
ds_read_b64_tr_b16 a[60:61], v49 offset:32768
ds_read_b64_tr_b16 a[62:63], v49 offset:36864
v_mfma_f32_16x16x32_bf16 v[148:151], a[76:79], a[28:31], v[148:151]
s_waitcnt vmcnt(13)
s_barrier
buffer_load_dwordx4 v6, s[92:95], s52 offen lds
s_cbranch_vccnz L_kt_t2_12
L_kt_r2_12:
v_mfma_f32_16x16x32_bf16 v[152:155], a[128:131], a[32:35], v[152:155]
s_waitcnt lgkmcnt(6)
ds_read_b64_tr_b16 a[64:65], v50 offset:32768
ds_read_b64_tr_b16 a[66:67], v50 offset:36864
v_mfma_f32_16x16x32_bf16 v[156:159], a[128:131], a[36:39], v[156:159]
s_add_u32 s52, s82, s84
s_add_u32 m0, s50, 8192
v_mfma_f32_16x16x32_bf16 v[88:91], a[48:51], a[32:35], v[88:91]
s_waitcnt lgkmcnt(6)
ds_read_b64_tr_b16 a[68:69], v51 offset:32768
ds_read_b64_tr_b16 a[70:71], v51 offset:36864
v_mfma_f32_16x16x32_bf16 v[92:95], a[48:51], a[36:39], v[92:95]
buffer_load_dwordx4 v6, s[92:95], s52 offen lds
v_mfma_f32_16x16x32_bf16 v[96:99], a[52:55], a[32:35], v[96:99]
s_waitcnt lgkmcnt(6)
ds_read_b64_tr_b16 a[72:73], v52 offset:32768
ds_read_b64_tr_b16 a[74:75], v52 offset:36864
v_mfma_f32_16x16x32_bf16 v[100:103], a[52:55], a[36:39], v[100:103]
v_mfma_f32_16x16x32_bf16 v[104:107], a[56:59], a[32:35], v[104:107]
s_waitcnt lgkmcnt(6)
ds_read_b64_tr_b16 a[76:77], v53 offset:32768
ds_read_b64_tr_b16 a[78:79], v53 offset:36864
v_mfma_f32_16x16x32_bf16 v[108:111], a[56:59], a[36:39], v[108:111]
v_mfma_f32_16x16x32_bf16 v[112:115], a[60:63], a[32:35], v[112:115]
s_waitcnt lgkmcnt(6)
v_mfma_f32_16x16x32_bf16 v[116:119], a[60:63], a[36:39], v[116:119]
v_mfma_f32_16x16x32_bf16 v[120:123], a[64:67], a[32:35], v[120:123]
s_waitcnt lgkmcnt(4)
ds_read_b64_tr_b16 a[48:49], v38 offset:49152
ds_read_b64_tr_b16 a[50:51], v38 offset:53248
v_mfma_f32_16x16x32_bf16 v[124:127], a[64:67], a[36:39], v[124:127]
v_mfma_f32_16x16x32_bf16 v[128:131], a[68:71], a[32:35], v[128:131]
s_waitcnt lgkmcnt(4)
ds_read_b64_tr_b16 a[52:53], v39 offset:49152
ds_read_b64_tr_b16 a[54:55], v39 offset:53248
v_mfma_f32_16x16x32_bf16 v[132:135], a[68:71], a[36:39], v[132:135]
s_mul_i32 s37, s36, 18432
s_add_u32 s37, s37, 119537664
s_add_u32 s38, s37, 18432
v_mfma_f32_16x16x32_bf16 v[136:139], a[72:75], a[32:35], v[136:139]
s_waitcnt lgkmcnt(4)
ds_read_b64_tr_b16 a[56:57], v40 offset:49152
ds_read_b64_tr_b16 a[58:59], v40 offset:53248
v_mfma_f32_16x16x32_bf16 v[140:143], a[72:75], a[36:39], v[140:143]
buffer_load_dwordx4 v[192:195], v1, s[12:15], s37 offen offset:0 sc1
v_mfma_f32_16x16x32_bf16 v[144:147], a[76:79], a[32:35], v[144:147]
ds_read_b64_tr_b16 a[60:61], v41 offset:49152
ds_read_b64_tr_b16 a[62:63], v41 offset:53248
v_mfma_f32_16x16x32_bf16 v[148:151], a[76:79], a[36:39], v[148:151]
v_mfma_f32_16x16x32_bf16 v[152:155], a[132:135], a[40:43], v[152:155]
s_waitcnt lgkmcnt(6)
ds_read_b64_tr_b16 a[64:65], v42 offset:49152
ds_read_b64_tr_b16 a[66:67], v42 offset:53248
v_mfma_f32_16x16x32_bf16 v[156:159], a[132:135], a[44:47], v[156:159]
buffer_load_dwordx4 v[196:199], v1, s[12:15], s38 offen offset:0 sc1
v_mfma_f32_16x16x32_bf16 v[88:91], a[48:51], a[40:43], v[88:91]
s_waitcnt lgkmcnt(6)
ds_read_b64_tr_b16 a[68:69], v43 offset:49152
ds_read_b64_tr_b16 a[70:71], v43 offset:53248
v_mfma_f32_16x16x32_bf16 v[92:95], a[48:51], a[44:47], v[92:95]
v_mfma_f32_16x16x32_bf16 v[96:99], a[52:55], a[40:43], v[96:99]
s_waitcnt lgkmcnt(6)
ds_read_b64_tr_b16 a[72:73], v44 offset:49152
ds_read_b64_tr_b16 a[74:75], v44 offset:53248
v_mfma_f32_16x16x32_bf16 v[100:103], a[52:55], a[44:47], v[100:103]
s_waitcnt vmcnt(13)
v_accvgpr_read_b32 v35, a216
v_accvgpr_read_b32 v36, a220
v_mfma_f32_16x16x32_bf16 v[104:107], a[56:59], a[40:43], v[104:107]
s_waitcnt lgkmcnt(6)
ds_read_b64_tr_b16 a[76:77], v45 offset:49152
ds_read_b64_tr_b16 a[78:79], v45 offset:53248
v_mfma_f32_16x16x32_bf16 v[108:111], a[56:59], a[44:47], v[108:111]
buffer_load_dwordx4 v[200:203], v1, s[12:15], s37 offen offset:1024 sc1
v_mfma_f32_16x16x32_bf16 v[112:115], a[60:63], a[40:43], v[112:115]
s_waitcnt lgkmcnt(6)
v_accvgpr_read_b32 v37, a224
v_accvgpr_read_b32 v74, a228
v_mfma_f32_16x16x32_bf16 v[116:119], a[60:63], a[44:47], v[116:119]
v_max3_u32 v35, v35, v36, v37
v_max_u32 v35, v35, v74
v_mfma_f32_16x16x32_bf16 v[120:123], a[64:67], a[40:43], v[120:123]
s_waitcnt lgkmcnt(4)
ds_read_b64_tr_b16 a[48:49], v38 offset:57344
ds_read_b64_tr_b16 a[50:51], v38 offset:61440
v_mfma_f32_16x16x32_bf16 v[124:127], a[64:67], a[44:47], v[124:127]
buffer_load_dwordx4 v[204:207], v1, s[12:15], s38 offen offset:1024 sc1
v_mfma_f32_16x16x32_bf16 v[128:131], a[68:71], a[40:43], v[128:131]
s_waitcnt lgkmcnt(4)
ds_read_b64_tr_b16 a[52:53], v39 offset:57344
ds_read_b64_tr_b16 a[54:55], v39 offset:61440
v_mfma_f32_16x16x32_bf16 v[132:135], a[68:71], a[44:47], v[132:135]
v_cmp_eq_u32 vcc, -1, v35
v_mfma_f32_16x16x32_bf16 v[136:139], a[72:75], a[40:43], v[136:139]
s_waitcnt lgkmcnt(4)
ds_read_b64_tr_b16 a[56:57], v40 offset:57344
ds_read_b64_tr_b16 a[58:59], v40 offset:61440
v_mfma_f32_16x16x32_bf16 v[140:143], a[72:75], a[44:47], v[140:143]
s_cbranch_vccnz L_kt_t2_14
L_kt_r2_14:
v_mfma_f32_16x16x32_bf16 v[144:147], a[76:79], a[40:43], v[144:147]
ds_read_b64_tr_b16 a[60:61], v41 offset:57344
ds_read_b64_tr_b16 a[62:63], v41 offset:61440
v_mfma_f32_16x16x32_bf16 v[148:151], a[76:79], a[44:47], v[148:151]
buffer_load_dwordx4 v[208:211], v1, s[12:15], s37 offen offset:2048 sc1
v_mfma_f32_16x16x32_bf16 v[152:155], a[136:139], a[216:219], v[152:155]
s_waitcnt lgkmcnt(6)
ds_read_b64_tr_b16 a[64:65], v42 offset:57344
ds_read_b64_tr_b16 a[66:67], v42 offset:61440
v_mfma_f32_16x16x32_bf16 v[156:159], a[136:139], a[220:223], v[156:159]
v_mfma_f32_16x16x32_bf16 v[88:91], a[48:51], a[216:219], v[88:91]
s_waitcnt lgkmcnt(6)
ds_read_b64_tr_b16 a[68:69], v43 offset:57344
ds_read_b64_tr_b16 a[70:71], v43 offset:61440
v_mfma_f32_16x16x32_bf16 v[92:95], a[48:51], a[220:223], v[92:95]
buffer_load_dwordx4 v[212:215], v1, s[12:15], s38 offen offset:2048 sc1
v_mfma_f32_16x16x32_bf16 v[96:99], a[52:55], a[216:219], v[96:99]
s_waitcnt lgkmcnt(6)
ds_read_b64_tr_b16 a[72:73], v44 offset:57344
ds_read_b64_tr_b16 a[74:75], v44 offset:61440
v_mfma_f32_16x16x32_bf16 v[100:103], a[52:55], a[220:223], v[100:103]
v_mfma_f32_16x16x32_bf16 v[104:107], a[56:59], a[216:219], v[104:107]
s_waitcnt lgkmcnt(6)
ds_read_b64_tr_b16 a[76:77], v45 offset:57344
ds_read_b64_tr_b16 a[78:79], v45 offset:61440
v_mfma_f32_16x16x32_bf16 v[108:111], a[56:59], a[220:223], v[108:111]
s_waitcnt vmcnt(13)
v_accvgpr_read_b32 v35, a232
v_accvgpr_read_b32 v36, a236
v_mfma_f32_16x16x32_bf16 v[112:115], a[60:63], a[216:219], v[112:115]
s_waitcnt lgkmcnt(6)
v_accvgpr_read_b32 v37, a240
v_accvgpr_read_b32 v74, a244
v_mfma_f32_16x16x32_bf16 v[116:119], a[60:63], a[220:223], v[116:119]
buffer_load_dwordx4 v[216:219], v1, s[12:15], s37 offen offset:3072 sc1
v_mfma_f32_16x16x32_bf16 v[120:123], a[64:67], a[216:219], v[120:123]
s_waitcnt lgkmcnt(4)
v_max3_u32 v35, v35, v36, v37
v_max_u32 v35, v35, v74
v_mfma_f32_16x16x32_bf16 v[124:127], a[64:67], a[220:223], v[124:127]
v_cmp_eq_u32 vcc, -1, v35
s_mul_i32 s53, s35, 18432
v_mfma_f32_16x16x32_bf16 v[128:131], a[68:71], a[216:219], v[128:131]
s_waitcnt lgkmcnt(2)
s_add_u32 s53, s53, s76
s_lshl_b32 s54, s33, 9
v_mfma_f32_16x16x32_bf16 v[132:135], a[68:71], a[220:223], v[132:135]
buffer_load_dwordx4 v[220:223], v1, s[12:15], s38 offen offset:3072 sc1
v_mfma_f32_16x16x32_bf16 v[136:139], a[72:75], a[216:219], v[136:139]
s_waitcnt lgkmcnt(0)
ds_read_b64_tr_b16 a[48:49], v46 offset:49152
ds_read_b64_tr_b16 a[50:51], v46 offset:53248
v_mfma_f32_16x16x32_bf16 v[140:143], a[72:75], a[220:223], v[140:143]
s_cbranch_vccnz L_kt_t2_16
L_kt_r2_16:
s_add_u32 s55, s53, s54
s_add_u32 s55, s55, 16384
v_mfma_f32_16x16x32_bf16 v[144:147], a[76:79], a[216:219], v[144:147]
s_add_u32 s37, s37, 4096
ds_read_b64_tr_b16 a[52:53], v47 offset:49152
ds_read_b64_tr_b16 a[54:55], v47 offset:53248
v_mfma_f32_16x16x32_bf16 v[148:151], a[76:79], a[220:223], v[148:151]
s_waitcnt vmcnt(13)
s_barrier
v_mfma_f32_16x16x32_bf16 v[152:155], a[140:143], a[224:227], v[152:155]
s_lshl_b32 s54, s33, 12
ds_read_b64_tr_b16 a[56:57], v46 offset:57344
ds_read_b64_tr_b16 a[58:59], v46 offset:61440
v_mfma_f32_16x16x32_bf16 v[156:159], a[140:143], a[228:231], v[156:159]
buffer_load_dwordx4 v[224:227], v1, s[12:15], s37 offen offset:0 sc1
v_mfma_f32_16x16x32_bf16 v[152:155], a[144:147], a[232:235], v[152:155]
s_add_u32 s53, s53, s54
ds_read_b64_tr_b16 a[60:61], v47 offset:57344
ds_read_b64_tr_b16 a[62:63], v47 offset:61440
v_mfma_f32_16x16x32_bf16 v[156:159], a[144:147], a[236:239], v[156:159]
s_waitcnt vmcnt(12)
s_barrier
v_mfma_f32_16x16x32_bf16 v[152:155], a[148:151], a[240:243], v[152:155]
s_waitcnt lgkmcnt(6)
ds_read_b64_tr_b16 a[64:65], v46 offset:40960
ds_read_b64_tr_b16 a[66:67], v46 offset:45056
v_mfma_f32_16x16x32_bf16 v[156:159], a[148:151], a[244:247], v[156:159]
s_add_u32 s38, s38, 4096
s_add_u32 s54, s53, 18432
v_mfma_f32_16x16x32_bf16 v[88:91], a[48:51], a[224:227], v[88:91]
s_waitcnt lgkmcnt(6)
ds_read_b64_tr_b16 a[68:69], v47 offset:40960
ds_read_b64_tr_b16 a[70:71], v47 offset:45056
v_mfma_f32_16x16x32_bf16 v[92:95], a[48:51], a[228:231], v[92:95]
buffer_load_dwordx4 v[228:231], v1, s[12:15], s38 offen offset:0 sc1
v_mfma_f32_16x16x32_bf16 v[96:99], a[52:55], a[224:227], v[96:99]
s_waitcnt lgkmcnt(6)
ds_read_b64_tr_b16 a[72:73], v48 offset:49152
ds_read_b64_tr_b16 a[74:75], v48 offset:53248
v_mfma_f32_16x16x32_bf16 v[100:103], a[52:55], a[228:231], v[100:103]
v_cvt_pk_bf16_f32 v152, v152, v153
v_cvt_pk_bf16_f32 v153, v154, v155
v_mfma_f32_16x16x32_bf16 v[88:91], a[56:59], a[232:235], v[88:91]
s_waitcnt lgkmcnt(6)
ds_read_b64_tr_b16 a[76:77], v49 offset:49152
ds_read_b64_tr_b16 a[78:79], v49 offset:53248
v_mfma_f32_16x16x32_bf16 v[92:95], a[56:59], a[236:239], v[92:95]
v_cvt_pk_bf16_f32 v154, v156, v157
v_cvt_pk_bf16_f32 v155, v158, v159
v_mfma_f32_16x16x32_bf16 v[96:99], a[60:63], a[232:235], v[96:99]
s_waitcnt lgkmcnt(6)
ds_read_b64_tr_b16 a[48:49], v48 offset:57344
ds_read_b64_tr_b16 a[50:51], v48 offset:61440
v_mfma_f32_16x16x32_bf16 v[100:103], a[60:63], a[236:239], v[100:103]
buffer_load_dwordx4 v[232:235], v1, s[12:15], s37 offen offset:1024 sc1
v_pk_max_i16 v152, v152, 0
v_mfma_f32_16x16x32_bf16 v[88:91], a[64:67], a[240:243], v[88:91]
s_waitcnt lgkmcnt(6)
ds_read_b64_tr_b16 a[52:53], v49 offset:57344
ds_read_b64_tr_b16 a[54:55], v49 offset:61440
v_mfma_f32_16x16x32_bf16 v[92:95], a[64:67], a[244:247], v[92:95]
v_pk_max_i16 v153, v153, 0
v_pk_max_i16 v154, v154, 0
v_mfma_f32_16x16x32_bf16 v[96:99], a[68:71], a[240:243], v[96:99]
s_waitcnt lgkmcnt(6)
ds_read_b64_tr_b16 a[56:57], v48 offset:40960
ds_read_b64_tr_b16 a[58:59], v48 offset:45056
v_mfma_f32_16x16x32_bf16 v[100:103], a[68:71], a[244:247], v[100:103]
v_pk_max_i16 v155, v155, 0
v_permlane32_swap_b32 v152, v154
v_mfma_f32_16x16x32_bf16 v[104:107], a[72:75], a[224:227], v[104:107]
s_waitcnt lgkmcnt(6)
ds_read_b64_tr_b16 a[60:61], v49 offset:40960
ds_read_b64_tr_b16 a[62:63], v49 offset:45056
buffer_load_dwordx4 v[236:239], v1, s[12:15], s38 offen offset:1024 sc1
v_mfma_f32_16x16x32_bf16 v[108:111], a[72:75], a[228:231], v[108:111]
v_permlane32_swap_b32 v153, v155
buffer_store_dwordx4 v[152:155], v11, s[12:15], s55 offen sc1
v_mfma_f32_16x16x32_bf16 v[112:115], a[76:79], a[224:227], v[112:115]
s_waitcnt lgkmcnt(6)
ds_read_b64_tr_b16 a[64:65], v50 offset:49152
ds_read_b64_tr_b16 a[66:67], v50 offset:53248
v_mfma_f32_16x16x32_bf16 v[116:119], a[76:79], a[228:231], v[116:119]
v_cvt_pk_bf16_f32 v160, v88, v89
v_cvt_pk_bf16_f32 v161, v90, v91
v_mfma_f32_16x16x32_bf16 v[104:107], a[48:51], a[232:235], v[104:107]
s_waitcnt lgkmcnt(6)
ds_read_b64_tr_b16 a[68:69], v51 offset:49152
ds_read_b64_tr_b16 a[70:71], v51 offset:53248
v_mfma_f32_16x16x32_bf16 v[108:111], a[48:51], a[236:239], v[108:111]
buffer_load_dwordx4 v[240:243], v1, s[12:15], s37 offen offset:2048 sc1
v_cvt_pk_bf16_f32 v162, v96, v97
v_cvt_pk_bf16_f32 v163, v98, v99
v_mfma_f32_16x16x32_bf16 v[112:115], a[52:55], a[232:235], v[112:115]
s_waitcnt lgkmcnt(6)
ds_read_b64_tr_b16 a[72:73], v50 offset:57344
ds_read_b64_tr_b16 a[74:75], v50 offset:61440
v_mfma_f32_16x16x32_bf16 v[116:119], a[52:55], a[236:239], v[116:119]
v_pk_max_i16 v160, v160, 0
v_pk_max_i16 v161, v161, 0
v_mfma_f32_16x16x32_bf16 v[104:107], a[56:59], a[240:243], v[104:107]
s_waitcnt lgkmcnt(6)
ds_read_b64_tr_b16 a[76:77], v51 offset:57344
ds_read_b64_tr_b16 a[78:79], v51 offset:61440
v_mfma_f32_16x16x32_bf16 v[108:111], a[56:59], a[244:247], v[108:111]
v_pk_max_i16 v162, v162, 0
v_pk_max_i16 v163, v163, 0
buffer_store_dwordx4 v[160:163], v1, s[12:15], s53 offen offset:0 sc1
v_mfma_f32_16x16x32_bf16 v[112:115], a[60:63], a[240:243], v[112:115]
s_waitcnt lgkmcnt(6)
ds_read_b64_tr_b16 a[48:49], v50 offset:40960
ds_read_b64_tr_b16 a[50:51], v50 offset:45056
buffer_load_dwordx4 v[244:247], v1, s[12:15], s38 offen offset:2048 sc1
v_mfma_f32_16x16x32_bf16 v[116:119], a[60:63], a[244:247], v[116:119]
v_cvt_pk_bf16_f32 v164, v92, v93
v_cvt_pk_bf16_f32 v165, v94, v95
v_mfma_f32_16x16x32_bf16 v[120:123], a[64:67], a[224:227], v[120:123]
s_waitcnt lgkmcnt(6)
ds_read_b64_tr_b16 a[52:53], v51 offset:40960
ds_read_b64_tr_b16 a[54:55], v51 offset:45056
v_mfma_f32_16x16x32_bf16 v[124:127], a[64:67], a[228:231], v[124:127]
v_cvt_pk_bf16_f32 v166, v100, v101
v_cvt_pk_bf16_f32 v167, v102, v103
v_mfma_f32_16x16x32_bf16 v[128:131], a[68:71], a[224:227], v[128:131]
s_waitcnt lgkmcnt(6)
ds_read_b64_tr_b16 a[56:57], v52 offset:49152
ds_read_b64_tr_b16 a[58:59], v52 offset:53248
v_mfma_f32_16x16x32_bf16 v[132:135], a[68:71], a[228:231], v[132:135]
buffer_load_dwordx4 v[248:251], v1, s[12:15], s37 offen offset:3072 sc1
v_pk_max_i16 v164, v164, 0
v_pk_max_i16 v165, v165, 0
v_mfma_f32_16x16x32_bf16 v[120:123], a[72:75], a[232:235], v[120:123]
s_waitcnt lgkmcnt(6)
ds_read_b64_tr_b16 a[60:61], v53 offset:49152
ds_read_b64_tr_b16 a[62:63], v53 offset:53248
v_mfma_f32_16x16x32_bf16 v[124:127], a[72:75], a[236:239], v[124:127]
v_pk_max_i16 v166, v166, 0
v_pk_max_i16 v167, v167, 0
buffer_store_dwordx4 v[164:167], v1, s[12:15], s54 offen offset:0 sc1
v_mfma_f32_16x16x32_bf16 v[128:131], a[76:79], a[232:235], v[128:131]
s_waitcnt lgkmcnt(6)
ds_read_b64_tr_b16 a[64:65], v52 offset:57344
ds_read_b64_tr_b16 a[66:67], v52 offset:61440
v_mfma_f32_16x16x32_bf16 v[132:135], a[76:79], a[236:239], v[132:135]
v_cvt_pk_bf16_f32 v168, v104, v105
v_cvt_pk_bf16_f32 v169, v106, v107
v_mfma_f32_16x16x32_bf16 v[120:123], a[48:51], a[240:243], v[120:123]
s_waitcnt lgkmcnt(6)
ds_read_b64_tr_b16 a[68:69], v53 offset:57344
ds_read_b64_tr_b16 a[70:71], v53 offset:61440
buffer_load_dwordx4 v[252:255], v1, s[12:15], s38 offen offset:3072 sc1
v_mfma_f32_16x16x32_bf16 v[124:127], a[48:51], a[244:247], v[124:127]
v_cvt_pk_bf16_f32 v170, v112, v113
v_cvt_pk_bf16_f32 v171, v114, v115
v_mfma_f32_16x16x32_bf16 v[128:131], a[52:55], a[240:243], v[128:131]
s_waitcnt lgkmcnt(6)
ds_read_b64_tr_b16 a[72:73], v52 offset:40960
ds_read_b64_tr_b16 a[74:75], v52 offset:45056
v_mfma_f32_16x16x32_bf16 v[132:135], a[52:55], a[244:247], v[132:135]
v_pk_max_i16 v168, v168, 0
v_pk_max_i16 v169, v169, 0
v_mfma_f32_16x16x32_bf16 v[136:139], a[56:59], a[224:227], v[136:139]
s_waitcnt lgkmcnt(6)
ds_read_b64_tr_b16 a[76:77], v53 offset:40960
ds_read_b64_tr_b16 a[78:79], v53 offset:45056
v_mfma_f32_16x16x32_bf16 v[140:143], a[56:59], a[228:231], v[140:143]
v_pk_max_i16 v170, v170, 0
v_pk_max_i16 v171, v171, 0
buffer_store_dwordx4 v[168:171], v1, s[12:15], s53 offen offset:1024 sc1
v_mfma_f32_16x16x32_bf16 v[144:147], a[60:63], a[224:227], v[144:147]
s_waitcnt lgkmcnt(6)
v_cvt_pk_bf16_f32 v172, v108, v109
v_cvt_pk_bf16_f32 v173, v110, v111
v_mfma_f32_16x16x32_bf16 v[148:151], a[60:63], a[228:231], v[148:151]
s_waitcnt vmcnt(16)
v_cvt_pk_bf16_f32 v174, v116, v117
v_cvt_pk_bf16_f32 v175, v118, v119
v_mfma_f32_16x16x32_bf16 v[136:139], a[64:67], a[232:235], v[136:139]
s_waitcnt lgkmcnt(4)
v_pk_max_i16 v172, v172, 0
v_pk_max_i16 v173, v173, 0
v_mfma_f32_16x16x32_bf16 v[140:143], a[64:67], a[236:239], v[140:143]
v_max3_u32 v35, v192, v196, v200
v_pk_max_i16 v174, v174, 0
v_mfma_f32_16x16x32_bf16 v[144:147], a[68:71], a[232:235], v[144:147]
s_waitcnt lgkmcnt(2)
ds_read_b64_tr_b16 a[48:49], v54 offset:0
ds_read_b64_tr_b16 a[50:51], v54 offset:4096
v_mfma_f32_16x16x32_bf16 v[148:151], a[68:71], a[236:239], v[148:151]
v_max_u32 v35, v35, v204
v_pk_max_i16 v175, v175, 0
buffer_store_dwordx4 v[172:175], v1, s[12:15], s54 offen offset:1024 sc1
v_mfma_f32_16x16x32_bf16 v[136:139], a[72:75], a[240:243], v[136:139]
s_waitcnt lgkmcnt(2)
ds_read_b64_tr_b16 a[52:53], v55 offset:0
ds_read_b64_tr_b16 a[54:55], v55 offset:4096
v_mfma_f32_16x16x32_bf16 v[140:143], a[72:75], a[244:247], v[140:143]
v_cmp_eq_u32 vcc, -1, v35
v_cvt_pk_bf16_f32 v176, v120, v121
v_mfma_f32_16x16x32_bf16 v[144:147], a[76:79], a[240:243], v[144:147]
ds_read_b64_tr_b16 a[56:57], v54 offset:8192
ds_read_b64_tr_b16 a[58:59], v54 offset:12288
v_mfma_f32_16x16x32_bf16 v[148:151], a[76:79], a[244:247], v[148:151]
s_mul_i32 s39, s36, 18432
s_add_u32 s39, s39, 119537664
s_add_u32 s40, s39, 18432
s_cbranch_vccnz L_kt_t3_0
L_kt_r3_0:
s_barrier
v_mfma_f32_16x16x32_bf16 v[152:155], a[80:83], v[192:195], 0
ds_read_b64_tr_b16 a[60:61], v55 offset:8192
ds_read_b64_tr_b16 a[62:63], v55 offset:12288
v_mfma_f32_16x16x32_bf16 v[156:159], a[80:83], v[196:199], 0
v_cvt_pk_bf16_f32 v177, v122, v123
v_cvt_pk_bf16_f32 v178, v128, v129
v_mfma_f32_16x16x32_bf16 v[152:155], a[84:87], v[200:203], v[152:155]
s_waitcnt lgkmcnt(6)
ds_read_b64_tr_b16 a[64:65], v56 offset:0
ds_read_b64_tr_b16 a[66:67], v56 offset:4096
v_mfma_f32_16x16x32_bf16 v[156:159], a[84:87], v[204:207], v[156:159]
v_cvt_pk_bf16_f32 v179, v130, v131
v_pk_max_i16 v176, v176, 0
v_mfma_f32_16x16x32_bf16 v[88:91], a[48:51], v[192:195], 0
s_waitcnt lgkmcnt(6)
ds_read_b64_tr_b16 a[68:69], v57 offset:0
ds_read_b64_tr_b16 a[70:71], v57 offset:4096
v_mfma_f32_16x16x32_bf16 v[92:95], a[48:51], v[196:199], 0
v_pk_max_i16 v177, v177, 0
v_pk_max_i16 v178, v178, 0
v_mfma_f32_16x16x32_bf16 v[96:99], a[52:55], v[192:195], 0
s_waitcnt lgkmcnt(6)
ds_read_b64_tr_b16 a[72:73], v56 offset:8192
ds_read_b64_tr_b16 a[74:75], v56 offset:12288
v_mfma_f32_16x16x32_bf16 v[100:103], a[52:55], v[196:199], 0
v_pk_max_i16 v179, v179, 0
buffer_store_dwordx4 v[176:179], v1, s[12:15], s53 offen offset:2048 sc1
v_mfma_f32_16x16x32_bf16 v[88:91], a[56:59], v[200:203], v[88:91]
s_waitcnt lgkmcnt(6)
ds_read_b64_tr_b16 a[76:77], v57 offset:8192
ds_read_b64_tr_b16 a[78:79], v57 offset:12288
v_mfma_f32_16x16x32_bf16 v[92:95], a[56:59], v[204:207], v[92:95]
v_cvt_pk_bf16_f32 v180, v124, v125
v_cvt_pk_bf16_f32 v181, v126, v127
v_mfma_f32_16x16x32_bf16 v[96:99], a[60:63], v[200:203], v[96:99]
s_waitcnt lgkmcnt(6)
ds_read_b64_tr_b16 a[48:49], v58 offset:0
ds_read_b64_tr_b16 a[50:51], v58 offset:4096
v_mfma_f32_16x16x32_bf16 v[100:103], a[60:63], v[204:207], v[100:103]
v_cvt_pk_bf16_f32 v182, v132, v133
v_cvt_pk_bf16_f32 v183, v134, v135
v_mfma_f32_16x16x32_bf16 v[104:107], a[64:67], v[192:195], 0
s_waitcnt lgkmcnt(6)
ds_read_b64_tr_b16 a[52:53], v59 offset:0
ds_read_b64_tr_b16 a[54:55], v59 offset:4096
v_mfma_f32_16x16x32_bf16 v[108:111], a[64:67], v[196:199], 0
v_pk_max_i16 v180, v180, 0
v_pk_max_i16 v181, v181, 0
v_mfma_f32_16x16x32_bf16 v[112:115], a[68:71], v[192:195], 0
s_waitcnt lgkmcnt(6)
ds_read_b64_tr_b16 a[56:57], v58 offset:8192
ds_read_b64_tr_b16 a[58:59], v58 offset:12288
v_mfma_f32_16x16x32_bf16 v[116:119], a[68:71], v[196:199], 0
v_pk_max_i16 v182, v182, 0
v_pk_max_i16 v183, v183, 0
buffer_store_dwordx4 v[180:183], v1, s[12:15], s54 offen offset:2048 sc1
v_mfma_f32_16x16x32_bf16 v[104:107], a[72:75], v[200:203], v[104:107]
s_waitcnt lgkmcnt(6)
ds_read_b64_tr_b16 a[60:61], v59 offset:8192
ds_read_b64_tr_b16 a[62:63], v59 offset:12288
v_mfma_f32_16x16x32_bf16 v[108:111], a[72:75], v[204:207], v[108:111]
v_cvt_pk_bf16_f32 v184, v136, v137
v_cvt_pk_bf16_f32 v185, v138, v139
v_mfma_f32_16x16x32_bf16 v[112:115], a[76:79], v[200:203], v[112:115]
s_waitcnt lgkmcnt(6)
ds_read_b64_tr_b16 a[64:65], v60 offset:0
ds_read_b64_tr_b16 a[66:67], v60 offset:4096
v_mfma_f32_16x16x32_bf16 v[116:119], a[76:79], v[204:207], v[116:119]
v_cvt_pk_bf16_f32 v186, v144, v145
v_cvt_pk_bf16_f32 v187, v146, v147
v_mfma_f32_16x16x32_bf16 v[120:123], a[48:51], v[192:195], 0
s_waitcnt lgkmcnt(6)
ds_read_b64_tr_b16 a[68:69], v61 offset:0
ds_read_b64_tr_b16 a[70:71], v61 offset:4096
v_mfma_f32_16x16x32_bf16 v[124:127], a[48:51], v[196:199], 0
v_pk_max_i16 v184, v184, 0
v_pk_max_i16 v185, v185, 0
v_mfma_f32_16x16x32_bf16 v[128:131], a[52:55], v[192:195], 0
s_waitcnt lgkmcnt(6)
ds_read_b64_tr_b16 a[72:73], v60 offset:8192
ds_read_b64_tr_b16 a[74:75], v60 offset:12288
v_mfma_f32_16x16x32_bf16 v[132:135], a[52:55], v[196:199], 0
v_pk_max_i16 v186, v186, 0
v_pk_max_i16 v187, v187, 0
buffer_store_dwordx4 v[184:187], v1, s[12:15], s53 offen offset:3072 sc1
v_mfma_f32_16x16x32_bf16 v[120:123], a[56:59], v[200:203], v[120:123]
s_waitcnt lgkmcnt(6)
ds_read_b64_tr_b16 a[76:77], v61 offset:8192
ds_read_b64_tr_b16 a[78:79], v61 offset:12288
v_mfma_f32_16x16x32_bf16 v[124:127], a[56:59], v[204:207], v[124:127]
v_cvt_pk_bf16_f32 v188, v140, v141
v_cvt_pk_bf16_f32 v189, v142, v143
v_mfma_f32_16x16x32_bf16 v[128:131], a[60:63], v[200:203], v[128:131]
s_waitcnt lgkmcnt(6)
v_cvt_pk_bf16_f32 v190, v148, v149
v_cvt_pk_bf16_f32 v191, v150, v151
v_mfma_f32_16x16x32_bf16 v[132:135], a[60:63], v[204:207], v[132:135]
s_waitcnt vmcnt(16)
v_pk_max_i16 v188, v188, 0
v_pk_max_i16 v189, v189, 0
v_mfma_f32_16x16x32_bf16 v[136:139], a[64:67], v[192:195], 0
s_waitcnt lgkmcnt(4)
ds_read_b64_tr_b16 a[48:49], v38 offset:0
ds_read_b64_tr_b16 a[50:51], v38 offset:4096
v_pk_max_i16 v190, v190, 0
v_pk_max_i16 v191, v191, 0
buffer_store_dwordx4 v[188:191], v1, s[12:15], s54 offen offset:3072 sc1
v_mfma_f32_16x16x32_bf16 v[140:143], a[64:67], v[196:199], 0
v_max3_u32 v35, v208, v212, v216
v_max_u32 v35, v35, v220
v_mfma_f32_16x16x32_bf16 v[144:147], a[68:71], v[192:195], 0
s_waitcnt lgkmcnt(4)
ds_read_b64_tr_b16 a[52:53], v39 offset:0
ds_read_b64_tr_b16 a[54:55], v39 offset:4096
v_mfma_f32_16x16x32_bf16 v[148:151], a[68:71], v[196:199], 0
v_cmp_eq_u32 vcc, -1, v35
v_mfma_f32_16x16x32_bf16 v[136:139], a[72:75], v[200:203], v[136:139]
s_waitcnt lgkmcnt(4)
ds_read_b64_tr_b16 a[56:57], v40 offset:0
ds_read_b64_tr_b16 a[58:59], v40 offset:4096
v_mfma_f32_16x16x32_bf16 v[140:143], a[72:75], v[204:207], v[140:143]
s_cbranch_vccnz L_kt_t3_2
L_kt_r3_2:
v_mfma_f32_16x16x32_bf16 v[144:147], a[76:79], v[200:203], v[144:147]
ds_read_b64_tr_b16 a[60:61], v41 offset:0
ds_read_b64_tr_b16 a[62:63], v41 offset:4096
v_mfma_f32_16x16x32_bf16 v[148:151], a[76:79], v[204:207], v[148:151]
v_mfma_f32_16x16x32_bf16 v[152:155], a[88:91], v[208:211], v[152:155]
s_waitcnt lgkmcnt(6)
ds_read_b64_tr_b16 a[64:65], v42 offset:0
ds_read_b64_tr_b16 a[66:67], v42 offset:4096
v_mfma_f32_16x16x32_bf16 v[156:159], a[88:91], v[212:215], v[156:159]
v_mfma_f32_16x16x32_bf16 v[88:91], a[48:51], v[208:211], v[88:91]
s_waitcnt lgkmcnt(6)
ds_read_b64_tr_b16 a[68:69], v43 offset:0
ds_read_b64_tr_b16 a[70:71], v43 offset:4096
v_mfma_f32_16x16x32_bf16 v[92:95], a[48:51], v[212:215], v[92:95]
v_mfma_f32_16x16x32_bf16 v[96:99], a[52:55], v[208:211], v[96:99]
s_waitcnt lgkmcnt(6)
ds_read_b64_tr_b16 a[72:73], v44 offset:0
ds_read_b64_tr_b16 a[74:75], v44 offset:4096
v_mfma_f32_16x16x32_bf16 v[100:103], a[52:55], v[212:215], v[100:103]
v_mfma_f32_16x16x32_bf16 v[104:107], a[56:59], v[208:211], v[104:107]
s_waitcnt lgkmcnt(6)
ds_read_b64_tr_b16 a[76:77], v45 offset:0
ds_read_b64_tr_b16 a[78:79], v45 offset:4096
v_mfma_f32_16x16x32_bf16 v[108:111], a[56:59], v[212:215], v[108:111]
s_add_u32 s37, s37, 4096
v_mfma_f32_16x16x32_bf16 v[112:115], a[60:63], v[208:211], v[112:115]
s_waitcnt lgkmcnt(6)
v_mfma_f32_16x16x32_bf16 v[116:119], a[60:63], v[212:215], v[116:119]
buffer_load_dwordx4 a[0:3], v1, s[12:15], s37 offen offset:0 sc1
v_mfma_f32_16x16x32_bf16 v[120:123], a[64:67], v[208:211], v[120:123]
s_waitcnt lgkmcnt(4)
ds_read_b64_tr_b16 a[48:49], v38 offset:8192
ds_read_b64_tr_b16 a[50:51], v38 offset:12288
v_mfma_f32_16x16x32_bf16 v[124:127], a[64:67], v[212:215], v[124:127]
v_mfma_f32_16x16x32_bf16 v[128:131], a[68:71], v[208:211], v[128:131]
s_waitcnt lgkmcnt(4)
ds_read_b64_tr_b16 a[52:53], v39 offset:8192
ds_read_b64_tr_b16 a[54:55], v39 offset:12288
v_mfma_f32_16x16x32_bf16 v[132:135], a[68:71], v[212:215], v[132:135]
s_add_u32 s38, s38, 4096
v_mfma_f32_16x16x32_bf16 v[136:139], a[72:75], v[208:211], v[136:139]
s_waitcnt lgkmcnt(4)
ds_read_b64_tr_b16 a[56:57], v40 offset:8192
ds_read_b64_tr_b16 a[58:59], v40 offset:12288
v_mfma_f32_16x16x32_bf16 v[140:143], a[72:75], v[212:215], v[140:143]
buffer_load_dwordx4 a[4:7], v1, s[12:15], s38 offen offset:0 sc1
v_mfma_f32_16x16x32_bf16 v[144:147], a[76:79], v[208:211], v[144:147]
ds_read_b64_tr_b16 a[60:61], v41 offset:8192
ds_read_b64_tr_b16 a[62:63], v41 offset:12288
v_mfma_f32_16x16x32_bf16 v[148:151], a[76:79], v[212:215], v[148:151]
s_barrier
v_mfma_f32_16x16x32_bf16 v[152:155], a[92:95], v[216:219], v[152:155]
s_waitcnt lgkmcnt(6)
ds_read_b64_tr_b16 a[64:65], v42 offset:8192
ds_read_b64_tr_b16 a[66:67], v42 offset:12288
v_mfma_f32_16x16x32_bf16 v[156:159], a[92:95], v[220:223], v[156:159]
buffer_load_dwordx4 a[8:11], v1, s[12:15], s37 offen offset:1024 sc1
v_mfma_f32_16x16x32_bf16 v[88:91], a[48:51], v[216:219], v[88:91]
s_waitcnt lgkmcnt(6)
ds_read_b64_tr_b16 a[68:69], v43 offset:8192
ds_read_b64_tr_b16 a[70:71], v43 offset:12288
v_mfma_f32_16x16x32_bf16 v[92:95], a[48:51], v[220:223], v[92:95]
v_mfma_f32_16x16x32_bf16 v[96:99], a[52:55], v[216:219], v[96:99]
s_waitcnt lgkmcnt(6)
ds_read_b64_tr_b16 a[72:73], v44 offset:8192
ds_read_b64_tr_b16 a[74:75], v44 offset:12288
v_mfma_f32_16x16x32_bf16 v[100:103], a[52:55], v[220:223], v[100:103]
v_mfma_f32_16x16x32_bf16 v[104:107], a[56:59], v[216:219], v[104:107]
s_waitcnt lgkmcnt(6)
ds_read_b64_tr_b16 a[76:77], v45 offset:8192
ds_read_b64_tr_b16 a[78:79], v45 offset:12288
v_mfma_f32_16x16x32_bf16 v[108:111], a[56:59], v[220:223], v[108:111]
buffer_load_dwordx4 a[12:15], v1, s[12:15], s38 offen offset:1024 sc1
v_mfma_f32_16x16x32_bf16 v[112:115], a[60:63], v[216:219], v[112:115]
s_waitcnt lgkmcnt(6)
v_mfma_f32_16x16x32_bf16 v[116:119], a[60:63], v[220:223], v[116:119]
s_waitcnt vmcnt(17)
v_max3_u32 v35, v224, v228, v232
v_max_u32 v35, v35, v236
v_mfma_f32_16x16x32_bf16 v[120:123], a[64:67], v[216:219], v[120:123]
s_waitcnt lgkmcnt(4)
ds_read_b64_tr_b16 a[48:49], v46 offset:0
ds_read_b64_tr_b16 a[50:51], v46 offset:4096
v_mfma_f32_16x16x32_bf16 v[124:127], a[64:67], v[220:223], v[124:127]
buffer_load_dwordx4 a[16:19], v1, s[12:15], s37 offen offset:2048 sc1
v_mfma_f32_16x16x32_bf16 v[128:131], a[68:71], v[216:219], v[128:131]
s_waitcnt lgkmcnt(4)
ds_read_b64_tr_b16 a[52:53], v47 offset:0
ds_read_b64_tr_b16 a[54:55], v47 offset:4096
v_mfma_f32_16x16x32_bf16 v[132:135], a[68:71], v[220:223], v[132:135]
v_cmp_eq_u32 vcc, -1, v35
v_mfma_f32_16x16x32_bf16 v[136:139], a[72:75], v[216:219], v[136:139]
s_waitcnt lgkmcnt(4)
ds_read_b64_tr_b16 a[56:57], v48 offset:0
ds_read_b64_tr_b16 a[58:59], v48 offset:4096
v_mfma_f32_16x16x32_bf16 v[140:143], a[72:75], v[220:223], v[140:143]
s_cbranch_vccnz L_kt_t3_4
L_kt_r3_4:
v_mfma_f32_16x16x32_bf16 v[144:147], a[76:79], v[216:219], v[144:147]
ds_read_b64_tr_b16 a[60:61], v49 offset:0
ds_read_b64_tr_b16 a[62:63], v49 offset:4096
v_mfma_f32_16x16x32_bf16 v[148:151], a[76:79], v[220:223], v[148:151]
buffer_load_dwordx4 a[20:23], v1, s[12:15], s38 offen offset:2048 sc1
v_mfma_f32_16x16x32_bf16 v[152:155], a[96:99], v[224:227], v[152:155]
s_waitcnt lgkmcnt(6)
ds_read_b64_tr_b16 a[64:65], v50 offset:0
ds_read_b64_tr_b16 a[66:67], v50 offset:4096
v_mfma_f32_16x16x32_bf16 v[156:159], a[96:99], v[228:231], v[156:159]
v_mfma_f32_16x16x32_bf16 v[88:91], a[48:51], v[224:227], v[88:91]
s_waitcnt lgkmcnt(6)
ds_read_b64_tr_b16 a[68:69], v51 offset:0
ds_read_b64_tr_b16 a[70:71], v51 offset:4096
v_mfma_f32_16x16x32_bf16 v[92:95], a[48:51], v[228:231], v[92:95]
buffer_load_dwordx4 a[24:27], v1, s[12:15], s37 offen offset:3072 sc1
v_mfma_f32_16x16x32_bf16 v[96:99], a[52:55], v[224:227], v[96:99]
s_waitcnt lgkmcnt(6)
ds_read_b64_tr_b16 a[72:73], v52 offset:0
ds_read_b64_tr_b16 a[74:75], v52 offset:4096
v_mfma_f32_16x16x32_bf16 v[100:103], a[52:55], v[228:231], v[100:103]
v_mfma_f32_16x16x32_bf16 v[104:107], a[56:59], v[224:227], v[104:107]
s_waitcnt lgkmcnt(6)
ds_read_b64_tr_b16 a[76:77], v53 offset:0
ds_read_b64_tr_b16 a[78:79], v53 offset:4096
v_mfma_f32_16x16x32_bf16 v[108:111], a[56:59], v[228:231], v[108:111]
v_mfma_f32_16x16x32_bf16 v[112:115], a[60:63], v[224:227], v[112:115]
s_waitcnt lgkmcnt(6)
v_mfma_f32_16x16x32_bf16 v[116:119], a[60:63], v[228:231], v[116:119]
buffer_load_dwordx4 a[28:31], v1, s[12:15], s38 offen offset:3072 sc1
v_mfma_f32_16x16x32_bf16 v[120:123], a[64:67], v[224:227], v[120:123]
s_waitcnt lgkmcnt(4)
ds_read_b64_tr_b16 a[48:49], v46 offset:8192
ds_read_b64_tr_b16 a[50:51], v46 offset:12288
v_mfma_f32_16x16x32_bf16 v[124:127], a[64:67], v[228:231], v[124:127]
s_add_u32 s37, s37, 4096
v_mfma_f32_16x16x32_bf16 v[128:131], a[68:71], v[224:227], v[128:131]
s_waitcnt lgkmcnt(4)
ds_read_b64_tr_b16 a[52:53], v47 offset:8192
ds_read_b64_tr_b16 a[54:55], v47 offset:12288
v_mfma_f32_16x16x32_bf16 v[132:135], a[68:71], v[228:231], v[132:135]
buffer_load_dwordx4 a[32:35], v1, s[12:15], s37 offen offset:0 sc1
v_mfma_f32_16x16x32_bf16 v[136:139], a[72:75], v[224:227], v[136:139]
s_waitcnt lgkmcnt(4)
ds_read_b64_tr_b16 a[56:57], v48 offset:8192
ds_read_b64_tr_b16 a[58:59], v48 offset:12288
v_mfma_f32_16x16x32_bf16 v[140:143], a[72:75], v[228:231], v[140:143]
v_mfma_f32_16x16x32_bf16 v[144:147], a[76:79], v[224:227], v[144:147]
s_add_u32 s38, s38, 4096
ds_read_b64_tr_b16 a[60:61], v49 offset:8192
ds_read_b64_tr_b16 a[62:63], v49 offset:12288
v_mfma_f32_16x16x32_bf16 v[148:151], a[76:79], v[228:231], v[148:151]
v_mfma_f32_16x16x32_bf16 v[152:155], a[100:103], v[232:235], v[152:155]
s_waitcnt lgkmcnt(6)
ds_read_b64_tr_b16 a[64:65], v50 offset:8192
ds_read_b64_tr_b16 a[66:67], v50 offset:12288
v_mfma_f32_16x16x32_bf16 v[156:159], a[100:103], v[236:239], v[156:159]
buffer_load_dwordx4 a[36:39], v1, s[12:15], s38 offen offset:0 sc1
v_mfma_f32_16x16x32_bf16 v[88:91], a[48:51], v[232:235], v[88:91]
s_waitcnt lgkmcnt(6)
ds_read_b64_tr_b16 a[68:69], v51 offset:8192
ds_read_b64_tr_b16 a[70:71], v51 offset:12288
v_mfma_f32_16x16x32_bf16 v[92:95], a[48:51], v[236:239], v[92:95]
s_lshl_b32 s91, s2, 2
s_add_u32 s91, s91, s3
s_lshl_b32 s91, s91, 10
v_mfma_f32_16x16x32_bf16 v[96:99], a[52:55], v[232:235], v[96:99]
s_waitcnt lgkmcnt(6)
ds_read_b64_tr_b16 a[72:73], v52 offset:8192
ds_read_b64_tr_b16 a[74:75], v52 offset:12288
v_mfma_f32_16x16x32_bf16 v[100:103], a[52:55], v[236:239], v[100:103]
buffer_load_dwordx4 a[40:43], v1, s[12:15], s37 offen offset:1024 sc1
v_mfma_f32_16x16x32_bf16 v[104:107], a[56:59], v[232:235], v[104:107]
s_waitcnt lgkmcnt(6)
ds_read_b64_tr_b16 a[76:77], v53 offset:8192
ds_read_b64_tr_b16 a[78:79], v53 offset:12288
v_mfma_f32_16x16x32_bf16 v[108:111], a[56:59], v[236:239], v[108:111]
s_add_u32 s91, s91, 122683392
v_mfma_f32_16x16x32_bf16 v[112:115], a[60:63], v[232:235], v[112:115]
s_waitcnt lgkmcnt(6)
v_mfma_f32_16x16x32_bf16 v[116:119], a[60:63], v[236:239], v[116:119]
s_waitcnt vmcnt(17)
v_max3_u32 v35, v240, v244, v248
v_max_u32 v35, v35, v252
v_mfma_f32_16x16x32_bf16 v[120:123], a[64:67], v[232:235], v[120:123]
s_waitcnt lgkmcnt(4)
ds_read_b64_tr_b16 a[48:49], v38 offset:16384
ds_read_b64_tr_b16 a[50:51], v38 offset:20480
v_mfma_f32_16x16x32_bf16 v[124:127], a[64:67], v[236:239], v[124:127]
s_waitcnt vmcnt(11)
v_cmp_eq_u32 vcc, -1, v35
v_mfma_f32_16x16x32_bf16 v[128:131], a[68:71], v[232:235], v[128:131]
s_waitcnt lgkmcnt(4)
ds_read_b64_tr_b16 a[52:53], v39 offset:16384
ds_read_b64_tr_b16 a[54:55], v39 offset:20480
buffer_store_dword a248, v17, s[12:15], s91 offen offset:0 sc1
v_mfma_f32_16x16x32_bf16 v[132:135], a[68:71], v[236:239], v[132:135]
buffer_load_dwordx4 a[44:47], v1, s[12:15], s38 offen offset:1024 sc1
v_mfma_f32_16x16x32_bf16 v[136:139], a[72:75], v[232:235], v[136:139]
s_waitcnt lgkmcnt(4)
ds_read_b64_tr_b16 a[56:57], v40 offset:16384
ds_read_b64_tr_b16 a[58:59], v40 offset:20480
v_mfma_f32_16x16x32_bf16 v[140:143], a[72:75], v[236:239], v[140:143]
s_cbranch_vccnz L_kt_t3_6
L_kt_r3_6:
s_lshl_b32 s72, s33, 15
s_sub_u32 s91, s91, s72
v_mfma_f32_16x16x32_bf16 v[144:147], a[76:79], v[232:235], v[144:147]
ds_read_b64_tr_b16 a[60:61], v41 offset:16384
ds_read_b64_tr_b16 a[62:63], v41 offset:20480
v_mfma_f32_16x16x32_bf16 v[148:151], a[76:79], v[236:239], v[148:151]
s_barrier
v_mfma_f32_16x16x32_bf16 v[152:155], a[104:107], v[240:243], v[152:155]
s_waitcnt lgkmcnt(6)
ds_read_b64_tr_b16 a[64:65], v42 offset:16384
ds_read_b64_tr_b16 a[66:67], v42 offset:20480
buffer_load_dwordx4 a[216:219], v1, s[12:15], s37 offen offset:2048 sc1
v_mfma_f32_16x16x32_bf16 v[156:159], a[104:107], v[244:247], v[156:159]
ds_read_b64_tr_b16 a[80:81], v62 offset:0
ds_read_b64_tr_b16 a[82:83], v62 offset:512
v_mfma_f32_16x16x32_bf16 v[88:91], a[48:51], v[240:243], v[88:91]
s_waitcnt lgkmcnt(8)
ds_read_b64_tr_b16 a[68:69], v43 offset:16384
ds_read_b64_tr_b16 a[70:71], v43 offset:20480
v_mfma_f32_16x16x32_bf16 v[92:95], a[48:51], v[244:247], v[92:95]
buffer_load_dwordx4 a[220:223], v1, s[12:15], s38 offen offset:2048 sc1
v_mfma_f32_16x16x32_bf16 v[96:99], a[52:55], v[240:243], v[96:99]
s_waitcnt lgkmcnt(8)
ds_read_b64_tr_b16 a[72:73], v44 offset:16384
ds_read_b64_tr_b16 a[74:75], v44 offset:20480
v_mfma_f32_16x16x32_bf16 v[100:103], a[52:55], v[244:247], v[100:103]
ds_read_b64_tr_b16 a[84:85], v62 offset:1024
ds_read_b64_tr_b16 a[86:87], v62 offset:1536
v_mfma_f32_16x16x32_bf16 v[104:107], a[56:59], v[240:243], v[104:107]
s_waitcnt lgkmcnt(10)
ds_read_b64_tr_b16 a[76:77], v45 offset:16384
ds_read_b64_tr_b16 a[78:79], v45 offset:20480
v_mfma_f32_16x16x32_bf16 v[108:111], a[56:59], v[244:247], v[108:111]
buffer_load_dwordx4 a[224:227], v1, s[12:15], s37 offen offset:3072 sc1
v_mfma_f32_16x16x32_bf16 v[112:115], a[60:63], v[240:243], v[112:115]
s_waitcnt lgkmcnt(10)
ds_read_b64_tr_b16 a[88:89], v62 offset:2048
ds_read_b64_tr_b16 a[90:91], v62 offset:2560
v_mfma_f32_16x16x32_bf16 v[116:119], a[60:63], v[244:247], v[116:119]
ds_read_b64_tr_b16 a[92:93], v62 offset:3072
ds_read_b64_tr_b16 a[94:95], v62 offset:3584
v_mfma_f32_16x16x32_bf16 v[120:123], a[64:67], v[240:243], v[120:123]
s_waitcnt lgkmcnt(10)
ds_read_b64_tr_b16 a[48:49], v38 offset:24576
ds_read_b64_tr_b16 a[50:51], v38 offset:28672
v_mfma_f32_16x16x32_bf16 v[124:127], a[64:67], v[244:247], v[124:127]
v_and_b32 v7, 3, v0
v_lshlrev_b32 v7, 15, v7
v_mfma_f32_16x16x32_bf16 v[128:131], a[68:71], v[240:243], v[128:131]
s_waitcnt lgkmcnt(10)
ds_read_b64_tr_b16 a[52:53], v39 offset:24576
ds_read_b64_tr_b16 a[54:55], v39 offset:28672
v_mfma_f32_16x16x32_bf16 v[132:135], a[68:71], v[244:247], v[132:135]
buffer_load_dwordx4 a[228:231], v1, s[12:15], s38 offen offset:3072 sc1
v_mfma_f32_16x16x32_bf16 v[136:139], a[72:75], v[240:243], v[136:139]
s_waitcnt lgkmcnt(8)
ds_read_b64_tr_b16 a[56:57], v40 offset:24576
ds_read_b64_tr_b16 a[58:59], v40 offset:28672
v_mfma_f32_16x16x32_bf16 v[140:143], a[72:75], v[244:247], v[140:143]
s_add_u32 s37, s37, 4096
s_add_u32 s91, s91, 0
v_mfma_f32_16x16x32_bf16 v[144:147], a[76:79], v[240:243], v[144:147]
ds_read_b64_tr_b16 a[60:61], v41 offset:24576
ds_read_b64_tr_b16 a[62:63], v41 offset:28672
v_mfma_f32_16x16x32_bf16 v[148:151], a[76:79], v[244:247], v[148:151]
buffer_load_dwordx4 a[232:235], v1, s[12:15], s37 offen offset:0 sc1
v_mfma_f32_16x16x32_bf16 v[152:155], a[108:111], v[248:251], v[152:155]
s_waitcnt lgkmcnt(6)
ds_read_b64_tr_b16 a[64:65], v42 offset:24576
ds_read_b64_tr_b16 a[66:67], v42 offset:28672
v_mfma_f32_16x16x32_bf16 v[156:159], a[108:111], v[252:255], v[156:159]
v_mfma_f32_16x16x32_bf16 v[88:91], a[48:51], v[248:251], v[88:91]
s_waitcnt lgkmcnt(6)
ds_read_b64_tr_b16 a[68:69], v43 offset:24576
ds_read_b64_tr_b16 a[70:71], v43 offset:28672
v_mfma_f32_16x16x32_bf16 v[92:95], a[48:51], v[252:255], v[92:95]
s_add_u32 s38, s38, 4096
v_mfma_f32_16x16x32_bf16 v[96:99], a[52:55], v[248:251], v[96:99]
s_waitcnt lgkmcnt(6)
ds_read_b64_tr_b16 a[72:73], v44 offset:24576
ds_read_b64_tr_b16 a[74:75], v44 offset:28672
v_mfma_f32_16x16x32_bf16 v[100:103], a[52:55], v[252:255], v[100:103]
buffer_load_dwordx4 a[236:239], v1, s[12:15], s38 offen offset:0 sc1
v_mfma_f32_16x16x32_bf16 v[104:107], a[56:59], v[248:251], v[104:107]
s_waitcnt lgkmcnt(6)
ds_read_b64_tr_b16 a[76:77], v45 offset:24576
ds_read_b64_tr_b16 a[78:79], v45 offset:28672
v_mfma_f32_16x16x32_bf16 v[108:111], a[56:59], v[252:255], v[108:111]
s_waitcnt vmcnt(15)
v_accvgpr_read_b32 v35, a0
v_accvgpr_read_b32 v36, a4
v_mfma_f32_16x16x32_bf16 v[112:115], a[60:63], v[248:251], v[112:115]
s_waitcnt lgkmcnt(6)
v_accvgpr_read_b32 v37, a8
v_accvgpr_read_b32 v74, a12
v_mfma_f32_16x16x32_bf16 v[116:119], a[60:63], v[252:255], v[116:119]
buffer_load_dwordx4 a[240:243], v1, s[12:15], s37 offen offset:1024 sc1
v_mfma_f32_16x16x32_bf16 v[120:123], a[64:67], v[248:251], v[120:123]
s_waitcnt lgkmcnt(4)
ds_read_b64_tr_b16 a[48:49], v46 offset:16384
ds_read_b64_tr_b16 a[50:51], v46 offset:20480
v_mfma_f32_16x16x32_bf16 v[124:127], a[64:67], v[252:255], v[124:127]
v_max3_u32 v35, v35, v36, v37
v_max_u32 v35, v35, v74
v_mfma_f32_16x16x32_bf16 v[128:131], a[68:71], v[248:251], v[128:131]
s_waitcnt lgkmcnt(4)
ds_read_b64_tr_b16 a[52:53], v47 offset:16384
ds_read_b64_tr_b16 a[54:55], v47 offset:20480
v_mfma_f32_16x16x32_bf16 v[132:135], a[68:71], v[252:255], v[132:135]
v_cmp_eq_u32 vcc, -1, v35
v_mfma_f32_16x16x32_bf16 v[136:139], a[72:75], v[248:251], v[136:139]
s_waitcnt lgkmcnt(4)
ds_read_b64_tr_b16 a[56:57], v48 offset:16384
ds_read_b64_tr_b16 a[58:59], v48 offset:20480
v_mfma_f32_16x16x32_bf16 v[140:143], a[72:75], v[252:255], v[140:143]
s_cbranch_vccnz L_kt_t3_8
L_kt_r3_8:
v_mfma_f32_16x16x32_bf16 v[144:147], a[76:79], v[248:251], v[144:147]
ds_read_b64_tr_b16 a[60:61], v49 offset:16384
ds_read_b64_tr_b16 a[62:63], v49 offset:20480
v_mfma_f32_16x16x32_bf16 v[148:151], a[76:79], v[252:255], v[148:151]
buffer_load_dwordx4 a[244:247], v1, s[12:15], s38 offen offset:1024 sc1
v_mfma_f32_16x16x32_bf16 v[152:155], a[112:115], a[0:3], v[152:155]
s_waitcnt lgkmcnt(6)
ds_read_b64_tr_b16 a[64:65], v50 offset:16384
ds_read_b64_tr_b16 a[66:67], v50 offset:20480
v_mfma_f32_16x16x32_bf16 v[156:159], a[112:115], a[4:7], v[156:159]
s_add_u32 s52, s80, 0
s_add_u32 m0, s49, 131072
v_mfma_f32_16x16x32_bf16 v[88:91], a[48:51], a[0:3], v[88:91]
s_waitcnt lgkmcnt(6)
ds_read_b64_tr_b16 a[68:69], v51 offset:16384
ds_read_b64_tr_b16 a[70:71], v51 offset:20480
v_mfma_f32_16x16x32_bf16 v[92:95], a[48:51], a[4:7], v[92:95]
buffer_load_dwordx4 v2, s[92:95], s52 offen lds
v_mfma_f32_16x16x32_bf16 v[96:99], a[52:55], a[0:3], v[96:99]
s_waitcnt lgkmcnt(6)
ds_read_b64_tr_b16 a[72:73], v52 offset:16384
ds_read_b64_tr_b16 a[74:75], v52 offset:20480
v_mfma_f32_16x16x32_bf16 v[100:103], a[52:55], a[4:7], v[100:103]
s_add_u32 s52, s80, 4608
s_add_u32 m0, s49, 132096
v_mfma_f32_16x16x32_bf16 v[104:107], a[56:59], a[0:3], v[104:107]
s_waitcnt lgkmcnt(6)
ds_read_b64_tr_b16 a[76:77], v53 offset:16384
ds_read_b64_tr_b16 a[78:79], v53 offset:20480
v_mfma_f32_16x16x32_bf16 v[108:111], a[56:59], a[4:7], v[108:111]
buffer_load_dwordx4 v3, s[92:95], s52 offen lds
v_mfma_f32_16x16x32_bf16 v[112:115], a[60:63], a[0:3], v[112:115]
s_waitcnt lgkmcnt(6)
v_mfma_f32_16x16x32_bf16 v[116:119], a[60:63], a[4:7], v[116:119]
s_add_u32 s52, s80, 36864
s_add_u32 m0, s49, 139264
v_mfma_f32_16x16x32_bf16 v[120:123], a[64:67], a[0:3], v[120:123]
s_waitcnt lgkmcnt(4)
ds_read_b64_tr_b16 a[48:49], v46 offset:24576
ds_read_b64_tr_b16 a[50:51], v46 offset:28672
v_mfma_f32_16x16x32_bf16 v[124:127], a[64:67], a[4:7], v[124:127]
buffer_load_dwordx4 v2, s[92:95], s52 offen lds
v_mfma_f32_16x16x32_bf16 v[128:131], a[68:71], a[0:3], v[128:131]
s_waitcnt lgkmcnt(4)
ds_read_b64_tr_b16 a[52:53], v47 offset:24576
ds_read_b64_tr_b16 a[54:55], v47 offset:28672
v_mfma_f32_16x16x32_bf16 v[132:135], a[68:71], a[4:7], v[132:135]
v_mfma_f32_16x16x32_bf16 v[136:139], a[72:75], a[0:3], v[136:139]
s_waitcnt lgkmcnt(4)
ds_read_b64_tr_b16 a[56:57], v48 offset:24576
ds_read_b64_tr_b16 a[58:59], v48 offset:28672
v_mfma_f32_16x16x32_bf16 v[140:143], a[72:75], a[4:7], v[140:143]
s_add_u32 s52, s80, 41472
s_add_u32 m0, s49, 140288
v_mfma_f32_16x16x32_bf16 v[144:147], a[76:79], a[0:3], v[144:147]
ds_read_b64_tr_b16 a[60:61], v49 offset:24576
ds_read_b64_tr_b16 a[62:63], v49 offset:28672
v_mfma_f32_16x16x32_bf16 v[148:151], a[76:79], a[4:7], v[148:151]
s_barrier
v_mfma_f32_16x16x32_bf16 v[152:155], a[116:119], a[8:11], v[152:155]
s_waitcnt lgkmcnt(6)
ds_read_b64_tr_b16 a[64:65], v50 offset:24576
ds_read_b64_tr_b16 a[66:67], v50 offset:28672
v_mfma_f32_16x16x32_bf16 v[156:159], a[116:119], a[12:15], v[156:159]
buffer_load_dwordx4 v3, s[92:95], s52 offen lds
v_mfma_f32_16x16x32_bf16 v[88:91], a[48:51], a[8:11], v[88:91]
s_waitcnt lgkmcnt(6)
ds_read_b64_tr_b16 a[68:69], v51 offset:24576
ds_read_b64_tr_b16 a[70:71], v51 offset:28672
v_mfma_f32_16x16x32_bf16 v[92:95], a[48:51], a[12:15], v[92:95]
s_add_u32 s52, s80, 73728
s_add_u32 m0, s49, 0
ds_read_b64_tr_b16 a[96:97], v62 offset:4096
v_mfma_f32_16x16x32_bf16 v[96:99], a[52:55], a[8:11], v[96:99]
s_waitcnt lgkmcnt(7)
ds_read_b64_tr_b16 a[72:73], v52 offset:24576
ds_read_b64_tr_b16 a[74:75], v52 offset:28672
v_mfma_f32_16x16x32_bf16 v[100:103], a[52:55], a[12:15], v[100:103]
buffer_load_dwordx4 v2, s[92:95], s52 offen lds
v_mfma_f32_16x16x32_bf16 v[104:107], a[56:59], a[8:11], v[104:107]
s_waitcnt lgkmcnt(7)
ds_read_b64_tr_b16 a[76:77], v53 offset:24576
ds_read_b64_tr_b16 a[78:79], v53 offset:28672
v_mfma_f32_16x16x32_bf16 v[108:111], a[56:59], a[12:15], v[108:111]
s_waitcnt vmcnt(18)
s_add_u32 s52, s80, 78336
v_accvgpr_read_b32 v35, a16
v_mfma_f32_16x16x32_bf16 v[112:115], a[60:63], a[8:11], v[112:115]
s_waitcnt lgkmcnt(7)
s_add_u32 m0, s49, 1024
v_accvgpr_read_b32 v36, a20
v_mfma_f32_16x16x32_bf16 v[116:119], a[60:63], a[12:15], v[116:119]
v_accvgpr_read_b32 v37, a24
v_accvgpr_read_b32 v74, a28
v_mfma_f32_16x16x32_bf16 v[120:123], a[64:67], a[8:11], v[120:123]
s_waitcnt lgkmcnt(5)
ds_read_b64_tr_b16 a[48:49], v38 offset:32768
ds_read_b64_tr_b16 a[50:51], v38 offset:36864
v_mfma_f32_16x16x32_bf16 v[124:127], a[64:67], a[12:15], v[124:127]
buffer_load_dwordx4 v3, s[92:95], s52 offen lds
v_mfma_f32_16x16x32_bf16 v[128:131], a[68:71], a[8:11], v[128:131]
s_waitcnt lgkmcnt(4)
ds_read_b64_tr_b16 a[52:53], v39 offset:32768
ds_read_b64_tr_b16 a[54:55], v39 offset:36864
v_mfma_f32_16x16x32_bf16 v[132:135], a[68:71], a[12:15], v[132:135]
v_max3_u32 v35, v35, v36, v37
s_add_u32 s52, s80, 110592
v_mfma_f32_16x16x32_bf16 v[136:139], a[72:75], a[8:11], v[136:139]
s_waitcnt lgkmcnt(4)
ds_read_b64_tr_b16 a[56:57], v40 offset:32768
ds_read_b64_tr_b16 a[58:59], v40 offset:36864
v_mfma_f32_16x16x32_bf16 v[140:143], a[72:75], a[12:15], v[140:143]
v_max_u32 v35, v35, v74
s_add_u32 m0, s49, 8192
v_cmp_eq_u32 vcc, -1, v35
v_mfma_f32_16x16x32_bf16 v[144:147], a[76:79], a[8:11], v[144:147]
ds_read_b64_tr_b16 a[60:61], v41 offset:32768
ds_read_b64_tr_b16 a[62:63], v41 offset:36864
buffer_load_dwordx4 v2, s[92:95], s52 offen lds
v_mfma_f32_16x16x32_bf16 v[148:151], a[76:79], a[12:15], v[148:151]
s_cbranch_vccnz L_kt_t3_10
L_kt_r3_10:
s_add_u32 s52, s80, 115200
s_add_u32 m0, s49, 9216
v_mfma_f32_16x16x32_bf16 v[152:155], a[120:123], a[16:19], v[152:155]
s_waitcnt lgkmcnt(6)
ds_read_b64_tr_b16 a[64:65], v42 offset:32768
ds_read_b64_tr_b16 a[66:67], v42 offset:36864
v_mfma_f32_16x16x32_bf16 v[156:159], a[120:123], a[20:23], v[156:159]
buffer_load_dword v8, v7, s[12:15], s91 offen sc1
v_mfma_f32_16x16x32_bf16 v[88:91], a[48:51], a[16:19], v[88:91]
s_waitcnt lgkmcnt(6)
ds_read_b64_tr_b16 a[68:69], v43 offset:32768
ds_read_b64_tr_b16 a[70:71], v43 offset:36864
v_mfma_f32_16x16x32_bf16 v[92:95], a[48:51], a[20:23], v[92:95]
buffer_load_dwordx4 v3, s[92:95], s52 offen lds
v_mfma_f32_16x16x32_bf16 v[96:99], a[52:55], a[16:19], v[96:99]
s_waitcnt lgkmcnt(6)
ds_read_b64_tr_b16 a[72:73], v44 offset:32768
ds_read_b64_tr_b16 a[74:75], v44 offset:36864
v_mfma_f32_16x16x32_bf16 v[100:103], a[52:55], a[20:23], v[100:103]
s_add_u32 s52, s83, s84
s_add_u32 m0, s50, 0
ds_read_b64_tr_b16 a[98:99], v62 offset:4608
v_mfma_f32_16x16x32_bf16 v[104:107], a[56:59], a[16:19], v[104:107]
s_waitcnt lgkmcnt(7)
ds_read_b64_tr_b16 a[76:77], v45 offset:32768
ds_read_b64_tr_b16 a[78:79], v45 offset:36864
v_mfma_f32_16x16x32_bf16 v[108:111], a[56:59], a[20:23], v[108:111]
buffer_load_dwordx4 v6, s[92:95], s52 offen lds
v_mfma_f32_16x16x32_bf16 v[112:115], a[60:63], a[16:19], v[112:115]
s_waitcnt lgkmcnt(7)
s_add_u32 s52, s81, 0
s_add_u32 m0, s49, 65536
v_mfma_f32_16x16x32_bf16 v[116:119], a[60:63], a[20:23], v[116:119]
ds_read_b64_tr_b16 a[100:101], v62 offset:5120
ds_read_b64_tr_b16 a[102:103], v62 offset:5632
v_mfma_f32_16x16x32_bf16 v[120:123], a[64:67], a[16:19], v[120:123]
s_waitcnt lgkmcnt(7)
ds_read_b64_tr_b16 a[48:49], v38 offset:40960
ds_read_b64_tr_b16 a[50:51], v38 offset:45056
v_mfma_f32_16x16x32_bf16 v[124:127], a[64:67], a[20:23], v[124:127]
buffer_load_dwordx4 v2, s[92:95], s52 offen lds
v_mfma_f32_16x16x32_bf16 v[128:131], a[68:71], a[16:19], v[128:131]
s_waitcnt lgkmcnt(7)
ds_read_b64_tr_b16 a[52:53], v39 offset:40960
ds_read_b64_tr_b16 a[54:55], v39 offset:45056
v_mfma_f32_16x16x32_bf16 v[132:135], a[68:71], a[20:23], v[132:135]
s_add_u32 s52, s81, 4608
s_add_u32 m0, s49, 66560
ds_read_b64_tr_b16 a[104:105], v62 offset:6144
v_mfma_f32_16x16x32_bf16 v[136:139], a[72:75], a[16:19], v[136:139]
s_waitcnt lgkmcnt(7)
ds_read_b64_tr_b16 a[56:57], v40 offset:40960
ds_read_b64_tr_b16 a[58:59], v40 offset:45056
v_mfma_f32_16x16x32_bf16 v[140:143], a[72:75], a[20:23], v[140:143]
buffer_load_dwordx4 v3, s[92:95], s52 offen lds
v_mfma_f32_16x16x32_bf16 v[144:147], a[76:79], a[16:19], v[144:147]
ds_read_b64_tr_b16 a[60:61], v41 offset:40960
ds_read_b64_tr_b16 a[62:63], v41 offset:45056
v_mfma_f32_16x16x32_bf16 v[148:151], a[76:79], a[20:23], v[148:151]
ds_read_b64_tr_b16 a[106:107], v62 offset:6656
ds_read_b64_tr_b16 a[108:109], v62 offset:7168
v_mfma_f32_16x16x32_bf16 v[152:155], a[124:127], a[24:27], v[152:155]
s_waitcnt lgkmcnt(9)
ds_read_b64_tr_b16 a[64:65], v42 offset:40960
ds_read_b64_tr_b16 a[66:67], v42 offset:45056
v_mfma_f32_16x16x32_bf16 v[156:159], a[124:127], a[28:31], v[156:159]
s_add_u32 s52, s81, 36864
s_add_u32 m0, s49, 73728
ds_read_b64_tr_b16 a[110:111], v62 offset:7680
v_mfma_f32_16x16x32_bf16 v[88:91], a[48:51], a[24:27], v[88:91]
s_waitcnt lgkmcnt(10)
ds_read_b64_tr_b16 a[68:69], v43 offset:40960
ds_read_b64_tr_b16 a[70:71], v43 offset:45056
v_mfma_f32_16x16x32_bf16 v[92:95], a[48:51], a[28:31], v[92:95]
buffer_load_dwordx4 v2, s[92:95], s52 offen lds
v_mfma_f32_16x16x32_bf16 v[96:99], a[52:55], a[24:27], v[96:99]
s_waitcnt lgkmcnt(9)
ds_read_b64_tr_b16 a[72:73], v44 offset:40960
ds_read_b64_tr_b16 a[74:75], v44 offset:45056
v_mfma_f32_16x16x32_bf16 v[100:103], a[52:55], a[28:31], v[100:103]
s_add_u32 s52, s81, 41472
s_waitcnt vmcnt(21)
s_add_u32 m0, s49, 74752
v_mfma_f32_16x16x32_bf16 v[104:107], a[56:59], a[24:27], v[104:107]
s_waitcnt lgkmcnt(9)
ds_read_b64_tr_b16 a[76:77], v45 offset:40960
ds_read_b64_tr_b16 a[78:79], v45 offset:45056
v_mfma_f32_16x16x32_bf16 v[108:111], a[56:59], a[28:31], v[108:111]
v_accvgpr_read_b32 v35, a32
v_accvgpr_read_b32 v36, a36
v_mfma_f32_16x16x32_bf16 v[112:115], a[60:63], a[24:27], v[112:115]
s_waitcnt lgkmcnt(7)
v_accvgpr_read_b32 v37, a40
v_accvgpr_read_b32 v74, a44
v_mfma_f32_16x16x32_bf16 v[116:119], a[60:63], a[28:31], v[116:119]
buffer_load_dwordx4 v3, s[92:95], s52 offen lds
v_mfma_f32_16x16x32_bf16 v[120:123], a[64:67], a[24:27], v[120:123]
s_waitcnt lgkmcnt(4)
ds_read_b64_tr_b16 a[48:49], v46 offset:32768
ds_read_b64_tr_b16 a[50:51], v46 offset:36864
v_mfma_f32_16x16x32_bf16 v[124:127], a[64:67], a[28:31], v[124:127]
s_add_u32 s52, s81, 73728
v_max3_u32 v35, v35, v36, v37
s_add_u32 m0, s49, 16384
v_mfma_f32_16x16x32_bf16 v[128:131], a[68:71], a[24:27], v[128:131]
s_waitcnt lgkmcnt(4)
ds_read_b64_tr_b16 a[52:53], v47 offset:32768
ds_read_b64_tr_b16 a[54:55], v47 offset:36864
v_mfma_f32_16x16x32_bf16 v[132:135], a[68:71], a[28:31], v[132:135]
v_max_u32 v35, v35, v74
v_cmp_eq_u32 vcc, -1, v35
v_mfma_f32_16x16x32_bf16 v[136:139], a[72:75], a[24:27], v[136:139]
s_waitcnt lgkmcnt(4)
ds_read_b64_tr_b16 a[56:57], v48 offset:32768
ds_read_b64_tr_b16 a[58:59], v48 offset:36864
v_mfma_f32_16x16x32_bf16 v[140:143], a[72:75], a[28:31], v[140:143]
buffer_load_dwordx4 v2, s[92:95], s52 offen lds
v_mfma_f32_16x16x32_bf16 v[144:147], a[76:79], a[24:27], v[144:147]
s_cbranch_vccnz L_kt_t3_12
L_kt_r3_12:
ds_read_b64_tr_b16 a[60:61], v49 offset:32768
ds_read_b64_tr_b16 a[62:63], v49 offset:36864
v_mfma_f32_16x16x32_bf16 v[148:151], a[76:79], a[28:31], v[148:151]
s_barrier
v_mfma_f32_16x16x32_bf16 v[152:155], a[128:131], a[32:35], v[152:155]
s_waitcnt lgkmcnt(6)
ds_read_b64_tr_b16 a[64:65], v50 offset:32768
ds_read_b64_tr_b16 a[66:67], v50 offset:36864
v_mfma_f32_16x16x32_bf16 v[156:159], a[128:131], a[36:39], v[156:159]
s_add_u32 s52, s81, 78336
s_add_u32 m0, s49, 17408
ds_read_b64_tr_b16 a[112:113], v62 offset:8192
v_mfma_f32_16x16x32_bf16 v[88:91], a[48:51], a[32:35], v[88:91]
s_waitcnt lgkmcnt(7)
ds_read_b64_tr_b16 a[68:69], v51 offset:32768
ds_read_b64_tr_b16 a[70:71], v51 offset:36864
buffer_load_dwordx4 v3, s[92:95], s52 offen lds
v_mfma_f32_16x16x32_bf16 v[92:95], a[48:51], a[36:39], v[92:95]
s_add_u32 s52, s48, 0
s_add_u32 m0, s51, 4096
ds_read_b64_tr_b16 a[114:115], v62 offset:8704
v_mfma_f32_16x16x32_bf16 v[96:99], a[52:55], a[32:35], v[96:99]
s_waitcnt lgkmcnt(8)
ds_read_b64_tr_b16 a[72:73], v52 offset:32768
ds_read_b64_tr_b16 a[74:75], v52 offset:36864
v_mfma_f32_16x16x32_bf16 v[100:103], a[52:55], a[36:39], v[100:103]
buffer_load_dwordx4 v6, s[92:95], s52 offen lds
v_mfma_f32_16x16x32_bf16 v[104:107], a[56:59], a[32:35], v[104:107]
s_waitcnt lgkmcnt(8)
ds_read_b64_tr_b16 a[76:77], v53 offset:32768
ds_read_b64_tr_b16 a[78:79], v53 offset:36864
v_mfma_f32_16x16x32_bf16 v[108:111], a[56:59], a[36:39], v[108:111]
s_add_u32 s52, s81, 110592
s_add_u32 m0, s49, 24576
ds_read_b64_tr_b16 a[116:117], v62 offset:9216
v_mfma_f32_16x16x32_bf16 v[112:115], a[60:63], a[32:35], v[112:115]
s_waitcnt lgkmcnt(9)
ds_read_b64_tr_b16 a[118:119], v62 offset:9728
ds_read_b64_tr_b16 a[120:121], v62 offset:10240
v_mfma_f32_16x16x32_bf16 v[116:119], a[60:63], a[36:39], v[116:119]
buffer_load_dwordx4 v2, s[92:95], s52 offen lds
v_mfma_f32_16x16x32_bf16 v[120:123], a[64:67], a[32:35], v[120:123]
s_waitcnt lgkmcnt(8)
ds_read_b64_tr_b16 a[48:49], v38 offset:49152
ds_read_b64_tr_b16 a[50:51], v38 offset:53248
v_mfma_f32_16x16x32_bf16 v[124:127], a[64:67], a[36:39], v[124:127]
ds_read_b64_tr_b16 a[122:123], v62 offset:10752
ds_read_b64_tr_b16 a[124:125], v62 offset:11264
v_mfma_f32_16x16x32_bf16 v[128:131], a[68:71], a[32:35], v[128:131]
s_waitcnt lgkmcnt(9)
ds_read_b64_tr_b16 a[52:53], v39 offset:49152
ds_read_b64_tr_b16 a[54:55], v39 offset:53248
v_mfma_f32_16x16x32_bf16 v[132:135], a[68:71], a[36:39], v[132:135]
s_add_u32 s52, s81, 115200
s_add_u32 m0, s49, 25600
ds_read_b64_tr_b16 a[126:127], v62 offset:11776
v_mfma_f32_16x16x32_bf16 v[136:139], a[72:75], a[32:35], v[136:139]
s_waitcnt lgkmcnt(10)
ds_read_b64_tr_b16 a[56:57], v40 offset:49152
ds_read_b64_tr_b16 a[58:59], v40 offset:53248
v_mfma_f32_16x16x32_bf16 v[140:143], a[72:75], a[36:39], v[140:143]
buffer_load_dwordx4 v3, s[92:95], s52 offen lds
v_mfma_f32_16x16x32_bf16 v[144:147], a[76:79], a[32:35], v[144:147]
ds_read_b64_tr_b16 a[60:61], v41 offset:49152
ds_read_b64_tr_b16 a[62:63], v41 offset:53248
v_mfma_f32_16x16x32_bf16 v[148:151], a[76:79], a[36:39], v[148:151]
s_add_u32 s52, s82, 0
s_add_u32 m0, s49, 81920
v_mfma_f32_16x16x32_bf16 v[152:155], a[132:135], a[40:43], v[152:155]
s_waitcnt lgkmcnt(9)
ds_read_b64_tr_b16 a[64:65], v42 offset:49152
ds_read_b64_tr_b16 a[66:67], v42 offset:53248
v_mfma_f32_16x16x32_bf16 v[156:159], a[132:135], a[44:47], v[156:159]
buffer_load_dwordx4 v2, s[92:95], s52 offen lds
v_mfma_f32_16x16x32_bf16 v[88:91], a[48:51], a[40:43], v[88:91]
s_waitcnt lgkmcnt(7)
ds_read_b64_tr_b16 a[68:69], v43 offset:49152
ds_read_b64_tr_b16 a[70:71], v43 offset:53248
v_mfma_f32_16x16x32_bf16 v[92:95], a[48:51], a[44:47], v[92:95]
v_mfma_f32_16x16x32_bf16 v[96:99], a[52:55], a[40:43], v[96:99]
s_waitcnt lgkmcnt(6)
ds_read_b64_tr_b16 a[72:73], v44 offset:49152
ds_read_b64_tr_b16 a[74:75], v44 offset:53248
v_mfma_f32_16x16x32_bf16 v[100:103], a[52:55], a[44:47], v[100:103]
s_add_u32 s52, s82, 4608
s_add_u32 m0, s49, 82944
s_waitcnt vmcnt(24)
v_mfma_f32_16x16x32_bf16 v[104:107], a[56:59], a[40:43], v[104:107]
s_waitcnt lgkmcnt(6)
ds_read_b64_tr_b16 a[76:77], v45 offset:49152
ds_read_b64_tr_b16 a[78:79], v45 offset:53248
v_mfma_f32_16x16x32_bf16 v[108:111], a[56:59], a[44:47], v[108:111]
v_accvgpr_read_b32 v35, a216
v_accvgpr_read_b32 v36, a220
v_mfma_f32_16x16x32_bf16 v[112:115], a[60:63], a[40:43], v[112:115]
s_waitcnt lgkmcnt(6)
v_accvgpr_read_b32 v37, a224
v_accvgpr_read_b32 v74, a228
v_mfma_f32_16x16x32_bf16 v[116:119], a[60:63], a[44:47], v[116:119]
buffer_load_dwordx4 v3, s[92:95], s52 offen lds
v_mfma_f32_16x16x32_bf16 v[120:123], a[64:67], a[40:43], v[120:123]
s_waitcnt lgkmcnt(4)
ds_read_b64_tr_b16 a[48:49], v38 offset:57344
ds_read_b64_tr_b16 a[50:51], v38 offset:61440
v_mfma_f32_16x16x32_bf16 v[124:127], a[64:67], a[44:47], v[124:127]
s_add_u32 s52, s82, 36864
s_add_u32 m0, s49, 90112
v_max3_u32 v35, v35, v36, v37
v_mfma_f32_16x16x32_bf16 v[128:131], a[68:71], a[40:43], v[128:131]
s_waitcnt lgkmcnt(4)
ds_read_b64_tr_b16 a[52:53], v39 offset:57344
ds_read_b64_tr_b16 a[54:55], v39 offset:61440
v_mfma_f32_16x16x32_bf16 v[132:135], a[68:71], a[44:47], v[132:135]
v_max_u32 v35, v35, v74
v_cmp_eq_u32 vcc, -1, v35
v_mfma_f32_16x16x32_bf16 v[136:139], a[72:75], a[40:43], v[136:139]
s_waitcnt lgkmcnt(4)
ds_read_b64_tr_b16 a[56:57], v40 offset:57344
ds_read_b64_tr_b16 a[58:59], v40 offset:61440
buffer_load_dwordx4 v2, s[92:95], s52 offen lds
v_mfma_f32_16x16x32_bf16 v[140:143], a[72:75], a[44:47], v[140:143]
s_add_u32 s52, s82, 41472
s_cbranch_vccnz L_kt_t3_14
L_kt_r3_14:
s_add_u32 m0, s49, 91136
v_mfma_f32_16x16x32_bf16 v[144:147], a[76:79], a[40:43], v[144:147]
ds_read_b64_tr_b16 a[60:61], v41 offset:57344
ds_read_b64_tr_b16 a[62:63], v41 offset:61440
v_mfma_f32_16x16x32_bf16 v[148:151], a[76:79], a[44:47], v[148:151]
buffer_load_dwordx4 v3, s[92:95], s52 offen lds
v_mfma_f32_16x16x32_bf16 v[152:155], a[136:139], a[216:219], v[152:155]
s_waitcnt lgkmcnt(6)
ds_read_b64_tr_b16 a[64:65], v42 offset:57344
ds_read_b64_tr_b16 a[66:67], v42 offset:61440
v_mfma_f32_16x16x32_bf16 v[156:159], a[136:139], a[220:223], v[156:159]
s_add_u32 s52, s82, 73728
s_add_u32 m0, s49, 32768
v_mfma_f32_16x16x32_bf16 v[88:91], a[48:51], a[216:219], v[88:91]
s_waitcnt lgkmcnt(6)
ds_read_b64_tr_b16 a[68:69], v43 offset:57344
ds_read_b64_tr_b16 a[70:71], v43 offset:61440
v_mfma_f32_16x16x32_bf16 v[92:95], a[48:51], a[220:223], v[92:95]
buffer_load_dwordx4 v2, s[92:95], s52 offen lds
v_mfma_f32_16x16x32_bf16 v[96:99], a[52:55], a[216:219], v[96:99]
s_waitcnt lgkmcnt(6)
ds_read_b64_tr_b16 a[72:73], v44 offset:57344
ds_read_b64_tr_b16 a[74:75], v44 offset:61440
v_mfma_f32_16x16x32_bf16 v[100:103], a[52:55], a[220:223], v[100:103]
v_mfma_f32_16x16x32_bf16 v[104:107], a[56:59], a[216:219], v[104:107]
s_waitcnt lgkmcnt(6)
ds_read_b64_tr_b16 a[76:77], v45 offset:57344
ds_read_b64_tr_b16 a[78:79], v45 offset:61440
v_mfma_f32_16x16x32_bf16 v[108:111], a[56:59], a[220:223], v[108:111]
s_add_u32 s52, s82, 78336
s_add_u32 m0, s49, 33792
s_waitcnt vmcnt(24)
v_mfma_f32_16x16x32_bf16 v[112:115], a[60:63], a[216:219], v[112:115]
s_waitcnt lgkmcnt(6)
s_waitcnt vmcnt(16)
v_cmp_ne_u32 s[62:63], s60, v8
v_mfma_f32_16x16x32_bf16 v[116:119], a[60:63], a[220:223], v[116:119]
s_cmp_lg_u64 s[62:63], 0
s_cbranch_scc1 L_kt_ft2
L_kt_fr2:
v_accvgpr_read_b32 v35, a232
v_mfma_f32_16x16x32_bf16 v[120:123], a[64:67], a[216:219], v[120:123]
s_waitcnt lgkmcnt(4)
v_accvgpr_read_b32 v36, a236
v_accvgpr_read_b32 v37, a240
v_mfma_f32_16x16x32_bf16 v[124:127], a[64:67], a[220:223], v[124:127]
buffer_load_dwordx4 v3, s[92:95], s52 offen lds
v_mfma_f32_16x16x32_bf16 v[128:131], a[68:71], a[216:219], v[128:131]
s_waitcnt lgkmcnt(2)
s_add_u32 s52, s82, 110592
v_accvgpr_read_b32 v74, a244
v_mfma_f32_16x16x32_bf16 v[132:135], a[68:71], a[220:223], v[132:135]
s_add_u32 m0, s49, 40960
v_max3_u32 v35, v35, v36, v37
v_max_u32 v35, v35, v74
v_mfma_f32_16x16x32_bf16 v[136:139], a[72:75], a[216:219], v[136:139]
s_waitcnt lgkmcnt(0)
ds_read_b64_tr_b16 a[48:49], v46 offset:49152
ds_read_b64_tr_b16 a[50:51], v46 offset:53248
v_mfma_f32_16x16x32_bf16 v[140:143], a[72:75], a[220:223], v[140:143]
buffer_load_dwordx4 v2, s[92:95], s52 offen lds
v_mfma_f32_16x16x32_bf16 v[144:147], a[76:79], a[216:219], v[144:147]
s_add_u32 s52, s82, 115200
ds_read_b64_tr_b16 a[52:53], v47 offset:49152
ds_read_b64_tr_b16 a[54:55], v47 offset:53248
v_mfma_f32_16x16x32_bf16 v[148:151], a[76:79], a[220:223], v[148:151]
s_barrier
v_cmp_eq_u32 vcc, -1, v35
v_mfma_f32_16x16x32_bf16 v[152:155], a[140:143], a[224:227], v[152:155]
s_add_u32 m0, s49, 41984
ds_read_b64_tr_b16 a[56:57], v46 offset:57344
ds_read_b64_tr_b16 a[58:59], v46 offset:61440
v_mfma_f32_16x16x32_bf16 v[156:159], a[140:143], a[228:231], v[156:159]
s_cbranch_vccnz L_kt_t3_16
L_kt_r3_16:
s_mul_i32 s53, s36, 18432
s_add_u32 s53, s53, s76
v_mfma_f32_16x16x32_bf16 v[152:155], a[144:147], a[232:235], v[152:155]
s_lshl_b32 s54, s33, 9
ds_read_b64_tr_b16 a[60:61], v47 offset:57344
ds_read_b64_tr_b16 a[62:63], v47 offset:61440
v_mfma_f32_16x16x32_bf16 v[156:159], a[144:147], a[236:239], v[156:159]
buffer_load_dwordx4 v3, s[92:95], s52 offen lds
v_mfma_f32_16x16x32_bf16 v[152:155], a[148:151], a[240:243], v[152:155]
s_waitcnt lgkmcnt(6)
ds_read_b64_tr_b16 a[64:65], v46 offset:40960
ds_read_b64_tr_b16 a[66:67], v46 offset:45056
v_mfma_f32_16x16x32_bf16 v[156:159], a[148:151], a[244:247], v[156:159]
s_mul_i32 s85, s35, 18432
s_add_u32 s85, s85, s76
s_lshl_b32 s37, s41, 10
v_mfma_f32_16x16x32_bf16 v[88:91], a[48:51], a[224:227], v[88:91]
s_waitcnt lgkmcnt(6)
ds_read_b64_tr_b16 a[68:69], v47 offset:40960
ds_read_b64_tr_b16 a[70:71], v47 offset:45056
v_mfma_f32_16x16x32_bf16 v[92:95], a[48:51], a[228:231], v[92:95]
s_and_b32 s37, s37, 0x3000
s_add_u32 s55, s53, s54
s_add_u32 s37, s37, s85
v_mfma_f32_16x16x32_bf16 v[96:99], a[52:55], a[224:227], v[96:99]
s_waitcnt lgkmcnt(6)
ds_read_b64_tr_b16 a[72:73], v48 offset:49152
ds_read_b64_tr_b16 a[74:75], v48 offset:53248
buffer_load_dwordx4 v[224:227], v1, s[12:15], s37 offen offset:0 sc1
v_mfma_f32_16x16x32_bf16 v[100:103], a[52:55], a[228:231], v[100:103]
s_add_u32 s55, s55, 16384
s_lshl_b32 s54, s33, 12
s_add_u32 s53, s53, s54
v_mfma_f32_16x16x32_bf16 v[88:91], a[56:59], a[232:235], v[88:91]
s_waitcnt lgkmcnt(6)
ds_read_b64_tr_b16 a[76:77], v49 offset:49152
ds_read_b64_tr_b16 a[78:79], v49 offset:53248
v_mfma_f32_16x16x32_bf16 v[92:95], a[56:59], a[236:239], v[92:95]
s_add_u32 s54, s53, 18432
v_cvt_pk_bf16_f32 v152, v152, v153
v_cvt_pk_bf16_f32 v153, v154, v155
v_mfma_f32_16x16x32_bf16 v[96:99], a[60:63], a[232:235], v[96:99]
s_waitcnt lgkmcnt(6)
ds_read_b64_tr_b16 a[48:49], v48 offset:57344
ds_read_b64_tr_b16 a[50:51], v48 offset:61440
v_mfma_f32_16x16x32_bf16 v[100:103], a[60:63], a[236:239], v[100:103]
v_cvt_pk_bf16_f32 v154, v156, v157
s_add_u32 s38, s37, 18432
buffer_load_dwordx4 v[228:231], v1, s[12:15], s38 offen offset:0 sc1
v_mfma_f32_16x16x32_bf16 v[88:91], a[64:67], a[240:243], v[88:91]
s_waitcnt lgkmcnt(6)
ds_read_b64_tr_b16 a[52:53], v49 offset:57344
ds_read_b64_tr_b16 a[54:55], v49 offset:61440
v_mfma_f32_16x16x32_bf16 v[92:95], a[64:67], a[244:247], v[92:95]
v_cvt_pk_bf16_f32 v155, v158, v159
v_pk_max_i16 v152, v152, 0
v_mfma_f32_16x16x32_bf16 v[96:99], a[68:71], a[240:243], v[96:99]
s_waitcnt lgkmcnt(6)
ds_read_b64_tr_b16 a[56:57], v48 offset:40960
ds_read_b64_tr_b16 a[58:59], v48 offset:45056
v_mfma_f32_16x16x32_bf16 v[100:103], a[68:71], a[244:247], v[100:103]
v_pk_max_i16 v153, v153, 0
v_pk_max_i16 v154, v154, 0
v_mfma_f32_16x16x32_bf16 v[104:107], a[72:75], a[224:227], v[104:107]
s_waitcnt lgkmcnt(6)
ds_read_b64_tr_b16 a[60:61], v49 offset:40960
ds_read_b64_tr_b16 a[62:63], v49 offset:45056
buffer_load_dwordx4 v[232:235], v1, s[12:15], s37 offen offset:1024 sc1
v_mfma_f32_16x16x32_bf16 v[108:111], a[72:75], a[228:231], v[108:111]
v_pk_max_i16 v155, v155, 0
v_permlane32_swap_b32 v152, v154
v_mfma_f32_16x16x32_bf16 v[112:115], a[76:79], a[224:227], v[112:115]
s_waitcnt lgkmcnt(6)
ds_read_b64_tr_b16 a[64:65], v50 offset:49152
ds_read_b64_tr_b16 a[66:67], v50 offset:53248
v_mfma_f32_16x16x32_bf16 v[116:119], a[76:79], a[228:231], v[116:119]
v_permlane32_swap_b32 v153, v155
buffer_store_dwordx4 v[152:155], v11, s[12:15], s55 offen sc1
v_mfma_f32_16x16x32_bf16 v[104:107], a[48:51], a[232:235], v[104:107]
s_waitcnt lgkmcnt(6)
ds_read_b64_tr_b16 a[68:69], v51 offset:49152
ds_read_b64_tr_b16 a[70:71], v51 offset:53248
v_mfma_f32_16x16x32_bf16 v[108:111], a[48:51], a[236:239], v[108:111]
buffer_load_dwordx4 v[236:239], v1, s[12:15], s38 offen offset:1024 sc1
v_cvt_pk_bf16_f32 v192, v88, v89
v_cvt_pk_bf16_f32 v193, v90, v91
v_mfma_f32_16x16x32_bf16 v[112:115], a[52:55], a[232:235], v[112:115]
s_waitcnt lgkmcnt(6)
ds_read_b64_tr_b16 a[72:73], v50 offset:57344
ds_read_b64_tr_b16 a[74:75], v50 offset:61440
v_mfma_f32_16x16x32_bf16 v[116:119], a[52:55], a[236:239], v[116:119]
v_cvt_pk_bf16_f32 v194, v96, v97
v_cvt_pk_bf16_f32 v195, v98, v99
v_mfma_f32_16x16x32_bf16 v[104:107], a[56:59], a[240:243], v[104:107]
s_waitcnt lgkmcnt(6)
ds_read_b64_tr_b16 a[76:77], v51 offset:57344
ds_read_b64_tr_b16 a[78:79], v51 offset:61440
v_mfma_f32_16x16x32_bf16 v[108:111], a[56:59], a[244:247], v[108:111]
v_pk_max_i16 v192, v192, 0
v_pk_max_i16 v193, v193, 0
v_mfma_f32_16x16x32_bf16 v[112:115], a[60:63], a[240:243], v[112:115]
s_waitcnt lgkmcnt(6)
ds_read_b64_tr_b16 a[48:49], v50 offset:40960
ds_read_b64_tr_b16 a[50:51], v50 offset:45056
v_mfma_f32_16x16x32_bf16 v[116:119], a[60:63], a[244:247], v[116:119]
v_pk_max_i16 v194, v194, 0
v_pk_max_i16 v195, v195, 0
buffer_store_dwordx4 v[192:195], v1, s[12:15], s53 offen offset:0 sc1
v_mfma_f32_16x16x32_bf16 v[120:123], a[64:67], a[224:227], v[120:123]
s_waitcnt lgkmcnt(6)
ds_read_b64_tr_b16 a[52:53], v51 offset:40960
ds_read_b64_tr_b16 a[54:55], v51 offset:45056
v_mfma_f32_16x16x32_bf16 v[124:127], a[64:67], a[228:231], v[124:127]
v_cvt_pk_bf16_f32 v196, v92, v93
v_cvt_pk_bf16_f32 v197, v94, v95
v_mfma_f32_16x16x32_bf16 v[128:131], a[68:71], a[224:227], v[128:131]
s_waitcnt lgkmcnt(6)
ds_read_b64_tr_b16 a[56:57], v52 offset:49152
ds_read_b64_tr_b16 a[58:59], v52 offset:53248
v_mfma_f32_16x16x32_bf16 v[132:135], a[68:71], a[228:231], v[132:135]
v_cvt_pk_bf16_f32 v198, v100, v101
v_cvt_pk_bf16_f32 v199, v102, v103
v_mfma_f32_16x16x32_bf16 v[120:123], a[72:75], a[232:235], v[120:123]
s_waitcnt lgkmcnt(6)
ds_read_b64_tr_b16 a[60:61], v53 offset:49152
ds_read_b64_tr_b16 a[62:63], v53 offset:53248
v_mfma_f32_16x16x32_bf16 v[124:127], a[72:75], a[236:239], v[124:127]
v_pk_max_i16 v196, v196, 0
v_pk_max_i16 v197, v197, 0
v_mfma_f32_16x16x32_bf16 v[128:131], a[76:79], a[232:235], v[128:131]
s_waitcnt lgkmcnt(6)
ds_read_b64_tr_b16 a[64:65], v52 offset:57344
ds_read_b64_tr_b16 a[66:67], v52 offset:61440
v_mfma_f32_16x16x32_bf16 v[132:135], a[76:79], a[236:239], v[132:135]
v_pk_max_i16 v198, v198, 0
v_pk_max_i16 v199, v199, 0
buffer_store_dwordx4 v[196:199], v1, s[12:15], s54 offen offset:0 sc1
v_mfma_f32_16x16x32_bf16 v[120:123], a[48:51], a[240:243], v[120:123]
s_waitcnt lgkmcnt(6)
ds_read_b64_tr_b16 a[68:69], v53 offset:57344
ds_read_b64_tr_b16 a[70:71], v53 offset:61440
v_mfma_f32_16x16x32_bf16 v[124:127], a[48:51], a[244:247], v[124:127]
v_cvt_pk_bf16_f32 v200, v104, v105
v_cvt_pk_bf16_f32 v201, v106, v107
v_mfma_f32_16x16x32_bf16 v[128:131], a[52:55], a[240:243], v[128:131]
s_waitcnt lgkmcnt(6)
ds_read_b64_tr_b16 a[72:73], v52 offset:40960
ds_read_b64_tr_b16 a[74:75], v52 offset:45056
v_mfma_f32_16x16x32_bf16 v[132:135], a[52:55], a[244:247], v[132:135]
v_cvt_pk_bf16_f32 v202, v112, v113
v_cvt_pk_bf16_f32 v203, v114, v115
v_mfma_f32_16x16x32_bf16 v[136:139], a[56:59], a[224:227], v[136:139]
s_waitcnt lgkmcnt(6)
ds_read_b64_tr_b16 a[76:77], v53 offset:40960
ds_read_b64_tr_b16 a[78:79], v53 offset:45056
v_mfma_f32_16x16x32_bf16 v[140:143], a[56:59], a[228:231], v[140:143]
v_pk_max_i16 v200, v200, 0
v_pk_max_i16 v201, v201, 0
v_mfma_f32_16x16x32_bf16 v[144:147], a[60:63], a[224:227], v[144:147]
s_waitcnt lgkmcnt(6)
v_pk_max_i16 v202, v202, 0
v_pk_max_i16 v203, v203, 0
buffer_store_dwordx4 v[200:203], v1, s[12:15], s53 offen offset:1024 sc1
v_mfma_f32_16x16x32_bf16 v[148:151], a[60:63], a[228:231], v[148:151]
v_cvt_pk_bf16_f32 v204, v108, v109
v_cvt_pk_bf16_f32 v205, v110, v111
v_mfma_f32_16x16x32_bf16 v[136:139], a[64:67], a[232:235], v[136:139]
s_waitcnt lgkmcnt(4)
v_cvt_pk_bf16_f32 v206, v116, v117
v_cvt_pk_bf16_f32 v207, v118, v119
v_mfma_f32_16x16x32_bf16 v[140:143], a[64:67], a[236:239], v[140:143]
v_pk_max_i16 v204, v204, 0
v_pk_max_i16 v205, v205, 0
v_mfma_f32_16x16x32_bf16 v[144:147], a[68:71], a[232:235], v[144:147]
s_waitcnt lgkmcnt(2)
ds_read_b64_tr_b16 a[48:49], v54 offset:0
ds_read_b64_tr_b16 a[50:51], v54 offset:4096
v_mfma_f32_16x16x32_bf16 v[148:151], a[68:71], a[236:239], v[148:151]
v_pk_max_i16 v206, v206, 0
v_pk_max_i16 v207, v207, 0
buffer_store_dwordx4 v[204:207], v1, s[12:15], s54 offen offset:1024 sc1
v_mfma_f32_16x16x32_bf16 v[136:139], a[72:75], a[240:243], v[136:139]
s_waitcnt lgkmcnt(2)
ds_read_b64_tr_b16 a[52:53], v55 offset:0
ds_read_b64_tr_b16 a[54:55], v55 offset:4096
v_mfma_f32_16x16x32_bf16 v[140:143], a[72:75], a[244:247], v[140:143]
v_cvt_pk_bf16_f32 v208, v120, v121
v_cvt_pk_bf16_f32 v209, v122, v123
v_mfma_f32_16x16x32_bf16 v[144:147], a[76:79], a[240:243], v[144:147]
ds_read_b64_tr_b16 a[56:57], v54 offset:8192
ds_read_b64_tr_b16 a[58:59], v54 offset:12288
v_mfma_f32_16x16x32_bf16 v[148:151], a[76:79], a[244:247], v[148:151]
s_waitcnt vmcnt(26)
s_barrier
v_mfma_f32_16x16x32_bf16 v[152:155], a[80:83], v[160:163], 0
ds_read_b64_tr_b16 a[60:61], v55 offset:8192
ds_read_b64_tr_b16 a[62:63], v55 offset:12288
v_mfma_f32_16x16x32_bf16 v[156:159], a[80:83], v[164:167], 0
v_cvt_pk_bf16_f32 v210, v128, v129
v_cvt_pk_bf16_f32 v211, v130, v131
v_mfma_f32_16x16x32_bf16 v[152:155], a[84:87], v[168:171], v[152:155]
s_waitcnt lgkmcnt(6)
ds_read_b64_tr_b16 a[64:65], v56 offset:0
ds_read_b64_tr_b16 a[66:67], v56 offset:4096
v_mfma_f32_16x16x32_bf16 v[156:159], a[84:87], v[172:175], v[156:159]
v_pk_max_i16 v208, v208, 0
v_pk_max_i16 v209, v209, 0
v_mfma_f32_16x16x32_bf16 v[88:91], a[48:51], v[160:163], 0
s_waitcnt lgkmcnt(6)
ds_read_b64_tr_b16 a[68:69], v57 offset:0
ds_read_b64_tr_b16 a[70:71], v57 offset:4096
v_mfma_f32_16x16x32_bf16 v[92:95], a[48:51], v[164:167], 0
v_pk_max_i16 v210, v210, 0
v_pk_max_i16 v211, v211, 0
buffer_store_dwordx4 v[208:211], v1, s[12:15], s53 offen offset:2048 sc1
v_mfma_f32_16x16x32_bf16 v[96:99], a[52:55], v[160:163], 0
s_waitcnt lgkmcnt(6)
ds_read_b64_tr_b16 a[72:73], v56 offset:8192
ds_read_b64_tr_b16 a[74:75], v56 offset:12288
v_mfma_f32_16x16x32_bf16 v[100:103], a[52:55], v[164:167], 0
v_cvt_pk_bf16_f32 v212, v124, v125
v_cvt_pk_bf16_f32 v213, v126, v127
v_mfma_f32_16x16x32_bf16 v[88:91], a[56:59], v[168:171], v[88:91]
s_waitcnt lgkmcnt(6)
ds_read_b64_tr_b16 a[76:77], v57 offset:8192
ds_read_b64_tr_b16 a[78:79], v57 offset:12288
v_mfma_f32_16x16x32_bf16 v[92:95], a[56:59], v[172:175], v[92:95]
v_cvt_pk_bf16_f32 v214, v132, v133
v_cvt_pk_bf16_f32 v215, v134, v135
v_mfma_f32_16x16x32_bf16 v[96:99], a[60:63], v[168:171], v[96:99]
s_waitcnt lgkmcnt(6)
ds_read_b64_tr_b16 a[48:49], v58 offset:0
ds_read_b64_tr_b16 a[50:51], v58 offset:4096
v_mfma_f32_16x16x32_bf16 v[100:103], a[60:63], v[172:175], v[100:103]
v_pk_max_i16 v212, v212, 0
v_pk_max_i16 v213, v213, 0
v_mfma_f32_16x16x32_bf16 v[104:107], a[64:67], v[160:163], 0
s_waitcnt lgkmcnt(6)
ds_read_b64_tr_b16 a[52:53], v59 offset:0
ds_read_b64_tr_b16 a[54:55], v59 offset:4096
v_mfma_f32_16x16x32_bf16 v[108:111], a[64:67], v[164:167], 0
v_pk_max_i16 v214, v214, 0
v_pk_max_i16 v215, v215, 0
buffer_store_dwordx4 v[212:215], v1, s[12:15], s54 offen offset:2048 sc1
v_mfma_f32_16x16x32_bf16 v[112:115], a[68:71], v[160:163], 0
s_waitcnt lgkmcnt(6)
ds_read_b64_tr_b16 a[56:57], v58 offset:8192
ds_read_b64_tr_b16 a[58:59], v58 offset:12288
v_mfma_f32_16x16x32_bf16 v[116:119], a[68:71], v[164:167], 0
v_cvt_pk_bf16_f32 v216, v136, v137
v_cvt_pk_bf16_f32 v217, v138, v139
v_mfma_f32_16x16x32_bf16 v[104:107], a[72:75], v[168:171], v[104:107]
s_waitcnt lgkmcnt(6)
ds_read_b64_tr_b16 a[60:61], v59 offset:8192
ds_read_b64_tr_b16 a[62:63], v59 offset:12288
v_mfma_f32_16x16x32_bf16 v[108:111], a[72:75], v[172:175], v[108:111]
v_cvt_pk_bf16_f32 v218, v144, v145
v_cvt_pk_bf16_f32 v219, v146, v147
v_mfma_f32_16x16x32_bf16 v[112:115], a[76:79], v[168:171], v[112:115]
s_waitcnt lgkmcnt(6)
ds_read_b64_tr_b16 a[64:65], v60 offset:0
ds_read_b64_tr_b16 a[66:67], v60 offset:4096
v_mfma_f32_16x16x32_bf16 v[116:119], a[76:79], v[172:175], v[116:119]
v_pk_max_i16 v216, v216, 0
v_pk_max_i16 v217, v217, 0
v_mfma_f32_16x16x32_bf16 v[120:123], a[48:51], v[160:163], 0
s_waitcnt lgkmcnt(6)
ds_read_b64_tr_b16 a[68:69], v61 offset:0
ds_read_b64_tr_b16 a[70:71], v61 offset:4096
v_mfma_f32_16x16x32_bf16 v[124:127], a[48:51], v[164:167], 0
v_pk_max_i16 v218, v218, 0
v_pk_max_i16 v219, v219, 0
buffer_store_dwordx4 v[216:219], v1, s[12:15], s53 offen offset:3072 sc1
v_mfma_f32_16x16x32_bf16 v[128:131], a[52:55], v[160:163], 0
s_waitcnt lgkmcnt(6)
ds_read_b64_tr_b16 a[72:73], v60 offset:8192
ds_read_b64_tr_b16 a[74:75], v60 offset:12288
v_mfma_f32_16x16x32_bf16 v[132:135], a[52:55], v[164:167], 0
v_cvt_pk_bf16_f32 v220, v140, v141
v_cvt_pk_bf16_f32 v221, v142, v143
v_mfma_f32_16x16x32_bf16 v[120:123], a[56:59], v[168:171], v[120:123]
s_waitcnt lgkmcnt(6)
ds_read_b64_tr_b16 a[76:77], v61 offset:8192
ds_read_b64_tr_b16 a[78:79], v61 offset:12288
v_mfma_f32_16x16x32_bf16 v[124:127], a[56:59], v[172:175], v[124:127]
v_cvt_pk_bf16_f32 v222, v148, v149
v_cvt_pk_bf16_f32 v223, v150, v151
v_mfma_f32_16x16x32_bf16 v[128:131], a[60:63], v[168:171], v[128:131]
s_waitcnt lgkmcnt(6)
v_pk_max_i16 v220, v220, 0
v_pk_max_i16 v221, v221, 0
v_mfma_f32_16x16x32_bf16 v[132:135], a[60:63], v[172:175], v[132:135]
v_pk_max_i16 v222, v222, 0
v_pk_max_i16 v223, v223, 0
buffer_store_dwordx4 v[220:223], v1, s[12:15], s54 offen offset:3072 sc1
v_mfma_f32_16x16x32_bf16 v[136:139], a[64:67], v[160:163], 0
s_waitcnt lgkmcnt(4)
ds_read_b64_tr_b16 a[48:49], v38 offset:0
ds_read_b64_tr_b16 a[50:51], v38 offset:4096
v_mfma_f32_16x16x32_bf16 v[140:143], a[64:67], v[164:167], 0
ds_read_b64_tr_b16 a[128:129], v62 offset:0
ds_read_b64_tr_b16 a[130:131], v62 offset:512
v_mfma_f32_16x16x32_bf16 v[144:147], a[68:71], v[160:163], 0
s_waitcnt lgkmcnt(6)
ds_read_b64_tr_b16 a[52:53], v39 offset:0
ds_read_b64_tr_b16 a[54:55], v39 offset:4096
v_mfma_f32_16x16x32_bf16 v[148:151], a[68:71], v[164:167], 0
ds_read_b64_tr_b16 a[132:133], v62 offset:1024
ds_read_b64_tr_b16 a[134:135], v62 offset:1536
v_mfma_f32_16x16x32_bf16 v[136:139], a[72:75], v[168:171], v[136:139]
s_waitcnt lgkmcnt(8)
ds_read_b64_tr_b16 a[56:57], v40 offset:0
ds_read_b64_tr_b16 a[58:59], v40 offset:4096
v_mfma_f32_16x16x32_bf16 v[140:143], a[72:75], v[172:175], v[140:143]
ds_read_b64_tr_b16 a[136:137], v62 offset:2048
ds_read_b64_tr_b16 a[138:139], v62 offset:2560
v_mfma_f32_16x16x32_bf16 v[144:147], a[76:79], v[168:171], v[144:147]
ds_read_b64_tr_b16 a[60:61], v41 offset:0
ds_read_b64_tr_b16 a[62:63], v41 offset:4096
v_mfma_f32_16x16x32_bf16 v[148:151], a[76:79], v[172:175], v[148:151]
ds_read_b64_tr_b16 a[140:141], v62 offset:3072
ds_read_b64_tr_b16 a[142:143], v62 offset:3584
v_mfma_f32_16x16x32_bf16 v[152:155], a[88:91], v[176:179], v[152:155]
s_waitcnt lgkmcnt(14)
ds_read_b64_tr_b16 a[64:65], v42 offset:0
ds_read_b64_tr_b16 a[66:67], v42 offset:4096
v_mfma_f32_16x16x32_bf16 v[156:159], a[88:91], v[180:183], v[156:159]
v_mfma_f32_16x16x32_bf16 v[88:91], a[48:51], v[176:179], v[88:91]
s_waitcnt lgkmcnt(12)
ds_read_b64_tr_b16 a[68:69], v43 offset:0
ds_read_b64_tr_b16 a[70:71], v43 offset:4096
v_mfma_f32_16x16x32_bf16 v[92:95], a[48:51], v[180:183], v[92:95]
v_mfma_f32_16x16x32_bf16 v[96:99], a[52:55], v[176:179], v[96:99]
s_waitcnt lgkmcnt(10)
ds_read_b64_tr_b16 a[72:73], v44 offset:0
ds_read_b64_tr_b16 a[74:75], v44 offset:4096
v_mfma_f32_16x16x32_bf16 v[100:103], a[52:55], v[180:183], v[100:103]
v_mfma_f32_16x16x32_bf16 v[104:107], a[56:59], v[176:179], v[104:107]
s_waitcnt lgkmcnt(8)
ds_read_b64_tr_b16 a[76:77], v45 offset:0
ds_read_b64_tr_b16 a[78:79], v45 offset:4096
v_mfma_f32_16x16x32_bf16 v[108:111], a[56:59], v[180:183], v[108:111]
v_mfma_f32_16x16x32_bf16 v[112:115], a[60:63], v[176:179], v[112:115]
s_waitcnt lgkmcnt(6)
v_mfma_f32_16x16x32_bf16 v[116:119], a[60:63], v[180:183], v[116:119]
buffer_load_dwordx4 v[240:243], v1, s[12:15], s37 offen offset:2048 sc1
v_mfma_f32_16x16x32_bf16 v[120:123], a[64:67], v[176:179], v[120:123]
s_waitcnt lgkmcnt(4)
ds_read_b64_tr_b16 a[48:49], v38 offset:8192
ds_read_b64_tr_b16 a[50:51], v38 offset:12288
v_mfma_f32_16x16x32_bf16 v[124:127], a[64:67], v[180:183], v[124:127]
v_mfma_f32_16x16x32_bf16 v[128:131], a[68:71], v[176:179], v[128:131]
s_waitcnt lgkmcnt(4)
ds_read_b64_tr_b16 a[52:53], v39 offset:8192
ds_read_b64_tr_b16 a[54:55], v39 offset:12288
v_mfma_f32_16x16x32_bf16 v[132:135], a[68:71], v[180:183], v[132:135]
v_mfma_f32_16x16x32_bf16 v[136:139], a[72:75], v[176:179], v[136:139]
s_waitcnt lgkmcnt(4)
ds_read_b64_tr_b16 a[56:57], v40 offset:8192
ds_read_b64_tr_b16 a[58:59], v40 offset:12288
v_mfma_f32_16x16x32_bf16 v[140:143], a[72:75], v[180:183], v[140:143]
buffer_load_dwordx4 v[244:247], v1, s[12:15], s38 offen offset:2048 sc1
v_mfma_f32_16x16x32_bf16 v[144:147], a[76:79], v[176:179], v[144:147]
ds_read_b64_tr_b16 a[60:61], v41 offset:8192
ds_read_b64_tr_b16 a[62:63], v41 offset:12288
v_mfma_f32_16x16x32_bf16 v[148:151], a[76:79], v[180:183], v[148:151]
s_waitcnt vmcnt(25)
s_barrier
v_mfma_f32_16x16x32_bf16 v[152:155], a[92:95], v[184:187], v[152:155]
s_waitcnt lgkmcnt(6)
ds_read_b64_tr_b16 a[64:65], v42 offset:8192
ds_read_b64_tr_b16 a[66:67], v42 offset:12288
v_mfma_f32_16x16x32_bf16 v[156:159], a[92:95], v[188:191], v[156:159]
buffer_load_dwordx4 v[248:251], v1, s[12:15], s37 offen offset:3072 sc1
v_mfma_f32_16x16x32_bf16 v[88:91], a[48:51], v[184:187], v[88:91]
s_waitcnt lgkmcnt(6)
ds_read_b64_tr_b16 a[68:69], v43 offset:8192
ds_read_b64_tr_b16 a[70:71], v43 offset:12288
v_mfma_f32_16x16x32_bf16 v[92:95], a[48:51], v[188:191], v[92:95]
ds_read_b64_tr_b16 a[144:145], v62 offset:4096
ds_read_b64_tr_b16 a[146:147], v62 offset:4608
v_mfma_f32_16x16x32_bf16 v[96:99], a[52:55], v[184:187], v[96:99]
s_waitcnt lgkmcnt(8)
ds_read_b64_tr_b16 a[72:73], v44 offset:8192
ds_read_b64_tr_b16 a[74:75], v44 offset:12288
v_mfma_f32_16x16x32_bf16 v[100:103], a[52:55], v[188:191], v[100:103]
ds_read_b64_tr_b16 a[148:149], v62 offset:5120
ds_read_b64_tr_b16 a[150:151], v62 offset:5632
v_mfma_f32_16x16x32_bf16 v[104:107], a[56:59], v[184:187], v[104:107]
s_waitcnt lgkmcnt(10)
ds_read_b64_tr_b16 a[76:77], v45 offset:8192
ds_read_b64_tr_b16 a[78:79], v45 offset:12288
v_mfma_f32_16x16x32_bf16 v[108:111], a[56:59], v[188:191], v[108:111]
buffer_load_dwordx4 v[252:255], v1, s[12:15], s38 offen offset:3072 sc1
v_mfma_f32_16x16x32_bf16 v[112:115], a[60:63], v[184:187], v[112:115]
s_waitcnt lgkmcnt(10)
v_mfma_f32_16x16x32_bf16 v[116:119], a[60:63], v[188:191], v[116:119]
s_lshl_b32 s37, s41, 8
s_and_b32 s37, s37, 0x3000
s_add_u32 s37, s37, s85
v_mfma_f32_16x16x32_bf16 v[120:123], a[64:67], v[184:187], v[120:123]
s_waitcnt lgkmcnt(8)
ds_read_b64_tr_b16 a[48:49], v46 offset:0
ds_read_b64_tr_b16 a[50:51], v46 offset:4096
v_mfma_f32_16x16x32_bf16 v[124:127], a[64:67], v[188:191], v[124:127]
buffer_load_dwordx4 a[0:3], v1, s[12:15], s37 offen offset:0 sc1
v_mfma_f32_16x16x32_bf16 v[128:131], a[68:71], v[184:187], v[128:131]
s_waitcnt lgkmcnt(6)
ds_read_b64_tr_b16 a[52:53], v47 offset:0
ds_read_b64_tr_b16 a[54:55], v47 offset:4096
v_mfma_f32_16x16x32_bf16 v[132:135], a[68:71], v[188:191], v[132:135]
v_mfma_f32_16x16x32_bf16 v[136:139], a[72:75], v[184:187], v[136:139]
s_waitcnt lgkmcnt(4)
ds_read_b64_tr_b16 a[56:57], v48 offset:0
ds_read_b64_tr_b16 a[58:59], v48 offset:4096
v_mfma_f32_16x16x32_bf16 v[140:143], a[72:75], v[188:191], v[140:143]
s_add_u32 s38, s37, 18432
v_mfma_f32_16x16x32_bf16 v[144:147], a[76:79], v[184:187], v[144:147]
s_waitcnt vmcnt(16)
ds_read_b64_tr_b16 a[60:61], v49 offset:0
ds_read_b64_tr_b16 a[62:63], v49 offset:4096
v_mfma_f32_16x16x32_bf16 v[148:151], a[76:79], v[188:191], v[148:151]
buffer_load_dwordx4 a[4:7], v1, s[12:15], s38 offen offset:0 sc1
v_mfma_f32_16x16x32_bf16 v[152:155], a[96:99], v[224:227], v[152:155]
s_waitcnt lgkmcnt(6)
ds_read_b64_tr_b16 a[64:65], v50 offset:0
ds_read_b64_tr_b16 a[66:67], v50 offset:4096
v_mfma_f32_16x16x32_bf16 v[156:159], a[96:99], v[228:231], v[156:159]
v_mfma_f32_16x16x32_bf16 v[88:91], a[48:51], v[224:227], v[88:91]
s_waitcnt lgkmcnt(6)
ds_read_b64_tr_b16 a[68:69], v51 offset:0
ds_read_b64_tr_b16 a[70:71], v51 offset:4096
v_mfma_f32_16x16x32_bf16 v[92:95], a[48:51], v[228:231], v[92:95]
buffer_load_dwordx4 a[8:11], v1, s[12:15], s37 offen offset:1024 sc1
v_mfma_f32_16x16x32_bf16 v[96:99], a[52:55], v[224:227], v[96:99]
s_waitcnt lgkmcnt(6)
ds_read_b64_tr_b16 a[72:73], v52 offset:0
ds_read_b64_tr_b16 a[74:75], v52 offset:4096
v_mfma_f32_16x16x32_bf16 v[100:103], a[52:55], v[228:231], v[100:103]
v_mfma_f32_16x16x32_bf16 v[104:107], a[56:59], v[224:227], v[104:107]
s_waitcnt lgkmcnt(6)
ds_read_b64_tr_b16 a[76:77], v53 offset:0
ds_read_b64_tr_b16 a[78:79], v53 offset:4096
v_mfma_f32_16x16x32_bf16 v[108:111], a[56:59], v[228:231], v[108:111]
v_mfma_f32_16x16x32_bf16 v[112:115], a[60:63], v[224:227], v[112:115]
s_waitcnt lgkmcnt(6)
v_mfma_f32_16x16x32_bf16 v[116:119], a[60:63], v[228:231], v[116:119]
buffer_load_dwordx4 a[12:15], v1, s[12:15], s38 offen offset:1024 sc1
v_mfma_f32_16x16x32_bf16 v[120:123], a[64:67], v[224:227], v[120:123]
s_waitcnt lgkmcnt(4)
ds_read_b64_tr_b16 a[48:49], v46 offset:8192
ds_read_b64_tr_b16 a[50:51], v46 offset:12288
v_mfma_f32_16x16x32_bf16 v[124:127], a[64:67], v[228:231], v[124:127]
s_add_u32 s52, s83, 0
s_add_u32 m0, s49, 98304
v_mfma_f32_16x16x32_bf16 v[128:131], a[68:71], v[224:227], v[128:131]
s_waitcnt lgkmcnt(4)
ds_read_b64_tr_b16 a[52:53], v47 offset:8192
ds_read_b64_tr_b16 a[54:55], v47 offset:12288
v_mfma_f32_16x16x32_bf16 v[132:135], a[68:71], v[228:231], v[132:135]
buffer_load_dwordx4 v2, s[92:95], s52 offen lds
v_mfma_f32_16x16x32_bf16 v[136:139], a[72:75], v[224:227], v[136:139]
s_waitcnt lgkmcnt(4)
ds_read_b64_tr_b16 a[56:57], v48 offset:8192
ds_read_b64_tr_b16 a[58:59], v48 offset:12288
v_mfma_f32_16x16x32_bf16 v[140:143], a[72:75], v[228:231], v[140:143]
v_mfma_f32_16x16x32_bf16 v[144:147], a[76:79], v[224:227], v[144:147]
s_waitcnt vmcnt(17)
ds_read_b64_tr_b16 a[60:61], v49 offset:8192
ds_read_b64_tr_b16 a[62:63], v49 offset:12288
v_mfma_f32_16x16x32_bf16 v[148:151], a[76:79], v[228:231], v[148:151]
s_add_u32 s52, s83, 4608
s_add_u32 m0, s49, 99328
v_mfma_f32_16x16x32_bf16 v[152:155], a[100:103], v[232:235], v[152:155]
s_waitcnt lgkmcnt(6)
ds_read_b64_tr_b16 a[64:65], v50 offset:8192
ds_read_b64_tr_b16 a[66:67], v50 offset:12288
v_mfma_f32_16x16x32_bf16 v[156:159], a[100:103], v[236:239], v[156:159]
buffer_load_dwordx4 v3, s[92:95], s52 offen lds
v_mfma_f32_16x16x32_bf16 v[88:91], a[48:51], v[232:235], v[88:91]
s_waitcnt lgkmcnt(6)
ds_read_b64_tr_b16 a[68:69], v51 offset:8192
ds_read_b64_tr_b16 a[70:71], v51 offset:12288
v_mfma_f32_16x16x32_bf16 v[92:95], a[48:51], v[236:239], v[92:95]
s_lshl_b32 s91, s2, 2
s_add_u32 s91, s91, s3
s_lshl_b32 s91, s91, 10
v_mfma_f32_16x16x32_bf16 v[96:99], a[52:55], v[232:235], v[96:99]
s_waitcnt lgkmcnt(6)
ds_read_b64_tr_b16 a[72:73], v52 offset:8192
ds_read_b64_tr_b16 a[74:75], v52 offset:12288
v_mfma_f32_16x16x32_bf16 v[100:103], a[52:55], v[236:239], v[100:103]
buffer_load_dwordx4 a[16:19], v1, s[12:15], s37 offen offset:2048 sc1
v_mfma_f32_16x16x32_bf16 v[104:107], a[56:59], v[232:235], v[104:107]
s_waitcnt lgkmcnt(6)
ds_read_b64_tr_b16 a[76:77], v53 offset:8192
ds_read_b64_tr_b16 a[78:79], v53 offset:12288
v_mfma_f32_16x16x32_bf16 v[108:111], a[56:59], v[236:239], v[108:111]
s_add_u32 s91, s91, 122683392
v_mfma_f32_16x16x32_bf16 v[112:115], a[60:63], v[232:235], v[112:115]
s_waitcnt lgkmcnt(6)
v_mfma_f32_16x16x32_bf16 v[116:119], a[60:63], v[236:239], v[116:119]
v_mfma_f32_16x16x32_bf16 v[120:123], a[64:67], v[232:235], v[120:123]
s_waitcnt lgkmcnt(4)
ds_read_b64_tr_b16 a[48:49], v38 offset:16384
ds_read_b64_tr_b16 a[50:51], v38 offset:20480
v_mfma_f32_16x16x32_bf16 v[124:127], a[64:67], v[236:239], v[124:127]
s_waitcnt vmcnt(11)
v_mfma_f32_16x16x32_bf16 v[128:131], a[68:71], v[232:235], v[128:131]
s_waitcnt lgkmcnt(4)
ds_read_b64_tr_b16 a[52:53], v39 offset:16384
ds_read_b64_tr_b16 a[54:55], v39 offset:20480
buffer_store_dword a248, v17, s[12:15], s91 offen offset:64 sc1
v_mfma_f32_16x16x32_bf16 v[132:135], a[68:71], v[236:239], v[132:135]
buffer_load_dwordx4 a[20:23], v1, s[12:15], s38 offen offset:2048 sc1
v_mfma_f32_16x16x32_bf16 v[136:139], a[72:75], v[232:235], v[136:139]
s_waitcnt lgkmcnt(4)
ds_read_b64_tr_b16 a[56:57], v40 offset:16384
ds_read_b64_tr_b16 a[58:59], v40 offset:20480
v_mfma_f32_16x16x32_bf16 v[140:143], a[72:75], v[236:239], v[140:143]
buffer_load_dwordx4 a[24:27], v1, s[12:15], s37 offen offset:3072 sc1
v_mfma_f32_16x16x32_bf16 v[144:147], a[76:79], v[232:235], v[144:147]
s_waitcnt vmcnt(12)
ds_read_b64_tr_b16 a[60:61], v41 offset:16384
ds_read_b64_tr_b16 a[62:63], v41 offset:20480
v_mfma_f32_16x16x32_bf16 v[148:151], a[76:79], v[236:239], v[148:151]
s_barrier
v_mfma_f32_16x16x32_bf16 v[152:155], a[104:107], v[240:243], v[152:155]
s_waitcnt lgkmcnt(6)
ds_read_b64_tr_b16 a[64:65], v42 offset:16384
ds_read_b64_tr_b16 a[66:67], v42 offset:20480
buffer_store_dwordx4 a[212:215], v9, s[12:15], s100 offen offset:0 sc1
v_mfma_f32_16x16x32_bf16 v[156:159], a[104:107], v[244:247], v[156:159]
s_lshl_b32 s72, s33, 15
s_sub_u32 s91, s91, s72
v_and_b32 v7, 3, v0
v_mfma_f32_16x16x32_bf16 v[88:91], a[48:51], v[240:243], v[88:91]
s_waitcnt lgkmcnt(6)
ds_read_b64_tr_b16 a[68:69], v43 offset:16384
ds_read_b64_tr_b16 a[70:71], v43 offset:20480
v_mfma_f32_16x16x32_bf16 v[92:95], a[48:51], v[244:247], v[92:95]
buffer_load_dwordx4 a[28:31], v1, s[12:15], s38 offen offset:3072 sc1
v_mfma_f32_16x16x32_bf16 v[96:99], a[52:55], v[240:243], v[96:99]
s_waitcnt lgkmcnt(6)
ds_read_b64_tr_b16 a[72:73], v44 offset:16384
ds_read_b64_tr_b16 a[74:75], v44 offset:20480
v_mfma_f32_16x16x32_bf16 v[100:103], a[52:55], v[244:247], v[100:103]
s_lshl_b32 s37, s41, 6
s_and_b32 s37, s37, 0x3000
s_add_u32 s37, s37, s85
v_mfma_f32_16x16x32_bf16 v[104:107], a[56:59], v[240:243], v[104:107]
s_waitcnt lgkmcnt(6)
ds_read_b64_tr_b16 a[76:77], v45 offset:16384
ds_read_b64_tr_b16 a[78:79], v45 offset:20480
v_mfma_f32_16x16x32_bf16 v[108:111], a[56:59], v[244:247], v[108:111]
buffer_store_dwordx4 a[212:215], v9, s[12:15], s101 offen offset:0 sc1
v_mfma_f32_16x16x32_bf16 v[112:115], a[60:63], v[240:243], v[112:115]
s_waitcnt lgkmcnt(6)
v_lshlrev_b32 v7, 15, v7
s_add_u32 s91, s91, 64
v_mfma_f32_16x16x32_bf16 v[116:119], a[60:63], v[244:247], v[116:119]
buffer_load_dwordx4 a[32:35], v1, s[12:15], s37 offen offset:0 sc1
v_mfma_f32_16x16x32_bf16 v[120:123], a[64:67], v[240:243], v[120:123]
s_waitcnt lgkmcnt(4)
ds_read_b64_tr_b16 a[48:49], v38 offset:24576
ds_read_b64_tr_b16 a[50:51], v38 offset:28672
v_mfma_f32_16x16x32_bf16 v[124:127], a[64:67], v[244:247], v[124:127]
s_add_u32 s38, s37, 18432
v_mfma_f32_16x16x32_bf16 v[128:131], a[68:71], v[240:243], v[128:131]
s_waitcnt lgkmcnt(4)
ds_read_b64_tr_b16 a[52:53], v39 offset:24576
ds_read_b64_tr_b16 a[54:55], v39 offset:28672
v_mfma_f32_16x16x32_bf16 v[132:135], a[68:71], v[244:247], v[132:135]
buffer_store_dwordx4 a[212:215], v9, s[12:15], s100 offen offset:256 sc1
v_mfma_f32_16x16x32_bf16 v[136:139], a[72:75], v[240:243], v[136:139]
s_waitcnt lgkmcnt(4)
ds_read_b64_tr_b16 a[56:57], v40 offset:24576
ds_read_b64_tr_b16 a[58:59], v40 offset:28672
v_mfma_f32_16x16x32_bf16 v[140:143], a[72:75], v[244:247], v[140:143]
buffer_load_dwordx4 a[36:39], v1, s[12:15], s38 offen offset:0 sc1
v_mfma_f32_16x16x32_bf16 v[144:147], a[76:79], v[240:243], v[144:147]
s_waitcnt vmcnt(16)
ds_read_b64_tr_b16 a[60:61], v41 offset:24576
ds_read_b64_tr_b16 a[62:63], v41 offset:28672
v_mfma_f32_16x16x32_bf16 v[148:151], a[76:79], v[244:247], v[148:151]
s_add_u32 s52, s83, 36864
s_add_u32 m0, s49, 49152
v_mfma_f32_16x16x32_bf16 v[152:155], a[108:111], v[248:251], v[152:155]
s_waitcnt lgkmcnt(6)
ds_read_b64_tr_b16 a[64:65], v42 offset:24576
ds_read_b64_tr_b16 a[66:67], v42 offset:28672
v_mfma_f32_16x16x32_bf16 v[156:159], a[108:111], v[252:255], v[156:159]
buffer_load_dwordx4 v2, s[92:95], s52 offen lds
v_mfma_f32_16x16x32_bf16 v[88:91], a[48:51], v[248:251], v[88:91]
s_waitcnt lgkmcnt(6)
ds_read_b64_tr_b16 a[68:69], v43 offset:24576
ds_read_b64_tr_b16 a[70:71], v43 offset:28672
v_mfma_f32_16x16x32_bf16 v[92:95], a[48:51], v[252:255], v[92:95]
buffer_store_dwordx4 a[212:215], v9, s[12:15], s101 offen offset:256 sc1
v_mfma_f32_16x16x32_bf16 v[96:99], a[52:55], v[248:251], v[96:99]
s_waitcnt lgkmcnt(6)
ds_read_b64_tr_b16 a[72:73], v44 offset:24576
ds_read_b64_tr_b16 a[74:75], v44 offset:28672
v_mfma_f32_16x16x32_bf16 v[100:103], a[52:55], v[252:255], v[100:103]
s_add_u32 s52, s83, 41472
s_add_u32 m0, s49, 50176
v_mfma_f32_16x16x32_bf16 v[104:107], a[56:59], v[248:251], v[104:107]
s_waitcnt lgkmcnt(6)
ds_read_b64_tr_b16 a[76:77], v45 offset:24576
ds_read_b64_tr_b16 a[78:79], v45 offset:28672
v_mfma_f32_16x16x32_bf16 v[108:111], a[56:59], v[252:255], v[108:111]
buffer_load_dwordx4 v3, s[92:95], s52 offen lds
v_mfma_f32_16x16x32_bf16 v[112:115], a[60:63], v[248:251], v[112:115]
s_waitcnt lgkmcnt(6)
s_add_u32 s52, s83, 73728
s_add_u32 m0, s49, 57344
v_mfma_f32_16x16x32_bf16 v[116:119], a[60:63], v[252:255], v[116:119]
buffer_store_dwordx4 a[212:215], v9, s[12:15], s100 offen offset:512 sc1
v_mfma_f32_16x16x32_bf16 v[120:123], a[64:67], v[248:251], v[120:123]
s_waitcnt lgkmcnt(4)
ds_read_b64_tr_b16 a[48:49], v46 offset:16384
ds_read_b64_tr_b16 a[50:51], v46 offset:20480
v_mfma_f32_16x16x32_bf16 v[124:127], a[64:67], v[252:255], v[124:127]
buffer_load_dwordx4 v2, s[92:95], s52 offen lds
v_mfma_f32_16x16x32_bf16 v[128:131], a[68:71], v[248:251], v[128:131]
s_waitcnt lgkmcnt(4)
ds_read_b64_tr_b16 a[52:53], v47 offset:16384
ds_read_b64_tr_b16 a[54:55], v47 offset:20480
v_mfma_f32_16x16x32_bf16 v[132:135], a[68:71], v[252:255], v[132:135]
s_add_u32 s52, s83, 78336
s_add_u32 m0, s49, 58368
v_mfma_f32_16x16x32_bf16 v[136:139], a[72:75], v[248:251], v[136:139]
s_waitcnt lgkmcnt(4)
ds_read_b64_tr_b16 a[56:57], v48 offset:16384
ds_read_b64_tr_b16 a[58:59], v48 offset:20480
v_mfma_f32_16x16x32_bf16 v[140:143], a[72:75], v[252:255], v[140:143]
buffer_load_dwordx4 v3, s[92:95], s52 offen lds
v_mfma_f32_16x16x32_bf16 v[144:147], a[76:79], v[248:251], v[144:147]
s_waitcnt vmcnt(20)
ds_read_b64_tr_b16 a[60:61], v49 offset:16384
ds_read_b64_tr_b16 a[62:63], v49 offset:20480
v_mfma_f32_16x16x32_bf16 v[148:151], a[76:79], v[252:255], v[148:151]
buffer_store_dwordx4 a[212:215], v9, s[12:15], s101 offen offset:512 sc1
v_mfma_f32_16x16x32_bf16 v[152:155], a[112:115], a[0:3], v[152:155]
s_waitcnt lgkmcnt(6)
ds_read_b64_tr_b16 a[64:65], v50 offset:16384
ds_read_b64_tr_b16 a[66:67], v50 offset:20480
v_mfma_f32_16x16x32_bf16 v[156:159], a[112:115], a[4:7], v[156:159]
s_add_u32 s52, s83, 110592
s_add_u32 m0, s49, 114688
v_mfma_f32_16x16x32_bf16 v[88:91], a[48:51], a[0:3], v[88:91]
s_waitcnt lgkmcnt(6)
ds_read_b64_tr_b16 a[68:69], v51 offset:16384
ds_read_b64_tr_b16 a[70:71], v51 offset:20480
v_mfma_f32_16x16x32_bf16 v[92:95], a[48:51], a[4:7], v[92:95]
buffer_load_dwordx4 v2, s[92:95], s52 offen lds
v_mfma_f32_16x16x32_bf16 v[96:99], a[52:55], a[0:3], v[96:99]
s_waitcnt lgkmcnt(6)
ds_read_b64_tr_b16 a[72:73], v52 offset:16384
ds_read_b64_tr_b16 a[74:75], v52 offset:20480
v_mfma_f32_16x16x32_bf16 v[100:103], a[52:55], a[4:7], v[100:103]
s_add_u32 s52, s83, 115200
s_add_u32 m0, s49, 115712
v_mfma_f32_16x16x32_bf16 v[104:107], a[56:59], a[0:3], v[104:107]
s_waitcnt lgkmcnt(6)
ds_read_b64_tr_b16 a[76:77], v53 offset:16384
ds_read_b64_tr_b16 a[78:79], v53 offset:20480
v_mfma_f32_16x16x32_bf16 v[108:111], a[56:59], a[4:7], v[108:111]
buffer_store_dwordx4 a[212:215], v9, s[12:15], s100 offen offset:768 sc1
v_mfma_f32_16x16x32_bf16 v[112:115], a[60:63], a[0:3], v[112:115]
s_waitcnt lgkmcnt(6)
v_mfma_f32_16x16x32_bf16 v[116:119], a[60:63], a[4:7], v[116:119]
buffer_load_dwordx4 v3, s[92:95], s52 offen lds
v_mfma_f32_16x16x32_bf16 v[120:123], a[64:67], a[0:3], v[120:123]
s_waitcnt lgkmcnt(4)
ds_read_b64_tr_b16 a[48:49], v46 offset:24576
ds_read_b64_tr_b16 a[50:51], v46 offset:28672
v_mfma_f32_16x16x32_bf16 v[124:127], a[64:67], a[4:7], v[124:127]
buffer_load_dwordx4 a[40:43], v1, s[12:15], s37 offen offset:1024 sc1
v_mfma_f32_16x16x32_bf16 v[128:131], a[68:71], a[0:3], v[128:131]
s_waitcnt lgkmcnt(4)
ds_read_b64_tr_b16 a[52:53], v47 offset:24576
ds_read_b64_tr_b16 a[54:55], v47 offset:28672
v_mfma_f32_16x16x32_bf16 v[132:135], a[68:71], a[4:7], v[132:135]
buffer_store_dwordx4 a[212:215], v9, s[12:15], s101 offen offset:768 sc1
v_mfma_f32_16x16x32_bf16 v[136:139], a[72:75], a[0:3], v[136:139]
s_waitcnt lgkmcnt(4)
ds_read_b64_tr_b16 a[56:57], v48 offset:24576
ds_read_b64_tr_b16 a[58:59], v48 offset:28672
v_mfma_f32_16x16x32_bf16 v[140:143], a[72:75], a[4:7], v[140:143]
v_mfma_f32_16x16x32_bf16 v[144:147], a[76:79], a[0:3], v[144:147]
s_waitcnt vmcnt(24)
ds_read_b64_tr_b16 a[60:61], v49 offset:24576
ds_read_b64_tr_b16 a[62:63], v49 offset:28672
v_mfma_f32_16x16x32_bf16 v[148:151], a[76:79], a[4:7], v[148:151]
s_waitcnt vmcnt(22)
s_barrier
v_mfma_f32_16x16x32_bf16 v[152:155], a[116:119], a[8:11], v[152:155]
s_waitcnt lgkmcnt(6)
ds_read_b64_tr_b16 a[64:65], v50 offset:24576
ds_read_b64_tr_b16 a[66:67], v50 offset:28672
v_mfma_f32_16x16x32_bf16 v[156:159], a[116:119], a[12:15], v[156:159]
buffer_load_dwordx4 a[44:47], v1, s[12:15], s38 offen offset:1024 sc1
v_mfma_f32_16x16x32_bf16 v[88:91], a[48:51], a[8:11], v[88:91]
s_waitcnt lgkmcnt(6)
ds_read_b64_tr_b16 a[68:69], v51 offset:24576
ds_read_b64_tr_b16 a[70:71], v51 offset:28672
v_mfma_f32_16x16x32_bf16 v[92:95], a[48:51], a[12:15], v[92:95]
buffer_store_dwordx4 a[212:215], v10, s[12:15], s100 offen offset:1024 sc1
v_mfma_f32_16x16x32_bf16 v[96:99], a[52:55], a[8:11], v[96:99]
s_waitcnt lgkmcnt(6)
ds_read_b64_tr_b16 a[72:73], v52 offset:24576
ds_read_b64_tr_b16 a[74:75], v52 offset:28672
v_mfma_f32_16x16x32_bf16 v[100:103], a[52:55], a[12:15], v[100:103]
buffer_load_dwordx4 a[216:219], v1, s[12:15], s37 offen offset:2048 sc1
v_mfma_f32_16x16x32_bf16 v[104:107], a[56:59], a[8:11], v[104:107]
s_waitcnt lgkmcnt(6)
ds_read_b64_tr_b16 a[76:77], v53 offset:24576
ds_read_b64_tr_b16 a[78:79], v53 offset:28672
v_mfma_f32_16x16x32_bf16 v[108:111], a[56:59], a[12:15], v[108:111]
v_mfma_f32_16x16x32_bf16 v[112:115], a[60:63], a[8:11], v[112:115]
s_waitcnt lgkmcnt(6)
v_mfma_f32_16x16x32_bf16 v[116:119], a[60:63], a[12:15], v[116:119]
buffer_load_dwordx4 a[220:223], v1, s[12:15], s38 offen offset:2048 sc1
v_mfma_f32_16x16x32_bf16 v[120:123], a[64:67], a[8:11], v[120:123]
s_waitcnt lgkmcnt(4)
ds_read_b64_tr_b16 a[48:49], v38 offset:32768
ds_read_b64_tr_b16 a[50:51], v38 offset:36864
v_mfma_f32_16x16x32_bf16 v[124:127], a[64:67], a[12:15], v[124:127]
v_mfma_f32_16x16x32_bf16 v[128:131], a[68:71], a[8:11], v[128:131]
s_waitcnt lgkmcnt(4)
ds_read_b64_tr_b16 a[52:53], v39 offset:32768
ds_read_b64_tr_b16 a[54:55], v39 offset:36864
v_mfma_f32_16x16x32_bf16 v[132:135], a[68:71], a[12:15], v[132:135]
buffer_load_dwordx4 a[224:227], v1, s[12:15], s37 offen offset:3072 sc1
v_mfma_f32_16x16x32_bf16 v[136:139], a[72:75], a[8:11], v[136:139]
s_waitcnt lgkmcnt(4)
ds_read_b64_tr_b16 a[56:57], v40 offset:32768
ds_read_b64_tr_b16 a[58:59], v40 offset:36864
v_mfma_f32_16x16x32_bf16 v[140:143], a[72:75], a[12:15], v[140:143]
v_mfma_f32_16x16x32_bf16 v[144:147], a[76:79], a[8:11], v[144:147]
s_waitcnt vmcnt(24)
ds_read_b64_tr_b16 a[60:61], v41 offset:32768
ds_read_b64_tr_b16 a[62:63], v41 offset:36864
v_mfma_f32_16x16x32_bf16 v[148:151], a[76:79], a[12:15], v[148:151]
v_mfma_f32_16x16x32_bf16 v[152:155], a[120:123], a[16:19], v[152:155]
s_waitcnt lgkmcnt(6)
ds_read_b64_tr_b16 a[64:65], v42 offset:32768
ds_read_b64_tr_b16 a[66:67], v42 offset:36864
v_mfma_f32_16x16x32_bf16 v[156:159], a[120:123], a[20:23], v[156:159]
buffer_load_dword v8, v7, s[12:15], s91 offen sc1
v_mfma_f32_16x16x32_bf16 v[88:91], a[48:51], a[16:19], v[88:91]
s_waitcnt lgkmcnt(6)
ds_read_b64_tr_b16 a[68:69], v43 offset:32768
ds_read_b64_tr_b16 a[70:71], v43 offset:36864
v_mfma_f32_16x16x32_bf16 v[92:95], a[48:51], a[20:23], v[92:95]
buffer_load_dwordx4 a[228:231], v1, s[12:15], s38 offen offset:3072 sc1
v_mfma_f32_16x16x32_bf16 v[96:99], a[52:55], a[16:19], v[96:99]
s_waitcnt lgkmcnt(6)
ds_read_b64_tr_b16 a[72:73], v44 offset:32768
ds_read_b64_tr_b16 a[74:75], v44 offset:36864
v_mfma_f32_16x16x32_bf16 v[100:103], a[52:55], a[20:23], v[100:103]
s_add_u32 s52, s47, 0
s_add_u32 m0, s49, 122880
v_mfma_f32_16x16x32_bf16 v[104:107], a[56:59], a[16:19], v[104:107]
s_waitcnt lgkmcnt(6)
ds_read_b64_tr_b16 a[76:77], v45 offset:32768
ds_read_b64_tr_b16 a[78:79], v45 offset:36864
v_mfma_f32_16x16x32_bf16 v[108:111], a[56:59], a[20:23], v[108:111]
buffer_load_dwordx4 v2, s[92:95], s52 offen lds
v_mfma_f32_16x16x32_bf16 v[112:115], a[60:63], a[16:19], v[112:115]
s_waitcnt lgkmcnt(6)
s_add_u32 s52, s47, 4608
s_add_u32 m0, s49, 123904
v_mfma_f32_16x16x32_bf16 v[116:119], a[60:63], a[20:23], v[116:119]
v_mfma_f32_16x16x32_bf16 v[120:123], a[64:67], a[16:19], v[120:123]
s_waitcnt lgkmcnt(4)
ds_read_b64_tr_b16 a[48:49], v38 offset:40960
ds_read_b64_tr_b16 a[50:51], v38 offset:45056
v_mfma_f32_16x16x32_bf16 v[124:127], a[64:67], a[20:23], v[124:127]
buffer_load_dwordx4 v3, s[92:95], s52 offen lds
v_mfma_f32_16x16x32_bf16 v[128:131], a[68:71], a[16:19], v[128:131]
s_waitcnt lgkmcnt(4)
ds_read_b64_tr_b16 a[52:53], v39 offset:40960
ds_read_b64_tr_b16 a[54:55], v39 offset:45056
v_mfma_f32_16x16x32_bf16 v[132:135], a[68:71], a[20:23], v[132:135]
s_add_u32 s37, s85, 16384
v_mfma_f32_16x16x32_bf16 v[136:139], a[72:75], a[16:19], v[136:139]
s_waitcnt lgkmcnt(4)
ds_read_b64_tr_b16 a[56:57], v40 offset:40960
ds_read_b64_tr_b16 a[58:59], v40 offset:45056
v_mfma_f32_16x16x32_bf16 v[140:143], a[72:75], a[20:23], v[140:143]
buffer_load_dwordx4 a[232:235], v1, s[12:15], s37 offen offset:0 sc1
v_mfma_f32_16x16x32_bf16 v[144:147], a[76:79], a[16:19], v[144:147]
s_waitcnt vmcnt(26)
ds_read_b64_tr_b16 a[60:61], v41 offset:40960
ds_read_b64_tr_b16 a[62:63], v41 offset:45056
v_mfma_f32_16x16x32_bf16 v[148:151], a[76:79], a[20:23], v[148:151]
v_mfma_f32_16x16x32_bf16 v[152:155], a[124:127], a[24:27], v[152:155]
s_waitcnt lgkmcnt(6)
ds_read_b64_tr_b16 a[64:65], v42 offset:40960
ds_read_b64_tr_b16 a[66:67], v42 offset:45056
v_mfma_f32_16x16x32_bf16 v[156:159], a[124:127], a[28:31], v[156:159]
s_add_u32 s38, s37, 18432
v_mfma_f32_16x16x32_bf16 v[88:91], a[48:51], a[24:27], v[88:91]
s_waitcnt lgkmcnt(6)
ds_read_b64_tr_b16 a[68:69], v43 offset:40960
ds_read_b64_tr_b16 a[70:71], v43 offset:45056
v_mfma_f32_16x16x32_bf16 v[92:95], a[48:51], a[28:31], v[92:95]
buffer_load_dwordx4 a[236:239], v1, s[12:15], s38 offen offset:0 sc1
v_mfma_f32_16x16x32_bf16 v[96:99], a[52:55], a[24:27], v[96:99]
s_waitcnt lgkmcnt(6)
ds_read_b64_tr_b16 a[72:73], v44 offset:40960
ds_read_b64_tr_b16 a[74:75], v44 offset:45056
v_mfma_f32_16x16x32_bf16 v[100:103], a[52:55], a[28:31], v[100:103]
v_mfma_f32_16x16x32_bf16 v[104:107], a[56:59], a[24:27], v[104:107]
s_waitcnt lgkmcnt(6)
ds_read_b64_tr_b16 a[76:77], v45 offset:40960
ds_read_b64_tr_b16 a[78:79], v45 offset:45056
v_mfma_f32_16x16x32_bf16 v[108:111], a[56:59], a[28:31], v[108:111]
buffer_load_dwordx4 a[240:243], v1, s[12:15], s37 offen offset:1024 sc1
v_mfma_f32_16x16x32_bf16 v[112:115], a[60:63], a[24:27], v[112:115]
s_waitcnt lgkmcnt(6)
v_mfma_f32_16x16x32_bf16 v[116:119], a[60:63], a[28:31], v[116:119]
v_mfma_f32_16x16x32_bf16 v[120:123], a[64:67], a[24:27], v[120:123]
s_waitcnt lgkmcnt(4)
ds_read_b64_tr_b16 a[48:49], v46 offset:32768
ds_read_b64_tr_b16 a[50:51], v46 offset:36864
v_mfma_f32_16x16x32_bf16 v[124:127], a[64:67], a[28:31], v[124:127]
v_mfma_f32_16x16x32_bf16 v[128:131], a[68:71], a[24:27], v[128:131]
s_waitcnt lgkmcnt(4)
ds_read_b64_tr_b16 a[52:53], v47 offset:32768
ds_read_b64_tr_b16 a[54:55], v47 offset:36864
v_mfma_f32_16x16x32_bf16 v[132:135], a[68:71], a[28:31], v[132:135]
buffer_load_dwordx4 a[244:247], v1, s[12:15], s38 offen offset:1024 sc1
v_mfma_f32_16x16x32_bf16 v[136:139], a[72:75], a[24:27], v[136:139]
s_waitcnt lgkmcnt(4)
ds_read_b64_tr_b16 a[56:57], v48 offset:32768
ds_read_b64_tr_b16 a[58:59], v48 offset:36864
v_mfma_f32_16x16x32_bf16 v[140:143], a[72:75], a[28:31], v[140:143]
s_add_u32 s52, s47, 36864
s_add_u32 m0, s49, 106496
v_mfma_f32_16x16x32_bf16 v[144:147], a[76:79], a[24:27], v[144:147]
s_waitcnt vmcnt(25)
ds_read_b64_tr_b16 a[60:61], v49 offset:32768
ds_read_b64_tr_b16 a[62:63], v49 offset:36864
v_mfma_f32_16x16x32_bf16 v[148:151], a[76:79], a[28:31], v[148:151]
s_waitcnt vmcnt(15)
s_barrier
v_mfma_f32_16x16x32_bf16 v[152:155], a[128:131], a[32:35], v[152:155]
s_waitcnt lgkmcnt(6)
ds_read_b64_tr_b16 a[64:65], v50 offset:32768
ds_read_b64_tr_b16 a[66:67], v50 offset:36864
v_mfma_f32_16x16x32_bf16 v[156:159], a[128:131], a[36:39], v[156:159]
buffer_load_dwordx4 v2, s[92:95], s52 offen lds
v_mfma_f32_16x16x32_bf16 v[88:91], a[48:51], a[32:35], v[88:91]
s_waitcnt lgkmcnt(6)
ds_read_b64_tr_b16 a[68:69], v51 offset:32768
ds_read_b64_tr_b16 a[70:71], v51 offset:36864
v_mfma_f32_16x16x32_bf16 v[92:95], a[48:51], a[36:39], v[92:95]
s_add_u32 s52, s47, 41472
s_add_u32 m0, s49, 107520
v_mfma_f32_16x16x32_bf16 v[96:99], a[52:55], a[32:35], v[96:99]
s_waitcnt lgkmcnt(6)
ds_read_b64_tr_b16 a[72:73], v52 offset:32768
ds_read_b64_tr_b16 a[74:75], v52 offset:36864
v_mfma_f32_16x16x32_bf16 v[100:103], a[52:55], a[36:39], v[100:103]
buffer_load_dwordx4 v3, s[92:95], s52 offen lds
v_mfma_f32_16x16x32_bf16 v[104:107], a[56:59], a[32:35], v[104:107]
s_waitcnt lgkmcnt(6)
ds_read_b64_tr_b16 a[76:77], v53 offset:32768
ds_read_b64_tr_b16 a[78:79], v53 offset:36864
v_mfma_f32_16x16x32_bf16 v[108:111], a[56:59], a[36:39], v[108:111]
v_mfma_f32_16x16x32_bf16 v[112:115], a[60:63], a[32:35], v[112:115]
s_waitcnt lgkmcnt(6)
v_mfma_f32_16x16x32_bf16 v[116:119], a[60:63], a[36:39], v[116:119]
v_mfma_f32_16x16x32_bf16 v[120:123], a[64:67], a[32:35], v[120:123]
s_waitcnt lgkmcnt(4)
ds_read_b64_tr_b16 a[48:49], v38 offset:49152
ds_read_b64_tr_b16 a[50:51], v38 offset:53248
v_mfma_f32_16x16x32_bf16 v[124:127], a[64:67], a[36:39], v[124:127]
v_mfma_f32_16x16x32_bf16 v[128:131], a[68:71], a[32:35], v[128:131]
s_waitcnt lgkmcnt(4)
ds_read_b64_tr_b16 a[52:53], v39 offset:49152
ds_read_b64_tr_b16 a[54:55], v39 offset:53248
v_mfma_f32_16x16x32_bf16 v[132:135], a[68:71], a[36:39], v[132:135]
v_mfma_f32_16x16x32_bf16 v[136:139], a[72:75], a[32:35], v[136:139]
s_waitcnt lgkmcnt(4)
ds_read_b64_tr_b16 a[56:57], v40 offset:49152
ds_read_b64_tr_b16 a[58:59], v40 offset:53248
v_mfma_f32_16x16x32_bf16 v[140:143], a[72:75], a[36:39], v[140:143]
v_mfma_f32_16x16x32_bf16 v[144:147], a[76:79], a[32:35], v[144:147]
s_waitcnt vmcnt(14)
ds_read_b64_tr_b16 a[60:61], v41 offset:49152
ds_read_b64_tr_b16 a[62:63], v41 offset:53248
v_mfma_f32_16x16x32_bf16 v[148:151], a[76:79], a[36:39], v[148:151]
v_mfma_f32_16x16x32_bf16 v[152:155], a[132:135], a[40:43], v[152:155]
s_waitcnt lgkmcnt(6)
ds_read_b64_tr_b16 a[64:65], v42 offset:49152
ds_read_b64_tr_b16 a[66:67], v42 offset:53248
v_mfma_f32_16x16x32_bf16 v[156:159], a[132:135], a[44:47], v[156:159]
v_mfma_f32_16x16x32_bf16 v[88:91], a[48:51], a[40:43], v[88:91]
s_waitcnt lgkmcnt(6)
ds_read_b64_tr_b16 a[68:69], v43 offset:49152
ds_read_b64_tr_b16 a[70:71], v43 offset:53248
v_mfma_f32_16x16x32_bf16 v[92:95], a[48:51], a[44:47], v[92:95]
v_mfma_f32_16x16x32_bf16 v[96:99], a[52:55], a[40:43], v[96:99]
s_waitcnt lgkmcnt(6)
ds_read_b64_tr_b16 a[72:73], v44 offset:49152
ds_read_b64_tr_b16 a[74:75], v44 offset:53248
v_mfma_f32_16x16x32_bf16 v[100:103], a[52:55], a[44:47], v[100:103]
v_mfma_f32_16x16x32_bf16 v[104:107], a[56:59], a[40:43], v[104:107]
s_waitcnt lgkmcnt(6)
ds_read_b64_tr_b16 a[76:77], v45 offset:49152
ds_read_b64_tr_b16 a[78:79], v45 offset:53248
v_mfma_f32_16x16x32_bf16 v[108:111], a[56:59], a[44:47], v[108:111]
v_mfma_f32_16x16x32_bf16 v[112:115], a[60:63], a[40:43], v[112:115]
s_waitcnt lgkmcnt(6)
v_mfma_f32_16x16x32_bf16 v[116:119], a[60:63], a[44:47], v[116:119]
v_mfma_f32_16x16x32_bf16 v[120:123], a[64:67], a[40:43], v[120:123]
s_waitcnt lgkmcnt(4)
ds_read_b64_tr_b16 a[48:49], v38 offset:57344
ds_read_b64_tr_b16 a[50:51], v38 offset:61440
v_mfma_f32_16x16x32_bf16 v[124:127], a[64:67], a[44:47], v[124:127]
v_mfma_f32_16x16x32_bf16 v[128:131], a[68:71], a[40:43], v[128:131]
s_waitcnt lgkmcnt(4)
ds_read_b64_tr_b16 a[52:53], v39 offset:57344
ds_read_b64_tr_b16 a[54:55], v39 offset:61440
v_mfma_f32_16x16x32_bf16 v[132:135], a[68:71], a[44:47], v[132:135]
v_mfma_f32_16x16x32_bf16 v[136:139], a[72:75], a[40:43], v[136:139]
s_waitcnt lgkmcnt(4)
ds_read_b64_tr_b16 a[56:57], v40 offset:57344
ds_read_b64_tr_b16 a[58:59], v40 offset:61440
v_mfma_f32_16x16x32_bf16 v[140:143], a[72:75], a[44:47], v[140:143]
v_mfma_f32_16x16x32_bf16 v[144:147], a[76:79], a[40:43], v[144:147]
s_waitcnt vmcnt(11)
ds_read_b64_tr_b16 a[60:61], v41 offset:57344
ds_read_b64_tr_b16 a[62:63], v41 offset:61440
v_mfma_f32_16x16x32_bf16 v[148:151], a[76:79], a[44:47], v[148:151]
v_mfma_f32_16x16x32_bf16 v[152:155], a[136:139], a[216:219], v[152:155]
s_waitcnt lgkmcnt(6)
ds_read_b64_tr_b16 a[64:65], v42 offset:57344
ds_read_b64_tr_b16 a[66:67], v42 offset:61440
v_mfma_f32_16x16x32_bf16 v[156:159], a[136:139], a[220:223], v[156:159]
v_mfma_f32_16x16x32_bf16 v[88:91], a[48:51], a[216:219], v[88:91]
s_waitcnt lgkmcnt(6)
ds_read_b64_tr_b16 a[68:69], v43 offset:57344
ds_read_b64_tr_b16 a[70:71], v43 offset:61440
v_mfma_f32_16x16x32_bf16 v[92:95], a[48:51], a[220:223], v[92:95]
v_mfma_f32_16x16x32_bf16 v[96:99], a[52:55], a[216:219], v[96:99]
s_waitcnt lgkmcnt(6)
ds_read_b64_tr_b16 a[72:73], v44 offset:57344
ds_read_b64_tr_b16 a[74:75], v44 offset:61440
v_mfma_f32_16x16x32_bf16 v[100:103], a[52:55], a[220:223], v[100:103]
v_mfma_f32_16x16x32_bf16 v[104:107], a[56:59], a[216:219], v[104:107]
s_waitcnt lgkmcnt(6)
ds_read_b64_tr_b16 a[76:77], v45 offset:57344
ds_read_b64_tr_b16 a[78:79], v45 offset:61440
v_mfma_f32_16x16x32_bf16 v[108:111], a[56:59], a[220:223], v[108:111]
s_mul_i32 s53, s35, 18432
s_add_u32 s53, s53, s75
s_add_u32 s53, s53, 167772160
v_mfma_f32_16x16x32_bf16 v[112:115], a[60:63], a[216:219], v[112:115]
s_waitcnt lgkmcnt(6)
s_waitcnt vmcnt(9)
v_cmp_ne_u32 s[62:63], s60, v8
v_mfma_f32_16x16x32_bf16 v[116:119], a[60:63], a[220:223], v[116:119]
s_cmp_lg_u64 s[62:63], 0
s_cbranch_scc1 L_kt_ft3
L_kt_fr3:
s_add_u32 s54, s53, 18432
v_mfma_f32_16x16x32_bf16 v[120:123], a[64:67], a[216:219], v[120:123]
s_waitcnt lgkmcnt(4)
v_mfma_f32_16x16x32_bf16 v[124:127], a[64:67], a[220:223], v[124:127]
v_mfma_f32_16x16x32_bf16 v[128:131], a[68:71], a[216:219], v[128:131]
s_waitcnt lgkmcnt(2)
v_mfma_f32_16x16x32_bf16 v[132:135], a[68:71], a[220:223], v[132:135]
v_mfma_f32_16x16x32_bf16 v[136:139], a[72:75], a[216:219], v[136:139]
s_waitcnt lgkmcnt(0)
ds_read_b64_tr_b16 a[48:49], v46 offset:49152
ds_read_b64_tr_b16 a[50:51], v46 offset:53248
v_mfma_f32_16x16x32_bf16 v[140:143], a[72:75], a[220:223], v[140:143]
s_mul_i32 s85, s36, 18432
s_add_u32 s85, s85, s76
s_lshl_b32 s37, s41, 10
v_mfma_f32_16x16x32_bf16 v[144:147], a[76:79], a[216:219], v[144:147]
s_waitcnt vmcnt(8)
ds_read_b64_tr_b16 a[52:53], v47 offset:49152
ds_read_b64_tr_b16 a[54:55], v47 offset:53248
v_mfma_f32_16x16x32_bf16 v[148:151], a[76:79], a[220:223], v[148:151]
s_waitcnt vmcnt(6)
s_barrier
v_mfma_f32_16x16x32_bf16 v[152:155], a[140:143], a[224:227], v[152:155]
s_waitcnt vmcnt(4)
ds_read_b64_tr_b16 a[56:57], v46 offset:57344
ds_read_b64_tr_b16 a[58:59], v46 offset:61440
v_mfma_f32_16x16x32_bf16 v[156:159], a[140:143], a[228:231], v[156:159]
s_and_b32 s37, s37, 0x3000
s_add_u32 s37, s37, s85
buffer_load_dwordx4 v[224:227], v1, s[12:15], s37 offen offset:0 sc1
v_mfma_f32_16x16x32_bf16 v[152:155], a[144:147], a[232:235], v[152:155]
s_waitcnt vmcnt(3)
ds_read_b64_tr_b16 a[60:61], v47 offset:57344
ds_read_b64_tr_b16 a[62:63], v47 offset:61440
v_mfma_f32_16x16x32_bf16 v[156:159], a[144:147], a[236:239], v[156:159]
s_waitcnt vmcnt(1)
s_barrier
v_mfma_f32_16x16x32_bf16 v[152:155], a[148:151], a[240:243], v[152:155]
s_waitcnt lgkmcnt(6)
ds_read_b64_tr_b16 a[64:65], v46 offset:40960
ds_read_b64_tr_b16 a[66:67], v46 offset:45056
v_mfma_f32_16x16x32_bf16 v[156:159], a[148:151], a[244:247], v[156:159]
s_add_u32 s38, s37, 18432
v_mfma_f32_16x16x32_bf16 v[88:91], a[48:51], a[224:227], v[88:91]
s_waitcnt lgkmcnt(6)
ds_read_b64_tr_b16 a[68:69], v47 offset:40960
ds_read_b64_tr_b16 a[70:71], v47 offset:45056
buffer_load_dwordx4 v[228:231], v1, s[12:15], s38 offen offset:0 sc1
v_mfma_f32_16x16x32_bf16 v[92:95], a[48:51], a[228:231], v[92:95]
v_mfma_f32_16x16x32_bf16 v[96:99], a[52:55], a[224:227], v[96:99]
s_waitcnt lgkmcnt(6)
ds_read_b64_tr_b16 a[72:73], v48 offset:49152
ds_read_b64_tr_b16 a[74:75], v48 offset:53248
v_mfma_f32_16x16x32_bf16 v[100:103], a[52:55], a[228:231], v[100:103]
buffer_load_dwordx4 v[232:235], v1, s[12:15], s37 offen offset:1024 sc1
v_mfma_f32_16x16x32_bf16 v[88:91], a[56:59], a[232:235], v[88:91]
s_waitcnt lgkmcnt(6)
ds_read_b64_tr_b16 a[76:77], v49 offset:49152
ds_read_b64_tr_b16 a[78:79], v49 offset:53248
v_mfma_f32_16x16x32_bf16 v[92:95], a[56:59], a[236:239], v[92:95]
v_cvt_pk_bf16_f32 v152, v152, v153
v_cvt_pk_bf16_f32 v153, v154, v155
v_mfma_f32_16x16x32_bf16 v[96:99], a[60:63], a[232:235], v[96:99]
s_waitcnt lgkmcnt(6)
ds_read_b64_tr_b16 a[48:49], v48 offset:57344
ds_read_b64_tr_b16 a[50:51], v48 offset:61440
v_mfma_f32_16x16x32_bf16 v[100:103], a[60:63], a[236:239], v[100:103]
buffer_load_dwordx4 v[236:239], v1, s[12:15], s38 offen offset:1024 sc1
v_mfma_f32_16x16x32_bf16 v[88:91], a[64:67], a[240:243], v[88:91]
s_waitcnt lgkmcnt(6)
ds_read_b64_tr_b16 a[52:53], v49 offset:57344
ds_read_b64_tr_b16 a[54:55], v49 offset:61440
v_mfma_f32_16x16x32_bf16 v[92:95], a[64:67], a[244:247], v[92:95]
v_cvt_pk_bf16_f32 v154, v156, v157
v_cvt_pk_bf16_f32 v155, v158, v159
v_mfma_f32_16x16x32_bf16 v[96:99], a[68:71], a[240:243], v[96:99]
s_waitcnt lgkmcnt(6)
ds_read_b64_tr_b16 a[56:57], v48 offset:40960
ds_read_b64_tr_b16 a[58:59], v48 offset:45056
v_mfma_f32_16x16x32_bf16 v[100:103], a[68:71], a[244:247], v[100:103]
v_permlane32_swap_b32 v152, v154
v_permlane32_swap_b32 v153, v155
buffer_store_dwordx4 v[152:155], v10, s[12:15], s53 offen offset:1024 sc1
v_mfma_f32_16x16x32_bf16 v[104:107], a[72:75], a[224:227], v[104:107]
s_waitcnt lgkmcnt(6)
ds_read_b64_tr_b16 a[60:61], v49 offset:40960
ds_read_b64_tr_b16 a[62:63], v49 offset:45056
v_mfma_f32_16x16x32_bf16 v[108:111], a[72:75], a[228:231], v[108:111]
v_cvt_pk_bf16_f32 v160, v88, v89
v_cvt_pk_bf16_f32 v161, v90, v91
v_mfma_f32_16x16x32_bf16 v[112:115], a[76:79], a[224:227], v[112:115]
s_waitcnt lgkmcnt(6)
ds_read_b64_tr_b16 a[64:65], v50 offset:49152
ds_read_b64_tr_b16 a[66:67], v50 offset:53248
v_mfma_f32_16x16x32_bf16 v[116:119], a[76:79], a[228:231], v[116:119]
v_cvt_pk_bf16_f32 v162, v96, v97
v_cvt_pk_bf16_f32 v163, v98, v99
v_mfma_f32_16x16x32_bf16 v[104:107], a[48:51], a[232:235], v[104:107]
s_waitcnt lgkmcnt(6)
ds_read_b64_tr_b16 a[68:69], v51 offset:49152
ds_read_b64_tr_b16 a[70:71], v51 offset:53248
v_mfma_f32_16x16x32_bf16 v[108:111], a[48:51], a[236:239], v[108:111]
buffer_store_dwordx4 v[160:163], v9, s[12:15], s53 offen offset:0 sc1
v_mfma_f32_16x16x32_bf16 v[112:115], a[52:55], a[232:235], v[112:115]
s_waitcnt lgkmcnt(6)
ds_read_b64_tr_b16 a[72:73], v50 offset:57344
ds_read_b64_tr_b16 a[74:75], v50 offset:61440
v_mfma_f32_16x16x32_bf16 v[116:119], a[52:55], a[236:239], v[116:119]
v_cvt_pk_bf16_f32 v164, v92, v93
v_cvt_pk_bf16_f32 v165, v94, v95
v_mfma_f32_16x16x32_bf16 v[104:107], a[56:59], a[240:243], v[104:107]
s_waitcnt lgkmcnt(6)
ds_read_b64_tr_b16 a[76:77], v51 offset:57344
ds_read_b64_tr_b16 a[78:79], v51 offset:61440
v_mfma_f32_16x16x32_bf16 v[108:111], a[56:59], a[244:247], v[108:111]
v_cvt_pk_bf16_f32 v166, v100, v101
v_cvt_pk_bf16_f32 v167, v102, v103
buffer_store_dwordx4 v[164:167], v9, s[12:15], s54 offen offset:0 sc1
v_mfma_f32_16x16x32_bf16 v[112:115], a[60:63], a[240:243], v[112:115]
s_waitcnt lgkmcnt(6)
ds_read_b64_tr_b16 a[48:49], v50 offset:40960
ds_read_b64_tr_b16 a[50:51], v50 offset:45056
v_mfma_f32_16x16x32_bf16 v[116:119], a[60:63], a[244:247], v[116:119]
v_mfma_f32_16x16x32_bf16 v[120:123], a[64:67], a[224:227], v[120:123]
s_waitcnt lgkmcnt(6)
ds_read_b64_tr_b16 a[52:53], v51 offset:40960
ds_read_b64_tr_b16 a[54:55], v51 offset:45056
v_mfma_f32_16x16x32_bf16 v[124:127], a[64:67], a[228:231], v[124:127]
v_cvt_pk_bf16_f32 v168, v104, v105
v_cvt_pk_bf16_f32 v169, v106, v107
v_mfma_f32_16x16x32_bf16 v[128:131], a[68:71], a[224:227], v[128:131]
s_waitcnt lgkmcnt(6)
ds_read_b64_tr_b16 a[56:57], v52 offset:49152
ds_read_b64_tr_b16 a[58:59], v52 offset:53248
v_mfma_f32_16x16x32_bf16 v[132:135], a[68:71], a[228:231], v[132:135]
v_cvt_pk_bf16_f32 v170, v112, v113
v_cvt_pk_bf16_f32 v171, v114, v115
v_mfma_f32_16x16x32_bf16 v[120:123], a[72:75], a[232:235], v[120:123]
s_waitcnt lgkmcnt(6)
ds_read_b64_tr_b16 a[60:61], v53 offset:49152
ds_read_b64_tr_b16 a[62:63], v53 offset:53248
v_mfma_f32_16x16x32_bf16 v[124:127], a[72:75], a[236:239], v[124:127]
buffer_store_dwordx4 v[168:171], v9, s[12:15], s53 offen offset:256 sc1
v_mfma_f32_16x16x32_bf16 v[128:131], a[76:79], a[232:235], v[128:131]
s_waitcnt lgkmcnt(6)
ds_read_b64_tr_b16 a[64:65], v52 offset:57344
ds_read_b64_tr_b16 a[66:67], v52 offset:61440
v_mfma_f32_16x16x32_bf16 v[132:135], a[76:79], a[236:239], v[132:135]
v_cvt_pk_bf16_f32 v172, v108, v109
v_cvt_pk_bf16_f32 v173, v110, v111
v_mfma_f32_16x16x32_bf16 v[120:123], a[48:51], a[240:243], v[120:123]
s_waitcnt lgkmcnt(6)
ds_read_b64_tr_b16 a[68:69], v53 offset:57344
ds_read_b64_tr_b16 a[70:71], v53 offset:61440
v_mfma_f32_16x16x32_bf16 v[124:127], a[48:51], a[244:247], v[124:127]
v_cvt_pk_bf16_f32 v174, v116, v117
v_cvt_pk_bf16_f32 v175, v118, v119
buffer_store_dwordx4 v[172:175], v9, s[12:15], s54 offen offset:256 sc1
v_mfma_f32_16x16x32_bf16 v[128:131], a[52:55], a[240:243], v[128:131]
s_waitcnt lgkmcnt(6)
ds_read_b64_tr_b16 a[72:73], v52 offset:40960
ds_read_b64_tr_b16 a[74:75], v52 offset:45056
v_mfma_f32_16x16x32_bf16 v[132:135], a[52:55], a[244:247], v[132:135]
v_mfma_f32_16x16x32_bf16 v[136:139], a[56:59], a[224:227], v[136:139]
s_waitcnt lgkmcnt(6)
ds_read_b64_tr_b16 a[76:77], v53 offset:40960
ds_read_b64_tr_b16 a[78:79], v53 offset:45056
v_mfma_f32_16x16x32_bf16 v[140:143], a[56:59], a[228:231], v[140:143]
v_cvt_pk_bf16_f32 v176, v120, v121
v_cvt_pk_bf16_f32 v177, v122, v123
v_mfma_f32_16x16x32_bf16 v[144:147], a[60:63], a[224:227], v[144:147]
s_waitcnt lgkmcnt(6)
v_cvt_pk_bf16_f32 v178, v128, v129
v_cvt_pk_bf16_f32 v179, v130, v131
v_mfma_f32_16x16x32_bf16 v[148:151], a[60:63], a[228:231], v[148:151]
buffer_store_dwordx4 v[176:179], v9, s[12:15], s53 offen offset:512 sc1
v_mfma_f32_16x16x32_bf16 v[136:139], a[64:67], a[232:235], v[136:139]
s_waitcnt lgkmcnt(4)
v_cvt_pk_bf16_f32 v180, v124, v125
v_cvt_pk_bf16_f32 v181, v126, v127
v_mfma_f32_16x16x32_bf16 v[140:143], a[64:67], a[236:239], v[140:143]
v_cvt_pk_bf16_f32 v182, v132, v133
v_cvt_pk_bf16_f32 v183, v134, v135
v_mfma_f32_16x16x32_bf16 v[144:147], a[68:71], a[232:235], v[144:147]
s_waitcnt lgkmcnt(2)
ds_read_b64_tr_b16 a[48:49], v54 offset:0
ds_read_b64_tr_b16 a[50:51], v54 offset:4096
buffer_store_dwordx4 v[180:183], v9, s[12:15], s54 offen offset:512 sc1
v_mfma_f32_16x16x32_bf16 v[148:151], a[68:71], a[236:239], v[148:151]
v_mfma_f32_16x16x32_bf16 v[136:139], a[72:75], a[240:243], v[136:139]
s_waitcnt lgkmcnt(2)
ds_read_b64_tr_b16 a[52:53], v55 offset:0
ds_read_b64_tr_b16 a[54:55], v55 offset:4096
v_mfma_f32_16x16x32_bf16 v[140:143], a[72:75], a[244:247], v[140:143]
v_mfma_f32_16x16x32_bf16 v[144:147], a[76:79], a[240:243], v[144:147]
ds_read_b64_tr_b16 a[56:57], v54 offset:8192
ds_read_b64_tr_b16 a[58:59], v54 offset:12288
v_mfma_f32_16x16x32_bf16 v[148:151], a[76:79], a[244:247], v[148:151]
v_mfma_f32_16x16x32_bf16 v[152:155], a[80:83], v[192:195], 0
ds_read_b64_tr_b16 a[60:61], v55 offset:8192
ds_read_b64_tr_b16 a[62:63], v55 offset:12288
v_mfma_f32_16x16x32_bf16 v[156:159], a[80:83], v[196:199], 0
v_cvt_pk_bf16_f32 v184, v136, v137
v_cvt_pk_bf16_f32 v185, v138, v139
v_mfma_f32_16x16x32_bf16 v[152:155], a[84:87], v[200:203], v[152:155]
s_waitcnt lgkmcnt(6)
ds_read_b64_tr_b16 a[64:65], v56 offset:0
ds_read_b64_tr_b16 a[66:67], v56 offset:4096
v_mfma_f32_16x16x32_bf16 v[156:159], a[84:87], v[204:207], v[156:159]
v_cvt_pk_bf16_f32 v186, v144, v145
v_cvt_pk_bf16_f32 v187, v146, v147
v_mfma_f32_16x16x32_bf16 v[88:91], a[48:51], v[192:195], 0
s_waitcnt lgkmcnt(6)
ds_read_b64_tr_b16 a[68:69], v57 offset:0
ds_read_b64_tr_b16 a[70:71], v57 offset:4096
v_mfma_f32_16x16x32_bf16 v[92:95], a[48:51], v[196:199], 0
buffer_store_dwordx4 v[184:187], v9, s[12:15], s53 offen offset:768 sc1
v_mfma_f32_16x16x32_bf16 v[96:99], a[52:55], v[192:195], 0
s_waitcnt lgkmcnt(6)
ds_read_b64_tr_b16 a[72:73], v56 offset:8192
ds_read_b64_tr_b16 a[74:75], v56 offset:12288
v_mfma_f32_16x16x32_bf16 v[100:103], a[52:55], v[196:199], 0
v_cvt_pk_bf16_f32 v188, v140, v141
v_cvt_pk_bf16_f32 v189, v142, v143
v_mfma_f32_16x16x32_bf16 v[88:91], a[56:59], v[200:203], v[88:91]
s_waitcnt lgkmcnt(6)
ds_read_b64_tr_b16 a[76:77], v57 offset:8192
ds_read_b64_tr_b16 a[78:79], v57 offset:12288
v_mfma_f32_16x16x32_bf16 v[92:95], a[56:59], v[204:207], v[92:95]
v_cvt_pk_bf16_f32 v190, v148, v149
v_cvt_pk_bf16_f32 v191, v150, v151
buffer_store_dwordx4 v[188:191], v9, s[12:15], s54 offen offset:768 sc1
v_mfma_f32_16x16x32_bf16 v[96:99], a[60:63], v[200:203], v[96:99]
s_waitcnt lgkmcnt(6)
ds_read_b64_tr_b16 a[48:49], v58 offset:0
ds_read_b64_tr_b16 a[50:51], v58 offset:4096
v_mfma_f32_16x16x32_bf16 v[100:103], a[60:63], v[204:207], v[100:103]
v_mfma_f32_16x16x32_bf16 v[104:107], a[64:67], v[192:195], 0
s_waitcnt lgkmcnt(6)
ds_read_b64_tr_b16 a[52:53], v59 offset:0
ds_read_b64_tr_b16 a[54:55], v59 offset:4096
v_mfma_f32_16x16x32_bf16 v[108:111], a[64:67], v[196:199], 0
v_mfma_f32_16x16x32_bf16 v[112:115], a[68:71], v[192:195], 0
s_waitcnt lgkmcnt(6)
ds_read_b64_tr_b16 a[56:57], v58 offset:8192
ds_read_b64_tr_b16 a[58:59], v58 offset:12288
v_mfma_f32_16x16x32_bf16 v[116:119], a[68:71], v[196:199], 0
v_mfma_f32_16x16x32_bf16 v[104:107], a[72:75], v[200:203], v[104:107]
s_waitcnt lgkmcnt(6)
ds_read_b64_tr_b16 a[60:61], v59 offset:8192
ds_read_b64_tr_b16 a[62:63], v59 offset:12288
v_mfma_f32_16x16x32_bf16 v[108:111], a[72:75], v[204:207], v[108:111]
v_mfma_f32_16x16x32_bf16 v[112:115], a[76:79], v[200:203], v[112:115]
s_waitcnt lgkmcnt(6)
ds_read_b64_tr_b16 a[64:65], v60 offset:0
ds_read_b64_tr_b16 a[66:67], v60 offset:4096
v_mfma_f32_16x16x32_bf16 v[116:119], a[76:79], v[204:207], v[116:119]
v_mfma_f32_16x16x32_bf16 v[120:123], a[48:51], v[192:195], 0
s_waitcnt lgkmcnt(6)
ds_read_b64_tr_b16 a[68:69], v61 offset:0
ds_read_b64_tr_b16 a[70:71], v61 offset:4096
v_mfma_f32_16x16x32_bf16 v[124:127], a[48:51], v[196:199], 0
v_mfma_f32_16x16x32_bf16 v[128:131], a[52:55], v[192:195], 0
s_waitcnt lgkmcnt(6)
ds_read_b64_tr_b16 a[72:73], v60 offset:8192
ds_read_b64_tr_b16 a[74:75], v60 offset:12288
v_mfma_f32_16x16x32_bf16 v[132:135], a[52:55], v[196:199], 0
v_mfma_f32_16x16x32_bf16 v[120:123], a[56:59], v[200:203], v[120:123]
s_waitcnt lgkmcnt(6)
ds_read_b64_tr_b16 a[76:77], v61 offset:8192
ds_read_b64_tr_b16 a[78:79], v61 offset:12288
v_mfma_f32_16x16x32_bf16 v[124:127], a[56:59], v[204:207], v[124:127]
v_mfma_f32_16x16x32_bf16 v[128:131], a[60:63], v[200:203], v[128:131]
s_waitcnt lgkmcnt(6)
v_mfma_f32_16x16x32_bf16 v[132:135], a[60:63], v[204:207], v[132:135]
v_mfma_f32_16x16x32_bf16 v[136:139], a[64:67], v[192:195], 0
s_waitcnt lgkmcnt(4)
ds_read_b64_tr_b16 a[48:49], v38 offset:0
ds_read_b64_tr_b16 a[50:51], v38 offset:4096
v_mfma_f32_16x16x32_bf16 v[140:143], a[64:67], v[196:199], 0
v_mfma_f32_16x16x32_bf16 v[144:147], a[68:71], v[192:195], 0
s_waitcnt lgkmcnt(4)
ds_read_b64_tr_b16 a[52:53], v39 offset:0
ds_read_b64_tr_b16 a[54:55], v39 offset:4096
v_mfma_f32_16x16x32_bf16 v[148:151], a[68:71], v[196:199], 0
v_mfma_f32_16x16x32_bf16 v[136:139], a[72:75], v[200:203], v[136:139]
s_waitcnt lgkmcnt(4)
ds_read_b64_tr_b16 a[56:57], v40 offset:0
ds_read_b64_tr_b16 a[58:59], v40 offset:4096
v_mfma_f32_16x16x32_bf16 v[140:143], a[72:75], v[204:207], v[140:143]
v_mfma_f32_16x16x32_bf16 v[144:147], a[76:79], v[200:203], v[144:147]
ds_read_b64_tr_b16 a[60:61], v41 offset:0
ds_read_b64_tr_b16 a[62:63], v41 offset:4096
v_mfma_f32_16x16x32_bf16 v[148:151], a[76:79], v[204:207], v[148:151]
v_mfma_f32_16x16x32_bf16 v[152:155], a[88:91], v[208:211], v[152:155]
s_waitcnt lgkmcnt(6)
ds_read_b64_tr_b16 a[64:65], v42 offset:0
ds_read_b64_tr_b16 a[66:67], v42 offset:4096
v_mfma_f32_16x16x32_bf16 v[156:159], a[88:91], v[212:215], v[156:159]
v_mfma_f32_16x16x32_bf16 v[88:91], a[48:51], v[208:211], v[88:91]
s_waitcnt lgkmcnt(6)
ds_read_b64_tr_b16 a[68:69], v43 offset:0
ds_read_b64_tr_b16 a[70:71], v43 offset:4096
v_mfma_f32_16x16x32_bf16 v[92:95], a[48:51], v[212:215], v[92:95]
v_mfma_f32_16x16x32_bf16 v[96:99], a[52:55], v[208:211], v[96:99]
s_waitcnt lgkmcnt(6)
ds_read_b64_tr_b16 a[72:73], v44 offset:0
ds_read_b64_tr_b16 a[74:75], v44 offset:4096
v_mfma_f32_16x16x32_bf16 v[100:103], a[52:55], v[212:215], v[100:103]
v_mfma_f32_16x16x32_bf16 v[104:107], a[56:59], v[208:211], v[104:107]
s_waitcnt lgkmcnt(6)
ds_read_b64_tr_b16 a[76:77], v45 offset:0
ds_read_b64_tr_b16 a[78:79], v45 offset:4096
v_mfma_f32_16x16x32_bf16 v[108:111], a[56:59], v[212:215], v[108:111]
v_mfma_f32_16x16x32_bf16 v[112:115], a[60:63], v[208:211], v[112:115]
s_waitcnt lgkmcnt(6)
v_mfma_f32_16x16x32_bf16 v[116:119], a[60:63], v[212:215], v[116:119]
buffer_load_dwordx4 v[240:243], v1, s[12:15], s37 offen offset:2048 sc1
v_mfma_f32_16x16x32_bf16 v[120:123], a[64:67], v[208:211], v[120:123]
s_waitcnt lgkmcnt(4)
ds_read_b64_tr_b16 a[48:49], v38 offset:8192
ds_read_b64_tr_b16 a[50:51], v38 offset:12288
v_mfma_f32_16x16x32_bf16 v[124:127], a[64:67], v[212:215], v[124:127]
v_mfma_f32_16x16x32_bf16 v[128:131], a[68:71], v[208:211], v[128:131]
s_waitcnt lgkmcnt(4)
ds_read_b64_tr_b16 a[52:53], v39 offset:8192
ds_read_b64_tr_b16 a[54:55], v39 offset:12288
v_mfma_f32_16x16x32_bf16 v[132:135], a[68:71], v[212:215], v[132:135]
v_mfma_f32_16x16x32_bf16 v[136:139], a[72:75], v[208:211], v[136:139]
s_waitcnt lgkmcnt(4)
ds_read_b64_tr_b16 a[56:57], v40 offset:8192
ds_read_b64_tr_b16 a[58:59], v40 offset:12288
v_mfma_f32_16x16x32_bf16 v[140:143], a[72:75], v[212:215], v[140:143]
buffer_load_dwordx4 v[244:247], v1, s[12:15], s38 offen offset:2048 sc1
v_mfma_f32_16x16x32_bf16 v[144:147], a[76:79], v[208:211], v[144:147]
ds_read_b64_tr_b16 a[60:61], v41 offset:8192
ds_read_b64_tr_b16 a[62:63], v41 offset:12288
v_mfma_f32_16x16x32_bf16 v[148:151], a[76:79], v[212:215], v[148:151]
v_mfma_f32_16x16x32_bf16 v[152:155], a[92:95], v[216:219], v[152:155]
s_waitcnt lgkmcnt(6)
ds_read_b64_tr_b16 a[64:65], v42 offset:8192
ds_read_b64_tr_b16 a[66:67], v42 offset:12288
v_mfma_f32_16x16x32_bf16 v[156:159], a[92:95], v[220:223], v[156:159]
buffer_load_dwordx4 v[248:251], v1, s[12:15], s37 offen offset:3072 sc1
v_mfma_f32_16x16x32_bf16 v[88:91], a[48:51], v[216:219], v[88:91]
s_waitcnt lgkmcnt(6)
ds_read_b64_tr_b16 a[68:69], v43 offset:8192
ds_read_b64_tr_b16 a[70:71], v43 offset:12288
v_mfma_f32_16x16x32_bf16 v[92:95], a[48:51], v[220:223], v[92:95]
v_mfma_f32_16x16x32_bf16 v[96:99], a[52:55], v[216:219], v[96:99]
s_waitcnt lgkmcnt(6)
ds_read_b64_tr_b16 a[72:73], v44 offset:8192
ds_read_b64_tr_b16 a[74:75], v44 offset:12288
v_mfma_f32_16x16x32_bf16 v[100:103], a[52:55], v[220:223], v[100:103]
v_mfma_f32_16x16x32_bf16 v[104:107], a[56:59], v[216:219], v[104:107]
s_waitcnt lgkmcnt(6)
ds_read_b64_tr_b16 a[76:77], v45 offset:8192
ds_read_b64_tr_b16 a[78:79], v45 offset:12288
v_mfma_f32_16x16x32_bf16 v[108:111], a[56:59], v[220:223], v[108:111]
buffer_load_dwordx4 v[252:255], v1, s[12:15], s38 offen offset:3072 sc1
v_mfma_f32_16x16x32_bf16 v[112:115], a[60:63], v[216:219], v[112:115]
s_waitcnt lgkmcnt(6)
s_lshl_b32 s91, s2, 2
s_add_u32 s91, s91, s3
v_mfma_f32_16x16x32_bf16 v[116:119], a[60:63], v[220:223], v[116:119]
s_lshl_b32 s37, s41, 8
s_and_b32 s37, s37, 0x3000
s_add_u32 s37, s37, s85
v_mfma_f32_16x16x32_bf16 v[120:123], a[64:67], v[216:219], v[120:123]
s_waitcnt lgkmcnt(4)
ds_read_b64_tr_b16 a[48:49], v46 offset:0
ds_read_b64_tr_b16 a[50:51], v46 offset:4096
v_mfma_f32_16x16x32_bf16 v[124:127], a[64:67], v[220:223], v[124:127]
buffer_load_dwordx4 a[0:3], v1, s[12:15], s37 offen offset:0 sc1
v_mfma_f32_16x16x32_bf16 v[128:131], a[68:71], v[216:219], v[128:131]
s_waitcnt lgkmcnt(4)
ds_read_b64_tr_b16 a[52:53], v47 offset:0
ds_read_b64_tr_b16 a[54:55], v47 offset:4096
v_mfma_f32_16x16x32_bf16 v[132:135], a[68:71], v[220:223], v[132:135]
s_lshl_b32 s91, s91, 10
s_add_u32 s91, s91, 122683392
v_mfma_f32_16x16x32_bf16 v[136:139], a[72:75], v[216:219], v[136:139]
s_waitcnt lgkmcnt(4)
ds_read_b64_tr_b16 a[56:57], v48 offset:0
ds_read_b64_tr_b16 a[58:59], v48 offset:4096
v_mfma_f32_16x16x32_bf16 v[140:143], a[72:75], v[220:223], v[140:143]
s_add_u32 s38, s37, 18432
v_mfma_f32_16x16x32_bf16 v[144:147], a[76:79], v[216:219], v[144:147]
s_waitcnt vmcnt(16)
ds_read_b64_tr_b16 a[60:61], v49 offset:0
ds_read_b64_tr_b16 a[62:63], v49 offset:4096
v_mfma_f32_16x16x32_bf16 v[148:151], a[76:79], v[220:223], v[148:151]
s_waitcnt vmcnt(5)
v_mfma_f32_16x16x32_bf16 v[152:155], a[96:99], v[224:227], v[152:155]
s_waitcnt lgkmcnt(6)
ds_read_b64_tr_b16 a[64:65], v50 offset:0
ds_read_b64_tr_b16 a[66:67], v50 offset:4096
buffer_store_dword a248, v17, s[12:15], s91 offen offset:128 sc1
v_mfma_f32_16x16x32_bf16 v[156:159], a[96:99], v[228:231], v[156:159]
buffer_load_dwordx4 a[4:7], v1, s[12:15], s38 offen offset:0 sc1
v_mfma_f32_16x16x32_bf16 v[88:91], a[48:51], v[224:227], v[88:91]
s_waitcnt lgkmcnt(6)
ds_read_b64_tr_b16 a[68:69], v51 offset:0
ds_read_b64_tr_b16 a[70:71], v51 offset:4096
v_mfma_f32_16x16x32_bf16 v[92:95], a[48:51], v[228:231], v[92:95]
buffer_load_dwordx4 a[8:11], v1, s[12:15], s37 offen offset:1024 sc1
v_mfma_f32_16x16x32_bf16 v[96:99], a[52:55], v[224:227], v[96:99]
s_waitcnt lgkmcnt(6)
ds_read_b64_tr_b16 a[72:73], v52 offset:0
ds_read_b64_tr_b16 a[74:75], v52 offset:4096
v_mfma_f32_16x16x32_bf16 v[100:103], a[52:55], v[228:231], v[100:103]
s_lshl_b32 s91, s34, 2
s_add_u32 s91, s91, s3
s_lshl_b32 s91, s91, 5
v_mfma_f32_16x16x32_bf16 v[104:107], a[56:59], v[224:227], v[104:107]
s_waitcnt lgkmcnt(6)
ds_read_b64_tr_b16 a[76:77], v53 offset:0
ds_read_b64_tr_b16 a[78:79], v53 offset:4096
v_mfma_f32_16x16x32_bf16 v[108:111], a[56:59], v[228:231], v[108:111]
s_lshr_b32 s72, s32, 1
s_add_u32 s91, s91, s72
s_lshl_b32 s91, s91, 10
v_mfma_f32_16x16x32_bf16 v[112:115], a[60:63], v[224:227], v[112:115]
s_waitcnt lgkmcnt(6)
s_add_u32 s91, s91, 122683392
v_and_b32 v7, 7, v0
v_mfma_f32_16x16x32_bf16 v[116:119], a[60:63], v[228:231], v[116:119]
buffer_load_dwordx4 a[12:15], v1, s[12:15], s38 offen offset:1024 sc1
v_mfma_f32_16x16x32_bf16 v[120:123], a[64:67], v[224:227], v[120:123]
s_waitcnt lgkmcnt(4)
ds_read_b64_tr_b16 a[48:49], v46 offset:8192
ds_read_b64_tr_b16 a[50:51], v46 offset:12288
v_mfma_f32_16x16x32_bf16 v[124:127], a[64:67], v[228:231], v[124:127]
v_lshlrev_b32 v7, 12, v7
s_add_u32 s91, s91, 128
v_mfma_f32_16x16x32_bf16 v[128:131], a[68:71], v[224:227], v[128:131]
s_waitcnt lgkmcnt(4)
ds_read_b64_tr_b16 a[52:53], v47 offset:8192
ds_read_b64_tr_b16 a[54:55], v47 offset:12288
v_mfma_f32_16x16x32_bf16 v[132:135], a[68:71], v[228:231], v[132:135]
buffer_load_dwordx4 a[16:19], v1, s[12:15], s37 offen offset:2048 sc1
v_mfma_f32_16x16x32_bf16 v[136:139], a[72:75], v[224:227], v[136:139]
s_waitcnt lgkmcnt(4)
ds_read_b64_tr_b16 a[56:57], v48 offset:8192
ds_read_b64_tr_b16 a[58:59], v48 offset:12288
v_mfma_f32_16x16x32_bf16 v[140:143], a[72:75], v[228:231], v[140:143]
v_mfma_f32_16x16x32_bf16 v[144:147], a[76:79], v[224:227], v[144:147]
ds_read_b64_tr_b16 a[60:61], v49 offset:8192
ds_read_b64_tr_b16 a[62:63], v49 offset:12288
v_mfma_f32_16x16x32_bf16 v[148:151], a[76:79], v[228:231], v[148:151]
v_mfma_f32_16x16x32_bf16 v[152:155], a[100:103], v[232:235], v[152:155]
s_waitcnt lgkmcnt(6)
ds_read_b64_tr_b16 a[64:65], v50 offset:8192
ds_read_b64_tr_b16 a[66:67], v50 offset:12288
v_mfma_f32_16x16x32_bf16 v[156:159], a[100:103], v[236:239], v[156:159]
buffer_load_dwordx4 a[20:23], v1, s[12:15], s38 offen offset:2048 sc1
v_mfma_f32_16x16x32_bf16 v[88:91], a[48:51], v[232:235], v[88:91]
s_waitcnt lgkmcnt(6)
ds_read_b64_tr_b16 a[68:69], v51 offset:8192
ds_read_b64_tr_b16 a[70:71], v51 offset:12288
v_mfma_f32_16x16x32_bf16 v[92:95], a[48:51], v[236:239], v[92:95]
v_mfma_f32_16x16x32_bf16 v[96:99], a[52:55], v[232:235], v[96:99]
s_waitcnt lgkmcnt(6)
ds_read_b64_tr_b16 a[72:73], v52 offset:8192
ds_read_b64_tr_b16 a[74:75], v52 offset:12288
v_mfma_f32_16x16x32_bf16 v[100:103], a[52:55], v[236:239], v[100:103]
buffer_load_dwordx4 a[24:27], v1, s[12:15], s37 offen offset:3072 sc1
v_mfma_f32_16x16x32_bf16 v[104:107], a[56:59], v[232:235], v[104:107]
s_waitcnt lgkmcnt(6)
ds_read_b64_tr_b16 a[76:77], v53 offset:8192
ds_read_b64_tr_b16 a[78:79], v53 offset:12288
v_mfma_f32_16x16x32_bf16 v[108:111], a[56:59], v[236:239], v[108:111]
v_mfma_f32_16x16x32_bf16 v[112:115], a[60:63], v[232:235], v[112:115]
s_waitcnt lgkmcnt(6)
v_mfma_f32_16x16x32_bf16 v[116:119], a[60:63], v[236:239], v[116:119]
v_mfma_f32_16x16x32_bf16 v[120:123], a[64:67], v[232:235], v[120:123]
s_waitcnt lgkmcnt(4)
ds_read_b64_tr_b16 a[48:49], v38 offset:16384
ds_read_b64_tr_b16 a[50:51], v38 offset:20480
v_mfma_f32_16x16x32_bf16 v[124:127], a[64:67], v[236:239], v[124:127]
buffer_load_dwordx4 a[28:31], v1, s[12:15], s38 offen offset:3072 sc1
v_mfma_f32_16x16x32_bf16 v[128:131], a[68:71], v[232:235], v[128:131]
s_waitcnt lgkmcnt(4)
ds_read_b64_tr_b16 a[52:53], v39 offset:16384
ds_read_b64_tr_b16 a[54:55], v39 offset:20480
v_mfma_f32_16x16x32_bf16 v[132:135], a[68:71], v[236:239], v[132:135]
s_lshl_b32 s37, s41, 6
s_and_b32 s37, s37, 0x3000
s_add_u32 s37, s37, s85
v_mfma_f32_16x16x32_bf16 v[136:139], a[72:75], v[232:235], v[136:139]
s_waitcnt lgkmcnt(4)
ds_read_b64_tr_b16 a[56:57], v40 offset:16384
ds_read_b64_tr_b16 a[58:59], v40 offset:20480
v_mfma_f32_16x16x32_bf16 v[140:143], a[72:75], v[236:239], v[140:143]
buffer_load_dwordx4 a[32:35], v1, s[12:15], s37 offen offset:0 sc1
v_mfma_f32_16x16x32_bf16 v[144:147], a[76:79], v[232:235], v[144:147]
s_waitcnt vmcnt(12)
ds_read_b64_tr_b16 a[60:61], v41 offset:16384
ds_read_b64_tr_b16 a[62:63], v41 offset:20480
v_mfma_f32_16x16x32_bf16 v[148:151], a[76:79], v[236:239], v[148:151]
v_mfma_f32_16x16x32_bf16 v[152:155], a[104:107], v[240:243], v[152:155]
s_waitcnt lgkmcnt(6)
ds_read_b64_tr_b16 a[64:65], v42 offset:16384
ds_read_b64_tr_b16 a[66:67], v42 offset:20480
v_mfma_f32_16x16x32_bf16 v[156:159], a[104:107], v[244:247], v[156:159]
s_add_u32 s38, s37, 18432
v_mfma_f32_16x16x32_bf16 v[88:91], a[48:51], v[240:243], v[88:91]
s_waitcnt lgkmcnt(6)
ds_read_b64_tr_b16 a[68:69], v43 offset:16384
ds_read_b64_tr_b16 a[70:71], v43 offset:20480
v_mfma_f32_16x16x32_bf16 v[92:95], a[48:51], v[244:247], v[92:95]
buffer_load_dwordx4 a[36:39], v1, s[12:15], s38 offen offset:0 sc1
v_mfma_f32_16x16x32_bf16 v[96:99], a[52:55], v[240:243], v[96:99]
s_waitcnt lgkmcnt(6)
ds_read_b64_tr_b16 a[72:73], v44 offset:16384
ds_read_b64_tr_b16 a[74:75], v44 offset:20480
v_mfma_f32_16x16x32_bf16 v[100:103], a[52:55], v[244:247], v[100:103]
v_mfma_f32_16x16x32_bf16 v[104:107], a[56:59], v[240:243], v[104:107]
s_waitcnt lgkmcnt(6)
ds_read_b64_tr_b16 a[76:77], v45 offset:16384
ds_read_b64_tr_b16 a[78:79], v45 offset:20480
v_mfma_f32_16x16x32_bf16 v[108:111], a[56:59], v[244:247], v[108:111]
buffer_load_dwordx4 a[40:43], v1, s[12:15], s37 offen offset:1024 sc1
v_mfma_f32_16x16x32_bf16 v[112:115], a[60:63], v[240:243], v[112:115]
s_waitcnt lgkmcnt(6)
v_mfma_f32_16x16x32_bf16 v[116:119], a[60:63], v[244:247], v[116:119]
v_mfma_f32_16x16x32_bf16 v[120:123], a[64:67], v[240:243], v[120:123]
s_waitcnt lgkmcnt(4)
ds_read_b64_tr_b16 a[48:49], v38 offset:24576
ds_read_b64_tr_b16 a[50:51], v38 offset:28672
v_mfma_f32_16x16x32_bf16 v[124:127], a[64:67], v[244:247], v[124:127]
v_mfma_f32_16x16x32_bf16 v[128:131], a[68:71], v[240:243], v[128:131]
s_waitcnt lgkmcnt(4)
ds_read_b64_tr_b16 a[52:53], v39 offset:24576
ds_read_b64_tr_b16 a[54:55], v39 offset:28672
v_mfma_f32_16x16x32_bf16 v[132:135], a[68:71], v[244:247], v[132:135]
buffer_load_dwordx4 a[44:47], v1, s[12:15], s38 offen offset:1024 sc1
v_mfma_f32_16x16x32_bf16 v[136:139], a[72:75], v[240:243], v[136:139]
s_waitcnt lgkmcnt(4)
ds_read_b64_tr_b16 a[56:57], v40 offset:24576
ds_read_b64_tr_b16 a[58:59], v40 offset:28672
v_mfma_f32_16x16x32_bf16 v[140:143], a[72:75], v[244:247], v[140:143]
v_mfma_f32_16x16x32_bf16 v[144:147], a[76:79], v[240:243], v[144:147]
s_waitcnt vmcnt(13)
ds_read_b64_tr_b16 a[60:61], v41 offset:24576
ds_read_b64_tr_b16 a[62:63], v41 offset:28672
v_mfma_f32_16x16x32_bf16 v[148:151], a[76:79], v[244:247], v[148:151]
buffer_load_dwordx4 a[216:219], v1, s[12:15], s37 offen offset:2048 sc1
v_mfma_f32_16x16x32_bf16 v[152:155], a[108:111], v[248:251], v[152:155]
s_waitcnt lgkmcnt(6)
ds_read_b64_tr_b16 a[64:65], v42 offset:24576
ds_read_b64_tr_b16 a[66:67], v42 offset:28672
v_mfma_f32_16x16x32_bf16 v[156:159], a[108:111], v[252:255], v[156:159]
v_mfma_f32_16x16x32_bf16 v[88:91], a[48:51], v[248:251], v[88:91]
s_waitcnt lgkmcnt(6)
ds_read_b64_tr_b16 a[68:69], v43 offset:24576
ds_read_b64_tr_b16 a[70:71], v43 offset:28672
v_mfma_f32_16x16x32_bf16 v[92:95], a[48:51], v[252:255], v[92:95]
v_mfma_f32_16x16x32_bf16 v[96:99], a[52:55], v[248:251], v[96:99]
s_waitcnt lgkmcnt(6)
ds_read_b64_tr_b16 a[72:73], v44 offset:24576
ds_read_b64_tr_b16 a[74:75], v44 offset:28672
v_mfma_f32_16x16x32_bf16 v[100:103], a[52:55], v[252:255], v[100:103]
buffer_load_dwordx4 a[220:223], v1, s[12:15], s38 offen offset:2048 sc1
v_mfma_f32_16x16x32_bf16 v[104:107], a[56:59], v[248:251], v[104:107]
s_waitcnt lgkmcnt(6)
ds_read_b64_tr_b16 a[76:77], v45 offset:24576
ds_read_b64_tr_b16 a[78:79], v45 offset:28672
v_mfma_f32_16x16x32_bf16 v[108:111], a[56:59], v[252:255], v[108:111]
v_mfma_f32_16x16x32_bf16 v[112:115], a[60:63], v[248:251], v[112:115]
s_waitcnt lgkmcnt(6)
v_mfma_f32_16x16x32_bf16 v[116:119], a[60:63], v[252:255], v[116:119]
buffer_load_dwordx4 a[224:227], v1, s[12:15], s37 offen offset:3072 sc1
v_mfma_f32_16x16x32_bf16 v[120:123], a[64:67], v[248:251], v[120:123]
s_waitcnt lgkmcnt(4)
ds_read_b64_tr_b16 a[48:49], v46 offset:16384
ds_read_b64_tr_b16 a[50:51], v46 offset:20480
v_mfma_f32_16x16x32_bf16 v[124:127], a[64:67], v[252:255], v[124:127]
v_mfma_f32_16x16x32_bf16 v[128:131], a[68:71], v[248:251], v[128:131]
s_waitcnt lgkmcnt(4)
ds_read_b64_tr_b16 a[52:53], v47 offset:16384
ds_read_b64_tr_b16 a[54:55], v47 offset:20480
v_mfma_f32_16x16x32_bf16 v[132:135], a[68:71], v[252:255], v[132:135]
v_mfma_f32_16x16x32_bf16 v[136:139], a[72:75], v[248:251], v[136:139]
s_waitcnt lgkmcnt(4)
ds_read_b64_tr_b16 a[56:57], v48 offset:16384
ds_read_b64_tr_b16 a[58:59], v48 offset:20480
v_mfma_f32_16x16x32_bf16 v[140:143], a[72:75], v[252:255], v[140:143]
buffer_load_dwordx4 a[228:231], v1, s[12:15], s38 offen offset:3072 sc1
v_mfma_f32_16x16x32_bf16 v[144:147], a[76:79], v[248:251], v[144:147]
s_waitcnt vmcnt(14)
ds_read_b64_tr_b16 a[60:61], v49 offset:16384
ds_read_b64_tr_b16 a[62:63], v49 offset:20480
v_mfma_f32_16x16x32_bf16 v[148:151], a[76:79], v[252:255], v[148:151]
s_add_u32 s37, s85, 16384
v_mfma_f32_16x16x32_bf16 v[152:155], a[112:115], a[0:3], v[152:155]
s_waitcnt lgkmcnt(6)
ds_read_b64_tr_b16 a[64:65], v50 offset:16384
ds_read_b64_tr_b16 a[66:67], v50 offset:20480
v_mfma_f32_16x16x32_bf16 v[156:159], a[112:115], a[4:7], v[156:159]
buffer_load_dwordx4 a[232:235], v1, s[12:15], s37 offen offset:0 sc1
v_mfma_f32_16x16x32_bf16 v[88:91], a[48:51], a[0:3], v[88:91]
s_waitcnt lgkmcnt(6)
ds_read_b64_tr_b16 a[68:69], v51 offset:16384
ds_read_b64_tr_b16 a[70:71], v51 offset:20480
v_mfma_f32_16x16x32_bf16 v[92:95], a[48:51], a[4:7], v[92:95]
v_mfma_f32_16x16x32_bf16 v[96:99], a[52:55], a[0:3], v[96:99]
s_waitcnt lgkmcnt(6)
ds_read_b64_tr_b16 a[72:73], v52 offset:16384
ds_read_b64_tr_b16 a[74:75], v52 offset:20480
v_mfma_f32_16x16x32_bf16 v[100:103], a[52:55], a[4:7], v[100:103]
s_add_u32 s38, s37, 18432
v_mfma_f32_16x16x32_bf16 v[104:107], a[56:59], a[0:3], v[104:107]
s_waitcnt lgkmcnt(6)
ds_read_b64_tr_b16 a[76:77], v53 offset:16384
ds_read_b64_tr_b16 a[78:79], v53 offset:20480
v_mfma_f32_16x16x32_bf16 v[108:111], a[56:59], a[4:7], v[108:111]
buffer_load_dwordx4 a[236:239], v1, s[12:15], s38 offen offset:0 sc1
v_mfma_f32_16x16x32_bf16 v[112:115], a[60:63], a[0:3], v[112:115]
s_waitcnt lgkmcnt(6)
v_mfma_f32_16x16x32_bf16 v[116:119], a[60:63], a[4:7], v[116:119]
v_mfma_f32_16x16x32_bf16 v[120:123], a[64:67], a[0:3], v[120:123]
s_waitcnt lgkmcnt(4)
ds_read_b64_tr_b16 a[48:49], v46 offset:24576
ds_read_b64_tr_b16 a[50:51], v46 offset:28672
v_mfma_f32_16x16x32_bf16 v[124:127], a[64:67], a[4:7], v[124:127]
buffer_load_dwordx4 a[240:243], v1, s[12:15], s37 offen offset:1024 sc1
v_mfma_f32_16x16x32_bf16 v[128:131], a[68:71], a[0:3], v[128:131]
s_waitcnt lgkmcnt(4)
ds_read_b64_tr_b16 a[52:53], v47 offset:24576
ds_read_b64_tr_b16 a[54:55], v47 offset:28672
v_mfma_f32_16x16x32_bf16 v[132:135], a[68:71], a[4:7], v[132:135]
v_mfma_f32_16x16x32_bf16 v[136:139], a[72:75], a[0:3], v[136:139]
s_waitcnt lgkmcnt(4)
ds_read_b64_tr_b16 a[56:57], v48 offset:24576
ds_read_b64_tr_b16 a[58:59], v48 offset:28672
v_mfma_f32_16x16x32_bf16 v[140:143], a[72:75], a[4:7], v[140:143]
v_mfma_f32_16x16x32_bf16 v[144:147], a[76:79], a[0:3], v[144:147]
s_waitcnt vmcnt(15)
ds_read_b64_tr_b16 a[60:61], v49 offset:24576
ds_read_b64_tr_b16 a[62:63], v49 offset:28672
v_mfma_f32_16x16x32_bf16 v[148:151], a[76:79], a[4:7], v[148:151]
buffer_load_dwordx4 a[244:247], v1, s[12:15], s38 offen offset:1024 sc1
v_mfma_f32_16x16x32_bf16 v[152:155], a[116:119], a[8:11], v[152:155]
s_waitcnt lgkmcnt(6)
ds_read_b64_tr_b16 a[64:65], v50 offset:24576
ds_read_b64_tr_b16 a[66:67], v50 offset:28672
v_mfma_f32_16x16x32_bf16 v[156:159], a[116:119], a[12:15], v[156:159]
v_mfma_f32_16x16x32_bf16 v[88:91], a[48:51], a[8:11], v[88:91]
s_waitcnt lgkmcnt(6)
ds_read_b64_tr_b16 a[68:69], v51 offset:24576
ds_read_b64_tr_b16 a[70:71], v51 offset:28672
v_mfma_f32_16x16x32_bf16 v[92:95], a[48:51], a[12:15], v[92:95]
v_mfma_f32_16x16x32_bf16 v[96:99], a[52:55], a[8:11], v[96:99]
s_waitcnt lgkmcnt(6)
ds_read_b64_tr_b16 a[72:73], v52 offset:24576
ds_read_b64_tr_b16 a[74:75], v52 offset:28672
v_mfma_f32_16x16x32_bf16 v[100:103], a[52:55], a[12:15], v[100:103]
v_mfma_f32_16x16x32_bf16 v[104:107], a[56:59], a[8:11], v[104:107]
s_waitcnt lgkmcnt(6)
ds_read_b64_tr_b16 a[76:77], v53 offset:24576
ds_read_b64_tr_b16 a[78:79], v53 offset:28672
v_mfma_f32_16x16x32_bf16 v[108:111], a[56:59], a[12:15], v[108:111]
v_mfma_f32_16x16x32_bf16 v[112:115], a[60:63], a[8:11], v[112:115]
s_waitcnt lgkmcnt(6)
v_mfma_f32_16x16x32_bf16 v[116:119], a[60:63], a[12:15], v[116:119]
v_mfma_f32_16x16x32_bf16 v[120:123], a[64:67], a[8:11], v[120:123]
s_waitcnt lgkmcnt(4)
ds_read_b64_tr_b16 a[48:49], v38 offset:32768
ds_read_b64_tr_b16 a[50:51], v38 offset:36864
v_mfma_f32_16x16x32_bf16 v[124:127], a[64:67], a[12:15], v[124:127]
v_mfma_f32_16x16x32_bf16 v[128:131], a[68:71], a[8:11], v[128:131]
s_waitcnt lgkmcnt(4)
ds_read_b64_tr_b16 a[52:53], v39 offset:32768
ds_read_b64_tr_b16 a[54:55], v39 offset:36864
v_mfma_f32_16x16x32_bf16 v[132:135], a[68:71], a[12:15], v[132:135]
v_mfma_f32_16x16x32_bf16 v[136:139], a[72:75], a[8:11], v[136:139]
s_waitcnt lgkmcnt(4)
ds_read_b64_tr_b16 a[56:57], v40 offset:32768
ds_read_b64_tr_b16 a[58:59], v40 offset:36864
v_mfma_f32_16x16x32_bf16 v[140:143], a[72:75], a[12:15], v[140:143]
v_mfma_f32_16x16x32_bf16 v[144:147], a[76:79], a[8:11], v[144:147]
s_waitcnt vmcnt(14)
ds_read_b64_tr_b16 a[60:61], v41 offset:32768
ds_read_b64_tr_b16 a[62:63], v41 offset:36864
v_mfma_f32_16x16x32_bf16 v[148:151], a[76:79], a[12:15], v[148:151]
v_mfma_f32_16x16x32_bf16 v[152:155], a[120:123], a[16:19], v[152:155]
s_waitcnt lgkmcnt(6)
ds_read_b64_tr_b16 a[64:65], v42 offset:32768
ds_read_b64_tr_b16 a[66:67], v42 offset:36864
v_mfma_f32_16x16x32_bf16 v[156:159], a[120:123], a[20:23], v[156:159]
v_mfma_f32_16x16x32_bf16 v[88:91], a[48:51], a[16:19], v[88:91]
s_waitcnt lgkmcnt(6)
ds_read_b64_tr_b16 a[68:69], v43 offset:32768
ds_read_b64_tr_b16 a[70:71], v43 offset:36864
v_mfma_f32_16x16x32_bf16 v[92:95], a[48:51], a[20:23], v[92:95]
v_mfma_f32_16x16x32_bf16 v[96:99], a[52:55], a[16:19], v[96:99]
s_waitcnt lgkmcnt(6)
ds_read_b64_tr_b16 a[72:73], v44 offset:32768
ds_read_b64_tr_b16 a[74:75], v44 offset:36864
v_mfma_f32_16x16x32_bf16 v[100:103], a[52:55], a[20:23], v[100:103]
v_mfma_f32_16x16x32_bf16 v[104:107], a[56:59], a[16:19], v[104:107]
s_waitcnt lgkmcnt(6)
ds_read_b64_tr_b16 a[76:77], v45 offset:32768
ds_read_b64_tr_b16 a[78:79], v45 offset:36864
v_mfma_f32_16x16x32_bf16 v[108:111], a[56:59], a[20:23], v[108:111]
v_mfma_f32_16x16x32_bf16 v[112:115], a[60:63], a[16:19], v[112:115]
s_waitcnt lgkmcnt(6)
v_mfma_f32_16x16x32_bf16 v[116:119], a[60:63], a[20:23], v[116:119]
v_mfma_f32_16x16x32_bf16 v[120:123], a[64:67], a[16:19], v[120:123]
s_waitcnt lgkmcnt(4)
ds_read_b64_tr_b16 a[48:49], v38 offset:40960
ds_read_b64_tr_b16 a[50:51], v38 offset:45056
v_mfma_f32_16x16x32_bf16 v[124:127], a[64:67], a[20:23], v[124:127]
v_mfma_f32_16x16x32_bf16 v[128:131], a[68:71], a[16:19], v[128:131]
s_waitcnt lgkmcnt(4)
ds_read_b64_tr_b16 a[52:53], v39 offset:40960
ds_read_b64_tr_b16 a[54:55], v39 offset:45056
v_mfma_f32_16x16x32_bf16 v[132:135], a[68:71], a[20:23], v[132:135]
v_mfma_f32_16x16x32_bf16 v[136:139], a[72:75], a[16:19], v[136:139]
s_waitcnt lgkmcnt(4)
ds_read_b64_tr_b16 a[56:57], v40 offset:40960
ds_read_b64_tr_b16 a[58:59], v40 offset:45056
v_mfma_f32_16x16x32_bf16 v[140:143], a[72:75], a[20:23], v[140:143]
v_mfma_f32_16x16x32_bf16 v[144:147], a[76:79], a[16:19], v[144:147]
s_waitcnt vmcnt(12)
ds_read_b64_tr_b16 a[60:61], v41 offset:40960
ds_read_b64_tr_b16 a[62:63], v41 offset:45056
v_mfma_f32_16x16x32_bf16 v[148:151], a[76:79], a[20:23], v[148:151]
v_mfma_f32_16x16x32_bf16 v[152:155], a[124:127], a[24:27], v[152:155]
s_waitcnt lgkmcnt(6)
ds_read_b64_tr_b16 a[64:65], v42 offset:40960
ds_read_b64_tr_b16 a[66:67], v42 offset:45056
v_mfma_f32_16x16x32_bf16 v[156:159], a[124:127], a[28:31], v[156:159]
v_mfma_f32_16x16x32_bf16 v[88:91], a[48:51], a[24:27], v[88:91]
s_waitcnt lgkmcnt(6)
ds_read_b64_tr_b16 a[68:69], v43 offset:40960
ds_read_b64_tr_b16 a[70:71], v43 offset:45056
v_mfma_f32_16x16x32_bf16 v[92:95], a[48:51], a[28:31], v[92:95]
buffer_load_dword v8, v7, s[12:15], s91 offen sc1
v_mfma_f32_16x16x32_bf16 v[96:99], a[52:55], a[24:27], v[96:99]
s_waitcnt lgkmcnt(6)
ds_read_b64_tr_b16 a[72:73], v44 offset:40960
ds_read_b64_tr_b16 a[74:75], v44 offset:45056
v_mfma_f32_16x16x32_bf16 v[100:103], a[52:55], a[28:31], v[100:103]
v_mfma_f32_16x16x32_bf16 v[104:107], a[56:59], a[24:27], v[104:107]
s_waitcnt lgkmcnt(6)
ds_read_b64_tr_b16 a[76:77], v45 offset:40960
ds_read_b64_tr_b16 a[78:79], v45 offset:45056
v_mfma_f32_16x16x32_bf16 v[108:111], a[56:59], a[28:31], v[108:111]
v_mfma_f32_16x16x32_bf16 v[112:115], a[60:63], a[24:27], v[112:115]
s_waitcnt lgkmcnt(6)
v_mfma_f32_16x16x32_bf16 v[116:119], a[60:63], a[28:31], v[116:119]
v_mfma_f32_16x16x32_bf16 v[120:123], a[64:67], a[24:27], v[120:123]
s_waitcnt lgkmcnt(4)
ds_read_b64_tr_b16 a[48:49], v46 offset:32768
ds_read_b64_tr_b16 a[50:51], v46 offset:36864
v_mfma_f32_16x16x32_bf16 v[124:127], a[64:67], a[28:31], v[124:127]
v_mfma_f32_16x16x32_bf16 v[128:131], a[68:71], a[24:27], v[128:131]
s_waitcnt lgkmcnt(4)
ds_read_b64_tr_b16 a[52:53], v47 offset:32768
ds_read_b64_tr_b16 a[54:55], v47 offset:36864
v_mfma_f32_16x16x32_bf16 v[132:135], a[68:71], a[28:31], v[132:135]
v_mfma_f32_16x16x32_bf16 v[136:139], a[72:75], a[24:27], v[136:139]
s_waitcnt lgkmcnt(4)
ds_read_b64_tr_b16 a[56:57], v48 offset:32768
ds_read_b64_tr_b16 a[58:59], v48 offset:36864
v_mfma_f32_16x16x32_bf16 v[140:143], a[72:75], a[28:31], v[140:143]
v_mfma_f32_16x16x32_bf16 v[144:147], a[76:79], a[24:27], v[144:147]
s_waitcnt vmcnt(11)
ds_read_b64_tr_b16 a[60:61], v49 offset:32768
ds_read_b64_tr_b16 a[62:63], v49 offset:36864
v_mfma_f32_16x16x32_bf16 v[148:151], a[76:79], a[28:31], v[148:151]
v_mfma_f32_16x16x32_bf16 v[152:155], a[128:131], a[32:35], v[152:155]
s_waitcnt lgkmcnt(6)
ds_read_b64_tr_b16 a[64:65], v50 offset:32768
ds_read_b64_tr_b16 a[66:67], v50 offset:36864
v_mfma_f32_16x16x32_bf16 v[156:159], a[128:131], a[36:39], v[156:159]
v_mfma_f32_16x16x32_bf16 v[88:91], a[48:51], a[32:35], v[88:91]
s_waitcnt lgkmcnt(6)
ds_read_b64_tr_b16 a[68:69], v51 offset:32768
ds_read_b64_tr_b16 a[70:71], v51 offset:36864
v_mfma_f32_16x16x32_bf16 v[92:95], a[48:51], a[36:39], v[92:95]
v_mfma_f32_16x16x32_bf16 v[96:99], a[52:55], a[32:35], v[96:99]
s_waitcnt lgkmcnt(6)
ds_read_b64_tr_b16 a[72:73], v52 offset:32768
ds_read_b64_tr_b16 a[74:75], v52 offset:36864
v_mfma_f32_16x16x32_bf16 v[100:103], a[52:55], a[36:39], v[100:103]
v_mfma_f32_16x16x32_bf16 v[104:107], a[56:59], a[32:35], v[104:107]
s_waitcnt lgkmcnt(6)
ds_read_b64_tr_b16 a[76:77], v53 offset:32768
ds_read_b64_tr_b16 a[78:79], v53 offset:36864
v_mfma_f32_16x16x32_bf16 v[108:111], a[56:59], a[36:39], v[108:111]
v_mfma_f32_16x16x32_bf16 v[112:115], a[60:63], a[32:35], v[112:115]
s_waitcnt lgkmcnt(6)
v_mfma_f32_16x16x32_bf16 v[116:119], a[60:63], a[36:39], v[116:119]
v_mfma_f32_16x16x32_bf16 v[120:123], a[64:67], a[32:35], v[120:123]
s_waitcnt lgkmcnt(4)
ds_read_b64_tr_b16 a[48:49], v38 offset:49152
ds_read_b64_tr_b16 a[50:51], v38 offset:53248
v_mfma_f32_16x16x32_bf16 v[124:127], a[64:67], a[36:39], v[124:127]
v_mfma_f32_16x16x32_bf16 v[128:131], a[68:71], a[32:35], v[128:131]
s_waitcnt lgkmcnt(4)
ds_read_b64_tr_b16 a[52:53], v39 offset:49152
ds_read_b64_tr_b16 a[54:55], v39 offset:53248
v_mfma_f32_16x16x32_bf16 v[132:135], a[68:71], a[36:39], v[132:135]
v_mfma_f32_16x16x32_bf16 v[136:139], a[72:75], a[32:35], v[136:139]
s_waitcnt lgkmcnt(4)
ds_read_b64_tr_b16 a[56:57], v40 offset:49152
ds_read_b64_tr_b16 a[58:59], v40 offset:53248
v_mfma_f32_16x16x32_bf16 v[140:143], a[72:75], a[36:39], v[140:143]
v_mfma_f32_16x16x32_bf16 v[144:147], a[76:79], a[32:35], v[144:147]
s_waitcnt vmcnt(9)
ds_read_b64_tr_b16 a[60:61], v41 offset:49152
ds_read_b64_tr_b16 a[62:63], v41 offset:53248
v_mfma_f32_16x16x32_bf16 v[148:151], a[76:79], a[36:39], v[148:151]
v_mfma_f32_16x16x32_bf16 v[152:155], a[132:135], a[40:43], v[152:155]
s_waitcnt lgkmcnt(6)
ds_read_b64_tr_b16 a[64:65], v42 offset:49152
ds_read_b64_tr_b16 a[66:67], v42 offset:53248
v_mfma_f32_16x16x32_bf16 v[156:159], a[132:135], a[44:47], v[156:159]
v_mfma_f32_16x16x32_bf16 v[88:91], a[48:51], a[40:43], v[88:91]
s_waitcnt lgkmcnt(6)
ds_read_b64_tr_b16 a[68:69], v43 offset:49152
ds_read_b64_tr_b16 a[70:71], v43 offset:53248
v_mfma_f32_16x16x32_bf16 v[92:95], a[48:51], a[44:47], v[92:95]
v_mfma_f32_16x16x32_bf16 v[96:99], a[52:55], a[40:43], v[96:99]
s_waitcnt lgkmcnt(6)
ds_read_b64_tr_b16 a[72:73], v44 offset:49152
ds_read_b64_tr_b16 a[74:75], v44 offset:53248
v_mfma_f32_16x16x32_bf16 v[100:103], a[52:55], a[44:47], v[100:103]
v_mfma_f32_16x16x32_bf16 v[104:107], a[56:59], a[40:43], v[104:107]
s_waitcnt lgkmcnt(6)
ds_read_b64_tr_b16 a[76:77], v45 offset:49152
ds_read_b64_tr_b16 a[78:79], v45 offset:53248
v_mfma_f32_16x16x32_bf16 v[108:111], a[56:59], a[44:47], v[108:111]
v_mfma_f32_16x16x32_bf16 v[112:115], a[60:63], a[40:43], v[112:115]
s_waitcnt lgkmcnt(6)
v_mfma_f32_16x16x32_bf16 v[116:119], a[60:63], a[44:47], v[116:119]
v_mfma_f32_16x16x32_bf16 v[120:123], a[64:67], a[40:43], v[120:123]
s_waitcnt lgkmcnt(4)
ds_read_b64_tr_b16 a[48:49], v38 offset:57344
ds_read_b64_tr_b16 a[50:51], v38 offset:61440
v_mfma_f32_16x16x32_bf16 v[124:127], a[64:67], a[44:47], v[124:127]
v_mfma_f32_16x16x32_bf16 v[128:131], a[68:71], a[40:43], v[128:131]
s_waitcnt lgkmcnt(4)
ds_read_b64_tr_b16 a[52:53], v39 offset:57344
ds_read_b64_tr_b16 a[54:55], v39 offset:61440
v_mfma_f32_16x16x32_bf16 v[132:135], a[68:71], a[44:47], v[132:135]
v_mfma_f32_16x16x32_bf16 v[136:139], a[72:75], a[40:43], v[136:139]
s_waitcnt lgkmcnt(4)
ds_read_b64_tr_b16 a[56:57], v40 offset:57344
ds_read_b64_tr_b16 a[58:59], v40 offset:61440
v_mfma_f32_16x16x32_bf16 v[140:143], a[72:75], a[44:47], v[140:143]
v_mfma_f32_16x16x32_bf16 v[144:147], a[76:79], a[40:43], v[144:147]
s_waitcnt vmcnt(7)
ds_read_b64_tr_b16 a[60:61], v41 offset:57344
ds_read_b64_tr_b16 a[62:63], v41 offset:61440
v_mfma_f32_16x16x32_bf16 v[148:151], a[76:79], a[44:47], v[148:151]
v_mfma_f32_16x16x32_bf16 v[152:155], a[136:139], a[216:219], v[152:155]
s_waitcnt lgkmcnt(6)
ds_read_b64_tr_b16 a[64:65], v42 offset:57344
ds_read_b64_tr_b16 a[66:67], v42 offset:61440
v_mfma_f32_16x16x32_bf16 v[156:159], a[136:139], a[220:223], v[156:159]
v_mfma_f32_16x16x32_bf16 v[88:91], a[48:51], a[216:219], v[88:91]
s_waitcnt lgkmcnt(6)
ds_read_b64_tr_b16 a[68:69], v43 offset:57344
ds_read_b64_tr_b16 a[70:71], v43 offset:61440
v_mfma_f32_16x16x32_bf16 v[92:95], a[48:51], a[220:223], v[92:95]
v_mfma_f32_16x16x32_bf16 v[96:99], a[52:55], a[216:219], v[96:99]
s_waitcnt lgkmcnt(6)
ds_read_b64_tr_b16 a[72:73], v44 offset:57344
ds_read_b64_tr_b16 a[74:75], v44 offset:61440
v_mfma_f32_16x16x32_bf16 v[100:103], a[52:55], a[220:223], v[100:103]
v_mfma_f32_16x16x32_bf16 v[104:107], a[56:59], a[216:219], v[104:107]
s_waitcnt lgkmcnt(6)
ds_read_b64_tr_b16 a[76:77], v45 offset:57344
ds_read_b64_tr_b16 a[78:79], v45 offset:61440
v_mfma_f32_16x16x32_bf16 v[108:111], a[56:59], a[220:223], v[108:111]
s_mul_i32 s53, s36, 18432
s_add_u32 s53, s53, s75
s_add_u32 s53, s53, 167772160
v_mfma_f32_16x16x32_bf16 v[112:115], a[60:63], a[216:219], v[112:115]
s_waitcnt lgkmcnt(6)
s_add_u32 s54, s53, 18432
v_mfma_f32_16x16x32_bf16 v[116:119], a[60:63], a[220:223], v[116:119]
v_mfma_f32_16x16x32_bf16 v[120:123], a[64:67], a[216:219], v[120:123]
s_waitcnt lgkmcnt(4)
v_mfma_f32_16x16x32_bf16 v[124:127], a[64:67], a[220:223], v[124:127]
v_mfma_f32_16x16x32_bf16 v[128:131], a[68:71], a[216:219], v[128:131]
s_waitcnt lgkmcnt(2)
v_accvgpr_read_b32 v30, a200
v_accvgpr_read_b32 v31, a201
v_mfma_f32_16x16x32_bf16 v[132:135], a[68:71], a[220:223], v[132:135]
v_accvgpr_read_b32 v32, a202
v_accvgpr_read_b32 v33, a203
v_mfma_f32_16x16x32_bf16 v[136:139], a[72:75], a[216:219], v[136:139]
s_waitcnt lgkmcnt(0)
ds_read_b64_tr_b16 a[48:49], v46 offset:49152
ds_read_b64_tr_b16 a[50:51], v46 offset:53248
v_mfma_f32_16x16x32_bf16 v[140:143], a[72:75], a[220:223], v[140:143]
v_accvgpr_read_b32 v34, a204
v_lshlrev_b32 v20, 16, v30
v_mfma_f32_16x16x32_bf16 v[144:147], a[76:79], a[216:219], v[144:147]
s_waitcnt vmcnt(5)
ds_read_b64_tr_b16 a[52:53], v47 offset:49152
ds_read_b64_tr_b16 a[54:55], v47 offset:53248
v_mfma_f32_16x16x32_bf16 v[148:151], a[76:79], a[220:223], v[148:151]
v_and_b32 v21, 0xffff0000, v30
v_lshlrev_b32 v22, 16, v31
v_mfma_f32_16x16x32_bf16 v[152:155], a[140:143], a[224:227], v[152:155]
s_waitcnt vmcnt(3)
ds_read_b64_tr_b16 a[56:57], v46 offset:57344
ds_read_b64_tr_b16 a[58:59], v46 offset:61440
v_mfma_f32_16x16x32_bf16 v[156:159], a[140:143], a[228:231], v[156:159]
v_and_b32 v23, 0xffff0000, v31
v_lshlrev_b32 v24, 16, v32
v_mfma_f32_16x16x32_bf16 v[152:155], a[144:147], a[232:235], v[152:155]
s_waitcnt vmcnt(1)
ds_read_b64_tr_b16 a[60:61], v47 offset:57344
ds_read_b64_tr_b16 a[62:63], v47 offset:61440
v_mfma_f32_16x16x32_bf16 v[156:159], a[144:147], a[236:239], v[156:159]
v_and_b32 v25, 0xffff0000, v32
v_lshlrev_b32 v26, 16, v33
v_mfma_f32_16x16x32_bf16 v[152:155], a[148:151], a[240:243], v[152:155]
s_waitcnt lgkmcnt(6)
ds_read_b64_tr_b16 a[64:65], v46 offset:40960
ds_read_b64_tr_b16 a[66:67], v46 offset:45056
v_mfma_f32_16x16x32_bf16 v[156:159], a[148:151], a[244:247], v[156:159]
s_waitcnt vmcnt(0)
v_cmp_ne_u32 s[62:63], s60, v8
v_and_b32 v27, 0xffff0000, v33
v_mfma_f32_16x16x32_bf16 v[88:91], a[48:51], a[224:227], v[88:91]
s_waitcnt lgkmcnt(6)
ds_read_b64_tr_b16 a[68:69], v47 offset:40960
ds_read_b64_tr_b16 a[70:71], v47 offset:45056
v_mfma_f32_16x16x32_bf16 v[92:95], a[48:51], a[228:231], v[92:95]
s_cmp_lg_u64 s[62:63], 0
s_cbranch_scc1 L_kt_ft4
L_kt_fr4:
v_lshlrev_b32 v28, 16, v34
v_mfma_f32_16x16x32_bf16 v[96:99], a[52:55], a[224:227], v[96:99]
s_waitcnt lgkmcnt(6)
ds_read_b64_tr_b16 a[72:73], v48 offset:49152
ds_read_b64_tr_b16 a[74:75], v48 offset:53248
v_mfma_f32_16x16x32_bf16 v[100:103], a[52:55], a[228:231], v[100:103]
v_cvt_pk_bf16_f32 v152, v152, v153
v_cvt_pk_bf16_f32 v153, v154, v155
v_mfma_f32_16x16x32_bf16 v[88:91], a[56:59], a[232:235], v[88:91]
s_waitcnt lgkmcnt(6)
ds_read_b64_tr_b16 a[76:77], v49 offset:49152
ds_read_b64_tr_b16 a[78:79], v49 offset:53248
v_mfma_f32_16x16x32_bf16 v[92:95], a[56:59], a[236:239], v[92:95]
s_mul_i32 s56, s66, 18432
s_add_u32 s56, s56, s86
s_add_u32 s56, s56, 167772160
v_mfma_f32_16x16x32_bf16 v[96:99], a[60:63], a[232:235], v[96:99]
s_waitcnt lgkmcnt(6)
ds_read_b64_tr_b16 a[48:49], v48 offset:57344
ds_read_b64_tr_b16 a[50:51], v48 offset:61440
v_mfma_f32_16x16x32_bf16 v[100:103], a[60:63], a[236:239], v[100:103]
s_add_u32 s57, s56, 9437184
v_cvt_pk_bf16_f32 v154, v156, v157
v_cvt_pk_bf16_f32 v155, v158, v159
v_mfma_f32_16x16x32_bf16 v[88:91], a[64:67], a[240:243], v[88:91]
s_waitcnt lgkmcnt(6)
ds_read_b64_tr_b16 a[52:53], v49 offset:57344
ds_read_b64_tr_b16 a[54:55], v49 offset:61440
v_mfma_f32_16x16x32_bf16 v[92:95], a[64:67], a[244:247], v[92:95]
buffer_load_dwordx4 v[224:227], v13, s[12:15], s56 offen offset:1024 sc1
v_mfma_f32_16x16x32_bf16 v[96:99], a[68:71], a[240:243], v[96:99]
s_waitcnt lgkmcnt(6)
ds_read_b64_tr_b16 a[56:57], v48 offset:40960
ds_read_b64_tr_b16 a[58:59], v48 offset:45056
v_mfma_f32_16x16x32_bf16 v[100:103], a[68:71], a[244:247], v[100:103]
v_permlane32_swap_b32 v152, v154
v_permlane32_swap_b32 v153, v155
buffer_store_dwordx4 v[152:155], v10, s[12:15], s53 offen offset:1024 sc1
v_mfma_f32_16x16x32_bf16 v[104:107], a[72:75], a[224:227], v[104:107]
s_waitcnt lgkmcnt(6)
ds_read_b64_tr_b16 a[60:61], v49 offset:40960
ds_read_b64_tr_b16 a[62:63], v49 offset:45056
v_mfma_f32_16x16x32_bf16 v[108:111], a[72:75], a[228:231], v[108:111]
buffer_load_dwordx4 v[160:163], v12, s[12:15], s56 offen offset:0 sc1
v_mfma_f32_16x16x32_bf16 v[112:115], a[76:79], a[224:227], v[112:115]
s_waitcnt lgkmcnt(6)
ds_read_b64_tr_b16 a[64:65], v50 offset:49152
ds_read_b64_tr_b16 a[66:67], v50 offset:53248
v_mfma_f32_16x16x32_bf16 v[116:119], a[76:79], a[228:231], v[116:119]
v_cvt_pk_bf16_f32 v192, v88, v89
v_cvt_pk_bf16_f32 v193, v90, v91
v_mfma_f32_16x16x32_bf16 v[104:107], a[48:51], a[232:235], v[104:107]
s_waitcnt lgkmcnt(6)
ds_read_b64_tr_b16 a[68:69], v51 offset:49152
ds_read_b64_tr_b16 a[70:71], v51 offset:53248
v_mfma_f32_16x16x32_bf16 v[108:111], a[48:51], a[236:239], v[108:111]
v_cvt_pk_bf16_f32 v194, v96, v97
v_cvt_pk_bf16_f32 v195, v98, v99
buffer_store_dwordx4 v[192:195], v9, s[12:15], s53 offen offset:0 sc1
v_mfma_f32_16x16x32_bf16 v[112:115], a[52:55], a[232:235], v[112:115]
s_waitcnt lgkmcnt(6)
ds_read_b64_tr_b16 a[72:73], v50 offset:57344
ds_read_b64_tr_b16 a[74:75], v50 offset:61440
v_mfma_f32_16x16x32_bf16 v[116:119], a[52:55], a[236:239], v[116:119]
v_cvt_pk_bf16_f32 v196, v92, v93
v_cvt_pk_bf16_f32 v197, v94, v95
v_mfma_f32_16x16x32_bf16 v[104:107], a[56:59], a[240:243], v[104:107]
s_waitcnt lgkmcnt(6)
ds_read_b64_tr_b16 a[76:77], v51 offset:57344
ds_read_b64_tr_b16 a[78:79], v51 offset:61440
buffer_load_dwordx4 v[164:167], v12, s[12:15], s57 offen offset:0 sc1
v_mfma_f32_16x16x32_bf16 v[108:111], a[56:59], a[244:247], v[108:111]
v_cvt_pk_bf16_f32 v198, v100, v101
v_cvt_pk_bf16_f32 v199, v102, v103
buffer_store_dwordx4 v[196:199], v9, s[12:15], s54 offen offset:0 sc1
v_mfma_f32_16x16x32_bf16 v[112:115], a[60:63], a[240:243], v[112:115]
s_waitcnt lgkmcnt(6)
ds_read_b64_tr_b16 a[48:49], v50 offset:40960
ds_read_b64_tr_b16 a[50:51], v50 offset:45056
v_mfma_f32_16x16x32_bf16 v[116:119], a[60:63], a[244:247], v[116:119]
buffer_load_dwordx4 v[168:171], v12, s[12:15], s56 offen offset:256 sc1
v_mfma_f32_16x16x32_bf16 v[120:123], a[64:67], a[224:227], v[120:123]
s_waitcnt lgkmcnt(6)
ds_read_b64_tr_b16 a[52:53], v51 offset:40960
ds_read_b64_tr_b16 a[54:55], v51 offset:45056
v_mfma_f32_16x16x32_bf16 v[124:127], a[64:67], a[228:231], v[124:127]
v_cvt_pk_bf16_f32 v200, v104, v105
v_cvt_pk_bf16_f32 v201, v106, v107
v_mfma_f32_16x16x32_bf16 v[128:131], a[68:71], a[224:227], v[128:131]
s_waitcnt lgkmcnt(6)
ds_read_b64_tr_b16 a[56:57], v52 offset:49152
ds_read_b64_tr_b16 a[58:59], v52 offset:53248
v_mfma_f32_16x16x32_bf16 v[132:135], a[68:71], a[228:231], v[132:135]
v_cvt_pk_bf16_f32 v202, v112, v113
v_cvt_pk_bf16_f32 v203, v114, v115
v_mfma_f32_16x16x32_bf16 v[120:123], a[72:75], a[232:235], v[120:123]
s_waitcnt lgkmcnt(6)
ds_read_b64_tr_b16 a[60:61], v53 offset:49152
ds_read_b64_tr_b16 a[62:63], v53 offset:53248
v_mfma_f32_16x16x32_bf16 v[124:127], a[72:75], a[236:239], v[124:127]
buffer_store_dwordx4 v[200:203], v9, s[12:15], s53 offen offset:256 sc1
v_cvt_pk_bf16_f32 v204, v108, v109
v_mfma_f32_16x16x32_bf16 v[128:131], a[76:79], a[232:235], v[128:131]
s_waitcnt lgkmcnt(6)
ds_read_b64_tr_b16 a[64:65], v52 offset:57344
ds_read_b64_tr_b16 a[66:67], v52 offset:61440
buffer_load_dwordx4 v[172:175], v12, s[12:15], s57 offen offset:256 sc1
v_mfma_f32_16x16x32_bf16 v[132:135], a[76:79], a[236:239], v[132:135]
v_cvt_pk_bf16_f32 v205, v110, v111
v_cvt_pk_bf16_f32 v206, v116, v117
v_mfma_f32_16x16x32_bf16 v[120:123], a[48:51], a[240:243], v[120:123]
s_waitcnt lgkmcnt(6)
ds_read_b64_tr_b16 a[68:69], v53 offset:57344
ds_read_b64_tr_b16 a[70:71], v53 offset:61440
v_mfma_f32_16x16x32_bf16 v[124:127], a[48:51], a[244:247], v[124:127]
v_cvt_pk_bf16_f32 v207, v118, v119
buffer_store_dwordx4 v[204:207], v9, s[12:15], s54 offen offset:256 sc1
v_mfma_f32_16x16x32_bf16 v[128:131], a[52:55], a[240:243], v[128:131]
s_waitcnt lgkmcnt(6)
ds_read_b64_tr_b16 a[72:73], v52 offset:40960
ds_read_b64_tr_b16 a[74:75], v52 offset:45056
v_mfma_f32_16x16x32_bf16 v[132:135], a[52:55], a[244:247], v[132:135]
buffer_load_dwordx4 v[176:179], v12, s[12:15], s56 offen offset:512 sc1
v_mfma_f32_16x16x32_bf16 v[136:139], a[56:59], a[224:227], v[136:139]
s_waitcnt lgkmcnt(6)
ds_read_b64_tr_b16 a[76:77], v53 offset:40960
ds_read_b64_tr_b16 a[78:79], v53 offset:45056
v_mfma_f32_16x16x32_bf16 v[140:143], a[56:59], a[228:231], v[140:143]
v_cvt_pk_bf16_f32 v208, v120, v121
v_cvt_pk_bf16_f32 v209, v122, v123
v_mfma_f32_16x16x32_bf16 v[144:147], a[60:63], a[224:227], v[144:147]
s_waitcnt lgkmcnt(6)
v_cvt_pk_bf16_f32 v210, v128, v129
v_cvt_pk_bf16_f32 v211, v130, v131
v_mfma_f32_16x16x32_bf16 v[148:151], a[60:63], a[228:231], v[148:151]
v_cvt_pk_bf16_f32 v212, v124, v125
v_cvt_pk_bf16_f32 v213, v126, v127
v_mfma_f32_16x16x32_bf16 v[136:139], a[64:67], a[232:235], v[136:139]
s_waitcnt lgkmcnt(4)
buffer_load_dwordx4 v[180:183], v12, s[12:15], s57 offen offset:512 sc1
v_cvt_pk_bf16_f32 v214, v132, v133
v_cvt_pk_bf16_f32 v215, v134, v135
v_mfma_f32_16x16x32_bf16 v[140:143], a[64:67], a[236:239], v[140:143]
buffer_store_dwordx4 v[208:211], v9, s[12:15], s53 offen offset:512 sc1
v_mfma_f32_16x16x32_bf16 v[144:147], a[68:71], a[232:235], v[144:147]
s_waitcnt lgkmcnt(2)
buffer_store_dwordx4 v[212:215], v9, s[12:15], s54 offen offset:512 sc1
v_mfma_f32_16x16x32_bf16 v[148:151], a[68:71], a[236:239], v[148:151]
v_and_b32 v29, 0xffff0000, v34
s_mul_i32 s68, s66, 18432
v_mfma_f32_16x16x32_bf16 v[136:139], a[72:75], a[240:243], v[136:139]
s_waitcnt lgkmcnt(0)
s_add_u32 s69, s68, s88
s_add_u32 s70, s68, s89
v_mfma_f32_16x16x32_bf16 v[140:143], a[72:75], a[244:247], v[140:143]
buffer_load_dwordx4 v[184:187], v12, s[12:15], s56 offen offset:768 sc1
v_mfma_f32_16x16x32_bf16 v[144:147], a[76:79], a[240:243], v[144:147]
s_add_u32 s71, s68, s90
s_add_u32 s68, s68, s87
v_mfma_f32_16x16x32_bf16 v[148:151], a[76:79], a[244:247], v[148:151]
v_cvt_pk_bf16_f32 v216, v136, v137
v_cvt_pk_bf16_f32 v217, v138, v139
s_nop 2
v_cvt_pk_bf16_f32 v218, v144, v145
v_cvt_pk_bf16_f32 v219, v146, v147
v_cvt_pk_bf16_f32 v220, v140, v141
v_cvt_pk_bf16_f32 v221, v142, v143
buffer_store_dwordx4 v[216:219], v9, s[12:15], s53 offen offset:768 sc1
buffer_load_dwordx4 v[188:191], v12, s[12:15], s57 offen offset:768 sc1
v_cvt_pk_bf16_f32 v222, v148, v149
v_cvt_pk_bf16_f32 v223, v150, v151
buffer_store_dwordx4 v[220:223], v9, s[12:15], s54 offen offset:768 sc1
s_waitcnt vmcnt(1)
v_mfma_f32_16x16x32_bf16 v[84:87], a[160:163], v[224:227], 0
v_mfma_f32_16x16x32_bf16 v[76:79], a[152:155], v[160:163], 0
v_mfma_f32_16x16x32_bf16 v[80:83], a[152:155], v[176:179], 0
v_mfma_f32_16x16x32_bf16 v[76:79], a[152:155], v[164:167], v[76:79]
v_mfma_f32_16x16x32_bf16 v[80:83], a[152:155], v[180:183], v[80:83]
v_mfma_f32_16x16x32_bf16 v[76:79], a[156:159], v[168:171], v[76:79]
v_mfma_f32_16x16x32_bf16 v[80:83], a[156:159], v[184:187], v[80:83]
v_mfma_f32_16x16x32_bf16 v[76:79], a[156:159], v[172:175], v[76:79]
v_mfma_f32_16x16x32_bf16 v[80:83], a[156:159], v[188:191], v[80:83]
v_add_f32_dpp v84, v84, v84 row_ror:8 row_mask:0xf bank_mask:0xf
v_add_f32_dpp v85, v85, v85 row_ror:8 row_mask:0xf bank_mask:0xf
s_nop 4
v_cvt_pk_bf16_f32 v30, v76, v77
v_cvt_pk_bf16_f32 v31, v78, v79
v_cvt_pk_bf16_f32 v32, v80, v81
v_cvt_pk_bf16_f32 v33, v82, v83
v_cvt_pk_bf16_f32 v34, v84, v85
v_lshlrev_b32 v76, 16, v30
v_and_b32 v77, 0xffff0000, v30
v_lshlrev_b32 v78, 16, v31
v_and_b32 v79, 0xffff0000, v31
v_lshlrev_b32 v80, 16, v32
v_and_b32 v81, 0xffff0000, v32
v_lshlrev_b32 v82, 16, v33
v_and_b32 v83, 0xffff0000, v33
v_lshlrev_b32 v84, 16, v34
v_and_b32 v85, 0xffff0000, v34
v_add_f32 v76, v76, v20
v_add_f32 v77, v77, v21
v_add_f32 v78, v78, v22
v_add_f32 v79, v79, v23
v_add_f32 v80, v80, v24
v_add_f32 v81, v81, v25
v_add_f32 v82, v82, v26
v_add_f32 v83, v83, v27
v_add_f32 v84, v84, v28
v_add_f32 v85, v85, v29
v_cvt_pk_bf16_f32 v30, v76, v77
v_cvt_pk_bf16_f32 v31, v78, v79
v_cvt_pk_bf16_f32 v32, v80, v81
v_cvt_pk_bf16_f32 v33, v82, v83
v_cvt_pk_bf16_f32 v34, v84, v85
buffer_store_dwordx2 v[30:31], v14, s[28:31], s68 offen
buffer_store_dwordx2 v[32:33], v14, s[28:31], s68 offen offset:128
buffer_store_dword v34, v15, s[28:31], s69 offen
s_mul_i32 s56, s67, 18432
s_add_u32 s56, s56, s86
s_add_u32 s56, s56, 167772160
s_add_u32 s57, s56, 9437184
buffer_load_dwordx4 a[196:199], v13, s[12:15], s56 offen offset:1024 sc1
buffer_load_dwordx4 a[164:167], v12, s[12:15], s56 offen offset:0 sc1
buffer_load_dwordx4 a[168:171], v12, s[12:15], s57 offen offset:0 sc1
buffer_load_dwordx4 a[172:175], v12, s[12:15], s56 offen offset:256 sc1
buffer_load_dwordx4 a[176:179], v12, s[12:15], s57 offen offset:256 sc1
buffer_load_dwordx4 a[180:183], v12, s[12:15], s56 offen offset:512 sc1
buffer_load_dwordx4 a[184:187], v12, s[12:15], s57 offen offset:512 sc1
buffer_load_dwordx4 a[188:191], v12, s[12:15], s56 offen offset:768 sc1
buffer_load_dwordx4 a[192:195], v12, s[12:15], s57 offen offset:768 sc1
v_accvgpr_read_b32 v30, a206
v_accvgpr_read_b32 v31, a207
v_accvgpr_read_b32 v32, a208
v_accvgpr_read_b32 v33, a209
v_accvgpr_read_b32 v34, a210
v_lshlrev_b32 v20, 16, v30
v_and_b32 v21, 0xffff0000, v30
v_lshlrev_b32 v22, 16, v31
v_and_b32 v23, 0xffff0000, v31
v_lshlrev_b32 v24, 16, v32
v_and_b32 v25, 0xffff0000, v32
v_lshlrev_b32 v26, 16, v33
v_and_b32 v27, 0xffff0000, v33
v_lshlrev_b32 v28, 16, v34
v_and_b32 v29, 0xffff0000, v34
s_mul_i32 s68, s67, 18432
s_add_u32 s69, s68, s88
s_add_u32 s70, s68, s89
s_add_u32 s71, s68, s90
s_add_u32 s68, s68, s87
s_waitcnt vmcnt(0)
v_mfma_f32_16x16x32_bf16 v[84:87], a[160:163], a[196:199], 0
v_mfma_f32_16x16x32_bf16 v[76:79], a[152:155], a[164:167], 0
v_mfma_f32_16x16x32_bf16 v[80:83], a[152:155], a[180:183], 0
v_mfma_f32_16x16x32_bf16 v[76:79], a[152:155], a[168:171], v[76:79]
v_mfma_f32_16x16x32_bf16 v[80:83], a[152:155], a[184:187], v[80:83]
v_mfma_f32_16x16x32_bf16 v[76:79], a[156:159], a[172:175], v[76:79]
v_mfma_f32_16x16x32_bf16 v[80:83], a[156:159], a[188:191], v[80:83]
v_mfma_f32_16x16x32_bf16 v[76:79], a[156:159], a[176:179], v[76:79]
v_mfma_f32_16x16x32_bf16 v[80:83], a[156:159], a[192:195], v[80:83]
s_nop 6
v_add_f32 v64, v84, v76
v_add_f32 v64, v64, v80
v_cmp_u_f32 s[62:63], v64, v64
s_nop 0
s_cmp_lg_u64 s[62:63], 0
s_cbranch_scc1 L_kt_rt11
L_kt_rr11:
v_add_f32_dpp v84, v84, v84 row_ror:8 row_mask:0xf bank_mask:0xf
v_add_f32_dpp v85, v85, v85 row_ror:8 row_mask:0xf bank_mask:0xf
v_cvt_pk_bf16_f32 v30, v76, v77
v_cvt_pk_bf16_f32 v31, v78, v79
v_cvt_pk_bf16_f32 v32, v80, v81
v_cvt_pk_bf16_f32 v33, v82, v83
v_cvt_pk_bf16_f32 v34, v84, v85
v_lshlrev_b32 v76, 16, v30
v_and_b32 v77, 0xffff0000, v30
v_lshlrev_b32 v78, 16, v31
v_and_b32 v79, 0xffff0000, v31
v_lshlrev_b32 v80, 16, v32
v_and_b32 v81, 0xffff0000, v32
v_lshlrev_b32 v82, 16, v33
v_and_b32 v83, 0xffff0000, v33
v_lshlrev_b32 v84, 16, v34
v_and_b32 v85, 0xffff0000, v34
v_add_f32 v76, v76, v20
v_add_f32 v77, v77, v21
v_add_f32 v78, v78, v22
v_add_f32 v79, v79, v23
v_add_f32 v80, v80, v24
v_add_f32 v81, v81, v25
v_add_f32 v82, v82, v26
v_add_f32 v83, v83, v27
v_add_f32 v84, v84, v28
v_add_f32 v85, v85, v29
v_cvt_pk_bf16_f32 v30, v76, v77
v_cvt_pk_bf16_f32 v31, v78, v79
v_cvt_pk_bf16_f32 v32, v80, v81
v_cvt_pk_bf16_f32 v33, v82, v83
v_cvt_pk_bf16_f32 v34, v84, v85
buffer_store_dwordx2 v[30:31], v14, s[28:31], s68 offen
buffer_store_dwordx2 v[32:33], v14, s[28:31], s68 offen offset:128
buffer_store_dword v34, v15, s[28:31], s69 offen
s_or_b32 s80, s2, s3
s_mov_b32 s81, 123994112
s_cmp_eq_u32 s80, 0
s_cselect_b64 exec, 1, 0
buffer_store_dword a248, off, s[12:15], s81 sc1
s_mov_b64 exec, -1
L_kt_end:
s_endpgm
L_kt_t2_2:
s_mov_b32 s59, 2
s_branch L_kt_aslow2
L_kt_t2_4:
s_mov_b32 s59, 4
s_branch L_kt_aslow2
L_kt_t2_6:
s_mov_b32 s59, 6
s_branch L_kt_aslow2
L_kt_t2_8:
s_mov_b32 s59, 8
s_branch L_kt_aslow2
L_kt_t2_10:
s_mov_b32 s59, 10
s_branch L_kt_aslow2
L_kt_t2_12:
s_mov_b32 s59, 12
s_branch L_kt_aslow2
L_kt_t2_14:
s_mov_b32 s59, 14
s_branch L_kt_aslow2
L_kt_t2_16:
s_mov_b32 s59, 16
s_branch L_kt_aslow2
L_kt_t3_0:
s_mov_b32 s59, 0
s_branch L_kt_aslow3
L_kt_t3_2:
s_mov_b32 s59, 2
s_branch L_kt_aslow3
L_kt_t3_4:
s_mov_b32 s59, 4
s_branch L_kt_aslow3
L_kt_t3_6:
s_mov_b32 s59, 6
s_branch L_kt_aslow3
L_kt_t3_8:
s_mov_b32 s59, 8
s_branch L_kt_aslow3
L_kt_t3_10:
s_mov_b32 s59, 10
s_branch L_kt_aslow3
L_kt_t3_12:
s_mov_b32 s59, 12
s_branch L_kt_aslow3
L_kt_t3_14:
s_mov_b32 s59, 14
s_branch L_kt_aslow3
L_kt_t3_16:
s_mov_b32 s59, 16
s_branch L_kt_aslow3
L_kt_ft2:
s_mov_b32 s59, 2
s_branch L_kt_fslow
L_kt_ft3:
s_mov_b32 s59, 3
s_branch L_kt_fslow
L_kt_ft4:
s_mov_b32 s59, 4
s_branch L_kt_fslow
L_kt_rt00:
s_mov_b32 s59, 0
s_branch L_kt_rslow
L_kt_rt01:
s_mov_b32 s59, 1
s_branch L_kt_rslow
L_kt_rt11:
s_mov_b32 s59, 2
s_branch L_kt_rslow
L_kt_aslow2:
s_cmp_gt_u32 s59, 0
s_cbranch_scc1 L_kt_as2_0
s_add_u32 s20, s39, 0
s_add_u32 s21, s40, 0
buffer_load_dwordx4 v[160:163], v1, s[12:15], s20 offen offset:0 sc1
buffer_load_dwordx4 v[164:167], v1, s[12:15], s21 offen offset:0 sc1
buffer_load_dwordx4 v[168:171], v1, s[12:15], s20 offen offset:1024 sc1
buffer_load_dwordx4 v[172:175], v1, s[12:15], s21 offen offset:1024 sc1
L_kt_as2_0:
s_cmp_gt_u32 s59, 2
s_cbranch_scc1 L_kt_as2_2
s_add_u32 s20, s39, 2048
s_add_u32 s21, s40, 2048
buffer_load_dwordx4 v[176:179], v1, s[12:15], s20 offen offset:0 sc1
buffer_load_dwordx4 v[180:183], v1, s[12:15], s21 offen offset:0 sc1
buffer_load_dwordx4 v[184:187], v1, s[12:15], s20 offen offset:1024 sc1
buffer_load_dwordx4 v[188:191], v1, s[12:15], s21 offen offset:1024 sc1
L_kt_as2_2:
s_cmp_gt_u32 s59, 4
s_cbranch_scc1 L_kt_as2_4
s_add_u32 s20, s39, 4096
s_add_u32 s21, s40, 4096
buffer_load_dwordx4 v[224:227], v1, s[12:15], s20 offen offset:0 sc1
buffer_load_dwordx4 v[228:231], v1, s[12:15], s21 offen offset:0 sc1
buffer_load_dwordx4 v[232:235], v1, s[12:15], s20 offen offset:1024 sc1
buffer_load_dwordx4 v[236:239], v1, s[12:15], s21 offen offset:1024 sc1
L_kt_as2_4:
s_cmp_gt_u32 s59, 6
s_cbranch_scc1 L_kt_as2_6
s_add_u32 s20, s39, 6144
s_add_u32 s21, s40, 6144
buffer_load_dwordx4 v[240:243], v1, s[12:15], s20 offen offset:0 sc1
buffer_load_dwordx4 v[244:247], v1, s[12:15], s21 offen offset:0 sc1
buffer_load_dwordx4 v[248:251], v1, s[12:15], s20 offen offset:1024 sc1
buffer_load_dwordx4 v[252:255], v1, s[12:15], s21 offen offset:1024 sc1
L_kt_as2_6:
s_cmp_gt_u32 s59, 8
s_cbranch_scc1 L_kt_as2_8
s_add_u32 s20, s39, 8192
s_add_u32 s21, s40, 8192
buffer_load_dwordx4 a[0:3], v1, s[12:15], s20 offen offset:0 sc1
buffer_load_dwordx4 a[4:7], v1, s[12:15], s21 offen offset:0 sc1
buffer_load_dwordx4 a[8:11], v1, s[12:15], s20 offen offset:1024 sc1
buffer_load_dwordx4 a[12:15], v1, s[12:15], s21 offen offset:1024 sc1
L_kt_as2_8:
s_cmp_gt_u32 s59, 10
s_cbranch_scc1 L_kt_as2_10
s_add_u32 s20, s39, 10240
s_add_u32 s21, s40, 10240
buffer_load_dwordx4 a[16:19], v1, s[12:15], s20 offen offset:0 sc1
buffer_load_dwordx4 a[20:23], v1, s[12:15], s21 offen offset:0 sc1
buffer_load_dwordx4 a[24:27], v1, s[12:15], s20 offen offset:1024 sc1
buffer_load_dwordx4 a[28:31], v1, s[12:15], s21 offen offset:1024 sc1
L_kt_as2_10:
s_cmp_gt_u32 s59, 12
s_cbranch_scc1 L_kt_as2_12
s_add_u32 s20, s39, 12288
s_add_u32 s21, s40, 12288
buffer_load_dwordx4 a[32:35], v1, s[12:15], s20 offen offset:0 sc1
buffer_load_dwordx4 a[36:39], v1, s[12:15], s21 offen offset:0 sc1
buffer_load_dwordx4 a[40:43], v1, s[12:15], s20 offen offset:1024 sc1
buffer_load_dwordx4 a[44:47], v1, s[12:15], s21 offen offset:1024 sc1
L_kt_as2_12:
s_cmp_gt_u32 s59, 14
s_cbranch_scc1 L_kt_as2_14
s_add_u32 s20, s39, 14336
s_add_u32 s21, s40, 14336
buffer_load_dwordx4 a[216:219], v1, s[12:15], s20 offen offset:0 sc1
buffer_load_dwordx4 a[220:223], v1, s[12:15], s21 offen offset:0 sc1
buffer_load_dwordx4 a[224:227], v1, s[12:15], s20 offen offset:1024 sc1
buffer_load_dwordx4 a[228:231], v1, s[12:15], s21 offen offset:1024 sc1
L_kt_as2_14:
s_cmp_gt_u32 s59, 16
s_cbranch_scc1 L_kt_as2_16
s_add_u32 s20, s39, 16384
s_add_u32 s21, s40, 16384
buffer_load_dwordx4 a[232:235], v1, s[12:15], s20 offen offset:0 sc1
buffer_load_dwordx4 a[236:239], v1, s[12:15], s21 offen offset:0 sc1
buffer_load_dwordx4 a[240:243], v1, s[12:15], s20 offen offset:1024 sc1
buffer_load_dwordx4 a[244:247], v1, s[12:15], s21 offen offset:1024 sc1
L_kt_as2_16:
s_mov_b64 vcc, 0
s_waitcnt vmcnt(0)
s_cmp_gt_u32 s59, 0
s_cbranch_scc1 L_kt_ac2_0
v_max3_u32 v35, v160, v164, v168
v_max_u32 v35, v35, v172
v_cmp_eq_u32 s[20:21], -1, v35
s_nop 0
s_or_b64 vcc, vcc, s[20:21]
L_kt_ac2_0:
s_cmp_gt_u32 s59, 2
s_cbranch_scc1 L_kt_ac2_2
v_max3_u32 v35, v176, v180, v184
v_max_u32 v35, v35, v188
v_cmp_eq_u32 s[20:21], -1, v35
s_nop 0
s_or_b64 vcc, vcc, s[20:21]
L_kt_ac2_2:
s_cmp_gt_u32 s59, 4
s_cbranch_scc1 L_kt_ac2_4
v_max3_u32 v35, v224, v228, v232
v_max_u32 v35, v35, v236
v_cmp_eq_u32 s[20:21], -1, v35
s_nop 0
s_or_b64 vcc, vcc, s[20:21]
L_kt_ac2_4:
s_cmp_gt_u32 s59, 6
s_cbranch_scc1 L_kt_ac2_6
v_max3_u32 v35, v240, v244, v248
v_max_u32 v35, v35, v252
v_cmp_eq_u32 s[20:21], -1, v35
s_nop 0
s_or_b64 vcc, vcc, s[20:21]
L_kt_ac2_6:
s_cmp_gt_u32 s59, 8
s_cbranch_scc1 L_kt_ac2_8
v_accvgpr_read_b32 v35, a0
v_accvgpr_read_b32 v36, a4
v_accvgpr_read_b32 v37, a8
v_accvgpr_read_b32 v74, a12
v_max3_u32 v35, v35, v36, v37
v_max_u32 v35, v35, v74
v_cmp_eq_u32 s[20:21], -1, v35
s_nop 0
s_or_b64 vcc, vcc, s[20:21]
L_kt_ac2_8:
s_cmp_gt_u32 s59, 10
s_cbranch_scc1 L_kt_ac2_10
v_accvgpr_read_b32 v35, a16
v_accvgpr_read_b32 v36, a20
v_accvgpr_read_b32 v37, a24
v_accvgpr_read_b32 v74, a28
v_max3_u32 v35, v35, v36, v37
v_max_u32 v35, v35, v74
v_cmp_eq_u32 s[20:21], -1, v35
s_nop 0
s_or_b64 vcc, vcc, s[20:21]
L_kt_ac2_10:
s_cmp_gt_u32 s59, 12
s_cbranch_scc1 L_kt_ac2_12
v_accvgpr_read_b32 v35, a32
v_accvgpr_read_b32 v36, a36
v_accvgpr_read_b32 v37, a40
v_accvgpr_read_b32 v74, a44
v_max3_u32 v35, v35, v36, v37
v_max_u32 v35, v35, v74
v_cmp_eq_u32 s[20:21], -1, v35
s_nop 0
s_or_b64 vcc, vcc, s[20:21]
L_kt_ac2_12:
s_cmp_gt_u32 s59, 14
s_cbranch_scc1 L_kt_ac2_14
v_accvgpr_read_b32 v35, a216
v_accvgpr_read_b32 v36, a220
v_accvgpr_read_b32 v37, a224
v_accvgpr_read_b32 v74, a228
v_max3_u32 v35, v35, v36, v37
v_max_u32 v35, v35, v74
v_cmp_eq_u32 s[20:21], -1, v35
s_nop 0
s_or_b64 vcc, vcc, s[20:21]
L_kt_ac2_14:
s_cmp_gt_u32 s59, 16
s_cbranch_scc1 L_kt_ac2_16
v_accvgpr_read_b32 v35, a232
v_accvgpr_read_b32 v36, a236
v_accvgpr_read_b32 v37, a240
v_accvgpr_read_b32 v74, a244
v_max3_u32 v35, v35, v36, v37
v_max_u32 v35, v35, v74
v_cmp_eq_u32 s[20:21], -1, v35
s_nop 0
s_or_b64 vcc, vcc, s[20:21]
L_kt_ac2_16:
s_sub_u32 s58, s58, 1
s_cselect_b32 s58, 0, s58
s_cselect_b64 vcc, 0, vcc
s_cbranch_vccnz L_kt_aslow2
s_cmp_eq_u32 s59, 2
s_cbranch_scc1 L_kt_r2_2
s_cmp_eq_u32 s59, 4
s_cbranch_scc1 L_kt_r2_4
s_cmp_eq_u32 s59, 6
s_cbranch_scc1 L_kt_r2_6
s_cmp_eq_u32 s59, 8
s_cbranch_scc1 L_kt_r2_8
s_cmp_eq_u32 s59, 10
s_cbranch_scc1 L_kt_r2_10
s_cmp_eq_u32 s59, 12
s_cbranch_scc1 L_kt_r2_12
s_cmp_eq_u32 s59, 14
s_cbranch_scc1 L_kt_r2_14
s_branch L_kt_r2_16
L_kt_aslow3:
s_cmp_gt_u32 s59, 0
s_cbranch_scc1 L_kt_as3_0
s_add_u32 s20, s39, 0
s_add_u32 s21, s40, 0
buffer_load_dwordx4 v[192:195], v1, s[12:15], s20 offen offset:0 sc1
buffer_load_dwordx4 v[196:199], v1, s[12:15], s21 offen offset:0 sc1
buffer_load_dwordx4 v[200:203], v1, s[12:15], s20 offen offset:1024 sc1
buffer_load_dwordx4 v[204:207], v1, s[12:15], s21 offen offset:1024 sc1
L_kt_as3_0:
s_cmp_gt_u32 s59, 2
s_cbranch_scc1 L_kt_as3_2
s_add_u32 s20, s39, 2048
s_add_u32 s21, s40, 2048
buffer_load_dwordx4 v[208:211], v1, s[12:15], s20 offen offset:0 sc1
buffer_load_dwordx4 v[212:215], v1, s[12:15], s21 offen offset:0 sc1
buffer_load_dwordx4 v[216:219], v1, s[12:15], s20 offen offset:1024 sc1
buffer_load_dwordx4 v[220:223], v1, s[12:15], s21 offen offset:1024 sc1
L_kt_as3_2:
s_cmp_gt_u32 s59, 4
s_cbranch_scc1 L_kt_as3_4
s_add_u32 s20, s39, 4096
s_add_u32 s21, s40, 4096
buffer_load_dwordx4 v[224:227], v1, s[12:15], s20 offen offset:0 sc1
buffer_load_dwordx4 v[228:231], v1, s[12:15], s21 offen offset:0 sc1
buffer_load_dwordx4 v[232:235], v1, s[12:15], s20 offen offset:1024 sc1
buffer_load_dwordx4 v[236:239], v1, s[12:15], s21 offen offset:1024 sc1
L_kt_as3_4:
s_cmp_gt_u32 s59, 6
s_cbranch_scc1 L_kt_as3_6
s_add_u32 s20, s39, 6144
s_add_u32 s21, s40, 6144
buffer_load_dwordx4 v[240:243], v1, s[12:15], s20 offen offset:0 sc1
buffer_load_dwordx4 v[244:247], v1, s[12:15], s21 offen offset:0 sc1
buffer_load_dwordx4 v[248:251], v1, s[12:15], s20 offen offset:1024 sc1
buffer_load_dwordx4 v[252:255], v1, s[12:15], s21 offen offset:1024 sc1
L_kt_as3_6:
s_cmp_gt_u32 s59, 8
s_cbranch_scc1 L_kt_as3_8
s_add_u32 s20, s39, 8192
s_add_u32 s21, s40, 8192
buffer_load_dwordx4 a[0:3], v1, s[12:15], s20 offen offset:0 sc1
buffer_load_dwordx4 a[4:7], v1, s[12:15], s21 offen offset:0 sc1
buffer_load_dwordx4 a[8:11], v1, s[12:15], s20 offen offset:1024 sc1
buffer_load_dwordx4 a[12:15], v1, s[12:15], s21 offen offset:1024 sc1
L_kt_as3_8:
s_cmp_gt_u32 s59, 10
s_cbranch_scc1 L_kt_as3_10
s_add_u32 s20, s39, 10240
s_add_u32 s21, s40, 10240
buffer_load_dwordx4 a[16:19], v1, s[12:15], s20 offen offset:0 sc1
buffer_load_dwordx4 a[20:23], v1, s[12:15], s21 offen offset:0 sc1
buffer_load_dwordx4 a[24:27], v1, s[12:15], s20 offen offset:1024 sc1
buffer_load_dwordx4 a[28:31], v1, s[12:15], s21 offen offset:1024 sc1
L_kt_as3_10:
s_cmp_gt_u32 s59, 12
s_cbranch_scc1 L_kt_as3_12
s_add_u32 s20, s39, 12288
s_add_u32 s21, s40, 12288
buffer_load_dwordx4 a[32:35], v1, s[12:15], s20 offen offset:0 sc1
buffer_load_dwordx4 a[36:39], v1, s[12:15], s21 offen offset:0 sc1
buffer_load_dwordx4 a[40:43], v1, s[12:15], s20 offen offset:1024 sc1
buffer_load_dwordx4 a[44:47], v1, s[12:15], s21 offen offset:1024 sc1
L_kt_as3_12:
s_cmp_gt_u32 s59, 14
s_cbranch_scc1 L_kt_as3_14
s_add_u32 s20, s39, 14336
s_add_u32 s21, s40, 14336
buffer_load_dwordx4 a[216:219], v1, s[12:15], s20 offen offset:0 sc1
buffer_load_dwordx4 a[220:223], v1, s[12:15], s21 offen offset:0 sc1
buffer_load_dwordx4 a[224:227], v1, s[12:15], s20 offen offset:1024 sc1
buffer_load_dwordx4 a[228:231], v1, s[12:15], s21 offen offset:1024 sc1
L_kt_as3_14:
s_cmp_gt_u32 s59, 16
s_cbranch_scc1 L_kt_as3_16
s_add_u32 s20, s39, 16384
s_add_u32 s21, s40, 16384
buffer_load_dwordx4 a[232:235], v1, s[12:15], s20 offen offset:0 sc1
buffer_load_dwordx4 a[236:239], v1, s[12:15], s21 offen offset:0 sc1
buffer_load_dwordx4 a[240:243], v1, s[12:15], s20 offen offset:1024 sc1
buffer_load_dwordx4 a[244:247], v1, s[12:15], s21 offen offset:1024 sc1
L_kt_as3_16:
s_mov_b64 vcc, 0
s_waitcnt vmcnt(0)
s_cmp_gt_u32 s59, 0
s_cbranch_scc1 L_kt_ac3_0
v_max3_u32 v35, v192, v196, v200
v_max_u32 v35, v35, v204
v_cmp_eq_u32 s[20:21], -1, v35
s_nop 0
s_or_b64 vcc, vcc, s[20:21]
L_kt_ac3_0:
s_cmp_gt_u32 s59, 2
s_cbranch_scc1 L_kt_ac3_2
v_max3_u32 v35, v208, v212, v216
v_max_u32 v35, v35, v220
v_cmp_eq_u32 s[20:21], -1, v35
s_nop 0
s_or_b64 vcc, vcc, s[20:21]
L_kt_ac3_2:
s_cmp_gt_u32 s59, 4
s_cbranch_scc1 L_kt_ac3_4
v_max3_u32 v35, v224, v228, v232
v_max_u32 v35, v35, v236
v_cmp_eq_u32 s[20:21], -1, v35
s_nop 0
s_or_b64 vcc, vcc, s[20:21]
L_kt_ac3_4:
s_cmp_gt_u32 s59, 6
s_cbranch_scc1 L_kt_ac3_6
v_max3_u32 v35, v240, v244, v248
v_max_u32 v35, v35, v252
v_cmp_eq_u32 s[20:21], -1, v35
s_nop 0
s_or_b64 vcc, vcc, s[20:21]
L_kt_ac3_6:
s_cmp_gt_u32 s59, 8
s_cbranch_scc1 L_kt_ac3_8
v_accvgpr_read_b32 v35, a0
v_accvgpr_read_b32 v36, a4
v_accvgpr_read_b32 v37, a8
v_accvgpr_read_b32 v74, a12
v_max3_u32 v35, v35, v36, v37
v_max_u32 v35, v35, v74
v_cmp_eq_u32 s[20:21], -1, v35
s_nop 0
s_or_b64 vcc, vcc, s[20:21]
L_kt_ac3_8:
s_cmp_gt_u32 s59, 10
s_cbranch_scc1 L_kt_ac3_10
v_accvgpr_read_b32 v35, a16
v_accvgpr_read_b32 v36, a20
v_accvgpr_read_b32 v37, a24
v_accvgpr_read_b32 v74, a28
v_max3_u32 v35, v35, v36, v37
v_max_u32 v35, v35, v74
v_cmp_eq_u32 s[20:21], -1, v35
s_nop 0
s_or_b64 vcc, vcc, s[20:21]
L_kt_ac3_10:
s_cmp_gt_u32 s59, 12
s_cbranch_scc1 L_kt_ac3_12
v_accvgpr_read_b32 v35, a32
v_accvgpr_read_b32 v36, a36
v_accvgpr_read_b32 v37, a40
v_accvgpr_read_b32 v74, a44
v_max3_u32 v35, v35, v36, v37
v_max_u32 v35, v35, v74
v_cmp_eq_u32 s[20:21], -1, v35
s_nop 0
s_or_b64 vcc, vcc, s[20:21]
L_kt_ac3_12:
s_cmp_gt_u32 s59, 14
s_cbranch_scc1 L_kt_ac3_14
v_accvgpr_read_b32 v35, a216
v_accvgpr_read_b32 v36, a220
v_accvgpr_read_b32 v37, a224
v_accvgpr_read_b32 v74, a228
v_max3_u32 v35, v35, v36, v37
v_max_u32 v35, v35, v74
v_cmp_eq_u32 s[20:21], -1, v35
s_nop 0
s_or_b64 vcc, vcc, s[20:21]
L_kt_ac3_14:
s_cmp_gt_u32 s59, 16
s_cbranch_scc1 L_kt_ac3_16
v_accvgpr_read_b32 v35, a232
v_accvgpr_read_b32 v36, a236
v_accvgpr_read_b32 v37, a240
v_accvgpr_read_b32 v74, a244
v_max3_u32 v35, v35, v36, v37
v_max_u32 v35, v35, v74
v_cmp_eq_u32 s[20:21], -1, v35
s_nop 0
s_or_b64 vcc, vcc, s[20:21]
L_kt_ac3_16:
s_sub_u32 s58, s58, 1
s_cselect_b32 s58, 0, s58
s_cselect_b64 vcc, 0, vcc
s_cbranch_vccnz L_kt_aslow3
s_cmp_eq_u32 s59, 0
s_cbranch_scc1 L_kt_r3_0
s_cmp_eq_u32 s59, 2
s_cbranch_scc1 L_kt_r3_2
s_cmp_eq_u32 s59, 4
s_cbranch_scc1 L_kt_r3_4
s_cmp_eq_u32 s59, 6
s_cbranch_scc1 L_kt_r3_6
s_cmp_eq_u32 s59, 8
s_cbranch_scc1 L_kt_r3_8
s_cmp_eq_u32 s59, 10
s_cbranch_scc1 L_kt_r3_10
s_cmp_eq_u32 s59, 12
s_cbranch_scc1 L_kt_r3_12
s_cmp_eq_u32 s59, 14
s_cbranch_scc1 L_kt_r3_14
s_branch L_kt_r3_16
L_kt_pas:
buffer_load_dword v37, v18, s[12:15], s7 offen sc1
s_waitcnt vmcnt(0)
s_add_u32 s20, s6, 65536
s_mov_b64 exec, 1
buffer_store_dword a248, off, s[12:15], s20 sc1
s_mov_b64 exec, -1
v_cmp_ne_u32 vcc, s60, v37
s_nop 4
s_cbranch_vccz L_kt_pa3
L_kt_pa2:
buffer_load_dword v37, v18, s[12:15], s7 offen sc1
s_waitcnt vmcnt(0)
v_cmp_ne_u32 vcc, s60, v37
s_sub_u32 s58, s58, 1
s_cselect_b32 s58, 0, s58
s_cselect_b64 vcc, 0, vcc
s_nop 1
s_cbranch_vccnz L_kt_pa2
L_kt_pa3:
s_lshl_b32 s37, s41, 12
s_and_b32 s37, s37, 0x3000
s_add_u32 s37, s37, s85
buffer_load_dwordx4 a[216:219], v1, s[12:15], s37 offen offset:0 sc1
s_add_u32 s38, s37, 18432
buffer_load_dwordx4 a[220:223], v1, s[12:15], s38 offen offset:0 sc1
buffer_load_dwordx4 a[224:227], v1, s[12:15], s37 offen offset:1024 sc1
buffer_load_dwordx4 a[228:231], v1, s[12:15], s38 offen offset:1024 sc1
buffer_load_dwordx4 a[232:235], v1, s[12:15], s37 offen offset:2048 sc1
buffer_load_dwordx4 a[236:239], v1, s[12:15], s38 offen offset:2048 sc1
buffer_load_dwordx4 a[240:243], v1, s[12:15], s37 offen offset:3072 sc1
buffer_load_dwordx4 a[244:247], v1, s[12:15], s38 offen offset:3072 sc1
s_lshl_b32 s37, s41, 10
s_and_b32 s37, s37, 0x3000
s_add_u32 s37, s37, s85
buffer_load_dwordx4 a[0:3], v1, s[12:15], s37 offen offset:0 sc1
s_add_u32 s38, s37, 18432
buffer_load_dwordx4 a[4:7], v1, s[12:15], s38 offen offset:0 sc1
buffer_load_dwordx4 a[8:11], v1, s[12:15], s37 offen offset:1024 sc1
buffer_load_dwordx4 a[12:15], v1, s[12:15], s38 offen offset:1024 sc1
buffer_load_dwordx4 a[16:19], v1, s[12:15], s37 offen offset:2048 sc1
buffer_load_dwordx4 a[20:23], v1, s[12:15], s38 offen offset:2048 sc1
buffer_load_dwordx4 a[24:27], v1, s[12:15], s37 offen offset:3072 sc1
buffer_load_dwordx4 a[28:31], v1, s[12:15], s38 offen offset:3072 sc1
s_waitcnt vmcnt(0)
s_branch L_kt_par
L_kt_pls:
buffer_load_dword v71, v70, s[12:15], s73 offen sc1
s_waitcnt vmcnt(0)
v_cmp_ne_u32 s[62:63], s60, v71
s_sub_u32 s58, s58, 1
s_cselect_b32 s58, 0, s58
s_cselect_b64 s[62:63], 0, s[62:63]
s_cmp_lg_u64 s[62:63], 0
s_cbranch_scc1 L_kt_pls
s_branch L_kt_plr
L_kt_pcs:
buffer_load_dwordx2 v[74:75], v72, s[12:15], s91 offen sc1
s_waitcnt vmcnt(0)
v_cmp_ne_u64 s[62:63], s[60:61], v[74:75]
s_sub_u32 s58, s58, 1
s_cselect_b32 s58, 0, s58
s_cselect_b64 s[62:63], 0, s[62:63]
s_cmp_lg_u64 s[62:63], 0
s_cbranch_scc1 L_kt_pcs
s_branch L_kt_pcr
L_kt_fslow:
s_mov_b64 s[22:23], vcc
L_kt_fs:
buffer_load_dword v8, v7, s[12:15], s91 offen sc1
s_waitcnt vmcnt(0)
v_cmp_ne_u32 vcc, s60, v8
s_sub_u32 s58, s58, 1
s_cselect_b32 s58, 0, s58
s_cselect_b64 vcc, 0, vcc
s_nop 1
s_cbranch_vccnz L_kt_fs
s_mov_b64 vcc, s[22:23]
s_nop 4
s_cmp_eq_u32 s59, 2
s_cbranch_scc1 L_kt_fr2
s_cmp_eq_u32 s59, 3
s_cbranch_scc1 L_kt_fr3
s_branch L_kt_fr4
L_kt_rslow:
s_mov_b64 s[22:23], vcc
L_kt_rs:
s_mov_b64 vcc, 0
v_accvgpr_read_b32 v64, a196
v_accvgpr_read_b32 v65, a197
v_accvgpr_read_b32 v66, a198
v_accvgpr_read_b32 v67, a199
v_max3_u32 v64, v64, v65, v66
v_max_u32 v64, v64, v67
v_cmp_eq_u32 s[20:21], -1, v64
s_nop 0
s_cmp_eq_u64 s[20:21], 0
s_cbranch_scc1 L_kt_rs8
s_mov_b64 exec, s[20:21]
buffer_load_dwordx4 a[196:199], v13, s[12:15], s56 offen offset:1024 sc1
s_mov_b64 vcc, -1
s_mov_b64 exec, -1
L_kt_rs8:
v_accvgpr_read_b32 v64, a164
v_accvgpr_read_b32 v65, a165
v_accvgpr_read_b32 v66, a166
v_accvgpr_read_b32 v67, a167
v_max3_u32 v64, v64, v65, v66
v_max_u32 v64, v64, v67
v_cmp_eq_u32 s[20:21], -1, v64
s_nop 0
s_cmp_eq_u64 s[20:21], 0
s_cbranch_scc1 L_kt_rs0
s_mov_b64 exec, s[20:21]
buffer_load_dwordx4 a[164:167], v12, s[12:15], s56 offen offset:0 sc1
s_mov_b64 vcc, -1
s_mov_b64 exec, -1
L_kt_rs0:
v_accvgpr_read_b32 v64, a168
v_accvgpr_read_b32 v65, a169
v_accvgpr_read_b32 v66, a170
v_accvgpr_read_b32 v67, a171
v_max3_u32 v64, v64, v65, v66
v_max_u32 v64, v64, v67
v_cmp_eq_u32 s[20:21], -1, v64
s_nop 0
s_cmp_eq_u64 s[20:21], 0
s_cbranch_scc1 L_kt_rs1
s_mov_b64 exec, s[20:21]
buffer_load_dwordx4 a[168:171], v12, s[12:15], s57 offen offset:0 sc1
s_mov_b64 vcc, -1
s_mov_b64 exec, -1
L_kt_rs1:
v_accvgpr_read_b32 v64, a172
v_accvgpr_read_b32 v65, a173
v_accvgpr_read_b32 v66, a174
v_accvgpr_read_b32 v67, a175
v_max3_u32 v64, v64, v65, v66
v_max_u32 v64, v64, v67
v_cmp_eq_u32 s[20:21], -1, v64
s_nop 0
s_cmp_eq_u64 s[20:21], 0
s_cbranch_scc1 L_kt_rs2
s_mov_b64 exec, s[20:21]
buffer_load_dwordx4 a[172:175], v12, s[12:15], s56 offen offset:256 sc1
s_mov_b64 vcc, -1
s_mov_b64 exec, -1
L_kt_rs2:
v_accvgpr_read_b32 v64, a176
v_accvgpr_read_b32 v65, a177
v_accvgpr_read_b32 v66, a178
v_accvgpr_read_b32 v67, a179
v_max3_u32 v64, v64, v65, v66
v_max_u32 v64, v64, v67
v_cmp_eq_u32 s[20:21], -1, v64
s_nop 0
s_cmp_eq_u64 s[20:21], 0
s_cbranch_scc1 L_kt_rs3
s_mov_b64 exec, s[20:21]
buffer_load_dwordx4 a[176:179], v12, s[12:15], s57 offen offset:256 sc1
s_mov_b64 vcc, -1
s_mov_b64 exec, -1
L_kt_rs3:
v_accvgpr_read_b32 v64, a180
v_accvgpr_read_b32 v65, a181
v_accvgpr_read_b32 v66, a182
v_accvgpr_read_b32 v67, a183
v_max3_u32 v64, v64, v65, v66
v_max_u32 v64, v64, v67
v_cmp_eq_u32 s[20:21], -1, v64
s_nop 0
s_cmp_eq_u64 s[20:21], 0
s_cbranch_scc1 L_kt_rs4
s_mov_b64 exec, s[20:21]
buffer_load_dwordx4 a[180:183], v12, s[12:15], s56 offen offset:512 sc1
s_mov_b64 vcc, -1
s_mov_b64 exec, -1
L_kt_rs4:
v_accvgpr_read_b32 v64, a184
v_accvgpr_read_b32 v65, a185
v_accvgpr_read_b32 v66, a186
v_accvgpr_read_b32 v67, a187
v_max3_u32 v64, v64, v65, v66
v_max_u32 v64, v64, v67
v_cmp_eq_u32 s[20:21], -1, v64
s_nop 0
s_cmp_eq_u64 s[20:21], 0
s_cbranch_scc1 L_kt_rs5
s_mov_b64 exec, s[20:21]
buffer_load_dwordx4 a[184:187], v12, s[12:15], s57 offen offset:512 sc1
s_mov_b64 vcc, -1
s_mov_b64 exec, -1
L_kt_rs5:
v_accvgpr_read_b32 v64, a188
v_accvgpr_read_b32 v65, a189
v_accvgpr_read_b32 v66, a190
v_accvgpr_read_b32 v67, a191
v_max3_u32 v64, v64, v65, v66
v_max_u32 v64, v64, v67
v_cmp_eq_u32 s[20:21], -1, v64
s_nop 0
s_cmp_eq_u64 s[20:21], 0
s_cbranch_scc1 L_kt_rs6
s_mov_b64 exec, s[20:21]
buffer_load_dwordx4 a[188:191], v12, s[12:15], s56 offen offset:768 sc1
s_mov_b64 vcc, -1
s_mov_b64 exec, -1
L_kt_rs6:
v_accvgpr_read_b32 v64, a192
v_accvgpr_read_b32 v65, a193
v_accvgpr_read_b32 v66, a194
v_accvgpr_read_b32 v67, a195
v_max3_u32 v64, v64, v65, v66
v_max_u32 v64, v64, v67
v_cmp_eq_u32 s[20:21], -1, v64
s_nop 0
s_cmp_eq_u64 s[20:21], 0
s_cbranch_scc1 L_kt_rs7
s_mov_b64 exec, s[20:21]
buffer_load_dwordx4 a[192:195], v12, s[12:15], s57 offen offset:768 sc1
s_mov_b64 vcc, -1
s_mov_b64 exec, -1
L_kt_rs7:
s_waitcnt vmcnt(0)
s_sub_u32 s58, s58, 1
s_cselect_b32 s58, 0, s58
s_cselect_b64 vcc, 0, vcc
s_cbranch_vccnz L_kt_rs
v_mfma_f32_16x16x32_bf16 v[84:87], a[160:163], a[196:199], 0
v_mfma_f32_16x16x32_bf16 v[76:79], a[152:155], a[164:167], 0
v_mfma_f32_16x16x32_bf16 v[80:83], a[152:155], a[180:183], 0
v_mfma_f32_16x16x32_bf16 v[76:79], a[152:155], a[168:171], v[76:79]
v_mfma_f32_16x16x32_bf16 v[80:83], a[152:155], a[184:187], v[80:83]
v_mfma_f32_16x16x32_bf16 v[76:79], a[156:159], a[172:175], v[76:79]
v_mfma_f32_16x16x32_bf16 v[80:83], a[156:159], a[188:191], v[80:83]
v_mfma_f32_16x16x32_bf16 v[76:79], a[156:159], a[176:179], v[76:79]
v_mfma_f32_16x16x32_bf16 v[80:83], a[156:159], a[192:195], v[80:83]
s_mov_b64 vcc, s[22:23]
s_nop 7
L_kt_last:
s_cmp_eq_u32 s59, 0
s_cbranch_scc1 L_kt_rr00
s_cmp_eq_u32 s59, 1
s_cbranch_scc1 L_kt_rr01
s_branch L_kt_rr11
.section .rodata,"a"
.p2align 6
.amdhsa_kernel sequential_preLN__compressed_kv_cla__dense_activation_relu__prompt_kernel
  .amdhsa_next_free_vgpr 512
  .amdhsa_next_free_sgpr 102
  .amdhsa_accum_offset 256
  .amdhsa_group_segment_fixed_size 0
  .amdhsa_kernarg_size 96
  .amdhsa_user_sgpr_count 2
  .amdhsa_user_sgpr_kernarg_segment_ptr 1
  .amdhsa_system_sgpr_workgroup_id_x 1
  .amdhsa_float_denorm_mode_32 3
  .amdhsa_float_denorm_mode_16_64 3
.end_amdhsa_kernel
```
